```python
import torch

def _softmax(x, axis=-1):
    return torch.softmax(x, dim=axis)
def _gelu(x):
    return torch.nn.functional.gelu(x, approximate="tanh")
def _silu(x):
    return torch.nn.functional.silu(x)
def _sigmoid(x):
    return torch.sigmoid(x)
def _layernorm(x, axis=-1, eps=1e-5):
    m = x.mean(dim=axis, keepdim=True)
    v = x.var(dim=axis, keepdim=True, unbiased=False)
    return (x - m) / torch.sqrt(v + eps)
def _scatter_add(tgt, idx, src, axis=0):
    return tgt.clone().index_add_(axis, idx, src)
def _segment_sum(src, seg, n):
    out = torch.zeros((n,) + src.shape[1:], dtype=src.dtype)
    return out.index_add_(0, seg, src)
def _pad(x, pw):
    flat = tuple(v for pair in reversed(pw) for v in pair)
    return torch.nn.functional.pad(x, flat)

kernel_name = 'interleave_layers__ssm_conv_h3__mixer_s_mlp__prompt'

def setup_inputs():

    _w = (lambda a: (lambda t: t.to(torch.bfloat16) if t.is_floating_point() else t)(torch.as_tensor(a)))
    def _A_setup():
        B, S, D = 1, 2048, 1024
        ks = 4
        return {
            "q": _w((lambda *s: torch.randn(*s, dtype=torch.bfloat16) * 0.05)(B, S, D)),
            "k": _w((lambda *s: torch.randn(*s, dtype=torch.bfloat16) * 0.4)(B, S, D)),
            "v": _w((lambda *s: torch.randn(*s, dtype=torch.bfloat16) * 0.4)(B, S, D)),
            "shift_k": _w((lambda *s: torch.randn(*s, dtype=torch.bfloat16) * 0.4)(D, ks) * 0.5),
            "ssm_k": _w((lambda *s: torch.randn(*s, dtype=torch.bfloat16) * 0.4)(D, S) * (1.0 / S ** 0.5)),
            "ssm_D": _w((lambda *s: torch.randn(*s, dtype=torch.bfloat16) * 0.4)(D)),
        }
    _A_in = _A_setup()

    def _B_setup():
        B, S, D, F = 1, 2048, 1024, 3584
        return {
            "x":  _w((lambda *s: torch.randn(*s, dtype=torch.bfloat16) * 0.05)(B, S, D)),
            "w1": _w((lambda *s: torch.randn(*s, dtype=torch.bfloat16) * 1.6)(D, D) * (D ** -0.5)),
            "w2": _w((lambda *s: torch.randn(*s, dtype=torch.bfloat16) * 1.6)(D, D) * (D ** -0.5)),
            "w3": _w((lambda *s: torch.randn(*s, dtype=torch.bfloat16) * 1.6)(D, F) * (D ** -0.5)),
            "w4": _w((lambda *s: torch.randn(*s, dtype=torch.bfloat16) * 1.6)(F, D) * (F ** -0.5)),
        }
    _B_in = _B_setup()

    return {
        "A_q": _A_in["q"],
        "A_k": _A_in["k"],
        "A_v": _A_in["v"],
        "A_shift_k": _A_in["shift_k"],
        "A_ssm_k": _A_in["ssm_k"],
        "A_ssm_D": _A_in["ssm_D"],
        "B_x": _B_in["x"],
        "B_w1": _B_in["w1"],
        "B_w2": _B_in["w2"],
        "B_w3": _B_in["w3"],
        "B_w4": _B_in["w4"],
    }

def reference(A_q, A_k, A_v, A_shift_k, A_ssm_k, A_ssm_D, B_x, B_w1, B_w2, B_w3, B_w4):
    def _A_ref(q, k, v, shift_k, ssm_k, ssm_D):
        B, S, D = q.shape
        ks = shift_k.shape[-1]
        k_pad = _pad(k, ((0, 0), (ks - 1, 0), (0, 0)))
        k_shift = torch.zeros_like(k)
        for t in range(ks):
            k_shift = k_shift + k_pad[:, t:t + S, :] * shift_k[:, ks - 1 - t][None, None, :]
        kv = k_shift * v
        L = 2 * S
        kv_pad = _pad(kv, ((0, 0), (0, S), (0, 0)))
        kf_pad = _pad(ssm_k, ((0, 0), (0, S)))
        kv_f = (lambda x, axes=(-2,-1): torch.fft.rfft2(x.float(), dim=axes))(kv_pad[:, None, :, :], axes=(1, 2))
        kf_f = (lambda x, axes=(-2,-1): torch.fft.rfft2(x.float(), dim=axes))(kf_pad[:, None, :], axes=(1, 2))
        kf_f = (lambda x, *d: x.permute(*d))(kf_f, 1, 2, 0)
        y_f = kv_f * kf_f[None, :, :, :]
        y = (lambda x, s, axes=(-2,-1): torch.fft.irfft2(x, s=s, dim=axes).to(torch.bfloat16))(y_f, (1, L), axes=(1, 2))[:, 0, :S, :]
        y = y + kv * ssm_D[None, None, :]
        return q * y

    def _B_ref(x, w1, w2, w3, w4):
        B, S, D = x.shape
        h = _gelu(_layernorm(x, axis=-1) @ w1)
        c = D // 4
        g0 = _pad(h[:, :, 0*c:1*c], ((0, 0), (1, 0), (0, 0)))[:, :S, :]
        g1 = _pad(h[:, :, 1*c:2*c], ((0, 0), (0, 1), (0, 0)))[:, 1:, :]
        g2 = _pad(h[:, :, 2*c:3*c], ((0, 0), (2, 0), (0, 0)))[:, :S, :]
        g3 = _pad(h[:, :, 3*c:   ], ((0, 0), (0, 2), (0, 0)))[:, 2:, :]
        hs = torch.concatenate([g0, g1, g2, g3], axis=-1) @ w2
        x1 = x + hs
        h2 = _gelu(_layernorm(x1, axis=-1) @ w3) @ w4
        return x1 + h2

    x = A_q
    x = x + _A_ref(_layernorm(x, axis=-1), A_k, A_v, A_shift_k, A_ssm_k, A_ssm_D)
    x = x + _B_ref(_layernorm(x, axis=-1), B_w1, B_w2, B_w3, B_w4)
    x = x + _A_ref(_layernorm(x, axis=-1), A_k, A_v, A_shift_k, A_ssm_k, A_ssm_D)
    x = x + _B_ref(_layernorm(x, axis=-1), B_w1, B_w2, B_w3, B_w4)
    return x
```

```asm
; @launch grid=(256,1,1) block=(512,1,1) lds=163840
.amdgcn_target "amdgcn-amd-amdhsa--gfx950"
.text
.globl interleave_layers__ssm_conv_h3__mixer_s_mlp__prompt_kernel
.p2align 8
.type interleave_layers__ssm_conv_h3__mixer_s_mlp__prompt_kernel,@function
interleave_layers__ssm_conv_h3__mixer_s_mlp__prompt_kernel:
    s_cmp_ge_u32 s2, 256
    s_cbranch_scc1 K_end
    s_load_dwordx8 s[8:15], s[0:1], 8
    s_load_dwordx2 s[6:7], s[0:1], 0
    s_load_dwordx8 s[68:75], s[0:1], 56
    s_load_dwordx2 s[4:5], s[0:1], 104
    s_load_dwordx2 s[84:85], s[0:1], 96
    s_memrealtime s[46:47]
    v_lshrrev_b32 v1, 6, v0
    s_nop 0
    v_readfirstlane_b32 s30, v1
    s_getpc_b64 s[48:49]
K_pc:
    s_lshr_b32 s36, s2, 3
    s_lshl_b32 s36, s36, 12
    v_lshlrev_b32 v252, 3, v0
    v_add_u32 v252, s36, v252
    v_cmp_gt_u32 vcc, K_end-K_pc-8, v252
    s_nop 0
    s_and_saveexec_b64 s[36:37], vcc
    s_cbranch_execz K_3
    v_mov_b32 v253, s49
    v_add_co_u32 v252, vcc, s48, v252
    s_nop 1
    v_addc_co_u32 v253, vcc, 0, v253, vcc
    global_load_dword v250, v[252:253], off
K_3:
    s_mov_b64 exec, -1
    v_bfe_u32 v8, v0, 4, 2
    v_and_b32 v9, 15, v0
    v_lshlrev_b32 v6, 11, v8
    v_lshlrev_b32 v8, 1, v8
    v_xor_b32 v8, v8, v9
    v_lshl_add_u32 v8, v8, 4, v6
    s_and_b32 s34, s2, 7
    s_lshr_b32 s35, s2, 3
    s_lshl_b32 s36, s35, 17
    s_lshl_b32 s37, s34, 8
    s_add_u32 s36, s36, s37
    s_lshl_b32 s37, s30, 6
    s_and_b32 s38, s37, 128
    s_add_u32 s37, s37, 64
    s_and_b32 s37, s37, 128
    v_xor_b32 v6, s38, v8
    v_xor_b32 v7, s37, v8
    s_lshl_b32 s37, s30, 14
    s_add_u32 s37, s37, s36
    s_add_u32 s38, s37, 8192
    s_lshl_b32 s39, s30, 11
    s_mov_b32 s18, 4194304
    s_mov_b32 s19, 0x20000
    s_mov_b32 s22, s18
    s_mov_b32 s23, s19
    s_add_u32 m0, s39, 99328
    s_waitcnt lgkmcnt(0)
    s_mov_b64 s[16:17], s[8:9]
    s_mov_b64 s[20:21], s[10:11]
    buffer_load_dwordx4 v6, s[16:19], s37 offen nt lds
    s_add_u32 m0, m0, 1024
    s_nop 0
    buffer_load_dwordx4 v7, s[16:19], s38 offen nt lds
    s_add_u32 m0, s39, 115712
    s_nop 0
    buffer_load_dwordx4 v6, s[20:23], s37 offen nt lds
    s_add_u32 m0, m0, 1024
    s_nop 0
    buffer_load_dwordx4 v6, s[20:23], s38 offen nt lds
    s_mov_b32 s86, 256
    s_mov_b32 s87, 0x20000
    v_mov_b32 v10, 0
    s_cmp_lg_u32 s30, 0
    s_cbranch_scc1 KV_t0
    s_sub_u32 s36, s36, 8192
    v_add_u32 v8, s36, v8
    s_mov_b32 m0, 98304
    s_nop 0
    buffer_load_dwordx4 v8, s[16:19], 0 offen nt lds
    s_cmp_lg_u32 s2, 0
    s_cbranch_scc1 KV_t0
    s_lshl_b32 s44, s46, 6
    s_or_b32 s44, s44, 1
    v_mov_b32 v9, s44
    s_mov_b64 exec, 1
    buffer_store_dword v9, v10, s[84:87], 0 offen sc1
    s_mov_b64 exec, -1
KV_t0:
    s_lshl_b32 s37, s34, 10
    s_lshl_b32 s38, s30, 7
    s_add_u32 s37, s37, s38
    v_and_b32 v9, 15, v0
    v_lshlrev_b32 v9, 3, v9
    s_mov_b32 s24, s12
    s_mov_b32 s25, s13
    s_mov_b32 s26, 0x2000
    s_mov_b32 s27, 0x20000
    buffer_load_dwordx2 v[12:13], v9, s[24:27], s37 offen
    v_and_b32 v1, 63, v0
    v_lshlrev_b32 v2, 4, v1
    v_lshlrev_b32 v3, 2, v1
    s_and_b32 s32, s2, 7
    s_lshr_b32 s33, s2, 3
    s_and_b32 s28, s32, 2
    s_lshr_b32 s34, s32, 2
    s_or_b32 s28, s28, s34
    s_lshl_b32 s28, s28, 2
    s_and_b32 s34, s33, 3
    s_add_u32 s28, s28, s34
    s_and_b32 s31, s32, 1
    s_lshr_b32 s33, s33, 2
    s_lshl_b32 s29, s31, 3
    s_add_u32 s29, s29, s33
    s_and_b32 s67, s33, 4
    s_mov_b32 s60, 0
    s_mov_b32 s61, 40000
    s_mov_b32 s52, 0
    s_mov_b32 s55, 0
    s_mov_b32 s92, 0
    s_mov_b32 s93, 0
    s_mov_b32 s94, 0
    s_mov_b32 s56, s4
    s_mov_b32 s57, s5
    s_mov_b32 s58, 0xa000000
    s_mov_b32 s59, 0x20000
    s_add_u32 s62, s4, 33554432
    s_addc_u32 s63, s5, 0
    s_cmp_lg_u32 s30, 4
    s_cbranch_scc1 HB_1
    v_add_u32 v14, 162816, v3
    ds_write_b32 v14, v10
HB_1:
    s_mov_b64 s[88:89], s[70:71]
    s_mov_b32 s90, 2097152
    s_mov_b32 s91, 0x20000
    s_lshl3_add_u32 s36, s2, s30
    s_lshl_b32 s36, s36, 10
    s_mov_b64 s[80:81], s[68:69]
    s_mov_b32 s82, 2097152
    s_mov_b32 s83, 0x20000
    s_mov_b32 s50, s36
    v_lshrrev_b32 v14, 3, v1
    v_lshlrev_b32 v118, 11, v14
    v_and_b32 v14, 6, v14
    v_and_b32 v15, 7, v1
    v_xor_b32 v14, v14, v15
    v_lshl_add_u32 v118, v14, 4, v118
    s_lshl_b32 s48, s29, 7
    s_lshl_b32 s36, s30, 14
    s_add_u32 s48, s48, s36
    s_lshl_b32 s49, s30, 10
    s_add_u32 s48, s48, 1048576
    s_and_b32 s41, s30, 3
    s_and_b32 s38, s2, 7
    s_lshl_b32 s38, s38, 5
    s_lshr_b32 s39, s2, 3
    s_add_u32 s38, s38, s39
    s_lshl_b32 s39, s38, 2
    s_add_u32 s39, s39, s41
    s_mul_i32 s40, s41, 24576
    s_lshl_b32 s36, s39, 12
    s_add_u32 s12, s14, s36
    s_addc_u32 s13, s15, 0
    s_mov_b32 s14, 4096
    s_mov_b32 s15, 0x20000
    s_lshr_b32 s45, s30, 2
    s_lshl_b32 s45, s45, 11
    s_add_u32 s36, s45, 0xffffffc0
    v_add_u32 v22, s36, v2
    v_add_u32 v23, 16, v22
    s_add_u32 s36, s45, 0x3c0
    v_add_u32 v24, s36, v2
    v_add_u32 v25, 16, v24
    s_mov_b32 s36, 4032
    v_add_u32 v26, s36, v2
    v_add_u32 v27, 16, v26
    buffer_load_dwordx4 v[28:31], v22, s[12:15], 0 offen nt
    buffer_load_dwordx2 v[32:33], v23, s[12:15], 0 offen nt
    buffer_load_dwordx4 v[34:37], v24, s[12:15], 0 offen nt
    buffer_load_dwordx2 v[38:39], v25, s[12:15], 0 offen nt
    buffer_load_dwordx4 v[40:43], v26, s[12:15], 0 offen nt
    buffer_load_dwordx2 v[44:45], v27, s[12:15], 0 offen nt
    buffer_load_dwordx4 v[240:243], v2, s[88:91], s50 offen
    buffer_load_dwordx4 v[240:243], v2, s[80:83], s50 offen
    v_add_u32 v19, s40, v2
    v_add_u32 v20, s45, v19
    s_load_dwordx2 s[34:35], s[0:1], 40
    s_lshl_b32 s36, s38, 14
    s_add_u32 s36, s36, 25165824
    s_add_u32 s20, s4, s36
    s_addc_u32 s21, s5, 0
    s_mov_b32 s22, 16384
    s_mov_b32 s23, 0x20000
    s_lshl_b32 s36, s30, 6
    v_add_u32 v216, 0, v1
    v_mul_u32_u24 v217, 171, v216
    v_lshrrev_b32 v217, 10, v217
    v_lshlrev_b32 v219, 8, v217
    v_mul_u32_u24 v217, 6, v217
    v_sub_u32 v216, v216, v217
    v_lshl_add_u32 v219, v216, 4, v219
    v_and_b32 v216, 4, v216
    v_lshl_add_u32 v219, v216, 20, v219
    v_add_u32 v219, s36, v219
    v_add_u32 v216, 64, v1
    v_mul_u32_u24 v217, 171, v216
    v_lshrrev_b32 v217, 10, v217
    v_lshlrev_b32 v220, 8, v217
    v_mul_u32_u24 v217, 6, v217
    v_sub_u32 v216, v216, v217
    v_lshl_add_u32 v220, v216, 4, v220
    v_and_b32 v216, 4, v216
    v_lshl_add_u32 v220, v216, 20, v220
    v_add_u32 v220, s36, v220
    v_add_u32 v216, 128, v1
    v_mul_u32_u24 v217, 171, v216
    v_lshrrev_b32 v217, 10, v217
    v_lshlrev_b32 v221, 8, v217
    v_mul_u32_u24 v217, 6, v217
    v_sub_u32 v216, v216, v217
    v_lshl_add_u32 v221, v216, 4, v221
    v_and_b32 v216, 4, v216
    v_lshl_add_u32 v221, v216, 20, v221
    v_add_u32 v221, s36, v221
    s_waitcnt lgkmcnt(0)
    s_lshr_b32 s36, s39, 1
    s_lshl_b32 s36, s36, 2
    s_load_dword s41, s[34:35], s36
    v_and_b32 v224, 15, v1
    v_lshrrev_b32 v225, 4, v1
    v_and_b32 v216, 3, v224
    v_mul_u32_u24 v222, 4160, v216
    v_lshl_add_u32 v222, v225, 4, v222
    v_lshrrev_b32 v216, 2, v224
    v_lshl_add_u32 v222, v216, 3, v222
    v_add_u32 v222, s40, v222
    v_sub_u32 v216, 15, v224
    v_mul_u32_u24 v223, 96, v216
    v_add_u32 v223, s40, v223
    v_lshl_add_u32 v223, v225, 4, v223
    s_lshr_b32 s36, s38, 2
    s_lshl_b32 s36, s36, 12
    s_add_u32 s36, s36, 23330816
    v_lshlrev_b32 v226, 7, v1
    v_add_u32 v226, s36, v226
    v_lshrrev_b32 v14, 2, v1
    v_lshlrev_b32 v74, 7, v14
    v_bfe_u32 v14, v14, 1, 2
    s_and_b32 s35, s30, 2
    v_and_b32 v15, 1, v1
    v_or_b32 v15, s35, v15
    v_xor_b32 v14, v14, v15
    v_lshl_add_u32 v74, v14, 5, v74
    v_and_b32 v14, 2, v1
    v_lshl_add_u32 v74, v14, 2, v74
    s_and_b32 s35, s30, 1
    s_lshl_b32 s35, s35, 4
    s_add_u32 s35, s35, 24576
    v_add_u32 v74, s35, v74
    v_add_u32 v75, 65536, v74
    v_and_b32 v81, 7, v0
    v_lshrrev_b32 v84, 6, v0
    v_lshlrev_b32 v84, 4, v84
    v_bfe_u32 v85, v0, 3, 3
    v_add_u32 v84, v84, v85
    s_lshr_b32 s78, s29, 1
    s_lshl_b32 s78, s78, 16
    s_and_b32 s79, s29, 1
    s_lshl_b32 s79, s79, 7
    s_add_u32 s78, s78, s79
    s_lshr_b32 s79, s30, 1
    s_lshl_b32 s79, s79, 13
    s_add_u32 s78, s78, s79
    v_lshlrev_b32 v78, 8, v84
    v_lshl_add_u32 v78, v81, 4, v78
    v_add_u32 v78, s78, v78
    s_lshl_b32 s78, s28, 7
    s_lshl_b32 s79, s29, 3
    s_add_u32 s78, s78, s79
    v_add_u32 v79, s78, v81
    v_lshlrev_b32 v80, 11, v79
    v_and_b32 v85, 3, v79
    v_lshrrev_b32 v82, 2, v79
    v_lshlrev_b32 v82, 14, v82
    v_lshl_add_u32 v82, v85, 11, v82
    v_lshl_add_u32 v82, v84, 4, v82
    v_lshrrev_b32 v85, 2, v84
    v_lshlrev_b32 v85, 3, v85
    v_and_b32 v84, 3, v84
    v_add_u32 v84, v84, v85
    v_lshl_add_u32 v80, v84, 3, v80
    v_lshlrev_b32 v79, 3, v79
    v_lshl_add_u32 v79, v84, 14, v79
    v_lshrrev_b32 v14, 4, v1
    v_lshlrev_b32 v119, 11, v14
    v_add_u32 v14, 0, v14
    v_lshlrev_b32 v14, 1, v14
    v_and_b32 v15, 15, v1
    v_xor_b32 v14, v14, v15
    v_lshl_add_u32 v119, v14, 4, v119
    v_lshrrev_b32 v14, 4, v1
    v_lshlrev_b32 v120, 11, v14
    v_add_u32 v14, 4, v14
    v_lshlrev_b32 v14, 1, v14
    v_and_b32 v15, 15, v1
    v_xor_b32 v14, v14, v15
    v_lshl_add_u32 v120, v14, 4, v120
    v_add_u32 v15, 0, v1
    v_mul_u32_u24 v14, 2341, v15
    v_lshrrev_b32 v14, 16, v14
    v_mul_u32_u24 v121, 28, v14
    v_sub_u32 v15, v15, v121
    v_mul_u32_u24 v121, 7168, v14
    v_lshrrev_b32 v14, 1, v14
    v_and_b32 v14, 2, v14
    v_xor_b32 v15, v15, v14
    v_lshl_add_u32 v121, v15, 4, v121
    v_add_u32 v15, 64, v1
    v_mul_u32_u24 v14, 2341, v15
    v_lshrrev_b32 v14, 16, v14
    v_mul_u32_u24 v122, 28, v14
    v_sub_u32 v15, v15, v122
    v_mul_u32_u24 v122, 7168, v14
    v_lshrrev_b32 v14, 1, v14
    v_and_b32 v14, 2, v14
    v_xor_b32 v15, v15, v14
    v_lshl_add_u32 v122, v15, 4, v122
    v_add_u32 v15, 128, v1
    v_mul_u32_u24 v14, 2341, v15
    v_lshrrev_b32 v14, 16, v14
    v_mul_u32_u24 v123, 28, v14
    v_sub_u32 v15, v15, v123
    v_mul_u32_u24 v123, 7168, v14
    v_lshrrev_b32 v14, 1, v14
    v_and_b32 v14, 2, v14
    v_xor_b32 v15, v15, v14
    v_lshl_add_u32 v123, v15, 4, v123
    v_add_u32 v15, 192, v1
    v_mul_u32_u24 v14, 2341, v15
    v_lshrrev_b32 v14, 16, v14
    v_mul_u32_u24 v124, 28, v14
    v_sub_u32 v15, v15, v124
    v_mul_u32_u24 v124, 7168, v14
    v_lshrrev_b32 v14, 1, v14
    v_and_b32 v14, 2, v14
    v_xor_b32 v15, v15, v14
    v_lshl_add_u32 v124, v15, 4, v124
    v_add_u32 v15, 256, v1
    v_mul_u32_u24 v14, 2341, v15
    v_lshrrev_b32 v14, 16, v14
    v_mul_u32_u24 v125, 28, v14
    v_sub_u32 v15, v15, v125
    v_mul_u32_u24 v125, 7168, v14
    v_lshrrev_b32 v14, 1, v14
    v_and_b32 v14, 2, v14
    v_xor_b32 v15, v15, v14
    v_lshl_add_u32 v125, v15, 4, v125
    v_add_u32 v15, 320, v1
    v_mul_u32_u24 v14, 2341, v15
    v_lshrrev_b32 v14, 16, v14
    v_mul_u32_u24 v126, 28, v14
    v_sub_u32 v15, v15, v126
    v_mul_u32_u24 v126, 7168, v14
    v_lshrrev_b32 v14, 1, v14
    v_and_b32 v14, 2, v14
    v_xor_b32 v15, v15, v14
    v_lshl_add_u32 v126, v15, 4, v126
    v_add_u32 v15, 384, v1
    v_mul_u32_u24 v14, 2341, v15
    v_lshrrev_b32 v14, 16, v14
    v_mul_u32_u24 v127, 28, v14
    v_sub_u32 v15, v15, v127
    v_mul_u32_u24 v127, 7168, v14
    v_lshrrev_b32 v14, 1, v14
    v_and_b32 v14, 2, v14
    v_xor_b32 v15, v15, v14
    v_lshl_add_u32 v127, v15, 4, v127
    s_waitcnt lgkmcnt(0)
    s_bitcmp1_b32 s39, 0
    s_cselect_b32 s36, 0, 16
    s_lshl_b32 s41, s41, s36
    s_and_b32 s41, s41, 0xffff0000
    s_lshr_b32 s42, s41, 16
    v_lshl_add_u32 v216, v225, 3, v224
    v_sub_u32 v216, 31, v216
    v_and_b32 v217, 1, v216
    v_cmp_eq_u32 vcc, 1, v217
    v_mov_b32 v217, s42
    v_mov_b32 v218, s41
    v_cndmask_b32 v217, v217, v218, vcc
    v_ashrrev_i32 v216, 1, v216
    v_cmp_eq_u32 vcc, 0, v216
    s_nop 1
    v_cndmask_b32 v228, 0, v217, vcc
    v_cmp_eq_u32 vcc, 1, v216
    s_nop 1
    v_cndmask_b32 v229, 0, v217, vcc
    v_cmp_eq_u32 vcc, 2, v216
    s_nop 1
    v_cndmask_b32 v230, 0, v217, vcc
    v_cmp_eq_u32 vcc, 3, v216
    s_nop 1
    v_cndmask_b32 v231, 0, v217, vcc
    v_cmp_eq_u32 vcc, 8, v216
    s_nop 1
    v_cndmask_b32 v232, 0, v217, vcc
    v_cmp_eq_u32 vcc, 9, v216
    s_nop 1
    v_cndmask_b32 v233, 0, v217, vcc
    v_cmp_eq_u32 vcc, 10, v216
    s_nop 1
    v_cndmask_b32 v234, 0, v217, vcc
    v_cmp_eq_u32 vcc, 11, v216
    s_nop 1
    v_cndmask_b32 v235, 0, v217, vcc
    s_mov_b32 s8, s6
    s_mov_b32 s9, s7
    s_mov_b32 s10, 0x400000
    s_mov_b32 s11, 0x20000
    v_mov_b32 v60, 0
    v_mov_b32 v61, 0
    v_mov_b32 v62, 0
    v_mov_b32 v63, 0
    s_lshr_b32 s36, s30, 2
    s_mul_i32 s36, s36, 720
    v_add_u32 v14, s36, v19
    s_bfm_b64 exec, 45, 0
    ds_write_b128 v14, v[60:63] offset:22784
    s_mov_b64 exec, -1
    s_and_b32 s34, s2, 7
    s_lshr_b32 s35, s2, 3
    v_bfe_u32 v14, v1, 2, 3
    v_xor_b32 v14, s30, v14
    v_lshlrev_b32 v16, 5, v14
    v_and_b32 v14, 3, v1
    v_lshl_add_u32 v16, v14, 3, v16
    v_bfe_u32 v14, v1, 2, 2
    v_lshl_add_u32 v16, v14, 8, v16
    v_lshrrev_b32 v14, 4, v1
    v_lshl_add_u32 v16, v14, 12, v16
    v_add_u32 v16, 98304, v16
    v_xor_b32 v17, 128, v16
    s_add_u32 s16, s4, 0x1800000
    s_addc_u32 s17, s5, 0
    s_mov_b32 s18, 0x400000
    s_mov_b32 s19, 0x20000
    v_bfe_u32 v18, v1, 2, 2
    v_lshlrev_b32 v18, 14, v18
    v_and_b32 v14, 3, v1
    v_lshl_add_u32 v18, v14, 6, v18
    v_bfe_u32 v14, v1, 4, 1
    v_lshrrev_b32 v15, 5, v1
    v_lshl_add_u32 v14, v14, 1, v15
    v_xor_b32 v14, 3, v14
    v_lshl_add_u32 v18, v14, 4, v18
    s_lshl3_add_u32 s42, s34, s30
    s_lshl_b32 s43, s42, 16
    s_sub_u32 s37, 31, s35
    s_lshl_b32 s37, s37, 9
    s_add_u32 s43, s43, s37
    s_lshl_b32 s44, s42, 5
    s_add_u32 s44, s44, s35
    s_lshl_b32 s44, s44, 7
    s_add_u32 s44, s44, 23330816
    s_waitcnt vmcnt(8) lgkmcnt(0)
    s_barrier
    ds_read_b64_tr_b16 v[128:129], v16 offset:0
    ds_read_b64_tr_b16 v[130:131], v16 offset:1024
    ds_read_b64_tr_b16 v[132:133], v16 offset:2048
    ds_read_b64_tr_b16 v[134:135], v16 offset:3072
    ds_read_b64_tr_b16 v[136:137], v17 offset:4096
    ds_read_b64_tr_b16 v[138:139], v16 offset:17408
    ds_read_b64_tr_b16 v[140:141], v16 offset:18432
    ds_read_b64_tr_b16 v[142:143], v16 offset:19456
    ds_read_b64_tr_b16 v[144:145], v16 offset:20480
    s_load_dword s52, s[84:85], 0
    v_lshlrev_b32 v46, 16, v12
    v_and_b32 v47, 0xffff0000, v12
    v_lshlrev_b32 v48, 16, v13
    v_and_b32 v49, 0xffff0000, v13
    s_waitcnt lgkmcnt(0)
    v_lshlrev_b32 v146, 16, v128
    v_and_b32 v147, 0xffff0000, v128
    v_lshlrev_b32 v148, 16, v129
    v_and_b32 v149, 0xffff0000, v129
    v_lshlrev_b32 v150, 16, v130
    v_and_b32 v151, 0xffff0000, v130
    v_lshlrev_b32 v152, 16, v131
    v_and_b32 v153, 0xffff0000, v131
    v_lshlrev_b32 v154, 16, v132
    v_and_b32 v155, 0xffff0000, v132
    v_lshlrev_b32 v156, 16, v133
    v_and_b32 v157, 0xffff0000, v133
    v_lshlrev_b32 v158, 16, v134
    v_and_b32 v159, 0xffff0000, v134
    v_lshlrev_b32 v160, 16, v135
    v_and_b32 v161, 0xffff0000, v135
    v_lshlrev_b32 v162, 16, v136
    v_and_b32 v163, 0xffff0000, v136
    v_lshlrev_b32 v164, 16, v137
    v_and_b32 v165, 0xffff0000, v137
    v_mul_f32 v166, v147, v49
    v_mul_f32 v167, v148, v49
    v_mul_f32 v168, v149, v49
    v_mul_f32 v169, v150, v49
    v_mul_f32 v170, v151, v49
    v_mul_f32 v171, v152, v49
    v_mul_f32 v172, v153, v49
    v_mul_f32 v173, v154, v49
    v_mul_f32 v174, v155, v49
    v_mul_f32 v175, v156, v49
    v_mul_f32 v176, v157, v49
    v_mul_f32 v177, v158, v49
    v_mul_f32 v178, v159, v49
    v_mul_f32 v179, v160, v49
    v_mul_f32 v180, v161, v49
    v_mul_f32 v181, v162, v49
    v_fmac_f32 v166, v148, v48
    v_fmac_f32 v167, v149, v48
    v_fmac_f32 v168, v150, v48
    v_fmac_f32 v169, v151, v48
    v_fmac_f32 v170, v152, v48
    v_fmac_f32 v171, v153, v48
    v_fmac_f32 v172, v154, v48
    v_fmac_f32 v173, v155, v48
    v_fmac_f32 v174, v156, v48
    v_fmac_f32 v175, v157, v48
    v_fmac_f32 v176, v158, v48
    v_fmac_f32 v177, v159, v48
    v_fmac_f32 v178, v160, v48
    v_fmac_f32 v179, v161, v48
    v_fmac_f32 v180, v162, v48
    v_fmac_f32 v181, v163, v48
    v_fmac_f32 v166, v149, v47
    v_fmac_f32 v167, v150, v47
    v_fmac_f32 v168, v151, v47
    v_fmac_f32 v169, v152, v47
    v_fmac_f32 v170, v153, v47
    v_fmac_f32 v171, v154, v47
    v_fmac_f32 v172, v155, v47
    v_fmac_f32 v173, v156, v47
    v_fmac_f32 v174, v157, v47
    v_fmac_f32 v175, v158, v47
    v_fmac_f32 v176, v159, v47
    v_fmac_f32 v177, v160, v47
    v_fmac_f32 v178, v161, v47
    v_fmac_f32 v179, v162, v47
    v_fmac_f32 v180, v163, v47
    v_fmac_f32 v181, v164, v47
    v_fmac_f32 v166, v150, v46
    v_fmac_f32 v167, v151, v46
    v_fmac_f32 v168, v152, v46
    v_fmac_f32 v169, v153, v46
    v_fmac_f32 v170, v154, v46
    v_fmac_f32 v171, v155, v46
    v_fmac_f32 v172, v156, v46
    v_fmac_f32 v173, v157, v46
    v_fmac_f32 v174, v158, v46
    v_fmac_f32 v175, v159, v46
    v_fmac_f32 v176, v160, v46
    v_fmac_f32 v177, v161, v46
    v_fmac_f32 v178, v162, v46
    v_fmac_f32 v179, v163, v46
    v_fmac_f32 v180, v164, v46
    v_fmac_f32 v181, v165, v46
    v_lshlrev_b32 v146, 16, v138
    v_and_b32 v147, 0xffff0000, v138
    v_lshlrev_b32 v148, 16, v139
    v_and_b32 v149, 0xffff0000, v139
    v_lshlrev_b32 v150, 16, v140
    v_and_b32 v151, 0xffff0000, v140
    v_lshlrev_b32 v152, 16, v141
    v_and_b32 v153, 0xffff0000, v141
    v_lshlrev_b32 v154, 16, v142
    v_and_b32 v155, 0xffff0000, v142
    v_lshlrev_b32 v156, 16, v143
    v_and_b32 v157, 0xffff0000, v143
    v_lshlrev_b32 v158, 16, v144
    v_and_b32 v159, 0xffff0000, v144
    v_lshlrev_b32 v160, 16, v145
    v_and_b32 v161, 0xffff0000, v145
    v_mul_f32 v166, v166, v146
    v_mul_f32 v167, v167, v147
    v_mul_f32 v168, v168, v148
    v_mul_f32 v169, v169, v149
    v_mul_f32 v170, v170, v150
    v_mul_f32 v171, v171, v151
    v_mul_f32 v172, v172, v152
    v_mul_f32 v173, v173, v153
    v_mul_f32 v174, v174, v154
    v_mul_f32 v175, v175, v155
    v_mul_f32 v176, v176, v156
    v_mul_f32 v177, v177, v157
    v_mul_f32 v178, v178, v158
    v_mul_f32 v179, v179, v159
    v_mul_f32 v180, v180, v160
    v_mul_f32 v181, v181, v161
    v_cvt_pk_bf16_f32 v52, v173, v172
    v_cvt_pk_bf16_f32 v53, v171, v170
    v_cvt_pk_bf16_f32 v54, v169, v168
    v_cvt_pk_bf16_f32 v55, v167, v166
    v_cvt_pk_bf16_f32 v56, v181, v180
    v_cvt_pk_bf16_f32 v57, v179, v178
    v_cvt_pk_bf16_f32 v58, v177, v176
    v_cvt_pk_bf16_f32 v59, v175, v174
    s_cmp_lg_u32 s52, 0
    s_cbranch_scc1 HB_q
    s_mov_b32 s53, 0
HB_p:
    buffer_load_dword v14, v10, s[84:87], 0 offen sc1
    s_waitcnt vmcnt(0)
    v_readfirstlane_b32 s52, v14
    s_nop 0
    s_cmp_lg_u32 s52, 0
    s_cbranch_scc1 HB_q
    s_add_u32 s53, s53, 1
    s_cmp_lt_u32 s53, s61
    s_cbranch_scc1 HB_p
    s_mov_b32 s52, 1
    s_mov_b32 s61, 0
HB_q:
    v_permlane32_swap_b32 v52, v56
    v_permlane32_swap_b32 v53, v57
    v_permlane32_swap_b32 v54, v58
    v_permlane32_swap_b32 v55, v59
    v_mov_b32 v14, s52
    buffer_store_dwordx4 v[52:55], v18, s[16:19], s43 offen offset:256 sc1
    buffer_store_dwordx4 v[56:59], v18, s[16:19], s43 offen offset:0 sc1
    s_lshl_b32 s37, s42, 7
    s_lshl_b32 s53, s35, 13
    s_add_u32 s37, s37, s53
    s_add_u32 s37, s37, 23592960
    s_cmp_ge_u32 s35, 16
    s_cbranch_scc1 KV_ni
    s_mov_b64 exec, 1
    buffer_store_dword v14, v10, s[56:59], s37 offen sc1
    s_mov_b64 exec, -1
KV_ni:
    s_waitcnt vmcnt(4)
    v_alignbit_b32 v128, v29, v28, 16
    v_mov_b32 v132, v29
    v_alignbit_b32 v136, v30, v29, 16
    v_alignbit_b32 v129, v30, v29, 16
    v_mov_b32 v133, v30
    v_alignbit_b32 v137, v31, v30, 16
    v_alignbit_b32 v130, v31, v30, 16
    v_mov_b32 v134, v31
    v_alignbit_b32 v138, v32, v31, 16
    v_alignbit_b32 v131, v32, v31, 16
    v_mov_b32 v135, v32
    v_alignbit_b32 v139, v33, v32, 16
    ds_write_b128 v20, v[128:131] offset:0
    ds_write_b128 v20, v[132:135] offset:4160
    ds_write_b128 v20, v[136:139] offset:8320
    ds_write_b128 v20, v[30:33] offset:12480
    s_waitcnt vmcnt(0)
    s_mov_b64 exec, 1
    buffer_store_dword v14, v10, s[56:59], s44 offen sc1
    s_mov_b64 exec, -1
    v_alignbit_b32 v140, v35, v34, 16
    v_mov_b32 v144, v35
    v_alignbit_b32 v148, v36, v35, 16
    v_alignbit_b32 v141, v36, v35, 16
    v_mov_b32 v145, v36
    v_alignbit_b32 v149, v37, v36, 16
    v_alignbit_b32 v142, v37, v36, 16
    v_mov_b32 v146, v37
    v_alignbit_b32 v150, v38, v37, 16
    v_alignbit_b32 v143, v38, v37, 16
    v_mov_b32 v147, v38
    v_alignbit_b32 v151, v39, v38, 16
    ds_write_b128 v20, v[140:143] offset:1024
    ds_write_b128 v20, v[144:147] offset:5184
    ds_write_b128 v20, v[148:151] offset:9344
    ds_write_b128 v20, v[36:39] offset:13504
    v_alignbit_b32 v152, v41, v40, 16
    v_mov_b32 v156, v41
    v_alignbit_b32 v160, v42, v41, 16
    v_alignbit_b32 v153, v42, v41, 16
    v_mov_b32 v157, v42
    v_alignbit_b32 v161, v43, v42, 16
    v_alignbit_b32 v154, v43, v42, 16
    v_mov_b32 v158, v43
    v_alignbit_b32 v162, v44, v43, 16
    v_alignbit_b32 v155, v44, v43, 16
    v_mov_b32 v159, v44
    v_alignbit_b32 v163, v45, v44, 16
    s_mov_b64 exec, 0xf
    ds_write_b128 v19, v[152:155] offset:4096
    ds_write_b128 v19, v[156:159] offset:8256
    ds_write_b128 v19, v[160:163] offset:12416
    ds_write_b128 v19, v[42:45] offset:16576
    s_mov_b64 exec, -1
    s_waitcnt lgkmcnt(0)
    s_barrier
    s_add_u32 s36, s67, 1
    s_and_b32 s36, s36, 7
    s_lshl_b32 s36, s36, 17
    s_add_u32 s36, s36, s48
    s_add_u32 m0, s49, 98304
    s_nop 0
    buffer_load_dwordx4 v118, s[88:91], s36 offen lds
    s_add_u32 s36, s67, 2
    s_and_b32 s36, s36, 7
    s_lshl_b32 s36, s36, 17
    s_add_u32 s36, s36, s48
    s_add_u32 m0, s49, 106496
    s_nop 0
    buffer_load_dwordx4 v118, s[88:91], s36 offen lds
    s_add_u32 s36, s67, 3
    s_and_b32 s36, s36, 7
    s_lshl_b32 s36, s36, 17
    s_add_u32 s36, s36, s48
    s_add_u32 m0, s49, 114688
    s_nop 0
    buffer_load_dwordx4 v118, s[88:91], s36 offen lds
    s_add_u32 s36, s67, 4
    s_and_b32 s36, s36, 7
    s_lshl_b32 s36, s36, 17
    s_add_u32 s36, s36, s48
    s_add_u32 m0, s49, 122880
    s_nop 0
    buffer_load_dwordx4 v118, s[88:91], s36 offen lds
    s_add_u32 s36, s67, 5
    s_and_b32 s36, s36, 7
    s_lshl_b32 s36, s36, 17
    s_add_u32 s36, s36, s48
    s_add_u32 m0, s49, 131072
    s_nop 0
    buffer_load_dwordx4 v118, s[88:91], s36 offen lds
    s_add_u32 s36, s67, 6
    s_and_b32 s36, s36, 7
    s_lshl_b32 s36, s36, 17
    s_add_u32 s36, s36, s48
    s_add_u32 m0, s49, 139264
    s_nop 0
    buffer_load_dwordx4 v118, s[88:91], s36 offen lds
    s_add_u32 s36, s67, 7
    s_and_b32 s36, s36, 7
    s_lshl_b32 s36, s36, 17
    s_add_u32 s36, s36, s48
    s_add_u32 m0, s49, 147456
    s_nop 0
    buffer_load_dwordx4 v118, s[88:91], s36 offen lds
    s_cmp_ge_u32 s30, 4
    s_cbranch_scc1 FR_b
    s_cmp_lg_u32 s30, 0
    s_cbranch_scc1 CV_w
    s_mov_b32 s53, 0
    s_add_u32 s54, s52, 0
    s_bfm_b64 exec, 32, 0
poll_1:
    buffer_load_dword v8, v226, s[56:59], 0 offen sc1
    s_waitcnt vmcnt(0)
    v_cmp_eq_u32 vcc, s54, v8
    s_nop 0
    s_cmp_eq_u64 vcc, exec
    s_cbranch_scc1 pok_2
    s_sleep 5
    s_add_u32 s53, s53, 1
    s_cmp_lt_u32 s53, s61
    s_cbranch_scc1 poll_1
    s_mov_b32 s61, 0
pok_2:
    s_mov_b64 exec, -1
    v_mov_b32 v8, 162832
    v_mov_b32 v9, 1
    s_waitcnt lgkmcnt(0)
    ds_write_b32 v8, v9
CV_w:
    s_add_u32 m0, s40, 16640
    s_movk_i32 s36, 8192
    v_mov_b32 v8, 162832
spin_3:
    ds_read_b32 v9, v8
    s_waitcnt lgkmcnt(0)
    v_readfirstlane_b32 s53, v9
    s_nop 0
    s_cmp_ge_u32 s53, 1
    s_cbranch_scc0 spin_3
    buffer_load_dwordx4 v219, s[20:23], 0 offen sc1 lds
    s_add_u32 m0, m0, 1024
    s_nop 0
    buffer_load_dwordx4 v220, s[20:23], 0 offen sc1 lds
    s_add_u32 m0, m0, 1024
    s_nop 0
    buffer_load_dwordx4 v221, s[20:23], 0 offen sc1 lds
    s_add_u32 m0, m0, 1024
    s_nop 0
    buffer_load_dwordx4 v219, s[20:23], s36 offen sc1 lds
    s_add_u32 m0, m0, 1024
    s_nop 0
    buffer_load_dwordx4 v220, s[20:23], s36 offen sc1 lds
    s_add_u32 m0, m0, 1024
    s_nop 0
    buffer_load_dwordx4 v221, s[20:23], s36 offen sc1 lds
    s_waitcnt vmcnt(0)
    s_barrier
    buffer_load_dwordx2 v[86:87], v80, s[8:11], 0 offen offset:0 nt
    buffer_load_dwordx2 v[88:89], v80, s[8:11], 0 offen offset:32 nt
    buffer_load_dwordx2 v[90:91], v80, s[8:11], 0 offen offset:128 nt
    buffer_load_dwordx2 v[92:93], v80, s[8:11], 0 offen offset:160 nt
    ds_read_b128 v[184:187], v223 offset:21248
    ds_read_b128 v[188:191], v223 offset:19712
    ds_read_b128 v[192:195], v223 offset:18176
    ds_read_b128 v[196:199], v223 offset:16640
    ds_read_b64 v[120:121], v222 offset:0
    ds_read_b64 v[122:123], v222 offset:8
    ds_read_b64 v[124:125], v222 offset:32
    ds_read_b64 v[126:127], v222 offset:40
    ds_read_b64 v[128:129], v222 offset:1024
    ds_read_b64 v[130:131], v222 offset:1032
    ds_read_b64 v[132:133], v222 offset:1056
    ds_read_b64 v[134:135], v222 offset:1064
    ds_read_b64 v[136:137], v222 offset:2048
    ds_read_b64 v[138:139], v222 offset:2056
    ds_read_b64 v[140:141], v222 offset:2080
    ds_read_b64 v[142:143], v222 offset:2088
    ds_read_b64 v[144:145], v222 offset:3072
    ds_read_b64 v[146:147], v222 offset:3080
    ds_read_b64 v[148:149], v222 offset:3104
    ds_read_b64 v[150:151], v222 offset:3112
    s_waitcnt lgkmcnt(15)
    v_mfma_f32_16x16x32_bf16 v[20:23], v[228:231], v[184:187], 0
    v_mfma_f32_16x16x32_bf16 v[24:27], v[232:235], v[184:187], 0
    v_mfma_f32_16x16x32_bf16 v[28:31], v[228:231], v[188:191], 0
    v_mfma_f32_16x16x32_bf16 v[32:35], v[232:235], v[188:191], 0
    v_mfma_f32_16x16x32_bf16 v[36:39], v[228:231], v[192:195], 0
    v_mfma_f32_16x16x32_bf16 v[40:43], v[232:235], v[192:195], 0
    v_mfma_f32_16x16x32_bf16 v[44:47], v[228:231], v[196:199], 0
    v_mfma_f32_16x16x32_bf16 v[48:51], v[232:235], v[196:199], 0
    s_mov_b32 s43, 0
CV_r:
    s_waitcnt lgkmcnt(0)
    v_mfma_f32_16x16x32_bf16 v[20:23], v[120:123], v[184:187], v[20:23]
    v_mfma_f32_16x16x32_bf16 v[28:31], v[120:123], v[188:191], v[28:31]
    v_mfma_f32_16x16x32_bf16 v[36:39], v[120:123], v[192:195], v[36:39]
    v_mfma_f32_16x16x32_bf16 v[44:47], v[120:123], v[196:199], v[44:47]
    v_mfma_f32_16x16x32_bf16 v[24:27], v[124:127], v[184:187], v[24:27]
    v_mfma_f32_16x16x32_bf16 v[32:35], v[124:127], v[188:191], v[32:35]
    v_mfma_f32_16x16x32_bf16 v[40:43], v[124:127], v[192:195], v[40:43]
    v_mfma_f32_16x16x32_bf16 v[48:51], v[124:127], v[196:199], v[48:51]
    v_mfma_f32_16x16x32_bf16 v[28:31], v[128:131], v[184:187], v[28:31]
    v_mfma_f32_16x16x32_bf16 v[36:39], v[128:131], v[188:191], v[36:39]
    v_mfma_f32_16x16x32_bf16 v[44:47], v[128:131], v[192:195], v[44:47]
    v_mfma_f32_16x16x32_bf16 v[32:35], v[132:135], v[184:187], v[32:35]
    v_mfma_f32_16x16x32_bf16 v[40:43], v[132:135], v[188:191], v[40:43]
    v_mfma_f32_16x16x32_bf16 v[48:51], v[132:135], v[192:195], v[48:51]
    v_mfma_f32_16x16x32_bf16 v[36:39], v[136:139], v[184:187], v[36:39]
    v_mfma_f32_16x16x32_bf16 v[44:47], v[136:139], v[188:191], v[44:47]
    v_mfma_f32_16x16x32_bf16 v[40:43], v[140:143], v[184:187], v[40:43]
    v_mfma_f32_16x16x32_bf16 v[48:51], v[140:143], v[188:191], v[48:51]
    v_mfma_f32_16x16x32_bf16 v[44:47], v[144:147], v[184:187], v[44:47]
    v_mfma_f32_16x16x32_bf16 v[48:51], v[148:151], v[184:187], v[48:51]
    ds_read_b128 v[200:203], v223 offset:21344
    ds_read_b128 v[204:207], v223 offset:19808
    ds_read_b128 v[208:211], v223 offset:18272
    ds_read_b128 v[212:215], v223 offset:16736
    ds_read_b64 v[152:153], v222 offset:64
    ds_read_b64 v[154:155], v222 offset:72
    ds_read_b64 v[156:157], v222 offset:96
    ds_read_b64 v[158:159], v222 offset:104
    ds_read_b64 v[160:161], v222 offset:1088
    ds_read_b64 v[162:163], v222 offset:1096
    ds_read_b64 v[164:165], v222 offset:1120
    ds_read_b64 v[166:167], v222 offset:1128
    ds_read_b64 v[168:169], v222 offset:2112
    ds_read_b64 v[170:171], v222 offset:2120
    ds_read_b64 v[172:173], v222 offset:2144
    ds_read_b64 v[174:175], v222 offset:2152
    ds_read_b64 v[176:177], v222 offset:3136
    ds_read_b64 v[178:179], v222 offset:3144
    ds_read_b64 v[180:181], v222 offset:3168
    ds_read_b64 v[182:183], v222 offset:3176
    s_waitcnt lgkmcnt(0)
    v_mfma_f32_16x16x32_bf16 v[20:23], v[152:155], v[200:203], v[20:23]
    v_mfma_f32_16x16x32_bf16 v[28:31], v[152:155], v[204:207], v[28:31]
    v_mfma_f32_16x16x32_bf16 v[36:39], v[152:155], v[208:211], v[36:39]
    v_mfma_f32_16x16x32_bf16 v[44:47], v[152:155], v[212:215], v[44:47]
    v_mfma_f32_16x16x32_bf16 v[24:27], v[156:159], v[200:203], v[24:27]
    v_mfma_f32_16x16x32_bf16 v[32:35], v[156:159], v[204:207], v[32:35]
    v_mfma_f32_16x16x32_bf16 v[40:43], v[156:159], v[208:211], v[40:43]
    v_mfma_f32_16x16x32_bf16 v[48:51], v[156:159], v[212:215], v[48:51]
    v_mfma_f32_16x16x32_bf16 v[28:31], v[160:163], v[200:203], v[28:31]
    v_mfma_f32_16x16x32_bf16 v[36:39], v[160:163], v[204:207], v[36:39]
    v_mfma_f32_16x16x32_bf16 v[44:47], v[160:163], v[208:211], v[44:47]
    v_mfma_f32_16x16x32_bf16 v[32:35], v[164:167], v[200:203], v[32:35]
    v_mfma_f32_16x16x32_bf16 v[40:43], v[164:167], v[204:207], v[40:43]
    v_mfma_f32_16x16x32_bf16 v[48:51], v[164:167], v[208:211], v[48:51]
    v_mfma_f32_16x16x32_bf16 v[36:39], v[168:171], v[200:203], v[36:39]
    v_mfma_f32_16x16x32_bf16 v[44:47], v[168:171], v[204:207], v[44:47]
    v_mfma_f32_16x16x32_bf16 v[40:43], v[172:175], v[200:203], v[40:43]
    v_mfma_f32_16x16x32_bf16 v[48:51], v[172:175], v[204:207], v[48:51]
    v_mfma_f32_16x16x32_bf16 v[44:47], v[176:179], v[200:203], v[44:47]
    v_mfma_f32_16x16x32_bf16 v[48:51], v[180:183], v[200:203], v[48:51]
    ds_read_b128 v[184:187], v223 offset:21440
    ds_read_b128 v[188:191], v223 offset:19904
    ds_read_b128 v[192:195], v223 offset:18368
    ds_read_b128 v[196:199], v223 offset:16832
    ds_read_b64 v[120:121], v222 offset:128
    ds_read_b64 v[122:123], v222 offset:136
    ds_read_b64 v[124:125], v222 offset:160
    ds_read_b64 v[126:127], v222 offset:168
    ds_read_b64 v[128:129], v222 offset:1152
    ds_read_b64 v[130:131], v222 offset:1160
    ds_read_b64 v[132:133], v222 offset:1184
    ds_read_b64 v[134:135], v222 offset:1192
    ds_read_b64 v[136:137], v222 offset:2176
    ds_read_b64 v[138:139], v222 offset:2184
    ds_read_b64 v[140:141], v222 offset:2208
    ds_read_b64 v[142:143], v222 offset:2216
    ds_read_b64 v[144:145], v222 offset:3200
    ds_read_b64 v[146:147], v222 offset:3208
    ds_read_b64 v[148:149], v222 offset:3232
    ds_read_b64 v[150:151], v222 offset:3240
    v_add_u32 v222, 128, v222
    v_add_u32 v223, 192, v223
    s_add_u32 s43, s43, 1
    s_cmp_lt_u32 s43, 3
    s_cbranch_scc1 CV_r
CV_l:
    s_waitcnt lgkmcnt(0)
    v_mfma_f32_16x16x32_bf16 v[20:23], v[120:123], v[184:187], v[20:23]
    ds_read_b128 v[200:203], v223 offset:21344
    ds_read_b128 v[204:207], v223 offset:19808
    v_mfma_f32_16x16x32_bf16 v[28:31], v[120:123], v[188:191], v[28:31]
    ds_read_b128 v[208:211], v223 offset:18272
    v_mfma_f32_16x16x32_bf16 v[36:39], v[120:123], v[192:195], v[36:39]
    ds_read_b128 v[212:215], v223 offset:16736
    v_mfma_f32_16x16x32_bf16 v[44:47], v[120:123], v[196:199], v[44:47]
    ds_read_b64 v[152:153], v222 offset:64
    ds_read_b64 v[154:155], v222 offset:72
    v_mfma_f32_16x16x32_bf16 v[24:27], v[124:127], v[184:187], v[24:27]
    ds_read_b64 v[156:157], v222 offset:96
    v_mfma_f32_16x16x32_bf16 v[32:35], v[124:127], v[188:191], v[32:35]
    ds_read_b64 v[158:159], v222 offset:104
    v_mfma_f32_16x16x32_bf16 v[40:43], v[124:127], v[192:195], v[40:43]
    ds_read_b64 v[160:161], v222 offset:1088
    ds_read_b64 v[162:163], v222 offset:1096
    v_mfma_f32_16x16x32_bf16 v[48:51], v[124:127], v[196:199], v[48:51]
    ds_read_b64 v[164:165], v222 offset:1120
    v_mfma_f32_16x16x32_bf16 v[28:31], v[128:131], v[184:187], v[28:31]
    ds_read_b64 v[166:167], v222 offset:1128
    v_mfma_f32_16x16x32_bf16 v[36:39], v[128:131], v[188:191], v[36:39]
    ds_read_b64 v[168:169], v222 offset:2112
    ds_read_b64 v[170:171], v222 offset:2120
    v_mfma_f32_16x16x32_bf16 v[44:47], v[128:131], v[192:195], v[44:47]
    ds_read_b64 v[172:173], v222 offset:2144
    v_mfma_f32_16x16x32_bf16 v[32:35], v[132:135], v[184:187], v[32:35]
    ds_read_b64 v[174:175], v222 offset:2152
    v_mfma_f32_16x16x32_bf16 v[40:43], v[132:135], v[188:191], v[40:43]
    ds_read_b64 v[176:177], v222 offset:3136
    ds_read_b64 v[178:179], v222 offset:3144
    v_mfma_f32_16x16x32_bf16 v[48:51], v[132:135], v[192:195], v[48:51]
    ds_read_b64 v[180:181], v222 offset:3168
    v_mfma_f32_16x16x32_bf16 v[36:39], v[136:139], v[184:187], v[36:39]
    ds_read_b64 v[182:183], v222 offset:3176
    v_mfma_f32_16x16x32_bf16 v[44:47], v[136:139], v[188:191], v[44:47]
    v_mfma_f32_16x16x32_bf16 v[40:43], v[140:143], v[184:187], v[40:43]
    v_mfma_f32_16x16x32_bf16 v[48:51], v[140:143], v[188:191], v[48:51]
    v_mfma_f32_16x16x32_bf16 v[44:47], v[144:147], v[184:187], v[44:47]
    v_mfma_f32_16x16x32_bf16 v[48:51], v[148:151], v[184:187], v[48:51]
    s_waitcnt lgkmcnt(0)
    v_mfma_f32_16x16x32_bf16 v[20:23], v[152:155], v[200:203], v[20:23]
    ds_read_b128 v[184:187], v223 offset:21440
    ds_read_b128 v[188:191], v223 offset:19904
    v_mfma_f32_16x16x32_bf16 v[28:31], v[152:155], v[204:207], v[28:31]
    ds_read_b128 v[192:195], v223 offset:18368
    v_mfma_f32_16x16x32_bf16 v[36:39], v[152:155], v[208:211], v[36:39]
    ds_read_b128 v[196:199], v223 offset:16832
    v_mfma_f32_16x16x32_bf16 v[44:47], v[152:155], v[212:215], v[44:47]
    ds_read_b64 v[120:121], v222 offset:128
    ds_read_b64 v[122:123], v222 offset:136
    v_mfma_f32_16x16x32_bf16 v[24:27], v[156:159], v[200:203], v[24:27]
    ds_read_b64 v[124:125], v222 offset:160
    v_mfma_f32_16x16x32_bf16 v[32:35], v[156:159], v[204:207], v[32:35]
    ds_read_b64 v[126:127], v222 offset:168
    v_mfma_f32_16x16x32_bf16 v[40:43], v[156:159], v[208:211], v[40:43]
    ds_read_b64 v[128:129], v222 offset:1152
    ds_read_b64 v[130:131], v222 offset:1160
    v_mfma_f32_16x16x32_bf16 v[48:51], v[156:159], v[212:215], v[48:51]
    ds_read_b64 v[132:133], v222 offset:1184
    v_mfma_f32_16x16x32_bf16 v[28:31], v[160:163], v[200:203], v[28:31]
    ds_read_b64 v[134:135], v222 offset:1192
    v_mfma_f32_16x16x32_bf16 v[36:39], v[160:163], v[204:207], v[36:39]
    ds_read_b64 v[136:137], v222 offset:2176
    ds_read_b64 v[138:139], v222 offset:2184
    v_mfma_f32_16x16x32_bf16 v[44:47], v[160:163], v[208:211], v[44:47]
    ds_read_b64 v[140:141], v222 offset:2208
    v_mfma_f32_16x16x32_bf16 v[32:35], v[164:167], v[200:203], v[32:35]
    ds_read_b64 v[142:143], v222 offset:2216
    v_mfma_f32_16x16x32_bf16 v[40:43], v[164:167], v[204:207], v[40:43]
    ds_read_b64 v[144:145], v222 offset:3200
    ds_read_b64 v[146:147], v222 offset:3208
    v_mfma_f32_16x16x32_bf16 v[48:51], v[164:167], v[208:211], v[48:51]
    ds_read_b64 v[148:149], v222 offset:3232
    v_mfma_f32_16x16x32_bf16 v[36:39], v[168:171], v[200:203], v[36:39]
    ds_read_b64 v[150:151], v222 offset:3240
    v_mfma_f32_16x16x32_bf16 v[44:47], v[168:171], v[204:207], v[44:47]
    v_add_u32 v222, 128, v222
    v_add_u32 v223, 192, v223
    v_mfma_f32_16x16x32_bf16 v[40:43], v[172:175], v[200:203], v[40:43]
    s_add_u32 s43, s43, 1
    v_mfma_f32_16x16x32_bf16 v[48:51], v[172:175], v[204:207], v[48:51]
    s_cmp_lt_u32 s43, 8
    v_mfma_f32_16x16x32_bf16 v[44:47], v[176:179], v[200:203], v[44:47]
    v_mfma_f32_16x16x32_bf16 v[48:51], v[180:183], v[200:203], v[48:51]
    s_cbranch_scc1 CV_l
    s_mul_i32 s36, s30, 24640
    v_mul_u32_u24 v12, 72, v224
    v_lshl_add_u32 v12, v225, 2, v12
    v_add_u32 v12, s36, v12
    v_add_u32 v13, 1152, v12
    v_add_u32 v14, 2304, v12
    v_add_u32 v15, 3456, v12
    v_bfe_u32 v6, v1, 2, 2
    v_mul_u32_u24 v16, 24640, v6
    v_mul_u32_u24 v6, 72, v225
    v_add_u32 v16, v16, v6
    v_and_b32 v6, 3, v1
    v_lshl_add_u32 v16, v6, 3, v16
    s_mul_i32 s36, s30, 1152
    v_add_u32 v16, s36, v16
    s_waitcnt lgkmcnt(0)
    v_cvt_pk_bf16_f32 v20, v20, v22
    v_cvt_pk_bf16_f32 v21, v21, v23
    ds_write2_b32 v12, v20, v21 offset0:0 offset1:8
    v_cvt_pk_bf16_f32 v24, v24, v26
    v_cvt_pk_bf16_f32 v25, v25, v27
    ds_write2_b32 v12, v24, v25 offset0:4 offset1:12
    v_cvt_pk_bf16_f32 v28, v28, v30
    v_cvt_pk_bf16_f32 v29, v29, v31
    ds_write2_b32 v13, v28, v29 offset0:0 offset1:8
    v_cvt_pk_bf16_f32 v32, v32, v34
    v_cvt_pk_bf16_f32 v33, v33, v35
    ds_write2_b32 v13, v32, v33 offset0:4 offset1:12
    v_cvt_pk_bf16_f32 v36, v36, v38
    v_cvt_pk_bf16_f32 v37, v37, v39
    ds_write2_b32 v14, v36, v37 offset0:0 offset1:8
    v_cvt_pk_bf16_f32 v40, v40, v42
    v_cvt_pk_bf16_f32 v41, v41, v43
    ds_write2_b32 v14, v40, v41 offset0:4 offset1:12
    v_cvt_pk_bf16_f32 v44, v44, v46
    v_cvt_pk_bf16_f32 v45, v45, v47
    ds_write2_b32 v15, v44, v45 offset0:0 offset1:8
    v_cvt_pk_bf16_f32 v48, v48, v50
    v_cvt_pk_bf16_f32 v49, v49, v51
    ds_write2_b32 v15, v48, v49 offset0:4 offset1:12
    s_add_u32 s12, s4, 0x1c00000
    s_addc_u32 s13, s5, 0
    s_mov_b32 s14, 0x400000
    s_mov_b32 s15, 0x20000
    s_lshl_b32 s36, s38, 14
    s_lshl_b32 s37, s30, 12
    s_add_u32 s36, s36, s37
    v_mov_b32 v8, 162824
    v_mov_b32 v9, 1
    s_waitcnt lgkmcnt(0)
    s_mov_b64 exec, 1
    ds_add_u32 v8, v9
    s_mov_b64 exec, -1
    v_mov_b32 v8, 162824
spin_4:
    ds_read_b32 v9, v8
    s_waitcnt lgkmcnt(0)
    v_readfirstlane_b32 s53, v9
    s_nop 0
    s_cmp_ge_u32 s53, 4
    s_cbranch_scc0 spin_4
    ds_read_b64_tr_b16 v[120:121], v16 offset:0
    ds_read_b64_tr_b16 v[122:123], v16 offset:32
    ds_read_b64_tr_b16 v[124:125], v16 offset:288
    ds_read_b64_tr_b16 v[126:127], v16 offset:320
    ds_read_b64_tr_b16 v[128:129], v16 offset:576
    ds_read_b64_tr_b16 v[130:131], v16 offset:608
    ds_read_b64_tr_b16 v[132:133], v16 offset:864
    ds_read_b64_tr_b16 v[134:135], v16 offset:896
    s_waitcnt lgkmcnt(6)
    buffer_store_dwordx4 v[120:123], v2, s[12:15], s36 offen offset:0 sc1
    s_waitcnt lgkmcnt(4)
    buffer_store_dwordx4 v[124:127], v2, s[12:15], s36 offen offset:1024 sc1
    s_waitcnt lgkmcnt(2)
    buffer_store_dwordx4 v[128:131], v2, s[12:15], s36 offen offset:2048 sc1
    s_waitcnt lgkmcnt(0)
    buffer_store_dwordx4 v[132:135], v2, s[12:15], s36 offen offset:3072 sc1
    v_mov_b32 v6, 162840
    v_mov_b32 v7, 1
    s_waitcnt lgkmcnt(0)
    s_mov_b64 exec, 1
    ds_add_u32 v6, v7
    s_mov_b64 exec, -1
    s_and_b32 s36, s2, 7
    s_lshr_b32 s53, s2, 5
    s_lshl3_add_u32 s36, s36, s53
    s_lshl_b32 s36, s36, 7
    s_add_u32 s36, s36, 23592960
    v_mov_b32 v6, 1
    v_mov_b32 v7, 162820
    v_lshlrev_b32 v9, 13, v1
    s_mov_b64 exec, 1
    s_waitcnt vmcnt(0)
    s_waitcnt lgkmcnt(0)
    ds_add_rtn_u32 v8, v7, v6
    ds_read_b32 v10, v7 offset:28
    s_waitcnt lgkmcnt(0)
    v_readfirstlane_b32 s54, v8
    v_readfirstlane_b32 s53, v10
    s_cmp_lg_u32 s54, 7
    s_cbranch_scc1 fa_5
    s_mov_b64 exec, 0xffff
    s_or_b32 s53, s53, 1
    v_mov_b32 v6, s53
    buffer_atomic_add v6, v9, s[56:59], s36 offen sc1
fa_5:
    s_mov_b64 exec, -1
    s_branch FR_end
FR_b:
    s_and_b32 s36, s30, 3
    s_lshl_b32 s36, s36, 14
    s_lshl_b32 s48, s29, 7
    s_add_u32 s48, s48, s36
    s_waitcnt vmcnt(0)
    s_barrier
    ds_read_b64_tr_b16 v[148:149], v75 offset:8192
    ds_read_b64_tr_b16 v[150:151], v75 offset:10240
    ds_read_b64_tr_b16 v[156:157], v75 offset:12288
    ds_read_b64_tr_b16 v[158:159], v75 offset:14336
    ds_read_b64_tr_b16 v[164:165], v75 offset:16384
    ds_read_b64_tr_b16 v[166:167], v75 offset:18432
    ds_read_b64_tr_b16 v[172:173], v75 offset:20480
    ds_read_b64_tr_b16 v[174:175], v75 offset:22528
    ds_read_b64_tr_b16 v[180:181], v75 offset:24576
    ds_read_b64_tr_b16 v[182:183], v75 offset:26624
    ds_read_b64_tr_b16 v[188:189], v75 offset:28672
    ds_read_b64_tr_b16 v[190:191], v75 offset:30720
    ds_read_b64_tr_b16 v[196:197], v75 offset:32768
    ds_read_b64_tr_b16 v[198:199], v75 offset:34816
    ds_read_b64_tr_b16 v[204:205], v75 offset:36864
    ds_read_b64_tr_b16 v[206:207], v75 offset:38912
    ds_read_b64_tr_b16 v[212:213], v75 offset:40960
    ds_read_b64_tr_b16 v[214:215], v75 offset:43008
    ds_read_b64_tr_b16 v[220:221], v75 offset:45056
    ds_read_b64_tr_b16 v[222:223], v75 offset:47104
    ds_read_b64_tr_b16 v[228:229], v75 offset:49152
    ds_read_b64_tr_b16 v[230:231], v75 offset:51200
    ds_read_b64_tr_b16 v[236:237], v75 offset:53248
    ds_read_b64_tr_b16 v[238:239], v75 offset:55296
    ds_read_b64_tr_b16 v[244:245], v75 offset:57344
    ds_read_b64_tr_b16 v[246:247], v75 offset:59392
    ds_read_b64_tr_b16 v[252:253], v75 offset:61440
    ds_read_b64_tr_b16 v[254:255], v75 offset:63488
    s_cmp_lg_u32 s30, 4
    s_cbranch_scc1 FB_ni
    v_mov_b32 v8, s52
    s_lshr_b32 s53, s28, 3
    s_lshl_b32 s53, s53, 2
    s_and_b32 s54, s28, 3
    s_add_u32 s53, s53, s54
    s_lshl_b32 s53, s53, 23
    s_lshr_b32 s54, s28, 2
    s_xor_b32 s54, s54, s94
    s_and_b32 s54, s54, 1
    s_lshl_b32 s54, s54, 13
    s_add_u32 s37, s53, s54
    s_add_u32 s37, s37, 33554432
    s_andn2_b32 s37, s37, 0x2000
    s_lshl_b32 s53, s29, 7
    s_add_u32 s37, s37, s53
    s_add_u32 s37, s37, 1835008
    v_and_b32 v9, 1, v1
    v_lshlrev_b32 v9, 13, v9
    v_bfe_u32 v10, v1, 1, 1
    v_lshl_add_u32 v9, v10, 26, v9
    v_lshrrev_b32 v10, 2, v1
    v_lshl_add_u32 v9, v10, 11, v9
    s_mov_b64 exec, 0xff
    buffer_store_dword v8, v9, s[56:59], s37 offen sc1
    s_cmp_lg_u32 s28, 0
    s_cbranch_scc1 FB_n2
    s_add_u32 s37, s53, 23068672
    s_mov_b64 exec, 1
    buffer_store_dword v8, v9, s[56:59], s37 offen sc1
FB_n2:
    s_mov_b64 exec, -1
FB_ni:
    s_cmp_ge_u32 s2, 255
    s_cbranch_scc1 KV_n3
    s_cmp_lg_u32 s30, 5
    s_cbranch_scc1 KV_n3
    s_and_b32 s42, s2, 31
    s_lshl_b32 s42, s42, 8
    s_lshr_b32 s43, s2, 5
    s_lshl_b32 s43, s43, 14
    s_add_u32 s42, s42, s43
    s_add_u32 s42, s42, 35520512
    v_and_b32 v8, 1, v1
    v_lshlrev_b32 v8, 13, v8
    v_lshrrev_b32 v9, 1, v1
    v_lshl_add_u32 v8, v9, 7, v8
    s_mov_b64 exec, 0xf
    buffer_store_dword v8, v8, s[56:59], s42 offen sc1
    s_mov_b64 exec, -1
KV_n3:
    buffer_load_dwordx2 v[86:87], v80, s[8:11], 0 offen offset:0 nt
    buffer_load_dwordx2 v[88:89], v80, s[8:11], 0 offen offset:32 nt
    buffer_load_dwordx2 v[90:91], v80, s[8:11], 0 offen offset:128 nt
    buffer_load_dwordx2 v[92:93], v80, s[8:11], 0 offen offset:160 nt
    s_add_u32 s36, s67, 0
    s_and_b32 s36, s36, 7
    s_lshl_b32 s36, s36, 17
    s_add_u32 s36, s36, s48
    buffer_load_dwordx4 v[128:131], v118, s[88:91], s36 offen
    s_add_u32 s36, s36, 65536
    buffer_load_dwordx4 v[136:139], v118, s[88:91], s36 offen
    s_add_u32 s36, s67, 1
    s_and_b32 s36, s36, 7
    s_lshl_b32 s36, s36, 17
    s_add_u32 s36, s36, s48
    buffer_load_dwordx4 v[144:147], v118, s[88:91], s36 offen
    s_add_u32 s36, s36, 65536
    buffer_load_dwordx4 v[152:155], v118, s[88:91], s36 offen
    s_add_u32 s36, s67, 2
    s_and_b32 s36, s36, 7
    s_lshl_b32 s36, s36, 17
    s_add_u32 s36, s36, s48
    buffer_load_dwordx4 v[160:163], v118, s[88:91], s36 offen
    s_add_u32 s36, s36, 65536
    buffer_load_dwordx4 v[168:171], v118, s[88:91], s36 offen
    s_add_u32 s36, s67, 3
    s_and_b32 s36, s36, 7
    s_lshl_b32 s36, s36, 17
    s_add_u32 s36, s36, s48
    buffer_load_dwordx4 v[176:179], v118, s[88:91], s36 offen
    s_add_u32 s36, s36, 65536
    buffer_load_dwordx4 v[184:187], v118, s[88:91], s36 offen
    s_add_u32 s36, s67, 4
    s_and_b32 s36, s36, 7
    s_lshl_b32 s36, s36, 17
    s_add_u32 s36, s36, s48
    buffer_load_dwordx4 v[192:195], v118, s[88:91], s36 offen
    s_add_u32 s36, s36, 65536
    buffer_load_dwordx4 v[200:203], v118, s[88:91], s36 offen
    s_add_u32 s36, s67, 5
    s_and_b32 s36, s36, 7
    s_lshl_b32 s36, s36, 17
    s_add_u32 s36, s36, s48
    buffer_load_dwordx4 v[208:211], v118, s[88:91], s36 offen
    s_add_u32 s36, s36, 65536
    buffer_load_dwordx4 v[216:219], v118, s[88:91], s36 offen
    s_add_u32 s36, s67, 6
    s_and_b32 s36, s36, 7
    s_lshl_b32 s36, s36, 17
    s_add_u32 s36, s36, s48
    buffer_load_dwordx4 v[224:227], v118, s[88:91], s36 offen
    s_add_u32 s36, s36, 65536
    buffer_load_dwordx4 v[232:235], v118, s[88:91], s36 offen
    s_add_u32 s36, s67, 7
    s_and_b32 s36, s36, 7
    s_lshl_b32 s36, s36, 17
    s_add_u32 s36, s36, s48
    buffer_load_dwordx4 v[240:243], v118, s[88:91], s36 offen
    s_add_u32 s36, s36, 65536
    buffer_load_dwordx4 v[248:251], v118, s[88:91], s36 offen
    s_add_u32 s36, s67, 0
    s_and_b32 s36, s36, 7
    s_lshl_b32 s36, s36, 17
    s_add_u32 s36, s36, s48
    s_add_u32 s36, s36, 1048576
    buffer_load_dwordx4 v[132:135], v118, s[88:91], s36 offen
    s_add_u32 s36, s36, 65536
    buffer_load_dwordx4 v[140:143], v118, s[88:91], s36 offen
    v_mov_b32 v6, 162836
    v_mov_b32 v7, 1
    s_waitcnt lgkmcnt(0)
    s_mov_b64 exec, 1
    ds_add_u32 v6, v7
    s_mov_b64 exec, -1
    s_add_u32 s36, s67, 0
    s_and_b32 s36, s36, 7
    s_lshl_b32 s36, s36, 17
    s_add_u32 s36, s36, s48
    buffer_load_dwordx4 v[12:15], v118, s[80:83], s36 offen
    s_add_u32 s36, s36, 65536
    buffer_load_dwordx4 v[16:19], v118, s[80:83], s36 offen
    s_add_u32 s36, s67, 1
    s_and_b32 s36, s36, 7
    s_lshl_b32 s36, s36, 17
    s_add_u32 s36, s36, s48
    buffer_load_dwordx4 v[20:23], v118, s[80:83], s36 offen
    s_add_u32 s36, s36, 65536
    buffer_load_dwordx4 v[24:27], v118, s[80:83], s36 offen
    s_add_u32 s36, s67, 2
    s_and_b32 s36, s36, 7
    s_lshl_b32 s36, s36, 17
    s_add_u32 s36, s36, s48
    buffer_load_dwordx4 v[28:31], v118, s[80:83], s36 offen
    s_add_u32 s36, s36, 65536
    buffer_load_dwordx4 v[32:35], v118, s[80:83], s36 offen
    s_add_u32 s36, s67, 3
    s_and_b32 s36, s36, 7
    s_lshl_b32 s36, s36, 17
    s_add_u32 s36, s36, s48
    buffer_load_dwordx4 v[36:39], v118, s[80:83], s36 offen
    s_add_u32 s36, s36, 65536
    buffer_load_dwordx4 v[40:43], v118, s[80:83], s36 offen
    s_add_u32 s36, s67, 4
    s_and_b32 s36, s36, 7
    s_lshl_b32 s36, s36, 17
    s_add_u32 s36, s36, s48
    buffer_load_dwordx4 v[44:47], v118, s[80:83], s36 offen
    s_add_u32 s36, s36, 65536
    buffer_load_dwordx4 v[48:51], v118, s[80:83], s36 offen
    s_add_u32 s36, s67, 5
    s_and_b32 s36, s36, 7
    s_lshl_b32 s36, s36, 17
    s_add_u32 s36, s36, s48
    buffer_load_dwordx4 v[52:55], v118, s[80:83], s36 offen
    s_add_u32 s36, s36, 65536
    buffer_load_dwordx4 v[56:59], v118, s[80:83], s36 offen
    s_add_u32 s36, s67, 6
    s_and_b32 s36, s36, 7
    s_lshl_b32 s36, s36, 17
    s_add_u32 s36, s36, s48
    buffer_load_dwordx4 v[60:63], v118, s[80:83], s36 offen
    s_add_u32 s36, s36, 65536
    buffer_load_dwordx4 v[64:67], v118, s[80:83], s36 offen
    s_add_u32 s36, s67, 7
    s_and_b32 s36, s36, 7
    s_lshl_b32 s36, s36, 17
    s_add_u32 s36, s36, s48
    buffer_load_dwordx4 v[68:71], v118, s[80:83], s36 offen
    s_add_u32 s36, s36, 65536
    buffer_load_dwordx4 v[94:97], v118, s[80:83], s36 offen
    s_add_u32 s36, s67, 0
    s_and_b32 s36, s36, 7
    s_lshl_b32 s36, s36, 17
    s_add_u32 s36, s36, s48
    s_add_u32 s36, s36, 1048576
    buffer_load_dwordx4 v[98:101], v118, s[80:83], s36 offen
    s_add_u32 s36, s36, 65536
    buffer_load_dwordx4 v[102:105], v118, s[80:83], s36 offen
    s_waitcnt vmcnt(40)
    s_cmp_ge_u32 s2, 255
    s_cbranch_scc1 FB_np
    s_cmp_lg_u32 s30, 5
    s_cbranch_scc1 FB_np
    s_and_b32 s42, s2, 31
    s_lshl_b32 s42, s42, 8
    s_lshr_b32 s43, s2, 5
    s_lshl_b32 s43, s43, 14
    s_add_u32 s42, s42, s43
    s_add_u32 s42, s42, 35520512
    s_mov_b32 s46, -1
    s_mov_b32 s47, -1
    s_mov_b32 s43, 0
FB_ml:
    s_memtime s[34:35]
    s_waitcnt lgkmcnt(0)
    s_load_dword s32, s[4:5], s42 offset:0 glc
    s_waitcnt lgkmcnt(0)
    s_memtime s[36:37]
    s_waitcnt lgkmcnt(0)
    s_sub_u32 s36, s36, s34
    s_min_u32 s46, s46, s36
    s_memtime s[34:35]
    s_waitcnt lgkmcnt(0)
    s_load_dword s32, s[4:5], s42 offset:8192 glc
    s_waitcnt lgkmcnt(0)
    s_memtime s[36:37]
    s_waitcnt lgkmcnt(0)
    s_sub_u32 s36, s36, s34
    s_min_u32 s47, s47, s36
    s_add_u32 s42, s42, 128
    s_add_u32 s43, s43, 1
    s_cmp_lt_u32 s43, 1
    s_cbranch_scc1 FB_ml
    s_cmp_lt_u32 s47, s46
    s_cselect_b32 s45, 1, 0
    s_lshr_b32 s46, s28, 2
    s_xor_b32 s45, s45, s46
    s_and_b32 s45, s45, 1
    s_lshl_b32 s45, s45, 8
    v_mov_b32 v6, 162848
    v_mov_b32 v7, s45
    s_waitcnt lgkmcnt(0)
    ds_write_b32 v6, v7
FB_np:
    s_and_b32 s36, s2, 7
    s_lshr_b32 s53, s2, 5
    s_lshl3_add_u32 s36, s36, s53
    s_lshl_b32 s36, s36, 7
    s_add_u32 s36, s36, 23592960
    v_mov_b32 v6, 1
    v_mov_b32 v7, 162820
    v_lshlrev_b32 v9, 13, v1
    s_mov_b64 exec, 1
    s_waitcnt lgkmcnt(0)
    ds_add_rtn_u32 v8, v7, v6
    ds_read_b32 v10, v7 offset:28
    s_waitcnt lgkmcnt(0)
    v_readfirstlane_b32 s54, v8
    v_readfirstlane_b32 s53, v10
    s_cmp_lg_u32 s54, 7
    s_cbranch_scc1 fa_6
    s_mov_b64 exec, 0xffff
    s_or_b32 s53, s53, 1
    v_mov_b32 v6, s53
    buffer_atomic_add v6, v9, s[56:59], s36 offen sc1
fa_6:
    s_mov_b64 exec, -1
    v_mov_b32 v6, 162836
spin_7:
    ds_read_b32 v7, v6
    s_waitcnt lgkmcnt(0)
    v_readfirstlane_b32 s53, v7
    s_nop 0
    s_cmp_ge_u32 s53, 4
    s_cbranch_scc0 spin_7
    s_and_b32 s49, s30, 3
    s_lshl_b32 s49, s49, 10
    s_add_u32 s36, s67, 1
    s_and_b32 s36, s36, 7
    s_lshl_b32 s36, s36, 17
    s_add_u32 s36, s36, s48
    s_add_u32 s36, s36, 1048576
    s_add_u32 m0, s49, 98304
    s_nop 0
    buffer_load_dwordx4 v118, s[80:83], s36 offen lds
    s_add_u32 s36, s36, 65536
    s_add_u32 m0, s49, 102400
    s_nop 0
    buffer_load_dwordx4 v118, s[80:83], s36 offen lds
    s_add_u32 s36, s67, 2
    s_and_b32 s36, s36, 7
    s_lshl_b32 s36, s36, 17
    s_add_u32 s36, s36, s48
    s_add_u32 s36, s36, 1048576
    s_add_u32 m0, s49, 106496
    s_nop 0
    buffer_load_dwordx4 v118, s[80:83], s36 offen lds
    s_add_u32 s36, s36, 65536
    s_add_u32 m0, s49, 110592
    s_nop 0
    buffer_load_dwordx4 v118, s[80:83], s36 offen lds
    s_add_u32 s36, s67, 3
    s_and_b32 s36, s36, 7
    s_lshl_b32 s36, s36, 17
    s_add_u32 s36, s36, s48
    s_add_u32 s36, s36, 1048576
    s_add_u32 m0, s49, 114688
    s_nop 0
    buffer_load_dwordx4 v118, s[80:83], s36 offen lds
    s_add_u32 s36, s36, 65536
    s_add_u32 m0, s49, 118784
    s_nop 0
    buffer_load_dwordx4 v118, s[80:83], s36 offen lds
    s_add_u32 s36, s67, 4
    s_and_b32 s36, s36, 7
    s_lshl_b32 s36, s36, 17
    s_add_u32 s36, s36, s48
    s_add_u32 s36, s36, 1048576
    s_add_u32 m0, s49, 122880
    s_nop 0
    buffer_load_dwordx4 v118, s[80:83], s36 offen lds
    s_add_u32 s36, s36, 65536
    s_add_u32 m0, s49, 126976
    s_nop 0
    buffer_load_dwordx4 v118, s[80:83], s36 offen lds
    s_add_u32 s36, s67, 5
    s_and_b32 s36, s36, 7
    s_lshl_b32 s36, s36, 17
    s_add_u32 s36, s36, s48
    s_add_u32 s36, s36, 1048576
    s_add_u32 m0, s49, 131072
    s_nop 0
    buffer_load_dwordx4 v118, s[80:83], s36 offen lds
    s_add_u32 s36, s36, 65536
    s_add_u32 m0, s49, 135168
    s_nop 0
    buffer_load_dwordx4 v118, s[80:83], s36 offen lds
    s_add_u32 s36, s67, 6
    s_and_b32 s36, s36, 7
    s_lshl_b32 s36, s36, 17
    s_add_u32 s36, s36, s48
    s_add_u32 s36, s36, 1048576
    s_add_u32 m0, s49, 139264
    s_nop 0
    buffer_load_dwordx4 v118, s[80:83], s36 offen lds
    s_add_u32 s36, s36, 65536
    s_add_u32 m0, s49, 143360
    s_nop 0
    buffer_load_dwordx4 v118, s[80:83], s36 offen lds
    s_add_u32 s36, s67, 7
    s_and_b32 s36, s36, 7
    s_lshl_b32 s36, s36, 17
    s_add_u32 s36, s36, s48
    s_add_u32 s36, s36, 1048576
    s_add_u32 m0, s49, 147456
    s_nop 0
    buffer_load_dwordx4 v118, s[80:83], s36 offen lds
    s_add_u32 s36, s36, 65536
    s_add_u32 m0, s49, 151552
    s_nop 0
    buffer_load_dwordx4 v118, s[80:83], s36 offen lds
    s_waitcnt vmcnt(0)
    v_mov_b32 v6, 162840
spin_8:
    s_sleep 2
    ds_read_b32 v7, v6
    s_waitcnt lgkmcnt(0)
    v_readfirstlane_b32 s53, v7
    s_nop 0
    s_cmp_ge_u32 s53, 4
    s_cbranch_scc0 spin_8
    s_and_b32 s36, s30, 3
    s_lshl_b32 s36, s36, 10
    s_add_u32 s36, s36, 24576
    v_add_u32 v8, s36, v2
    v_add_u32 v9, 65536, v8
    ds_write_b128 v8, v[128:131] offset:0
    ds_write_b128 v8, v[136:139] offset:4096
    ds_write_b128 v8, v[144:147] offset:8192
    ds_write_b128 v8, v[152:155] offset:12288
    ds_write_b128 v8, v[160:163] offset:16384
    ds_write_b128 v8, v[168:171] offset:20480
    ds_write_b128 v8, v[176:179] offset:24576
    ds_write_b128 v8, v[184:187] offset:28672
    ds_write_b128 v8, v[192:195] offset:32768
    ds_write_b128 v8, v[200:203] offset:36864
    ds_write_b128 v8, v[208:211] offset:40960
    ds_write_b128 v8, v[216:219] offset:45056
    ds_write_b128 v8, v[224:227] offset:49152
    ds_write_b128 v8, v[232:235] offset:53248
    ds_write_b128 v8, v[240:243] offset:57344
    ds_write_b128 v8, v[248:251] offset:61440
    ds_write_b128 v9, v[132:135] offset:0
    ds_write_b128 v9, v[140:143] offset:4096
    v_mov_b32 v6, 162836
    v_mov_b32 v7, 1
    s_waitcnt lgkmcnt(0)
    s_mov_b64 exec, 1
    ds_add_u32 v6, v7
    s_mov_b64 exec, -1
    v_mov_b32 v6, 162836
spin_9:
    ds_read_b32 v7, v6
    s_waitcnt lgkmcnt(0)
    v_readfirstlane_b32 s53, v7
    s_nop 0
    s_cmp_ge_u32 s53, 8
    s_cbranch_scc0 spin_9
    ds_read_b64_tr_b16 v[128:129], v74 offset:0
    ds_read_b64_tr_b16 v[130:131], v74 offset:2048
    ds_read_b64_tr_b16 v[136:137], v74 offset:4096
    ds_read_b64_tr_b16 v[138:139], v74 offset:6144
    ds_read_b64_tr_b16 v[144:145], v74 offset:8192
    ds_read_b64_tr_b16 v[146:147], v74 offset:10240
    ds_read_b64_tr_b16 v[152:153], v74 offset:12288
    ds_read_b64_tr_b16 v[154:155], v74 offset:14336
    ds_read_b64_tr_b16 v[160:161], v74 offset:16384
    ds_read_b64_tr_b16 v[162:163], v74 offset:18432
    ds_read_b64_tr_b16 v[168:169], v74 offset:20480
    ds_read_b64_tr_b16 v[170:171], v74 offset:22528
    ds_read_b64_tr_b16 v[176:177], v74 offset:24576
    ds_read_b64_tr_b16 v[178:179], v74 offset:26624
    ds_read_b64_tr_b16 v[184:185], v74 offset:28672
    ds_read_b64_tr_b16 v[186:187], v74 offset:30720
    ds_read_b64_tr_b16 v[192:193], v74 offset:32768
    ds_read_b64_tr_b16 v[194:195], v74 offset:34816
    ds_read_b64_tr_b16 v[200:201], v74 offset:36864
    ds_read_b64_tr_b16 v[202:203], v74 offset:38912
    ds_read_b64_tr_b16 v[208:209], v74 offset:40960
    ds_read_b64_tr_b16 v[210:211], v74 offset:43008
    ds_read_b64_tr_b16 v[216:217], v74 offset:45056
    ds_read_b64_tr_b16 v[218:219], v74 offset:47104
    ds_read_b64_tr_b16 v[224:225], v74 offset:49152
    ds_read_b64_tr_b16 v[226:227], v74 offset:51200
    ds_read_b64_tr_b16 v[232:233], v74 offset:53248
    ds_read_b64_tr_b16 v[234:235], v74 offset:55296
    ds_read_b64_tr_b16 v[240:241], v74 offset:57344
    ds_read_b64_tr_b16 v[242:243], v74 offset:59392
    ds_read_b64_tr_b16 v[248:249], v74 offset:61440
    ds_read_b64_tr_b16 v[250:251], v74 offset:63488
    ds_read_b64_tr_b16 v[132:133], v75 offset:0
    ds_read_b64_tr_b16 v[134:135], v75 offset:2048
    ds_read_b64_tr_b16 v[140:141], v75 offset:4096
    ds_read_b64_tr_b16 v[142:143], v75 offset:6144
    v_mov_b32 v6, 162836
    v_mov_b32 v7, 1
    s_waitcnt lgkmcnt(0)
    s_mov_b64 exec, 1
    ds_add_u32 v6, v7
    s_mov_b64 exec, -1
    v_mov_b32 v6, 162836
spin_10:
    ds_read_b32 v7, v6
    s_waitcnt lgkmcnt(0)
    v_readfirstlane_b32 s53, v7
    s_nop 0
    s_cmp_ge_u32 s53, 12
    s_cbranch_scc0 spin_10
    ds_write_b128 v8, v[12:15] offset:0
    ds_write_b128 v8, v[16:19] offset:4096
    ds_write_b128 v8, v[20:23] offset:8192
    ds_write_b128 v8, v[24:27] offset:12288
    ds_write_b128 v8, v[28:31] offset:16384
    ds_write_b128 v8, v[32:35] offset:20480
    ds_write_b128 v8, v[36:39] offset:24576
    ds_write_b128 v8, v[40:43] offset:28672
    ds_write_b128 v8, v[44:47] offset:32768
    ds_write_b128 v8, v[48:51] offset:36864
    ds_write_b128 v8, v[52:55] offset:40960
    ds_write_b128 v8, v[56:59] offset:45056
    ds_write_b128 v8, v[60:63] offset:49152
    ds_write_b128 v8, v[64:67] offset:53248
    ds_write_b128 v8, v[68:71] offset:57344
    ds_write_b128 v8, v[94:97] offset:61440
    ds_write_b128 v9, v[98:101] offset:0
    ds_write_b128 v9, v[102:105] offset:4096
    s_waitcnt lgkmcnt(0)
FR_end:
LAYER:
    v_lshlrev_b32 v72, 6, v81
    v_add_u32 v72, 161792, v72
    s_lshl_b32 s35, s30, 3
    v_add_u32 v71, s35, v72
    v_lshrrev_b32 v6, 2, v1
    v_lshlrev_b32 v74, 7, v6
    v_bfe_u32 v6, v6, 1, 2
    s_and_b32 s35, s30, 2
    v_and_b32 v7, 1, v1
    v_or_b32 v7, s35, v7
    v_xor_b32 v6, v6, v7
    v_lshl_add_u32 v74, v6, 5, v74
    v_and_b32 v6, 2, v1
    v_lshl_add_u32 v74, v6, 2, v74
    s_and_b32 s35, s30, 1
    s_lshl_b32 s35, s35, 4
    s_add_u32 s35, s35, 24576
    v_add_u32 v74, s35, v74
    v_add_u32 v75, 65536, v74
    s_cmp_eq_u32 s60, 0
    s_cbranch_scc1 R_l0
    s_sub_u32 s8, s62, 0x3b00000
    s_subb_u32 s9, s63, 0
    s_mov_b32 s10, 0x7e000
    s_mov_b32 s11, 0x20000
    s_sub_u32 s12, s62, 0x3a80000
    s_subb_u32 s13, s63, 0
    s_mov_b32 s14, 0x7e000
    s_mov_b32 s15, 0x20000
    s_waitcnt vmcnt(0)
    v_lshlrev_b32 v102, 16, v110
    v_and_b32 v103, 0xffff0000, v110
    v_lshlrev_b32 v52, 16, v86
    v_and_b32 v53, 0xffff0000, v86
    v_lshlrev_b32 v28, 16, v94
    v_and_b32 v29, 0xffff0000, v94
    v_pk_add_f32 v[52:53], v[52:53], v[28:29]
    v_lshlrev_b32 v104, 16, v111
    v_and_b32 v105, 0xffff0000, v111
    v_lshlrev_b32 v54, 16, v87
    v_and_b32 v55, 0xffff0000, v87
    v_lshlrev_b32 v30, 16, v95
    v_and_b32 v31, 0xffff0000, v95
    v_pk_add_f32 v[54:55], v[54:55], v[30:31]
    v_lshlrev_b32 v106, 16, v112
    v_and_b32 v107, 0xffff0000, v112
    v_lshlrev_b32 v56, 16, v88
    v_and_b32 v57, 0xffff0000, v88
    v_lshlrev_b32 v32, 16, v96
    v_and_b32 v33, 0xffff0000, v96
    v_pk_add_f32 v[56:57], v[56:57], v[32:33]
    v_lshlrev_b32 v108, 16, v113
    v_and_b32 v109, 0xffff0000, v113
    v_lshlrev_b32 v58, 16, v89
    v_and_b32 v59, 0xffff0000, v89
    v_lshlrev_b32 v34, 16, v97
    v_and_b32 v35, 0xffff0000, v97
    v_pk_add_f32 v[58:59], v[58:59], v[34:35]
    v_lshlrev_b32 v110, 16, v114
    v_and_b32 v111, 0xffff0000, v114
    v_lshlrev_b32 v60, 16, v90
    v_and_b32 v61, 0xffff0000, v90
    v_lshlrev_b32 v36, 16, v98
    v_and_b32 v37, 0xffff0000, v98
    v_pk_add_f32 v[60:61], v[60:61], v[36:37]
    v_lshlrev_b32 v112, 16, v115
    v_and_b32 v113, 0xffff0000, v115
    v_lshlrev_b32 v62, 16, v91
    v_and_b32 v63, 0xffff0000, v91
    v_lshlrev_b32 v38, 16, v99
    v_and_b32 v39, 0xffff0000, v99
    v_pk_add_f32 v[62:63], v[62:63], v[38:39]
    v_lshlrev_b32 v114, 16, v116
    v_and_b32 v115, 0xffff0000, v116
    v_lshlrev_b32 v64, 16, v92
    v_and_b32 v65, 0xffff0000, v92
    v_lshlrev_b32 v40, 16, v100
    v_and_b32 v41, 0xffff0000, v100
    v_pk_add_f32 v[64:65], v[64:65], v[40:41]
    v_lshlrev_b32 v116, 16, v117
    v_and_b32 v117, 0xffff0000, v117
    v_lshlrev_b32 v66, 16, v93
    v_and_b32 v67, 0xffff0000, v93
    v_lshlrev_b32 v42, 16, v101
    v_and_b32 v43, 0xffff0000, v101
    v_pk_add_f32 v[66:67], v[66:67], v[42:43]
    s_cmp_lg_u32 s30, 4
    s_cbranch_scc1 pdone_11
    s_lshl_b32 s54, s60, 1
    s_add_u32 s54, s54, 0
    v_mov_b32 v8, 162872
spin_12:
    s_sleep 8
    ds_read_b32 v9, v8
    s_waitcnt lgkmcnt(0)
    v_readfirstlane_b32 s53, v9
    s_nop 0
    s_cmp_ge_u32 s53, s54
    s_cbranch_scc0 spin_12
    s_add_u32 s54, s55, 0xfc000400
    v_mov_b32 v9, s54
    s_mov_b32 s53, 0
    s_add_u32 s54, s52, 16
    s_bfm_b64 exec, 1, 0
poll_13:
    buffer_load_dword v8, v9, s[56:59], 0 offen sc1
    s_waitcnt vmcnt(0)
    v_cmp_eq_u32 vcc, s54, v8
    s_nop 0
    s_cmp_eq_u64 vcc, exec
    s_cbranch_scc1 pok_14
    s_sleep 5
    s_add_u32 s53, s53, 1
    s_cmp_lt_u32 s53, s61
    s_cbranch_scc1 poll_13
    s_mov_b32 s61, 0
pok_14:
    s_mov_b64 exec, -1
pdone_11:
    s_barrier
    buffer_load_dwordx4 v[86:89], v78, s[8:11], 0 offen offset:0 sc1
    buffer_load_dwordx4 v[94:97], v78, s[12:15], 0 offen offset:0 sc1
    buffer_load_dwordx4 v[90:93], v78, s[8:11], 0 offen offset:2048 sc1
    buffer_load_dwordx4 v[98:101], v78, s[12:15], 0 offen offset:2048 sc1
    s_cmp_ge_u32 s30, 4
    s_cbranch_scc1 w1in_15
    ds_read_b64_tr_b16 v[128:129], v74 offset:0
    ds_read_b64_tr_b16 v[130:131], v74 offset:2048
    ds_read_b64_tr_b16 v[136:137], v74 offset:4096
    ds_read_b64_tr_b16 v[138:139], v74 offset:6144
    ds_read_b64_tr_b16 v[144:145], v74 offset:8192
    ds_read_b64_tr_b16 v[146:147], v74 offset:10240
    ds_read_b64_tr_b16 v[152:153], v74 offset:12288
    ds_read_b64_tr_b16 v[154:155], v74 offset:14336
    ds_read_b64_tr_b16 v[160:161], v74 offset:16384
    ds_read_b64_tr_b16 v[162:163], v74 offset:18432
    ds_read_b64_tr_b16 v[168:169], v74 offset:20480
    ds_read_b64_tr_b16 v[170:171], v74 offset:22528
    ds_read_b64_tr_b16 v[176:177], v74 offset:24576
    ds_read_b64_tr_b16 v[178:179], v74 offset:26624
    ds_read_b64_tr_b16 v[184:185], v74 offset:28672
    ds_read_b64_tr_b16 v[186:187], v74 offset:30720
    ds_read_b64_tr_b16 v[192:193], v74 offset:32768
    ds_read_b64_tr_b16 v[194:195], v74 offset:34816
    ds_read_b64_tr_b16 v[200:201], v74 offset:36864
    ds_read_b64_tr_b16 v[202:203], v74 offset:38912
    ds_read_b64_tr_b16 v[208:209], v74 offset:40960
    ds_read_b64_tr_b16 v[210:211], v74 offset:43008
    ds_read_b64_tr_b16 v[216:217], v74 offset:45056
    ds_read_b64_tr_b16 v[218:219], v74 offset:47104
    ds_read_b64_tr_b16 v[224:225], v74 offset:49152
    ds_read_b64_tr_b16 v[226:227], v74 offset:51200
    ds_read_b64_tr_b16 v[232:233], v74 offset:53248
    ds_read_b64_tr_b16 v[234:235], v74 offset:55296
    ds_read_b64_tr_b16 v[240:241], v74 offset:57344
    ds_read_b64_tr_b16 v[242:243], v74 offset:59392
    ds_read_b64_tr_b16 v[248:249], v74 offset:61440
    ds_read_b64_tr_b16 v[250:251], v74 offset:63488
    ds_read_b64_tr_b16 v[132:133], v75 offset:0
    ds_read_b64_tr_b16 v[134:135], v75 offset:2048
    ds_read_b64_tr_b16 v[140:141], v75 offset:4096
    ds_read_b64_tr_b16 v[142:143], v75 offset:6144
    ds_read_b64_tr_b16 v[148:149], v75 offset:8192
    ds_read_b64_tr_b16 v[150:151], v75 offset:10240
    ds_read_b64_tr_b16 v[156:157], v75 offset:12288
    ds_read_b64_tr_b16 v[158:159], v75 offset:14336
    ds_read_b64_tr_b16 v[164:165], v75 offset:16384
    ds_read_b64_tr_b16 v[166:167], v75 offset:18432
    ds_read_b64_tr_b16 v[172:173], v75 offset:20480
    ds_read_b64_tr_b16 v[174:175], v75 offset:22528
    ds_read_b64_tr_b16 v[180:181], v75 offset:24576
    ds_read_b64_tr_b16 v[182:183], v75 offset:26624
    ds_read_b64_tr_b16 v[188:189], v75 offset:28672
    ds_read_b64_tr_b16 v[190:191], v75 offset:30720
    ds_read_b64_tr_b16 v[196:197], v75 offset:32768
    ds_read_b64_tr_b16 v[198:199], v75 offset:34816
    ds_read_b64_tr_b16 v[204:205], v75 offset:36864
    ds_read_b64_tr_b16 v[206:207], v75 offset:38912
    ds_read_b64_tr_b16 v[212:213], v75 offset:40960
    ds_read_b64_tr_b16 v[214:215], v75 offset:43008
    ds_read_b64_tr_b16 v[220:221], v75 offset:45056
    ds_read_b64_tr_b16 v[222:223], v75 offset:47104
    ds_read_b64_tr_b16 v[228:229], v75 offset:49152
    ds_read_b64_tr_b16 v[230:231], v75 offset:51200
    ds_read_b64_tr_b16 v[236:237], v75 offset:53248
    ds_read_b64_tr_b16 v[238:239], v75 offset:55296
    ds_read_b64_tr_b16 v[244:245], v75 offset:57344
    ds_read_b64_tr_b16 v[246:247], v75 offset:59392
    ds_read_b64_tr_b16 v[252:253], v75 offset:61440
    ds_read_b64_tr_b16 v[254:255], v75 offset:63488
w1in_15:
    s_waitcnt vmcnt(2)
    v_lshlrev_b32 v12, 16, v86
    v_and_b32 v13, 0xffff0000, v86
    v_lshlrev_b32 v28, 16, v94
    v_and_b32 v29, 0xffff0000, v94
    v_pk_add_f32 v[12:13], v[12:13], v[28:29]
    v_pk_add_f32 v[12:13], v[12:13], v[52:53]
    v_cvt_pk_bf16_f32 v44, v12, v13
    v_lshlrev_b32 v12, 16, v44
    v_and_b32 v13, 0xffff0000, v44
    v_lshlrev_b32 v14, 16, v87
    v_and_b32 v15, 0xffff0000, v87
    v_lshlrev_b32 v30, 16, v95
    v_and_b32 v31, 0xffff0000, v95
    v_pk_add_f32 v[14:15], v[14:15], v[30:31]
    v_pk_add_f32 v[14:15], v[14:15], v[54:55]
    v_cvt_pk_bf16_f32 v44, v14, v15
    v_lshlrev_b32 v14, 16, v44
    v_and_b32 v15, 0xffff0000, v44
    v_lshlrev_b32 v16, 16, v88
    v_and_b32 v17, 0xffff0000, v88
    v_lshlrev_b32 v32, 16, v96
    v_and_b32 v33, 0xffff0000, v96
    v_pk_add_f32 v[16:17], v[16:17], v[32:33]
    v_pk_add_f32 v[16:17], v[16:17], v[56:57]
    v_cvt_pk_bf16_f32 v44, v16, v17
    v_lshlrev_b32 v16, 16, v44
    v_and_b32 v17, 0xffff0000, v44
    v_lshlrev_b32 v18, 16, v89
    v_and_b32 v19, 0xffff0000, v89
    v_lshlrev_b32 v34, 16, v97
    v_and_b32 v35, 0xffff0000, v97
    v_pk_add_f32 v[18:19], v[18:19], v[34:35]
    v_pk_add_f32 v[18:19], v[18:19], v[58:59]
    v_cvt_pk_bf16_f32 v44, v18, v19
    v_lshlrev_b32 v18, 16, v44
    v_and_b32 v19, 0xffff0000, v44
    s_waitcnt vmcnt(0)
    v_lshlrev_b32 v20, 16, v90
    v_and_b32 v21, 0xffff0000, v90
    v_lshlrev_b32 v36, 16, v98
    v_and_b32 v37, 0xffff0000, v98
    v_pk_add_f32 v[20:21], v[20:21], v[36:37]
    v_pk_add_f32 v[20:21], v[20:21], v[60:61]
    v_cvt_pk_bf16_f32 v44, v20, v21
    v_lshlrev_b32 v20, 16, v44
    v_and_b32 v21, 0xffff0000, v44
    v_lshlrev_b32 v22, 16, v91
    v_and_b32 v23, 0xffff0000, v91
    v_lshlrev_b32 v38, 16, v99
    v_and_b32 v39, 0xffff0000, v99
    v_pk_add_f32 v[22:23], v[22:23], v[38:39]
    v_pk_add_f32 v[22:23], v[22:23], v[62:63]
    v_cvt_pk_bf16_f32 v44, v22, v23
    v_lshlrev_b32 v22, 16, v44
    v_and_b32 v23, 0xffff0000, v44
    v_lshlrev_b32 v24, 16, v92
    v_and_b32 v25, 0xffff0000, v92
    v_lshlrev_b32 v40, 16, v100
    v_and_b32 v41, 0xffff0000, v100
    v_pk_add_f32 v[24:25], v[24:25], v[40:41]
    v_pk_add_f32 v[24:25], v[24:25], v[64:65]
    v_cvt_pk_bf16_f32 v44, v24, v25
    v_lshlrev_b32 v24, 16, v44
    v_and_b32 v25, 0xffff0000, v44
    v_lshlrev_b32 v26, 16, v93
    v_and_b32 v27, 0xffff0000, v93
    v_lshlrev_b32 v42, 16, v101
    v_and_b32 v43, 0xffff0000, v101
    v_pk_add_f32 v[26:27], v[26:27], v[42:43]
    v_pk_add_f32 v[26:27], v[26:27], v[66:67]
    v_cvt_pk_bf16_f32 v44, v26, v27
    v_lshlrev_b32 v26, 16, v44
    v_and_b32 v27, 0xffff0000, v44
    v_pk_add_f32 v[48:49], v[12:13], v[14:15]
    v_pk_mul_f32 v[50:51], v[12:13], v[12:13]
    v_pk_fma_f32 v[50:51], v[14:15], v[14:15], v[50:51]
    v_pk_add_f32 v[48:49], v[48:49], v[16:17]
    v_pk_fma_f32 v[50:51], v[16:17], v[16:17], v[50:51]
    v_pk_add_f32 v[48:49], v[48:49], v[18:19]
    v_pk_fma_f32 v[50:51], v[18:19], v[18:19], v[50:51]
    v_pk_add_f32 v[48:49], v[48:49], v[20:21]
    v_pk_fma_f32 v[50:51], v[20:21], v[20:21], v[50:51]
    v_pk_add_f32 v[48:49], v[48:49], v[22:23]
    v_pk_fma_f32 v[50:51], v[22:23], v[22:23], v[50:51]
    v_pk_add_f32 v[48:49], v[48:49], v[24:25]
    v_pk_fma_f32 v[50:51], v[24:25], v[24:25], v[50:51]
    v_pk_add_f32 v[48:49], v[48:49], v[26:27]
    v_pk_fma_f32 v[50:51], v[26:27], v[26:27], v[50:51]
    v_add_f32 v46, v48, v49
    v_add_f32 v47, v50, v51
    s_nop 0
    v_add_f32_dpp v46, v46, v46 row_ror:8 row_mask:0xf bank_mask:0xf
    v_add_f32_dpp v47, v47, v47 row_ror:8 row_mask:0xf bank_mask:0xf
    v_mov_b32 v48, v46
    v_mov_b32 v49, v47
    s_nop 0
    v_permlane16_swap_b32 v46, v48
    v_permlane16_swap_b32 v47, v49
    v_pk_add_f32 v[46:47], v[46:47], v[48:49]
    v_mov_b32 v48, v46
    v_mov_b32 v49, v47
    s_nop 0
    v_permlane32_swap_b32 v46, v48
    v_permlane32_swap_b32 v47, v49
    v_pk_add_f32 v[46:47], v[46:47], v[48:49]
    ds_write_b64 v71, v[46:47] offset:0
    s_waitcnt lgkmcnt(0)
    s_barrier
    ds_read_b128 v[52:55], v72 offset:0
    ds_read_b128 v[56:59], v72 offset:16
    ds_read_b128 v[60:63], v72 offset:32
    ds_read_b128 v[64:67], v72 offset:48
    s_waitcnt lgkmcnt(0)
    v_pk_add_f32 v[52:53], v[52:53], v[54:55]
    v_pk_add_f32 v[56:57], v[56:57], v[58:59]
    v_pk_add_f32 v[60:61], v[60:61], v[62:63]
    v_pk_add_f32 v[64:65], v[64:65], v[66:67]
    v_pk_add_f32 v[52:53], v[52:53], v[56:57]
    v_pk_add_f32 v[60:61], v[60:61], v[64:65]
    v_pk_add_f32 v[52:53], v[52:53], v[60:61]
    v_mul_f32 v68, 0x3a800000, v52
    v_mul_f32 v70, 0x3a800000, v53
    v_fma_f32 v70, -v68, v68, v70
    v_max_f32 v70, 0, v70
    v_cvt_pk_bf16_f32 v68, v68, v68
    v_lshlrev_b32 v68, 16, v68
    v_cvt_pk_bf16_f32 v70, v70, v70
    v_lshlrev_b32 v70, 16, v70
    v_add_f32 v70, 0x3727c5ac, v70
    v_cvt_pk_bf16_f32 v70, v70, v70
    v_lshlrev_b32 v70, 16, v70
    v_sqrt_f32 v70, v70
    s_nop 0
    v_cvt_pk_bf16_f32 v70, v70, v70
    v_lshlrev_b32 v70, 16, v70
    v_rcp_f32 v69, v70
    s_lshl_b32 s22, s60, 24
    s_lshl_b32 s23, s94, 13
    s_add_u32 s22, s22, s23
    s_add_u32 s22, s22, 167772160
    s_add_u32 s20, s4, s22
    s_addc_u32 s21, s5, 0
    s_mov_b32 s22, 8380416
    s_mov_b32 s23, 0x20000
    v_pk_add_f32 v[28:29], v[12:13], v[68:69] op_sel_hi:[1,0] neg_lo:[0,1] neg_hi:[0,1]
    v_pk_mul_f32 v[28:29], v[28:29], v[68:69] op_sel:[0,1] op_sel_hi:[1,1]
    v_pk_fma_f32 v[12:13], v[28:29], v[102:103], v[12:13]
    v_cvt_pk_bf16_f32 v86, v12, v13
    v_pk_add_f32 v[30:31], v[14:15], v[68:69] op_sel_hi:[1,0] neg_lo:[0,1] neg_hi:[0,1]
    v_pk_mul_f32 v[30:31], v[30:31], v[68:69] op_sel:[0,1] op_sel_hi:[1,1]
    v_pk_fma_f32 v[14:15], v[30:31], v[104:105], v[14:15]
    v_cvt_pk_bf16_f32 v87, v14, v15
    v_pk_add_f32 v[32:33], v[16:17], v[68:69] op_sel_hi:[1,0] neg_lo:[0,1] neg_hi:[0,1]
    v_pk_mul_f32 v[32:33], v[32:33], v[68:69] op_sel:[0,1] op_sel_hi:[1,1]
    v_pk_fma_f32 v[16:17], v[32:33], v[106:107], v[16:17]
    v_cvt_pk_bf16_f32 v88, v16, v17
    v_pk_add_f32 v[34:35], v[18:19], v[68:69] op_sel_hi:[1,0] neg_lo:[0,1] neg_hi:[0,1]
    v_pk_mul_f32 v[34:35], v[34:35], v[68:69] op_sel:[0,1] op_sel_hi:[1,1]
    v_pk_fma_f32 v[18:19], v[34:35], v[108:109], v[18:19]
    v_cvt_pk_bf16_f32 v89, v18, v19
    buffer_store_dwordx4 v[86:89], v82, s[20:23], 0 offen offset:0 sc1
    v_pk_add_f32 v[36:37], v[20:21], v[68:69] op_sel_hi:[1,0] neg_lo:[0,1] neg_hi:[0,1]
    v_pk_mul_f32 v[36:37], v[36:37], v[68:69] op_sel:[0,1] op_sel_hi:[1,1]
    v_pk_fma_f32 v[20:21], v[36:37], v[110:111], v[20:21]
    v_cvt_pk_bf16_f32 v90, v20, v21
    v_pk_add_f32 v[38:39], v[22:23], v[68:69] op_sel_hi:[1,0] neg_lo:[0,1] neg_hi:[0,1]
    v_pk_mul_f32 v[38:39], v[38:39], v[68:69] op_sel:[0,1] op_sel_hi:[1,1]
    v_pk_fma_f32 v[22:23], v[38:39], v[112:113], v[22:23]
    v_cvt_pk_bf16_f32 v91, v22, v23
    v_pk_add_f32 v[40:41], v[24:25], v[68:69] op_sel_hi:[1,0] neg_lo:[0,1] neg_hi:[0,1]
    v_pk_mul_f32 v[40:41], v[40:41], v[68:69] op_sel:[0,1] op_sel_hi:[1,1]
    v_pk_fma_f32 v[24:25], v[40:41], v[114:115], v[24:25]
    v_cvt_pk_bf16_f32 v92, v24, v25
    v_pk_add_f32 v[42:43], v[26:27], v[68:69] op_sel_hi:[1,0] neg_lo:[0,1] neg_hi:[0,1]
    v_pk_mul_f32 v[42:43], v[42:43], v[68:69] op_sel:[0,1] op_sel_hi:[1,1]
    v_pk_fma_f32 v[26:27], v[42:43], v[116:117], v[26:27]
    v_cvt_pk_bf16_f32 v93, v26, v27
    buffer_store_dwordx4 v[90:93], v82, s[20:23], 0 offen offset:128 sc1
    s_branch R_s2
R_l0:
    v_lshlrev_b32 v12, 16, v86
    v_and_b32 v13, 0xffff0000, v86
    v_lshlrev_b32 v14, 16, v87
    v_and_b32 v15, 0xffff0000, v87
    v_lshlrev_b32 v16, 16, v88
    v_and_b32 v17, 0xffff0000, v88
    v_lshlrev_b32 v18, 16, v89
    v_and_b32 v19, 0xffff0000, v89
    v_lshlrev_b32 v20, 16, v90
    v_and_b32 v21, 0xffff0000, v90
    v_lshlrev_b32 v22, 16, v91
    v_and_b32 v23, 0xffff0000, v91
    v_lshlrev_b32 v24, 16, v92
    v_and_b32 v25, 0xffff0000, v92
    v_lshlrev_b32 v26, 16, v93
    v_and_b32 v27, 0xffff0000, v93
    v_pk_add_f32 v[48:49], v[12:13], v[14:15]
    v_pk_mul_f32 v[50:51], v[12:13], v[12:13]
    v_pk_fma_f32 v[50:51], v[14:15], v[14:15], v[50:51]
    v_pk_add_f32 v[48:49], v[48:49], v[16:17]
    v_pk_fma_f32 v[50:51], v[16:17], v[16:17], v[50:51]
    v_pk_add_f32 v[48:49], v[48:49], v[18:19]
    v_pk_fma_f32 v[50:51], v[18:19], v[18:19], v[50:51]
    v_pk_add_f32 v[48:49], v[48:49], v[20:21]
    v_pk_fma_f32 v[50:51], v[20:21], v[20:21], v[50:51]
    v_pk_add_f32 v[48:49], v[48:49], v[22:23]
    v_pk_fma_f32 v[50:51], v[22:23], v[22:23], v[50:51]
    v_pk_add_f32 v[48:49], v[48:49], v[24:25]
    v_pk_fma_f32 v[50:51], v[24:25], v[24:25], v[50:51]
    v_pk_add_f32 v[48:49], v[48:49], v[26:27]
    v_pk_fma_f32 v[50:51], v[26:27], v[26:27], v[50:51]
    v_add_f32 v46, v48, v49
    v_add_f32 v47, v50, v51
    s_nop 0
    v_add_f32_dpp v46, v46, v46 row_ror:8 row_mask:0xf bank_mask:0xf
    v_add_f32_dpp v47, v47, v47 row_ror:8 row_mask:0xf bank_mask:0xf
    v_mov_b32 v48, v46
    v_mov_b32 v49, v47
    s_nop 0
    v_permlane16_swap_b32 v46, v48
    v_permlane16_swap_b32 v47, v49
    v_pk_add_f32 v[46:47], v[46:47], v[48:49]
    v_mov_b32 v48, v46
    v_mov_b32 v49, v47
    s_nop 0
    v_permlane32_swap_b32 v46, v48
    v_permlane32_swap_b32 v47, v49
    v_pk_add_f32 v[46:47], v[46:47], v[48:49]
    ds_write_b64 v71, v[46:47] offset:0
    s_waitcnt lgkmcnt(0)
    s_barrier
    ds_read_b128 v[52:55], v72 offset:0
    ds_read_b128 v[56:59], v72 offset:16
    ds_read_b128 v[60:63], v72 offset:32
    ds_read_b128 v[64:67], v72 offset:48
    s_waitcnt lgkmcnt(0)
    v_pk_add_f32 v[52:53], v[52:53], v[54:55]
    v_pk_add_f32 v[56:57], v[56:57], v[58:59]
    v_pk_add_f32 v[60:61], v[60:61], v[62:63]
    v_pk_add_f32 v[64:65], v[64:65], v[66:67]
    v_pk_add_f32 v[52:53], v[52:53], v[56:57]
    v_pk_add_f32 v[60:61], v[60:61], v[64:65]
    v_pk_add_f32 v[52:53], v[52:53], v[60:61]
    v_mul_f32 v68, 0x3a800000, v52
    v_mul_f32 v70, 0x3a800000, v53
    v_fma_f32 v70, -v68, v68, v70
    v_max_f32 v70, 0, v70
    s_cmp_ge_u32 s30, 4
    s_cbranch_scc1 w1in_16
    ds_read_b64_tr_b16 v[128:129], v74 offset:0
    ds_read_b64_tr_b16 v[130:131], v74 offset:2048
    ds_read_b64_tr_b16 v[136:137], v74 offset:4096
    ds_read_b64_tr_b16 v[138:139], v74 offset:6144
    ds_read_b64_tr_b16 v[144:145], v74 offset:8192
    ds_read_b64_tr_b16 v[146:147], v74 offset:10240
    ds_read_b64_tr_b16 v[152:153], v74 offset:12288
    ds_read_b64_tr_b16 v[154:155], v74 offset:14336
    ds_read_b64_tr_b16 v[160:161], v74 offset:16384
    ds_read_b64_tr_b16 v[162:163], v74 offset:18432
    ds_read_b64_tr_b16 v[168:169], v74 offset:20480
    ds_read_b64_tr_b16 v[170:171], v74 offset:22528
    ds_read_b64_tr_b16 v[176:177], v74 offset:24576
    ds_read_b64_tr_b16 v[178:179], v74 offset:26624
    ds_read_b64_tr_b16 v[184:185], v74 offset:28672
    ds_read_b64_tr_b16 v[186:187], v74 offset:30720
    ds_read_b64_tr_b16 v[192:193], v74 offset:32768
    ds_read_b64_tr_b16 v[194:195], v74 offset:34816
    ds_read_b64_tr_b16 v[200:201], v74 offset:36864
    ds_read_b64_tr_b16 v[202:203], v74 offset:38912
    ds_read_b64_tr_b16 v[208:209], v74 offset:40960
    ds_read_b64_tr_b16 v[210:211], v74 offset:43008
    ds_read_b64_tr_b16 v[216:217], v74 offset:45056
    ds_read_b64_tr_b16 v[218:219], v74 offset:47104
    ds_read_b64_tr_b16 v[224:225], v74 offset:49152
    ds_read_b64_tr_b16 v[226:227], v74 offset:51200
    ds_read_b64_tr_b16 v[232:233], v74 offset:53248
    ds_read_b64_tr_b16 v[234:235], v74 offset:55296
    ds_read_b64_tr_b16 v[240:241], v74 offset:57344
    ds_read_b64_tr_b16 v[242:243], v74 offset:59392
    ds_read_b64_tr_b16 v[248:249], v74 offset:61440
    ds_read_b64_tr_b16 v[250:251], v74 offset:63488
    ds_read_b64_tr_b16 v[132:133], v75 offset:0
    ds_read_b64_tr_b16 v[134:135], v75 offset:2048
    ds_read_b64_tr_b16 v[140:141], v75 offset:4096
    ds_read_b64_tr_b16 v[142:143], v75 offset:6144
    ds_read_b64_tr_b16 v[148:149], v75 offset:8192
    ds_read_b64_tr_b16 v[150:151], v75 offset:10240
    ds_read_b64_tr_b16 v[156:157], v75 offset:12288
    ds_read_b64_tr_b16 v[158:159], v75 offset:14336
    ds_read_b64_tr_b16 v[164:165], v75 offset:16384
    ds_read_b64_tr_b16 v[166:167], v75 offset:18432
    ds_read_b64_tr_b16 v[172:173], v75 offset:20480
    ds_read_b64_tr_b16 v[174:175], v75 offset:22528
    ds_read_b64_tr_b16 v[180:181], v75 offset:24576
    ds_read_b64_tr_b16 v[182:183], v75 offset:26624
    ds_read_b64_tr_b16 v[188:189], v75 offset:28672
    ds_read_b64_tr_b16 v[190:191], v75 offset:30720
    ds_read_b64_tr_b16 v[196:197], v75 offset:32768
    ds_read_b64_tr_b16 v[198:199], v75 offset:34816
    ds_read_b64_tr_b16 v[204:205], v75 offset:36864
    ds_read_b64_tr_b16 v[206:207], v75 offset:38912
    ds_read_b64_tr_b16 v[212:213], v75 offset:40960
    ds_read_b64_tr_b16 v[214:215], v75 offset:43008
    ds_read_b64_tr_b16 v[220:221], v75 offset:45056
    ds_read_b64_tr_b16 v[222:223], v75 offset:47104
    ds_read_b64_tr_b16 v[228:229], v75 offset:49152
    ds_read_b64_tr_b16 v[230:231], v75 offset:51200
    ds_read_b64_tr_b16 v[236:237], v75 offset:53248
    ds_read_b64_tr_b16 v[238:239], v75 offset:55296
    ds_read_b64_tr_b16 v[244:245], v75 offset:57344
    ds_read_b64_tr_b16 v[246:247], v75 offset:59392
    ds_read_b64_tr_b16 v[252:253], v75 offset:61440
    ds_read_b64_tr_b16 v[254:255], v75 offset:63488
w1in_16:
    v_cvt_pk_bf16_f32 v68, v68, v68
    v_lshlrev_b32 v68, 16, v68
    v_cvt_pk_bf16_f32 v70, v70, v70
    v_lshlrev_b32 v70, 16, v70
    v_add_f32 v70, 0x3727c5ac, v70
    v_cvt_pk_bf16_f32 v70, v70, v70
    v_lshlrev_b32 v70, 16, v70
    v_sqrt_f32 v70, v70
    s_nop 0
    v_cvt_pk_bf16_f32 v70, v70, v70
    v_lshlrev_b32 v70, 16, v70
    v_rcp_f32 v69, v70
    s_nop 0
    v_pk_add_f32 v[28:29], v[12:13], v[68:69] op_sel_hi:[1,0] neg_lo:[0,1] neg_hi:[0,1]
    v_cvt_pk_bf16_f32 v44, v28, v29
    v_lshlrev_b32 v28, 16, v44
    v_and_b32 v29, 0xffff0000, v44
    v_pk_mul_f32 v[28:29], v[28:29], v[68:69] op_sel:[0,1] op_sel_hi:[1,1]
    v_cvt_pk_bf16_f32 v44, v28, v29
    v_lshlrev_b32 v28, 16, v44
    v_and_b32 v29, 0xffff0000, v44
    v_pk_add_f32 v[30:31], v[14:15], v[68:69] op_sel_hi:[1,0] neg_lo:[0,1] neg_hi:[0,1]
    v_cvt_pk_bf16_f32 v44, v30, v31
    v_lshlrev_b32 v30, 16, v44
    v_and_b32 v31, 0xffff0000, v44
    v_pk_mul_f32 v[30:31], v[30:31], v[68:69] op_sel:[0,1] op_sel_hi:[1,1]
    v_cvt_pk_bf16_f32 v44, v30, v31
    v_lshlrev_b32 v30, 16, v44
    v_and_b32 v31, 0xffff0000, v44
    v_pk_add_f32 v[32:33], v[16:17], v[68:69] op_sel_hi:[1,0] neg_lo:[0,1] neg_hi:[0,1]
    v_cvt_pk_bf16_f32 v44, v32, v33
    v_lshlrev_b32 v32, 16, v44
    v_and_b32 v33, 0xffff0000, v44
    v_pk_mul_f32 v[32:33], v[32:33], v[68:69] op_sel:[0,1] op_sel_hi:[1,1]
    v_cvt_pk_bf16_f32 v44, v32, v33
    v_lshlrev_b32 v32, 16, v44
    v_and_b32 v33, 0xffff0000, v44
    v_pk_add_f32 v[34:35], v[18:19], v[68:69] op_sel_hi:[1,0] neg_lo:[0,1] neg_hi:[0,1]
    v_cvt_pk_bf16_f32 v44, v34, v35
    v_lshlrev_b32 v34, 16, v44
    v_and_b32 v35, 0xffff0000, v44
    v_pk_mul_f32 v[34:35], v[34:35], v[68:69] op_sel:[0,1] op_sel_hi:[1,1]
    v_cvt_pk_bf16_f32 v44, v34, v35
    v_lshlrev_b32 v34, 16, v44
    v_and_b32 v35, 0xffff0000, v44
    v_pk_add_f32 v[36:37], v[20:21], v[68:69] op_sel_hi:[1,0] neg_lo:[0,1] neg_hi:[0,1]
    v_cvt_pk_bf16_f32 v44, v36, v37
    v_lshlrev_b32 v36, 16, v44
    v_and_b32 v37, 0xffff0000, v44
    v_pk_mul_f32 v[36:37], v[36:37], v[68:69] op_sel:[0,1] op_sel_hi:[1,1]
    v_cvt_pk_bf16_f32 v44, v36, v37
    v_lshlrev_b32 v36, 16, v44
    v_and_b32 v37, 0xffff0000, v44
    v_pk_add_f32 v[38:39], v[22:23], v[68:69] op_sel_hi:[1,0] neg_lo:[0,1] neg_hi:[0,1]
    v_cvt_pk_bf16_f32 v44, v38, v39
    v_lshlrev_b32 v38, 16, v44
    v_and_b32 v39, 0xffff0000, v44
    v_pk_mul_f32 v[38:39], v[38:39], v[68:69] op_sel:[0,1] op_sel_hi:[1,1]
    v_cvt_pk_bf16_f32 v44, v38, v39
    v_lshlrev_b32 v38, 16, v44
    v_and_b32 v39, 0xffff0000, v44
    v_pk_add_f32 v[40:41], v[24:25], v[68:69] op_sel_hi:[1,0] neg_lo:[0,1] neg_hi:[0,1]
    v_cvt_pk_bf16_f32 v44, v40, v41
    v_lshlrev_b32 v40, 16, v44
    v_and_b32 v41, 0xffff0000, v44
    v_pk_mul_f32 v[40:41], v[40:41], v[68:69] op_sel:[0,1] op_sel_hi:[1,1]
    v_cvt_pk_bf16_f32 v44, v40, v41
    v_lshlrev_b32 v40, 16, v44
    v_and_b32 v41, 0xffff0000, v44
    v_pk_add_f32 v[42:43], v[26:27], v[68:69] op_sel_hi:[1,0] neg_lo:[0,1] neg_hi:[0,1]
    v_cvt_pk_bf16_f32 v44, v42, v43
    v_lshlrev_b32 v42, 16, v44
    v_and_b32 v43, 0xffff0000, v44
    v_pk_mul_f32 v[42:43], v[42:43], v[68:69] op_sel:[0,1] op_sel_hi:[1,1]
    v_cvt_pk_bf16_f32 v44, v42, v43
    v_lshlrev_b32 v42, 16, v44
    v_and_b32 v43, 0xffff0000, v44
    s_cmp_lg_u32 s30, 0
    s_cbranch_scc1 R_fw
    s_lshl_b32 s36, s28, 13
    s_add_u32 s36, s36, 23592960
    v_lshlrev_b32 v56, 7, v1
    v_add_u32 v56, s36, v56
    s_mov_b32 s53, 0
R_fp:
    buffer_load_dword v52, v56, s[56:59], 0 offen sc1
    s_waitcnt vmcnt(0)
    v_subrev_u32 v52, s52, v52
    v_and_b32 v53, 0xfffff8ff, v52
    v_cmp_eq_u32 vcc, 4, v53
    s_nop 0
    s_cmp_eq_u64 vcc, exec
    s_cbranch_scc1 R_fq
    s_sleep 3
    s_add_u32 s53, s53, 1
    s_cmp_lt_u32 s53, s61
    s_cbranch_scc1 R_fp
    s_mov_b32 s61, 0
R_fq:
    v_lshrrev_b32 v52, 8, v52
    v_mov_b32 v53, 162844
    ds_add_u32 v53, v52
R_fw:
    s_waitcnt lgkmcnt(0)
    s_barrier
    s_add_u32 s80, s4, 0x1c00000
    s_addc_u32 s81, s5, 0
    s_mov_b32 s82, 0x400000
    s_mov_b32 s83, 0x20000
    s_mov_b32 s78, 0
    buffer_load_dwordx2 v[110:111], v79, s[80:83], s78 offen sc1
    s_mov_b32 s78, 65536
    buffer_load_dwordx2 v[112:113], v79, s[80:83], s78 offen sc1
    s_mov_b32 s78, 262144
    buffer_load_dwordx2 v[114:115], v79, s[80:83], s78 offen sc1
    s_mov_b32 s78, 327680
    buffer_load_dwordx2 v[116:117], v79, s[80:83], s78 offen sc1
    v_mov_b32 v6, 162844
    ds_read_b32 v7, v6
    s_cmp_ge_u32 s30, 4
    s_cbranch_scc1 w1in_17
    v_mov_b32 v52, 0x3f803f80
    v_mov_b32 v53, 0x3f803f80
    v_mov_b32 v54, 0x3f803f80
    v_mov_b32 v55, 0x3f803f80
    s_lshl_b32 s35, s30, 6
    s_add_u32 s35, s35, 163328
    v_and_b32 v64, 48, v1
    v_add_u32 v64, s35, v64
    s_waitcnt lgkmcnt(0)
    v_mfma_f32_16x16x32_bf16 v[56:59], v[128:131], v[52:55], 0
    v_mfma_f32_16x16x32_bf16 v[56:59], v[132:135], v[52:55], v[56:59]
    v_mfma_f32_16x16x32_bf16 v[56:59], v[136:139], v[52:55], v[56:59]
    v_mfma_f32_16x16x32_bf16 v[56:59], v[140:143], v[52:55], v[56:59]
    v_mfma_f32_16x16x32_bf16 v[56:59], v[144:147], v[52:55], v[56:59]
    v_mfma_f32_16x16x32_bf16 v[56:59], v[148:151], v[52:55], v[56:59]
    v_mfma_f32_16x16x32_bf16 v[56:59], v[152:155], v[52:55], v[56:59]
    v_mfma_f32_16x16x32_bf16 v[56:59], v[156:159], v[52:55], v[56:59]
    v_mfma_f32_16x16x32_bf16 v[56:59], v[160:163], v[52:55], v[56:59]
    v_mfma_f32_16x16x32_bf16 v[56:59], v[164:167], v[52:55], v[56:59]
    v_mfma_f32_16x16x32_bf16 v[56:59], v[168:171], v[52:55], v[56:59]
    v_mfma_f32_16x16x32_bf16 v[56:59], v[172:175], v[52:55], v[56:59]
    v_mfma_f32_16x16x32_bf16 v[56:59], v[176:179], v[52:55], v[56:59]
    v_mfma_f32_16x16x32_bf16 v[56:59], v[180:183], v[52:55], v[56:59]
    v_mfma_f32_16x16x32_bf16 v[56:59], v[184:187], v[52:55], v[56:59]
    v_mfma_f32_16x16x32_bf16 v[56:59], v[188:191], v[52:55], v[56:59]
    v_mfma_f32_16x16x32_bf16 v[56:59], v[192:195], v[52:55], v[56:59]
    v_mfma_f32_16x16x32_bf16 v[56:59], v[196:199], v[52:55], v[56:59]
    v_mfma_f32_16x16x32_bf16 v[56:59], v[200:203], v[52:55], v[56:59]
    v_mfma_f32_16x16x32_bf16 v[56:59], v[204:207], v[52:55], v[56:59]
    v_mfma_f32_16x16x32_bf16 v[56:59], v[208:211], v[52:55], v[56:59]
    v_mfma_f32_16x16x32_bf16 v[56:59], v[212:215], v[52:55], v[56:59]
    v_mfma_f32_16x16x32_bf16 v[56:59], v[216:219], v[52:55], v[56:59]
    v_mfma_f32_16x16x32_bf16 v[56:59], v[220:223], v[52:55], v[56:59]
    v_mfma_f32_16x16x32_bf16 v[56:59], v[224:227], v[52:55], v[56:59]
    v_mfma_f32_16x16x32_bf16 v[56:59], v[228:231], v[52:55], v[56:59]
    v_mfma_f32_16x16x32_bf16 v[56:59], v[232:235], v[52:55], v[56:59]
    v_mfma_f32_16x16x32_bf16 v[56:59], v[236:239], v[52:55], v[56:59]
    v_mfma_f32_16x16x32_bf16 v[56:59], v[240:243], v[52:55], v[56:59]
    v_mfma_f32_16x16x32_bf16 v[56:59], v[244:247], v[52:55], v[56:59]
    v_mfma_f32_16x16x32_bf16 v[56:59], v[248:251], v[52:55], v[56:59]
    v_mfma_f32_16x16x32_bf16 v[56:59], v[252:255], v[52:55], v[56:59]
    s_mov_b32 exec_lo, 0x10001
    s_mov_b32 exec_hi, 0x10001
    s_nop 5
    ds_write_b128 v64, v[56:59]
    s_mov_b64 exec, -1
    s_waitcnt lgkmcnt(0)
w1in_17:
    s_waitcnt lgkmcnt(0)
    v_readfirstlane_b32 s94, v7
    s_nop 0
    s_cmp_gt_u32 s94, 127
    s_cselect_b32 s94, 1, 0
    s_lshr_b32 s53, s28, 3
    s_lshl_b32 s53, s53, 2
    s_and_b32 s54, s28, 3
    s_add_u32 s53, s53, s54
    s_lshl_b32 s53, s53, 23
    s_lshr_b32 s54, s28, 2
    s_xor_b32 s54, s54, s94
    s_and_b32 s54, s54, 1
    s_lshl_b32 s54, s54, 13
    s_add_u32 s55, s53, s54
    s_add_u32 s55, s55, 33554432
    s_add_u32 s62, s4, s55
    s_addc_u32 s63, s5, 0
    s_sub_u32 s36, s28, 1
    s_max_i32 s36, s36, 0
    s_lshr_b32 s53, s36, 3
    s_lshl_b32 s53, s53, 2
    s_and_b32 s54, s36, 3
    s_add_u32 s53, s53, s54
    s_lshl_b32 s53, s53, 23
    s_lshr_b32 s54, s36, 2
    s_xor_b32 s54, s54, s94
    s_and_b32 s54, s54, 1
    s_lshl_b32 s54, s54, 13
    s_add_u32 s92, s53, s54
    s_add_u32 s92, s92, 33554432
    s_sub_u32 s92, s92, s55
    s_add_u32 s36, s28, 1
    s_min_u32 s36, s36, 15
    s_lshr_b32 s53, s36, 3
    s_lshl_b32 s53, s53, 2
    s_and_b32 s54, s36, 3
    s_add_u32 s53, s53, s54
    s_lshl_b32 s53, s53, 23
    s_lshr_b32 s54, s36, 2
    s_xor_b32 s54, s54, s94
    s_and_b32 s54, s54, 1
    s_lshl_b32 s54, s54, 13
    s_add_u32 s93, s53, s54
    s_add_u32 s93, s93, 33554432
    s_sub_u32 s93, s93, s55
    s_add_u32 s55, s55, 1835008
    s_lshl_b32 s22, s60, 24
    s_lshl_b32 s23, s94, 13
    s_add_u32 s22, s22, s23
    s_add_u32 s22, s22, 167772160
    s_add_u32 s20, s4, s22
    s_addc_u32 s21, s5, 0
    s_mov_b32 s22, 8380416
    s_mov_b32 s23, 0x20000
    s_waitcnt vmcnt(0)
    v_lshlrev_b32 v52, 16, v110
    v_and_b32 v53, 0xffff0000, v110
    v_pk_mul_f32 v[28:29], v[28:29], v[52:53]
    v_cvt_pk_bf16_f32 v44, v28, v29
    v_lshlrev_b32 v28, 16, v44
    v_and_b32 v29, 0xffff0000, v44
    v_pk_add_f32 v[12:13], v[12:13], v[28:29]
    v_cvt_pk_bf16_f32 v86, v12, v13
    v_lshlrev_b32 v52, 16, v111
    v_and_b32 v53, 0xffff0000, v111
    v_pk_mul_f32 v[30:31], v[30:31], v[52:53]
    v_cvt_pk_bf16_f32 v44, v30, v31
    v_lshlrev_b32 v30, 16, v44
    v_and_b32 v31, 0xffff0000, v44
    v_pk_add_f32 v[14:15], v[14:15], v[30:31]
    v_cvt_pk_bf16_f32 v87, v14, v15
    v_lshlrev_b32 v52, 16, v112
    v_and_b32 v53, 0xffff0000, v112
    v_pk_mul_f32 v[32:33], v[32:33], v[52:53]
    v_cvt_pk_bf16_f32 v44, v32, v33
    v_lshlrev_b32 v32, 16, v44
    v_and_b32 v33, 0xffff0000, v44
    v_pk_add_f32 v[16:17], v[16:17], v[32:33]
    v_cvt_pk_bf16_f32 v88, v16, v17
    v_lshlrev_b32 v52, 16, v113
    v_and_b32 v53, 0xffff0000, v113
    v_pk_mul_f32 v[34:35], v[34:35], v[52:53]
    v_cvt_pk_bf16_f32 v44, v34, v35
    v_lshlrev_b32 v34, 16, v44
    v_and_b32 v35, 0xffff0000, v44
    v_pk_add_f32 v[18:19], v[18:19], v[34:35]
    v_cvt_pk_bf16_f32 v89, v18, v19
    buffer_store_dwordx4 v[86:89], v82, s[20:23], 0 offen offset:0 sc1
    v_lshlrev_b32 v52, 16, v114
    v_and_b32 v53, 0xffff0000, v114
    v_pk_mul_f32 v[36:37], v[36:37], v[52:53]
    v_cvt_pk_bf16_f32 v44, v36, v37
    v_lshlrev_b32 v36, 16, v44
    v_and_b32 v37, 0xffff0000, v44
    v_pk_add_f32 v[20:21], v[20:21], v[36:37]
    v_cvt_pk_bf16_f32 v90, v20, v21
    v_lshlrev_b32 v52, 16, v115
    v_and_b32 v53, 0xffff0000, v115
    v_pk_mul_f32 v[38:39], v[38:39], v[52:53]
    v_cvt_pk_bf16_f32 v44, v38, v39
    v_lshlrev_b32 v38, 16, v44
    v_and_b32 v39, 0xffff0000, v44
    v_pk_add_f32 v[22:23], v[22:23], v[38:39]
    v_cvt_pk_bf16_f32 v91, v22, v23
    v_lshlrev_b32 v52, 16, v116
    v_and_b32 v53, 0xffff0000, v116
    v_pk_mul_f32 v[40:41], v[40:41], v[52:53]
    v_cvt_pk_bf16_f32 v44, v40, v41
    v_lshlrev_b32 v40, 16, v44
    v_and_b32 v41, 0xffff0000, v44
    v_pk_add_f32 v[24:25], v[24:25], v[40:41]
    v_cvt_pk_bf16_f32 v92, v24, v25
    v_lshlrev_b32 v52, 16, v117
    v_and_b32 v53, 0xffff0000, v117
    v_pk_mul_f32 v[42:43], v[42:43], v[52:53]
    v_cvt_pk_bf16_f32 v44, v42, v43
    v_lshlrev_b32 v42, 16, v44
    v_and_b32 v43, 0xffff0000, v44
    v_pk_add_f32 v[26:27], v[26:27], v[42:43]
    v_cvt_pk_bf16_f32 v93, v26, v27
    buffer_store_dwordx4 v[90:93], v82, s[20:23], 0 offen offset:128 sc1
R_s2:
    v_lshlrev_b32 v12, 16, v86
    v_and_b32 v13, 0xffff0000, v86
    v_lshlrev_b32 v14, 16, v87
    v_and_b32 v15, 0xffff0000, v87
    v_lshlrev_b32 v16, 16, v88
    v_and_b32 v17, 0xffff0000, v88
    v_lshlrev_b32 v18, 16, v89
    v_and_b32 v19, 0xffff0000, v89
    v_lshlrev_b32 v20, 16, v90
    v_and_b32 v21, 0xffff0000, v90
    v_lshlrev_b32 v22, 16, v91
    v_and_b32 v23, 0xffff0000, v91
    v_lshlrev_b32 v24, 16, v92
    v_and_b32 v25, 0xffff0000, v92
    v_lshlrev_b32 v26, 16, v93
    v_and_b32 v27, 0xffff0000, v93
    v_pk_add_f32 v[48:49], v[12:13], v[14:15]
    v_pk_mul_f32 v[50:51], v[12:13], v[12:13]
    v_pk_fma_f32 v[50:51], v[14:15], v[14:15], v[50:51]
    v_pk_add_f32 v[48:49], v[48:49], v[16:17]
    v_pk_fma_f32 v[50:51], v[16:17], v[16:17], v[50:51]
    v_pk_add_f32 v[48:49], v[48:49], v[18:19]
    v_pk_fma_f32 v[50:51], v[18:19], v[18:19], v[50:51]
    v_pk_add_f32 v[48:49], v[48:49], v[20:21]
    v_pk_fma_f32 v[50:51], v[20:21], v[20:21], v[50:51]
    v_pk_add_f32 v[48:49], v[48:49], v[22:23]
    v_pk_fma_f32 v[50:51], v[22:23], v[22:23], v[50:51]
    v_pk_add_f32 v[48:49], v[48:49], v[24:25]
    v_pk_fma_f32 v[50:51], v[24:25], v[24:25], v[50:51]
    v_pk_add_f32 v[48:49], v[48:49], v[26:27]
    v_pk_fma_f32 v[50:51], v[26:27], v[26:27], v[50:51]
    v_add_f32 v46, v48, v49
    v_add_f32 v47, v50, v51
    s_nop 0
    v_add_f32_dpp v46, v46, v46 row_ror:8 row_mask:0xf bank_mask:0xf
    v_add_f32_dpp v47, v47, v47 row_ror:8 row_mask:0xf bank_mask:0xf
    v_mov_b32 v48, v46
    v_mov_b32 v49, v47
    s_nop 0
    v_permlane16_swap_b32 v46, v48
    v_permlane16_swap_b32 v47, v49
    v_pk_add_f32 v[46:47], v[46:47], v[48:49]
    v_mov_b32 v48, v46
    v_mov_b32 v49, v47
    s_nop 0
    v_permlane32_swap_b32 v46, v48
    v_permlane32_swap_b32 v47, v49
    v_pk_add_f32 v[46:47], v[46:47], v[48:49]
    ds_write_b64 v71, v[46:47] offset:512
    s_waitcnt lgkmcnt(0)
    s_barrier
    s_cmp_lg_u32 s30, 7
    s_cbranch_scc1 R_nl
    ds_read_b128 v[52:55], v72 offset:512
    ds_read_b128 v[56:59], v72 offset:528
    ds_read_b128 v[60:63], v72 offset:544
    ds_read_b128 v[64:67], v72 offset:560
    s_waitcnt lgkmcnt(0)
    v_pk_add_f32 v[52:53], v[52:53], v[54:55]
    v_pk_add_f32 v[56:57], v[56:57], v[58:59]
    v_pk_add_f32 v[60:61], v[60:61], v[62:63]
    v_pk_add_f32 v[64:65], v[64:65], v[66:67]
    v_pk_add_f32 v[52:53], v[52:53], v[56:57]
    v_pk_add_f32 v[60:61], v[60:61], v[64:65]
    v_pk_add_f32 v[52:53], v[52:53], v[60:61]
    v_mul_f32 v68, 0x3a800000, v52
    v_mul_f32 v70, 0x3a800000, v53
    v_fma_f32 v70, -v68, v68, v70
    v_max_f32 v70, 0, v70
    v_mov_b32 v32, v68
    v_mov_b32 v33, v70
    v_cvt_pk_bf16_f32 v68, v68, v68
    v_lshlrev_b32 v68, 16, v68
    v_cvt_pk_bf16_f32 v70, v70, v70
    v_lshlrev_b32 v70, 16, v70
    v_add_f32 v70, 0x3727c5ac, v70
    v_cvt_pk_bf16_f32 v70, v70, v70
    v_lshlrev_b32 v70, 16, v70
    v_sqrt_f32 v70, v70
    s_nop 0
    v_cvt_pk_bf16_f32 v70, v70, v70
    v_lshlrev_b32 v70, 16, v70
    v_rcp_f32 v69, v70
    v_sub_f32 v32, v32, v68
    v_mul_f32 v32, v32, v69
    v_mul_f32 v33, v33, v69
    v_mul_f32 v33, v33, v69
    v_cvt_pk_bf16_f32 v32, v32, v32
    v_lshlrev_b32 v32, 16, v32
    v_cvt_pk_bf16_f32 v33, v33, v33
    v_lshlrev_b32 v33, 16, v33
    v_add_f32 v33, 0x3727c5ac, v33
    v_cvt_pk_bf16_f32 v33, v33, v33
    v_lshlrev_b32 v33, 16, v33
    v_sqrt_f32 v33, v33
    s_nop 0
    v_cvt_pk_bf16_f32 v33, v33, v33
    v_lshlrev_b32 v33, 16, v33
    v_cvt_pk_bf16_f32 v28, v68, v70
    v_cvt_pk_bf16_f32 v30, v32, v33
    v_mov_b32 v29, s52
    v_mov_b32 v31, s52
    s_lshl_b32 s26, s60, 15
    s_add_u32 s26, s26, 23199744
    s_add_u32 s24, s4, s26
    s_addc_u32 s25, s5, 0
    s_mov_b32 s26, 32768
    s_mov_b32 s27, 0x20000
    s_lshl_b32 s36, s28, 4
    s_add_u32 s36, s36, s29
    s_lshl_b32 s36, s36, 7
    s_mov_b64 exec, 0xff
    buffer_store_dwordx4 v[28:31], v2, s[24:27], s36 offen sc1
    s_mov_b64 exec, -1
    s_waitcnt vmcnt(1)
    s_branch R_n2
R_nl:
    s_cmp_lt_u32 s30, 4
    s_cbranch_scc1 R_n1
    s_waitcnt vmcnt(0)
    s_branch R_n2
R_n1:
    s_waitcnt vmcnt(0)
R_n2:
    s_add_u32 s53, s55, 0
    v_mov_b32 v8, 1
    v_mov_b32 v9, 162820
    v_mov_b32 v11, 0
    s_mov_b64 exec, 1
    ds_add_rtn_u32 v10, v9, v8
    s_waitcnt lgkmcnt(0)
    v_readfirstlane_b32 s54, v10
    s_nop 0
    s_and_b32 s54, s54, 7
    s_cmp_lg_u32 s54, 7
    s_cbranch_scc1 pub_18
    buffer_atomic_add v8, v11, s[56:59], s53 offen sc1
pub_18:
    s_mov_b64 exec, -1
    s_cmp_ge_u32 s30, 4
    s_cbranch_scc1 LOADERS
    s_cmp_lg_u32 s30, 0
    s_cbranch_scc1 pdone_19
    s_add_u32 s54, s55, 0x0
    v_mov_b32 v105, s54
    s_bitcmp1_b32 s29, 2
    s_cselect_b32 s53, s93, s92
    s_add_u32 s53, s53, s54
    v_writelane_b32 v105, s53, 1
    s_mov_b32 s53, 0
    s_add_u32 s54, s52, 16
    s_bfm_b64 exec, 2, 0
poll_20:
    buffer_load_dword v104, v105, s[56:59], 0 offen sc1
    s_waitcnt vmcnt(0)
    v_cmp_eq_u32 vcc, s54, v104
    s_nop 0
    s_cmp_eq_u64 vcc, exec
    s_cbranch_scc1 pok_21
    s_sleep 5
    s_add_u32 s53, s53, 1
    s_cmp_lt_u32 s53, s61
    s_cbranch_scc1 poll_20
    s_mov_b32 s61, 0
pok_21:
    s_mov_b64 exec, -1
pdone_19:
    s_barrier
    v_and_b32 v8, 15, v1
    v_lshrrev_b32 v9, 4, v1
    s_lshl_b32 s36, s30, 6
    s_add_u32 s36, s36, 163328
    v_lshlrev_b32 v6, 4, v9
    v_add_u32 v6, s36, v6
    ds_read_b128 v[84:87], v6
    v_xor_b32 v6, v9, v8
    v_lshlrev_b32 v7, 8, v8
    v_xor_b32 v10, 0, v6
    v_lshl_add_u32 v10, v10, 4, v7
    v_add_u32 v14, 106496, v10
    v_xor_b32 v11, 4, v6
    v_lshl_add_u32 v11, v11, 4, v7
    v_add_u32 v15, 106496, v11
    v_xor_b32 v12, 8, v6
    v_lshl_add_u32 v12, v12, 4, v7
    v_add_u32 v16, 106496, v12
    v_xor_b32 v13, 12, v6
    v_lshl_add_u32 v13, v13, 4, v7
    v_add_u32 v17, 106496, v13
    v_lshlrev_b32 v18, 4, v8
    v_add_u32 v18, 155648, v18
    s_add_u32 s16, s62, 0x400000
    s_addc_u32 s17, s63, 0
    s_mov_b32 s18, 0x7e000
    s_mov_b32 s19, 0x20000
    v_and_b32 v6, 1, v9
    v_lshlrev_b32 v114, 16, v6
    v_lshrrev_b32 v6, 1, v9
    v_lshl_add_u32 v114, v6, 8, v114
    v_lshl_add_u32 v114, v8, 4, v114
    s_bfe_u32 s36, s30, 0x10001
    s_lshl1_add_u32 s36, s29, s36
    s_lshr_b32 s53, s36, 3
    s_lshl_b32 s53, s53, 14
    s_and_b32 s39, s36, 7
    s_lshl_b32 s39, s39, 10
    s_add_u32 s39, s39, s53
    s_and_b32 s36, s30, 1
    s_lshl_b32 s36, s36, 9
    s_add_u32 s39, s39, s36
    s_and_b32 s12, s30, 3
    s_lshl_b32 s12, s12, 15
    s_add_u32 s53, s67, 0
    s_and_b32 s8, s53, 4
    s_and_b32 s53, s53, 2
    s_lshl_b32 s8, s8, 12
    s_lshl_b32 s53, s53, 11
    s_add_u32 s8, s8, s53
    s_add_u32 s8, s8, s12
    s_add_u32 s53, s67, 2
    s_and_b32 s9, s53, 4
    s_and_b32 s53, s53, 2
    s_lshl_b32 s9, s9, 12
    s_lshl_b32 s53, s53, 11
    s_add_u32 s9, s9, s53
    s_add_u32 s9, s9, s12
    s_add_u32 s53, s67, 4
    s_and_b32 s10, s53, 4
    s_and_b32 s53, s53, 2
    s_lshl_b32 s10, s10, 12
    s_lshl_b32 s53, s53, 11
    s_add_u32 s10, s10, s53
    s_add_u32 s10, s10, s12
    s_add_u32 s53, s67, 6
    s_and_b32 s11, s53, 4
    s_and_b32 s53, s53, 2
    s_lshl_b32 s11, s11, 12
    s_lshl_b32 s53, s53, 11
    s_add_u32 s11, s11, s53
    s_add_u32 s11, s11, s12
    s_and_b32 s53, s30, 2
    s_lshl_b32 s53, s53, 11
    s_and_b32 s12, s30, 1
    s_lshl_b32 s12, s12, 13
    s_add_u32 s12, s12, s53
    s_and_b32 s20, s30, 1
    s_lshl_b32 s20, s20, 8
    s_add_u32 s20, s20, s55
    s_add_u32 s21, s52, 16
    v_mov_b32 v112, 0x7f000000
    v_writelane_b32 v112, 0, 0
    v_mov_b32 v113, 1
    s_and_b32 s40, s30, 1
    s_lshl1_add_u32 s40, s31, s40
    s_lshl_b32 s40, s40, 7
    s_add_u32 s40, s40, s55
    s_waitcnt lgkmcnt(0)
    s_barrier
    ds_read_b128 v[36:39], v10 offset:16384
    ds_read_b128 v[40:43], v10 offset:20480
    ds_read_b128 v[44:47], v10 offset:24576
    ds_read_b128 v[48:51], v10 offset:28672
    ds_read_b128 v[52:55], v11 offset:16384
    ds_read_b128 v[56:59], v11 offset:20480
    ds_read_b128 v[60:63], v11 offset:24576
    ds_read_b128 v[64:67], v11 offset:28672
    s_waitcnt lgkmcnt(4)
    v_mfma_f32_16x16x32_bf16 v[20:23], v[128:131], v[36:39], 0
    ds_read_b128 v[68:71], v12 offset:16384
    v_mfma_f32_16x16x32_bf16 v[24:27], v[128:131], v[40:43], 0
    ds_read_b128 v[72:75], v12 offset:20480
    v_mfma_f32_16x16x32_bf16 v[24:27], v[132:135], v[48:51], v[24:27]
    ds_read_b128 v[76:79], v12 offset:24576
    v_mfma_f32_16x16x32_bf16 v[20:23], v[132:135], v[44:47], v[20:23]
    ds_read_b128 v[80:83], v12 offset:28672
    s_waitcnt lgkmcnt(4)
    v_mfma_f32_16x16x32_bf16 v[20:23], v[136:139], v[52:55], v[20:23]
    ds_read_b128 v[36:39], v13 offset:16384
    v_mfma_f32_16x16x32_bf16 v[24:27], v[136:139], v[56:59], v[24:27]
    ds_read_b128 v[40:43], v13 offset:20480
    v_mfma_f32_16x16x32_bf16 v[24:27], v[140:143], v[64:67], v[24:27]
    ds_read_b128 v[44:47], v13 offset:24576
    v_mfma_f32_16x16x32_bf16 v[20:23], v[140:143], v[60:63], v[20:23]
    ds_read_b128 v[48:51], v13 offset:28672
    s_barrier
    s_waitcnt lgkmcnt(4)
    v_mfma_f32_16x16x32_bf16 v[20:23], v[144:147], v[68:71], v[20:23]
    ds_read_b128 v[52:55], v10 offset:32768
    v_mfma_f32_16x16x32_bf16 v[24:27], v[144:147], v[72:75], v[24:27]
    ds_read_b128 v[56:59], v10 offset:36864
    v_mfma_f32_16x16x32_bf16 v[24:27], v[148:151], v[80:83], v[24:27]
    ds_read_b128 v[60:63], v10 offset:40960
    v_mfma_f32_16x16x32_bf16 v[20:23], v[148:151], v[76:79], v[20:23]
    ds_read_b128 v[64:67], v10 offset:45056
    s_waitcnt lgkmcnt(4)
    v_mfma_f32_16x16x32_bf16 v[20:23], v[152:155], v[36:39], v[20:23]
    ds_read_b128 v[68:71], v11 offset:32768
    v_mfma_f32_16x16x32_bf16 v[24:27], v[152:155], v[40:43], v[24:27]
    ds_read_b128 v[72:75], v11 offset:36864
    v_mfma_f32_16x16x32_bf16 v[24:27], v[156:159], v[48:51], v[24:27]
    ds_read_b128 v[76:79], v11 offset:40960
    v_mfma_f32_16x16x32_bf16 v[20:23], v[156:159], v[44:47], v[20:23]
    ds_read_b128 v[80:83], v11 offset:45056
    s_waitcnt lgkmcnt(4)
    v_mfma_f32_16x16x32_bf16 v[20:23], v[160:163], v[52:55], v[20:23]
    ds_read_b128 v[36:39], v12 offset:32768
    v_mfma_f32_16x16x32_bf16 v[24:27], v[160:163], v[56:59], v[24:27]
    ds_read_b128 v[40:43], v12 offset:36864
    v_mfma_f32_16x16x32_bf16 v[24:27], v[164:167], v[64:67], v[24:27]
    ds_read_b128 v[44:47], v12 offset:40960
    v_mfma_f32_16x16x32_bf16 v[20:23], v[164:167], v[60:63], v[20:23]
    ds_read_b128 v[48:51], v12 offset:45056
    s_waitcnt lgkmcnt(4)
    v_mfma_f32_16x16x32_bf16 v[20:23], v[168:171], v[68:71], v[20:23]
    ds_read_b128 v[52:55], v13 offset:32768
    v_mfma_f32_16x16x32_bf16 v[24:27], v[168:171], v[72:75], v[24:27]
    ds_read_b128 v[56:59], v13 offset:36864
    v_mfma_f32_16x16x32_bf16 v[24:27], v[172:175], v[80:83], v[24:27]
    ds_read_b128 v[60:63], v13 offset:40960
    v_mfma_f32_16x16x32_bf16 v[20:23], v[172:175], v[76:79], v[20:23]
    ds_read_b128 v[64:67], v13 offset:45056
    s_barrier
    s_waitcnt lgkmcnt(4)
    v_mfma_f32_16x16x32_bf16 v[20:23], v[176:179], v[36:39], v[20:23]
    ds_read_b128 v[68:71], v14 offset:0
    v_mfma_f32_16x16x32_bf16 v[24:27], v[176:179], v[40:43], v[24:27]
    ds_read_b128 v[72:75], v14 offset:4096
    v_mfma_f32_16x16x32_bf16 v[24:27], v[180:183], v[48:51], v[24:27]
    ds_read_b128 v[76:79], v14 offset:8192
    v_mfma_f32_16x16x32_bf16 v[20:23], v[180:183], v[44:47], v[20:23]
    ds_read_b128 v[80:83], v14 offset:12288
    s_waitcnt lgkmcnt(4)
    v_mfma_f32_16x16x32_bf16 v[20:23], v[184:187], v[52:55], v[20:23]
    ds_read_b128 v[36:39], v15 offset:0
    v_mfma_f32_16x16x32_bf16 v[24:27], v[184:187], v[56:59], v[24:27]
    ds_read_b128 v[40:43], v15 offset:4096
    v_mfma_f32_16x16x32_bf16 v[24:27], v[188:191], v[64:67], v[24:27]
    ds_read_b128 v[44:47], v15 offset:8192
    v_mfma_f32_16x16x32_bf16 v[20:23], v[188:191], v[60:63], v[20:23]
    ds_read_b128 v[48:51], v15 offset:12288
    s_waitcnt lgkmcnt(4)
    v_mfma_f32_16x16x32_bf16 v[20:23], v[192:195], v[68:71], v[20:23]
    ds_read_b128 v[52:55], v16 offset:0
    v_mfma_f32_16x16x32_bf16 v[24:27], v[192:195], v[72:75], v[24:27]
    ds_read_b128 v[56:59], v16 offset:4096
    v_mfma_f32_16x16x32_bf16 v[24:27], v[196:199], v[80:83], v[24:27]
    ds_read_b128 v[60:63], v16 offset:8192
    v_mfma_f32_16x16x32_bf16 v[20:23], v[196:199], v[76:79], v[20:23]
    ds_read_b128 v[64:67], v16 offset:12288
    s_waitcnt lgkmcnt(4)
    v_mfma_f32_16x16x32_bf16 v[20:23], v[200:203], v[36:39], v[20:23]
    ds_read_b128 v[68:71], v17 offset:0
    v_mfma_f32_16x16x32_bf16 v[24:27], v[200:203], v[40:43], v[24:27]
    ds_read_b128 v[72:75], v17 offset:4096
    v_mfma_f32_16x16x32_bf16 v[24:27], v[204:207], v[48:51], v[24:27]
    ds_read_b128 v[76:79], v17 offset:8192
    v_mfma_f32_16x16x32_bf16 v[20:23], v[204:207], v[44:47], v[20:23]
    ds_read_b128 v[80:83], v17 offset:12288
    s_barrier
    s_waitcnt lgkmcnt(4)
    v_mfma_f32_16x16x32_bf16 v[20:23], v[208:211], v[52:55], v[20:23]
    ds_read_b128 v[36:39], v14 offset:16384
    v_mfma_f32_16x16x32_bf16 v[24:27], v[208:211], v[56:59], v[24:27]
    ds_read_b128 v[40:43], v14 offset:20480
    v_mfma_f32_16x16x32_bf16 v[24:27], v[212:215], v[64:67], v[24:27]
    ds_read_b128 v[44:47], v14 offset:24576
    v_mfma_f32_16x16x32_bf16 v[20:23], v[212:215], v[60:63], v[20:23]
    ds_read_b128 v[48:51], v14 offset:28672
    s_waitcnt lgkmcnt(4)
    v_mfma_f32_16x16x32_bf16 v[20:23], v[216:219], v[68:71], v[20:23]
    ds_read_b128 v[52:55], v15 offset:16384
    v_mfma_f32_16x16x32_bf16 v[24:27], v[216:219], v[72:75], v[24:27]
    ds_read_b128 v[56:59], v15 offset:20480
    v_mfma_f32_16x16x32_bf16 v[24:27], v[220:223], v[80:83], v[24:27]
    ds_read_b128 v[60:63], v15 offset:24576
    v_mfma_f32_16x16x32_bf16 v[20:23], v[220:223], v[76:79], v[20:23]
    ds_read_b128 v[64:67], v15 offset:28672
    s_waitcnt lgkmcnt(4)
    v_mfma_f32_16x16x32_bf16 v[20:23], v[224:227], v[36:39], v[20:23]
    ds_read_b128 v[68:71], v16 offset:16384
    v_mfma_f32_16x16x32_bf16 v[24:27], v[224:227], v[40:43], v[24:27]
    ds_read_b128 v[72:75], v16 offset:20480
    v_mfma_f32_16x16x32_bf16 v[24:27], v[228:231], v[48:51], v[24:27]
    ds_read_b128 v[76:79], v16 offset:24576
    v_mfma_f32_16x16x32_bf16 v[20:23], v[228:231], v[44:47], v[20:23]
    ds_read_b128 v[80:83], v16 offset:28672
    s_waitcnt lgkmcnt(4)
    v_mfma_f32_16x16x32_bf16 v[20:23], v[232:235], v[52:55], v[20:23]
    ds_read_b128 v[36:39], v17 offset:16384
    v_mfma_f32_16x16x32_bf16 v[24:27], v[232:235], v[56:59], v[24:27]
    ds_read_b128 v[40:43], v17 offset:20480
    v_mfma_f32_16x16x32_bf16 v[24:27], v[236:239], v[64:67], v[24:27]
    ds_read_b128 v[44:47], v17 offset:24576
    v_mfma_f32_16x16x32_bf16 v[20:23], v[236:239], v[60:63], v[20:23]
    ds_read_b128 v[48:51], v17 offset:28672
    s_barrier
    ds_read_b128 v[88:91], v18 offset:0
    ds_read_b128 v[92:95], v18 offset:2048
    ds_read_b128 v[96:99], v18 offset:256
    ds_read_b128 v[100:103], v18 offset:2304
    s_waitcnt lgkmcnt(8)
    v_mfma_f32_16x16x32_bf16 v[20:23], v[240:243], v[68:71], v[20:23]
    ds_read_b128 v[52:55], v14 offset:32768
    v_mfma_f32_16x16x32_bf16 v[24:27], v[240:243], v[72:75], v[24:27]
    ds_read_b128 v[56:59], v14 offset:36864
    v_mfma_f32_16x16x32_bf16 v[24:27], v[244:247], v[80:83], v[24:27]
    ds_read_b128 v[60:63], v14 offset:40960
    v_mfma_f32_16x16x32_bf16 v[20:23], v[244:247], v[76:79], v[20:23]
    ds_read_b128 v[64:67], v14 offset:45056
    s_waitcnt lgkmcnt(8)
    v_mfma_f32_16x16x32_bf16 v[20:23], v[248:251], v[36:39], v[20:23]
    ds_read_b128 v[68:71], v15 offset:32768
    v_mfma_f32_16x16x32_bf16 v[24:27], v[248:251], v[40:43], v[24:27]
    ds_read_b128 v[72:75], v15 offset:36864
    v_mfma_f32_16x16x32_bf16 v[24:27], v[252:255], v[48:51], v[24:27]
    ds_read_b128 v[76:79], v15 offset:40960
    v_mfma_f32_16x16x32_bf16 v[20:23], v[252:255], v[44:47], v[20:23]
    ds_read_b128 v[80:83], v15 offset:45056
    s_waitcnt lgkmcnt(4)
    v_mfma_f32_16x16x32_bf16 v[28:31], v[128:131], v[52:55], 0
    ds_read_b128 v[36:39], v16 offset:32768
    v_mfma_f32_16x16x32_bf16 v[32:35], v[128:131], v[56:59], 0
    ds_read_b128 v[40:43], v16 offset:36864
    v_mfma_f32_16x16x32_bf16 v[32:35], v[132:135], v[64:67], v[32:35]
    ds_read_b128 v[44:47], v16 offset:40960
    v_mfma_f32_16x16x32_bf16 v[28:31], v[132:135], v[60:63], v[28:31]
    ds_read_b128 v[48:51], v16 offset:45056
    v_pk_fma_f32 v[20:21], v[88:89], v[84:85], v[20:21]
    v_pk_fma_f32 v[22:23], v[88:89], v[86:87], v[22:23]
    v_pk_fma_f32 v[24:25], v[96:97], v[84:85], v[24:25]
    v_pk_fma_f32 v[26:27], v[96:97], v[86:87], v[26:27]
    v_pk_mul_f32 v[104:105], v[20:21], v[20:21]
    v_pk_mul_f32 v[106:107], v[22:23], v[22:23]
    v_pk_mul_f32 v[108:109], v[24:25], v[24:25]
    v_pk_mul_f32 v[110:111], v[26:27], v[26:27]
    v_pk_fma_f32 v[104:105], v[104:105], v[92:93], v[90:91]
    v_pk_fma_f32 v[106:107], v[106:107], v[92:93], v[90:91]
    v_pk_fma_f32 v[108:109], v[108:109], v[100:101], v[98:99]
    v_pk_fma_f32 v[110:111], v[110:111], v[100:101], v[98:99]
    v_pk_mul_f32 v[104:105], v[104:105], v[20:21]
    v_pk_mul_f32 v[106:107], v[106:107], v[22:23]
    v_pk_mul_f32 v[108:109], v[108:109], v[24:25]
    v_pk_mul_f32 v[110:111], v[110:111], v[26:27]
    v_exp_f32 v104, v104
    v_exp_f32 v105, v105
    v_exp_f32 v106, v106
    v_exp_f32 v107, v107
    v_exp_f32 v108, v108
    v_exp_f32 v109, v109
    v_exp_f32 v110, v110
    v_exp_f32 v111, v111
    v_pk_fma_f32 v[104:105], v[104:105], v[94:95], v[94:95]
    v_pk_fma_f32 v[106:107], v[106:107], v[94:95], v[94:95]
    v_pk_fma_f32 v[108:109], v[108:109], v[102:103], v[102:103]
    v_pk_fma_f32 v[110:111], v[110:111], v[102:103], v[102:103]
    v_rcp_f32 v104, v104
    v_rcp_f32 v105, v105
    v_rcp_f32 v106, v106
    v_rcp_f32 v107, v107
    v_rcp_f32 v108, v108
    v_rcp_f32 v109, v109
    v_rcp_f32 v110, v110
    v_rcp_f32 v111, v111
    v_pk_mul_f32 v[20:21], v[20:21], v[104:105]
    v_pk_mul_f32 v[22:23], v[22:23], v[106:107]
    v_pk_mul_f32 v[24:25], v[24:25], v[108:109]
    v_pk_mul_f32 v[26:27], v[26:27], v[110:111]
    v_cvt_pk_bf16_f32 v104, v20, v21
    v_cvt_pk_bf16_f32 v105, v22, v23
    v_cvt_pk_bf16_f32 v106, v24, v25
    v_cvt_pk_bf16_f32 v107, v26, v27
    s_add_u32 s36, s39, 0
    v_permlane16_swap_b32 v104, v106
    v_permlane16_swap_b32 v105, v107
    buffer_store_dwordx4 v[104:107], v114, s[16:19], s36 offen sc1
    s_waitcnt lgkmcnt(4)
    v_mfma_f32_16x16x32_bf16 v[28:31], v[136:139], v[68:71], v[28:31]
    ds_read_b128 v[52:55], v17 offset:32768
    v_mfma_f32_16x16x32_bf16 v[32:35], v[136:139], v[72:75], v[32:35]
    ds_read_b128 v[56:59], v17 offset:36864
    v_mfma_f32_16x16x32_bf16 v[32:35], v[140:143], v[80:83], v[32:35]
    ds_read_b128 v[60:63], v17 offset:40960
    v_mfma_f32_16x16x32_bf16 v[28:31], v[140:143], v[76:79], v[28:31]
    ds_read_b128 v[64:67], v17 offset:45056
    s_barrier
    s_waitcnt lgkmcnt(4)
    v_mfma_f32_16x16x32_bf16 v[28:31], v[144:147], v[36:39], v[28:31]
    ds_read_b128 v[68:71], v10 offset:16384
    v_mfma_f32_16x16x32_bf16 v[32:35], v[144:147], v[40:43], v[32:35]
    ds_read_b128 v[72:75], v10 offset:20480
    v_mfma_f32_16x16x32_bf16 v[32:35], v[148:151], v[48:51], v[32:35]
    ds_read_b128 v[76:79], v10 offset:24576
    v_mfma_f32_16x16x32_bf16 v[28:31], v[148:151], v[44:47], v[28:31]
    ds_read_b128 v[80:83], v10 offset:28672
    s_waitcnt lgkmcnt(4)
    v_mfma_f32_16x16x32_bf16 v[28:31], v[152:155], v[52:55], v[28:31]
    ds_read_b128 v[36:39], v11 offset:16384
    v_mfma_f32_16x16x32_bf16 v[32:35], v[152:155], v[56:59], v[32:35]
    ds_read_b128 v[40:43], v11 offset:20480
    v_mfma_f32_16x16x32_bf16 v[32:35], v[156:159], v[64:67], v[32:35]
    ds_read_b128 v[44:47], v11 offset:24576
    v_mfma_f32_16x16x32_bf16 v[28:31], v[156:159], v[60:63], v[28:31]
    ds_read_b128 v[48:51], v11 offset:28672
    s_waitcnt lgkmcnt(4)
    v_mfma_f32_16x16x32_bf16 v[28:31], v[160:163], v[68:71], v[28:31]
    ds_read_b128 v[52:55], v12 offset:16384
    v_mfma_f32_16x16x32_bf16 v[32:35], v[160:163], v[72:75], v[32:35]
    ds_read_b128 v[56:59], v12 offset:20480
    v_mfma_f32_16x16x32_bf16 v[32:35], v[164:167], v[80:83], v[32:35]
    ds_read_b128 v[60:63], v12 offset:24576
    v_mfma_f32_16x16x32_bf16 v[28:31], v[164:167], v[76:79], v[28:31]
    ds_read_b128 v[64:67], v12 offset:28672
    s_waitcnt lgkmcnt(4)
    v_mfma_f32_16x16x32_bf16 v[28:31], v[168:171], v[36:39], v[28:31]
    ds_read_b128 v[68:71], v13 offset:16384
    v_mfma_f32_16x16x32_bf16 v[32:35], v[168:171], v[40:43], v[32:35]
    ds_read_b128 v[72:75], v13 offset:20480
    v_mfma_f32_16x16x32_bf16 v[32:35], v[172:175], v[48:51], v[32:35]
    ds_read_b128 v[76:79], v13 offset:24576
    v_mfma_f32_16x16x32_bf16 v[28:31], v[172:175], v[44:47], v[28:31]
    ds_read_b128 v[80:83], v13 offset:28672
    s_barrier
    s_waitcnt lgkmcnt(4)
    v_mfma_f32_16x16x32_bf16 v[28:31], v[176:179], v[52:55], v[28:31]
    ds_read_b128 v[36:39], v10 offset:32768
    v_mfma_f32_16x16x32_bf16 v[32:35], v[176:179], v[56:59], v[32:35]
    ds_read_b128 v[40:43], v10 offset:36864
    v_mfma_f32_16x16x32_bf16 v[32:35], v[180:183], v[64:67], v[32:35]
    ds_read_b128 v[44:47], v10 offset:40960
    v_mfma_f32_16x16x32_bf16 v[28:31], v[180:183], v[60:63], v[28:31]
    ds_read_b128 v[48:51], v10 offset:45056
    s_waitcnt lgkmcnt(4)
    v_mfma_f32_16x16x32_bf16 v[28:31], v[184:187], v[68:71], v[28:31]
    ds_read_b128 v[52:55], v11 offset:32768
    v_mfma_f32_16x16x32_bf16 v[32:35], v[184:187], v[72:75], v[32:35]
    ds_read_b128 v[56:59], v11 offset:36864
    v_mfma_f32_16x16x32_bf16 v[32:35], v[188:191], v[80:83], v[32:35]
    ds_read_b128 v[60:63], v11 offset:40960
    v_mfma_f32_16x16x32_bf16 v[28:31], v[188:191], v[76:79], v[28:31]
    ds_read_b128 v[64:67], v11 offset:45056
    s_waitcnt lgkmcnt(4)
    v_mfma_f32_16x16x32_bf16 v[28:31], v[192:195], v[36:39], v[28:31]
    ds_read_b128 v[68:71], v12 offset:32768
    v_mfma_f32_16x16x32_bf16 v[32:35], v[192:195], v[40:43], v[32:35]
    ds_read_b128 v[72:75], v12 offset:36864
    v_mfma_f32_16x16x32_bf16 v[32:35], v[196:199], v[48:51], v[32:35]
    ds_read_b128 v[76:79], v12 offset:40960
    v_mfma_f32_16x16x32_bf16 v[28:31], v[196:199], v[44:47], v[28:31]
    ds_read_b128 v[80:83], v12 offset:45056
    s_waitcnt lgkmcnt(4)
    v_mfma_f32_16x16x32_bf16 v[28:31], v[200:203], v[52:55], v[28:31]
    ds_read_b128 v[36:39], v13 offset:32768
    v_mfma_f32_16x16x32_bf16 v[32:35], v[200:203], v[56:59], v[32:35]
    ds_read_b128 v[40:43], v13 offset:36864
    v_mfma_f32_16x16x32_bf16 v[32:35], v[204:207], v[64:67], v[32:35]
    ds_read_b128 v[44:47], v13 offset:40960
    v_mfma_f32_16x16x32_bf16 v[28:31], v[204:207], v[60:63], v[28:31]
    ds_read_b128 v[48:51], v13 offset:45056
    s_barrier
    s_waitcnt lgkmcnt(4)
    v_mfma_f32_16x16x32_bf16 v[28:31], v[208:211], v[68:71], v[28:31]
    ds_read_b128 v[52:55], v14 offset:0
    v_mfma_f32_16x16x32_bf16 v[32:35], v[208:211], v[72:75], v[32:35]
    ds_read_b128 v[56:59], v14 offset:4096
    v_mfma_f32_16x16x32_bf16 v[32:35], v[212:215], v[80:83], v[32:35]
    ds_read_b128 v[60:63], v14 offset:8192
    v_mfma_f32_16x16x32_bf16 v[28:31], v[212:215], v[76:79], v[28:31]
    ds_read_b128 v[64:67], v14 offset:12288
    s_waitcnt lgkmcnt(4)
    v_mfma_f32_16x16x32_bf16 v[28:31], v[216:219], v[36:39], v[28:31]
    ds_read_b128 v[68:71], v15 offset:0
    v_mfma_f32_16x16x32_bf16 v[32:35], v[216:219], v[40:43], v[32:35]
    ds_read_b128 v[72:75], v15 offset:4096
    v_mfma_f32_16x16x32_bf16 v[32:35], v[220:223], v[48:51], v[32:35]
    ds_read_b128 v[76:79], v15 offset:8192
    v_mfma_f32_16x16x32_bf16 v[28:31], v[220:223], v[44:47], v[28:31]
    ds_read_b128 v[80:83], v15 offset:12288
    s_waitcnt lgkmcnt(4)
    v_mfma_f32_16x16x32_bf16 v[28:31], v[224:227], v[52:55], v[28:31]
    ds_read_b128 v[36:39], v16 offset:0
    v_mfma_f32_16x16x32_bf16 v[32:35], v[224:227], v[56:59], v[32:35]
    ds_read_b128 v[40:43], v16 offset:4096
    v_mfma_f32_16x16x32_bf16 v[32:35], v[228:231], v[64:67], v[32:35]
    ds_read_b128 v[44:47], v16 offset:8192
    v_mfma_f32_16x16x32_bf16 v[28:31], v[228:231], v[60:63], v[28:31]
    ds_read_b128 v[48:51], v16 offset:12288
    s_waitcnt lgkmcnt(4)
    v_mfma_f32_16x16x32_bf16 v[28:31], v[232:235], v[68:71], v[28:31]
    ds_read_b128 v[52:55], v17 offset:0
    v_mfma_f32_16x16x32_bf16 v[32:35], v[232:235], v[72:75], v[32:35]
    ds_read_b128 v[56:59], v17 offset:4096
    v_mfma_f32_16x16x32_bf16 v[32:35], v[236:239], v[80:83], v[32:35]
    ds_read_b128 v[60:63], v17 offset:8192
    v_mfma_f32_16x16x32_bf16 v[28:31], v[236:239], v[76:79], v[28:31]
    ds_read_b128 v[64:67], v17 offset:12288
    s_barrier
    ds_read_b128 v[88:91], v18 offset:512
    ds_read_b128 v[92:95], v18 offset:2560
    ds_read_b128 v[96:99], v18 offset:768
    ds_read_b128 v[100:103], v18 offset:2816
    s_waitcnt vmcnt(0)
    buffer_atomic_add v113, v112, s[56:59], s40 offen offset:2048 sc1
    s_waitcnt lgkmcnt(8)
    v_mfma_f32_16x16x32_bf16 v[28:31], v[240:243], v[36:39], v[28:31]
    ds_read_b128 v[68:71], v14 offset:16384
    v_mfma_f32_16x16x32_bf16 v[32:35], v[240:243], v[40:43], v[32:35]
    ds_read_b128 v[72:75], v14 offset:20480
    v_mfma_f32_16x16x32_bf16 v[32:35], v[244:247], v[48:51], v[32:35]
    ds_read_b128 v[76:79], v14 offset:24576
    v_mfma_f32_16x16x32_bf16 v[28:31], v[244:247], v[44:47], v[28:31]
    ds_read_b128 v[80:83], v14 offset:28672
    s_waitcnt lgkmcnt(8)
    v_mfma_f32_16x16x32_bf16 v[28:31], v[248:251], v[52:55], v[28:31]
    ds_read_b128 v[36:39], v15 offset:16384
    v_mfma_f32_16x16x32_bf16 v[32:35], v[248:251], v[56:59], v[32:35]
    ds_read_b128 v[40:43], v15 offset:20480
    v_mfma_f32_16x16x32_bf16 v[32:35], v[252:255], v[64:67], v[32:35]
    ds_read_b128 v[44:47], v15 offset:24576
    v_mfma_f32_16x16x32_bf16 v[28:31], v[252:255], v[60:63], v[28:31]
    ds_read_b128 v[48:51], v15 offset:28672
    s_waitcnt lgkmcnt(4)
    v_mfma_f32_16x16x32_bf16 v[20:23], v[128:131], v[68:71], 0
    ds_read_b128 v[52:55], v16 offset:16384
    v_mfma_f32_16x16x32_bf16 v[24:27], v[128:131], v[72:75], 0
    ds_read_b128 v[56:59], v16 offset:20480
    v_mfma_f32_16x16x32_bf16 v[24:27], v[132:135], v[80:83], v[24:27]
    ds_read_b128 v[60:63], v16 offset:24576
    v_mfma_f32_16x16x32_bf16 v[20:23], v[132:135], v[76:79], v[20:23]
    ds_read_b128 v[64:67], v16 offset:28672
    v_pk_fma_f32 v[28:29], v[88:89], v[84:85], v[28:29]
    v_pk_fma_f32 v[30:31], v[88:89], v[86:87], v[30:31]
    v_pk_fma_f32 v[32:33], v[96:97], v[84:85], v[32:33]
    v_pk_fma_f32 v[34:35], v[96:97], v[86:87], v[34:35]
    v_pk_mul_f32 v[104:105], v[28:29], v[28:29]
    v_pk_mul_f32 v[106:107], v[30:31], v[30:31]
    v_pk_mul_f32 v[108:109], v[32:33], v[32:33]
    v_pk_mul_f32 v[110:111], v[34:35], v[34:35]
    v_pk_fma_f32 v[104:105], v[104:105], v[92:93], v[90:91]
    v_pk_fma_f32 v[106:107], v[106:107], v[92:93], v[90:91]
    v_pk_fma_f32 v[108:109], v[108:109], v[100:101], v[98:99]
    v_pk_fma_f32 v[110:111], v[110:111], v[100:101], v[98:99]
    v_pk_mul_f32 v[104:105], v[104:105], v[28:29]
    v_pk_mul_f32 v[106:107], v[106:107], v[30:31]
    v_pk_mul_f32 v[108:109], v[108:109], v[32:33]
    v_pk_mul_f32 v[110:111], v[110:111], v[34:35]
    v_exp_f32 v104, v104
    v_exp_f32 v105, v105
    v_exp_f32 v106, v106
    v_exp_f32 v107, v107
    v_exp_f32 v108, v108
    v_exp_f32 v109, v109
    v_exp_f32 v110, v110
    v_exp_f32 v111, v111
    v_pk_fma_f32 v[104:105], v[104:105], v[94:95], v[94:95]
    v_pk_fma_f32 v[106:107], v[106:107], v[94:95], v[94:95]
    v_pk_fma_f32 v[108:109], v[108:109], v[102:103], v[102:103]
    v_pk_fma_f32 v[110:111], v[110:111], v[102:103], v[102:103]
    v_rcp_f32 v104, v104
    v_rcp_f32 v105, v105
    v_rcp_f32 v106, v106
    v_rcp_f32 v107, v107
    v_rcp_f32 v108, v108
    v_rcp_f32 v109, v109
    v_rcp_f32 v110, v110
    v_rcp_f32 v111, v111
    v_pk_mul_f32 v[28:29], v[28:29], v[104:105]
    v_pk_mul_f32 v[30:31], v[30:31], v[106:107]
    v_pk_mul_f32 v[32:33], v[32:33], v[108:109]
    v_pk_mul_f32 v[34:35], v[34:35], v[110:111]
    v_cvt_pk_bf16_f32 v104, v28, v29
    v_cvt_pk_bf16_f32 v105, v30, v31
    v_cvt_pk_bf16_f32 v106, v32, v33
    v_cvt_pk_bf16_f32 v107, v34, v35
    s_add_u32 s36, s39, 131072
    v_permlane16_swap_b32 v104, v106
    v_permlane16_swap_b32 v105, v107
    buffer_store_dwordx4 v[104:107], v114, s[16:19], s36 offen sc1
    s_waitcnt lgkmcnt(4)
    v_mfma_f32_16x16x32_bf16 v[20:23], v[136:139], v[36:39], v[20:23]
    ds_read_b128 v[68:71], v17 offset:16384
    v_mfma_f32_16x16x32_bf16 v[24:27], v[136:139], v[40:43], v[24:27]
    ds_read_b128 v[72:75], v17 offset:20480
    v_mfma_f32_16x16x32_bf16 v[24:27], v[140:143], v[48:51], v[24:27]
    ds_read_b128 v[76:79], v17 offset:24576
    v_mfma_f32_16x16x32_bf16 v[20:23], v[140:143], v[44:47], v[20:23]
    ds_read_b128 v[80:83], v17 offset:28672
    s_barrier
    s_waitcnt lgkmcnt(4)
    v_mfma_f32_16x16x32_bf16 v[20:23], v[144:147], v[52:55], v[20:23]
    ds_read_b128 v[36:39], v14 offset:32768
    v_mfma_f32_16x16x32_bf16 v[24:27], v[144:147], v[56:59], v[24:27]
    ds_read_b128 v[40:43], v14 offset:36864
    v_mfma_f32_16x16x32_bf16 v[24:27], v[148:151], v[64:67], v[24:27]
    ds_read_b128 v[44:47], v14 offset:40960
    v_mfma_f32_16x16x32_bf16 v[20:23], v[148:151], v[60:63], v[20:23]
    ds_read_b128 v[48:51], v14 offset:45056
    s_waitcnt lgkmcnt(4)
    v_mfma_f32_16x16x32_bf16 v[20:23], v[152:155], v[68:71], v[20:23]
    ds_read_b128 v[52:55], v15 offset:32768
    v_mfma_f32_16x16x32_bf16 v[24:27], v[152:155], v[72:75], v[24:27]
    ds_read_b128 v[56:59], v15 offset:36864
    v_mfma_f32_16x16x32_bf16 v[24:27], v[156:159], v[80:83], v[24:27]
    ds_read_b128 v[60:63], v15 offset:40960
    v_mfma_f32_16x16x32_bf16 v[20:23], v[156:159], v[76:79], v[20:23]
    ds_read_b128 v[64:67], v15 offset:45056
    s_waitcnt lgkmcnt(4)
    v_mfma_f32_16x16x32_bf16 v[20:23], v[160:163], v[36:39], v[20:23]
    ds_read_b128 v[68:71], v16 offset:32768
    v_mfma_f32_16x16x32_bf16 v[24:27], v[160:163], v[40:43], v[24:27]
    ds_read_b128 v[72:75], v16 offset:36864
    v_mfma_f32_16x16x32_bf16 v[24:27], v[164:167], v[48:51], v[24:27]
    ds_read_b128 v[76:79], v16 offset:40960
    v_mfma_f32_16x16x32_bf16 v[20:23], v[164:167], v[44:47], v[20:23]
    ds_read_b128 v[80:83], v16 offset:45056
    s_waitcnt lgkmcnt(4)
    v_mfma_f32_16x16x32_bf16 v[20:23], v[168:171], v[52:55], v[20:23]
    ds_read_b128 v[36:39], v17 offset:32768
    v_mfma_f32_16x16x32_bf16 v[24:27], v[168:171], v[56:59], v[24:27]
    ds_read_b128 v[40:43], v17 offset:36864
    v_mfma_f32_16x16x32_bf16 v[24:27], v[172:175], v[64:67], v[24:27]
    ds_read_b128 v[44:47], v17 offset:40960
    v_mfma_f32_16x16x32_bf16 v[20:23], v[172:175], v[60:63], v[20:23]
    ds_read_b128 v[48:51], v17 offset:45056
    s_barrier
    s_waitcnt lgkmcnt(4)
    v_mfma_f32_16x16x32_bf16 v[20:23], v[176:179], v[68:71], v[20:23]
    ds_read_b128 v[52:55], v10 offset:16384
    v_mfma_f32_16x16x32_bf16 v[24:27], v[176:179], v[72:75], v[24:27]
    ds_read_b128 v[56:59], v10 offset:20480
    v_mfma_f32_16x16x32_bf16 v[24:27], v[180:183], v[80:83], v[24:27]
    ds_read_b128 v[60:63], v10 offset:24576
    v_mfma_f32_16x16x32_bf16 v[20:23], v[180:183], v[76:79], v[20:23]
    ds_read_b128 v[64:67], v10 offset:28672
    s_waitcnt lgkmcnt(4)
    v_mfma_f32_16x16x32_bf16 v[20:23], v[184:187], v[36:39], v[20:23]
    ds_read_b128 v[68:71], v11 offset:16384
    v_mfma_f32_16x16x32_bf16 v[24:27], v[184:187], v[40:43], v[24:27]
    ds_read_b128 v[72:75], v11 offset:20480
    v_mfma_f32_16x16x32_bf16 v[24:27], v[188:191], v[48:51], v[24:27]
    ds_read_b128 v[76:79], v11 offset:24576
    v_mfma_f32_16x16x32_bf16 v[20:23], v[188:191], v[44:47], v[20:23]
    ds_read_b128 v[80:83], v11 offset:28672
    s_waitcnt lgkmcnt(4)
    v_mfma_f32_16x16x32_bf16 v[20:23], v[192:195], v[52:55], v[20:23]
    ds_read_b128 v[36:39], v12 offset:16384
    v_mfma_f32_16x16x32_bf16 v[24:27], v[192:195], v[56:59], v[24:27]
    ds_read_b128 v[40:43], v12 offset:20480
    v_mfma_f32_16x16x32_bf16 v[24:27], v[196:199], v[64:67], v[24:27]
    ds_read_b128 v[44:47], v12 offset:24576
    v_mfma_f32_16x16x32_bf16 v[20:23], v[196:199], v[60:63], v[20:23]
    ds_read_b128 v[48:51], v12 offset:28672
    s_waitcnt lgkmcnt(4)
    v_mfma_f32_16x16x32_bf16 v[20:23], v[200:203], v[68:71], v[20:23]
    ds_read_b128 v[52:55], v13 offset:16384
    v_mfma_f32_16x16x32_bf16 v[24:27], v[200:203], v[72:75], v[24:27]
    ds_read_b128 v[56:59], v13 offset:20480
    v_mfma_f32_16x16x32_bf16 v[24:27], v[204:207], v[80:83], v[24:27]
    ds_read_b128 v[60:63], v13 offset:24576
    v_mfma_f32_16x16x32_bf16 v[20:23], v[204:207], v[76:79], v[20:23]
    ds_read_b128 v[64:67], v13 offset:28672
    s_barrier
    s_waitcnt lgkmcnt(4)
    v_mfma_f32_16x16x32_bf16 v[20:23], v[208:211], v[36:39], v[20:23]
    ds_read_b128 v[68:71], v10 offset:32768
    v_mfma_f32_16x16x32_bf16 v[24:27], v[208:211], v[40:43], v[24:27]
    ds_read_b128 v[72:75], v10 offset:36864
    v_mfma_f32_16x16x32_bf16 v[24:27], v[212:215], v[48:51], v[24:27]
    ds_read_b128 v[76:79], v10 offset:40960
    v_mfma_f32_16x16x32_bf16 v[20:23], v[212:215], v[44:47], v[20:23]
    ds_read_b128 v[80:83], v10 offset:45056
    s_waitcnt lgkmcnt(4)
    v_mfma_f32_16x16x32_bf16 v[20:23], v[216:219], v[52:55], v[20:23]
    ds_read_b128 v[36:39], v11 offset:32768
    v_mfma_f32_16x16x32_bf16 v[24:27], v[216:219], v[56:59], v[24:27]
    ds_read_b128 v[40:43], v11 offset:36864
    v_mfma_f32_16x16x32_bf16 v[24:27], v[220:223], v[64:67], v[24:27]
    ds_read_b128 v[44:47], v11 offset:40960
    v_mfma_f32_16x16x32_bf16 v[20:23], v[220:223], v[60:63], v[20:23]
    ds_read_b128 v[48:51], v11 offset:45056
    s_waitcnt lgkmcnt(4)
    v_mfma_f32_16x16x32_bf16 v[20:23], v[224:227], v[68:71], v[20:23]
    ds_read_b128 v[52:55], v12 offset:32768
    v_mfma_f32_16x16x32_bf16 v[24:27], v[224:227], v[72:75], v[24:27]
    ds_read_b128 v[56:59], v12 offset:36864
    v_mfma_f32_16x16x32_bf16 v[24:27], v[228:231], v[80:83], v[24:27]
    ds_read_b128 v[60:63], v12 offset:40960
    v_mfma_f32_16x16x32_bf16 v[20:23], v[228:231], v[76:79], v[20:23]
    ds_read_b128 v[64:67], v12 offset:45056
    s_waitcnt lgkmcnt(4)
    v_mfma_f32_16x16x32_bf16 v[20:23], v[232:235], v[36:39], v[20:23]
    ds_read_b128 v[68:71], v13 offset:32768
    v_mfma_f32_16x16x32_bf16 v[24:27], v[232:235], v[40:43], v[24:27]
    ds_read_b128 v[72:75], v13 offset:36864
    v_mfma_f32_16x16x32_bf16 v[24:27], v[236:239], v[48:51], v[24:27]
    ds_read_b128 v[76:79], v13 offset:40960
    v_mfma_f32_16x16x32_bf16 v[20:23], v[236:239], v[44:47], v[20:23]
    ds_read_b128 v[80:83], v13 offset:45056
    s_barrier
    ds_read_b128 v[88:91], v18 offset:1024
    ds_read_b128 v[92:95], v18 offset:3072
    ds_read_b128 v[96:99], v18 offset:1280
    ds_read_b128 v[100:103], v18 offset:3328
    s_waitcnt vmcnt(0)
    buffer_atomic_add v113, v112, s[56:59], s40 offen offset:2560 sc1
    s_waitcnt lgkmcnt(8)
    v_mfma_f32_16x16x32_bf16 v[20:23], v[240:243], v[52:55], v[20:23]
    ds_read_b128 v[36:39], v14 offset:0
    v_mfma_f32_16x16x32_bf16 v[24:27], v[240:243], v[56:59], v[24:27]
    ds_read_b128 v[40:43], v14 offset:4096
    v_mfma_f32_16x16x32_bf16 v[24:27], v[244:247], v[64:67], v[24:27]
    ds_read_b128 v[44:47], v14 offset:8192
    v_mfma_f32_16x16x32_bf16 v[20:23], v[244:247], v[60:63], v[20:23]
    ds_read_b128 v[48:51], v14 offset:12288
    s_waitcnt lgkmcnt(8)
    v_mfma_f32_16x16x32_bf16 v[20:23], v[248:251], v[68:71], v[20:23]
    ds_read_b128 v[52:55], v15 offset:0
    v_mfma_f32_16x16x32_bf16 v[24:27], v[248:251], v[72:75], v[24:27]
    ds_read_b128 v[56:59], v15 offset:4096
    v_mfma_f32_16x16x32_bf16 v[24:27], v[252:255], v[80:83], v[24:27]
    ds_read_b128 v[60:63], v15 offset:8192
    v_mfma_f32_16x16x32_bf16 v[20:23], v[252:255], v[76:79], v[20:23]
    ds_read_b128 v[64:67], v15 offset:12288
    s_waitcnt lgkmcnt(4)
    v_mfma_f32_16x16x32_bf16 v[28:31], v[128:131], v[36:39], 0
    ds_read_b128 v[68:71], v16 offset:0
    v_mfma_f32_16x16x32_bf16 v[32:35], v[128:131], v[40:43], 0
    ds_read_b128 v[72:75], v16 offset:4096
    v_mfma_f32_16x16x32_bf16 v[32:35], v[132:135], v[48:51], v[32:35]
    ds_read_b128 v[76:79], v16 offset:8192
    v_mfma_f32_16x16x32_bf16 v[28:31], v[132:135], v[44:47], v[28:31]
    ds_read_b128 v[80:83], v16 offset:12288
    v_pk_fma_f32 v[20:21], v[88:89], v[84:85], v[20:21]
    v_pk_fma_f32 v[22:23], v[88:89], v[86:87], v[22:23]
    v_pk_fma_f32 v[24:25], v[96:97], v[84:85], v[24:25]
    v_pk_fma_f32 v[26:27], v[96:97], v[86:87], v[26:27]
    v_pk_mul_f32 v[104:105], v[20:21], v[20:21]
    v_pk_mul_f32 v[106:107], v[22:23], v[22:23]
    v_pk_mul_f32 v[108:109], v[24:25], v[24:25]
    v_pk_mul_f32 v[110:111], v[26:27], v[26:27]
    v_pk_fma_f32 v[104:105], v[104:105], v[92:93], v[90:91]
    v_pk_fma_f32 v[106:107], v[106:107], v[92:93], v[90:91]
    v_pk_fma_f32 v[108:109], v[108:109], v[100:101], v[98:99]
    v_pk_fma_f32 v[110:111], v[110:111], v[100:101], v[98:99]
    v_pk_mul_f32 v[104:105], v[104:105], v[20:21]
    v_pk_mul_f32 v[106:107], v[106:107], v[22:23]
    v_pk_mul_f32 v[108:109], v[108:109], v[24:25]
    v_pk_mul_f32 v[110:111], v[110:111], v[26:27]
    v_exp_f32 v104, v104
    v_exp_f32 v105, v105
    v_exp_f32 v106, v106
    v_exp_f32 v107, v107
    v_exp_f32 v108, v108
    v_exp_f32 v109, v109
    v_exp_f32 v110, v110
    v_exp_f32 v111, v111
    v_pk_fma_f32 v[104:105], v[104:105], v[94:95], v[94:95]
    v_pk_fma_f32 v[106:107], v[106:107], v[94:95], v[94:95]
    v_pk_fma_f32 v[108:109], v[108:109], v[102:103], v[102:103]
    v_pk_fma_f32 v[110:111], v[110:111], v[102:103], v[102:103]
    v_rcp_f32 v104, v104
    v_rcp_f32 v105, v105
    v_rcp_f32 v106, v106
    v_rcp_f32 v107, v107
    v_rcp_f32 v108, v108
    v_rcp_f32 v109, v109
    v_rcp_f32 v110, v110
    v_rcp_f32 v111, v111
    v_pk_mul_f32 v[20:21], v[20:21], v[104:105]
    v_pk_mul_f32 v[22:23], v[22:23], v[106:107]
    v_pk_mul_f32 v[24:25], v[24:25], v[108:109]
    v_pk_mul_f32 v[26:27], v[26:27], v[110:111]
    v_cvt_pk_bf16_f32 v104, v20, v21
    v_cvt_pk_bf16_f32 v105, v22, v23
    v_cvt_pk_bf16_f32 v106, v24, v25
    v_cvt_pk_bf16_f32 v107, v26, v27
    s_add_u32 s36, s39, 262144
    v_permlane16_swap_b32 v104, v106
    v_permlane16_swap_b32 v105, v107
    buffer_store_dwordx4 v[104:107], v114, s[16:19], s36 offen sc1
    s_waitcnt lgkmcnt(4)
    v_mfma_f32_16x16x32_bf16 v[28:31], v[136:139], v[52:55], v[28:31]
    ds_read_b128 v[36:39], v17 offset:0
    v_mfma_f32_16x16x32_bf16 v[32:35], v[136:139], v[56:59], v[32:35]
    ds_read_b128 v[40:43], v17 offset:4096
    v_mfma_f32_16x16x32_bf16 v[32:35], v[140:143], v[64:67], v[32:35]
    ds_read_b128 v[44:47], v17 offset:8192
    v_mfma_f32_16x16x32_bf16 v[28:31], v[140:143], v[60:63], v[28:31]
    ds_read_b128 v[48:51], v17 offset:12288
    s_barrier
    s_waitcnt lgkmcnt(4)
    v_mfma_f32_16x16x32_bf16 v[28:31], v[144:147], v[68:71], v[28:31]
    ds_read_b128 v[52:55], v14 offset:16384
    v_mfma_f32_16x16x32_bf16 v[32:35], v[144:147], v[72:75], v[32:35]
    ds_read_b128 v[56:59], v14 offset:20480
    v_mfma_f32_16x16x32_bf16 v[32:35], v[148:151], v[80:83], v[32:35]
    ds_read_b128 v[60:63], v14 offset:24576
    v_mfma_f32_16x16x32_bf16 v[28:31], v[148:151], v[76:79], v[28:31]
    ds_read_b128 v[64:67], v14 offset:28672
    s_waitcnt lgkmcnt(4)
    v_mfma_f32_16x16x32_bf16 v[28:31], v[152:155], v[36:39], v[28:31]
    ds_read_b128 v[68:71], v15 offset:16384
    v_mfma_f32_16x16x32_bf16 v[32:35], v[152:155], v[40:43], v[32:35]
    ds_read_b128 v[72:75], v15 offset:20480
    v_mfma_f32_16x16x32_bf16 v[32:35], v[156:159], v[48:51], v[32:35]
    ds_read_b128 v[76:79], v15 offset:24576
    v_mfma_f32_16x16x32_bf16 v[28:31], v[156:159], v[44:47], v[28:31]
    ds_read_b128 v[80:83], v15 offset:28672
    s_waitcnt lgkmcnt(4)
    v_mfma_f32_16x16x32_bf16 v[28:31], v[160:163], v[52:55], v[28:31]
    ds_read_b128 v[36:39], v16 offset:16384
    v_mfma_f32_16x16x32_bf16 v[32:35], v[160:163], v[56:59], v[32:35]
    ds_read_b128 v[40:43], v16 offset:20480
    v_mfma_f32_16x16x32_bf16 v[32:35], v[164:167], v[64:67], v[32:35]
    ds_read_b128 v[44:47], v16 offset:24576
    v_mfma_f32_16x16x32_bf16 v[28:31], v[164:167], v[60:63], v[28:31]
    ds_read_b128 v[48:51], v16 offset:28672
    s_waitcnt lgkmcnt(4)
    v_mfma_f32_16x16x32_bf16 v[28:31], v[168:171], v[68:71], v[28:31]
    ds_read_b128 v[52:55], v17 offset:16384
    v_mfma_f32_16x16x32_bf16 v[32:35], v[168:171], v[72:75], v[32:35]
    ds_read_b128 v[56:59], v17 offset:20480
    v_mfma_f32_16x16x32_bf16 v[32:35], v[172:175], v[80:83], v[32:35]
    ds_read_b128 v[60:63], v17 offset:24576
    v_mfma_f32_16x16x32_bf16 v[28:31], v[172:175], v[76:79], v[28:31]
    ds_read_b128 v[64:67], v17 offset:28672
    s_barrier
    s_waitcnt lgkmcnt(4)
    v_mfma_f32_16x16x32_bf16 v[28:31], v[176:179], v[36:39], v[28:31]
    ds_read_b128 v[68:71], v14 offset:32768
    v_mfma_f32_16x16x32_bf16 v[32:35], v[176:179], v[40:43], v[32:35]
    ds_read_b128 v[72:75], v14 offset:36864
    v_mfma_f32_16x16x32_bf16 v[32:35], v[180:183], v[48:51], v[32:35]
    ds_read_b128 v[76:79], v14 offset:40960
    v_mfma_f32_16x16x32_bf16 v[28:31], v[180:183], v[44:47], v[28:31]
    ds_read_b128 v[80:83], v14 offset:45056
    s_waitcnt lgkmcnt(4)
    v_mfma_f32_16x16x32_bf16 v[28:31], v[184:187], v[52:55], v[28:31]
    ds_read_b128 v[36:39], v15 offset:32768
    v_mfma_f32_16x16x32_bf16 v[32:35], v[184:187], v[56:59], v[32:35]
    ds_read_b128 v[40:43], v15 offset:36864
    v_mfma_f32_16x16x32_bf16 v[32:35], v[188:191], v[64:67], v[32:35]
    ds_read_b128 v[44:47], v15 offset:40960
    v_mfma_f32_16x16x32_bf16 v[28:31], v[188:191], v[60:63], v[28:31]
    ds_read_b128 v[48:51], v15 offset:45056
    s_waitcnt lgkmcnt(4)
    v_mfma_f32_16x16x32_bf16 v[28:31], v[192:195], v[68:71], v[28:31]
    ds_read_b128 v[52:55], v16 offset:32768
    v_mfma_f32_16x16x32_bf16 v[32:35], v[192:195], v[72:75], v[32:35]
    ds_read_b128 v[56:59], v16 offset:36864
    v_mfma_f32_16x16x32_bf16 v[32:35], v[196:199], v[80:83], v[32:35]
    ds_read_b128 v[60:63], v16 offset:40960
    v_mfma_f32_16x16x32_bf16 v[28:31], v[196:199], v[76:79], v[28:31]
    ds_read_b128 v[64:67], v16 offset:45056
    s_waitcnt lgkmcnt(4)
    v_mfma_f32_16x16x32_bf16 v[28:31], v[200:203], v[36:39], v[28:31]
    ds_read_b128 v[68:71], v17 offset:32768
    v_mfma_f32_16x16x32_bf16 v[32:35], v[200:203], v[40:43], v[32:35]
    ds_read_b128 v[72:75], v17 offset:36864
    v_mfma_f32_16x16x32_bf16 v[32:35], v[204:207], v[48:51], v[32:35]
    ds_read_b128 v[76:79], v17 offset:40960
    v_mfma_f32_16x16x32_bf16 v[28:31], v[204:207], v[44:47], v[28:31]
    ds_read_b128 v[80:83], v17 offset:45056
    s_barrier
    s_waitcnt lgkmcnt(4)
    v_mfma_f32_16x16x32_bf16 v[28:31], v[208:211], v[52:55], v[28:31]
    ds_read_b128 v[36:39], v10 offset:16384
    v_mfma_f32_16x16x32_bf16 v[32:35], v[208:211], v[56:59], v[32:35]
    ds_read_b128 v[40:43], v10 offset:20480
    v_mfma_f32_16x16x32_bf16 v[32:35], v[212:215], v[64:67], v[32:35]
    ds_read_b128 v[44:47], v10 offset:24576
    v_mfma_f32_16x16x32_bf16 v[28:31], v[212:215], v[60:63], v[28:31]
    ds_read_b128 v[48:51], v10 offset:28672
    s_waitcnt lgkmcnt(4)
    v_mfma_f32_16x16x32_bf16 v[28:31], v[216:219], v[68:71], v[28:31]
    ds_read_b128 v[52:55], v11 offset:16384
    v_mfma_f32_16x16x32_bf16 v[32:35], v[216:219], v[72:75], v[32:35]
    ds_read_b128 v[56:59], v11 offset:20480
    v_mfma_f32_16x16x32_bf16 v[32:35], v[220:223], v[80:83], v[32:35]
    ds_read_b128 v[60:63], v11 offset:24576
    v_mfma_f32_16x16x32_bf16 v[28:31], v[220:223], v[76:79], v[28:31]
    ds_read_b128 v[64:67], v11 offset:28672
    s_waitcnt vmcnt(0)
    buffer_atomic_add v113, v112, s[56:59], s40 offen offset:3072 sc1
    s_waitcnt lgkmcnt(4)
    v_mfma_f32_16x16x32_bf16 v[28:31], v[224:227], v[36:39], v[28:31]
    ds_read_b128 v[68:71], v12 offset:16384
    v_mfma_f32_16x16x32_bf16 v[32:35], v[224:227], v[40:43], v[32:35]
    ds_read_b128 v[72:75], v12 offset:20480
    v_mfma_f32_16x16x32_bf16 v[32:35], v[228:231], v[48:51], v[32:35]
    ds_read_b128 v[76:79], v12 offset:24576
    v_mfma_f32_16x16x32_bf16 v[28:31], v[228:231], v[44:47], v[28:31]
    ds_read_b128 v[80:83], v12 offset:28672
    s_waitcnt lgkmcnt(4)
    v_mfma_f32_16x16x32_bf16 v[28:31], v[232:235], v[52:55], v[28:31]
    ds_read_b128 v[36:39], v13 offset:16384
    v_mfma_f32_16x16x32_bf16 v[32:35], v[232:235], v[56:59], v[32:35]
    ds_read_b128 v[40:43], v13 offset:20480
    v_mfma_f32_16x16x32_bf16 v[32:35], v[236:239], v[64:67], v[32:35]
    ds_read_b128 v[44:47], v13 offset:24576
    v_mfma_f32_16x16x32_bf16 v[28:31], v[236:239], v[60:63], v[28:31]
    ds_read_b128 v[48:51], v13 offset:28672
    s_barrier
    ds_read_b128 v[88:91], v18 offset:1536
    ds_read_b128 v[92:95], v18 offset:3584
    ds_read_b128 v[96:99], v18 offset:1792
    ds_read_b128 v[100:103], v18 offset:3840
    s_waitcnt lgkmcnt(8)
    v_mfma_f32_16x16x32_bf16 v[28:31], v[240:243], v[68:71], v[28:31]
    v_mfma_f32_16x16x32_bf16 v[32:35], v[240:243], v[72:75], v[32:35]
    v_mfma_f32_16x16x32_bf16 v[32:35], v[244:247], v[80:83], v[32:35]
    v_mfma_f32_16x16x32_bf16 v[28:31], v[244:247], v[76:79], v[28:31]
    s_waitcnt lgkmcnt(4)
    v_mfma_f32_16x16x32_bf16 v[28:31], v[248:251], v[36:39], v[28:31]
    v_mfma_f32_16x16x32_bf16 v[32:35], v[248:251], v[40:43], v[32:35]
    v_mfma_f32_16x16x32_bf16 v[32:35], v[252:255], v[48:51], v[32:35]
    v_mfma_f32_16x16x32_bf16 v[28:31], v[252:255], v[44:47], v[28:31]
    s_setprio 1
    s_waitcnt lgkmcnt(0)
    s_load_dword s32, s[4:5], s20 offset:2560
    s_load_dword s3, s[4:5], s20 offset:2688
    s_add_u32 m0, s12, 139264
    s_add_u32 s49, s11, 0
    buffer_load_dwordx4 v2, s[16:19], s49 offen offset:0 sc1 lds
    buffer_load_dwordx4 v2, s[16:19], s49 offen offset:1024 sc1 lds
    buffer_load_dwordx4 v2, s[16:19], s49 offen offset:2048 sc1 lds
    buffer_load_dwordx4 v2, s[16:19], s49 offen offset:3072 sc1 lds
    v_pk_fma_f32 v[28:29], v[88:89], v[84:85], v[28:29]
    v_pk_fma_f32 v[30:31], v[88:89], v[86:87], v[30:31]
    v_pk_fma_f32 v[32:33], v[96:97], v[84:85], v[32:33]
    v_pk_fma_f32 v[34:35], v[96:97], v[86:87], v[34:35]
    v_pk_mul_f32 v[104:105], v[28:29], v[28:29]
    v_pk_mul_f32 v[106:107], v[30:31], v[30:31]
    v_pk_mul_f32 v[108:109], v[32:33], v[32:33]
    v_pk_mul_f32 v[110:111], v[34:35], v[34:35]
    v_pk_fma_f32 v[104:105], v[104:105], v[92:93], v[90:91]
    v_pk_fma_f32 v[106:107], v[106:107], v[92:93], v[90:91]
    v_pk_fma_f32 v[108:109], v[108:109], v[100:101], v[98:99]
    v_pk_fma_f32 v[110:111], v[110:111], v[100:101], v[98:99]
    v_pk_mul_f32 v[104:105], v[104:105], v[28:29]
    v_pk_mul_f32 v[106:107], v[106:107], v[30:31]
    v_pk_mul_f32 v[108:109], v[108:109], v[32:33]
    v_pk_mul_f32 v[110:111], v[110:111], v[34:35]
    v_exp_f32 v104, v104
    v_exp_f32 v105, v105
    v_exp_f32 v106, v106
    v_exp_f32 v107, v107
    v_exp_f32 v108, v108
    v_exp_f32 v109, v109
    v_exp_f32 v110, v110
    v_exp_f32 v111, v111
    v_pk_fma_f32 v[104:105], v[104:105], v[94:95], v[94:95]
    v_pk_fma_f32 v[106:107], v[106:107], v[94:95], v[94:95]
    v_pk_fma_f32 v[108:109], v[108:109], v[102:103], v[102:103]
    v_pk_fma_f32 v[110:111], v[110:111], v[102:103], v[102:103]
    v_rcp_f32 v104, v104
    v_rcp_f32 v105, v105
    v_rcp_f32 v106, v106
    v_rcp_f32 v107, v107
    v_rcp_f32 v108, v108
    v_rcp_f32 v109, v109
    v_rcp_f32 v110, v110
    v_rcp_f32 v111, v111
    v_pk_mul_f32 v[28:29], v[28:29], v[104:105]
    v_pk_mul_f32 v[30:31], v[30:31], v[106:107]
    v_pk_mul_f32 v[32:33], v[32:33], v[108:109]
    v_pk_mul_f32 v[34:35], v[34:35], v[110:111]
    v_cvt_pk_bf16_f32 v104, v28, v29
    v_cvt_pk_bf16_f32 v105, v30, v31
    v_cvt_pk_bf16_f32 v106, v32, v33
    v_cvt_pk_bf16_f32 v107, v34, v35
    s_add_u32 s36, s39, 393216
    v_permlane16_swap_b32 v104, v106
    v_permlane16_swap_b32 v105, v107
    buffer_store_dwordx4 v[104:107], v114, s[16:19], s36 offen sc1
    s_add_u32 m0, s12, 16384
    s_add_u32 s49, s8, 131072
    s_barrier
    s_waitcnt lgkmcnt(0)
    s_cmp_eq_u32 s32, s21
    s_cselect_b32 s32, s3, 0
    s_cmp_eq_u32 s32, s21
    s_cbranch_scc1 hok_22
    s_add_u32 s53, s20, 2560
    v_lshlrev_b32 v85, 7, v1
    v_add_u32 v85, s53, v85
    s_mov_b32 s53, 0
    s_add_u32 s54, s52, 16
    s_bfm_b64 exec, 2, 0
poll_23:
    buffer_load_dword v84, v85, s[56:59], 0 offen sc1
    s_waitcnt vmcnt(0)
    v_cmp_eq_u32 vcc, s54, v84
    s_nop 0
    s_cmp_eq_u64 vcc, exec
    s_cbranch_scc1 pok_24
    s_sleep 8
    s_add_u32 s53, s53, 1
    s_cmp_lt_u32 s53, s61
    s_cbranch_scc1 poll_23
    s_mov_b32 s61, 0
pok_24:
    s_mov_b64 exec, -1
hok_22:
    buffer_load_dwordx4 v2, s[16:19], s49 offen offset:0 sc1 lds
    buffer_load_dwordx4 v2, s[16:19], s49 offen offset:1024 sc1 lds
    buffer_load_dwordx4 v2, s[16:19], s49 offen offset:2048 sc1 lds
    buffer_load_dwordx4 v2, s[16:19], s49 offen offset:3072 sc1 lds
    s_add_u32 m0, s12, 32768
    s_add_u32 s49, s9, 131072
    s_barrier
    buffer_load_dwordx4 v2, s[16:19], s49 offen offset:0 sc1 lds
    buffer_load_dwordx4 v2, s[16:19], s49 offen offset:1024 sc1 lds
    buffer_load_dwordx4 v2, s[16:19], s49 offen offset:2048 sc1 lds
    buffer_load_dwordx4 v2, s[16:19], s49 offen offset:3072 sc1 lds
    s_add_u32 m0, s12, 106496
    s_add_u32 s49, s10, 131072
    s_waitcnt vmcnt(9)
    s_barrier
    s_waitcnt vmcnt(8)
    buffer_atomic_add v113, v112, s[56:59], s40 offen offset:3584 sc1
    buffer_load_dwordx4 v2, s[16:19], s49 offen offset:0 sc1 lds
    buffer_load_dwordx4 v2, s[16:19], s49 offen offset:1024 sc1 lds
    buffer_load_dwordx4 v2, s[16:19], s49 offen offset:2048 sc1 lds
    buffer_load_dwordx4 v2, s[16:19], s49 offen offset:3072 sc1 lds
    s_add_u32 m0, s12, 122880
    s_add_u32 s49, s11, 131072
    s_waitcnt vmcnt(9)
    s_barrier
    s_load_dword s32, s[4:5], s20 offset:3072
    s_load_dword s3, s[4:5], s20 offset:3200
    buffer_load_dwordx4 v2, s[16:19], s49 offen offset:0 sc1 lds
    buffer_load_dwordx4 v2, s[16:19], s49 offen offset:1024 sc1 lds
    buffer_load_dwordx4 v2, s[16:19], s49 offen offset:2048 sc1 lds
    buffer_load_dwordx4 v2, s[16:19], s49 offen offset:3072 sc1 lds
    s_add_u32 m0, s12, 139264
    s_add_u32 s49, s8, 262144
    s_waitcnt vmcnt(9)
    s_barrier
    s_waitcnt lgkmcnt(0)
    s_cmp_eq_u32 s32, s21
    s_cselect_b32 s32, s3, 0
    s_cmp_eq_u32 s32, s21
    s_cbranch_scc1 hok_25
    s_add_u32 s53, s20, 3072
    v_lshlrev_b32 v85, 7, v1
    v_add_u32 v85, s53, v85
    s_mov_b32 s53, 0
    s_add_u32 s54, s52, 16
    s_bfm_b64 exec, 2, 0
poll_26:
    buffer_load_dword v84, v85, s[56:59], 0 offen sc1
    s_waitcnt vmcnt(0)
    v_cmp_eq_u32 vcc, s54, v84
    s_nop 0
    s_cmp_eq_u64 vcc, exec
    s_cbranch_scc1 pok_27
    s_sleep 8
    s_add_u32 s53, s53, 1
    s_cmp_lt_u32 s53, s61
    s_cbranch_scc1 poll_26
    s_mov_b32 s61, 0
pok_27:
    s_mov_b64 exec, -1
hok_25:
    buffer_load_dwordx4 v2, s[16:19], s49 offen offset:0 sc1 lds
    buffer_load_dwordx4 v2, s[16:19], s49 offen offset:1024 sc1 lds
    buffer_load_dwordx4 v2, s[16:19], s49 offen offset:2048 sc1 lds
    buffer_load_dwordx4 v2, s[16:19], s49 offen offset:3072 sc1 lds
    s_add_u32 m0, s12, 16384
    s_add_u32 s49, s9, 262144
    s_waitcnt vmcnt(8)
    s_barrier
    buffer_load_dwordx4 v2, s[16:19], s49 offen offset:0 sc1 lds
    buffer_load_dwordx4 v2, s[16:19], s49 offen offset:1024 sc1 lds
    buffer_load_dwordx4 v2, s[16:19], s49 offen offset:2048 sc1 lds
    buffer_load_dwordx4 v2, s[16:19], s49 offen offset:3072 sc1 lds
    s_add_u32 m0, s12, 32768
    s_add_u32 s49, s10, 262144
    s_waitcnt vmcnt(8)
    s_barrier
    buffer_load_dwordx4 v2, s[16:19], s49 offen offset:0 sc1 lds
    buffer_load_dwordx4 v2, s[16:19], s49 offen offset:1024 sc1 lds
    buffer_load_dwordx4 v2, s[16:19], s49 offen offset:2048 sc1 lds
    buffer_load_dwordx4 v2, s[16:19], s49 offen offset:3072 sc1 lds
    s_add_u32 m0, s12, 106496
    s_add_u32 s49, s11, 262144
    s_waitcnt vmcnt(8)
    s_barrier
    s_load_dword s32, s[4:5], s20 offset:3584
    s_load_dword s3, s[4:5], s20 offset:3712
    buffer_load_dwordx4 v2, s[16:19], s49 offen offset:0 sc1 lds
    buffer_load_dwordx4 v2, s[16:19], s49 offen offset:1024 sc1 lds
    buffer_load_dwordx4 v2, s[16:19], s49 offen offset:2048 sc1 lds
    buffer_load_dwordx4 v2, s[16:19], s49 offen offset:3072 sc1 lds
    s_add_u32 m0, s12, 122880
    s_add_u32 s49, s8, 393216
    s_waitcnt vmcnt(8)
    s_barrier
    s_waitcnt lgkmcnt(0)
    s_cmp_eq_u32 s32, s21
    s_cselect_b32 s32, s3, 0
    s_cmp_eq_u32 s32, s21
    s_cbranch_scc1 hok_28
    s_add_u32 s53, s20, 3584
    v_lshlrev_b32 v85, 7, v1
    v_add_u32 v85, s53, v85
    s_mov_b32 s53, 0
    s_add_u32 s54, s52, 16
    s_bfm_b64 exec, 2, 0
poll_29:
    buffer_load_dword v84, v85, s[56:59], 0 offen sc1
    s_waitcnt vmcnt(0)
    v_cmp_eq_u32 vcc, s54, v84
    s_nop 0
    s_cmp_eq_u64 vcc, exec
    s_cbranch_scc1 pok_30
    s_sleep 8
    s_add_u32 s53, s53, 1
    s_cmp_lt_u32 s53, s61
    s_cbranch_scc1 poll_29
    s_mov_b32 s61, 0
pok_30:
    s_mov_b64 exec, -1
hok_28:
    buffer_load_dwordx4 v2, s[16:19], s49 offen offset:0 sc1 lds
    buffer_load_dwordx4 v2, s[16:19], s49 offen offset:1024 sc1 lds
    buffer_load_dwordx4 v2, s[16:19], s49 offen offset:2048 sc1 lds
    buffer_load_dwordx4 v2, s[16:19], s49 offen offset:3072 sc1 lds
    s_add_u32 m0, s12, 139264
    s_add_u32 s49, s9, 393216
    s_waitcnt vmcnt(8)
    s_barrier
    buffer_load_dwordx4 v2, s[16:19], s49 offen offset:0 sc1 lds
    buffer_load_dwordx4 v2, s[16:19], s49 offen offset:1024 sc1 lds
    buffer_load_dwordx4 v2, s[16:19], s49 offen offset:2048 sc1 lds
    buffer_load_dwordx4 v2, s[16:19], s49 offen offset:3072 sc1 lds
    s_add_u32 m0, s12, 16384
    s_add_u32 s49, s10, 393216
    s_waitcnt vmcnt(8)
    s_barrier
    buffer_load_dwordx4 v2, s[16:19], s49 offen offset:0 sc1 lds
    buffer_load_dwordx4 v2, s[16:19], s49 offen offset:1024 sc1 lds
    buffer_load_dwordx4 v2, s[16:19], s49 offen offset:2048 sc1 lds
    buffer_load_dwordx4 v2, s[16:19], s49 offen offset:3072 sc1 lds
    s_add_u32 m0, s12, 32768
    s_add_u32 s49, s11, 393216
    s_waitcnt vmcnt(8)
    s_barrier
    buffer_load_dwordx4 v2, s[16:19], s49 offen offset:0 sc1 lds
    buffer_load_dwordx4 v2, s[16:19], s49 offen offset:1024 sc1 lds
    buffer_load_dwordx4 v2, s[16:19], s49 offen offset:2048 sc1 lds
    buffer_load_dwordx4 v2, s[16:19], s49 offen offset:3072 sc1 lds
    s_waitcnt vmcnt(8)
    s_barrier
    s_lshr_b32 s34, s30, 1
    s_and_b32 s35, s30, 1
    v_and_b32 v22, 15, v1
    v_lshrrev_b32 v23, 4, v1
    s_mul_i32 s37, s34, 4
    s_mul_i32 s38, s29, 14
    s_mul_i32 s36, s35, 7
    s_add_u32 s38, s38, s36
    s_mul_i32 s36, s34, 8192
    v_add_u32 v12, s36, v2
    v_lshrrev_b32 v6, 2, v1
    v_mul_u32_u24 v13, 448, v6
    v_and_b32 v7, 3, v1
    v_lshl_add_u32 v13, v7, 3, v13
    v_add_u32 v13, 49152, v13
    s_mul_i32 s36, s35, 224
    v_add_u32 v13, s36, v13
    v_bfe_u32 v6, v1, 4, 1
    v_lshlrev_b32 v6, 5, v6
    s_cmp_eq_u32 s35, 0
    s_cselect_b32 s36, 1, -1
    v_mul_lo_u32 v6, v6, s36
    v_sub_u32 v14, v13, v6
    v_add_u32 v13, v13, v6
    s_mov_b32 s42, 0
    s_mov_b32 s43, 0
    s_mov_b32 s48, 0
    v_mov_b32 v17, v12
    v_mov_b32 v18, v13
    v_mov_b32 v19, v14
    s_waitcnt vmcnt(4)
    s_barrier
    s_waitcnt vmcnt(0)
    s_barrier
    s_setprio 0
    s_waitcnt lgkmcnt(0)
    s_barrier
    ds_read_b128 v[136:139], v17 offset:0
    ds_read_b128 v[140:143], v17 offset:2048
    ds_read_b128 v[144:147], v17 offset:4096
    ds_read_b128 v[148:151], v17 offset:6144
    ds_read_b64_tr_b16 v[152:153], v18 offset:0
    ds_read_b64_tr_b16 v[154:155], v18 offset:7168
    ds_read_b64_tr_b16 v[156:157], v19 offset:32
    ds_read_b64_tr_b16 v[158:159], v19 offset:7200
    ds_read_b64_tr_b16 v[160:161], v18 offset:64
    ds_read_b64_tr_b16 v[162:163], v18 offset:7232
    ds_read_b64_tr_b16 v[164:165], v19 offset:96
    ds_read_b64_tr_b16 v[166:167], v19 offset:7264
    ds_read_b64_tr_b16 v[168:169], v18 offset:128
    ds_read_b64_tr_b16 v[170:171], v18 offset:7296
    ds_read_b64_tr_b16 v[172:173], v19 offset:160
    ds_read_b64_tr_b16 v[174:175], v19 offset:7328
    ds_read_b64_tr_b16 v[176:177], v18 offset:192
    ds_read_b64_tr_b16 v[178:179], v18 offset:7360
    s_waitcnt lgkmcnt(0)
    v_mfma_f32_16x16x32_bf16 v[24:27], v[152:155], v[136:139], 0
    ds_read_b128 v[180:183], v17 offset:1024
    v_mfma_f32_16x16x32_bf16 v[52:55], v[152:155], v[140:143], 0
    ds_read_b128 v[184:187], v17 offset:3072
    v_mfma_f32_16x16x32_bf16 v[80:83], v[152:155], v[144:147], 0
    ds_read_b128 v[188:191], v17 offset:5120
    v_mfma_f32_16x16x32_bf16 v[108:111], v[152:155], v[148:151], 0
    ds_read_b128 v[192:195], v17 offset:7168
    v_mfma_f32_16x16x32_bf16 v[112:115], v[156:159], v[148:151], 0
    ds_read_b64_tr_b16 v[196:197], v18 offset:14336
    v_mfma_f32_16x16x32_bf16 v[84:87], v[156:159], v[144:147], 0
    ds_read_b64_tr_b16 v[198:199], v18 offset:21504
    v_mfma_f32_16x16x32_bf16 v[56:59], v[156:159], v[140:143], 0
    v_mfma_f32_16x16x32_bf16 v[28:31], v[156:159], v[136:139], 0
    ds_read_b64_tr_b16 v[200:201], v19 offset:14368
    v_mfma_f32_16x16x32_bf16 v[32:35], v[160:163], v[136:139], 0
    ds_read_b64_tr_b16 v[202:203], v19 offset:21536
    v_mfma_f32_16x16x32_bf16 v[60:63], v[160:163], v[140:143], 0
    ds_read_b64_tr_b16 v[204:205], v18 offset:14400
    v_mfma_f32_16x16x32_bf16 v[88:91], v[160:163], v[144:147], 0
    ds_read_b64_tr_b16 v[206:207], v18 offset:21568
    v_mfma_f32_16x16x32_bf16 v[116:119], v[160:163], v[148:151], 0
    ds_read_b64_tr_b16 v[208:209], v19 offset:14432
    v_mfma_f32_16x16x32_bf16 v[120:123], v[164:167], v[148:151], 0
    ds_read_b64_tr_b16 v[210:211], v19 offset:21600
    v_mfma_f32_16x16x32_bf16 v[92:95], v[164:167], v[144:147], 0
    v_mfma_f32_16x16x32_bf16 v[64:67], v[164:167], v[140:143], 0
    ds_read_b64_tr_b16 v[212:213], v18 offset:14464
    v_mfma_f32_16x16x32_bf16 v[36:39], v[164:167], v[136:139], 0
    ds_read_b64_tr_b16 v[214:215], v18 offset:21632
    v_mfma_f32_16x16x32_bf16 v[40:43], v[168:171], v[136:139], 0
    ds_read_b64_tr_b16 v[216:217], v19 offset:14496
    v_mfma_f32_16x16x32_bf16 v[68:71], v[168:171], v[140:143], 0
    ds_read_b64_tr_b16 v[218:219], v19 offset:21664
    v_mfma_f32_16x16x32_bf16 v[96:99], v[168:171], v[144:147], 0
    ds_read_b64_tr_b16 v[220:221], v18 offset:14528
    v_mfma_f32_16x16x32_bf16 v[124:127], v[168:171], v[148:151], 0
    ds_read_b64_tr_b16 v[222:223], v18 offset:21696
    v_mfma_f32_16x16x32_bf16 v[128:131], v[172:175], v[148:151], 0
    s_add_u32 s42, s42, 16384
    s_cmp_eq_u32 s42, 49152
    v_mfma_f32_16x16x32_bf16 v[100:103], v[172:175], v[144:147], 0
    s_cselect_b32 s42, 0, s42
    s_add_u32 s48, s48, 28672
    v_mfma_f32_16x16x32_bf16 v[72:75], v[172:175], v[140:143], 0
    s_cmp_eq_u32 s48, 86016
    s_cselect_b32 s48, 0, s48
    v_mfma_f32_16x16x32_bf16 v[44:47], v[172:175], v[136:139], 0
    v_add_u32 v17, s42, v12
    v_add_u32 v18, s48, v13
    v_mfma_f32_16x16x32_bf16 v[48:51], v[176:179], v[136:139], 0
    v_add_u32 v19, s48, v14
    v_mfma_f32_16x16x32_bf16 v[76:79], v[176:179], v[140:143], 0
    v_mfma_f32_16x16x32_bf16 v[104:107], v[176:179], v[144:147], 0
    v_mfma_f32_16x16x32_bf16 v[132:135], v[176:179], v[148:151], 0
    s_waitcnt lgkmcnt(0)
    v_mfma_f32_16x16x32_bf16 v[24:27], v[196:199], v[180:183], v[24:27]
    v_mfma_f32_16x16x32_bf16 v[52:55], v[196:199], v[184:187], v[52:55]
    v_mfma_f32_16x16x32_bf16 v[80:83], v[196:199], v[188:191], v[80:83]
    v_mfma_f32_16x16x32_bf16 v[108:111], v[196:199], v[192:195], v[108:111]
    v_mfma_f32_16x16x32_bf16 v[112:115], v[200:203], v[192:195], v[112:115]
    v_mfma_f32_16x16x32_bf16 v[84:87], v[200:203], v[188:191], v[84:87]
    v_mfma_f32_16x16x32_bf16 v[56:59], v[200:203], v[184:187], v[56:59]
    v_mfma_f32_16x16x32_bf16 v[28:31], v[200:203], v[180:183], v[28:31]
    v_mfma_f32_16x16x32_bf16 v[32:35], v[204:207], v[180:183], v[32:35]
    v_mfma_f32_16x16x32_bf16 v[60:63], v[204:207], v[184:187], v[60:63]
    v_mfma_f32_16x16x32_bf16 v[88:91], v[204:207], v[188:191], v[88:91]
    v_mfma_f32_16x16x32_bf16 v[116:119], v[204:207], v[192:195], v[116:119]
    v_mfma_f32_16x16x32_bf16 v[120:123], v[208:211], v[192:195], v[120:123]
    v_mfma_f32_16x16x32_bf16 v[92:95], v[208:211], v[188:191], v[92:95]
    v_mfma_f32_16x16x32_bf16 v[64:67], v[208:211], v[184:187], v[64:67]
    v_mfma_f32_16x16x32_bf16 v[36:39], v[208:211], v[180:183], v[36:39]
    v_mfma_f32_16x16x32_bf16 v[40:43], v[212:215], v[180:183], v[40:43]
    v_mfma_f32_16x16x32_bf16 v[68:71], v[212:215], v[184:187], v[68:71]
    v_mfma_f32_16x16x32_bf16 v[96:99], v[212:215], v[188:191], v[96:99]
    v_mfma_f32_16x16x32_bf16 v[124:127], v[212:215], v[192:195], v[124:127]
    v_mfma_f32_16x16x32_bf16 v[128:131], v[216:219], v[192:195], v[128:131]
    s_add_u32 s43, s43, 1
    v_mfma_f32_16x16x32_bf16 v[100:103], v[216:219], v[188:191], v[100:103]
    v_mfma_f32_16x16x32_bf16 v[72:75], v[216:219], v[184:187], v[72:75]
    v_mfma_f32_16x16x32_bf16 v[44:47], v[216:219], v[180:183], v[44:47]
    v_mfma_f32_16x16x32_bf16 v[48:51], v[220:223], v[180:183], v[48:51]
    v_mfma_f32_16x16x32_bf16 v[76:79], v[220:223], v[184:187], v[76:79]
    v_mfma_f32_16x16x32_bf16 v[104:107], v[220:223], v[188:191], v[104:107]
    v_mfma_f32_16x16x32_bf16 v[132:135], v[220:223], v[192:195], v[132:135]
    s_barrier
    ds_read_b128 v[136:139], v17 offset:0
    ds_read_b128 v[140:143], v17 offset:2048
    ds_read_b128 v[144:147], v17 offset:4096
    ds_read_b128 v[148:151], v17 offset:6144
    ds_read_b64_tr_b16 v[152:153], v18 offset:0
    ds_read_b64_tr_b16 v[154:155], v18 offset:7168
    ds_read_b64_tr_b16 v[156:157], v19 offset:32
    ds_read_b64_tr_b16 v[158:159], v19 offset:7200
    ds_read_b64_tr_b16 v[160:161], v18 offset:64
    ds_read_b64_tr_b16 v[162:163], v18 offset:7232
    ds_read_b64_tr_b16 v[164:165], v19 offset:96
    ds_read_b64_tr_b16 v[166:167], v19 offset:7264
    ds_read_b64_tr_b16 v[168:169], v18 offset:128
    ds_read_b64_tr_b16 v[170:171], v18 offset:7296
    ds_read_b64_tr_b16 v[172:173], v19 offset:160
    ds_read_b64_tr_b16 v[174:175], v19 offset:7328
    ds_read_b64_tr_b16 v[176:177], v18 offset:192
    ds_read_b64_tr_b16 v[178:179], v18 offset:7360
mm_31:
    s_waitcnt lgkmcnt(0)
    v_mfma_f32_16x16x32_bf16 v[24:27], v[152:155], v[136:139], v[24:27]
    ds_read_b128 v[180:183], v17 offset:1024
    v_mfma_f32_16x16x32_bf16 v[52:55], v[152:155], v[140:143], v[52:55]
    ds_read_b128 v[184:187], v17 offset:3072
    v_mfma_f32_16x16x32_bf16 v[80:83], v[152:155], v[144:147], v[80:83]
    ds_read_b128 v[188:191], v17 offset:5120
    v_mfma_f32_16x16x32_bf16 v[108:111], v[152:155], v[148:151], v[108:111]
    ds_read_b128 v[192:195], v17 offset:7168
    v_mfma_f32_16x16x32_bf16 v[112:115], v[156:159], v[148:151], v[112:115]
    ds_read_b64_tr_b16 v[196:197], v18 offset:14336
    v_mfma_f32_16x16x32_bf16 v[84:87], v[156:159], v[144:147], v[84:87]
    ds_read_b64_tr_b16 v[198:199], v18 offset:21504
    v_mfma_f32_16x16x32_bf16 v[56:59], v[156:159], v[140:143], v[56:59]
    v_mfma_f32_16x16x32_bf16 v[28:31], v[156:159], v[136:139], v[28:31]
    ds_read_b64_tr_b16 v[200:201], v19 offset:14368
    v_mfma_f32_16x16x32_bf16 v[32:35], v[160:163], v[136:139], v[32:35]
    ds_read_b64_tr_b16 v[202:203], v19 offset:21536
    v_mfma_f32_16x16x32_bf16 v[60:63], v[160:163], v[140:143], v[60:63]
    ds_read_b64_tr_b16 v[204:205], v18 offset:14400
    v_mfma_f32_16x16x32_bf16 v[88:91], v[160:163], v[144:147], v[88:91]
    ds_read_b64_tr_b16 v[206:207], v18 offset:21568
    v_mfma_f32_16x16x32_bf16 v[116:119], v[160:163], v[148:151], v[116:119]
    ds_read_b64_tr_b16 v[208:209], v19 offset:14432
    v_mfma_f32_16x16x32_bf16 v[120:123], v[164:167], v[148:151], v[120:123]
    ds_read_b64_tr_b16 v[210:211], v19 offset:21600
    v_mfma_f32_16x16x32_bf16 v[92:95], v[164:167], v[144:147], v[92:95]
    v_mfma_f32_16x16x32_bf16 v[64:67], v[164:167], v[140:143], v[64:67]
    ds_read_b64_tr_b16 v[212:213], v18 offset:14464
    v_mfma_f32_16x16x32_bf16 v[36:39], v[164:167], v[136:139], v[36:39]
    ds_read_b64_tr_b16 v[214:215], v18 offset:21632
    v_mfma_f32_16x16x32_bf16 v[40:43], v[168:171], v[136:139], v[40:43]
    ds_read_b64_tr_b16 v[216:217], v19 offset:14496
    v_mfma_f32_16x16x32_bf16 v[68:71], v[168:171], v[140:143], v[68:71]
    ds_read_b64_tr_b16 v[218:219], v19 offset:21664
    v_mfma_f32_16x16x32_bf16 v[96:99], v[168:171], v[144:147], v[96:99]
    ds_read_b64_tr_b16 v[220:221], v18 offset:14528
    v_mfma_f32_16x16x32_bf16 v[124:127], v[168:171], v[148:151], v[124:127]
    ds_read_b64_tr_b16 v[222:223], v18 offset:21696
    v_mfma_f32_16x16x32_bf16 v[128:131], v[172:175], v[148:151], v[128:131]
    s_add_u32 s42, s42, 16384
    s_cmp_eq_u32 s42, 49152
    v_mfma_f32_16x16x32_bf16 v[100:103], v[172:175], v[144:147], v[100:103]
    s_cselect_b32 s42, 0, s42
    s_add_u32 s48, s48, 28672
    v_mfma_f32_16x16x32_bf16 v[72:75], v[172:175], v[140:143], v[72:75]
    s_cmp_eq_u32 s48, 86016
    s_cselect_b32 s48, 0, s48
    v_mfma_f32_16x16x32_bf16 v[44:47], v[172:175], v[136:139], v[44:47]
    v_add_u32 v17, s42, v12
    v_add_u32 v18, s48, v13
    v_mfma_f32_16x16x32_bf16 v[48:51], v[176:179], v[136:139], v[48:51]
    v_add_u32 v19, s48, v14
    v_mfma_f32_16x16x32_bf16 v[76:79], v[176:179], v[140:143], v[76:79]
    v_mfma_f32_16x16x32_bf16 v[104:107], v[176:179], v[144:147], v[104:107]
    v_mfma_f32_16x16x32_bf16 v[132:135], v[176:179], v[148:151], v[132:135]
    s_waitcnt lgkmcnt(0)
    s_barrier
    v_mfma_f32_16x16x32_bf16 v[24:27], v[196:199], v[180:183], v[24:27]
    ds_read_b128 v[136:139], v17 offset:0
    v_mfma_f32_16x16x32_bf16 v[52:55], v[196:199], v[184:187], v[52:55]
    ds_read_b128 v[140:143], v17 offset:2048
    v_mfma_f32_16x16x32_bf16 v[80:83], v[196:199], v[188:191], v[80:83]
    ds_read_b128 v[144:147], v17 offset:4096
    v_mfma_f32_16x16x32_bf16 v[108:111], v[196:199], v[192:195], v[108:111]
    ds_read_b128 v[148:151], v17 offset:6144
    v_mfma_f32_16x16x32_bf16 v[112:115], v[200:203], v[192:195], v[112:115]
    ds_read_b64_tr_b16 v[152:153], v18 offset:0
    v_mfma_f32_16x16x32_bf16 v[84:87], v[200:203], v[188:191], v[84:87]
    ds_read_b64_tr_b16 v[154:155], v18 offset:7168
    v_mfma_f32_16x16x32_bf16 v[56:59], v[200:203], v[184:187], v[56:59]
    v_mfma_f32_16x16x32_bf16 v[28:31], v[200:203], v[180:183], v[28:31]
    ds_read_b64_tr_b16 v[156:157], v19 offset:32
    v_mfma_f32_16x16x32_bf16 v[32:35], v[204:207], v[180:183], v[32:35]
    ds_read_b64_tr_b16 v[158:159], v19 offset:7200
    v_mfma_f32_16x16x32_bf16 v[60:63], v[204:207], v[184:187], v[60:63]
    ds_read_b64_tr_b16 v[160:161], v18 offset:64
    v_mfma_f32_16x16x32_bf16 v[88:91], v[204:207], v[188:191], v[88:91]
    ds_read_b64_tr_b16 v[162:163], v18 offset:7232
    v_mfma_f32_16x16x32_bf16 v[116:119], v[204:207], v[192:195], v[116:119]
    ds_read_b64_tr_b16 v[164:165], v19 offset:96
    v_mfma_f32_16x16x32_bf16 v[120:123], v[208:211], v[192:195], v[120:123]
    ds_read_b64_tr_b16 v[166:167], v19 offset:7264
    v_mfma_f32_16x16x32_bf16 v[92:95], v[208:211], v[188:191], v[92:95]
    v_mfma_f32_16x16x32_bf16 v[64:67], v[208:211], v[184:187], v[64:67]
    ds_read_b64_tr_b16 v[168:169], v18 offset:128
    v_mfma_f32_16x16x32_bf16 v[36:39], v[208:211], v[180:183], v[36:39]
    ds_read_b64_tr_b16 v[170:171], v18 offset:7296
    v_mfma_f32_16x16x32_bf16 v[40:43], v[212:215], v[180:183], v[40:43]
    ds_read_b64_tr_b16 v[172:173], v19 offset:160
    v_mfma_f32_16x16x32_bf16 v[68:71], v[212:215], v[184:187], v[68:71]
    ds_read_b64_tr_b16 v[174:175], v19 offset:7328
    v_mfma_f32_16x16x32_bf16 v[96:99], v[212:215], v[188:191], v[96:99]
    ds_read_b64_tr_b16 v[176:177], v18 offset:192
    v_mfma_f32_16x16x32_bf16 v[124:127], v[212:215], v[192:195], v[124:127]
    ds_read_b64_tr_b16 v[178:179], v18 offset:7360
    v_mfma_f32_16x16x32_bf16 v[128:131], v[216:219], v[192:195], v[128:131]
    s_add_u32 s43, s43, 1
    v_mfma_f32_16x16x32_bf16 v[100:103], v[216:219], v[188:191], v[100:103]
    s_cmp_lt_u32 s43, 15
    v_mfma_f32_16x16x32_bf16 v[72:75], v[216:219], v[184:187], v[72:75]
    v_mfma_f32_16x16x32_bf16 v[44:47], v[216:219], v[180:183], v[44:47]
    v_mfma_f32_16x16x32_bf16 v[48:51], v[220:223], v[180:183], v[48:51]
    v_mfma_f32_16x16x32_bf16 v[76:79], v[220:223], v[184:187], v[76:79]
    v_mfma_f32_16x16x32_bf16 v[104:107], v[220:223], v[188:191], v[104:107]
    v_mfma_f32_16x16x32_bf16 v[132:135], v[220:223], v[192:195], v[132:135]
    s_cbranch_scc1 mm_31
    s_waitcnt lgkmcnt(0)
    v_mfma_f32_16x16x32_bf16 v[24:27], v[152:155], v[136:139], v[24:27]
    ds_read_b128 v[180:183], v17 offset:1024
    v_mfma_f32_16x16x32_bf16 v[52:55], v[152:155], v[140:143], v[52:55]
    ds_read_b128 v[184:187], v17 offset:3072
    v_mfma_f32_16x16x32_bf16 v[80:83], v[152:155], v[144:147], v[80:83]
    ds_read_b128 v[188:191], v17 offset:5120
    v_mfma_f32_16x16x32_bf16 v[108:111], v[152:155], v[148:151], v[108:111]
    ds_read_b128 v[192:195], v17 offset:7168
    v_mfma_f32_16x16x32_bf16 v[112:115], v[156:159], v[148:151], v[112:115]
    ds_read_b64_tr_b16 v[196:197], v18 offset:14336
    v_mfma_f32_16x16x32_bf16 v[84:87], v[156:159], v[144:147], v[84:87]
    ds_read_b64_tr_b16 v[198:199], v18 offset:21504
    v_mfma_f32_16x16x32_bf16 v[56:59], v[156:159], v[140:143], v[56:59]
    v_mfma_f32_16x16x32_bf16 v[28:31], v[156:159], v[136:139], v[28:31]
    ds_read_b64_tr_b16 v[200:201], v19 offset:14368
    v_mfma_f32_16x16x32_bf16 v[32:35], v[160:163], v[136:139], v[32:35]
    ds_read_b64_tr_b16 v[202:203], v19 offset:21536
    v_mfma_f32_16x16x32_bf16 v[60:63], v[160:163], v[140:143], v[60:63]
    ds_read_b64_tr_b16 v[204:205], v18 offset:14400
    v_mfma_f32_16x16x32_bf16 v[88:91], v[160:163], v[144:147], v[88:91]
    ds_read_b64_tr_b16 v[206:207], v18 offset:21568
    v_mfma_f32_16x16x32_bf16 v[116:119], v[160:163], v[148:151], v[116:119]
    ds_read_b64_tr_b16 v[208:209], v19 offset:14432
    v_mfma_f32_16x16x32_bf16 v[120:123], v[164:167], v[148:151], v[120:123]
    ds_read_b64_tr_b16 v[210:211], v19 offset:21600
    v_mfma_f32_16x16x32_bf16 v[92:95], v[164:167], v[144:147], v[92:95]
    v_mfma_f32_16x16x32_bf16 v[64:67], v[164:167], v[140:143], v[64:67]
    ds_read_b64_tr_b16 v[212:213], v18 offset:14464
    v_mfma_f32_16x16x32_bf16 v[36:39], v[164:167], v[136:139], v[36:39]
    ds_read_b64_tr_b16 v[214:215], v18 offset:21632
    v_mfma_f32_16x16x32_bf16 v[40:43], v[168:171], v[136:139], v[40:43]
    ds_read_b64_tr_b16 v[216:217], v19 offset:14496
    v_mfma_f32_16x16x32_bf16 v[68:71], v[168:171], v[140:143], v[68:71]
    ds_read_b64_tr_b16 v[218:219], v19 offset:21664
    v_mfma_f32_16x16x32_bf16 v[96:99], v[168:171], v[144:147], v[96:99]
    ds_read_b64_tr_b16 v[220:221], v18 offset:14528
    v_mfma_f32_16x16x32_bf16 v[124:127], v[168:171], v[148:151], v[124:127]
    ds_read_b64_tr_b16 v[222:223], v18 offset:21696
    v_mfma_f32_16x16x32_bf16 v[128:131], v[172:175], v[148:151], v[128:131]
    v_mfma_f32_16x16x32_bf16 v[100:103], v[172:175], v[144:147], v[100:103]
    v_mfma_f32_16x16x32_bf16 v[72:75], v[172:175], v[140:143], v[72:75]
    v_mfma_f32_16x16x32_bf16 v[44:47], v[172:175], v[136:139], v[44:47]
    v_mfma_f32_16x16x32_bf16 v[48:51], v[176:179], v[136:139], v[48:51]
    v_mfma_f32_16x16x32_bf16 v[76:79], v[176:179], v[140:143], v[76:79]
    v_mfma_f32_16x16x32_bf16 v[104:107], v[176:179], v[144:147], v[104:107]
    v_mfma_f32_16x16x32_bf16 v[132:135], v[176:179], v[148:151], v[132:135]
    s_waitcnt lgkmcnt(0)
    s_barrier
    v_mfma_f32_16x16x32_bf16 v[24:27], v[196:199], v[180:183], v[24:27]
    s_mul_i32 s36, s35, 448
    s_add_u32 s36, s36, 159744
    v_lshlrev_b32 v6, 4, v23
    v_add_u32 v6, s36, v6
    v_mfma_f32_16x16x32_bf16 v[52:55], v[196:199], v[184:187], v[52:55]
    ds_read_b128 v[136:139], v6 offset:0
    ds_read_b128 v[140:143], v6 offset:64
    ds_read_b128 v[144:147], v6 offset:128
    v_mfma_f32_16x16x32_bf16 v[80:83], v[196:199], v[188:191], v[80:83]
    ds_read_b128 v[148:151], v6 offset:192
    ds_read_b128 v[152:155], v6 offset:256
    ds_read_b128 v[156:159], v6 offset:320
    v_mfma_f32_16x16x32_bf16 v[108:111], v[196:199], v[192:195], v[108:111]
    ds_read_b128 v[160:163], v6 offset:384
    s_lshl_b32 s36, s34, 9
    s_add_u32 s36, s36, 160768
    v_mfma_f32_16x16x32_bf16 v[112:115], v[200:203], v[192:195], v[112:115]
    v_lshlrev_b32 v7, 3, v22
    v_add_u32 v7, s36, v7
    ds_read_b64 v[164:165], v7 offset:0
    v_mfma_f32_16x16x32_bf16 v[84:87], v[200:203], v[188:191], v[84:87]
    ds_read_b64 v[166:167], v7 offset:128
    ds_read_b64 v[168:169], v7 offset:256
    ds_read_b64 v[170:171], v7 offset:384
    v_mfma_f32_16x16x32_bf16 v[56:59], v[200:203], v[184:187], v[56:59]
    s_mov_b32 s16, s62
    s_mov_b32 s17, s63
    s_mov_b32 s18, 0x1be000
    v_mfma_f32_16x16x32_bf16 v[28:31], v[200:203], v[180:183], v[28:31]
    s_mov_b32 s19, 0x20000
    s_mul_i32 s39, s37, 229376
    s_lshr_b32 s36, s38, 1
    v_mfma_f32_16x16x32_bf16 v[32:35], v[204:207], v[180:183], v[32:35]
    s_add_u32 s36, s36, 0
    s_lshr_b32 s53, s36, 3
    s_lshl_b32 s53, s53, 14
    v_mfma_f32_16x16x32_bf16 v[60:63], v[204:207], v[184:187], v[60:63]
    s_and_b32 s44, s36, 7
    s_lshl_b32 s44, s44, 10
    s_add_u32 s44, s44, s53
    v_mfma_f32_16x16x32_bf16 v[88:91], v[204:207], v[188:191], v[88:91]
    s_add_u32 s44, s44, s39
    s_lshr_b32 s36, s38, 1
    s_add_u32 s36, s36, 1
    s_lshr_b32 s53, s36, 3
    v_mfma_f32_16x16x32_bf16 v[116:119], v[204:207], v[192:195], v[116:119]
    s_lshl_b32 s53, s53, 14
    s_and_b32 s45, s36, 7
    s_lshl_b32 s45, s45, 10
    v_mfma_f32_16x16x32_bf16 v[120:123], v[208:211], v[192:195], v[120:123]
    s_add_u32 s45, s45, s53
    s_add_u32 s45, s45, s39
    s_lshr_b32 s36, s38, 1
    v_mfma_f32_16x16x32_bf16 v[92:95], v[208:211], v[188:191], v[92:95]
    s_add_u32 s36, s36, 2
    s_lshr_b32 s53, s36, 3
    s_lshl_b32 s53, s53, 14
    v_mfma_f32_16x16x32_bf16 v[64:67], v[208:211], v[184:187], v[64:67]
    s_and_b32 s46, s36, 7
    s_lshl_b32 s46, s46, 10
    s_add_u32 s46, s46, s53
    v_mfma_f32_16x16x32_bf16 v[36:39], v[208:211], v[180:183], v[36:39]
    s_add_u32 s46, s46, s39
    s_lshr_b32 s36, s38, 1
    s_add_u32 s36, s36, 3
    v_mfma_f32_16x16x32_bf16 v[40:43], v[212:215], v[180:183], v[40:43]
    s_lshr_b32 s53, s36, 3
    s_lshl_b32 s53, s53, 14
    s_and_b32 s47, s36, 7
    v_mfma_f32_16x16x32_bf16 v[68:71], v[212:215], v[184:187], v[68:71]
    s_lshl_b32 s47, s47, 10
    s_add_u32 s47, s47, s53
    s_add_u32 s47, s47, s39
    v_mfma_f32_16x16x32_bf16 v[96:99], v[212:215], v[188:191], v[96:99]
    s_lshl_b32 s36, s37, 1
    s_add_u32 s36, s36, s35
    s_lshl_b32 s36, s36, 10
    v_mfma_f32_16x16x32_bf16 v[124:127], v[212:215], v[192:195], v[124:127]
    v_add_u32 v12, s36, v2
    v_lshrrev_b32 v254, 1, v23
    v_lshlrev_b32 v254, 8, v254
    v_mfma_f32_16x16x32_bf16 v[128:131], v[216:219], v[192:195], v[128:131]
    v_lshl_add_u32 v254, v22, 4, v254
    v_and_b32 v224, 1, v23
    v_lshl_add_u32 v254, v224, 3, v254
    v_mfma_f32_16x16x32_bf16 v[100:103], v[216:219], v[188:191], v[100:103]
    v_mfma_f32_16x16x32_bf16 v[72:75], v[216:219], v[184:187], v[72:75]
    v_mfma_f32_16x16x32_bf16 v[44:47], v[216:219], v[180:183], v[44:47]
    v_mfma_f32_16x16x32_bf16 v[48:51], v[220:223], v[180:183], v[48:51]
    v_mfma_f32_16x16x32_bf16 v[76:79], v[220:223], v[184:187], v[76:79]
    v_mfma_f32_16x16x32_bf16 v[104:107], v[220:223], v[188:191], v[104:107]
    v_mfma_f32_16x16x32_bf16 v[132:135], v[220:223], v[192:195], v[132:135]
    s_waitcnt lgkmcnt(0)
    v_mul_f32 v184, 0xc0135761, v165
    v_mul_f32 v185, v165, v165
    v_mul_f32 v185, v185, v184
    v_mul_f32 v185, 0x3d372713, v185
    v_rcp_f32 v165, v165
    v_mul_f32 v186, 0xc0135761, v167
    v_mul_f32 v187, v167, v167
    v_mul_f32 v187, v187, v186
    v_mul_f32 v187, 0x3d372713, v187
    v_rcp_f32 v167, v167
    v_mul_f32 v188, 0xc0135761, v169
    v_mul_f32 v189, v169, v169
    v_mul_f32 v189, v189, v188
    v_mul_f32 v189, 0x3d372713, v189
    v_rcp_f32 v169, v169
    v_mul_f32 v190, 0xc0135761, v171
    v_mul_f32 v191, v171, v171
    v_mul_f32 v191, v191, v190
    v_mul_f32 v191, 0x3d372713, v191
    v_rcp_f32 v171, v171
    s_cmp_eq_u32 s35, 1
    s_cbranch_scc1 G3_e1
    v_pk_fma_f32 v[24:25], v[164:165], v[136:137], v[24:25] op_sel_hi:[0,1,1] neg_lo:[1,0,0] neg_hi:[1,0,0]
    v_pk_fma_f32 v[26:27], v[164:165], v[138:139], v[26:27] op_sel_hi:[0,1,1] neg_lo:[1,0,0] neg_hi:[1,0,0]
    v_pk_mul_f32 v[226:227], v[24:25], v[24:25]
    v_pk_mul_f32 v[228:229], v[26:27], v[26:27]
    v_pk_fma_f32 v[226:227], v[226:227], v[184:185], v[184:185] op_sel:[0,1,0] op_sel_hi:[1,1,0]
    v_pk_fma_f32 v[228:229], v[228:229], v[184:185], v[184:185] op_sel:[0,1,0] op_sel_hi:[1,1,0]
    v_pk_mul_f32 v[226:227], v[226:227], v[24:25]
    v_pk_mul_f32 v[228:229], v[228:229], v[26:27]
    v_exp_f32 v226, v226
    v_exp_f32 v227, v227
    v_exp_f32 v228, v228
    v_exp_f32 v229, v229
    v_pk_fma_f32 v[226:227], v[226:227], v[164:165], v[164:165] op_sel:[0,1,1] op_sel_hi:[1,1,1]
    v_pk_fma_f32 v[228:229], v[228:229], v[164:165], v[164:165] op_sel:[0,1,1] op_sel_hi:[1,1,1]
    v_rcp_f32 v226, v226
    v_rcp_f32 v227, v227
    v_rcp_f32 v228, v228
    v_rcp_f32 v229, v229
    v_pk_mul_f32 v[24:25], v[24:25], v[226:227]
    v_pk_mul_f32 v[26:27], v[26:27], v[228:229]
    v_pk_fma_f32 v[28:29], v[164:165], v[140:141], v[28:29] op_sel_hi:[0,1,1] neg_lo:[1,0,0] neg_hi:[1,0,0]
    v_pk_fma_f32 v[30:31], v[164:165], v[142:143], v[30:31] op_sel_hi:[0,1,1] neg_lo:[1,0,0] neg_hi:[1,0,0]
    v_pk_mul_f32 v[226:227], v[28:29], v[28:29]
    v_pk_mul_f32 v[228:229], v[30:31], v[30:31]
    v_pk_fma_f32 v[226:227], v[226:227], v[184:185], v[184:185] op_sel:[0,1,0] op_sel_hi:[1,1,0]
    v_pk_fma_f32 v[228:229], v[228:229], v[184:185], v[184:185] op_sel:[0,1,0] op_sel_hi:[1,1,0]
    v_pk_mul_f32 v[226:227], v[226:227], v[28:29]
    v_pk_mul_f32 v[228:229], v[228:229], v[30:31]
    v_exp_f32 v226, v226
    v_exp_f32 v227, v227
    v_exp_f32 v228, v228
    v_exp_f32 v229, v229
    v_pk_fma_f32 v[226:227], v[226:227], v[164:165], v[164:165] op_sel:[0,1,1] op_sel_hi:[1,1,1]
    v_pk_fma_f32 v[228:229], v[228:229], v[164:165], v[164:165] op_sel:[0,1,1] op_sel_hi:[1,1,1]
    v_rcp_f32 v226, v226
    v_rcp_f32 v227, v227
    v_rcp_f32 v228, v228
    v_rcp_f32 v229, v229
    v_pk_mul_f32 v[28:29], v[28:29], v[226:227]
    v_pk_mul_f32 v[30:31], v[30:31], v[228:229]
    v_cvt_pk_bf16_f32 v24, v24, v25
    v_cvt_pk_bf16_f32 v25, v26, v27
    v_cvt_pk_bf16_f32 v26, v28, v29
    v_cvt_pk_bf16_f32 v27, v30, v31
    ds_write_b128 v12, v[24:27] offset:0
    s_add_u32 s36, s44, 0
    buffer_store_dwordx4 v[24:27], v2, s[16:19], s36 offen sc1
    v_pk_fma_f32 v[52:53], v[166:167], v[136:137], v[52:53] op_sel_hi:[0,1,1] neg_lo:[1,0,0] neg_hi:[1,0,0]
    v_pk_fma_f32 v[54:55], v[166:167], v[138:139], v[54:55] op_sel_hi:[0,1,1] neg_lo:[1,0,0] neg_hi:[1,0,0]
    v_pk_mul_f32 v[226:227], v[52:53], v[52:53]
    v_pk_mul_f32 v[228:229], v[54:55], v[54:55]
    v_pk_fma_f32 v[226:227], v[226:227], v[186:187], v[186:187] op_sel:[0,1,0] op_sel_hi:[1,1,0]
    v_pk_fma_f32 v[228:229], v[228:229], v[186:187], v[186:187] op_sel:[0,1,0] op_sel_hi:[1,1,0]
    v_pk_mul_f32 v[226:227], v[226:227], v[52:53]
    v_pk_mul_f32 v[228:229], v[228:229], v[54:55]
    v_exp_f32 v226, v226
    v_exp_f32 v227, v227
    v_exp_f32 v228, v228
    v_exp_f32 v229, v229
    v_pk_fma_f32 v[226:227], v[226:227], v[166:167], v[166:167] op_sel:[0,1,1] op_sel_hi:[1,1,1]
    v_pk_fma_f32 v[228:229], v[228:229], v[166:167], v[166:167] op_sel:[0,1,1] op_sel_hi:[1,1,1]
    v_rcp_f32 v226, v226
    v_rcp_f32 v227, v227
    v_rcp_f32 v228, v228
    v_rcp_f32 v229, v229
    v_pk_mul_f32 v[52:53], v[52:53], v[226:227]
    v_pk_mul_f32 v[54:55], v[54:55], v[228:229]
    v_pk_fma_f32 v[56:57], v[166:167], v[140:141], v[56:57] op_sel_hi:[0,1,1] neg_lo:[1,0,0] neg_hi:[1,0,0]
    v_pk_fma_f32 v[58:59], v[166:167], v[142:143], v[58:59] op_sel_hi:[0,1,1] neg_lo:[1,0,0] neg_hi:[1,0,0]
    v_pk_mul_f32 v[226:227], v[56:57], v[56:57]
    v_pk_mul_f32 v[228:229], v[58:59], v[58:59]
    v_pk_fma_f32 v[226:227], v[226:227], v[186:187], v[186:187] op_sel:[0,1,0] op_sel_hi:[1,1,0]
    v_pk_fma_f32 v[228:229], v[228:229], v[186:187], v[186:187] op_sel:[0,1,0] op_sel_hi:[1,1,0]
    v_pk_mul_f32 v[226:227], v[226:227], v[56:57]
    v_pk_mul_f32 v[228:229], v[228:229], v[58:59]
    v_exp_f32 v226, v226
    v_exp_f32 v227, v227
    v_exp_f32 v228, v228
    v_exp_f32 v229, v229
    v_pk_fma_f32 v[226:227], v[226:227], v[166:167], v[166:167] op_sel:[0,1,1] op_sel_hi:[1,1,1]
    v_pk_fma_f32 v[228:229], v[228:229], v[166:167], v[166:167] op_sel:[0,1,1] op_sel_hi:[1,1,1]
    v_rcp_f32 v226, v226
    v_rcp_f32 v227, v227
    v_rcp_f32 v228, v228
    v_rcp_f32 v229, v229
    v_pk_mul_f32 v[56:57], v[56:57], v[226:227]
    v_pk_mul_f32 v[58:59], v[58:59], v[228:229]
    v_cvt_pk_bf16_f32 v52, v52, v53
    v_cvt_pk_bf16_f32 v53, v54, v55
    v_cvt_pk_bf16_f32 v54, v56, v57
    v_cvt_pk_bf16_f32 v55, v58, v59
    ds_write_b128 v12, v[52:55] offset:2048
    s_add_u32 s36, s44, 229376
    buffer_store_dwordx4 v[52:55], v2, s[16:19], s36 offen sc1
    v_pk_fma_f32 v[80:81], v[168:169], v[136:137], v[80:81] op_sel_hi:[0,1,1] neg_lo:[1,0,0] neg_hi:[1,0,0]
    v_pk_fma_f32 v[82:83], v[168:169], v[138:139], v[82:83] op_sel_hi:[0,1,1] neg_lo:[1,0,0] neg_hi:[1,0,0]
    v_pk_mul_f32 v[226:227], v[80:81], v[80:81]
    v_pk_mul_f32 v[228:229], v[82:83], v[82:83]
    v_pk_fma_f32 v[226:227], v[226:227], v[188:189], v[188:189] op_sel:[0,1,0] op_sel_hi:[1,1,0]
    v_pk_fma_f32 v[228:229], v[228:229], v[188:189], v[188:189] op_sel:[0,1,0] op_sel_hi:[1,1,0]
    v_pk_mul_f32 v[226:227], v[226:227], v[80:81]
    v_pk_mul_f32 v[228:229], v[228:229], v[82:83]
    v_exp_f32 v226, v226
    v_exp_f32 v227, v227
    v_exp_f32 v228, v228
    v_exp_f32 v229, v229
    v_pk_fma_f32 v[226:227], v[226:227], v[168:169], v[168:169] op_sel:[0,1,1] op_sel_hi:[1,1,1]
    v_pk_fma_f32 v[228:229], v[228:229], v[168:169], v[168:169] op_sel:[0,1,1] op_sel_hi:[1,1,1]
    v_rcp_f32 v226, v226
    v_rcp_f32 v227, v227
    v_rcp_f32 v228, v228
    v_rcp_f32 v229, v229
    v_pk_mul_f32 v[80:81], v[80:81], v[226:227]
    v_pk_mul_f32 v[82:83], v[82:83], v[228:229]
    v_pk_fma_f32 v[84:85], v[168:169], v[140:141], v[84:85] op_sel_hi:[0,1,1] neg_lo:[1,0,0] neg_hi:[1,0,0]
    v_pk_fma_f32 v[86:87], v[168:169], v[142:143], v[86:87] op_sel_hi:[0,1,1] neg_lo:[1,0,0] neg_hi:[1,0,0]
    v_pk_mul_f32 v[226:227], v[84:85], v[84:85]
    v_pk_mul_f32 v[228:229], v[86:87], v[86:87]
    v_pk_fma_f32 v[226:227], v[226:227], v[188:189], v[188:189] op_sel:[0,1,0] op_sel_hi:[1,1,0]
    v_pk_fma_f32 v[228:229], v[228:229], v[188:189], v[188:189] op_sel:[0,1,0] op_sel_hi:[1,1,0]
    v_pk_mul_f32 v[226:227], v[226:227], v[84:85]
    v_pk_mul_f32 v[228:229], v[228:229], v[86:87]
    v_exp_f32 v226, v226
    v_exp_f32 v227, v227
    v_exp_f32 v228, v228
    v_exp_f32 v229, v229
    v_pk_fma_f32 v[226:227], v[226:227], v[168:169], v[168:169] op_sel:[0,1,1] op_sel_hi:[1,1,1]
    v_pk_fma_f32 v[228:229], v[228:229], v[168:169], v[168:169] op_sel:[0,1,1] op_sel_hi:[1,1,1]
    v_rcp_f32 v226, v226
    v_rcp_f32 v227, v227
    v_rcp_f32 v228, v228
    v_rcp_f32 v229, v229
    v_pk_mul_f32 v[84:85], v[84:85], v[226:227]
    v_pk_mul_f32 v[86:87], v[86:87], v[228:229]
    v_cvt_pk_bf16_f32 v80, v80, v81
    v_cvt_pk_bf16_f32 v81, v82, v83
    v_cvt_pk_bf16_f32 v82, v84, v85
    v_cvt_pk_bf16_f32 v83, v86, v87
    ds_write_b128 v12, v[80:83] offset:4096
    s_add_u32 s36, s44, 458752
    buffer_store_dwordx4 v[80:83], v2, s[16:19], s36 offen sc1
    v_pk_fma_f32 v[108:109], v[170:171], v[136:137], v[108:109] op_sel_hi:[0,1,1] neg_lo:[1,0,0] neg_hi:[1,0,0]
    v_pk_fma_f32 v[110:111], v[170:171], v[138:139], v[110:111] op_sel_hi:[0,1,1] neg_lo:[1,0,0] neg_hi:[1,0,0]
    v_pk_mul_f32 v[226:227], v[108:109], v[108:109]
    v_pk_mul_f32 v[228:229], v[110:111], v[110:111]
    v_pk_fma_f32 v[226:227], v[226:227], v[190:191], v[190:191] op_sel:[0,1,0] op_sel_hi:[1,1,0]
    v_pk_fma_f32 v[228:229], v[228:229], v[190:191], v[190:191] op_sel:[0,1,0] op_sel_hi:[1,1,0]
    v_pk_mul_f32 v[226:227], v[226:227], v[108:109]
    v_pk_mul_f32 v[228:229], v[228:229], v[110:111]
    v_exp_f32 v226, v226
    v_exp_f32 v227, v227
    v_exp_f32 v228, v228
    v_exp_f32 v229, v229
    v_pk_fma_f32 v[226:227], v[226:227], v[170:171], v[170:171] op_sel:[0,1,1] op_sel_hi:[1,1,1]
    v_pk_fma_f32 v[228:229], v[228:229], v[170:171], v[170:171] op_sel:[0,1,1] op_sel_hi:[1,1,1]
    v_rcp_f32 v226, v226
    v_rcp_f32 v227, v227
    v_rcp_f32 v228, v228
    v_rcp_f32 v229, v229
    v_pk_mul_f32 v[108:109], v[108:109], v[226:227]
    v_pk_mul_f32 v[110:111], v[110:111], v[228:229]
    v_pk_fma_f32 v[112:113], v[170:171], v[140:141], v[112:113] op_sel_hi:[0,1,1] neg_lo:[1,0,0] neg_hi:[1,0,0]
    v_pk_fma_f32 v[114:115], v[170:171], v[142:143], v[114:115] op_sel_hi:[0,1,1] neg_lo:[1,0,0] neg_hi:[1,0,0]
    v_pk_mul_f32 v[226:227], v[112:113], v[112:113]
    v_pk_mul_f32 v[228:229], v[114:115], v[114:115]
    v_pk_fma_f32 v[226:227], v[226:227], v[190:191], v[190:191] op_sel:[0,1,0] op_sel_hi:[1,1,0]
    v_pk_fma_f32 v[228:229], v[228:229], v[190:191], v[190:191] op_sel:[0,1,0] op_sel_hi:[1,1,0]
    v_pk_mul_f32 v[226:227], v[226:227], v[112:113]
    v_pk_mul_f32 v[228:229], v[228:229], v[114:115]
    v_exp_f32 v226, v226
    v_exp_f32 v227, v227
    v_exp_f32 v228, v228
    v_exp_f32 v229, v229
    v_pk_fma_f32 v[226:227], v[226:227], v[170:171], v[170:171] op_sel:[0,1,1] op_sel_hi:[1,1,1]
    v_pk_fma_f32 v[228:229], v[228:229], v[170:171], v[170:171] op_sel:[0,1,1] op_sel_hi:[1,1,1]
    v_rcp_f32 v226, v226
    v_rcp_f32 v227, v227
    v_rcp_f32 v228, v228
    v_rcp_f32 v229, v229
    v_pk_mul_f32 v[112:113], v[112:113], v[226:227]
    v_pk_mul_f32 v[114:115], v[114:115], v[228:229]
    v_cvt_pk_bf16_f32 v108, v108, v109
    v_cvt_pk_bf16_f32 v109, v110, v111
    v_cvt_pk_bf16_f32 v110, v112, v113
    v_cvt_pk_bf16_f32 v111, v114, v115
    ds_write_b128 v12, v[108:111] offset:6144
    s_add_u32 s36, s44, 688128
    buffer_store_dwordx4 v[108:111], v2, s[16:19], s36 offen sc1
    v_pk_fma_f32 v[32:33], v[164:165], v[144:145], v[32:33] op_sel_hi:[0,1,1] neg_lo:[1,0,0] neg_hi:[1,0,0]
    v_pk_fma_f32 v[34:35], v[164:165], v[146:147], v[34:35] op_sel_hi:[0,1,1] neg_lo:[1,0,0] neg_hi:[1,0,0]
    v_pk_mul_f32 v[226:227], v[32:33], v[32:33]
    v_pk_mul_f32 v[228:229], v[34:35], v[34:35]
    v_pk_fma_f32 v[226:227], v[226:227], v[184:185], v[184:185] op_sel:[0,1,0] op_sel_hi:[1,1,0]
    v_pk_fma_f32 v[228:229], v[228:229], v[184:185], v[184:185] op_sel:[0,1,0] op_sel_hi:[1,1,0]
    v_pk_mul_f32 v[226:227], v[226:227], v[32:33]
    v_pk_mul_f32 v[228:229], v[228:229], v[34:35]
    v_exp_f32 v226, v226
    v_exp_f32 v227, v227
    v_exp_f32 v228, v228
    v_exp_f32 v229, v229
    v_pk_fma_f32 v[226:227], v[226:227], v[164:165], v[164:165] op_sel:[0,1,1] op_sel_hi:[1,1,1]
    v_pk_fma_f32 v[228:229], v[228:229], v[164:165], v[164:165] op_sel:[0,1,1] op_sel_hi:[1,1,1]
    v_rcp_f32 v226, v226
    v_rcp_f32 v227, v227
    v_rcp_f32 v228, v228
    v_rcp_f32 v229, v229
    v_pk_mul_f32 v[32:33], v[32:33], v[226:227]
    v_pk_mul_f32 v[34:35], v[34:35], v[228:229]
    v_pk_fma_f32 v[36:37], v[164:165], v[148:149], v[36:37] op_sel_hi:[0,1,1] neg_lo:[1,0,0] neg_hi:[1,0,0]
    v_pk_fma_f32 v[38:39], v[164:165], v[150:151], v[38:39] op_sel_hi:[0,1,1] neg_lo:[1,0,0] neg_hi:[1,0,0]
    v_pk_mul_f32 v[226:227], v[36:37], v[36:37]
    v_pk_mul_f32 v[228:229], v[38:39], v[38:39]
    v_pk_fma_f32 v[226:227], v[226:227], v[184:185], v[184:185] op_sel:[0,1,0] op_sel_hi:[1,1,0]
    v_pk_fma_f32 v[228:229], v[228:229], v[184:185], v[184:185] op_sel:[0,1,0] op_sel_hi:[1,1,0]
    v_pk_mul_f32 v[226:227], v[226:227], v[36:37]
    v_pk_mul_f32 v[228:229], v[228:229], v[38:39]
    v_exp_f32 v226, v226
    v_exp_f32 v227, v227
    v_exp_f32 v228, v228
    v_exp_f32 v229, v229
    v_pk_fma_f32 v[226:227], v[226:227], v[164:165], v[164:165] op_sel:[0,1,1] op_sel_hi:[1,1,1]
    v_pk_fma_f32 v[228:229], v[228:229], v[164:165], v[164:165] op_sel:[0,1,1] op_sel_hi:[1,1,1]
    v_rcp_f32 v226, v226
    v_rcp_f32 v227, v227
    v_rcp_f32 v228, v228
    v_rcp_f32 v229, v229
    v_pk_mul_f32 v[36:37], v[36:37], v[226:227]
    v_pk_mul_f32 v[38:39], v[38:39], v[228:229]
    v_cvt_pk_bf16_f32 v32, v32, v33
    v_cvt_pk_bf16_f32 v33, v34, v35
    v_cvt_pk_bf16_f32 v34, v36, v37
    v_cvt_pk_bf16_f32 v35, v38, v39
    ds_write_b128 v12, v[32:35] offset:16384
    s_add_u32 s53, s55, 1792
    s_lshl_b32 s54, s31, 7
    s_add_u32 s53, s53, s54
    v_mov_b32 v8, 1
    v_mov_b32 v9, 162864
    v_mov_b32 v11, 0
    s_mov_b64 exec, 1
    s_waitcnt vmcnt(0)
    ds_add_rtn_u32 v10, v9, v8
    s_waitcnt lgkmcnt(0)
    v_readfirstlane_b32 s54, v10
    s_nop 0
    s_and_b32 s54, s54, 3
    s_cmp_lg_u32 s54, 3
    s_cbranch_scc1 pub_32
    buffer_atomic_add v8, v11, s[56:59], s53 offen sc1
    v_mov_b32 v9, 162872
    ds_add_u32 v9, v8
pub_32:
    s_mov_b64 exec, -1
    v_pk_fma_f32 v[60:61], v[166:167], v[144:145], v[60:61] op_sel_hi:[0,1,1] neg_lo:[1,0,0] neg_hi:[1,0,0]
    v_pk_fma_f32 v[62:63], v[166:167], v[146:147], v[62:63] op_sel_hi:[0,1,1] neg_lo:[1,0,0] neg_hi:[1,0,0]
    v_pk_mul_f32 v[226:227], v[60:61], v[60:61]
    v_pk_mul_f32 v[228:229], v[62:63], v[62:63]
    v_pk_fma_f32 v[226:227], v[226:227], v[186:187], v[186:187] op_sel:[0,1,0] op_sel_hi:[1,1,0]
    v_pk_fma_f32 v[228:229], v[228:229], v[186:187], v[186:187] op_sel:[0,1,0] op_sel_hi:[1,1,0]
    v_pk_mul_f32 v[226:227], v[226:227], v[60:61]
    v_pk_mul_f32 v[228:229], v[228:229], v[62:63]
    v_exp_f32 v226, v226
    v_exp_f32 v227, v227
    v_exp_f32 v228, v228
    v_exp_f32 v229, v229
    v_pk_fma_f32 v[226:227], v[226:227], v[166:167], v[166:167] op_sel:[0,1,1] op_sel_hi:[1,1,1]
    v_pk_fma_f32 v[228:229], v[228:229], v[166:167], v[166:167] op_sel:[0,1,1] op_sel_hi:[1,1,1]
    v_rcp_f32 v226, v226
    v_rcp_f32 v227, v227
    v_rcp_f32 v228, v228
    v_rcp_f32 v229, v229
    v_pk_mul_f32 v[60:61], v[60:61], v[226:227]
    v_pk_mul_f32 v[62:63], v[62:63], v[228:229]
    v_pk_fma_f32 v[64:65], v[166:167], v[148:149], v[64:65] op_sel_hi:[0,1,1] neg_lo:[1,0,0] neg_hi:[1,0,0]
    v_pk_fma_f32 v[66:67], v[166:167], v[150:151], v[66:67] op_sel_hi:[0,1,1] neg_lo:[1,0,0] neg_hi:[1,0,0]
    v_pk_mul_f32 v[226:227], v[64:65], v[64:65]
    v_pk_mul_f32 v[228:229], v[66:67], v[66:67]
    v_pk_fma_f32 v[226:227], v[226:227], v[186:187], v[186:187] op_sel:[0,1,0] op_sel_hi:[1,1,0]
    v_pk_fma_f32 v[228:229], v[228:229], v[186:187], v[186:187] op_sel:[0,1,0] op_sel_hi:[1,1,0]
    v_pk_mul_f32 v[226:227], v[226:227], v[64:65]
    v_pk_mul_f32 v[228:229], v[228:229], v[66:67]
    v_exp_f32 v226, v226
    v_exp_f32 v227, v227
    v_exp_f32 v228, v228
    v_exp_f32 v229, v229
    v_pk_fma_f32 v[226:227], v[226:227], v[166:167], v[166:167] op_sel:[0,1,1] op_sel_hi:[1,1,1]
    v_pk_fma_f32 v[228:229], v[228:229], v[166:167], v[166:167] op_sel:[0,1,1] op_sel_hi:[1,1,1]
    v_rcp_f32 v226, v226
    v_rcp_f32 v227, v227
    v_rcp_f32 v228, v228
    v_rcp_f32 v229, v229
    v_pk_mul_f32 v[64:65], v[64:65], v[226:227]
    v_pk_mul_f32 v[66:67], v[66:67], v[228:229]
    v_cvt_pk_bf16_f32 v60, v60, v61
    v_cvt_pk_bf16_f32 v61, v62, v63
    v_cvt_pk_bf16_f32 v62, v64, v65
    v_cvt_pk_bf16_f32 v63, v66, v67
    ds_write_b128 v12, v[60:63] offset:18432
    v_pk_fma_f32 v[88:89], v[168:169], v[144:145], v[88:89] op_sel_hi:[0,1,1] neg_lo:[1,0,0] neg_hi:[1,0,0]
    v_pk_fma_f32 v[90:91], v[168:169], v[146:147], v[90:91] op_sel_hi:[0,1,1] neg_lo:[1,0,0] neg_hi:[1,0,0]
    v_pk_mul_f32 v[226:227], v[88:89], v[88:89]
    v_pk_mul_f32 v[228:229], v[90:91], v[90:91]
    v_pk_fma_f32 v[226:227], v[226:227], v[188:189], v[188:189] op_sel:[0,1,0] op_sel_hi:[1,1,0]
    v_pk_fma_f32 v[228:229], v[228:229], v[188:189], v[188:189] op_sel:[0,1,0] op_sel_hi:[1,1,0]
    v_pk_mul_f32 v[226:227], v[226:227], v[88:89]
    v_pk_mul_f32 v[228:229], v[228:229], v[90:91]
    v_exp_f32 v226, v226
    v_exp_f32 v227, v227
    v_exp_f32 v228, v228
    v_exp_f32 v229, v229
    v_pk_fma_f32 v[226:227], v[226:227], v[168:169], v[168:169] op_sel:[0,1,1] op_sel_hi:[1,1,1]
    v_pk_fma_f32 v[228:229], v[228:229], v[168:169], v[168:169] op_sel:[0,1,1] op_sel_hi:[1,1,1]
    v_rcp_f32 v226, v226
    v_rcp_f32 v227, v227
    v_rcp_f32 v228, v228
    v_rcp_f32 v229, v229
    v_pk_mul_f32 v[88:89], v[88:89], v[226:227]
    v_pk_mul_f32 v[90:91], v[90:91], v[228:229]
    v_pk_fma_f32 v[92:93], v[168:169], v[148:149], v[92:93] op_sel_hi:[0,1,1] neg_lo:[1,0,0] neg_hi:[1,0,0]
    v_pk_fma_f32 v[94:95], v[168:169], v[150:151], v[94:95] op_sel_hi:[0,1,1] neg_lo:[1,0,0] neg_hi:[1,0,0]
    v_pk_mul_f32 v[226:227], v[92:93], v[92:93]
    v_pk_mul_f32 v[228:229], v[94:95], v[94:95]
    v_pk_fma_f32 v[226:227], v[226:227], v[188:189], v[188:189] op_sel:[0,1,0] op_sel_hi:[1,1,0]
    v_pk_fma_f32 v[228:229], v[228:229], v[188:189], v[188:189] op_sel:[0,1,0] op_sel_hi:[1,1,0]
    v_pk_mul_f32 v[226:227], v[226:227], v[92:93]
    v_pk_mul_f32 v[228:229], v[228:229], v[94:95]
    v_exp_f32 v226, v226
    v_exp_f32 v227, v227
    v_exp_f32 v228, v228
    v_exp_f32 v229, v229
    v_pk_fma_f32 v[226:227], v[226:227], v[168:169], v[168:169] op_sel:[0,1,1] op_sel_hi:[1,1,1]
    v_pk_fma_f32 v[228:229], v[228:229], v[168:169], v[168:169] op_sel:[0,1,1] op_sel_hi:[1,1,1]
    v_rcp_f32 v226, v226
    v_rcp_f32 v227, v227
    v_rcp_f32 v228, v228
    v_rcp_f32 v229, v229
    v_pk_mul_f32 v[92:93], v[92:93], v[226:227]
    v_pk_mul_f32 v[94:95], v[94:95], v[228:229]
    v_cvt_pk_bf16_f32 v88, v88, v89
    v_cvt_pk_bf16_f32 v89, v90, v91
    v_cvt_pk_bf16_f32 v90, v92, v93
    v_cvt_pk_bf16_f32 v91, v94, v95
    ds_write_b128 v12, v[88:91] offset:20480
    v_pk_fma_f32 v[116:117], v[170:171], v[144:145], v[116:117] op_sel_hi:[0,1,1] neg_lo:[1,0,0] neg_hi:[1,0,0]
    v_pk_fma_f32 v[118:119], v[170:171], v[146:147], v[118:119] op_sel_hi:[0,1,1] neg_lo:[1,0,0] neg_hi:[1,0,0]
    v_pk_mul_f32 v[226:227], v[116:117], v[116:117]
    v_pk_mul_f32 v[228:229], v[118:119], v[118:119]
    v_pk_fma_f32 v[226:227], v[226:227], v[190:191], v[190:191] op_sel:[0,1,0] op_sel_hi:[1,1,0]
    v_pk_fma_f32 v[228:229], v[228:229], v[190:191], v[190:191] op_sel:[0,1,0] op_sel_hi:[1,1,0]
    v_pk_mul_f32 v[226:227], v[226:227], v[116:117]
    v_pk_mul_f32 v[228:229], v[228:229], v[118:119]
    v_exp_f32 v226, v226
    v_exp_f32 v227, v227
    v_exp_f32 v228, v228
    v_exp_f32 v229, v229
    v_pk_fma_f32 v[226:227], v[226:227], v[170:171], v[170:171] op_sel:[0,1,1] op_sel_hi:[1,1,1]
    v_pk_fma_f32 v[228:229], v[228:229], v[170:171], v[170:171] op_sel:[0,1,1] op_sel_hi:[1,1,1]
    v_rcp_f32 v226, v226
    v_rcp_f32 v227, v227
    v_rcp_f32 v228, v228
    v_rcp_f32 v229, v229
    v_pk_mul_f32 v[116:117], v[116:117], v[226:227]
    v_pk_mul_f32 v[118:119], v[118:119], v[228:229]
    v_pk_fma_f32 v[120:121], v[170:171], v[148:149], v[120:121] op_sel_hi:[0,1,1] neg_lo:[1,0,0] neg_hi:[1,0,0]
    v_pk_fma_f32 v[122:123], v[170:171], v[150:151], v[122:123] op_sel_hi:[0,1,1] neg_lo:[1,0,0] neg_hi:[1,0,0]
    v_pk_mul_f32 v[226:227], v[120:121], v[120:121]
    v_pk_mul_f32 v[228:229], v[122:123], v[122:123]
    v_pk_fma_f32 v[226:227], v[226:227], v[190:191], v[190:191] op_sel:[0,1,0] op_sel_hi:[1,1,0]
    v_pk_fma_f32 v[228:229], v[228:229], v[190:191], v[190:191] op_sel:[0,1,0] op_sel_hi:[1,1,0]
    v_pk_mul_f32 v[226:227], v[226:227], v[120:121]
    v_pk_mul_f32 v[228:229], v[228:229], v[122:123]
    v_exp_f32 v226, v226
    v_exp_f32 v227, v227
    v_exp_f32 v228, v228
    v_exp_f32 v229, v229
    v_pk_fma_f32 v[226:227], v[226:227], v[170:171], v[170:171] op_sel:[0,1,1] op_sel_hi:[1,1,1]
    v_pk_fma_f32 v[228:229], v[228:229], v[170:171], v[170:171] op_sel:[0,1,1] op_sel_hi:[1,1,1]
    v_rcp_f32 v226, v226
    v_rcp_f32 v227, v227
    v_rcp_f32 v228, v228
    v_rcp_f32 v229, v229
    v_pk_mul_f32 v[120:121], v[120:121], v[226:227]
    v_pk_mul_f32 v[122:123], v[122:123], v[228:229]
    v_cvt_pk_bf16_f32 v116, v116, v117
    v_cvt_pk_bf16_f32 v117, v118, v119
    v_cvt_pk_bf16_f32 v118, v120, v121
    v_cvt_pk_bf16_f32 v119, v122, v123
    ds_write_b128 v12, v[116:119] offset:22528
    v_pk_fma_f32 v[40:41], v[164:165], v[152:153], v[40:41] op_sel_hi:[0,1,1] neg_lo:[1,0,0] neg_hi:[1,0,0]
    v_pk_fma_f32 v[42:43], v[164:165], v[154:155], v[42:43] op_sel_hi:[0,1,1] neg_lo:[1,0,0] neg_hi:[1,0,0]
    v_pk_mul_f32 v[226:227], v[40:41], v[40:41]
    v_pk_mul_f32 v[228:229], v[42:43], v[42:43]
    v_pk_fma_f32 v[226:227], v[226:227], v[184:185], v[184:185] op_sel:[0,1,0] op_sel_hi:[1,1,0]
    v_pk_fma_f32 v[228:229], v[228:229], v[184:185], v[184:185] op_sel:[0,1,0] op_sel_hi:[1,1,0]
    v_pk_mul_f32 v[226:227], v[226:227], v[40:41]
    v_pk_mul_f32 v[228:229], v[228:229], v[42:43]
    v_exp_f32 v226, v226
    v_exp_f32 v227, v227
    v_exp_f32 v228, v228
    v_exp_f32 v229, v229
    v_pk_fma_f32 v[226:227], v[226:227], v[164:165], v[164:165] op_sel:[0,1,1] op_sel_hi:[1,1,1]
    v_pk_fma_f32 v[228:229], v[228:229], v[164:165], v[164:165] op_sel:[0,1,1] op_sel_hi:[1,1,1]
    v_rcp_f32 v226, v226
    v_rcp_f32 v227, v227
    v_rcp_f32 v228, v228
    v_rcp_f32 v229, v229
    v_pk_mul_f32 v[40:41], v[40:41], v[226:227]
    v_pk_mul_f32 v[42:43], v[42:43], v[228:229]
    v_pk_fma_f32 v[44:45], v[164:165], v[156:157], v[44:45] op_sel_hi:[0,1,1] neg_lo:[1,0,0] neg_hi:[1,0,0]
    v_pk_fma_f32 v[46:47], v[164:165], v[158:159], v[46:47] op_sel_hi:[0,1,1] neg_lo:[1,0,0] neg_hi:[1,0,0]
    v_pk_mul_f32 v[226:227], v[44:45], v[44:45]
    v_pk_mul_f32 v[228:229], v[46:47], v[46:47]
    v_pk_fma_f32 v[226:227], v[226:227], v[184:185], v[184:185] op_sel:[0,1,0] op_sel_hi:[1,1,0]
    v_pk_fma_f32 v[228:229], v[228:229], v[184:185], v[184:185] op_sel:[0,1,0] op_sel_hi:[1,1,0]
    v_pk_mul_f32 v[226:227], v[226:227], v[44:45]
    v_pk_mul_f32 v[228:229], v[228:229], v[46:47]
    v_exp_f32 v226, v226
    v_exp_f32 v227, v227
    v_exp_f32 v228, v228
    v_exp_f32 v229, v229
    v_pk_fma_f32 v[226:227], v[226:227], v[164:165], v[164:165] op_sel:[0,1,1] op_sel_hi:[1,1,1]
    v_pk_fma_f32 v[228:229], v[228:229], v[164:165], v[164:165] op_sel:[0,1,1] op_sel_hi:[1,1,1]
    v_rcp_f32 v226, v226
    v_rcp_f32 v227, v227
    v_rcp_f32 v228, v228
    v_rcp_f32 v229, v229
    v_pk_mul_f32 v[44:45], v[44:45], v[226:227]
    v_pk_mul_f32 v[46:47], v[46:47], v[228:229]
    v_cvt_pk_bf16_f32 v230, v40, v41
    v_cvt_pk_bf16_f32 v231, v42, v43
    v_cvt_pk_bf16_f32 v232, v44, v45
    v_cvt_pk_bf16_f32 v233, v46, v47
    ds_write_b128 v12, v[230:233] offset:32768
    v_pk_fma_f32 v[68:69], v[166:167], v[152:153], v[68:69] op_sel_hi:[0,1,1] neg_lo:[1,0,0] neg_hi:[1,0,0]
    v_pk_fma_f32 v[70:71], v[166:167], v[154:155], v[70:71] op_sel_hi:[0,1,1] neg_lo:[1,0,0] neg_hi:[1,0,0]
    v_pk_mul_f32 v[226:227], v[68:69], v[68:69]
    v_pk_mul_f32 v[228:229], v[70:71], v[70:71]
    v_pk_fma_f32 v[226:227], v[226:227], v[186:187], v[186:187] op_sel:[0,1,0] op_sel_hi:[1,1,0]
    v_pk_fma_f32 v[228:229], v[228:229], v[186:187], v[186:187] op_sel:[0,1,0] op_sel_hi:[1,1,0]
    v_pk_mul_f32 v[226:227], v[226:227], v[68:69]
    v_pk_mul_f32 v[228:229], v[228:229], v[70:71]
    v_exp_f32 v226, v226
    v_exp_f32 v227, v227
    v_exp_f32 v228, v228
    v_exp_f32 v229, v229
    v_pk_fma_f32 v[226:227], v[226:227], v[166:167], v[166:167] op_sel:[0,1,1] op_sel_hi:[1,1,1]
    v_pk_fma_f32 v[228:229], v[228:229], v[166:167], v[166:167] op_sel:[0,1,1] op_sel_hi:[1,1,1]
    v_rcp_f32 v226, v226
    v_rcp_f32 v227, v227
    v_rcp_f32 v228, v228
    v_rcp_f32 v229, v229
    v_pk_mul_f32 v[68:69], v[68:69], v[226:227]
    v_pk_mul_f32 v[70:71], v[70:71], v[228:229]
    v_pk_fma_f32 v[72:73], v[166:167], v[156:157], v[72:73] op_sel_hi:[0,1,1] neg_lo:[1,0,0] neg_hi:[1,0,0]
    v_pk_fma_f32 v[74:75], v[166:167], v[158:159], v[74:75] op_sel_hi:[0,1,1] neg_lo:[1,0,0] neg_hi:[1,0,0]
    v_pk_mul_f32 v[226:227], v[72:73], v[72:73]
    v_pk_mul_f32 v[228:229], v[74:75], v[74:75]
    v_pk_fma_f32 v[226:227], v[226:227], v[186:187], v[186:187] op_sel:[0,1,0] op_sel_hi:[1,1,0]
    v_pk_fma_f32 v[228:229], v[228:229], v[186:187], v[186:187] op_sel:[0,1,0] op_sel_hi:[1,1,0]
    v_pk_mul_f32 v[226:227], v[226:227], v[72:73]
    v_pk_mul_f32 v[228:229], v[228:229], v[74:75]
    v_exp_f32 v226, v226
    v_exp_f32 v227, v227
    v_exp_f32 v228, v228
    v_exp_f32 v229, v229
    v_pk_fma_f32 v[226:227], v[226:227], v[166:167], v[166:167] op_sel:[0,1,1] op_sel_hi:[1,1,1]
    v_pk_fma_f32 v[228:229], v[228:229], v[166:167], v[166:167] op_sel:[0,1,1] op_sel_hi:[1,1,1]
    v_rcp_f32 v226, v226
    v_rcp_f32 v227, v227
    v_rcp_f32 v228, v228
    v_rcp_f32 v229, v229
    v_pk_mul_f32 v[72:73], v[72:73], v[226:227]
    v_pk_mul_f32 v[74:75], v[74:75], v[228:229]
    v_cvt_pk_bf16_f32 v234, v68, v69
    v_cvt_pk_bf16_f32 v235, v70, v71
    v_cvt_pk_bf16_f32 v236, v72, v73
    v_cvt_pk_bf16_f32 v237, v74, v75
    ds_write_b128 v12, v[234:237] offset:34816
    v_pk_fma_f32 v[96:97], v[168:169], v[152:153], v[96:97] op_sel_hi:[0,1,1] neg_lo:[1,0,0] neg_hi:[1,0,0]
    v_pk_fma_f32 v[98:99], v[168:169], v[154:155], v[98:99] op_sel_hi:[0,1,1] neg_lo:[1,0,0] neg_hi:[1,0,0]
    v_pk_mul_f32 v[226:227], v[96:97], v[96:97]
    v_pk_mul_f32 v[228:229], v[98:99], v[98:99]
    v_pk_fma_f32 v[226:227], v[226:227], v[188:189], v[188:189] op_sel:[0,1,0] op_sel_hi:[1,1,0]
    v_pk_fma_f32 v[228:229], v[228:229], v[188:189], v[188:189] op_sel:[0,1,0] op_sel_hi:[1,1,0]
    v_pk_mul_f32 v[226:227], v[226:227], v[96:97]
    v_pk_mul_f32 v[228:229], v[228:229], v[98:99]
    v_exp_f32 v226, v226
    v_exp_f32 v227, v227
    v_exp_f32 v228, v228
    v_exp_f32 v229, v229
    v_pk_fma_f32 v[226:227], v[226:227], v[168:169], v[168:169] op_sel:[0,1,1] op_sel_hi:[1,1,1]
    v_pk_fma_f32 v[228:229], v[228:229], v[168:169], v[168:169] op_sel:[0,1,1] op_sel_hi:[1,1,1]
    v_rcp_f32 v226, v226
    v_rcp_f32 v227, v227
    v_rcp_f32 v228, v228
    v_rcp_f32 v229, v229
    v_pk_mul_f32 v[96:97], v[96:97], v[226:227]
    v_pk_mul_f32 v[98:99], v[98:99], v[228:229]
    v_pk_fma_f32 v[100:101], v[168:169], v[156:157], v[100:101] op_sel_hi:[0,1,1] neg_lo:[1,0,0] neg_hi:[1,0,0]
    v_pk_fma_f32 v[102:103], v[168:169], v[158:159], v[102:103] op_sel_hi:[0,1,1] neg_lo:[1,0,0] neg_hi:[1,0,0]
    v_pk_mul_f32 v[226:227], v[100:101], v[100:101]
    v_pk_mul_f32 v[228:229], v[102:103], v[102:103]
    v_pk_fma_f32 v[226:227], v[226:227], v[188:189], v[188:189] op_sel:[0,1,0] op_sel_hi:[1,1,0]
    v_pk_fma_f32 v[228:229], v[228:229], v[188:189], v[188:189] op_sel:[0,1,0] op_sel_hi:[1,1,0]
    v_pk_mul_f32 v[226:227], v[226:227], v[100:101]
    v_pk_mul_f32 v[228:229], v[228:229], v[102:103]
    v_exp_f32 v226, v226
    v_exp_f32 v227, v227
    v_exp_f32 v228, v228
    v_exp_f32 v229, v229
    v_pk_fma_f32 v[226:227], v[226:227], v[168:169], v[168:169] op_sel:[0,1,1] op_sel_hi:[1,1,1]
    v_pk_fma_f32 v[228:229], v[228:229], v[168:169], v[168:169] op_sel:[0,1,1] op_sel_hi:[1,1,1]
    v_rcp_f32 v226, v226
    v_rcp_f32 v227, v227
    v_rcp_f32 v228, v228
    v_rcp_f32 v229, v229
    v_pk_mul_f32 v[100:101], v[100:101], v[226:227]
    v_pk_mul_f32 v[102:103], v[102:103], v[228:229]
    v_cvt_pk_bf16_f32 v238, v96, v97
    v_cvt_pk_bf16_f32 v239, v98, v99
    v_cvt_pk_bf16_f32 v240, v100, v101
    v_cvt_pk_bf16_f32 v241, v102, v103
    ds_write_b128 v12, v[238:241] offset:36864
    v_pk_fma_f32 v[124:125], v[170:171], v[152:153], v[124:125] op_sel_hi:[0,1,1] neg_lo:[1,0,0] neg_hi:[1,0,0]
    v_pk_fma_f32 v[126:127], v[170:171], v[154:155], v[126:127] op_sel_hi:[0,1,1] neg_lo:[1,0,0] neg_hi:[1,0,0]
    v_pk_mul_f32 v[226:227], v[124:125], v[124:125]
    v_pk_mul_f32 v[228:229], v[126:127], v[126:127]
    v_pk_fma_f32 v[226:227], v[226:227], v[190:191], v[190:191] op_sel:[0,1,0] op_sel_hi:[1,1,0]
    v_pk_fma_f32 v[228:229], v[228:229], v[190:191], v[190:191] op_sel:[0,1,0] op_sel_hi:[1,1,0]
    v_pk_mul_f32 v[226:227], v[226:227], v[124:125]
    v_pk_mul_f32 v[228:229], v[228:229], v[126:127]
    v_exp_f32 v226, v226
    v_exp_f32 v227, v227
    v_exp_f32 v228, v228
    v_exp_f32 v229, v229
    v_pk_fma_f32 v[226:227], v[226:227], v[170:171], v[170:171] op_sel:[0,1,1] op_sel_hi:[1,1,1]
    v_pk_fma_f32 v[228:229], v[228:229], v[170:171], v[170:171] op_sel:[0,1,1] op_sel_hi:[1,1,1]
    v_rcp_f32 v226, v226
    v_rcp_f32 v227, v227
    v_rcp_f32 v228, v228
    v_rcp_f32 v229, v229
    v_pk_mul_f32 v[124:125], v[124:125], v[226:227]
    v_pk_mul_f32 v[126:127], v[126:127], v[228:229]
    v_pk_fma_f32 v[128:129], v[170:171], v[156:157], v[128:129] op_sel_hi:[0,1,1] neg_lo:[1,0,0] neg_hi:[1,0,0]
    v_pk_fma_f32 v[130:131], v[170:171], v[158:159], v[130:131] op_sel_hi:[0,1,1] neg_lo:[1,0,0] neg_hi:[1,0,0]
    v_pk_mul_f32 v[226:227], v[128:129], v[128:129]
    v_pk_mul_f32 v[228:229], v[130:131], v[130:131]
    v_pk_fma_f32 v[226:227], v[226:227], v[190:191], v[190:191] op_sel:[0,1,0] op_sel_hi:[1,1,0]
    v_pk_fma_f32 v[228:229], v[228:229], v[190:191], v[190:191] op_sel:[0,1,0] op_sel_hi:[1,1,0]
    v_pk_mul_f32 v[226:227], v[226:227], v[128:129]
    v_pk_mul_f32 v[228:229], v[228:229], v[130:131]
    v_exp_f32 v226, v226
    v_exp_f32 v227, v227
    v_exp_f32 v228, v228
    v_exp_f32 v229, v229
    v_pk_fma_f32 v[226:227], v[226:227], v[170:171], v[170:171] op_sel:[0,1,1] op_sel_hi:[1,1,1]
    v_pk_fma_f32 v[228:229], v[228:229], v[170:171], v[170:171] op_sel:[0,1,1] op_sel_hi:[1,1,1]
    v_rcp_f32 v226, v226
    v_rcp_f32 v227, v227
    v_rcp_f32 v228, v228
    v_rcp_f32 v229, v229
    v_pk_mul_f32 v[128:129], v[128:129], v[226:227]
    v_pk_mul_f32 v[130:131], v[130:131], v[228:229]
    v_cvt_pk_bf16_f32 v242, v124, v125
    v_cvt_pk_bf16_f32 v243, v126, v127
    v_cvt_pk_bf16_f32 v244, v128, v129
    v_cvt_pk_bf16_f32 v245, v130, v131
    ds_write_b128 v12, v[242:245] offset:38912
    v_pk_fma_f32 v[48:49], v[164:165], v[160:161], v[48:49] op_sel_hi:[0,1,1] neg_lo:[1,0,0] neg_hi:[1,0,0]
    v_pk_fma_f32 v[50:51], v[164:165], v[162:163], v[50:51] op_sel_hi:[0,1,1] neg_lo:[1,0,0] neg_hi:[1,0,0]
    v_pk_mul_f32 v[226:227], v[48:49], v[48:49]
    v_pk_mul_f32 v[228:229], v[50:51], v[50:51]
    v_pk_fma_f32 v[226:227], v[226:227], v[184:185], v[184:185] op_sel:[0,1,0] op_sel_hi:[1,1,0]
    v_pk_fma_f32 v[228:229], v[228:229], v[184:185], v[184:185] op_sel:[0,1,0] op_sel_hi:[1,1,0]
    v_pk_mul_f32 v[226:227], v[226:227], v[48:49]
    v_pk_mul_f32 v[228:229], v[228:229], v[50:51]
    v_exp_f32 v226, v226
    v_exp_f32 v227, v227
    v_exp_f32 v228, v228
    v_exp_f32 v229, v229
    v_pk_fma_f32 v[226:227], v[226:227], v[164:165], v[164:165] op_sel:[0,1,1] op_sel_hi:[1,1,1]
    v_pk_fma_f32 v[228:229], v[228:229], v[164:165], v[164:165] op_sel:[0,1,1] op_sel_hi:[1,1,1]
    v_rcp_f32 v226, v226
    v_rcp_f32 v227, v227
    v_rcp_f32 v228, v228
    v_rcp_f32 v229, v229
    v_pk_mul_f32 v[48:49], v[48:49], v[226:227]
    v_pk_mul_f32 v[50:51], v[50:51], v[228:229]
    v_cvt_pk_bf16_f32 v246, v48, v49
    v_cvt_pk_bf16_f32 v247, v50, v51
    s_add_u32 s36, s45, 0
    buffer_store_dwordx4 v[32:35], v2, s[16:19], s36 offen sc1
    v_pk_fma_f32 v[76:77], v[166:167], v[160:161], v[76:77] op_sel_hi:[0,1,1] neg_lo:[1,0,0] neg_hi:[1,0,0]
    v_pk_fma_f32 v[78:79], v[166:167], v[162:163], v[78:79] op_sel_hi:[0,1,1] neg_lo:[1,0,0] neg_hi:[1,0,0]
    v_pk_mul_f32 v[226:227], v[76:77], v[76:77]
    v_pk_mul_f32 v[228:229], v[78:79], v[78:79]
    v_pk_fma_f32 v[226:227], v[226:227], v[186:187], v[186:187] op_sel:[0,1,0] op_sel_hi:[1,1,0]
    v_pk_fma_f32 v[228:229], v[228:229], v[186:187], v[186:187] op_sel:[0,1,0] op_sel_hi:[1,1,0]
    v_pk_mul_f32 v[226:227], v[226:227], v[76:77]
    v_pk_mul_f32 v[228:229], v[228:229], v[78:79]
    v_exp_f32 v226, v226
    v_exp_f32 v227, v227
    v_exp_f32 v228, v228
    v_exp_f32 v229, v229
    v_pk_fma_f32 v[226:227], v[226:227], v[166:167], v[166:167] op_sel:[0,1,1] op_sel_hi:[1,1,1]
    v_pk_fma_f32 v[228:229], v[228:229], v[166:167], v[166:167] op_sel:[0,1,1] op_sel_hi:[1,1,1]
    v_rcp_f32 v226, v226
    v_rcp_f32 v227, v227
    v_rcp_f32 v228, v228
    v_rcp_f32 v229, v229
    v_pk_mul_f32 v[76:77], v[76:77], v[226:227]
    v_pk_mul_f32 v[78:79], v[78:79], v[228:229]
    v_cvt_pk_bf16_f32 v248, v76, v77
    v_cvt_pk_bf16_f32 v249, v78, v79
    s_add_u32 s36, s45, 229376
    buffer_store_dwordx4 v[60:63], v2, s[16:19], s36 offen sc1
    v_pk_fma_f32 v[104:105], v[168:169], v[160:161], v[104:105] op_sel_hi:[0,1,1] neg_lo:[1,0,0] neg_hi:[1,0,0]
    v_pk_fma_f32 v[106:107], v[168:169], v[162:163], v[106:107] op_sel_hi:[0,1,1] neg_lo:[1,0,0] neg_hi:[1,0,0]
    v_pk_mul_f32 v[226:227], v[104:105], v[104:105]
    v_pk_mul_f32 v[228:229], v[106:107], v[106:107]
    v_pk_fma_f32 v[226:227], v[226:227], v[188:189], v[188:189] op_sel:[0,1,0] op_sel_hi:[1,1,0]
    v_pk_fma_f32 v[228:229], v[228:229], v[188:189], v[188:189] op_sel:[0,1,0] op_sel_hi:[1,1,0]
    v_pk_mul_f32 v[226:227], v[226:227], v[104:105]
    v_pk_mul_f32 v[228:229], v[228:229], v[106:107]
    v_exp_f32 v226, v226
    v_exp_f32 v227, v227
    v_exp_f32 v228, v228
    v_exp_f32 v229, v229
    v_pk_fma_f32 v[226:227], v[226:227], v[168:169], v[168:169] op_sel:[0,1,1] op_sel_hi:[1,1,1]
    v_pk_fma_f32 v[228:229], v[228:229], v[168:169], v[168:169] op_sel:[0,1,1] op_sel_hi:[1,1,1]
    v_rcp_f32 v226, v226
    v_rcp_f32 v227, v227
    v_rcp_f32 v228, v228
    v_rcp_f32 v229, v229
    v_pk_mul_f32 v[104:105], v[104:105], v[226:227]
    v_pk_mul_f32 v[106:107], v[106:107], v[228:229]
    v_cvt_pk_bf16_f32 v250, v104, v105
    v_cvt_pk_bf16_f32 v251, v106, v107
    s_add_u32 s36, s45, 458752
    buffer_store_dwordx4 v[88:91], v2, s[16:19], s36 offen sc1
    v_pk_fma_f32 v[132:133], v[170:171], v[160:161], v[132:133] op_sel_hi:[0,1,1] neg_lo:[1,0,0] neg_hi:[1,0,0]
    v_pk_fma_f32 v[134:135], v[170:171], v[162:163], v[134:135] op_sel_hi:[0,1,1] neg_lo:[1,0,0] neg_hi:[1,0,0]
    v_pk_mul_f32 v[226:227], v[132:133], v[132:133]
    v_pk_mul_f32 v[228:229], v[134:135], v[134:135]
    v_pk_fma_f32 v[226:227], v[226:227], v[190:191], v[190:191] op_sel:[0,1,0] op_sel_hi:[1,1,0]
    v_pk_fma_f32 v[228:229], v[228:229], v[190:191], v[190:191] op_sel:[0,1,0] op_sel_hi:[1,1,0]
    v_pk_mul_f32 v[226:227], v[226:227], v[132:133]
    v_pk_mul_f32 v[228:229], v[228:229], v[134:135]
    v_exp_f32 v226, v226
    v_exp_f32 v227, v227
    v_exp_f32 v228, v228
    v_exp_f32 v229, v229
    v_pk_fma_f32 v[226:227], v[226:227], v[170:171], v[170:171] op_sel:[0,1,1] op_sel_hi:[1,1,1]
    v_pk_fma_f32 v[228:229], v[228:229], v[170:171], v[170:171] op_sel:[0,1,1] op_sel_hi:[1,1,1]
    v_rcp_f32 v226, v226
    v_rcp_f32 v227, v227
    v_rcp_f32 v228, v228
    v_rcp_f32 v229, v229
    v_pk_mul_f32 v[132:133], v[132:133], v[226:227]
    v_pk_mul_f32 v[134:135], v[134:135], v[228:229]
    v_cvt_pk_bf16_f32 v252, v132, v133
    v_cvt_pk_bf16_f32 v253, v134, v135
    s_add_u32 s36, s45, 688128
    buffer_store_dwordx4 v[116:119], v2, s[16:19], s36 offen sc1
    s_waitcnt lgkmcnt(0)
    s_mov_b32 s44, s46
    s_mov_b32 s45, s47
    s_branch G3_e2
G3_e1:
    v_pk_fma_f32 v[28:29], v[164:165], v[140:141], v[28:29] op_sel_hi:[0,1,1] neg_lo:[1,0,0] neg_hi:[1,0,0]
    v_pk_fma_f32 v[30:31], v[164:165], v[142:143], v[30:31] op_sel_hi:[0,1,1] neg_lo:[1,0,0] neg_hi:[1,0,0]
    v_pk_mul_f32 v[226:227], v[28:29], v[28:29]
    v_pk_mul_f32 v[228:229], v[30:31], v[30:31]
    v_pk_fma_f32 v[226:227], v[226:227], v[184:185], v[184:185] op_sel:[0,1,0] op_sel_hi:[1,1,0]
    v_pk_fma_f32 v[228:229], v[228:229], v[184:185], v[184:185] op_sel:[0,1,0] op_sel_hi:[1,1,0]
    v_pk_mul_f32 v[226:227], v[226:227], v[28:29]
    v_pk_mul_f32 v[228:229], v[228:229], v[30:31]
    v_exp_f32 v226, v226
    v_exp_f32 v227, v227
    v_exp_f32 v228, v228
    v_exp_f32 v229, v229
    v_pk_fma_f32 v[226:227], v[226:227], v[164:165], v[164:165] op_sel:[0,1,1] op_sel_hi:[1,1,1]
    v_pk_fma_f32 v[228:229], v[228:229], v[164:165], v[164:165] op_sel:[0,1,1] op_sel_hi:[1,1,1]
    v_rcp_f32 v226, v226
    v_rcp_f32 v227, v227
    v_rcp_f32 v228, v228
    v_rcp_f32 v229, v229
    v_pk_mul_f32 v[28:29], v[28:29], v[226:227]
    v_pk_mul_f32 v[30:31], v[30:31], v[228:229]
    v_pk_fma_f32 v[32:33], v[164:165], v[144:145], v[32:33] op_sel_hi:[0,1,1] neg_lo:[1,0,0] neg_hi:[1,0,0]
    v_pk_fma_f32 v[34:35], v[164:165], v[146:147], v[34:35] op_sel_hi:[0,1,1] neg_lo:[1,0,0] neg_hi:[1,0,0]
    v_pk_mul_f32 v[226:227], v[32:33], v[32:33]
    v_pk_mul_f32 v[228:229], v[34:35], v[34:35]
    v_pk_fma_f32 v[226:227], v[226:227], v[184:185], v[184:185] op_sel:[0,1,0] op_sel_hi:[1,1,0]
    v_pk_fma_f32 v[228:229], v[228:229], v[184:185], v[184:185] op_sel:[0,1,0] op_sel_hi:[1,1,0]
    v_pk_mul_f32 v[226:227], v[226:227], v[32:33]
    v_pk_mul_f32 v[228:229], v[228:229], v[34:35]
    v_exp_f32 v226, v226
    v_exp_f32 v227, v227
    v_exp_f32 v228, v228
    v_exp_f32 v229, v229
    v_pk_fma_f32 v[226:227], v[226:227], v[164:165], v[164:165] op_sel:[0,1,1] op_sel_hi:[1,1,1]
    v_pk_fma_f32 v[228:229], v[228:229], v[164:165], v[164:165] op_sel:[0,1,1] op_sel_hi:[1,1,1]
    v_rcp_f32 v226, v226
    v_rcp_f32 v227, v227
    v_rcp_f32 v228, v228
    v_rcp_f32 v229, v229
    v_pk_mul_f32 v[32:33], v[32:33], v[226:227]
    v_pk_mul_f32 v[34:35], v[34:35], v[228:229]
    v_cvt_pk_bf16_f32 v28, v28, v29
    v_cvt_pk_bf16_f32 v29, v30, v31
    v_cvt_pk_bf16_f32 v30, v32, v33
    v_cvt_pk_bf16_f32 v31, v34, v35
    ds_write_b128 v12, v[28:31] offset:0
    s_add_u32 s36, s45, 0
    buffer_store_dwordx4 v[28:31], v2, s[16:19], s36 offen sc1
    v_pk_fma_f32 v[56:57], v[166:167], v[140:141], v[56:57] op_sel_hi:[0,1,1] neg_lo:[1,0,0] neg_hi:[1,0,0]
    v_pk_fma_f32 v[58:59], v[166:167], v[142:143], v[58:59] op_sel_hi:[0,1,1] neg_lo:[1,0,0] neg_hi:[1,0,0]
    v_pk_mul_f32 v[226:227], v[56:57], v[56:57]
    v_pk_mul_f32 v[228:229], v[58:59], v[58:59]
    v_pk_fma_f32 v[226:227], v[226:227], v[186:187], v[186:187] op_sel:[0,1,0] op_sel_hi:[1,1,0]
    v_pk_fma_f32 v[228:229], v[228:229], v[186:187], v[186:187] op_sel:[0,1,0] op_sel_hi:[1,1,0]
    v_pk_mul_f32 v[226:227], v[226:227], v[56:57]
    v_pk_mul_f32 v[228:229], v[228:229], v[58:59]
    v_exp_f32 v226, v226
    v_exp_f32 v227, v227
    v_exp_f32 v228, v228
    v_exp_f32 v229, v229
    v_pk_fma_f32 v[226:227], v[226:227], v[166:167], v[166:167] op_sel:[0,1,1] op_sel_hi:[1,1,1]
    v_pk_fma_f32 v[228:229], v[228:229], v[166:167], v[166:167] op_sel:[0,1,1] op_sel_hi:[1,1,1]
    v_rcp_f32 v226, v226
    v_rcp_f32 v227, v227
    v_rcp_f32 v228, v228
    v_rcp_f32 v229, v229
    v_pk_mul_f32 v[56:57], v[56:57], v[226:227]
    v_pk_mul_f32 v[58:59], v[58:59], v[228:229]
    v_pk_fma_f32 v[60:61], v[166:167], v[144:145], v[60:61] op_sel_hi:[0,1,1] neg_lo:[1,0,0] neg_hi:[1,0,0]
    v_pk_fma_f32 v[62:63], v[166:167], v[146:147], v[62:63] op_sel_hi:[0,1,1] neg_lo:[1,0,0] neg_hi:[1,0,0]
    v_pk_mul_f32 v[226:227], v[60:61], v[60:61]
    v_pk_mul_f32 v[228:229], v[62:63], v[62:63]
    v_pk_fma_f32 v[226:227], v[226:227], v[186:187], v[186:187] op_sel:[0,1,0] op_sel_hi:[1,1,0]
    v_pk_fma_f32 v[228:229], v[228:229], v[186:187], v[186:187] op_sel:[0,1,0] op_sel_hi:[1,1,0]
    v_pk_mul_f32 v[226:227], v[226:227], v[60:61]
    v_pk_mul_f32 v[228:229], v[228:229], v[62:63]
    v_exp_f32 v226, v226
    v_exp_f32 v227, v227
    v_exp_f32 v228, v228
    v_exp_f32 v229, v229
    v_pk_fma_f32 v[226:227], v[226:227], v[166:167], v[166:167] op_sel:[0,1,1] op_sel_hi:[1,1,1]
    v_pk_fma_f32 v[228:229], v[228:229], v[166:167], v[166:167] op_sel:[0,1,1] op_sel_hi:[1,1,1]
    v_rcp_f32 v226, v226
    v_rcp_f32 v227, v227
    v_rcp_f32 v228, v228
    v_rcp_f32 v229, v229
    v_pk_mul_f32 v[60:61], v[60:61], v[226:227]
    v_pk_mul_f32 v[62:63], v[62:63], v[228:229]
    v_cvt_pk_bf16_f32 v56, v56, v57
    v_cvt_pk_bf16_f32 v57, v58, v59
    v_cvt_pk_bf16_f32 v58, v60, v61
    v_cvt_pk_bf16_f32 v59, v62, v63
    ds_write_b128 v12, v[56:59] offset:2048
    s_add_u32 s36, s45, 229376
    buffer_store_dwordx4 v[56:59], v2, s[16:19], s36 offen sc1
    v_pk_fma_f32 v[84:85], v[168:169], v[140:141], v[84:85] op_sel_hi:[0,1,1] neg_lo:[1,0,0] neg_hi:[1,0,0]
    v_pk_fma_f32 v[86:87], v[168:169], v[142:143], v[86:87] op_sel_hi:[0,1,1] neg_lo:[1,0,0] neg_hi:[1,0,0]
    v_pk_mul_f32 v[226:227], v[84:85], v[84:85]
    v_pk_mul_f32 v[228:229], v[86:87], v[86:87]
    v_pk_fma_f32 v[226:227], v[226:227], v[188:189], v[188:189] op_sel:[0,1,0] op_sel_hi:[1,1,0]
    v_pk_fma_f32 v[228:229], v[228:229], v[188:189], v[188:189] op_sel:[0,1,0] op_sel_hi:[1,1,0]
    v_pk_mul_f32 v[226:227], v[226:227], v[84:85]
    v_pk_mul_f32 v[228:229], v[228:229], v[86:87]
    v_exp_f32 v226, v226
    v_exp_f32 v227, v227
    v_exp_f32 v228, v228
    v_exp_f32 v229, v229
    v_pk_fma_f32 v[226:227], v[226:227], v[168:169], v[168:169] op_sel:[0,1,1] op_sel_hi:[1,1,1]
    v_pk_fma_f32 v[228:229], v[228:229], v[168:169], v[168:169] op_sel:[0,1,1] op_sel_hi:[1,1,1]
    v_rcp_f32 v226, v226
    v_rcp_f32 v227, v227
    v_rcp_f32 v228, v228
    v_rcp_f32 v229, v229
    v_pk_mul_f32 v[84:85], v[84:85], v[226:227]
    v_pk_mul_f32 v[86:87], v[86:87], v[228:229]
    v_pk_fma_f32 v[88:89], v[168:169], v[144:145], v[88:89] op_sel_hi:[0,1,1] neg_lo:[1,0,0] neg_hi:[1,0,0]
    v_pk_fma_f32 v[90:91], v[168:169], v[146:147], v[90:91] op_sel_hi:[0,1,1] neg_lo:[1,0,0] neg_hi:[1,0,0]
    v_pk_mul_f32 v[226:227], v[88:89], v[88:89]
    v_pk_mul_f32 v[228:229], v[90:91], v[90:91]
    v_pk_fma_f32 v[226:227], v[226:227], v[188:189], v[188:189] op_sel:[0,1,0] op_sel_hi:[1,1,0]
    v_pk_fma_f32 v[228:229], v[228:229], v[188:189], v[188:189] op_sel:[0,1,0] op_sel_hi:[1,1,0]
    v_pk_mul_f32 v[226:227], v[226:227], v[88:89]
    v_pk_mul_f32 v[228:229], v[228:229], v[90:91]
    v_exp_f32 v226, v226
    v_exp_f32 v227, v227
    v_exp_f32 v228, v228
    v_exp_f32 v229, v229
    v_pk_fma_f32 v[226:227], v[226:227], v[168:169], v[168:169] op_sel:[0,1,1] op_sel_hi:[1,1,1]
    v_pk_fma_f32 v[228:229], v[228:229], v[168:169], v[168:169] op_sel:[0,1,1] op_sel_hi:[1,1,1]
    v_rcp_f32 v226, v226
    v_rcp_f32 v227, v227
    v_rcp_f32 v228, v228
    v_rcp_f32 v229, v229
    v_pk_mul_f32 v[88:89], v[88:89], v[226:227]
    v_pk_mul_f32 v[90:91], v[90:91], v[228:229]
    v_cvt_pk_bf16_f32 v84, v84, v85
    v_cvt_pk_bf16_f32 v85, v86, v87
    v_cvt_pk_bf16_f32 v86, v88, v89
    v_cvt_pk_bf16_f32 v87, v90, v91
    ds_write_b128 v12, v[84:87] offset:4096
    s_add_u32 s36, s45, 458752
    buffer_store_dwordx4 v[84:87], v2, s[16:19], s36 offen sc1
    v_pk_fma_f32 v[112:113], v[170:171], v[140:141], v[112:113] op_sel_hi:[0,1,1] neg_lo:[1,0,0] neg_hi:[1,0,0]
    v_pk_fma_f32 v[114:115], v[170:171], v[142:143], v[114:115] op_sel_hi:[0,1,1] neg_lo:[1,0,0] neg_hi:[1,0,0]
    v_pk_mul_f32 v[226:227], v[112:113], v[112:113]
    v_pk_mul_f32 v[228:229], v[114:115], v[114:115]
    v_pk_fma_f32 v[226:227], v[226:227], v[190:191], v[190:191] op_sel:[0,1,0] op_sel_hi:[1,1,0]
    v_pk_fma_f32 v[228:229], v[228:229], v[190:191], v[190:191] op_sel:[0,1,0] op_sel_hi:[1,1,0]
    v_pk_mul_f32 v[226:227], v[226:227], v[112:113]
    v_pk_mul_f32 v[228:229], v[228:229], v[114:115]
    v_exp_f32 v226, v226
    v_exp_f32 v227, v227
    v_exp_f32 v228, v228
    v_exp_f32 v229, v229
    v_pk_fma_f32 v[226:227], v[226:227], v[170:171], v[170:171] op_sel:[0,1,1] op_sel_hi:[1,1,1]
    v_pk_fma_f32 v[228:229], v[228:229], v[170:171], v[170:171] op_sel:[0,1,1] op_sel_hi:[1,1,1]
    v_rcp_f32 v226, v226
    v_rcp_f32 v227, v227
    v_rcp_f32 v228, v228
    v_rcp_f32 v229, v229
    v_pk_mul_f32 v[112:113], v[112:113], v[226:227]
    v_pk_mul_f32 v[114:115], v[114:115], v[228:229]
    v_pk_fma_f32 v[116:117], v[170:171], v[144:145], v[116:117] op_sel_hi:[0,1,1] neg_lo:[1,0,0] neg_hi:[1,0,0]
    v_pk_fma_f32 v[118:119], v[170:171], v[146:147], v[118:119] op_sel_hi:[0,1,1] neg_lo:[1,0,0] neg_hi:[1,0,0]
    v_pk_mul_f32 v[226:227], v[116:117], v[116:117]
    v_pk_mul_f32 v[228:229], v[118:119], v[118:119]
    v_pk_fma_f32 v[226:227], v[226:227], v[190:191], v[190:191] op_sel:[0,1,0] op_sel_hi:[1,1,0]
    v_pk_fma_f32 v[228:229], v[228:229], v[190:191], v[190:191] op_sel:[0,1,0] op_sel_hi:[1,1,0]
    v_pk_mul_f32 v[226:227], v[226:227], v[116:117]
    v_pk_mul_f32 v[228:229], v[228:229], v[118:119]
    v_exp_f32 v226, v226
    v_exp_f32 v227, v227
    v_exp_f32 v228, v228
    v_exp_f32 v229, v229
    v_pk_fma_f32 v[226:227], v[226:227], v[170:171], v[170:171] op_sel:[0,1,1] op_sel_hi:[1,1,1]
    v_pk_fma_f32 v[228:229], v[228:229], v[170:171], v[170:171] op_sel:[0,1,1] op_sel_hi:[1,1,1]
    v_rcp_f32 v226, v226
    v_rcp_f32 v227, v227
    v_rcp_f32 v228, v228
    v_rcp_f32 v229, v229
    v_pk_mul_f32 v[116:117], v[116:117], v[226:227]
    v_pk_mul_f32 v[118:119], v[118:119], v[228:229]
    v_cvt_pk_bf16_f32 v112, v112, v113
    v_cvt_pk_bf16_f32 v113, v114, v115
    v_cvt_pk_bf16_f32 v114, v116, v117
    v_cvt_pk_bf16_f32 v115, v118, v119
    ds_write_b128 v12, v[112:115] offset:6144
    s_add_u32 s36, s45, 688128
    buffer_store_dwordx4 v[112:115], v2, s[16:19], s36 offen sc1
    v_pk_fma_f32 v[36:37], v[164:165], v[148:149], v[36:37] op_sel_hi:[0,1,1] neg_lo:[1,0,0] neg_hi:[1,0,0]
    v_pk_fma_f32 v[38:39], v[164:165], v[150:151], v[38:39] op_sel_hi:[0,1,1] neg_lo:[1,0,0] neg_hi:[1,0,0]
    v_pk_mul_f32 v[226:227], v[36:37], v[36:37]
    v_pk_mul_f32 v[228:229], v[38:39], v[38:39]
    v_pk_fma_f32 v[226:227], v[226:227], v[184:185], v[184:185] op_sel:[0,1,0] op_sel_hi:[1,1,0]
    v_pk_fma_f32 v[228:229], v[228:229], v[184:185], v[184:185] op_sel:[0,1,0] op_sel_hi:[1,1,0]
    v_pk_mul_f32 v[226:227], v[226:227], v[36:37]
    v_pk_mul_f32 v[228:229], v[228:229], v[38:39]
    v_exp_f32 v226, v226
    v_exp_f32 v227, v227
    v_exp_f32 v228, v228
    v_exp_f32 v229, v229
    v_pk_fma_f32 v[226:227], v[226:227], v[164:165], v[164:165] op_sel:[0,1,1] op_sel_hi:[1,1,1]
    v_pk_fma_f32 v[228:229], v[228:229], v[164:165], v[164:165] op_sel:[0,1,1] op_sel_hi:[1,1,1]
    v_rcp_f32 v226, v226
    v_rcp_f32 v227, v227
    v_rcp_f32 v228, v228
    v_rcp_f32 v229, v229
    v_pk_mul_f32 v[36:37], v[36:37], v[226:227]
    v_pk_mul_f32 v[38:39], v[38:39], v[228:229]
    v_pk_fma_f32 v[40:41], v[164:165], v[152:153], v[40:41] op_sel_hi:[0,1,1] neg_lo:[1,0,0] neg_hi:[1,0,0]
    v_pk_fma_f32 v[42:43], v[164:165], v[154:155], v[42:43] op_sel_hi:[0,1,1] neg_lo:[1,0,0] neg_hi:[1,0,0]
    v_pk_mul_f32 v[226:227], v[40:41], v[40:41]
    v_pk_mul_f32 v[228:229], v[42:43], v[42:43]
    v_pk_fma_f32 v[226:227], v[226:227], v[184:185], v[184:185] op_sel:[0,1,0] op_sel_hi:[1,1,0]
    v_pk_fma_f32 v[228:229], v[228:229], v[184:185], v[184:185] op_sel:[0,1,0] op_sel_hi:[1,1,0]
    v_pk_mul_f32 v[226:227], v[226:227], v[40:41]
    v_pk_mul_f32 v[228:229], v[228:229], v[42:43]
    v_exp_f32 v226, v226
    v_exp_f32 v227, v227
    v_exp_f32 v228, v228
    v_exp_f32 v229, v229
    v_pk_fma_f32 v[226:227], v[226:227], v[164:165], v[164:165] op_sel:[0,1,1] op_sel_hi:[1,1,1]
    v_pk_fma_f32 v[228:229], v[228:229], v[164:165], v[164:165] op_sel:[0,1,1] op_sel_hi:[1,1,1]
    v_rcp_f32 v226, v226
    v_rcp_f32 v227, v227
    v_rcp_f32 v228, v228
    v_rcp_f32 v229, v229
    v_pk_mul_f32 v[40:41], v[40:41], v[226:227]
    v_pk_mul_f32 v[42:43], v[42:43], v[228:229]
    v_cvt_pk_bf16_f32 v36, v36, v37
    v_cvt_pk_bf16_f32 v37, v38, v39
    v_cvt_pk_bf16_f32 v38, v40, v41
    v_cvt_pk_bf16_f32 v39, v42, v43
    ds_write_b128 v12, v[36:39] offset:16384
    s_add_u32 s53, s55, 1792
    s_lshl_b32 s54, s31, 7
    s_add_u32 s53, s53, s54
    v_mov_b32 v8, 1
    v_mov_b32 v9, 162864
    v_mov_b32 v11, 0
    s_mov_b64 exec, 1
    s_waitcnt vmcnt(0)
    ds_add_rtn_u32 v10, v9, v8
    s_waitcnt lgkmcnt(0)
    v_readfirstlane_b32 s54, v10
    s_nop 0
    s_and_b32 s54, s54, 3
    s_cmp_lg_u32 s54, 3
    s_cbranch_scc1 pub_33
    buffer_atomic_add v8, v11, s[56:59], s53 offen sc1
    v_mov_b32 v9, 162872
    ds_add_u32 v9, v8
pub_33:
    s_mov_b64 exec, -1
    v_pk_fma_f32 v[64:65], v[166:167], v[148:149], v[64:65] op_sel_hi:[0,1,1] neg_lo:[1,0,0] neg_hi:[1,0,0]
    v_pk_fma_f32 v[66:67], v[166:167], v[150:151], v[66:67] op_sel_hi:[0,1,1] neg_lo:[1,0,0] neg_hi:[1,0,0]
    v_pk_mul_f32 v[226:227], v[64:65], v[64:65]
    v_pk_mul_f32 v[228:229], v[66:67], v[66:67]
    v_pk_fma_f32 v[226:227], v[226:227], v[186:187], v[186:187] op_sel:[0,1,0] op_sel_hi:[1,1,0]
    v_pk_fma_f32 v[228:229], v[228:229], v[186:187], v[186:187] op_sel:[0,1,0] op_sel_hi:[1,1,0]
    v_pk_mul_f32 v[226:227], v[226:227], v[64:65]
    v_pk_mul_f32 v[228:229], v[228:229], v[66:67]
    v_exp_f32 v226, v226
    v_exp_f32 v227, v227
    v_exp_f32 v228, v228
    v_exp_f32 v229, v229
    v_pk_fma_f32 v[226:227], v[226:227], v[166:167], v[166:167] op_sel:[0,1,1] op_sel_hi:[1,1,1]
    v_pk_fma_f32 v[228:229], v[228:229], v[166:167], v[166:167] op_sel:[0,1,1] op_sel_hi:[1,1,1]
    v_rcp_f32 v226, v226
    v_rcp_f32 v227, v227
    v_rcp_f32 v228, v228
    v_rcp_f32 v229, v229
    v_pk_mul_f32 v[64:65], v[64:65], v[226:227]
    v_pk_mul_f32 v[66:67], v[66:67], v[228:229]
    v_pk_fma_f32 v[68:69], v[166:167], v[152:153], v[68:69] op_sel_hi:[0,1,1] neg_lo:[1,0,0] neg_hi:[1,0,0]
    v_pk_fma_f32 v[70:71], v[166:167], v[154:155], v[70:71] op_sel_hi:[0,1,1] neg_lo:[1,0,0] neg_hi:[1,0,0]
    v_pk_mul_f32 v[226:227], v[68:69], v[68:69]
    v_pk_mul_f32 v[228:229], v[70:71], v[70:71]
    v_pk_fma_f32 v[226:227], v[226:227], v[186:187], v[186:187] op_sel:[0,1,0] op_sel_hi:[1,1,0]
    v_pk_fma_f32 v[228:229], v[228:229], v[186:187], v[186:187] op_sel:[0,1,0] op_sel_hi:[1,1,0]
    v_pk_mul_f32 v[226:227], v[226:227], v[68:69]
    v_pk_mul_f32 v[228:229], v[228:229], v[70:71]
    v_exp_f32 v226, v226
    v_exp_f32 v227, v227
    v_exp_f32 v228, v228
    v_exp_f32 v229, v229
    v_pk_fma_f32 v[226:227], v[226:227], v[166:167], v[166:167] op_sel:[0,1,1] op_sel_hi:[1,1,1]
    v_pk_fma_f32 v[228:229], v[228:229], v[166:167], v[166:167] op_sel:[0,1,1] op_sel_hi:[1,1,1]
    v_rcp_f32 v226, v226
    v_rcp_f32 v227, v227
    v_rcp_f32 v228, v228
    v_rcp_f32 v229, v229
    v_pk_mul_f32 v[68:69], v[68:69], v[226:227]
    v_pk_mul_f32 v[70:71], v[70:71], v[228:229]
    v_cvt_pk_bf16_f32 v64, v64, v65
    v_cvt_pk_bf16_f32 v65, v66, v67
    v_cvt_pk_bf16_f32 v66, v68, v69
    v_cvt_pk_bf16_f32 v67, v70, v71
    ds_write_b128 v12, v[64:67] offset:18432
    v_pk_fma_f32 v[92:93], v[168:169], v[148:149], v[92:93] op_sel_hi:[0,1,1] neg_lo:[1,0,0] neg_hi:[1,0,0]
    v_pk_fma_f32 v[94:95], v[168:169], v[150:151], v[94:95] op_sel_hi:[0,1,1] neg_lo:[1,0,0] neg_hi:[1,0,0]
    v_pk_mul_f32 v[226:227], v[92:93], v[92:93]
    v_pk_mul_f32 v[228:229], v[94:95], v[94:95]
    v_pk_fma_f32 v[226:227], v[226:227], v[188:189], v[188:189] op_sel:[0,1,0] op_sel_hi:[1,1,0]
    v_pk_fma_f32 v[228:229], v[228:229], v[188:189], v[188:189] op_sel:[0,1,0] op_sel_hi:[1,1,0]
    v_pk_mul_f32 v[226:227], v[226:227], v[92:93]
    v_pk_mul_f32 v[228:229], v[228:229], v[94:95]
    v_exp_f32 v226, v226
    v_exp_f32 v227, v227
    v_exp_f32 v228, v228
    v_exp_f32 v229, v229
    v_pk_fma_f32 v[226:227], v[226:227], v[168:169], v[168:169] op_sel:[0,1,1] op_sel_hi:[1,1,1]
    v_pk_fma_f32 v[228:229], v[228:229], v[168:169], v[168:169] op_sel:[0,1,1] op_sel_hi:[1,1,1]
    v_rcp_f32 v226, v226
    v_rcp_f32 v227, v227
    v_rcp_f32 v228, v228
    v_rcp_f32 v229, v229
    v_pk_mul_f32 v[92:93], v[92:93], v[226:227]
    v_pk_mul_f32 v[94:95], v[94:95], v[228:229]
    v_pk_fma_f32 v[96:97], v[168:169], v[152:153], v[96:97] op_sel_hi:[0,1,1] neg_lo:[1,0,0] neg_hi:[1,0,0]
    v_pk_fma_f32 v[98:99], v[168:169], v[154:155], v[98:99] op_sel_hi:[0,1,1] neg_lo:[1,0,0] neg_hi:[1,0,0]
    v_pk_mul_f32 v[226:227], v[96:97], v[96:97]
    v_pk_mul_f32 v[228:229], v[98:99], v[98:99]
    v_pk_fma_f32 v[226:227], v[226:227], v[188:189], v[188:189] op_sel:[0,1,0] op_sel_hi:[1,1,0]
    v_pk_fma_f32 v[228:229], v[228:229], v[188:189], v[188:189] op_sel:[0,1,0] op_sel_hi:[1,1,0]
    v_pk_mul_f32 v[226:227], v[226:227], v[96:97]
    v_pk_mul_f32 v[228:229], v[228:229], v[98:99]
    v_exp_f32 v226, v226
    v_exp_f32 v227, v227
    v_exp_f32 v228, v228
    v_exp_f32 v229, v229
    v_pk_fma_f32 v[226:227], v[226:227], v[168:169], v[168:169] op_sel:[0,1,1] op_sel_hi:[1,1,1]
    v_pk_fma_f32 v[228:229], v[228:229], v[168:169], v[168:169] op_sel:[0,1,1] op_sel_hi:[1,1,1]
    v_rcp_f32 v226, v226
    v_rcp_f32 v227, v227
    v_rcp_f32 v228, v228
    v_rcp_f32 v229, v229
    v_pk_mul_f32 v[96:97], v[96:97], v[226:227]
    v_pk_mul_f32 v[98:99], v[98:99], v[228:229]
    v_cvt_pk_bf16_f32 v92, v92, v93
    v_cvt_pk_bf16_f32 v93, v94, v95
    v_cvt_pk_bf16_f32 v94, v96, v97
    v_cvt_pk_bf16_f32 v95, v98, v99
    ds_write_b128 v12, v[92:95] offset:20480
    v_pk_fma_f32 v[120:121], v[170:171], v[148:149], v[120:121] op_sel_hi:[0,1,1] neg_lo:[1,0,0] neg_hi:[1,0,0]
    v_pk_fma_f32 v[122:123], v[170:171], v[150:151], v[122:123] op_sel_hi:[0,1,1] neg_lo:[1,0,0] neg_hi:[1,0,0]
    v_pk_mul_f32 v[226:227], v[120:121], v[120:121]
    v_pk_mul_f32 v[228:229], v[122:123], v[122:123]
    v_pk_fma_f32 v[226:227], v[226:227], v[190:191], v[190:191] op_sel:[0,1,0] op_sel_hi:[1,1,0]
    v_pk_fma_f32 v[228:229], v[228:229], v[190:191], v[190:191] op_sel:[0,1,0] op_sel_hi:[1,1,0]
    v_pk_mul_f32 v[226:227], v[226:227], v[120:121]
    v_pk_mul_f32 v[228:229], v[228:229], v[122:123]
    v_exp_f32 v226, v226
    v_exp_f32 v227, v227
    v_exp_f32 v228, v228
    v_exp_f32 v229, v229
    v_pk_fma_f32 v[226:227], v[226:227], v[170:171], v[170:171] op_sel:[0,1,1] op_sel_hi:[1,1,1]
    v_pk_fma_f32 v[228:229], v[228:229], v[170:171], v[170:171] op_sel:[0,1,1] op_sel_hi:[1,1,1]
    v_rcp_f32 v226, v226
    v_rcp_f32 v227, v227
    v_rcp_f32 v228, v228
    v_rcp_f32 v229, v229
    v_pk_mul_f32 v[120:121], v[120:121], v[226:227]
    v_pk_mul_f32 v[122:123], v[122:123], v[228:229]
    v_pk_fma_f32 v[124:125], v[170:171], v[152:153], v[124:125] op_sel_hi:[0,1,1] neg_lo:[1,0,0] neg_hi:[1,0,0]
    v_pk_fma_f32 v[126:127], v[170:171], v[154:155], v[126:127] op_sel_hi:[0,1,1] neg_lo:[1,0,0] neg_hi:[1,0,0]
    v_pk_mul_f32 v[226:227], v[124:125], v[124:125]
    v_pk_mul_f32 v[228:229], v[126:127], v[126:127]
    v_pk_fma_f32 v[226:227], v[226:227], v[190:191], v[190:191] op_sel:[0,1,0] op_sel_hi:[1,1,0]
    v_pk_fma_f32 v[228:229], v[228:229], v[190:191], v[190:191] op_sel:[0,1,0] op_sel_hi:[1,1,0]
    v_pk_mul_f32 v[226:227], v[226:227], v[124:125]
    v_pk_mul_f32 v[228:229], v[228:229], v[126:127]
    v_exp_f32 v226, v226
    v_exp_f32 v227, v227
    v_exp_f32 v228, v228
    v_exp_f32 v229, v229
    v_pk_fma_f32 v[226:227], v[226:227], v[170:171], v[170:171] op_sel:[0,1,1] op_sel_hi:[1,1,1]
    v_pk_fma_f32 v[228:229], v[228:229], v[170:171], v[170:171] op_sel:[0,1,1] op_sel_hi:[1,1,1]
    v_rcp_f32 v226, v226
    v_rcp_f32 v227, v227
    v_rcp_f32 v228, v228
    v_rcp_f32 v229, v229
    v_pk_mul_f32 v[124:125], v[124:125], v[226:227]
    v_pk_mul_f32 v[126:127], v[126:127], v[228:229]
    v_cvt_pk_bf16_f32 v120, v120, v121
    v_cvt_pk_bf16_f32 v121, v122, v123
    v_cvt_pk_bf16_f32 v122, v124, v125
    v_cvt_pk_bf16_f32 v123, v126, v127
    ds_write_b128 v12, v[120:123] offset:22528
    v_pk_fma_f32 v[44:45], v[164:165], v[156:157], v[44:45] op_sel_hi:[0,1,1] neg_lo:[1,0,0] neg_hi:[1,0,0]
    v_pk_fma_f32 v[46:47], v[164:165], v[158:159], v[46:47] op_sel_hi:[0,1,1] neg_lo:[1,0,0] neg_hi:[1,0,0]
    v_pk_mul_f32 v[226:227], v[44:45], v[44:45]
    v_pk_mul_f32 v[228:229], v[46:47], v[46:47]
    v_pk_fma_f32 v[226:227], v[226:227], v[184:185], v[184:185] op_sel:[0,1,0] op_sel_hi:[1,1,0]
    v_pk_fma_f32 v[228:229], v[228:229], v[184:185], v[184:185] op_sel:[0,1,0] op_sel_hi:[1,1,0]
    v_pk_mul_f32 v[226:227], v[226:227], v[44:45]
    v_pk_mul_f32 v[228:229], v[228:229], v[46:47]
    v_exp_f32 v226, v226
    v_exp_f32 v227, v227
    v_exp_f32 v228, v228
    v_exp_f32 v229, v229
    v_pk_fma_f32 v[226:227], v[226:227], v[164:165], v[164:165] op_sel:[0,1,1] op_sel_hi:[1,1,1]
    v_pk_fma_f32 v[228:229], v[228:229], v[164:165], v[164:165] op_sel:[0,1,1] op_sel_hi:[1,1,1]
    v_rcp_f32 v226, v226
    v_rcp_f32 v227, v227
    v_rcp_f32 v228, v228
    v_rcp_f32 v229, v229
    v_pk_mul_f32 v[44:45], v[44:45], v[226:227]
    v_pk_mul_f32 v[46:47], v[46:47], v[228:229]
    v_pk_fma_f32 v[48:49], v[164:165], v[160:161], v[48:49] op_sel_hi:[0,1,1] neg_lo:[1,0,0] neg_hi:[1,0,0]
    v_pk_fma_f32 v[50:51], v[164:165], v[162:163], v[50:51] op_sel_hi:[0,1,1] neg_lo:[1,0,0] neg_hi:[1,0,0]
    v_pk_mul_f32 v[226:227], v[48:49], v[48:49]
    v_pk_mul_f32 v[228:229], v[50:51], v[50:51]
    v_pk_fma_f32 v[226:227], v[226:227], v[184:185], v[184:185] op_sel:[0,1,0] op_sel_hi:[1,1,0]
    v_pk_fma_f32 v[228:229], v[228:229], v[184:185], v[184:185] op_sel:[0,1,0] op_sel_hi:[1,1,0]
    v_pk_mul_f32 v[226:227], v[226:227], v[48:49]
    v_pk_mul_f32 v[228:229], v[228:229], v[50:51]
    v_exp_f32 v226, v226
    v_exp_f32 v227, v227
    v_exp_f32 v228, v228
    v_exp_f32 v229, v229
    v_pk_fma_f32 v[226:227], v[226:227], v[164:165], v[164:165] op_sel:[0,1,1] op_sel_hi:[1,1,1]
    v_pk_fma_f32 v[228:229], v[228:229], v[164:165], v[164:165] op_sel:[0,1,1] op_sel_hi:[1,1,1]
    v_rcp_f32 v226, v226
    v_rcp_f32 v227, v227
    v_rcp_f32 v228, v228
    v_rcp_f32 v229, v229
    v_pk_mul_f32 v[48:49], v[48:49], v[226:227]
    v_pk_mul_f32 v[50:51], v[50:51], v[228:229]
    v_cvt_pk_bf16_f32 v230, v44, v45
    v_cvt_pk_bf16_f32 v231, v46, v47
    v_cvt_pk_bf16_f32 v232, v48, v49
    v_cvt_pk_bf16_f32 v233, v50, v51
    ds_write_b128 v12, v[230:233] offset:32768
    v_pk_fma_f32 v[72:73], v[166:167], v[156:157], v[72:73] op_sel_hi:[0,1,1] neg_lo:[1,0,0] neg_hi:[1,0,0]
    v_pk_fma_f32 v[74:75], v[166:167], v[158:159], v[74:75] op_sel_hi:[0,1,1] neg_lo:[1,0,0] neg_hi:[1,0,0]
    v_pk_mul_f32 v[226:227], v[72:73], v[72:73]
    v_pk_mul_f32 v[228:229], v[74:75], v[74:75]
    v_pk_fma_f32 v[226:227], v[226:227], v[186:187], v[186:187] op_sel:[0,1,0] op_sel_hi:[1,1,0]
    v_pk_fma_f32 v[228:229], v[228:229], v[186:187], v[186:187] op_sel:[0,1,0] op_sel_hi:[1,1,0]
    v_pk_mul_f32 v[226:227], v[226:227], v[72:73]
    v_pk_mul_f32 v[228:229], v[228:229], v[74:75]
    v_exp_f32 v226, v226
    v_exp_f32 v227, v227
    v_exp_f32 v228, v228
    v_exp_f32 v229, v229
    v_pk_fma_f32 v[226:227], v[226:227], v[166:167], v[166:167] op_sel:[0,1,1] op_sel_hi:[1,1,1]
    v_pk_fma_f32 v[228:229], v[228:229], v[166:167], v[166:167] op_sel:[0,1,1] op_sel_hi:[1,1,1]
    v_rcp_f32 v226, v226
    v_rcp_f32 v227, v227
    v_rcp_f32 v228, v228
    v_rcp_f32 v229, v229
    v_pk_mul_f32 v[72:73], v[72:73], v[226:227]
    v_pk_mul_f32 v[74:75], v[74:75], v[228:229]
    v_pk_fma_f32 v[76:77], v[166:167], v[160:161], v[76:77] op_sel_hi:[0,1,1] neg_lo:[1,0,0] neg_hi:[1,0,0]
    v_pk_fma_f32 v[78:79], v[166:167], v[162:163], v[78:79] op_sel_hi:[0,1,1] neg_lo:[1,0,0] neg_hi:[1,0,0]
    v_pk_mul_f32 v[226:227], v[76:77], v[76:77]
    v_pk_mul_f32 v[228:229], v[78:79], v[78:79]
    v_pk_fma_f32 v[226:227], v[226:227], v[186:187], v[186:187] op_sel:[0,1,0] op_sel_hi:[1,1,0]
    v_pk_fma_f32 v[228:229], v[228:229], v[186:187], v[186:187] op_sel:[0,1,0] op_sel_hi:[1,1,0]
    v_pk_mul_f32 v[226:227], v[226:227], v[76:77]
    v_pk_mul_f32 v[228:229], v[228:229], v[78:79]
    v_exp_f32 v226, v226
    v_exp_f32 v227, v227
    v_exp_f32 v228, v228
    v_exp_f32 v229, v229
    v_pk_fma_f32 v[226:227], v[226:227], v[166:167], v[166:167] op_sel:[0,1,1] op_sel_hi:[1,1,1]
    v_pk_fma_f32 v[228:229], v[228:229], v[166:167], v[166:167] op_sel:[0,1,1] op_sel_hi:[1,1,1]
    v_rcp_f32 v226, v226
    v_rcp_f32 v227, v227
    v_rcp_f32 v228, v228
    v_rcp_f32 v229, v229
    v_pk_mul_f32 v[76:77], v[76:77], v[226:227]
    v_pk_mul_f32 v[78:79], v[78:79], v[228:229]
    v_cvt_pk_bf16_f32 v234, v72, v73
    v_cvt_pk_bf16_f32 v235, v74, v75
    v_cvt_pk_bf16_f32 v236, v76, v77
    v_cvt_pk_bf16_f32 v237, v78, v79
    ds_write_b128 v12, v[234:237] offset:34816
    v_pk_fma_f32 v[100:101], v[168:169], v[156:157], v[100:101] op_sel_hi:[0,1,1] neg_lo:[1,0,0] neg_hi:[1,0,0]
    v_pk_fma_f32 v[102:103], v[168:169], v[158:159], v[102:103] op_sel_hi:[0,1,1] neg_lo:[1,0,0] neg_hi:[1,0,0]
    v_pk_mul_f32 v[226:227], v[100:101], v[100:101]
    v_pk_mul_f32 v[228:229], v[102:103], v[102:103]
    v_pk_fma_f32 v[226:227], v[226:227], v[188:189], v[188:189] op_sel:[0,1,0] op_sel_hi:[1,1,0]
    v_pk_fma_f32 v[228:229], v[228:229], v[188:189], v[188:189] op_sel:[0,1,0] op_sel_hi:[1,1,0]
    v_pk_mul_f32 v[226:227], v[226:227], v[100:101]
    v_pk_mul_f32 v[228:229], v[228:229], v[102:103]
    v_exp_f32 v226, v226
    v_exp_f32 v227, v227
    v_exp_f32 v228, v228
    v_exp_f32 v229, v229
    v_pk_fma_f32 v[226:227], v[226:227], v[168:169], v[168:169] op_sel:[0,1,1] op_sel_hi:[1,1,1]
    v_pk_fma_f32 v[228:229], v[228:229], v[168:169], v[168:169] op_sel:[0,1,1] op_sel_hi:[1,1,1]
    v_rcp_f32 v226, v226
    v_rcp_f32 v227, v227
    v_rcp_f32 v228, v228
    v_rcp_f32 v229, v229
    v_pk_mul_f32 v[100:101], v[100:101], v[226:227]
    v_pk_mul_f32 v[102:103], v[102:103], v[228:229]
    v_pk_fma_f32 v[104:105], v[168:169], v[160:161], v[104:105] op_sel_hi:[0,1,1] neg_lo:[1,0,0] neg_hi:[1,0,0]
    v_pk_fma_f32 v[106:107], v[168:169], v[162:163], v[106:107] op_sel_hi:[0,1,1] neg_lo:[1,0,0] neg_hi:[1,0,0]
    v_pk_mul_f32 v[226:227], v[104:105], v[104:105]
    v_pk_mul_f32 v[228:229], v[106:107], v[106:107]
    v_pk_fma_f32 v[226:227], v[226:227], v[188:189], v[188:189] op_sel:[0,1,0] op_sel_hi:[1,1,0]
    v_pk_fma_f32 v[228:229], v[228:229], v[188:189], v[188:189] op_sel:[0,1,0] op_sel_hi:[1,1,0]
    v_pk_mul_f32 v[226:227], v[226:227], v[104:105]
    v_pk_mul_f32 v[228:229], v[228:229], v[106:107]
    v_exp_f32 v226, v226
    v_exp_f32 v227, v227
    v_exp_f32 v228, v228
    v_exp_f32 v229, v229
    v_pk_fma_f32 v[226:227], v[226:227], v[168:169], v[168:169] op_sel:[0,1,1] op_sel_hi:[1,1,1]
    v_pk_fma_f32 v[228:229], v[228:229], v[168:169], v[168:169] op_sel:[0,1,1] op_sel_hi:[1,1,1]
    v_rcp_f32 v226, v226
    v_rcp_f32 v227, v227
    v_rcp_f32 v228, v228
    v_rcp_f32 v229, v229
    v_pk_mul_f32 v[104:105], v[104:105], v[226:227]
    v_pk_mul_f32 v[106:107], v[106:107], v[228:229]
    v_cvt_pk_bf16_f32 v238, v100, v101
    v_cvt_pk_bf16_f32 v239, v102, v103
    v_cvt_pk_bf16_f32 v240, v104, v105
    v_cvt_pk_bf16_f32 v241, v106, v107
    ds_write_b128 v12, v[238:241] offset:36864
    v_pk_fma_f32 v[128:129], v[170:171], v[156:157], v[128:129] op_sel_hi:[0,1,1] neg_lo:[1,0,0] neg_hi:[1,0,0]
    v_pk_fma_f32 v[130:131], v[170:171], v[158:159], v[130:131] op_sel_hi:[0,1,1] neg_lo:[1,0,0] neg_hi:[1,0,0]
    v_pk_mul_f32 v[226:227], v[128:129], v[128:129]
    v_pk_mul_f32 v[228:229], v[130:131], v[130:131]
    v_pk_fma_f32 v[226:227], v[226:227], v[190:191], v[190:191] op_sel:[0,1,0] op_sel_hi:[1,1,0]
    v_pk_fma_f32 v[228:229], v[228:229], v[190:191], v[190:191] op_sel:[0,1,0] op_sel_hi:[1,1,0]
    v_pk_mul_f32 v[226:227], v[226:227], v[128:129]
    v_pk_mul_f32 v[228:229], v[228:229], v[130:131]
    v_exp_f32 v226, v226
    v_exp_f32 v227, v227
    v_exp_f32 v228, v228
    v_exp_f32 v229, v229
    v_pk_fma_f32 v[226:227], v[226:227], v[170:171], v[170:171] op_sel:[0,1,1] op_sel_hi:[1,1,1]
    v_pk_fma_f32 v[228:229], v[228:229], v[170:171], v[170:171] op_sel:[0,1,1] op_sel_hi:[1,1,1]
    v_rcp_f32 v226, v226
    v_rcp_f32 v227, v227
    v_rcp_f32 v228, v228
    v_rcp_f32 v229, v229
    v_pk_mul_f32 v[128:129], v[128:129], v[226:227]
    v_pk_mul_f32 v[130:131], v[130:131], v[228:229]
    v_pk_fma_f32 v[132:133], v[170:171], v[160:161], v[132:133] op_sel_hi:[0,1,1] neg_lo:[1,0,0] neg_hi:[1,0,0]
    v_pk_fma_f32 v[134:135], v[170:171], v[162:163], v[134:135] op_sel_hi:[0,1,1] neg_lo:[1,0,0] neg_hi:[1,0,0]
    v_pk_mul_f32 v[226:227], v[132:133], v[132:133]
    v_pk_mul_f32 v[228:229], v[134:135], v[134:135]
    v_pk_fma_f32 v[226:227], v[226:227], v[190:191], v[190:191] op_sel:[0,1,0] op_sel_hi:[1,1,0]
    v_pk_fma_f32 v[228:229], v[228:229], v[190:191], v[190:191] op_sel:[0,1,0] op_sel_hi:[1,1,0]
    v_pk_mul_f32 v[226:227], v[226:227], v[132:133]
    v_pk_mul_f32 v[228:229], v[228:229], v[134:135]
    v_exp_f32 v226, v226
    v_exp_f32 v227, v227
    v_exp_f32 v228, v228
    v_exp_f32 v229, v229
    v_pk_fma_f32 v[226:227], v[226:227], v[170:171], v[170:171] op_sel:[0,1,1] op_sel_hi:[1,1,1]
    v_pk_fma_f32 v[228:229], v[228:229], v[170:171], v[170:171] op_sel:[0,1,1] op_sel_hi:[1,1,1]
    v_rcp_f32 v226, v226
    v_rcp_f32 v227, v227
    v_rcp_f32 v228, v228
    v_rcp_f32 v229, v229
    v_pk_mul_f32 v[132:133], v[132:133], v[226:227]
    v_pk_mul_f32 v[134:135], v[134:135], v[228:229]
    v_cvt_pk_bf16_f32 v242, v128, v129
    v_cvt_pk_bf16_f32 v243, v130, v131
    v_cvt_pk_bf16_f32 v244, v132, v133
    v_cvt_pk_bf16_f32 v245, v134, v135
    ds_write_b128 v12, v[242:245] offset:38912
    v_pk_fma_f32 v[24:25], v[164:165], v[136:137], v[24:25] op_sel_hi:[0,1,1] neg_lo:[1,0,0] neg_hi:[1,0,0]
    v_pk_fma_f32 v[26:27], v[164:165], v[138:139], v[26:27] op_sel_hi:[0,1,1] neg_lo:[1,0,0] neg_hi:[1,0,0]
    v_pk_mul_f32 v[226:227], v[24:25], v[24:25]
    v_pk_mul_f32 v[228:229], v[26:27], v[26:27]
    v_pk_fma_f32 v[226:227], v[226:227], v[184:185], v[184:185] op_sel:[0,1,0] op_sel_hi:[1,1,0]
    v_pk_fma_f32 v[228:229], v[228:229], v[184:185], v[184:185] op_sel:[0,1,0] op_sel_hi:[1,1,0]
    v_pk_mul_f32 v[226:227], v[226:227], v[24:25]
    v_pk_mul_f32 v[228:229], v[228:229], v[26:27]
    v_exp_f32 v226, v226
    v_exp_f32 v227, v227
    v_exp_f32 v228, v228
    v_exp_f32 v229, v229
    v_pk_fma_f32 v[226:227], v[226:227], v[164:165], v[164:165] op_sel:[0,1,1] op_sel_hi:[1,1,1]
    v_pk_fma_f32 v[228:229], v[228:229], v[164:165], v[164:165] op_sel:[0,1,1] op_sel_hi:[1,1,1]
    v_rcp_f32 v226, v226
    v_rcp_f32 v227, v227
    v_rcp_f32 v228, v228
    v_rcp_f32 v229, v229
    v_pk_mul_f32 v[24:25], v[24:25], v[226:227]
    v_pk_mul_f32 v[26:27], v[26:27], v[228:229]
    v_cvt_pk_bf16_f32 v246, v24, v25
    v_cvt_pk_bf16_f32 v247, v26, v27
    s_add_u32 s36, s46, 0
    buffer_store_dwordx4 v[36:39], v2, s[16:19], s36 offen sc1
    v_pk_fma_f32 v[52:53], v[166:167], v[136:137], v[52:53] op_sel_hi:[0,1,1] neg_lo:[1,0,0] neg_hi:[1,0,0]
    v_pk_fma_f32 v[54:55], v[166:167], v[138:139], v[54:55] op_sel_hi:[0,1,1] neg_lo:[1,0,0] neg_hi:[1,0,0]
    v_pk_mul_f32 v[226:227], v[52:53], v[52:53]
    v_pk_mul_f32 v[228:229], v[54:55], v[54:55]
    v_pk_fma_f32 v[226:227], v[226:227], v[186:187], v[186:187] op_sel:[0,1,0] op_sel_hi:[1,1,0]
    v_pk_fma_f32 v[228:229], v[228:229], v[186:187], v[186:187] op_sel:[0,1,0] op_sel_hi:[1,1,0]
    v_pk_mul_f32 v[226:227], v[226:227], v[52:53]
    v_pk_mul_f32 v[228:229], v[228:229], v[54:55]
    v_exp_f32 v226, v226
    v_exp_f32 v227, v227
    v_exp_f32 v228, v228
    v_exp_f32 v229, v229
    v_pk_fma_f32 v[226:227], v[226:227], v[166:167], v[166:167] op_sel:[0,1,1] op_sel_hi:[1,1,1]
    v_pk_fma_f32 v[228:229], v[228:229], v[166:167], v[166:167] op_sel:[0,1,1] op_sel_hi:[1,1,1]
    v_rcp_f32 v226, v226
    v_rcp_f32 v227, v227
    v_rcp_f32 v228, v228
    v_rcp_f32 v229, v229
    v_pk_mul_f32 v[52:53], v[52:53], v[226:227]
    v_pk_mul_f32 v[54:55], v[54:55], v[228:229]
    v_cvt_pk_bf16_f32 v248, v52, v53
    v_cvt_pk_bf16_f32 v249, v54, v55
    s_add_u32 s36, s46, 229376
    buffer_store_dwordx4 v[64:67], v2, s[16:19], s36 offen sc1
    v_pk_fma_f32 v[80:81], v[168:169], v[136:137], v[80:81] op_sel_hi:[0,1,1] neg_lo:[1,0,0] neg_hi:[1,0,0]
    v_pk_fma_f32 v[82:83], v[168:169], v[138:139], v[82:83] op_sel_hi:[0,1,1] neg_lo:[1,0,0] neg_hi:[1,0,0]
    v_pk_mul_f32 v[226:227], v[80:81], v[80:81]
    v_pk_mul_f32 v[228:229], v[82:83], v[82:83]
    v_pk_fma_f32 v[226:227], v[226:227], v[188:189], v[188:189] op_sel:[0,1,0] op_sel_hi:[1,1,0]
    v_pk_fma_f32 v[228:229], v[228:229], v[188:189], v[188:189] op_sel:[0,1,0] op_sel_hi:[1,1,0]
    v_pk_mul_f32 v[226:227], v[226:227], v[80:81]
    v_pk_mul_f32 v[228:229], v[228:229], v[82:83]
    v_exp_f32 v226, v226
    v_exp_f32 v227, v227
    v_exp_f32 v228, v228
    v_exp_f32 v229, v229
    v_pk_fma_f32 v[226:227], v[226:227], v[168:169], v[168:169] op_sel:[0,1,1] op_sel_hi:[1,1,1]
    v_pk_fma_f32 v[228:229], v[228:229], v[168:169], v[168:169] op_sel:[0,1,1] op_sel_hi:[1,1,1]
    v_rcp_f32 v226, v226
    v_rcp_f32 v227, v227
    v_rcp_f32 v228, v228
    v_rcp_f32 v229, v229
    v_pk_mul_f32 v[80:81], v[80:81], v[226:227]
    v_pk_mul_f32 v[82:83], v[82:83], v[228:229]
    v_cvt_pk_bf16_f32 v250, v80, v81
    v_cvt_pk_bf16_f32 v251, v82, v83
    s_add_u32 s36, s46, 458752
    buffer_store_dwordx4 v[92:95], v2, s[16:19], s36 offen sc1
    v_pk_fma_f32 v[108:109], v[170:171], v[136:137], v[108:109] op_sel_hi:[0,1,1] neg_lo:[1,0,0] neg_hi:[1,0,0]
    v_pk_fma_f32 v[110:111], v[170:171], v[138:139], v[110:111] op_sel_hi:[0,1,1] neg_lo:[1,0,0] neg_hi:[1,0,0]
    v_pk_mul_f32 v[226:227], v[108:109], v[108:109]
    v_pk_mul_f32 v[228:229], v[110:111], v[110:111]
    v_pk_fma_f32 v[226:227], v[226:227], v[190:191], v[190:191] op_sel:[0,1,0] op_sel_hi:[1,1,0]
    v_pk_fma_f32 v[228:229], v[228:229], v[190:191], v[190:191] op_sel:[0,1,0] op_sel_hi:[1,1,0]
    v_pk_mul_f32 v[226:227], v[226:227], v[108:109]
    v_pk_mul_f32 v[228:229], v[228:229], v[110:111]
    v_exp_f32 v226, v226
    v_exp_f32 v227, v227
    v_exp_f32 v228, v228
    v_exp_f32 v229, v229
    v_pk_fma_f32 v[226:227], v[226:227], v[170:171], v[170:171] op_sel:[0,1,1] op_sel_hi:[1,1,1]
    v_pk_fma_f32 v[228:229], v[228:229], v[170:171], v[170:171] op_sel:[0,1,1] op_sel_hi:[1,1,1]
    v_rcp_f32 v226, v226
    v_rcp_f32 v227, v227
    v_rcp_f32 v228, v228
    v_rcp_f32 v229, v229
    v_pk_mul_f32 v[108:109], v[108:109], v[226:227]
    v_pk_mul_f32 v[110:111], v[110:111], v[228:229]
    v_cvt_pk_bf16_f32 v252, v108, v109
    v_cvt_pk_bf16_f32 v253, v110, v111
    s_add_u32 s36, s46, 688128
    buffer_store_dwordx4 v[120:123], v2, s[16:19], s36 offen sc1
    s_waitcnt lgkmcnt(0)
    s_add_u32 s45, s44, 512
    s_mov_b32 s44, s47
G3_e2:
    s_lshr_b32 s34, s30, 1
    s_and_b32 s35, s30, 1
    v_and_b32 v22, 15, v1
    v_lshrrev_b32 v23, 4, v1
    s_mul_i32 s37, s34, 4
    s_mul_i32 s38, s33, 8
    s_mul_i32 s36, s35, 4
    s_add_u32 s38, s38, s36
    s_lshr_b32 s36, s38, 1
    s_lshr_b32 s53, s36, 3
    s_lshl_b32 s53, s53, 14
    s_and_b32 s39, s36, 7
    s_lshl_b32 s39, s39, 10
    s_add_u32 s39, s39, s53
    s_lshl_b32 s36, s37, 16
    s_add_u32 s39, s39, s36
    s_mul_i32 s36, s34, 8192
    v_add_u32 v12, s36, v2
    v_lshrrev_b32 v6, 2, v1
    v_mul_u32_u24 v13, 256, v6
    v_and_b32 v7, 3, v1
    v_lshl_add_u32 v13, v7, 3, v13
    v_add_u32 v13, 49152, v13
    v_and_b32 v6, 7, v6
    s_mul_i32 s36, s35, 4
    s_add_u32 s36, s36, 3
    v_xor_b32 v7, s36, v6
    v_lshl_add_u32 v16, v7, 5, v13
    s_mul_i32 s36, s35, 4
    s_add_u32 s36, s36, 2
    v_xor_b32 v7, s36, v6
    v_lshl_add_u32 v15, v7, 5, v13
    s_mul_i32 s36, s35, 4
    s_add_u32 s36, s36, 1
    v_xor_b32 v7, s36, v6
    v_lshl_add_u32 v14, v7, 5, v13
    s_mul_i32 s36, s35, 4
    s_add_u32 s36, s36, 0
    v_xor_b32 v7, s36, v6
    v_lshl_add_u32 v13, v7, 5, v13
    s_mov_b32 s42, 0
    s_mov_b32 s43, 0
    s_mov_b32 s48, 0
    v_mov_b32 v17, v12
    v_mov_b32 v18, v13
    v_mov_b32 v19, v14
    v_mov_b32 v20, v15
    v_mov_b32 v21, v16
    s_waitcnt lgkmcnt(0)
    s_barrier
    ds_read_b128 v[24:27], v17 offset:0
    ds_read_b128 v[28:31], v17 offset:2048
    ds_read_b128 v[32:35], v17 offset:4096
    ds_read_b128 v[36:39], v17 offset:6144
    ds_read_b64_tr_b16 v[40:41], v18 offset:0
    ds_read_b64_tr_b16 v[42:43], v18 offset:4096
    ds_read_b64_tr_b16 v[44:45], v19 offset:0
    ds_read_b64_tr_b16 v[46:47], v19 offset:4096
    ds_read_b64_tr_b16 v[48:49], v20 offset:0
    ds_read_b64_tr_b16 v[50:51], v20 offset:4096
    ds_read_b64_tr_b16 v[52:53], v21 offset:0
    ds_read_b64_tr_b16 v[54:55], v21 offset:4096
    s_waitcnt lgkmcnt(0)
    v_mfma_f32_16x16x32_bf16 v[120:123], v[40:43], v[24:27], 0
    ds_read_b128 v[184:187], v17 offset:1024
    ds_read_b128 v[188:191], v17 offset:3072
    v_mfma_f32_16x16x32_bf16 v[136:139], v[40:43], v[28:31], 0
    ds_read_b128 v[192:195], v17 offset:5120
    v_mfma_f32_16x16x32_bf16 v[152:155], v[40:43], v[32:35], 0
    ds_read_b128 v[196:199], v17 offset:7168
    v_mfma_f32_16x16x32_bf16 v[168:171], v[40:43], v[36:39], 0
    s_add_u32 s36, s44, 0
    buffer_store_dwordx4 v[230:233], v2, s[16:19], s36 offen sc1
    v_mfma_f32_16x16x32_bf16 v[172:175], v[44:47], v[36:39], 0
    ds_read_b64_tr_b16 v[200:201], v18 offset:8192
    v_mfma_f32_16x16x32_bf16 v[156:159], v[44:47], v[32:35], 0
    ds_read_b64_tr_b16 v[202:203], v18 offset:12288
    v_mfma_f32_16x16x32_bf16 v[140:143], v[44:47], v[28:31], 0
    ds_read_b64_tr_b16 v[204:205], v19 offset:8192
    s_add_u32 s36, s45, 0
    buffer_store_dwordx2 v[246:247], v254, s[16:19], s36 offen sc1
    v_mfma_f32_16x16x32_bf16 v[124:127], v[44:47], v[24:27], 0
    ds_read_b64_tr_b16 v[206:207], v19 offset:12288
    v_mfma_f32_16x16x32_bf16 v[128:131], v[48:51], v[24:27], 0
    ds_read_b64_tr_b16 v[208:209], v20 offset:8192
    v_mfma_f32_16x16x32_bf16 v[144:147], v[48:51], v[28:31], 0
    ds_read_b64_tr_b16 v[210:211], v20 offset:12288
    v_mfma_f32_16x16x32_bf16 v[160:163], v[48:51], v[32:35], 0
    ds_read_b64_tr_b16 v[212:213], v21 offset:8192
    v_mfma_f32_16x16x32_bf16 v[176:179], v[48:51], v[36:39], 0
    ds_read_b64_tr_b16 v[214:215], v21 offset:12288
    s_add_u32 s42, s42, 16384
    s_cmp_eq_u32 s42, 49152
    s_cselect_b32 s42, 0, s42
    v_mfma_f32_16x16x32_bf16 v[180:183], v[52:55], v[36:39], 0
    s_add_u32 s48, s48, 16384
    s_cmp_eq_u32 s48, 98304
    s_cselect_b32 s48, 0, s48
    v_mfma_f32_16x16x32_bf16 v[164:167], v[52:55], v[32:35], 0
    v_add_u32 v17, s42, v12
    v_add_u32 v18, s48, v13
    v_add_u32 v19, s48, v14
    v_mfma_f32_16x16x32_bf16 v[148:151], v[52:55], v[28:31], 0
    v_add_u32 v20, s48, v15
    v_add_u32 v21, s48, v16
    v_mfma_f32_16x16x32_bf16 v[132:135], v[52:55], v[24:27], 0
    s_waitcnt lgkmcnt(0)
    s_barrier
    v_mfma_f32_16x16x32_bf16 v[120:123], v[200:203], v[184:187], v[120:123]
    ds_read_b128 v[24:27], v17 offset:0
    ds_read_b128 v[28:31], v17 offset:2048
    v_mfma_f32_16x16x32_bf16 v[136:139], v[200:203], v[188:191], v[136:139]
    ds_read_b128 v[32:35], v17 offset:4096
    v_mfma_f32_16x16x32_bf16 v[152:155], v[200:203], v[192:195], v[152:155]
    ds_read_b128 v[36:39], v17 offset:6144
    v_mfma_f32_16x16x32_bf16 v[168:171], v[200:203], v[196:199], v[168:171]
    s_add_u32 s36, s44, 229376
    buffer_store_dwordx4 v[234:237], v2, s[16:19], s36 offen sc1
    v_mfma_f32_16x16x32_bf16 v[172:175], v[204:207], v[196:199], v[172:175]
    ds_read_b64_tr_b16 v[40:41], v18 offset:0
    v_mfma_f32_16x16x32_bf16 v[156:159], v[204:207], v[192:195], v[156:159]
    ds_read_b64_tr_b16 v[42:43], v18 offset:4096
    v_mfma_f32_16x16x32_bf16 v[140:143], v[204:207], v[188:191], v[140:143]
    ds_read_b64_tr_b16 v[44:45], v19 offset:0
    s_add_u32 s36, s45, 229376
    buffer_store_dwordx2 v[248:249], v254, s[16:19], s36 offen sc1
    v_mfma_f32_16x16x32_bf16 v[124:127], v[204:207], v[184:187], v[124:127]
    ds_read_b64_tr_b16 v[46:47], v19 offset:4096
    v_mfma_f32_16x16x32_bf16 v[128:131], v[208:211], v[184:187], v[128:131]
    ds_read_b64_tr_b16 v[48:49], v20 offset:0
    v_mfma_f32_16x16x32_bf16 v[144:147], v[208:211], v[188:191], v[144:147]
    ds_read_b64_tr_b16 v[50:51], v20 offset:4096
    v_mfma_f32_16x16x32_bf16 v[160:163], v[208:211], v[192:195], v[160:163]
    ds_read_b64_tr_b16 v[52:53], v21 offset:0
    v_mfma_f32_16x16x32_bf16 v[176:179], v[208:211], v[196:199], v[176:179]
    ds_read_b64_tr_b16 v[54:55], v21 offset:4096
    s_add_u32 s43, s43, 1
    v_mfma_f32_16x16x32_bf16 v[180:183], v[212:215], v[196:199], v[180:183]
    s_cmp_lt_u32 s43, 27
    v_mfma_f32_16x16x32_bf16 v[164:167], v[212:215], v[192:195], v[164:167]
    v_mfma_f32_16x16x32_bf16 v[148:151], v[212:215], v[188:191], v[148:151]
    v_mfma_f32_16x16x32_bf16 v[132:135], v[212:215], v[184:187], v[132:135]
    s_waitcnt lgkmcnt(0)
    v_mfma_f32_16x16x32_bf16 v[120:123], v[40:43], v[24:27], v[120:123]
    ds_read_b128 v[184:187], v17 offset:1024
    ds_read_b128 v[188:191], v17 offset:3072
    v_mfma_f32_16x16x32_bf16 v[136:139], v[40:43], v[28:31], v[136:139]
    ds_read_b128 v[192:195], v17 offset:5120
    v_mfma_f32_16x16x32_bf16 v[152:155], v[40:43], v[32:35], v[152:155]
    ds_read_b128 v[196:199], v17 offset:7168
    v_mfma_f32_16x16x32_bf16 v[168:171], v[40:43], v[36:39], v[168:171]
    s_add_u32 s36, s44, 458752
    buffer_store_dwordx4 v[238:241], v2, s[16:19], s36 offen sc1
    v_mfma_f32_16x16x32_bf16 v[172:175], v[44:47], v[36:39], v[172:175]
    ds_read_b64_tr_b16 v[200:201], v18 offset:8192
    v_mfma_f32_16x16x32_bf16 v[156:159], v[44:47], v[32:35], v[156:159]
    ds_read_b64_tr_b16 v[202:203], v18 offset:12288
    v_mfma_f32_16x16x32_bf16 v[140:143], v[44:47], v[28:31], v[140:143]
    ds_read_b64_tr_b16 v[204:205], v19 offset:8192
    s_add_u32 s36, s45, 458752
    buffer_store_dwordx2 v[250:251], v254, s[16:19], s36 offen sc1
    v_mfma_f32_16x16x32_bf16 v[124:127], v[44:47], v[24:27], v[124:127]
    ds_read_b64_tr_b16 v[206:207], v19 offset:12288
    v_mfma_f32_16x16x32_bf16 v[128:131], v[48:51], v[24:27], v[128:131]
    ds_read_b64_tr_b16 v[208:209], v20 offset:8192
    v_mfma_f32_16x16x32_bf16 v[144:147], v[48:51], v[28:31], v[144:147]
    ds_read_b64_tr_b16 v[210:211], v20 offset:12288
    v_mfma_f32_16x16x32_bf16 v[160:163], v[48:51], v[32:35], v[160:163]
    ds_read_b64_tr_b16 v[212:213], v21 offset:8192
    v_mfma_f32_16x16x32_bf16 v[176:179], v[48:51], v[36:39], v[176:179]
    ds_read_b64_tr_b16 v[214:215], v21 offset:12288
    s_add_u32 s42, s42, 16384
    s_cmp_eq_u32 s42, 49152
    s_cselect_b32 s42, 0, s42
    v_mfma_f32_16x16x32_bf16 v[180:183], v[52:55], v[36:39], v[180:183]
    s_add_u32 s48, s48, 16384
    s_cmp_eq_u32 s48, 98304
    s_cselect_b32 s48, 0, s48
    v_mfma_f32_16x16x32_bf16 v[164:167], v[52:55], v[32:35], v[164:167]
    v_add_u32 v17, s42, v12
    v_add_u32 v18, s48, v13
    v_add_u32 v19, s48, v14
    v_mfma_f32_16x16x32_bf16 v[148:151], v[52:55], v[28:31], v[148:151]
    v_add_u32 v20, s48, v15
    v_add_u32 v21, s48, v16
    v_mfma_f32_16x16x32_bf16 v[132:135], v[52:55], v[24:27], v[132:135]
    s_waitcnt lgkmcnt(0)
    s_barrier
    v_mfma_f32_16x16x32_bf16 v[120:123], v[200:203], v[184:187], v[120:123]
    ds_read_b128 v[24:27], v17 offset:0
    ds_read_b128 v[28:31], v17 offset:2048
    v_mfma_f32_16x16x32_bf16 v[136:139], v[200:203], v[188:191], v[136:139]
    ds_read_b128 v[32:35], v17 offset:4096
    v_mfma_f32_16x16x32_bf16 v[152:155], v[200:203], v[192:195], v[152:155]
    ds_read_b128 v[36:39], v17 offset:6144
    v_mfma_f32_16x16x32_bf16 v[168:171], v[200:203], v[196:199], v[168:171]
    s_add_u32 s36, s44, 688128
    buffer_store_dwordx4 v[242:245], v2, s[16:19], s36 offen sc1
    v_mfma_f32_16x16x32_bf16 v[172:175], v[204:207], v[196:199], v[172:175]
    ds_read_b64_tr_b16 v[40:41], v18 offset:0
    v_mfma_f32_16x16x32_bf16 v[156:159], v[204:207], v[192:195], v[156:159]
    ds_read_b64_tr_b16 v[42:43], v18 offset:4096
    v_mfma_f32_16x16x32_bf16 v[140:143], v[204:207], v[188:191], v[140:143]
    ds_read_b64_tr_b16 v[44:45], v19 offset:0
    s_add_u32 s36, s45, 688128
    buffer_store_dwordx2 v[252:253], v254, s[16:19], s36 offen sc1
    v_mfma_f32_16x16x32_bf16 v[124:127], v[204:207], v[184:187], v[124:127]
    ds_read_b64_tr_b16 v[46:47], v19 offset:4096
    v_mfma_f32_16x16x32_bf16 v[128:131], v[208:211], v[184:187], v[128:131]
    ds_read_b64_tr_b16 v[48:49], v20 offset:0
    v_mfma_f32_16x16x32_bf16 v[144:147], v[208:211], v[188:191], v[144:147]
    ds_read_b64_tr_b16 v[50:51], v20 offset:4096
    v_mfma_f32_16x16x32_bf16 v[160:163], v[208:211], v[192:195], v[160:163]
    ds_read_b64_tr_b16 v[52:53], v21 offset:0
    v_mfma_f32_16x16x32_bf16 v[176:179], v[208:211], v[196:199], v[176:179]
    ds_read_b64_tr_b16 v[54:55], v21 offset:4096
    s_add_u32 s43, s43, 1
    v_mfma_f32_16x16x32_bf16 v[180:183], v[212:215], v[196:199], v[180:183]
    s_cmp_lt_u32 s43, 27
    v_mfma_f32_16x16x32_bf16 v[164:167], v[212:215], v[192:195], v[164:167]
    v_mfma_f32_16x16x32_bf16 v[148:151], v[212:215], v[188:191], v[148:151]
    v_mfma_f32_16x16x32_bf16 v[132:135], v[212:215], v[184:187], v[132:135]
    s_add_u32 s53, s55, 1536
    s_lshl_b32 s54, s31, 7
    s_add_u32 s53, s53, s54
    v_mov_b32 v8, 1
    v_mov_b32 v9, 162816
    v_mov_b32 v11, 0
    s_mov_b64 exec, 1
    s_waitcnt vmcnt(8)
    ds_add_rtn_u32 v10, v9, v8
    s_waitcnt lgkmcnt(0)
    v_readfirstlane_b32 s54, v10
    s_nop 0
    s_and_b32 s54, s54, 3
    s_cmp_lg_u32 s54, 3
    s_cbranch_scc1 pub_34
    buffer_atomic_add v8, v11, s[56:59], s53 offen sc1
pub_34:
    s_mov_b64 exec, -1
mm_35:
    s_waitcnt lgkmcnt(0)
    v_mfma_f32_16x16x32_bf16 v[120:123], v[40:43], v[24:27], v[120:123]
    ds_read_b128 v[184:187], v17 offset:1024
    v_mfma_f32_16x16x32_bf16 v[136:139], v[40:43], v[28:31], v[136:139]
    ds_read_b128 v[188:191], v17 offset:3072
    v_mfma_f32_16x16x32_bf16 v[152:155], v[40:43], v[32:35], v[152:155]
    ds_read_b128 v[192:195], v17 offset:5120
    v_mfma_f32_16x16x32_bf16 v[168:171], v[40:43], v[36:39], v[168:171]
    ds_read_b128 v[196:199], v17 offset:7168
    v_mfma_f32_16x16x32_bf16 v[172:175], v[44:47], v[36:39], v[172:175]
    ds_read_b64_tr_b16 v[200:201], v18 offset:8192
    v_mfma_f32_16x16x32_bf16 v[156:159], v[44:47], v[32:35], v[156:159]
    ds_read_b64_tr_b16 v[202:203], v18 offset:12288
    v_mfma_f32_16x16x32_bf16 v[140:143], v[44:47], v[28:31], v[140:143]
    ds_read_b64_tr_b16 v[204:205], v19 offset:8192
    v_mfma_f32_16x16x32_bf16 v[124:127], v[44:47], v[24:27], v[124:127]
    ds_read_b64_tr_b16 v[206:207], v19 offset:12288
    v_mfma_f32_16x16x32_bf16 v[128:131], v[48:51], v[24:27], v[128:131]
    ds_read_b64_tr_b16 v[208:209], v20 offset:8192
    v_mfma_f32_16x16x32_bf16 v[144:147], v[48:51], v[28:31], v[144:147]
    ds_read_b64_tr_b16 v[210:211], v20 offset:12288
    v_mfma_f32_16x16x32_bf16 v[160:163], v[48:51], v[32:35], v[160:163]
    ds_read_b64_tr_b16 v[212:213], v21 offset:8192
    v_mfma_f32_16x16x32_bf16 v[176:179], v[48:51], v[36:39], v[176:179]
    ds_read_b64_tr_b16 v[214:215], v21 offset:12288
    s_add_u32 s42, s42, 16384
    s_cmp_eq_u32 s42, 49152
    s_cselect_b32 s42, 0, s42
    v_mfma_f32_16x16x32_bf16 v[180:183], v[52:55], v[36:39], v[180:183]
    s_add_u32 s48, s48, 16384
    s_cmp_eq_u32 s48, 98304
    s_cselect_b32 s48, 0, s48
    v_mfma_f32_16x16x32_bf16 v[164:167], v[52:55], v[32:35], v[164:167]
    v_add_u32 v17, s42, v12
    v_add_u32 v18, s48, v13
    v_add_u32 v19, s48, v14
    v_mfma_f32_16x16x32_bf16 v[148:151], v[52:55], v[28:31], v[148:151]
    v_add_u32 v20, s48, v15
    v_add_u32 v21, s48, v16
    v_mfma_f32_16x16x32_bf16 v[132:135], v[52:55], v[24:27], v[132:135]
    s_waitcnt lgkmcnt(0)
    s_barrier
    v_mfma_f32_16x16x32_bf16 v[120:123], v[200:203], v[184:187], v[120:123]
    ds_read_b128 v[24:27], v17 offset:0
    v_mfma_f32_16x16x32_bf16 v[136:139], v[200:203], v[188:191], v[136:139]
    ds_read_b128 v[28:31], v17 offset:2048
    v_mfma_f32_16x16x32_bf16 v[152:155], v[200:203], v[192:195], v[152:155]
    ds_read_b128 v[32:35], v17 offset:4096
    v_mfma_f32_16x16x32_bf16 v[168:171], v[200:203], v[196:199], v[168:171]
    ds_read_b128 v[36:39], v17 offset:6144
    v_mfma_f32_16x16x32_bf16 v[172:175], v[204:207], v[196:199], v[172:175]
    ds_read_b64_tr_b16 v[40:41], v18 offset:0
    v_mfma_f32_16x16x32_bf16 v[156:159], v[204:207], v[192:195], v[156:159]
    ds_read_b64_tr_b16 v[42:43], v18 offset:4096
    v_mfma_f32_16x16x32_bf16 v[140:143], v[204:207], v[188:191], v[140:143]
    ds_read_b64_tr_b16 v[44:45], v19 offset:0
    v_mfma_f32_16x16x32_bf16 v[124:127], v[204:207], v[184:187], v[124:127]
    ds_read_b64_tr_b16 v[46:47], v19 offset:4096
    v_mfma_f32_16x16x32_bf16 v[128:131], v[208:211], v[184:187], v[128:131]
    ds_read_b64_tr_b16 v[48:49], v20 offset:0
    v_mfma_f32_16x16x32_bf16 v[144:147], v[208:211], v[188:191], v[144:147]
    ds_read_b64_tr_b16 v[50:51], v20 offset:4096
    v_mfma_f32_16x16x32_bf16 v[160:163], v[208:211], v[192:195], v[160:163]
    ds_read_b64_tr_b16 v[52:53], v21 offset:0
    v_mfma_f32_16x16x32_bf16 v[176:179], v[208:211], v[196:199], v[176:179]
    ds_read_b64_tr_b16 v[54:55], v21 offset:4096
    s_add_u32 s43, s43, 1
    v_mfma_f32_16x16x32_bf16 v[180:183], v[212:215], v[196:199], v[180:183]
    s_cmp_lt_u32 s43, 4
    v_mfma_f32_16x16x32_bf16 v[164:167], v[212:215], v[192:195], v[164:167]
    v_mfma_f32_16x16x32_bf16 v[148:151], v[212:215], v[188:191], v[148:151]
    v_mfma_f32_16x16x32_bf16 v[132:135], v[212:215], v[184:187], v[132:135]
    s_cbranch_scc1 mm_35
    s_add_u32 s53, s55, 768
    s_lshl_b32 s54, s31, 7
    s_add_u32 s53, s53, s54
    v_mov_b32 v8, 1
    v_mov_b32 v9, 162816
    v_mov_b32 v11, 0
    s_mov_b64 exec, 1
    s_waitcnt vmcnt(0)
    ds_add_rtn_u32 v10, v9, v8
    s_waitcnt lgkmcnt(0)
    v_readfirstlane_b32 s54, v10
    s_nop 0
    s_and_b32 s54, s54, 3
    s_cmp_lg_u32 s54, 3
    s_cbranch_scc1 pub_36
    buffer_atomic_add v8, v11, s[56:59], s53 offen sc1
pub_36:
    s_mov_b64 exec, -1
mm_37:
    s_waitcnt lgkmcnt(0)
    v_mfma_f32_16x16x32_bf16 v[120:123], v[40:43], v[24:27], v[120:123]
    ds_read_b128 v[184:187], v17 offset:1024
    v_mfma_f32_16x16x32_bf16 v[136:139], v[40:43], v[28:31], v[136:139]
    ds_read_b128 v[188:191], v17 offset:3072
    v_mfma_f32_16x16x32_bf16 v[152:155], v[40:43], v[32:35], v[152:155]
    ds_read_b128 v[192:195], v17 offset:5120
    v_mfma_f32_16x16x32_bf16 v[168:171], v[40:43], v[36:39], v[168:171]
    ds_read_b128 v[196:199], v17 offset:7168
    v_mfma_f32_16x16x32_bf16 v[172:175], v[44:47], v[36:39], v[172:175]
    ds_read_b64_tr_b16 v[200:201], v18 offset:8192
    v_mfma_f32_16x16x32_bf16 v[156:159], v[44:47], v[32:35], v[156:159]
    ds_read_b64_tr_b16 v[202:203], v18 offset:12288
    v_mfma_f32_16x16x32_bf16 v[140:143], v[44:47], v[28:31], v[140:143]
    ds_read_b64_tr_b16 v[204:205], v19 offset:8192
    v_mfma_f32_16x16x32_bf16 v[124:127], v[44:47], v[24:27], v[124:127]
    ds_read_b64_tr_b16 v[206:207], v19 offset:12288
    v_mfma_f32_16x16x32_bf16 v[128:131], v[48:51], v[24:27], v[128:131]
    ds_read_b64_tr_b16 v[208:209], v20 offset:8192
    v_mfma_f32_16x16x32_bf16 v[144:147], v[48:51], v[28:31], v[144:147]
    ds_read_b64_tr_b16 v[210:211], v20 offset:12288
    v_mfma_f32_16x16x32_bf16 v[160:163], v[48:51], v[32:35], v[160:163]
    ds_read_b64_tr_b16 v[212:213], v21 offset:8192
    v_mfma_f32_16x16x32_bf16 v[176:179], v[48:51], v[36:39], v[176:179]
    ds_read_b64_tr_b16 v[214:215], v21 offset:12288
    s_add_u32 s42, s42, 16384
    s_cmp_eq_u32 s42, 49152
    s_cselect_b32 s42, 0, s42
    v_mfma_f32_16x16x32_bf16 v[180:183], v[52:55], v[36:39], v[180:183]
    s_add_u32 s48, s48, 16384
    s_cmp_eq_u32 s48, 98304
    s_cselect_b32 s48, 0, s48
    v_mfma_f32_16x16x32_bf16 v[164:167], v[52:55], v[32:35], v[164:167]
    v_add_u32 v17, s42, v12
    v_add_u32 v18, s48, v13
    v_add_u32 v19, s48, v14
    v_mfma_f32_16x16x32_bf16 v[148:151], v[52:55], v[28:31], v[148:151]
    v_add_u32 v20, s48, v15
    v_add_u32 v21, s48, v16
    v_mfma_f32_16x16x32_bf16 v[132:135], v[52:55], v[24:27], v[132:135]
    s_waitcnt lgkmcnt(0)
    s_barrier
    v_mfma_f32_16x16x32_bf16 v[120:123], v[200:203], v[184:187], v[120:123]
    ds_read_b128 v[24:27], v17 offset:0
    v_mfma_f32_16x16x32_bf16 v[136:139], v[200:203], v[188:191], v[136:139]
    ds_read_b128 v[28:31], v17 offset:2048
    v_mfma_f32_16x16x32_bf16 v[152:155], v[200:203], v[192:195], v[152:155]
    ds_read_b128 v[32:35], v17 offset:4096
    v_mfma_f32_16x16x32_bf16 v[168:171], v[200:203], v[196:199], v[168:171]
    ds_read_b128 v[36:39], v17 offset:6144
    v_mfma_f32_16x16x32_bf16 v[172:175], v[204:207], v[196:199], v[172:175]
    ds_read_b64_tr_b16 v[40:41], v18 offset:0
    v_mfma_f32_16x16x32_bf16 v[156:159], v[204:207], v[192:195], v[156:159]
    ds_read_b64_tr_b16 v[42:43], v18 offset:4096
    v_mfma_f32_16x16x32_bf16 v[140:143], v[204:207], v[188:191], v[140:143]
    ds_read_b64_tr_b16 v[44:45], v19 offset:0
    v_mfma_f32_16x16x32_bf16 v[124:127], v[204:207], v[184:187], v[124:127]
    ds_read_b64_tr_b16 v[46:47], v19 offset:4096
    v_mfma_f32_16x16x32_bf16 v[128:131], v[208:211], v[184:187], v[128:131]
    ds_read_b64_tr_b16 v[48:49], v20 offset:0
    v_mfma_f32_16x16x32_bf16 v[144:147], v[208:211], v[188:191], v[144:147]
    ds_read_b64_tr_b16 v[50:51], v20 offset:4096
    v_mfma_f32_16x16x32_bf16 v[160:163], v[208:211], v[192:195], v[160:163]
    ds_read_b64_tr_b16 v[52:53], v21 offset:0
    v_mfma_f32_16x16x32_bf16 v[176:179], v[208:211], v[196:199], v[176:179]
    ds_read_b64_tr_b16 v[54:55], v21 offset:4096
    s_add_u32 s43, s43, 1
    v_mfma_f32_16x16x32_bf16 v[180:183], v[212:215], v[196:199], v[180:183]
    s_cmp_lt_u32 s43, 27
    v_mfma_f32_16x16x32_bf16 v[164:167], v[212:215], v[192:195], v[164:167]
    v_mfma_f32_16x16x32_bf16 v[148:151], v[212:215], v[188:191], v[148:151]
    v_mfma_f32_16x16x32_bf16 v[132:135], v[212:215], v[184:187], v[132:135]
    s_cbranch_scc1 mm_37
    s_waitcnt lgkmcnt(0)
    s_cmp_eq_u32 s60, 1
    s_cbranch_scc1 G4_last
    v_mfma_f32_16x16x32_bf16 v[120:123], v[40:43], v[24:27], v[120:123]
    ds_read_b128 v[184:187], v17 offset:1024
    ds_read_b128 v[188:191], v17 offset:3072
    ds_read_b128 v[192:195], v17 offset:5120
    ds_read_b128 v[196:199], v17 offset:7168
    ds_read_b64_tr_b16 v[200:201], v18 offset:8192
    ds_read_b64_tr_b16 v[202:203], v18 offset:12288
    ds_read_b64_tr_b16 v[204:205], v19 offset:8192
    v_mfma_f32_16x16x32_bf16 v[136:139], v[40:43], v[28:31], v[136:139]
    ds_read_b64_tr_b16 v[206:207], v19 offset:12288
    ds_read_b64_tr_b16 v[208:209], v20 offset:8192
    ds_read_b64_tr_b16 v[210:211], v20 offset:12288
    ds_read_b64_tr_b16 v[212:213], v21 offset:8192
    ds_read_b64_tr_b16 v[214:215], v21 offset:12288
    v_and_b32 v81, 7, v0
    v_mfma_f32_16x16x32_bf16 v[152:155], v[40:43], v[32:35], v[152:155]
    v_lshrrev_b32 v84, 6, v0
    v_lshlrev_b32 v84, 4, v84
    v_bfe_u32 v85, v0, 3, 3
    v_add_u32 v84, v84, v85
    s_lshr_b32 s78, s29, 1
    s_lshl_b32 s78, s78, 16
    v_mfma_f32_16x16x32_bf16 v[168:171], v[40:43], v[36:39], v[168:171]
    s_and_b32 s79, s29, 1
    s_lshl_b32 s79, s79, 7
    s_add_u32 s78, s78, s79
    s_lshr_b32 s79, s30, 1
    s_lshl_b32 s79, s79, 13
    s_add_u32 s78, s78, s79
    v_mfma_f32_16x16x32_bf16 v[172:175], v[44:47], v[36:39], v[172:175]
    v_lshlrev_b32 v78, 8, v84
    v_lshl_add_u32 v78, v81, 4, v78
    v_add_u32 v78, s78, v78
    s_lshl_b32 s78, s28, 7
    s_lshl_b32 s79, s29, 3
    s_add_u32 s78, s78, s79
    v_mfma_f32_16x16x32_bf16 v[156:159], v[44:47], v[32:35], v[156:159]
    v_add_u32 v79, s78, v81
    v_lshlrev_b32 v80, 11, v79
    v_and_b32 v85, 3, v79
    v_lshrrev_b32 v82, 2, v79
    v_lshlrev_b32 v82, 14, v82
    v_lshl_add_u32 v82, v85, 11, v82
    v_mfma_f32_16x16x32_bf16 v[140:143], v[44:47], v[28:31], v[140:143]
    v_lshl_add_u32 v82, v84, 4, v82
    v_lshrrev_b32 v85, 2, v84
    v_lshlrev_b32 v85, 3, v85
    v_and_b32 v84, 3, v84
    v_add_u32 v84, v84, v85
    v_lshl_add_u32 v80, v84, 3, v80
    v_mfma_f32_16x16x32_bf16 v[124:127], v[44:47], v[24:27], v[124:127]
    v_lshlrev_b32 v79, 3, v79
    v_lshl_add_u32 v79, v84, 14, v79
    s_lshl_b32 s86, s60, 24
    s_lshl_b32 s87, s94, 13
    s_add_u32 s86, s86, s87
    s_add_u32 s86, s86, 167772160
    v_mfma_f32_16x16x32_bf16 v[128:131], v[48:51], v[24:27], v[128:131]
    s_add_u32 s84, s4, s86
    s_addc_u32 s85, s5, 0
    s_mov_b32 s86, 8380416
    s_mov_b32 s87, 0x20000
    s_add_u32 s88, s62, 0x480000
    s_addc_u32 s89, s63, 0
    v_mfma_f32_16x16x32_bf16 v[144:147], v[48:51], v[28:31], v[144:147]
    s_mov_b32 s90, 0x7e000
    s_mov_b32 s91, 0x20000
    buffer_load_dwordx4 v[86:89], v82, s[84:87], 0 offen offset:0 sc1
    buffer_load_dwordx4 v[94:97], v78, s[88:91], 0 offen offset:0 sc1
    buffer_load_dwordx4 v[90:93], v82, s[84:87], 0 offen offset:128 sc1
    buffer_load_dwordx4 v[98:101], v78, s[88:91], 0 offen offset:2048 sc1
    v_mfma_f32_16x16x32_bf16 v[160:163], v[48:51], v[32:35], v[160:163]
    s_add_u32 s80, s4, 0x1c00000
    s_addc_u32 s81, s5, 0
    s_mov_b32 s82, 0x400000
    s_mov_b32 s83, 0x20000
    s_mov_b32 s78, 0
    buffer_load_dwordx2 v[110:111], v79, s[80:83], s78 offen sc1
    v_mfma_f32_16x16x32_bf16 v[176:179], v[48:51], v[36:39], v[176:179]
    s_mov_b32 s78, 65536
    buffer_load_dwordx2 v[112:113], v79, s[80:83], s78 offen sc1
    s_mov_b32 s78, 262144
    buffer_load_dwordx2 v[114:115], v79, s[80:83], s78 offen sc1
    s_mov_b32 s78, 327680
    buffer_load_dwordx2 v[116:117], v79, s[80:83], s78 offen sc1
    v_mfma_f32_16x16x32_bf16 v[180:183], v[52:55], v[36:39], v[180:183]
    v_mfma_f32_16x16x32_bf16 v[164:167], v[52:55], v[32:35], v[164:167]
    v_mfma_f32_16x16x32_bf16 v[148:151], v[52:55], v[28:31], v[148:151]
    v_mfma_f32_16x16x32_bf16 v[132:135], v[52:55], v[24:27], v[132:135]
    s_waitcnt lgkmcnt(0)
    v_mfma_f32_16x16x32_bf16 v[120:123], v[200:203], v[184:187], v[120:123]
    s_mul_i32 s36, s31, 524288
    v_mfma_f32_16x16x32_bf16 v[136:139], v[200:203], v[188:191], v[136:139]
    v_mfma_f32_16x16x32_bf16 v[152:155], v[200:203], v[192:195], v[152:155]
    s_add_u32 s36, s36, 5242880
    v_mfma_f32_16x16x32_bf16 v[168:171], v[200:203], v[196:199], v[168:171]
    v_mfma_f32_16x16x32_bf16 v[172:175], v[204:207], v[196:199], v[172:175]
    s_add_u32 s16, s62, s36
    v_mfma_f32_16x16x32_bf16 v[156:159], v[204:207], v[192:195], v[156:159]
    v_mfma_f32_16x16x32_bf16 v[140:143], v[204:207], v[188:191], v[140:143]
    s_addc_u32 s17, s63, 0
    v_mfma_f32_16x16x32_bf16 v[124:127], v[204:207], v[184:187], v[124:127]
    v_mfma_f32_16x16x32_bf16 v[128:131], v[208:211], v[184:187], v[128:131]
    s_mov_b32 s18, 516096
    v_mfma_f32_16x16x32_bf16 v[144:147], v[208:211], v[188:191], v[144:147]
    v_mfma_f32_16x16x32_bf16 v[160:163], v[208:211], v[192:195], v[160:163]
    s_mov_b32 s19, 0x20000
    v_mfma_f32_16x16x32_bf16 v[176:179], v[208:211], v[196:199], v[176:179]
    v_mfma_f32_16x16x32_bf16 v[180:183], v[212:215], v[196:199], v[180:183]
    v_mfma_f32_16x16x32_bf16 v[164:167], v[212:215], v[192:195], v[164:167]
    v_mfma_f32_16x16x32_bf16 v[148:151], v[212:215], v[188:191], v[148:151]
    v_mfma_f32_16x16x32_bf16 v[132:135], v[212:215], v[184:187], v[132:135]
    s_add_u32 s36, s39, 0
    v_cvt_pk_bf16_f32 v120, v120, v121
    v_cvt_pk_bf16_f32 v121, v122, v123
    v_cvt_pk_bf16_f32 v122, v124, v125
    v_cvt_pk_bf16_f32 v123, v126, v127
    buffer_store_dwordx4 v[120:123], v2, s[16:19], s36 offen offset:0 sc1
    v_cvt_pk_bf16_f32 v128, v128, v129
    v_cvt_pk_bf16_f32 v129, v130, v131
    v_cvt_pk_bf16_f32 v130, v132, v133
    v_cvt_pk_bf16_f32 v131, v134, v135
    buffer_store_dwordx4 v[128:131], v2, s[16:19], s36 offen offset:1024 sc1
    s_add_u32 s36, s39, 65536
    v_cvt_pk_bf16_f32 v136, v136, v137
    v_cvt_pk_bf16_f32 v137, v138, v139
    v_cvt_pk_bf16_f32 v138, v140, v141
    v_cvt_pk_bf16_f32 v139, v142, v143
    buffer_store_dwordx4 v[136:139], v2, s[16:19], s36 offen offset:0 sc1
    v_cvt_pk_bf16_f32 v144, v144, v145
    v_cvt_pk_bf16_f32 v145, v146, v147
    v_cvt_pk_bf16_f32 v146, v148, v149
    v_cvt_pk_bf16_f32 v147, v150, v151
    buffer_store_dwordx4 v[144:147], v2, s[16:19], s36 offen offset:1024 sc1
    s_add_u32 s36, s39, 131072
    v_cvt_pk_bf16_f32 v152, v152, v153
    v_cvt_pk_bf16_f32 v153, v154, v155
    v_cvt_pk_bf16_f32 v154, v156, v157
    v_cvt_pk_bf16_f32 v155, v158, v159
    buffer_store_dwordx4 v[152:155], v2, s[16:19], s36 offen offset:0 sc1
    v_cvt_pk_bf16_f32 v160, v160, v161
    v_cvt_pk_bf16_f32 v161, v162, v163
    v_cvt_pk_bf16_f32 v162, v164, v165
    v_cvt_pk_bf16_f32 v163, v166, v167
    buffer_store_dwordx4 v[160:163], v2, s[16:19], s36 offen offset:1024 sc1
    s_add_u32 s36, s39, 196608
    v_cvt_pk_bf16_f32 v168, v168, v169
    v_cvt_pk_bf16_f32 v169, v170, v171
    v_cvt_pk_bf16_f32 v170, v172, v173
    v_cvt_pk_bf16_f32 v171, v174, v175
    buffer_store_dwordx4 v[168:171], v2, s[16:19], s36 offen offset:0 sc1
    v_cvt_pk_bf16_f32 v176, v176, v177
    v_cvt_pk_bf16_f32 v177, v178, v179
    v_cvt_pk_bf16_f32 v178, v180, v181
    v_cvt_pk_bf16_f32 v179, v182, v183
    buffer_store_dwordx4 v[176:179], v2, s[16:19], s36 offen offset:1024 sc1
    s_barrier
    s_add_u32 s53, s55, 1024
    v_mov_b32 v8, 1
    v_mov_b32 v9, 162816
    v_mov_b32 v11, 0
    s_mov_b64 exec, 1
    s_waitcnt vmcnt(0)
    ds_add_rtn_u32 v10, v9, v8
    s_waitcnt lgkmcnt(0)
    v_readfirstlane_b32 s54, v10
    s_nop 0
    s_and_b32 s54, s54, 3
    s_cmp_lg_u32 s54, 3
    s_cbranch_scc1 pub_38
    buffer_atomic_add v8, v11, s[56:59], s53 offen sc1
    v_mov_b32 v9, 162872
    ds_add_u32 v9, v8
pub_38:
    s_mov_b64 exec, -1
    s_branch NEXT
G4_last:
    v_mfma_f32_16x16x32_bf16 v[120:123], v[40:43], v[24:27], v[120:123]
    ds_read_b128 v[184:187], v17 offset:1024
    ds_read_b128 v[188:191], v17 offset:3072
    ds_read_b128 v[192:195], v17 offset:5120
    ds_read_b128 v[196:199], v17 offset:7168
    ds_read_b64_tr_b16 v[200:201], v18 offset:8192
    v_mfma_f32_16x16x32_bf16 v[136:139], v[40:43], v[28:31], v[136:139]
    ds_read_b64_tr_b16 v[202:203], v18 offset:12288
    ds_read_b64_tr_b16 v[204:205], v19 offset:8192
    ds_read_b64_tr_b16 v[206:207], v19 offset:12288
    ds_read_b64_tr_b16 v[208:209], v20 offset:8192
    v_mfma_f32_16x16x32_bf16 v[152:155], v[40:43], v[32:35], v[152:155]
    ds_read_b64_tr_b16 v[210:211], v20 offset:12288
    ds_read_b64_tr_b16 v[212:213], v21 offset:8192
    ds_read_b64_tr_b16 v[214:215], v21 offset:12288
    s_load_dwordx2 s[6:7], s[0:1], 88
    s_lshl_b32 s86, s60, 24
    v_mfma_f32_16x16x32_bf16 v[168:171], v[40:43], v[36:39], v[168:171]
    s_lshl_b32 s87, s94, 13
    s_add_u32 s86, s86, s87
    s_add_u32 s86, s86, 167772160
    s_add_u32 s84, s4, s86
    v_mfma_f32_16x16x32_bf16 v[172:175], v[44:47], v[36:39], v[172:175]
    s_addc_u32 s85, s5, 0
    s_mov_b32 s86, 8380416
    s_mov_b32 s87, 0x20000
    s_add_u32 s88, s62, 0x480000
    s_addc_u32 s89, s63, 0
    v_mfma_f32_16x16x32_bf16 v[156:159], v[44:47], v[32:35], v[156:159]
    s_mov_b32 s90, 0x7e000
    s_mov_b32 s91, 0x20000
    s_lshl_b32 s40, s31, 17
    s_add_u32 s40, s40, s39
    v_mfma_f32_16x16x32_bf16 v[140:143], v[44:47], v[28:31], v[140:143]
    s_xor_b32 s41, s31, 1
    s_lshl_b32 s41, s41, 17
    s_add_u32 s41, s41, s39
    v_and_b32 v60, 3, v22
    v_mfma_f32_16x16x32_bf16 v[124:127], v[44:47], v[24:27], v[124:127]
    v_lshrrev_b32 v62, 2, v22
    v_lshlrev_b32 v62, 14, v62
    v_lshl_add_u32 v62, v60, 11, v62
    v_lshl_add_u32 v62, v23, 4, v62
    s_lshl_b32 s46, s28, 3
    v_mfma_f32_16x16x32_bf16 v[128:131], v[48:51], v[24:27], v[128:131]
    s_add_u32 s46, s46, s37
    s_lshl_b32 s47, s31, 1
    s_add_u32 s46, s46, s47
    s_lshl_b32 s49, s46, 16
    v_mfma_f32_16x16x32_bf16 v[144:147], v[48:51], v[28:31], v[144:147]
    s_lshl_b32 s47, s38, 5
    s_add_u32 s49, s49, s47
    s_add_u32 s36, s40, 0
    buffer_load_dwordx4 v[80:83], v62, s[84:87], s49 offen offset:0 sc1
    buffer_load_dwordx4 v[84:87], v2, s[88:91], s36 offen offset:0 sc1
    v_mfma_f32_16x16x32_bf16 v[160:163], v[48:51], v[32:35], v[160:163]
    buffer_load_dwordx4 v[88:91], v62, s[84:87], s49 offen offset:64 sc1
    buffer_load_dwordx4 v[92:95], v2, s[88:91], s36 offen offset:1024 sc1
    s_add_u32 s36, s40, 65536
    s_add_u32 s49, s49, 65536
    v_mfma_f32_16x16x32_bf16 v[176:179], v[48:51], v[36:39], v[176:179]
    buffer_load_dwordx4 v[96:99], v62, s[84:87], s49 offen offset:0 sc1
    buffer_load_dwordx4 v[100:103], v2, s[88:91], s36 offen offset:0 sc1
    buffer_load_dwordx4 v[104:107], v62, s[84:87], s49 offen offset:64 sc1
    buffer_load_dwordx4 v[108:111], v2, s[88:91], s36 offen offset:1024 sc1
    v_mfma_f32_16x16x32_bf16 v[180:183], v[52:55], v[36:39], v[180:183]
    v_mfma_f32_16x16x32_bf16 v[164:167], v[52:55], v[32:35], v[164:167]
    v_mfma_f32_16x16x32_bf16 v[148:151], v[52:55], v[28:31], v[148:151]
    v_mfma_f32_16x16x32_bf16 v[132:135], v[52:55], v[24:27], v[132:135]
    s_waitcnt lgkmcnt(0)
    v_mfma_f32_16x16x32_bf16 v[120:123], v[200:203], v[184:187], v[120:123]
    s_add_u32 s16, s62, 0x500000
    s_addc_u32 s17, s63, 0
    s_mov_b32 s18, 0x7e000
    v_mfma_f32_16x16x32_bf16 v[136:139], v[200:203], v[188:191], v[136:139]
    s_mov_b32 s19, 0x20000
    s_mov_b32 s20, s6
    s_mov_b32 s21, s7
    v_mfma_f32_16x16x32_bf16 v[152:155], v[200:203], v[192:195], v[152:155]
    s_mov_b32 s22, 0x400000
    s_mov_b32 s23, 0x20000
    v_mfma_f32_16x16x32_bf16 v[168:171], v[200:203], v[196:199], v[168:171]
    s_lshl_b32 s44, s29, 2
    s_add_u32 s44, s44, s30
    s_lshl_b32 s44, s44, 7
    v_mfma_f32_16x16x32_bf16 v[172:175], v[204:207], v[196:199], v[172:175]
    s_xor_b32 s45, s44, 4096
    s_add_u32 s44, s44, s55
    s_add_u32 s44, s44, 16384
    v_mfma_f32_16x16x32_bf16 v[156:159], v[204:207], v[192:195], v[156:159]
    s_add_u32 s45, s45, s55
    s_add_u32 s45, s45, 16384
    v_mfma_f32_16x16x32_bf16 v[140:143], v[204:207], v[188:191], v[140:143]
    v_mov_b32 v9, s45
    v_mov_b32 v10, s52
    v_mov_b32 v11, 0
    v_mfma_f32_16x16x32_bf16 v[124:127], v[204:207], v[184:187], v[124:127]
    s_lshl_b32 s46, s46, 15
    s_add_u32 s46, s46, s47
    s_add_u32 s47, s46, 32768
    v_mfma_f32_16x16x32_bf16 v[128:131], v[208:211], v[184:187], v[128:131]
    v_and_b32 v61, 1, v23
    v_lshlrev_b32 v60, 11, v22
    v_mfma_f32_16x16x32_bf16 v[144:147], v[208:211], v[188:191], v[144:147]
    v_lshl_add_u32 v60, v61, 5, v60
    v_lshrrev_b32 v61, 1, v23
    v_lshl_add_u32 v60, v61, 4, v60
    v_mfma_f32_16x16x32_bf16 v[160:163], v[208:211], v[192:195], v[160:163]
    v_cmp_gt_u32 s[48:49], 8, v22
    v_lshrrev_b32 v61, 3, v22
    v_mul_u32_u24 v61, 16320, v61
    v_mfma_f32_16x16x32_bf16 v[176:179], v[208:211], v[196:199], v[176:179]
    v_sub_u32 v60, v60, v61
    v_add_u32 v61, 16384, v60
    v_mfma_f32_16x16x32_bf16 v[180:183], v[212:215], v[196:199], v[180:183]
    v_mfma_f32_16x16x32_bf16 v[164:167], v[212:215], v[192:195], v[164:167]
    v_mfma_f32_16x16x32_bf16 v[148:151], v[212:215], v[188:191], v[148:151]
    v_mfma_f32_16x16x32_bf16 v[132:135], v[212:215], v[184:187], v[132:135]
    s_cmp_eq_u32 s31, 0
    s_cbranch_scc1 G4_k0
    v_swap_b32 v120, v152
    v_swap_b32 v121, v153
    v_swap_b32 v122, v154
    v_swap_b32 v123, v155
    v_swap_b32 v124, v156
    v_swap_b32 v125, v157
    v_swap_b32 v126, v158
    v_swap_b32 v127, v159
    v_swap_b32 v128, v160
    v_swap_b32 v129, v161
    v_swap_b32 v130, v162
    v_swap_b32 v131, v163
    v_swap_b32 v132, v164
    v_swap_b32 v133, v165
    v_swap_b32 v134, v166
    v_swap_b32 v135, v167
    v_swap_b32 v136, v168
    v_swap_b32 v137, v169
    v_swap_b32 v138, v170
    v_swap_b32 v139, v171
    v_swap_b32 v140, v172
    v_swap_b32 v141, v173
    v_swap_b32 v142, v174
    v_swap_b32 v143, v175
    v_swap_b32 v144, v176
    v_swap_b32 v145, v177
    v_swap_b32 v146, v178
    v_swap_b32 v147, v179
    v_swap_b32 v148, v180
    v_swap_b32 v149, v181
    v_swap_b32 v150, v182
    v_swap_b32 v151, v183
G4_k0:
    s_add_u32 s36, s41, 0
    v_cvt_pk_bf16_f32 v152, v152, v153
    v_cvt_pk_bf16_f32 v153, v154, v155
    v_cvt_pk_bf16_f32 v154, v156, v157
    v_cvt_pk_bf16_f32 v155, v158, v159
    buffer_store_dwordx4 v[152:155], v2, s[16:19], s36 offen offset:0 sc1
    v_cvt_pk_bf16_f32 v160, v160, v161
    v_cvt_pk_bf16_f32 v161, v162, v163
    v_cvt_pk_bf16_f32 v162, v164, v165
    v_cvt_pk_bf16_f32 v163, v166, v167
    buffer_store_dwordx4 v[160:163], v2, s[16:19], s36 offen offset:1024 sc1
    s_add_u32 s36, s41, 65536
    v_cvt_pk_bf16_f32 v168, v168, v169
    v_cvt_pk_bf16_f32 v169, v170, v171
    v_cvt_pk_bf16_f32 v170, v172, v173
    v_cvt_pk_bf16_f32 v171, v174, v175
    buffer_store_dwordx4 v[168:171], v2, s[16:19], s36 offen offset:0 sc1
    v_cvt_pk_bf16_f32 v176, v176, v177
    v_cvt_pk_bf16_f32 v177, v178, v179
    v_cvt_pk_bf16_f32 v178, v180, v181
    v_cvt_pk_bf16_f32 v179, v182, v183
    buffer_store_dwordx4 v[176:179], v2, s[16:19], s36 offen offset:1024 sc1
    s_waitcnt vmcnt(4)
    v_lshlrev_b32 v56, 16, v80
    v_and_b32 v57, 0xffff0000, v80
    v_pk_add_f32 v[120:121], v[120:121], v[56:57]
    v_lshlrev_b32 v58, 16, v81
    v_and_b32 v59, 0xffff0000, v81
    v_pk_add_f32 v[122:123], v[122:123], v[58:59]
    v_lshlrev_b32 v56, 16, v82
    v_and_b32 v57, 0xffff0000, v82
    v_pk_add_f32 v[124:125], v[124:125], v[56:57]
    v_lshlrev_b32 v58, 16, v83
    v_and_b32 v59, 0xffff0000, v83
    v_pk_add_f32 v[126:127], v[126:127], v[58:59]
    v_lshlrev_b32 v56, 16, v88
    v_and_b32 v57, 0xffff0000, v88
    v_pk_add_f32 v[128:129], v[128:129], v[56:57]
    v_lshlrev_b32 v58, 16, v89
    v_and_b32 v59, 0xffff0000, v89
    v_pk_add_f32 v[130:131], v[130:131], v[58:59]
    v_lshlrev_b32 v56, 16, v90
    v_and_b32 v57, 0xffff0000, v90
    v_pk_add_f32 v[132:133], v[132:133], v[56:57]
    v_lshlrev_b32 v58, 16, v91
    v_and_b32 v59, 0xffff0000, v91
    v_pk_add_f32 v[134:135], v[134:135], v[58:59]
    v_lshlrev_b32 v56, 16, v96
    v_and_b32 v57, 0xffff0000, v96
    v_pk_add_f32 v[136:137], v[136:137], v[56:57]
    v_lshlrev_b32 v58, 16, v97
    v_and_b32 v59, 0xffff0000, v97
    v_pk_add_f32 v[138:139], v[138:139], v[58:59]
    v_lshlrev_b32 v56, 16, v98
    v_and_b32 v57, 0xffff0000, v98
    v_pk_add_f32 v[140:141], v[140:141], v[56:57]
    v_lshlrev_b32 v58, 16, v99
    v_and_b32 v59, 0xffff0000, v99
    v_pk_add_f32 v[142:143], v[142:143], v[58:59]
    v_lshlrev_b32 v56, 16, v104
    v_and_b32 v57, 0xffff0000, v104
    v_pk_add_f32 v[144:145], v[144:145], v[56:57]
    v_lshlrev_b32 v58, 16, v105
    v_and_b32 v59, 0xffff0000, v105
    v_pk_add_f32 v[146:147], v[146:147], v[58:59]
    v_lshlrev_b32 v56, 16, v106
    v_and_b32 v57, 0xffff0000, v106
    v_pk_add_f32 v[148:149], v[148:149], v[56:57]
    v_lshlrev_b32 v58, 16, v107
    v_and_b32 v59, 0xffff0000, v107
    v_pk_add_f32 v[150:151], v[150:151], v[58:59]
    s_waitcnt vmcnt(0)
    s_mov_b64 exec, 1
    buffer_store_dword v10, v11, s[56:59], s44 offen sc1
    s_mov_b64 exec, -1
    v_lshlrev_b32 v56, 16, v84
    v_and_b32 v57, 0xffff0000, v84
    v_pk_add_f32 v[120:121], v[120:121], v[56:57]
    v_lshlrev_b32 v58, 16, v85
    v_and_b32 v59, 0xffff0000, v85
    v_pk_add_f32 v[122:123], v[122:123], v[58:59]
    v_lshlrev_b32 v56, 16, v86
    v_and_b32 v57, 0xffff0000, v86
    v_pk_add_f32 v[124:125], v[124:125], v[56:57]
    v_lshlrev_b32 v58, 16, v87
    v_and_b32 v59, 0xffff0000, v87
    v_pk_add_f32 v[126:127], v[126:127], v[58:59]
    v_lshlrev_b32 v56, 16, v92
    v_and_b32 v57, 0xffff0000, v92
    v_pk_add_f32 v[128:129], v[128:129], v[56:57]
    v_lshlrev_b32 v58, 16, v93
    v_and_b32 v59, 0xffff0000, v93
    v_pk_add_f32 v[130:131], v[130:131], v[58:59]
    v_lshlrev_b32 v56, 16, v94
    v_and_b32 v57, 0xffff0000, v94
    v_pk_add_f32 v[132:133], v[132:133], v[56:57]
    v_lshlrev_b32 v58, 16, v95
    v_and_b32 v59, 0xffff0000, v95
    v_pk_add_f32 v[134:135], v[134:135], v[58:59]
    v_lshlrev_b32 v56, 16, v100
    v_and_b32 v57, 0xffff0000, v100
    v_pk_add_f32 v[136:137], v[136:137], v[56:57]
    v_lshlrev_b32 v58, 16, v101
    v_and_b32 v59, 0xffff0000, v101
    v_pk_add_f32 v[138:139], v[138:139], v[58:59]
    v_lshlrev_b32 v56, 16, v102
    v_and_b32 v57, 0xffff0000, v102
    v_pk_add_f32 v[140:141], v[140:141], v[56:57]
    v_lshlrev_b32 v58, 16, v103
    v_and_b32 v59, 0xffff0000, v103
    v_pk_add_f32 v[142:143], v[142:143], v[58:59]
    v_lshlrev_b32 v56, 16, v108
    v_and_b32 v57, 0xffff0000, v108
    v_pk_add_f32 v[144:145], v[144:145], v[56:57]
    v_lshlrev_b32 v58, 16, v109
    v_and_b32 v59, 0xffff0000, v109
    v_pk_add_f32 v[146:147], v[146:147], v[58:59]
    v_lshlrev_b32 v56, 16, v110
    v_and_b32 v57, 0xffff0000, v110
    v_pk_add_f32 v[148:149], v[148:149], v[56:57]
    v_lshlrev_b32 v58, 16, v111
    v_and_b32 v59, 0xffff0000, v111
    v_pk_add_f32 v[150:151], v[150:151], v[58:59]
    s_mov_b32 s53, 0
    s_add_u32 s54, s52, 0
    s_bfm_b64 exec, 1, 0
poll_39:
    buffer_load_dword v8, v9, s[56:59], 0 offen sc1
    s_waitcnt vmcnt(0)
    v_cmp_eq_u32 vcc, s54, v8
    s_nop 0
    s_cmp_eq_u64 vcc, exec
    s_cbranch_scc1 pok_40
    s_sleep 2
    s_add_u32 s53, s53, 1
    s_cmp_lt_u32 s53, s61
    s_cbranch_scc1 poll_39
    s_mov_b32 s61, 0
pok_40:
    s_mov_b64 exec, -1
    s_add_u32 s36, s40, 0
    buffer_load_dwordx4 v[24:27], v2, s[16:19], s36 offen offset:0 sc1
    buffer_load_dwordx4 v[28:31], v2, s[16:19], s36 offen offset:1024 sc1
    s_add_u32 s36, s40, 65536
    buffer_load_dwordx4 v[32:35], v2, s[16:19], s36 offen offset:0 sc1
    buffer_load_dwordx4 v[36:39], v2, s[16:19], s36 offen offset:1024 sc1
    s_waitcnt vmcnt(3)
    v_lshlrev_b32 v56, 16, v24
    v_and_b32 v57, 0xffff0000, v24
    v_pk_add_f32 v[120:121], v[120:121], v[56:57]
    v_lshlrev_b32 v58, 16, v25
    v_and_b32 v59, 0xffff0000, v25
    v_pk_add_f32 v[122:123], v[122:123], v[58:59]
    v_lshlrev_b32 v56, 16, v26
    v_and_b32 v57, 0xffff0000, v26
    v_pk_add_f32 v[124:125], v[124:125], v[56:57]
    v_lshlrev_b32 v58, 16, v27
    v_and_b32 v59, 0xffff0000, v27
    v_pk_add_f32 v[126:127], v[126:127], v[58:59]
    v_cvt_pk_bf16_f32 v120, v120, v121
    v_cvt_pk_bf16_f32 v121, v122, v123
    v_cvt_pk_bf16_f32 v122, v124, v125
    v_cvt_pk_bf16_f32 v123, v126, v127
    s_nop 0
    v_permlane16_swap_b32 v120, v122
    v_permlane16_swap_b32 v121, v123
    s_waitcnt vmcnt(2)
    v_lshlrev_b32 v56, 16, v28
    v_and_b32 v57, 0xffff0000, v28
    v_pk_add_f32 v[128:129], v[128:129], v[56:57]
    v_lshlrev_b32 v58, 16, v29
    v_and_b32 v59, 0xffff0000, v29
    v_pk_add_f32 v[130:131], v[130:131], v[58:59]
    v_lshlrev_b32 v56, 16, v30
    v_and_b32 v57, 0xffff0000, v30
    v_pk_add_f32 v[132:133], v[132:133], v[56:57]
    v_lshlrev_b32 v58, 16, v31
    v_and_b32 v59, 0xffff0000, v31
    v_pk_add_f32 v[134:135], v[134:135], v[58:59]
    v_cvt_pk_bf16_f32 v128, v128, v129
    v_cvt_pk_bf16_f32 v129, v130, v131
    v_cvt_pk_bf16_f32 v130, v132, v133
    v_cvt_pk_bf16_f32 v131, v134, v135
    s_nop 0
    v_permlane16_swap_b32 v128, v130
    v_permlane16_swap_b32 v129, v131
    v_cndmask_b32 v132, v120, v128, s[48:49]
    v_cndmask_b32 v133, v121, v129, s[48:49]
    v_cndmask_b32 v134, v122, v130, s[48:49]
    v_cndmask_b32 v135, v123, v131, s[48:49]
    v_mov_b32_dpp v124, v132 row_ror:8 row_mask:0xf bank_mask:0xf
    v_mov_b32_dpp v125, v133 row_ror:8 row_mask:0xf bank_mask:0xf
    v_mov_b32_dpp v126, v134 row_ror:8 row_mask:0xf bank_mask:0xf
    v_mov_b32_dpp v127, v135 row_ror:8 row_mask:0xf bank_mask:0xf
    v_cndmask_b32 v120, v124, v120, s[48:49]
    v_cndmask_b32 v128, v128, v124, s[48:49]
    v_cndmask_b32 v121, v125, v121, s[48:49]
    v_cndmask_b32 v129, v129, v125, s[48:49]
    v_cndmask_b32 v122, v126, v122, s[48:49]
    v_cndmask_b32 v130, v130, v126, s[48:49]
    v_cndmask_b32 v123, v127, v123, s[48:49]
    v_cndmask_b32 v131, v131, v127, s[48:49]
    buffer_store_dwordx4 v[120:123], v60, s[20:23], s46 offen sc1
    buffer_store_dwordx4 v[128:131], v61, s[20:23], s46 offen sc1
    s_waitcnt vmcnt(3)
    v_lshlrev_b32 v56, 16, v32
    v_and_b32 v57, 0xffff0000, v32
    v_pk_add_f32 v[136:137], v[136:137], v[56:57]
    v_lshlrev_b32 v58, 16, v33
    v_and_b32 v59, 0xffff0000, v33
    v_pk_add_f32 v[138:139], v[138:139], v[58:59]
    v_lshlrev_b32 v56, 16, v34
    v_and_b32 v57, 0xffff0000, v34
    v_pk_add_f32 v[140:141], v[140:141], v[56:57]
    v_lshlrev_b32 v58, 16, v35
    v_and_b32 v59, 0xffff0000, v35
    v_pk_add_f32 v[142:143], v[142:143], v[58:59]
    v_cvt_pk_bf16_f32 v136, v136, v137
    v_cvt_pk_bf16_f32 v137, v138, v139
    v_cvt_pk_bf16_f32 v138, v140, v141
    v_cvt_pk_bf16_f32 v139, v142, v143
    s_nop 0
    v_permlane16_swap_b32 v136, v138
    v_permlane16_swap_b32 v137, v139
    s_waitcnt vmcnt(2)
    v_lshlrev_b32 v56, 16, v36
    v_and_b32 v57, 0xffff0000, v36
    v_pk_add_f32 v[144:145], v[144:145], v[56:57]
    v_lshlrev_b32 v58, 16, v37
    v_and_b32 v59, 0xffff0000, v37
    v_pk_add_f32 v[146:147], v[146:147], v[58:59]
    v_lshlrev_b32 v56, 16, v38
    v_and_b32 v57, 0xffff0000, v38
    v_pk_add_f32 v[148:149], v[148:149], v[56:57]
    v_lshlrev_b32 v58, 16, v39
    v_and_b32 v59, 0xffff0000, v39
    v_pk_add_f32 v[150:151], v[150:151], v[58:59]
    v_cvt_pk_bf16_f32 v144, v144, v145
    v_cvt_pk_bf16_f32 v145, v146, v147
    v_cvt_pk_bf16_f32 v146, v148, v149
    v_cvt_pk_bf16_f32 v147, v150, v151
    s_nop 0
    v_permlane16_swap_b32 v144, v146
    v_permlane16_swap_b32 v145, v147
    v_cndmask_b32 v148, v136, v144, s[48:49]
    v_cndmask_b32 v149, v137, v145, s[48:49]
    v_cndmask_b32 v150, v138, v146, s[48:49]
    v_cndmask_b32 v151, v139, v147, s[48:49]
    v_mov_b32_dpp v140, v148 row_ror:8 row_mask:0xf bank_mask:0xf
    v_mov_b32_dpp v141, v149 row_ror:8 row_mask:0xf bank_mask:0xf
    v_mov_b32_dpp v142, v150 row_ror:8 row_mask:0xf bank_mask:0xf
    v_mov_b32_dpp v143, v151 row_ror:8 row_mask:0xf bank_mask:0xf
    v_cndmask_b32 v136, v140, v136, s[48:49]
    v_cndmask_b32 v144, v144, v140, s[48:49]
    v_cndmask_b32 v137, v141, v137, s[48:49]
    v_cndmask_b32 v145, v145, v141, s[48:49]
    v_cndmask_b32 v138, v142, v138, s[48:49]
    v_cndmask_b32 v146, v146, v142, s[48:49]
    v_cndmask_b32 v139, v143, v139, s[48:49]
    v_cndmask_b32 v147, v147, v143, s[48:49]
    buffer_store_dwordx4 v[136:139], v60, s[20:23], s47 offen sc1
    buffer_store_dwordx4 v[144:147], v61, s[20:23], s47 offen sc1
    s_branch K_fin
LOADERS:
    v_and_b32 v8, 15, v1
    v_lshrrev_b32 v9, 4, v1
    s_and_b32 s34, s30, 1
    s_and_b32 s37, s30, 3
    s_lshr_b32 s38, s29, 3
    s_add_u32 s38, s38, 1
    s_sub_u32 s39, 0, s38
    s_bitcmp1_b32 s29, 2
    s_cselect_b32 s38, s38, s39
    s_lshl_b32 s48, s28, 7
    s_cmp_lt_u32 s37, 2
    s_cselect_b32 s36, s38, 0
    s_add_u32 s36, s36, s48
    s_lshl_b32 s45, s34, 6
    s_add_u32 s36, s36, s45
    v_add_u32 v72, s36, v1
    s_movk_i32 s45, 2048
    v_cmp_gt_u32 s[46:47], s45, v72
    v_lshlrev_b32 v72, 4, v72
    s_lshl_b32 s22, s60, 15
    s_add_u32 s22, s22, 23199744
    s_add_u32 s20, s4, s22
    s_addc_u32 s21, s5, 0
    s_mov_b32 s22, 32768
    s_mov_b32 s23, 0x20000
    s_lshl_b32 s36, s37, 2
    v_add_u32 v6, s36, v9
    v_xor_b32 v10, v6, v8
    s_add_u32 s36, s48, s38
    s_add_u32 s36, s36, 16
    v_add_u32 v6, s36, v6
    v_and_b32 v7, 3, v6
    v_lshrrev_b32 v11, 2, v6
    v_lshlrev_b32 v11, 14, v11
    v_lshl_add_u32 v11, v7, 11, v11
    v_lshl_add_u32 v11, v10, 4, v11
    v_subrev_u32 v10, 65536, v11
    s_add_u32 s40, s67, 0
    s_and_b32 s40, s40, 6
    s_lshl_b32 s40, s40, 7
    s_add_u32 s41, s67, 2
    s_and_b32 s41, s41, 6
    s_lshl_b32 s41, s41, 7
    s_add_u32 s42, s67, 4
    s_and_b32 s42, s42, 6
    s_lshl_b32 s42, s42, 7
    s_add_u32 s43, s67, 6
    s_and_b32 s43, s43, 6
    s_lshl_b32 s43, s43, 7
    s_lshl_b32 s44, s37, 10
    v_lshrrev_b32 v6, 3, v1
    v_and_b32 v17, 7, v1
    v_xor_b32 v17, v17, v6
    s_lshl_b32 s36, s37, 3
    s_add_u32 s36, s36, s48
    v_add_u32 v6, s36, v6
    v_and_b32 v7, 3, v6
    v_lshrrev_b32 v12, 2, v6
    v_lshlrev_b32 v12, 14, v12
    v_lshl_add_u32 v12, v7, 11, v12
    s_lshl_b32 s36, s29, 7
    v_lshl_add_u32 v12, v17, 4, v12
    v_add_u32 v12, s36, v12
    v_lshrrev_b32 v6, 1, v9
    s_lshl_b32 s36, s37, 1
    v_add_u32 v6, s36, v6
    v_and_b32 v7, 7, v8
    v_xor_b32 v6, v6, v7
    v_lshlrev_b32 v17, 7, v8
    v_lshl_add_u32 v17, v6, 4, v17
    v_and_b32 v6, 1, v9
    v_lshl_add_u32 v17, v6, 3, v17
    v_and_b32 v6, 1, v9
    v_lshlrev_b32 v13, 16, v6
    v_lshrrev_b32 v6, 1, v9
    v_lshl_add_u32 v13, v6, 8, v13
    v_lshl_add_u32 v13, v8, 4, v13
    s_bfe_u32 s36, s30, 0x10001
    s_lshl1_add_u32 s36, s29, s36
    s_lshr_b32 s53, s36, 3
    s_lshl_b32 s53, s53, 14
    s_and_b32 s39, s36, 7
    s_lshl_b32 s39, s39, 10
    s_add_u32 s39, s39, s53
    s_and_b32 s36, s30, 1
    s_lshl_b32 s36, s36, 9
    s_add_u32 s39, s39, s36
    v_mov_b32 v14, v2
    v_add_u32 v15, 106496, v2
    v_lshrrev_b32 v6, 5, v13
    v_and_b32 v6, 2048, v6
    v_and_b32 v16, 511, v13
    v_add_u32 v16, v16, v6
    s_lshl_b32 s36, s37, 9
    v_add_u32 v16, s36, v16
    s_lshl_b32 s14, s60, 24
    s_lshl_b32 s15, s94, 13
    s_add_u32 s14, s14, s15
    s_add_u32 s14, s14, 167772160
    s_add_u32 s12, s4, s14
    s_addc_u32 s13, s5, 0
    s_mov_b32 s14, 8380416
    s_mov_b32 s15, 0x20000
    s_add_u32 s16, s62, 0x400000
    s_addc_u32 s17, s63, 0
    s_mov_b32 s18, 0x7e000
    s_mov_b32 s19, 0x20000
    s_add_u32 s24, s62, 0x480000
    s_addc_u32 s25, s63, 0
    s_mov_b32 s26, 0x7e000
    s_mov_b32 s27, 0x20000
    s_and_b32 s82, s30, 3
    s_lshl_b32 s82, s82, 15
    s_add_u32 s53, s67, 0
    s_and_b32 s78, s53, 4
    s_and_b32 s53, s53, 2
    s_lshl_b32 s78, s78, 12
    s_lshl_b32 s53, s53, 11
    s_add_u32 s78, s78, s53
    s_add_u32 s78, s78, s82
    s_add_u32 s53, s67, 2
    s_and_b32 s79, s53, 4
    s_and_b32 s53, s53, 2
    s_lshl_b32 s79, s79, 12
    s_lshl_b32 s53, s53, 11
    s_add_u32 s79, s79, s53
    s_add_u32 s79, s79, s82
    s_add_u32 s53, s67, 4
    s_and_b32 s80, s53, 4
    s_and_b32 s53, s53, 2
    s_lshl_b32 s80, s80, 12
    s_lshl_b32 s53, s53, 11
    s_add_u32 s80, s80, s53
    s_add_u32 s80, s80, s82
    s_add_u32 s53, s67, 6
    s_and_b32 s81, s53, 4
    s_and_b32 s53, s53, 2
    s_lshl_b32 s81, s81, 12
    s_lshl_b32 s53, s53, 11
    s_add_u32 s81, s81, s53
    s_add_u32 s81, s81, s82
    s_and_b32 s53, s30, 2
    s_lshl_b32 s53, s53, 11
    s_and_b32 s82, s30, 1
    s_lshl_b32 s82, s82, 13
    s_add_u32 s82, s82, s53
    s_and_b32 s84, s30, 1
    s_lshl_b32 s84, s84, 8
    s_add_u32 s84, s84, s55
    s_add_u32 s85, s52, 16
    s_mov_b32 s53, 0
lns_41:
    buffer_load_dwordx4 v[52:55], v72, s[20:23], 0 offen sc1
    s_waitcnt vmcnt(0)
    v_cmp_eq_u32 vcc, s52, v53
    v_cmp_eq_u32 s[50:51], s52, v55
    s_nop 0
    s_and_b64 vcc, vcc, s[50:51]
    s_orn2_b64 vcc, vcc, s[46:47]
    s_cmp_eq_u64 vcc, -1
    s_cbranch_scc1 lnk_42
    s_sleep 4
    s_add_u32 s53, s53, 1
    s_cmp_lt_u32 s53, s61
    s_cbranch_scc1 lns_41
    s_mov_b32 s61, 0
lnk_42:
    v_lshlrev_b32 v56, 16, v52
    v_and_b32 v57, 0xffff0000, v52
    v_lshlrev_b32 v58, 16, v54
    v_and_b32 v59, 0xffff0000, v54
    v_cndmask_b32 v57, 1.0, v57, s[46:47]
    v_cndmask_b32 v59, 1.0, v59, s[46:47]
    s_lshl_b32 s36, s34, 10
    s_add_u32 s36, s36, 155648
    v_add_u32 v6, s36, v2
    s_cmp_ge_u32 s37, 2
    s_cbranch_scc1 lnx_43
    v_mul_f32 v66, v57, v59
    v_fma_f32 v60, -v58, v57, -v56
    v_rcp_f32 v7, v66
    v_mov_b32 v67, v66
    v_mov_b32 v61, v60
    v_mul_f32 v62, 0xc0135761, v7
    v_mul_f32 v7, v7, v7
    v_mov_b32 v63, v62
    v_mul_f32 v7, 0x3d372713, v7
    v_mul_f32 v64, v7, v62
    v_mov_b32 v65, v64
    ds_write_b128 v6, v[60:63] offset:0
    ds_write_b128 v6, v[64:67] offset:2048
    s_branch lnd_44
lnx_43:
    v_rcp_f32 v60, v57
    s_nop 0
    v_mul_f32 v62, -v56, v60
    v_mov_b32 v61, v60
    v_mov_b32 v63, v62
    ds_write_b128 v6, v[60:63] offset:5120
lnd_44:
    v_lshlrev_b32 v7, 4, v8
    v_add_u32 v7, 160768, v7
    s_setprio 1
    s_add_u32 m0, s44, 16384
    s_add_u32 s49, s40, 0
    s_barrier
    buffer_load_dwordx4 v10, s[12:15], s49 offen offset:0 sc1 lds
    s_add_u32 m0, s44, 23552
    s_nop 0
    buffer_load_dwordx4 v10, s[12:15], s49 offen offset:1024 sc1 lds
    s_add_u32 m0, s44, 20480
    s_nop 0
    buffer_load_dwordx4 v11, s[12:15], s49 offen offset:0 sc1 lds
    s_add_u32 m0, s44, 27648
    s_nop 0
    buffer_load_dwordx4 v11, s[12:15], s49 offen offset:1024 sc1 lds
    s_add_u32 m0, s44, 32768
    s_add_u32 s49, s41, 0
    buffer_load_dwordx4 v10, s[12:15], s49 offen offset:0 sc1 lds
    s_add_u32 m0, s44, 39936
    s_nop 0
    buffer_load_dwordx4 v10, s[12:15], s49 offen offset:1024 sc1 lds
    s_add_u32 m0, s44, 36864
    s_nop 0
    buffer_load_dwordx4 v11, s[12:15], s49 offen offset:0 sc1 lds
    s_add_u32 m0, s44, 44032
    s_nop 0
    buffer_load_dwordx4 v11, s[12:15], s49 offen offset:1024 sc1 lds
    s_add_u32 m0, s44, 106496
    s_add_u32 s49, s42, 0
    buffer_load_dwordx4 v10, s[12:15], s49 offen offset:0 sc1 lds
    s_add_u32 m0, s44, 113664
    s_nop 0
    buffer_load_dwordx4 v10, s[12:15], s49 offen offset:1024 sc1 lds
    s_add_u32 m0, s44, 110592
    s_nop 0
    buffer_load_dwordx4 v11, s[12:15], s49 offen offset:0 sc1 lds
    s_add_u32 m0, s44, 117760
    s_nop 0
    buffer_load_dwordx4 v11, s[12:15], s49 offen offset:1024 sc1 lds
    s_waitcnt lgkmcnt(0)
    s_add_u32 m0, s44, 122880
    s_add_u32 s49, s43, 0
    s_waitcnt vmcnt(8)
    s_barrier
    buffer_load_dwordx4 v10, s[12:15], s49 offen offset:0 sc1 lds
    s_add_u32 m0, s44, 130048
    s_nop 0
    buffer_load_dwordx4 v10, s[12:15], s49 offen offset:1024 sc1 lds
    s_add_u32 m0, s44, 126976
    s_nop 0
    buffer_load_dwordx4 v11, s[12:15], s49 offen offset:0 sc1 lds
    s_add_u32 m0, s44, 134144
    s_nop 0
    buffer_load_dwordx4 v11, s[12:15], s49 offen offset:1024 sc1 lds
    v_mov_b32 v10, v11
    v_add_u32 v11, 65536, v11
    s_add_u32 m0, s44, 139264
    s_add_u32 s49, s40, 65536
    s_waitcnt vmcnt(8)
    s_barrier
    buffer_load_dwordx4 v10, s[12:15], s49 offen offset:0 sc1 lds
    s_add_u32 m0, s44, 146432
    s_nop 0
    buffer_load_dwordx4 v10, s[12:15], s49 offen offset:1024 sc1 lds
    s_add_u32 m0, s44, 143360
    s_nop 0
    buffer_load_dwordx4 v11, s[12:15], s49 offen offset:0 sc1 lds
    s_add_u32 m0, s44, 150528
    s_nop 0
    buffer_load_dwordx4 v11, s[12:15], s49 offen offset:1024 sc1 lds
    s_add_u32 m0, s44, 16384
    s_add_u32 s49, s41, 65536
    s_waitcnt vmcnt(8)
    s_barrier
    buffer_load_dwordx4 v10, s[12:15], s49 offen offset:0 sc1 lds
    s_add_u32 m0, s44, 23552
    s_nop 0
    buffer_load_dwordx4 v10, s[12:15], s49 offen offset:1024 sc1 lds
    s_add_u32 m0, s44, 20480
    s_nop 0
    buffer_load_dwordx4 v11, s[12:15], s49 offen offset:0 sc1 lds
    s_add_u32 m0, s44, 27648
    s_nop 0
    buffer_load_dwordx4 v11, s[12:15], s49 offen offset:1024 sc1 lds
    s_add_u32 m0, s44, 32768
    s_add_u32 s49, s42, 65536
    s_waitcnt vmcnt(8)
    s_barrier
    buffer_load_dwordx4 v10, s[12:15], s49 offen offset:0 sc1 lds
    s_add_u32 m0, s44, 39936
    s_nop 0
    buffer_load_dwordx4 v10, s[12:15], s49 offen offset:1024 sc1 lds
    s_add_u32 m0, s44, 36864
    s_nop 0
    buffer_load_dwordx4 v11, s[12:15], s49 offen offset:0 sc1 lds
    s_add_u32 m0, s44, 44032
    s_nop 0
    buffer_load_dwordx4 v11, s[12:15], s49 offen offset:1024 sc1 lds
    s_add_u32 m0, s44, 106496
    s_add_u32 s49, s43, 65536
    s_waitcnt vmcnt(8)
    s_barrier
    buffer_load_dwordx4 v10, s[12:15], s49 offen offset:0 sc1 lds
    s_add_u32 m0, s44, 113664
    s_nop 0
    buffer_load_dwordx4 v10, s[12:15], s49 offen offset:1024 sc1 lds
    s_add_u32 m0, s44, 110592
    s_nop 0
    buffer_load_dwordx4 v11, s[12:15], s49 offen offset:0 sc1 lds
    s_add_u32 m0, s44, 117760
    s_nop 0
    buffer_load_dwordx4 v11, s[12:15], s49 offen offset:1024 sc1 lds
    s_add_u32 m0, s44, 0
    s_mov_b32 s36, 0
    buffer_load_dwordx4 v12, s[12:15], s36 offen sc1 lds
    s_add_u32 m0, s44, 4096
    s_mov_b32 s36, 131072
    buffer_load_dwordx4 v12, s[12:15], s36 offen sc1 lds
    s_add_u32 m0, s44, 8192
    s_mov_b32 s36, 262144
    buffer_load_dwordx4 v12, s[12:15], s36 offen sc1 lds
    s_add_u32 m0, s44, 12288
    s_mov_b32 s36, 393216
    buffer_load_dwordx4 v12, s[12:15], s36 offen sc1 lds
    s_add_u32 m0, s44, 122880
    s_add_u32 s49, s40, 196608
    s_waitcnt vmcnt(12)
    s_barrier
    buffer_load_dwordx4 v10, s[12:15], s49 offen offset:0 sc1 lds
    s_add_u32 m0, s44, 130048
    s_nop 0
    buffer_load_dwordx4 v10, s[12:15], s49 offen offset:1024 sc1 lds
    s_add_u32 m0, s44, 126976
    s_nop 0
    buffer_load_dwordx4 v11, s[12:15], s49 offen offset:0 sc1 lds
    s_add_u32 m0, s44, 134144
    s_nop 0
    buffer_load_dwordx4 v11, s[12:15], s49 offen offset:1024 sc1 lds
    s_add_u32 m0, s44, 139264
    s_add_u32 s49, s41, 196608
    s_waitcnt vmcnt(12)
    s_barrier
    buffer_load_dwordx4 v10, s[12:15], s49 offen offset:0 sc1 lds
    s_add_u32 m0, s44, 146432
    s_nop 0
    buffer_load_dwordx4 v10, s[12:15], s49 offen offset:1024 sc1 lds
    s_add_u32 m0, s44, 143360
    s_nop 0
    buffer_load_dwordx4 v11, s[12:15], s49 offen offset:0 sc1 lds
    s_add_u32 m0, s44, 150528
    s_nop 0
    buffer_load_dwordx4 v11, s[12:15], s49 offen offset:1024 sc1 lds
    s_add_u32 m0, s44, 16384
    s_add_u32 s49, s42, 196608
    s_waitcnt vmcnt(8)
    s_barrier
    buffer_load_dwordx4 v10, s[12:15], s49 offen offset:0 sc1 lds
    s_add_u32 m0, s44, 23552
    s_nop 0
    buffer_load_dwordx4 v10, s[12:15], s49 offen offset:1024 sc1 lds
    s_add_u32 m0, s44, 20480
    s_nop 0
    buffer_load_dwordx4 v11, s[12:15], s49 offen offset:0 sc1 lds
    s_add_u32 m0, s44, 27648
    s_nop 0
    buffer_load_dwordx4 v11, s[12:15], s49 offen offset:1024 sc1 lds
    ds_read_b64 v[22:23], v17 offset:0
    ds_read_b128 v[60:63], v7 offset:0
    ds_read_b64 v[26:27], v17 offset:2048
    ds_read_b128 v[64:67], v7 offset:256
    s_add_u32 m0, s44, 32768
    s_add_u32 s49, s43, 196608
    s_waitcnt vmcnt(8)
    s_barrier
    buffer_load_dwordx4 v10, s[12:15], s49 offen offset:0 sc1 lds
    s_waitcnt lgkmcnt(0)
    v_lshlrev_b32 v20, 16, v22
    v_and_b32 v21, 0xffff0000, v22
    v_lshlrev_b32 v22, 16, v23
    v_and_b32 v23, 0xffff0000, v23
    s_add_u32 m0, s44, 39936
    s_nop 0
    buffer_load_dwordx4 v10, s[12:15], s49 offen offset:1024 sc1 lds
    v_pk_fma_f32 v[20:21], v[20:21], v[60:61], v[62:63]
    v_pk_fma_f32 v[22:23], v[22:23], v[60:61], v[62:63]
    v_lshlrev_b32 v24, 16, v26
    v_and_b32 v25, 0xffff0000, v26
    v_lshlrev_b32 v26, 16, v27
    s_add_u32 m0, s44, 36864
    s_nop 0
    buffer_load_dwordx4 v11, s[12:15], s49 offen offset:0 sc1 lds
    v_and_b32 v27, 0xffff0000, v27
    v_pk_fma_f32 v[24:25], v[24:25], v[64:65], v[66:67]
    v_pk_fma_f32 v[26:27], v[26:27], v[64:65], v[66:67]
    s_add_u32 m0, s44, 44032
    s_nop 0
    buffer_load_dwordx4 v11, s[12:15], s49 offen offset:1024 sc1 lds
    ds_read_b64 v[30:31], v17 offset:4096
    ds_read_b128 v[60:63], v7 offset:512
    ds_read_b64 v[34:35], v17 offset:6144
    ds_read_b128 v[64:67], v7 offset:768
    s_mov_b32 s88, 0
    s_call_b64 s[76:77], SUB_w3_sub_3
    s_add_u32 m0, s44, 106496
    s_add_u32 s49, s40, 327680
    s_waitcnt vmcnt(15)
    s_barrier
    buffer_load_dwordx4 v10, s[12:15], s49 offen offset:0 sc1 lds
    s_waitcnt lgkmcnt(0)
    v_lshlrev_b32 v28, 16, v30
    v_and_b32 v29, 0xffff0000, v30
    v_lshlrev_b32 v30, 16, v31
    v_and_b32 v31, 0xffff0000, v31
    s_add_u32 m0, s44, 113664
    s_nop 0
    buffer_load_dwordx4 v10, s[12:15], s49 offen offset:1024 sc1 lds
    v_pk_fma_f32 v[28:29], v[28:29], v[60:61], v[62:63]
    v_pk_fma_f32 v[30:31], v[30:31], v[60:61], v[62:63]
    v_lshlrev_b32 v32, 16, v34
    v_and_b32 v33, 0xffff0000, v34
    v_lshlrev_b32 v34, 16, v35
    s_add_u32 m0, s44, 110592
    s_nop 0
    buffer_load_dwordx4 v11, s[12:15], s49 offen offset:0 sc1 lds
    v_and_b32 v35, 0xffff0000, v35
    v_pk_fma_f32 v[32:33], v[32:33], v[64:65], v[66:67]
    v_pk_fma_f32 v[34:35], v[34:35], v[64:65], v[66:67]
    s_add_u32 m0, s44, 117760
    s_nop 0
    buffer_load_dwordx4 v11, s[12:15], s49 offen offset:1024 sc1 lds
    ds_read_b64 v[38:39], v17 offset:8192
    ds_read_b128 v[60:63], v7 offset:1024
    ds_read_b64 v[42:43], v17 offset:10240
    ds_read_b128 v[64:67], v7 offset:1280
    s_add_u32 m0, s44, 122880
    s_add_u32 s49, s41, 327680
    s_waitcnt vmcnt(15)
    s_barrier
    buffer_load_dwordx4 v10, s[12:15], s49 offen offset:0 sc1 lds
    s_waitcnt lgkmcnt(0)
    v_lshlrev_b32 v36, 16, v38
    v_and_b32 v37, 0xffff0000, v38
    v_lshlrev_b32 v38, 16, v39
    v_and_b32 v39, 0xffff0000, v39
    s_add_u32 m0, s44, 130048
    s_nop 0
    buffer_load_dwordx4 v10, s[12:15], s49 offen offset:1024 sc1 lds
    v_pk_fma_f32 v[36:37], v[36:37], v[60:61], v[62:63]
    v_pk_fma_f32 v[38:39], v[38:39], v[60:61], v[62:63]
    v_lshlrev_b32 v40, 16, v42
    v_and_b32 v41, 0xffff0000, v42
    v_lshlrev_b32 v42, 16, v43
    s_add_u32 m0, s44, 126976
    s_nop 0
    buffer_load_dwordx4 v11, s[12:15], s49 offen offset:0 sc1 lds
    v_and_b32 v43, 0xffff0000, v43
    v_pk_fma_f32 v[40:41], v[40:41], v[64:65], v[66:67]
    v_pk_fma_f32 v[42:43], v[42:43], v[64:65], v[66:67]
    s_add_u32 m0, s44, 134144
    s_nop 0
    buffer_load_dwordx4 v11, s[12:15], s49 offen offset:1024 sc1 lds
    ds_read_b64 v[46:47], v17 offset:12288
    ds_read_b128 v[60:63], v7 offset:1536
    ds_read_b64 v[50:51], v17 offset:14336
    ds_read_b128 v[64:67], v7 offset:1792
    s_add_u32 m0, s44, 139264
    s_add_u32 s49, s42, 327680
    s_waitcnt vmcnt(15)
    s_barrier
    buffer_load_dwordx4 v10, s[12:15], s49 offen offset:0 sc1 lds
    s_waitcnt lgkmcnt(0)
    v_lshlrev_b32 v44, 16, v46
    v_and_b32 v45, 0xffff0000, v46
    v_lshlrev_b32 v46, 16, v47
    v_and_b32 v47, 0xffff0000, v47
    s_add_u32 m0, s44, 146432
    s_nop 0
    buffer_load_dwordx4 v10, s[12:15], s49 offen offset:1024 sc1 lds
    v_pk_fma_f32 v[44:45], v[44:45], v[60:61], v[62:63]
    v_pk_fma_f32 v[46:47], v[46:47], v[60:61], v[62:63]
    v_lshlrev_b32 v48, 16, v50
    v_and_b32 v49, 0xffff0000, v50
    v_lshlrev_b32 v50, 16, v51
    s_add_u32 m0, s44, 143360
    s_nop 0
    buffer_load_dwordx4 v11, s[12:15], s49 offen offset:0 sc1 lds
    v_and_b32 v51, 0xffff0000, v51
    v_pk_fma_f32 v[48:49], v[48:49], v[64:65], v[66:67]
    v_pk_fma_f32 v[50:51], v[50:51], v[64:65], v[66:67]
    s_add_u32 m0, s44, 150528
    s_nop 0
    buffer_load_dwordx4 v11, s[12:15], s49 offen offset:1024 sc1 lds
    s_add_u32 m0, s44, 16384
    s_add_u32 s49, s43, 327680
    s_waitcnt vmcnt(8)
    s_barrier
    s_load_dword s32, s[4:5], s84 offset:2048
    s_load_dword s3, s[4:5], s84 offset:2176
    buffer_load_dwordx4 v10, s[12:15], s49 offen offset:0 sc1 lds
    s_add_u32 m0, s44, 23552
    s_nop 0
    buffer_load_dwordx4 v10, s[12:15], s49 offen offset:1024 sc1 lds
    s_add_u32 m0, s44, 20480
    s_nop 0
    buffer_load_dwordx4 v11, s[12:15], s49 offen offset:0 sc1 lds
    s_add_u32 m0, s44, 27648
    s_nop 0
    buffer_load_dwordx4 v11, s[12:15], s49 offen offset:1024 sc1 lds
    s_mov_b32 s88, 1
    s_call_b64 s[76:77], SUB_w3_sub_3
    s_add_u32 m0, s82, 32768
    s_add_u32 s49, s78, 0
    s_waitcnt vmcnt(15)
    s_barrier
    s_waitcnt lgkmcnt(0)
    s_cmp_eq_u32 s32, s85
    s_cselect_b32 s32, s3, 0
    s_cmp_eq_u32 s32, s85
    s_cbranch_scc1 hok_45
    s_add_u32 s53, s84, 2048
    v_lshlrev_b32 v109, 7, v1
    v_add_u32 v109, s53, v109
    s_mov_b32 s53, 0
    s_add_u32 s54, s52, 16
    s_bfm_b64 exec, 2, 0
poll_46:
    buffer_load_dword v108, v109, s[56:59], 0 offen sc1
    s_waitcnt vmcnt(0)
    v_cmp_eq_u32 vcc, s54, v108
    s_nop 0
    s_cmp_eq_u64 vcc, exec
    s_cbranch_scc1 pok_47
    s_sleep 8
    s_add_u32 s53, s53, 1
    s_cmp_lt_u32 s53, s61
    s_cbranch_scc1 poll_46
    s_mov_b32 s61, 0
pok_47:
    s_mov_b64 exec, -1
hok_45:
    buffer_load_dwordx4 v2, s[16:19], s49 offen offset:0 sc1 lds
    buffer_load_dwordx4 v2, s[16:19], s49 offen offset:1024 sc1 lds
    buffer_load_dwordx4 v2, s[16:19], s49 offen offset:2048 sc1 lds
    buffer_load_dwordx4 v2, s[16:19], s49 offen offset:3072 sc1 lds
    s_add_u32 m0, s82, 106496
    s_add_u32 s49, s79, 0
    s_waitcnt vmcnt(15)
    s_barrier
    buffer_load_dwordx4 v2, s[16:19], s49 offen offset:0 sc1 lds
    buffer_load_dwordx4 v2, s[16:19], s49 offen offset:1024 sc1 lds
    buffer_load_dwordx4 v2, s[16:19], s49 offen offset:2048 sc1 lds
    buffer_load_dwordx4 v2, s[16:19], s49 offen offset:3072 sc1 lds
    s_add_u32 m0, s82, 122880
    s_add_u32 s49, s80, 0
    s_waitcnt vmcnt(15)
    s_barrier
    buffer_load_dwordx4 v2, s[16:19], s49 offen offset:0 sc1 lds
    buffer_load_dwordx4 v2, s[16:19], s49 offen offset:1024 sc1 lds
    buffer_load_dwordx4 v2, s[16:19], s49 offen offset:2048 sc1 lds
    buffer_load_dwordx4 v2, s[16:19], s49 offen offset:3072 sc1 lds
    s_setprio 0
    s_waitcnt vmcnt(8)
    s_barrier
    ds_read_b128 v[52:55], v14 offset:32768
    ds_read_b128 v[56:59], v14 offset:36864
    ds_read_b128 v[60:63], v14 offset:40960
    ds_read_b128 v[64:67], v14 offset:45056
    ds_read_b128 v[68:71], v14 offset:33792
    ds_read_b128 v[72:75], v14 offset:37888
    ds_read_b128 v[76:79], v14 offset:41984
    ds_read_b128 v[80:83], v14 offset:46080
    s_waitcnt lgkmcnt(4)
    v_mfma_f32_16x16x32_bf16 v[20:23], v[128:131], v[52:55], v[20:23]
    ds_read_b128 v[84:87], v14 offset:34816
    v_mfma_f32_16x16x32_bf16 v[24:27], v[128:131], v[56:59], v[24:27]
    ds_read_b128 v[88:91], v14 offset:38912
    v_mfma_f32_16x16x32_bf16 v[24:27], v[132:135], v[64:67], v[24:27]
    ds_read_b128 v[92:95], v14 offset:43008
    v_mfma_f32_16x16x32_bf16 v[20:23], v[132:135], v[60:63], v[20:23]
    ds_read_b128 v[96:99], v14 offset:47104
    s_waitcnt lgkmcnt(4)
    v_mfma_f32_16x16x32_bf16 v[20:23], v[136:139], v[68:71], v[20:23]
    ds_read_b128 v[52:55], v14 offset:35840
    v_mfma_f32_16x16x32_bf16 v[24:27], v[136:139], v[72:75], v[24:27]
    ds_read_b128 v[56:59], v14 offset:39936
    v_mfma_f32_16x16x32_bf16 v[24:27], v[140:143], v[80:83], v[24:27]
    ds_read_b128 v[60:63], v14 offset:44032
    v_mfma_f32_16x16x32_bf16 v[20:23], v[140:143], v[76:79], v[20:23]
    ds_read_b128 v[64:67], v14 offset:48128
    s_waitcnt vmcnt(4)
    s_barrier
    s_waitcnt lgkmcnt(4)
    v_mfma_f32_16x16x32_bf16 v[20:23], v[144:147], v[84:87], v[20:23]
    ds_read_b128 v[68:71], v15 offset:0
    v_mfma_f32_16x16x32_bf16 v[24:27], v[144:147], v[88:91], v[24:27]
    ds_read_b128 v[72:75], v15 offset:4096
    v_mfma_f32_16x16x32_bf16 v[24:27], v[148:151], v[96:99], v[24:27]
    ds_read_b128 v[76:79], v15 offset:8192
    v_mfma_f32_16x16x32_bf16 v[20:23], v[148:151], v[92:95], v[20:23]
    ds_read_b128 v[80:83], v15 offset:12288
    s_waitcnt lgkmcnt(4)
    v_mfma_f32_16x16x32_bf16 v[20:23], v[152:155], v[52:55], v[20:23]
    ds_read_b128 v[84:87], v15 offset:1024
    v_mfma_f32_16x16x32_bf16 v[24:27], v[152:155], v[56:59], v[24:27]
    ds_read_b128 v[88:91], v15 offset:5120
    v_mfma_f32_16x16x32_bf16 v[24:27], v[156:159], v[64:67], v[24:27]
    ds_read_b128 v[92:95], v15 offset:9216
    v_mfma_f32_16x16x32_bf16 v[20:23], v[156:159], v[60:63], v[20:23]
    ds_read_b128 v[96:99], v15 offset:13312
    s_waitcnt lgkmcnt(4)
    v_mfma_f32_16x16x32_bf16 v[20:23], v[160:163], v[68:71], v[20:23]
    ds_read_b128 v[52:55], v15 offset:2048
    v_mfma_f32_16x16x32_bf16 v[24:27], v[160:163], v[72:75], v[24:27]
    ds_read_b128 v[56:59], v15 offset:6144
    v_mfma_f32_16x16x32_bf16 v[24:27], v[164:167], v[80:83], v[24:27]
    ds_read_b128 v[60:63], v15 offset:10240
    v_mfma_f32_16x16x32_bf16 v[20:23], v[164:167], v[76:79], v[20:23]
    ds_read_b128 v[64:67], v15 offset:14336
    s_waitcnt lgkmcnt(4)
    v_mfma_f32_16x16x32_bf16 v[20:23], v[168:171], v[84:87], v[20:23]
    ds_read_b128 v[68:71], v15 offset:3072
    v_mfma_f32_16x16x32_bf16 v[24:27], v[168:171], v[88:91], v[24:27]
    ds_read_b128 v[72:75], v15 offset:7168
    v_mfma_f32_16x16x32_bf16 v[24:27], v[172:175], v[96:99], v[24:27]
    ds_read_b128 v[76:79], v15 offset:11264
    v_mfma_f32_16x16x32_bf16 v[20:23], v[172:175], v[92:95], v[20:23]
    ds_read_b128 v[80:83], v15 offset:15360
    s_waitcnt vmcnt(0)
    s_barrier
    s_waitcnt lgkmcnt(4)
    v_mfma_f32_16x16x32_bf16 v[20:23], v[176:179], v[52:55], v[20:23]
    ds_read_b128 v[84:87], v15 offset:16384
    v_mfma_f32_16x16x32_bf16 v[24:27], v[176:179], v[56:59], v[24:27]
    ds_read_b128 v[88:91], v15 offset:20480
    v_mfma_f32_16x16x32_bf16 v[24:27], v[180:183], v[64:67], v[24:27]
    ds_read_b128 v[92:95], v15 offset:24576
    v_mfma_f32_16x16x32_bf16 v[20:23], v[180:183], v[60:63], v[20:23]
    ds_read_b128 v[96:99], v15 offset:28672
    s_waitcnt lgkmcnt(4)
    v_mfma_f32_16x16x32_bf16 v[20:23], v[184:187], v[68:71], v[20:23]
    ds_read_b128 v[52:55], v15 offset:17408
    v_mfma_f32_16x16x32_bf16 v[24:27], v[184:187], v[72:75], v[24:27]
    ds_read_b128 v[56:59], v15 offset:21504
    v_mfma_f32_16x16x32_bf16 v[24:27], v[188:191], v[80:83], v[24:27]
    ds_read_b128 v[60:63], v15 offset:25600
    v_mfma_f32_16x16x32_bf16 v[20:23], v[188:191], v[76:79], v[20:23]
    ds_read_b128 v[64:67], v15 offset:29696
    s_waitcnt lgkmcnt(4)
    v_mfma_f32_16x16x32_bf16 v[20:23], v[192:195], v[84:87], v[20:23]
    ds_read_b128 v[68:71], v15 offset:18432
    v_mfma_f32_16x16x32_bf16 v[24:27], v[192:195], v[88:91], v[24:27]
    ds_read_b128 v[72:75], v15 offset:22528
    v_mfma_f32_16x16x32_bf16 v[24:27], v[196:199], v[96:99], v[24:27]
    ds_read_b128 v[76:79], v15 offset:26624
    v_mfma_f32_16x16x32_bf16 v[20:23], v[196:199], v[92:95], v[20:23]
    ds_read_b128 v[80:83], v15 offset:30720
    s_waitcnt lgkmcnt(4)
    v_mfma_f32_16x16x32_bf16 v[20:23], v[200:203], v[52:55], v[20:23]
    ds_read_b128 v[84:87], v15 offset:19456
    v_mfma_f32_16x16x32_bf16 v[24:27], v[200:203], v[56:59], v[24:27]
    ds_read_b128 v[88:91], v15 offset:23552
    v_mfma_f32_16x16x32_bf16 v[24:27], v[204:207], v[64:67], v[24:27]
    ds_read_b128 v[92:95], v15 offset:27648
    v_mfma_f32_16x16x32_bf16 v[20:23], v[204:207], v[60:63], v[20:23]
    ds_read_b128 v[96:99], v15 offset:31744
    s_barrier
    s_waitcnt lgkmcnt(4)
    v_mfma_f32_16x16x32_bf16 v[20:23], v[208:211], v[68:71], v[20:23]
    ds_read_b128 v[52:55], v15 offset:32768
    v_mfma_f32_16x16x32_bf16 v[24:27], v[208:211], v[72:75], v[24:27]
    ds_read_b128 v[56:59], v15 offset:36864
    v_mfma_f32_16x16x32_bf16 v[24:27], v[212:215], v[80:83], v[24:27]
    ds_read_b128 v[60:63], v15 offset:40960
    v_mfma_f32_16x16x32_bf16 v[20:23], v[212:215], v[76:79], v[20:23]
    ds_read_b128 v[64:67], v15 offset:45056
    s_waitcnt lgkmcnt(4)
    v_mfma_f32_16x16x32_bf16 v[20:23], v[216:219], v[84:87], v[20:23]
    ds_read_b128 v[68:71], v15 offset:33792
    v_mfma_f32_16x16x32_bf16 v[24:27], v[216:219], v[88:91], v[24:27]
    ds_read_b128 v[72:75], v15 offset:37888
    v_mfma_f32_16x16x32_bf16 v[24:27], v[220:223], v[96:99], v[24:27]
    ds_read_b128 v[76:79], v15 offset:41984
    v_mfma_f32_16x16x32_bf16 v[20:23], v[220:223], v[92:95], v[20:23]
    ds_read_b128 v[80:83], v15 offset:46080
    s_waitcnt lgkmcnt(4)
    v_mfma_f32_16x16x32_bf16 v[20:23], v[224:227], v[52:55], v[20:23]
    ds_read_b128 v[84:87], v15 offset:34816
    v_mfma_f32_16x16x32_bf16 v[24:27], v[224:227], v[56:59], v[24:27]
    ds_read_b128 v[88:91], v15 offset:38912
    v_mfma_f32_16x16x32_bf16 v[24:27], v[228:231], v[64:67], v[24:27]
    ds_read_b128 v[92:95], v15 offset:43008
    v_mfma_f32_16x16x32_bf16 v[20:23], v[228:231], v[60:63], v[20:23]
    ds_read_b128 v[96:99], v15 offset:47104
    s_waitcnt lgkmcnt(4)
    v_mfma_f32_16x16x32_bf16 v[20:23], v[232:235], v[68:71], v[20:23]
    ds_read_b128 v[52:55], v15 offset:35840
    v_mfma_f32_16x16x32_bf16 v[24:27], v[232:235], v[72:75], v[24:27]
    ds_read_b128 v[56:59], v15 offset:39936
    v_mfma_f32_16x16x32_bf16 v[24:27], v[236:239], v[80:83], v[24:27]
    ds_read_b128 v[60:63], v15 offset:44032
    v_mfma_f32_16x16x32_bf16 v[20:23], v[236:239], v[76:79], v[20:23]
    ds_read_b128 v[64:67], v15 offset:48128
    s_barrier
    s_waitcnt lgkmcnt(4)
    v_mfma_f32_16x16x32_bf16 v[20:23], v[240:243], v[84:87], v[20:23]
    ds_read_b128 v[68:71], v14 offset:16384
    v_mfma_f32_16x16x32_bf16 v[24:27], v[240:243], v[88:91], v[24:27]
    ds_read_b128 v[72:75], v14 offset:20480
    v_mfma_f32_16x16x32_bf16 v[24:27], v[244:247], v[96:99], v[24:27]
    ds_read_b128 v[76:79], v14 offset:24576
    v_mfma_f32_16x16x32_bf16 v[20:23], v[244:247], v[92:95], v[20:23]
    ds_read_b128 v[80:83], v14 offset:28672
    s_waitcnt lgkmcnt(4)
    v_mfma_f32_16x16x32_bf16 v[20:23], v[248:251], v[52:55], v[20:23]
    ds_read_b128 v[84:87], v14 offset:17408
    v_mfma_f32_16x16x32_bf16 v[24:27], v[248:251], v[56:59], v[24:27]
    ds_read_b128 v[88:91], v14 offset:21504
    v_mfma_f32_16x16x32_bf16 v[24:27], v[252:255], v[64:67], v[24:27]
    ds_read_b128 v[92:95], v14 offset:25600
    v_mfma_f32_16x16x32_bf16 v[20:23], v[252:255], v[60:63], v[20:23]
    ds_read_b128 v[96:99], v14 offset:29696
    s_waitcnt lgkmcnt(4)
    v_mfma_f32_16x16x32_bf16 v[28:31], v[128:131], v[68:71], v[28:31]
    ds_read_b128 v[52:55], v14 offset:18432
    v_mfma_f32_16x16x32_bf16 v[32:35], v[128:131], v[72:75], v[32:35]
    ds_read_b128 v[56:59], v14 offset:22528
    v_mfma_f32_16x16x32_bf16 v[32:35], v[132:135], v[80:83], v[32:35]
    ds_read_b128 v[60:63], v14 offset:26624
    v_mfma_f32_16x16x32_bf16 v[28:31], v[132:135], v[76:79], v[28:31]
    ds_read_b128 v[64:67], v14 offset:30720
    v_cvt_pk_bf16_f32 v20, v20, v21
    v_cvt_pk_bf16_f32 v21, v22, v23
    v_cvt_pk_bf16_f32 v22, v24, v25
    v_cvt_pk_bf16_f32 v23, v26, v27
    s_add_u32 s36, s39, 0
    v_permlane16_swap_b32 v20, v22
    v_permlane16_swap_b32 v21, v23
    s_waitcnt lgkmcnt(4)
    v_mfma_f32_16x16x32_bf16 v[28:31], v[136:139], v[84:87], v[28:31]
    ds_read_b128 v[68:71], v14 offset:19456
    v_mfma_f32_16x16x32_bf16 v[32:35], v[136:139], v[88:91], v[32:35]
    ds_read_b128 v[72:75], v14 offset:23552
    v_mfma_f32_16x16x32_bf16 v[32:35], v[140:143], v[96:99], v[32:35]
    ds_read_b128 v[76:79], v14 offset:27648
    v_mfma_f32_16x16x32_bf16 v[28:31], v[140:143], v[92:95], v[28:31]
    ds_read_b128 v[80:83], v14 offset:31744
    s_barrier
    s_waitcnt lgkmcnt(4)
    v_mfma_f32_16x16x32_bf16 v[28:31], v[144:147], v[52:55], v[28:31]
    ds_read_b128 v[84:87], v14 offset:32768
    v_mfma_f32_16x16x32_bf16 v[32:35], v[144:147], v[56:59], v[32:35]
    ds_read_b128 v[88:91], v14 offset:36864
    v_mfma_f32_16x16x32_bf16 v[32:35], v[148:151], v[64:67], v[32:35]
    ds_read_b128 v[92:95], v14 offset:40960
    v_mfma_f32_16x16x32_bf16 v[28:31], v[148:151], v[60:63], v[28:31]
    ds_read_b128 v[96:99], v14 offset:45056
    s_waitcnt lgkmcnt(4)
    v_mfma_f32_16x16x32_bf16 v[28:31], v[152:155], v[68:71], v[28:31]
    ds_read_b128 v[52:55], v14 offset:33792
    v_mfma_f32_16x16x32_bf16 v[32:35], v[152:155], v[72:75], v[32:35]
    ds_read_b128 v[56:59], v14 offset:37888
    v_mfma_f32_16x16x32_bf16 v[32:35], v[156:159], v[80:83], v[32:35]
    ds_read_b128 v[60:63], v14 offset:41984
    v_mfma_f32_16x16x32_bf16 v[28:31], v[156:159], v[76:79], v[28:31]
    ds_read_b128 v[64:67], v14 offset:46080
    s_waitcnt lgkmcnt(4)
    v_mfma_f32_16x16x32_bf16 v[28:31], v[160:163], v[84:87], v[28:31]
    ds_read_b128 v[68:71], v14 offset:34816
    v_mfma_f32_16x16x32_bf16 v[32:35], v[160:163], v[88:91], v[32:35]
    ds_read_b128 v[72:75], v14 offset:38912
    v_mfma_f32_16x16x32_bf16 v[32:35], v[164:167], v[96:99], v[32:35]
    ds_read_b128 v[76:79], v14 offset:43008
    v_mfma_f32_16x16x32_bf16 v[28:31], v[164:167], v[92:95], v[28:31]
    ds_read_b128 v[80:83], v14 offset:47104
    s_waitcnt lgkmcnt(4)
    v_mfma_f32_16x16x32_bf16 v[28:31], v[168:171], v[52:55], v[28:31]
    ds_read_b128 v[84:87], v14 offset:35840
    v_mfma_f32_16x16x32_bf16 v[32:35], v[168:171], v[56:59], v[32:35]
    ds_read_b128 v[88:91], v14 offset:39936
    v_mfma_f32_16x16x32_bf16 v[32:35], v[172:175], v[64:67], v[32:35]
    ds_read_b128 v[92:95], v14 offset:44032
    v_mfma_f32_16x16x32_bf16 v[28:31], v[172:175], v[60:63], v[28:31]
    ds_read_b128 v[96:99], v14 offset:48128
    s_barrier
    s_waitcnt lgkmcnt(4)
    v_mfma_f32_16x16x32_bf16 v[28:31], v[176:179], v[68:71], v[28:31]
    ds_read_b128 v[52:55], v15 offset:0
    v_mfma_f32_16x16x32_bf16 v[32:35], v[176:179], v[72:75], v[32:35]
    ds_read_b128 v[56:59], v15 offset:4096
    v_mfma_f32_16x16x32_bf16 v[32:35], v[180:183], v[80:83], v[32:35]
    ds_read_b128 v[60:63], v15 offset:8192
    v_mfma_f32_16x16x32_bf16 v[28:31], v[180:183], v[76:79], v[28:31]
    ds_read_b128 v[64:67], v15 offset:12288
    s_waitcnt lgkmcnt(4)
    v_mfma_f32_16x16x32_bf16 v[28:31], v[184:187], v[84:87], v[28:31]
    ds_read_b128 v[68:71], v15 offset:1024
    v_mfma_f32_16x16x32_bf16 v[32:35], v[184:187], v[88:91], v[32:35]
    ds_read_b128 v[72:75], v15 offset:5120
    v_mfma_f32_16x16x32_bf16 v[32:35], v[188:191], v[96:99], v[32:35]
    ds_read_b128 v[76:79], v15 offset:9216
    v_mfma_f32_16x16x32_bf16 v[28:31], v[188:191], v[92:95], v[28:31]
    ds_read_b128 v[80:83], v15 offset:13312
    s_waitcnt lgkmcnt(4)
    v_mfma_f32_16x16x32_bf16 v[28:31], v[192:195], v[52:55], v[28:31]
    ds_read_b128 v[84:87], v15 offset:2048
    v_mfma_f32_16x16x32_bf16 v[32:35], v[192:195], v[56:59], v[32:35]
    ds_read_b128 v[88:91], v15 offset:6144
    v_mfma_f32_16x16x32_bf16 v[32:35], v[196:199], v[64:67], v[32:35]
    ds_read_b128 v[92:95], v15 offset:10240
    v_mfma_f32_16x16x32_bf16 v[28:31], v[196:199], v[60:63], v[28:31]
    ds_read_b128 v[96:99], v15 offset:14336
    s_waitcnt lgkmcnt(4)
    v_mfma_f32_16x16x32_bf16 v[28:31], v[200:203], v[68:71], v[28:31]
    ds_read_b128 v[52:55], v15 offset:3072
    v_mfma_f32_16x16x32_bf16 v[32:35], v[200:203], v[72:75], v[32:35]
    ds_read_b128 v[56:59], v15 offset:7168
    v_mfma_f32_16x16x32_bf16 v[32:35], v[204:207], v[80:83], v[32:35]
    ds_read_b128 v[60:63], v15 offset:11264
    v_mfma_f32_16x16x32_bf16 v[28:31], v[204:207], v[76:79], v[28:31]
    ds_read_b128 v[64:67], v15 offset:15360
    s_barrier
    s_waitcnt lgkmcnt(4)
    v_mfma_f32_16x16x32_bf16 v[28:31], v[208:211], v[84:87], v[28:31]
    ds_read_b128 v[68:71], v15 offset:16384
    v_mfma_f32_16x16x32_bf16 v[32:35], v[208:211], v[88:91], v[32:35]
    ds_read_b128 v[72:75], v15 offset:20480
    v_mfma_f32_16x16x32_bf16 v[32:35], v[212:215], v[96:99], v[32:35]
    ds_read_b128 v[76:79], v15 offset:24576
    v_mfma_f32_16x16x32_bf16 v[28:31], v[212:215], v[92:95], v[28:31]
    ds_read_b128 v[80:83], v15 offset:28672
    s_waitcnt lgkmcnt(4)
    v_mfma_f32_16x16x32_bf16 v[28:31], v[216:219], v[52:55], v[28:31]
    ds_read_b128 v[84:87], v15 offset:17408
    v_mfma_f32_16x16x32_bf16 v[32:35], v[216:219], v[56:59], v[32:35]
    ds_read_b128 v[88:91], v15 offset:21504
    v_mfma_f32_16x16x32_bf16 v[32:35], v[220:223], v[64:67], v[32:35]
    ds_read_b128 v[92:95], v15 offset:25600
    v_mfma_f32_16x16x32_bf16 v[28:31], v[220:223], v[60:63], v[28:31]
    ds_read_b128 v[96:99], v15 offset:29696
    s_waitcnt lgkmcnt(4)
    v_mfma_f32_16x16x32_bf16 v[28:31], v[224:227], v[68:71], v[28:31]
    ds_read_b128 v[52:55], v15 offset:18432
    v_mfma_f32_16x16x32_bf16 v[32:35], v[224:227], v[72:75], v[32:35]
    ds_read_b128 v[56:59], v15 offset:22528
    v_mfma_f32_16x16x32_bf16 v[32:35], v[228:231], v[80:83], v[32:35]
    ds_read_b128 v[60:63], v15 offset:26624
    v_mfma_f32_16x16x32_bf16 v[28:31], v[228:231], v[76:79], v[28:31]
    ds_read_b128 v[64:67], v15 offset:30720
    s_waitcnt lgkmcnt(4)
    v_mfma_f32_16x16x32_bf16 v[28:31], v[232:235], v[84:87], v[28:31]
    ds_read_b128 v[68:71], v15 offset:19456
    v_mfma_f32_16x16x32_bf16 v[32:35], v[232:235], v[88:91], v[32:35]
    ds_read_b128 v[72:75], v15 offset:23552
    v_mfma_f32_16x16x32_bf16 v[32:35], v[236:239], v[96:99], v[32:35]
    ds_read_b128 v[76:79], v15 offset:27648
    v_mfma_f32_16x16x32_bf16 v[28:31], v[236:239], v[92:95], v[28:31]
    ds_read_b128 v[80:83], v15 offset:31744
    s_barrier
    s_waitcnt lgkmcnt(4)
    v_mfma_f32_16x16x32_bf16 v[28:31], v[240:243], v[52:55], v[28:31]
    ds_read_b128 v[84:87], v15 offset:32768
    v_mfma_f32_16x16x32_bf16 v[32:35], v[240:243], v[56:59], v[32:35]
    ds_read_b128 v[88:91], v15 offset:36864
    v_mfma_f32_16x16x32_bf16 v[32:35], v[244:247], v[64:67], v[32:35]
    ds_read_b128 v[92:95], v15 offset:40960
    v_mfma_f32_16x16x32_bf16 v[28:31], v[244:247], v[60:63], v[28:31]
    ds_read_b128 v[96:99], v15 offset:45056
    s_waitcnt lgkmcnt(4)
    v_mfma_f32_16x16x32_bf16 v[28:31], v[248:251], v[68:71], v[28:31]
    ds_read_b128 v[52:55], v15 offset:33792
    v_mfma_f32_16x16x32_bf16 v[32:35], v[248:251], v[72:75], v[32:35]
    ds_read_b128 v[56:59], v15 offset:37888
    v_mfma_f32_16x16x32_bf16 v[32:35], v[252:255], v[80:83], v[32:35]
    ds_read_b128 v[60:63], v15 offset:41984
    v_mfma_f32_16x16x32_bf16 v[28:31], v[252:255], v[76:79], v[28:31]
    ds_read_b128 v[64:67], v15 offset:46080
    s_waitcnt lgkmcnt(4)
    v_mfma_f32_16x16x32_bf16 v[36:39], v[128:131], v[84:87], v[36:39]
    ds_read_b128 v[68:71], v15 offset:34816
    v_mfma_f32_16x16x32_bf16 v[40:43], v[128:131], v[88:91], v[40:43]
    ds_read_b128 v[72:75], v15 offset:38912
    v_mfma_f32_16x16x32_bf16 v[40:43], v[132:135], v[96:99], v[40:43]
    ds_read_b128 v[76:79], v15 offset:43008
    v_mfma_f32_16x16x32_bf16 v[36:39], v[132:135], v[92:95], v[36:39]
    ds_read_b128 v[80:83], v15 offset:47104
    v_cvt_pk_bf16_f32 v28, v28, v29
    v_cvt_pk_bf16_f32 v29, v30, v31
    v_cvt_pk_bf16_f32 v30, v32, v33
    v_cvt_pk_bf16_f32 v31, v34, v35
    s_add_u32 s36, s39, 131072
    v_permlane16_swap_b32 v28, v30
    v_permlane16_swap_b32 v29, v31
    s_waitcnt lgkmcnt(4)
    v_mfma_f32_16x16x32_bf16 v[36:39], v[136:139], v[52:55], v[36:39]
    ds_read_b128 v[84:87], v15 offset:35840
    v_mfma_f32_16x16x32_bf16 v[40:43], v[136:139], v[56:59], v[40:43]
    ds_read_b128 v[88:91], v15 offset:39936
    v_mfma_f32_16x16x32_bf16 v[40:43], v[140:143], v[64:67], v[40:43]
    ds_read_b128 v[92:95], v15 offset:44032
    v_mfma_f32_16x16x32_bf16 v[36:39], v[140:143], v[60:63], v[36:39]
    ds_read_b128 v[96:99], v15 offset:48128
    s_barrier
    s_waitcnt lgkmcnt(4)
    v_mfma_f32_16x16x32_bf16 v[36:39], v[144:147], v[68:71], v[36:39]
    ds_read_b128 v[52:55], v14 offset:16384
    v_mfma_f32_16x16x32_bf16 v[40:43], v[144:147], v[72:75], v[40:43]
    ds_read_b128 v[56:59], v14 offset:20480
    v_mfma_f32_16x16x32_bf16 v[40:43], v[148:151], v[80:83], v[40:43]
    ds_read_b128 v[60:63], v14 offset:24576
    v_mfma_f32_16x16x32_bf16 v[36:39], v[148:151], v[76:79], v[36:39]
    ds_read_b128 v[64:67], v14 offset:28672
    s_waitcnt lgkmcnt(4)
    v_mfma_f32_16x16x32_bf16 v[36:39], v[152:155], v[84:87], v[36:39]
    ds_read_b128 v[68:71], v14 offset:17408
    v_mfma_f32_16x16x32_bf16 v[40:43], v[152:155], v[88:91], v[40:43]
    ds_read_b128 v[72:75], v14 offset:21504
    v_mfma_f32_16x16x32_bf16 v[40:43], v[156:159], v[96:99], v[40:43]
    ds_read_b128 v[76:79], v14 offset:25600
    v_mfma_f32_16x16x32_bf16 v[36:39], v[156:159], v[92:95], v[36:39]
    ds_read_b128 v[80:83], v14 offset:29696
    s_waitcnt lgkmcnt(4)
    v_mfma_f32_16x16x32_bf16 v[36:39], v[160:163], v[52:55], v[36:39]
    ds_read_b128 v[84:87], v14 offset:18432
    v_mfma_f32_16x16x32_bf16 v[40:43], v[160:163], v[56:59], v[40:43]
    ds_read_b128 v[88:91], v14 offset:22528
    v_mfma_f32_16x16x32_bf16 v[40:43], v[164:167], v[64:67], v[40:43]
    ds_read_b128 v[92:95], v14 offset:26624
    v_mfma_f32_16x16x32_bf16 v[36:39], v[164:167], v[60:63], v[36:39]
    ds_read_b128 v[96:99], v14 offset:30720
    s_waitcnt lgkmcnt(4)
    v_mfma_f32_16x16x32_bf16 v[36:39], v[168:171], v[68:71], v[36:39]
    ds_read_b128 v[52:55], v14 offset:19456
    v_mfma_f32_16x16x32_bf16 v[40:43], v[168:171], v[72:75], v[40:43]
    ds_read_b128 v[56:59], v14 offset:23552
    v_mfma_f32_16x16x32_bf16 v[40:43], v[172:175], v[80:83], v[40:43]
    ds_read_b128 v[60:63], v14 offset:27648
    v_mfma_f32_16x16x32_bf16 v[36:39], v[172:175], v[76:79], v[36:39]
    ds_read_b128 v[64:67], v14 offset:31744
    s_barrier
    s_waitcnt lgkmcnt(4)
    v_mfma_f32_16x16x32_bf16 v[36:39], v[176:179], v[84:87], v[36:39]
    ds_read_b128 v[68:71], v14 offset:32768
    v_mfma_f32_16x16x32_bf16 v[40:43], v[176:179], v[88:91], v[40:43]
    ds_read_b128 v[72:75], v14 offset:36864
    v_mfma_f32_16x16x32_bf16 v[40:43], v[180:183], v[96:99], v[40:43]
    ds_read_b128 v[76:79], v14 offset:40960
    v_mfma_f32_16x16x32_bf16 v[36:39], v[180:183], v[92:95], v[36:39]
    ds_read_b128 v[80:83], v14 offset:45056
    s_waitcnt lgkmcnt(4)
    v_mfma_f32_16x16x32_bf16 v[36:39], v[184:187], v[52:55], v[36:39]
    ds_read_b128 v[84:87], v14 offset:33792
    v_mfma_f32_16x16x32_bf16 v[40:43], v[184:187], v[56:59], v[40:43]
    ds_read_b128 v[88:91], v14 offset:37888
    v_mfma_f32_16x16x32_bf16 v[40:43], v[188:191], v[64:67], v[40:43]
    ds_read_b128 v[92:95], v14 offset:41984
    v_mfma_f32_16x16x32_bf16 v[36:39], v[188:191], v[60:63], v[36:39]
    ds_read_b128 v[96:99], v14 offset:46080
    s_waitcnt lgkmcnt(4)
    v_mfma_f32_16x16x32_bf16 v[36:39], v[192:195], v[68:71], v[36:39]
    ds_read_b128 v[52:55], v14 offset:34816
    v_mfma_f32_16x16x32_bf16 v[40:43], v[192:195], v[72:75], v[40:43]
    ds_read_b128 v[56:59], v14 offset:38912
    v_mfma_f32_16x16x32_bf16 v[40:43], v[196:199], v[80:83], v[40:43]
    ds_read_b128 v[60:63], v14 offset:43008
    v_mfma_f32_16x16x32_bf16 v[36:39], v[196:199], v[76:79], v[36:39]
    ds_read_b128 v[64:67], v14 offset:47104
    s_waitcnt lgkmcnt(4)
    v_mfma_f32_16x16x32_bf16 v[36:39], v[200:203], v[84:87], v[36:39]
    ds_read_b128 v[68:71], v14 offset:35840
    v_mfma_f32_16x16x32_bf16 v[40:43], v[200:203], v[88:91], v[40:43]
    ds_read_b128 v[72:75], v14 offset:39936
    v_mfma_f32_16x16x32_bf16 v[40:43], v[204:207], v[96:99], v[40:43]
    ds_read_b128 v[76:79], v14 offset:44032
    v_mfma_f32_16x16x32_bf16 v[36:39], v[204:207], v[92:95], v[36:39]
    ds_read_b128 v[80:83], v14 offset:48128
    s_barrier
    s_waitcnt lgkmcnt(4)
    v_mfma_f32_16x16x32_bf16 v[36:39], v[208:211], v[52:55], v[36:39]
    ds_read_b128 v[84:87], v15 offset:0
    v_mfma_f32_16x16x32_bf16 v[40:43], v[208:211], v[56:59], v[40:43]
    ds_read_b128 v[88:91], v15 offset:4096
    v_mfma_f32_16x16x32_bf16 v[40:43], v[212:215], v[64:67], v[40:43]
    ds_read_b128 v[92:95], v15 offset:8192
    v_mfma_f32_16x16x32_bf16 v[36:39], v[212:215], v[60:63], v[36:39]
    ds_read_b128 v[96:99], v15 offset:12288
    s_waitcnt lgkmcnt(4)
    v_mfma_f32_16x16x32_bf16 v[36:39], v[216:219], v[68:71], v[36:39]
    ds_read_b128 v[52:55], v15 offset:1024
    v_mfma_f32_16x16x32_bf16 v[40:43], v[216:219], v[72:75], v[40:43]
    ds_read_b128 v[56:59], v15 offset:5120
    v_mfma_f32_16x16x32_bf16 v[40:43], v[220:223], v[80:83], v[40:43]
    ds_read_b128 v[60:63], v15 offset:9216
    v_mfma_f32_16x16x32_bf16 v[36:39], v[220:223], v[76:79], v[36:39]
    ds_read_b128 v[64:67], v15 offset:13312
    s_waitcnt lgkmcnt(4)
    v_mfma_f32_16x16x32_bf16 v[36:39], v[224:227], v[84:87], v[36:39]
    ds_read_b128 v[68:71], v15 offset:2048
    v_mfma_f32_16x16x32_bf16 v[40:43], v[224:227], v[88:91], v[40:43]
    ds_read_b128 v[72:75], v15 offset:6144
    v_mfma_f32_16x16x32_bf16 v[40:43], v[228:231], v[96:99], v[40:43]
    ds_read_b128 v[76:79], v15 offset:10240
    v_mfma_f32_16x16x32_bf16 v[36:39], v[228:231], v[92:95], v[36:39]
    ds_read_b128 v[80:83], v15 offset:14336
    s_waitcnt lgkmcnt(4)
    v_mfma_f32_16x16x32_bf16 v[36:39], v[232:235], v[52:55], v[36:39]
    ds_read_b128 v[84:87], v15 offset:3072
    v_mfma_f32_16x16x32_bf16 v[40:43], v[232:235], v[56:59], v[40:43]
    ds_read_b128 v[88:91], v15 offset:7168
    v_mfma_f32_16x16x32_bf16 v[40:43], v[236:239], v[64:67], v[40:43]
    ds_read_b128 v[92:95], v15 offset:11264
    v_mfma_f32_16x16x32_bf16 v[36:39], v[236:239], v[60:63], v[36:39]
    ds_read_b128 v[96:99], v15 offset:15360
    s_barrier
    s_waitcnt lgkmcnt(4)
    v_mfma_f32_16x16x32_bf16 v[36:39], v[240:243], v[68:71], v[36:39]
    ds_read_b128 v[52:55], v15 offset:16384
    v_mfma_f32_16x16x32_bf16 v[40:43], v[240:243], v[72:75], v[40:43]
    ds_read_b128 v[56:59], v15 offset:20480
    v_mfma_f32_16x16x32_bf16 v[40:43], v[244:247], v[80:83], v[40:43]
    ds_read_b128 v[60:63], v15 offset:24576
    v_mfma_f32_16x16x32_bf16 v[36:39], v[244:247], v[76:79], v[36:39]
    ds_read_b128 v[64:67], v15 offset:28672
    s_waitcnt lgkmcnt(4)
    v_mfma_f32_16x16x32_bf16 v[36:39], v[248:251], v[84:87], v[36:39]
    ds_read_b128 v[68:71], v15 offset:17408
    v_mfma_f32_16x16x32_bf16 v[40:43], v[248:251], v[88:91], v[40:43]
    ds_read_b128 v[72:75], v15 offset:21504
    v_mfma_f32_16x16x32_bf16 v[40:43], v[252:255], v[96:99], v[40:43]
    ds_read_b128 v[76:79], v15 offset:25600
    v_mfma_f32_16x16x32_bf16 v[36:39], v[252:255], v[92:95], v[36:39]
    ds_read_b128 v[80:83], v15 offset:29696
    s_waitcnt lgkmcnt(4)
    v_mfma_f32_16x16x32_bf16 v[44:47], v[128:131], v[52:55], v[44:47]
    ds_read_b128 v[84:87], v15 offset:18432
    v_mfma_f32_16x16x32_bf16 v[48:51], v[128:131], v[56:59], v[48:51]
    ds_read_b128 v[88:91], v15 offset:22528
    v_mfma_f32_16x16x32_bf16 v[48:51], v[132:135], v[64:67], v[48:51]
    ds_read_b128 v[92:95], v15 offset:26624
    v_mfma_f32_16x16x32_bf16 v[44:47], v[132:135], v[60:63], v[44:47]
    ds_read_b128 v[96:99], v15 offset:30720
    v_cvt_pk_bf16_f32 v36, v36, v37
    v_cvt_pk_bf16_f32 v37, v38, v39
    v_cvt_pk_bf16_f32 v38, v40, v41
    v_cvt_pk_bf16_f32 v39, v42, v43
    s_add_u32 s36, s39, 262144
    v_permlane16_swap_b32 v36, v38
    v_permlane16_swap_b32 v37, v39
    s_waitcnt lgkmcnt(4)
    v_mfma_f32_16x16x32_bf16 v[44:47], v[136:139], v[68:71], v[44:47]
    ds_read_b128 v[52:55], v15 offset:19456
    v_mfma_f32_16x16x32_bf16 v[48:51], v[136:139], v[72:75], v[48:51]
    ds_read_b128 v[56:59], v15 offset:23552
    v_mfma_f32_16x16x32_bf16 v[48:51], v[140:143], v[80:83], v[48:51]
    ds_read_b128 v[60:63], v15 offset:27648
    v_mfma_f32_16x16x32_bf16 v[44:47], v[140:143], v[76:79], v[44:47]
    ds_read_b128 v[64:67], v15 offset:31744
    s_barrier
    s_waitcnt lgkmcnt(4)
    v_mfma_f32_16x16x32_bf16 v[44:47], v[144:147], v[84:87], v[44:47]
    ds_read_b128 v[68:71], v15 offset:32768
    v_mfma_f32_16x16x32_bf16 v[48:51], v[144:147], v[88:91], v[48:51]
    ds_read_b128 v[72:75], v15 offset:36864
    v_mfma_f32_16x16x32_bf16 v[48:51], v[148:151], v[96:99], v[48:51]
    ds_read_b128 v[76:79], v15 offset:40960
    v_mfma_f32_16x16x32_bf16 v[44:47], v[148:151], v[92:95], v[44:47]
    ds_read_b128 v[80:83], v15 offset:45056
    s_add_u32 s36, s39, 0
    buffer_store_dwordx4 v[20:23], v13, s[24:27], s36 offen sc1
    s_waitcnt lgkmcnt(4)
    v_mfma_f32_16x16x32_bf16 v[44:47], v[152:155], v[52:55], v[44:47]
    ds_read_b128 v[84:87], v15 offset:33792
    v_mfma_f32_16x16x32_bf16 v[48:51], v[152:155], v[56:59], v[48:51]
    ds_read_b128 v[88:91], v15 offset:37888
    v_mfma_f32_16x16x32_bf16 v[48:51], v[156:159], v[64:67], v[48:51]
    ds_read_b128 v[92:95], v15 offset:41984
    v_mfma_f32_16x16x32_bf16 v[44:47], v[156:159], v[60:63], v[44:47]
    ds_read_b128 v[96:99], v15 offset:46080
    s_add_u32 s36, s39, 131072
    buffer_store_dwordx4 v[28:31], v13, s[24:27], s36 offen sc1
    s_waitcnt lgkmcnt(4)
    v_mfma_f32_16x16x32_bf16 v[44:47], v[160:163], v[68:71], v[44:47]
    ds_read_b128 v[52:55], v15 offset:34816
    v_mfma_f32_16x16x32_bf16 v[48:51], v[160:163], v[72:75], v[48:51]
    ds_read_b128 v[56:59], v15 offset:38912
    v_mfma_f32_16x16x32_bf16 v[48:51], v[164:167], v[80:83], v[48:51]
    ds_read_b128 v[60:63], v15 offset:43008
    v_mfma_f32_16x16x32_bf16 v[44:47], v[164:167], v[76:79], v[44:47]
    ds_read_b128 v[64:67], v15 offset:47104
    s_add_u32 s36, s39, 262144
    buffer_store_dwordx4 v[36:39], v13, s[24:27], s36 offen sc1
    s_waitcnt lgkmcnt(4)
    v_mfma_f32_16x16x32_bf16 v[44:47], v[168:171], v[84:87], v[44:47]
    ds_read_b128 v[68:71], v15 offset:35840
    v_mfma_f32_16x16x32_bf16 v[48:51], v[168:171], v[88:91], v[48:51]
    ds_read_b128 v[72:75], v15 offset:39936
    v_mfma_f32_16x16x32_bf16 v[48:51], v[172:175], v[96:99], v[48:51]
    ds_read_b128 v[76:79], v15 offset:44032
    v_mfma_f32_16x16x32_bf16 v[44:47], v[172:175], v[92:95], v[44:47]
    ds_read_b128 v[80:83], v15 offset:48128
    s_barrier
    s_waitcnt lgkmcnt(4)
    v_mfma_f32_16x16x32_bf16 v[44:47], v[176:179], v[52:55], v[44:47]
    ds_read_b128 v[84:87], v14 offset:16384
    v_mfma_f32_16x16x32_bf16 v[48:51], v[176:179], v[56:59], v[48:51]
    ds_read_b128 v[88:91], v14 offset:20480
    v_mfma_f32_16x16x32_bf16 v[48:51], v[180:183], v[64:67], v[48:51]
    ds_read_b128 v[92:95], v14 offset:24576
    v_mfma_f32_16x16x32_bf16 v[44:47], v[180:183], v[60:63], v[44:47]
    ds_read_b128 v[96:99], v14 offset:28672
    s_waitcnt lgkmcnt(4)
    v_mfma_f32_16x16x32_bf16 v[44:47], v[184:187], v[68:71], v[44:47]
    ds_read_b128 v[52:55], v14 offset:17408
    v_mfma_f32_16x16x32_bf16 v[48:51], v[184:187], v[72:75], v[48:51]
    ds_read_b128 v[56:59], v14 offset:21504
    v_mfma_f32_16x16x32_bf16 v[48:51], v[188:191], v[80:83], v[48:51]
    ds_read_b128 v[60:63], v14 offset:25600
    v_mfma_f32_16x16x32_bf16 v[44:47], v[188:191], v[76:79], v[44:47]
    ds_read_b128 v[64:67], v14 offset:29696
    s_waitcnt lgkmcnt(4)
    v_mfma_f32_16x16x32_bf16 v[44:47], v[192:195], v[84:87], v[44:47]
    ds_read_b128 v[68:71], v14 offset:18432
    v_mfma_f32_16x16x32_bf16 v[48:51], v[192:195], v[88:91], v[48:51]
    ds_read_b128 v[72:75], v14 offset:22528
    v_mfma_f32_16x16x32_bf16 v[48:51], v[196:199], v[96:99], v[48:51]
    ds_read_b128 v[76:79], v14 offset:26624
    v_mfma_f32_16x16x32_bf16 v[44:47], v[196:199], v[92:95], v[44:47]
    ds_read_b128 v[80:83], v14 offset:30720
    s_waitcnt lgkmcnt(4)
    v_mfma_f32_16x16x32_bf16 v[44:47], v[200:203], v[52:55], v[44:47]
    ds_read_b128 v[84:87], v14 offset:19456
    v_mfma_f32_16x16x32_bf16 v[48:51], v[200:203], v[56:59], v[48:51]
    ds_read_b128 v[88:91], v14 offset:23552
    v_mfma_f32_16x16x32_bf16 v[48:51], v[204:207], v[64:67], v[48:51]
    ds_read_b128 v[92:95], v14 offset:27648
    v_mfma_f32_16x16x32_bf16 v[44:47], v[204:207], v[60:63], v[44:47]
    ds_read_b128 v[96:99], v14 offset:31744
    s_barrier
    s_waitcnt lgkmcnt(4)
    v_mfma_f32_16x16x32_bf16 v[44:47], v[208:211], v[68:71], v[44:47]
    ds_read_b128 v[52:55], v14 offset:32768
    v_mfma_f32_16x16x32_bf16 v[48:51], v[208:211], v[72:75], v[48:51]
    ds_read_b128 v[56:59], v14 offset:36864
    v_mfma_f32_16x16x32_bf16 v[48:51], v[212:215], v[80:83], v[48:51]
    ds_read_b128 v[60:63], v14 offset:40960
    v_mfma_f32_16x16x32_bf16 v[44:47], v[212:215], v[76:79], v[44:47]
    ds_read_b128 v[64:67], v14 offset:45056
    s_waitcnt lgkmcnt(4)
    v_mfma_f32_16x16x32_bf16 v[44:47], v[216:219], v[84:87], v[44:47]
    ds_read_b128 v[68:71], v14 offset:33792
    v_mfma_f32_16x16x32_bf16 v[48:51], v[216:219], v[88:91], v[48:51]
    ds_read_b128 v[72:75], v14 offset:37888
    v_mfma_f32_16x16x32_bf16 v[48:51], v[220:223], v[96:99], v[48:51]
    ds_read_b128 v[76:79], v14 offset:41984
    v_mfma_f32_16x16x32_bf16 v[44:47], v[220:223], v[92:95], v[44:47]
    ds_read_b128 v[80:83], v14 offset:46080
    s_waitcnt lgkmcnt(4)
    v_mfma_f32_16x16x32_bf16 v[44:47], v[224:227], v[52:55], v[44:47]
    ds_read_b128 v[84:87], v14 offset:34816
    v_mfma_f32_16x16x32_bf16 v[48:51], v[224:227], v[56:59], v[48:51]
    ds_read_b128 v[88:91], v14 offset:38912
    v_mfma_f32_16x16x32_bf16 v[48:51], v[228:231], v[64:67], v[48:51]
    ds_read_b128 v[92:95], v14 offset:43008
    v_mfma_f32_16x16x32_bf16 v[44:47], v[228:231], v[60:63], v[44:47]
    ds_read_b128 v[96:99], v14 offset:47104
    s_waitcnt lgkmcnt(4)
    v_mfma_f32_16x16x32_bf16 v[44:47], v[232:235], v[68:71], v[44:47]
    ds_read_b128 v[52:55], v14 offset:35840
    v_mfma_f32_16x16x32_bf16 v[48:51], v[232:235], v[72:75], v[48:51]
    ds_read_b128 v[56:59], v14 offset:39936
    v_mfma_f32_16x16x32_bf16 v[48:51], v[236:239], v[80:83], v[48:51]
    ds_read_b128 v[60:63], v14 offset:44032
    v_mfma_f32_16x16x32_bf16 v[44:47], v[236:239], v[76:79], v[44:47]
    ds_read_b128 v[64:67], v14 offset:48128
    ds_write_b128 v16, v[20:23] offset:0
    ds_write_b128 v16, v[28:31] offset:4096
    ds_write_b128 v16, v[36:39] offset:8192
    s_waitcnt lgkmcnt(7)
    v_mfma_f32_16x16x32_bf16 v[44:47], v[240:243], v[84:87], v[44:47]
    v_mfma_f32_16x16x32_bf16 v[48:51], v[240:243], v[88:91], v[48:51]
    v_mfma_f32_16x16x32_bf16 v[48:51], v[244:247], v[96:99], v[48:51]
    v_mfma_f32_16x16x32_bf16 v[44:47], v[244:247], v[92:95], v[44:47]
    s_waitcnt lgkmcnt(3)
    v_mfma_f32_16x16x32_bf16 v[44:47], v[248:251], v[52:55], v[44:47]
    v_mfma_f32_16x16x32_bf16 v[48:51], v[248:251], v[56:59], v[48:51]
    v_mfma_f32_16x16x32_bf16 v[48:51], v[252:255], v[64:67], v[48:51]
    v_mfma_f32_16x16x32_bf16 v[44:47], v[252:255], v[60:63], v[44:47]
    s_setprio 0
    s_nop 6
    v_cvt_pk_bf16_f32 v44, v44, v45
    v_cvt_pk_bf16_f32 v45, v46, v47
    v_cvt_pk_bf16_f32 v46, v48, v49
    v_cvt_pk_bf16_f32 v47, v50, v51
    s_add_u32 s36, s39, 393216
    v_permlane16_swap_b32 v44, v46
    v_permlane16_swap_b32 v45, v47
    s_add_u32 s36, s39, 393216
    buffer_store_dwordx4 v[44:47], v13, s[24:27], s36 offen sc1
    ds_write_b128 v16, v[44:47] offset:12288
    s_waitcnt lgkmcnt(0)
    s_barrier
    s_cmp_ge_u32 s30, 6
    s_cbranch_scc1 WLOAD
    s_and_b32 s35, s30, 1
    s_add_u32 s12, s62, 0x480000
    s_addc_u32 s13, s63, 0
    s_mov_b32 s14, 0x7e000
    s_mov_b32 s15, 0x20000
    s_mul_i32 s38, s35, 262144
    s_lshl_b32 s41, s35, 13
    s_mov_b32 s42, 0
    s_mov_b32 s44, s29
    s_add_u32 s54, s55, 0x100
    v_mov_b32 v9, s54
    v_lshl_add_u32 v9, v1, 7, v9
    s_add_u32 s44, s44, 1
    s_and_b32 s44, s44, 15
    s_add_u32 s46, s29, 1
    s_and_b32 s46, s46, 15
    s_cmp_eq_u32 s28, s29
    s_cselect_b32 s47, s46, s28
    s_mov_b32 s42, 16384
    s_add_u32 s54, s55, 0x580
    v_mov_b32 v11, s54
    v_lshlrev_b32 v10, 3, v1
    s_add_u32 s20, s62, 0x1c8000
    s_addc_u32 s21, s63, 0
    s_mov_b32 s22, 0x6000
    s_mov_b32 s23, 0x20000
    s_and_b32 s34, s30, 1
    s_lshl_b32 s34, s34, 9
    s_call_b64 s[76:77], PREP_a_issue_3
    s_mov_b32 m0, s19
    s_mov_b32 s39, s16
    s_and_b32 s36, s30, 3
    s_lshl_b32 s36, s36, 7
    s_add_u32 s36, s36, s55
    s_add_u32 s36, s36, 256
    v_mov_b32 v14, 1
    v_mov_b32 v15, 162816
    v_mov_b32 v17, 0
    s_mov_b64 exec, 1
    s_waitcnt vmcnt(0)
    buffer_atomic_add v14, v17, s[56:59], s36 offen sc1
pub_48:
    s_mov_b64 exec, -1
    s_call_b64 s[76:77], SUB_rest_2
    s_waitcnt lgkmcnt(0)
    s_mov_b32 s53, 0
    s_add_u32 s54, s52, 16
    s_bfm_b64 exec, 4, 0
poll_49:
    buffer_load_dword v8, v9, s[56:59], 0 offen sc1
    s_waitcnt vmcnt(0)
    v_cmp_eq_u32 vcc, s54, v8
    s_nop 0
    s_cmp_eq_u64 vcc, exec
    s_cbranch_scc1 pok_50
    s_sleep 5
    s_add_u32 s53, s53, 1
    s_cmp_lt_u32 s53, s61
    s_cbranch_scc1 poll_49
    s_mov_b32 s61, 0
pok_50:
    s_mov_b64 exec, -1
    buffer_load_dwordx4 v2, s[12:15], s39 offen sc1 lds
    buffer_load_dwordx4 v2, s[12:15], s39 offen offset:1024 sc1 lds
    s_call_b64 s[76:77], PREP_a_issue_3
    s_add_u32 m0, m0, 2048
    s_add_u32 s39, s39, 65536
    buffer_load_dwordx4 v2, s[12:15], s39 offen sc1 lds
    buffer_load_dwordx4 v2, s[12:15], s39 offen offset:1024 sc1 lds
    s_add_u32 m0, m0, 2048
    s_add_u32 s39, s39, 65536
    buffer_load_dwordx4 v2, s[12:15], s39 offen sc1 lds
    buffer_load_dwordx4 v2, s[12:15], s39 offen offset:1024 sc1 lds
    s_add_u32 m0, m0, 2048
    s_add_u32 s39, s39, 65536
    buffer_load_dwordx4 v2, s[12:15], s39 offen sc1 lds
    buffer_load_dwordx4 v2, s[12:15], s39 offen offset:1024 sc1 lds
    s_mov_b32 m0, s19
    s_mov_b32 s39, s16
    buffer_load_dwordx4 v2, s[12:15], s39 offen sc1 lds
    buffer_load_dwordx4 v2, s[12:15], s39 offen offset:1024 sc1 lds
    s_call_b64 s[76:77], PREP_a_issue_3
    s_add_u32 m0, m0, 2048
    s_add_u32 s39, s39, 65536
    buffer_load_dwordx4 v2, s[12:15], s39 offen sc1 lds
    buffer_load_dwordx4 v2, s[12:15], s39 offen offset:1024 sc1 lds
    s_add_u32 m0, m0, 2048
    s_add_u32 s39, s39, 65536
    buffer_load_dwordx4 v2, s[12:15], s39 offen sc1 lds
    buffer_load_dwordx4 v2, s[12:15], s39 offen offset:1024 sc1 lds
    s_add_u32 m0, m0, 2048
    s_add_u32 s39, s39, 65536
    buffer_load_dwordx4 v2, s[12:15], s39 offen sc1 lds
    buffer_load_dwordx4 v2, s[12:15], s39 offen offset:1024 sc1 lds
    s_mov_b32 m0, s19
    s_mov_b32 s39, s16
    s_waitcnt vmcnt(8)
    s_barrier
    buffer_load_dwordx4 v2, s[12:15], s39 offen sc1 lds
    buffer_load_dwordx4 v2, s[12:15], s39 offen offset:1024 sc1 lds
    s_call_b64 s[76:77], PREP_a_issue_3
    s_add_u32 m0, m0, 2048
    s_add_u32 s39, s39, 65536
    buffer_load_dwordx4 v2, s[12:15], s39 offen sc1 lds
    buffer_load_dwordx4 v2, s[12:15], s39 offen offset:1024 sc1 lds
    s_add_u32 m0, m0, 2048
    s_add_u32 s39, s39, 65536
    buffer_load_dwordx4 v2, s[12:15], s39 offen sc1 lds
    buffer_load_dwordx4 v2, s[12:15], s39 offen offset:1024 sc1 lds
    s_add_u32 m0, m0, 2048
    s_add_u32 s39, s39, 65536
    buffer_load_dwordx4 v2, s[12:15], s39 offen sc1 lds
    buffer_load_dwordx4 v2, s[12:15], s39 offen offset:1024 sc1 lds
    s_mov_b32 m0, s19
    s_mov_b32 s39, s16
    s_add_u32 s36, s34, 155648
    v_add_u32 v51, s36, v10
    ds_read_b64 v[18:19], v51 offset:0
    ds_read_b64 v[20:21], v51 offset:1024
    ds_read_b64 v[22:23], v51 offset:2048
    ds_read_b64 v[24:25], v51 offset:3072
    s_lshr_b32 s53, s29, 3
    s_lshl_b32 s53, s53, 14
    s_and_b32 s36, s29, 7
    s_lshl_b32 s36, s36, 10
    s_add_u32 s36, s36, s53
    s_add_u32 s36, s36, s34
    s_waitcnt lgkmcnt(0)
    v_pk_add_f32 v[18:19], v[18:19], v[20:21]
    v_pk_add_f32 v[18:19], v[18:19], v[22:23]
    v_pk_add_f32 v[18:19], v[18:19], v[24:25]
    buffer_store_dwordx2 v[18:19], v10, s[20:23], s36 offen sc1
    s_waitcnt vmcnt(9)
    s_barrier
    buffer_load_dwordx4 v2, s[12:15], s39 offen sc1 lds
    buffer_load_dwordx4 v2, s[12:15], s39 offen offset:1024 sc1 lds
    s_call_b64 s[76:77], PREP_a_issue_3
    s_add_u32 m0, m0, 2048
    s_add_u32 s39, s39, 65536
    buffer_load_dwordx4 v2, s[12:15], s39 offen sc1 lds
    buffer_load_dwordx4 v2, s[12:15], s39 offen offset:1024 sc1 lds
    s_add_u32 m0, m0, 2048
    s_add_u32 s39, s39, 65536
    buffer_load_dwordx4 v2, s[12:15], s39 offen sc1 lds
    buffer_load_dwordx4 v2, s[12:15], s39 offen offset:1024 sc1 lds
    s_add_u32 m0, m0, 2048
    s_add_u32 s39, s39, 65536
    buffer_load_dwordx4 v2, s[12:15], s39 offen sc1 lds
    buffer_load_dwordx4 v2, s[12:15], s39 offen offset:1024 sc1 lds
    s_mov_b32 m0, s19
    s_mov_b32 s39, s16
    s_waitcnt vmcnt(9)
    s_barrier
    buffer_load_dwordx4 v2, s[12:15], s39 offen sc1 lds
    buffer_load_dwordx4 v2, s[12:15], s39 offen offset:1024 sc1 lds
    s_call_b64 s[76:77], PREP_a_issue_3
    s_add_u32 m0, m0, 2048
    s_add_u32 s39, s39, 65536
    buffer_load_dwordx4 v2, s[12:15], s39 offen sc1 lds
    buffer_load_dwordx4 v2, s[12:15], s39 offen offset:1024 sc1 lds
    s_add_u32 m0, m0, 2048
    s_add_u32 s39, s39, 65536
    buffer_load_dwordx4 v2, s[12:15], s39 offen sc1 lds
    buffer_load_dwordx4 v2, s[12:15], s39 offen offset:1024 sc1 lds
    s_add_u32 m0, m0, 2048
    s_add_u32 s39, s39, 65536
    buffer_load_dwordx4 v2, s[12:15], s39 offen sc1 lds
    buffer_load_dwordx4 v2, s[12:15], s39 offen offset:1024 sc1 lds
    s_mov_b32 m0, s19
    s_mov_b32 s39, s16
    s_waitcnt vmcnt(16)
    s_add_u32 s53, s55, 1408
    v_mov_b32 v14, 1
    v_mov_b32 v15, 162816
    v_mov_b32 v17, 0
    s_mov_b64 exec, 1
    buffer_atomic_add v14, v17, s[56:59], s53 offen sc1
pub_51:
    s_mov_b64 exec, -1
    s_waitcnt vmcnt(9)
    s_barrier
    buffer_load_dwordx4 v2, s[12:15], s39 offen sc1 lds
    buffer_load_dwordx4 v2, s[12:15], s39 offen offset:1024 sc1 lds
    s_call_b64 s[76:77], PREP_a_issue_3
    s_add_u32 m0, m0, 2048
    s_add_u32 s39, s39, 65536
    buffer_load_dwordx4 v2, s[12:15], s39 offen sc1 lds
    buffer_load_dwordx4 v2, s[12:15], s39 offen offset:1024 sc1 lds
    s_add_u32 m0, m0, 2048
    s_add_u32 s39, s39, 65536
    buffer_load_dwordx4 v2, s[12:15], s39 offen sc1 lds
    buffer_load_dwordx4 v2, s[12:15], s39 offen offset:1024 sc1 lds
    s_add_u32 m0, m0, 2048
    s_add_u32 s39, s39, 65536
    buffer_load_dwordx4 v2, s[12:15], s39 offen sc1 lds
    buffer_load_dwordx4 v2, s[12:15], s39 offen offset:1024 sc1 lds
    s_mov_b32 m0, s19
    s_mov_b32 s39, s16
    s_waitcnt vmcnt(9)
    s_barrier
    buffer_load_dwordx4 v2, s[12:15], s39 offen sc1 lds
    buffer_load_dwordx4 v2, s[12:15], s39 offen offset:1024 sc1 lds
    s_call_b64 s[76:77], PREP_a_issue_3
    s_add_u32 m0, m0, 2048
    s_add_u32 s39, s39, 65536
    buffer_load_dwordx4 v2, s[12:15], s39 offen sc1 lds
    buffer_load_dwordx4 v2, s[12:15], s39 offen offset:1024 sc1 lds
    s_add_u32 m0, m0, 2048
    s_add_u32 s39, s39, 65536
    buffer_load_dwordx4 v2, s[12:15], s39 offen sc1 lds
    buffer_load_dwordx4 v2, s[12:15], s39 offen offset:1024 sc1 lds
    s_add_u32 m0, m0, 2048
    s_add_u32 s39, s39, 65536
    buffer_load_dwordx4 v2, s[12:15], s39 offen sc1 lds
    buffer_load_dwordx4 v2, s[12:15], s39 offen offset:1024 sc1 lds
    s_mov_b32 m0, s19
    s_mov_b32 s39, s16
    s_waitcnt vmcnt(8)
    s_barrier
    buffer_load_dwordx4 v2, s[12:15], s39 offen sc1 lds
    buffer_load_dwordx4 v2, s[12:15], s39 offen offset:1024 sc1 lds
    s_call_b64 s[76:77], PREP_a_issue_3
    s_add_u32 m0, m0, 2048
    s_add_u32 s39, s39, 65536
    buffer_load_dwordx4 v2, s[12:15], s39 offen sc1 lds
    buffer_load_dwordx4 v2, s[12:15], s39 offen offset:1024 sc1 lds
    s_add_u32 m0, m0, 2048
    s_add_u32 s39, s39, 65536
    buffer_load_dwordx4 v2, s[12:15], s39 offen sc1 lds
    buffer_load_dwordx4 v2, s[12:15], s39 offen offset:1024 sc1 lds
    s_add_u32 m0, m0, 2048
    s_add_u32 s39, s39, 65536
    buffer_load_dwordx4 v2, s[12:15], s39 offen sc1 lds
    buffer_load_dwordx4 v2, s[12:15], s39 offen offset:1024 sc1 lds
    s_mov_b32 m0, s19
    s_mov_b32 s39, s16
    s_lshl_b32 s53, s29, 7
    s_add_u32 s53, s53, 23068672
    v_mov_b32 v16, s53
    s_mov_b64 exec, 1
    buffer_load_dword v12, v11, s[56:59], 0 offen sc1
    s_mov_b64 exec, -1
    s_mov_b64 exec, 1
    buffer_load_dword v17, v16, s[56:59], 0 offen sc1
    s_mov_b64 exec, -1
    s_waitcnt vmcnt(10)
    s_barrier
    buffer_load_dwordx4 v2, s[12:15], s39 offen sc1 lds
    buffer_load_dwordx4 v2, s[12:15], s39 offen offset:1024 sc1 lds
    s_call_b64 s[76:77], PREP_a_issue_3
    s_add_u32 m0, m0, 2048
    s_add_u32 s39, s39, 65536
    buffer_load_dwordx4 v2, s[12:15], s39 offen sc1 lds
    buffer_load_dwordx4 v2, s[12:15], s39 offen offset:1024 sc1 lds
    s_add_u32 m0, m0, 2048
    s_add_u32 s39, s39, 65536
    buffer_load_dwordx4 v2, s[12:15], s39 offen sc1 lds
    buffer_load_dwordx4 v2, s[12:15], s39 offen offset:1024 sc1 lds
    s_add_u32 m0, m0, 2048
    s_add_u32 s39, s39, 65536
    buffer_load_dwordx4 v2, s[12:15], s39 offen sc1 lds
    buffer_load_dwordx4 v2, s[12:15], s39 offen offset:1024 sc1 lds
    s_mov_b32 m0, s19
    s_mov_b32 s39, s16
    s_waitcnt vmcnt(10)
    s_barrier
    buffer_load_dwordx4 v2, s[12:15], s39 offen sc1 lds
    buffer_load_dwordx4 v2, s[12:15], s39 offen offset:1024 sc1 lds
    s_call_b64 s[76:77], PREP_a_issue_3
    s_add_u32 m0, m0, 2048
    s_add_u32 s39, s39, 65536
    buffer_load_dwordx4 v2, s[12:15], s39 offen sc1 lds
    buffer_load_dwordx4 v2, s[12:15], s39 offen offset:1024 sc1 lds
    s_add_u32 m0, m0, 2048
    s_add_u32 s39, s39, 65536
    buffer_load_dwordx4 v2, s[12:15], s39 offen sc1 lds
    buffer_load_dwordx4 v2, s[12:15], s39 offen offset:1024 sc1 lds
    s_add_u32 m0, m0, 2048
    s_add_u32 s39, s39, 65536
    buffer_load_dwordx4 v2, s[12:15], s39 offen sc1 lds
    buffer_load_dwordx4 v2, s[12:15], s39 offen offset:1024 sc1 lds
    s_mov_b32 m0, s19
    s_mov_b32 s39, s16
    s_waitcnt vmcnt(16)
    v_readfirstlane_b32 s53, v12
    s_add_u32 s54, s52, 32
    s_cmp_eq_u32 s53, s54
    s_cbranch_scc1 fok_52
    s_mov_b32 s53, 0
    s_add_u32 s54, s52, 32
    s_bfm_b64 exec, 1, 0
poll_53:
    buffer_load_dword v12, v11, s[56:59], 0 offen sc1
    s_waitcnt vmcnt(0)
    v_cmp_eq_u32 vcc, s54, v12
    s_nop 0
    s_cmp_eq_u64 vcc, exec
    s_cbranch_scc1 pok_54
    s_sleep 5
    s_add_u32 s53, s53, 1
    s_cmp_lt_u32 s53, s61
    s_cbranch_scc1 poll_53
    s_mov_b32 s61, 0
pok_54:
    s_mov_b64 exec, -1
fok_52:
    s_add_u32 s36, s34, 0
    buffer_load_dwordx2 v[18:19], v10, s[20:23], s36 offen offset:0 sc1
    buffer_load_dwordx2 v[20:21], v10, s[20:23], s36 offen offset:1024 sc1
    buffer_load_dwordx2 v[22:23], v10, s[20:23], s36 offen offset:2048 sc1
    buffer_load_dwordx2 v[24:25], v10, s[20:23], s36 offen offset:3072 sc1
    s_add_u32 s36, s36, 4096
    buffer_load_dwordx2 v[26:27], v10, s[20:23], s36 offen offset:0 sc1
    buffer_load_dwordx2 v[28:29], v10, s[20:23], s36 offen offset:1024 sc1
    buffer_load_dwordx2 v[30:31], v10, s[20:23], s36 offen offset:2048 sc1
    buffer_load_dwordx2 v[32:33], v10, s[20:23], s36 offen offset:3072 sc1
    s_waitcnt vmcnt(16)
    s_barrier
    buffer_load_dwordx4 v2, s[12:15], s39 offen sc1 lds
    buffer_load_dwordx4 v2, s[12:15], s39 offen offset:1024 sc1 lds
    s_call_b64 s[76:77], PREP_a_issue_3
    s_add_u32 m0, m0, 2048
    s_add_u32 s39, s39, 65536
    buffer_load_dwordx4 v2, s[12:15], s39 offen sc1 lds
    buffer_load_dwordx4 v2, s[12:15], s39 offen offset:1024 sc1 lds
    s_add_u32 m0, m0, 2048
    s_add_u32 s39, s39, 65536
    buffer_load_dwordx4 v2, s[12:15], s39 offen sc1 lds
    buffer_load_dwordx4 v2, s[12:15], s39 offen offset:1024 sc1 lds
    s_add_u32 m0, m0, 2048
    s_add_u32 s39, s39, 65536
    buffer_load_dwordx4 v2, s[12:15], s39 offen sc1 lds
    buffer_load_dwordx4 v2, s[12:15], s39 offen offset:1024 sc1 lds
    s_mov_b32 m0, s19
    s_mov_b32 s39, s16
    s_add_u32 s36, s34, 16384
    buffer_load_dwordx2 v[34:35], v10, s[20:23], s36 offen offset:0 sc1
    buffer_load_dwordx2 v[36:37], v10, s[20:23], s36 offen offset:1024 sc1
    buffer_load_dwordx2 v[38:39], v10, s[20:23], s36 offen offset:2048 sc1
    buffer_load_dwordx2 v[40:41], v10, s[20:23], s36 offen offset:3072 sc1
    s_add_u32 s36, s36, 4096
    buffer_load_dwordx2 v[42:43], v10, s[20:23], s36 offen offset:0 sc1
    buffer_load_dwordx2 v[44:45], v10, s[20:23], s36 offen offset:1024 sc1
    buffer_load_dwordx2 v[46:47], v10, s[20:23], s36 offen offset:2048 sc1
    buffer_load_dwordx2 v[48:49], v10, s[20:23], s36 offen offset:3072 sc1
    s_waitcnt vmcnt(24)
    s_barrier
    buffer_load_dwordx4 v2, s[12:15], s39 offen sc1 lds
    buffer_load_dwordx4 v2, s[12:15], s39 offen offset:1024 sc1 lds
    s_call_b64 s[76:77], PREP_a_issue_3
    s_add_u32 m0, m0, 2048
    s_add_u32 s39, s39, 65536
    buffer_load_dwordx4 v2, s[12:15], s39 offen sc1 lds
    buffer_load_dwordx4 v2, s[12:15], s39 offen offset:1024 sc1 lds
    s_add_u32 m0, m0, 2048
    s_add_u32 s39, s39, 65536
    buffer_load_dwordx4 v2, s[12:15], s39 offen sc1 lds
    buffer_load_dwordx4 v2, s[12:15], s39 offen offset:1024 sc1 lds
    s_add_u32 m0, m0, 2048
    s_add_u32 s39, s39, 65536
    buffer_load_dwordx4 v2, s[12:15], s39 offen sc1 lds
    buffer_load_dwordx4 v2, s[12:15], s39 offen offset:1024 sc1 lds
    s_mov_b32 m0, s19
    s_mov_b32 s39, s16
    v_readfirstlane_b32 s53, v17
    s_add_u32 s54, s52, 32
    s_cmp_eq_u32 s53, s54
    s_cbranch_scc1 fok_55
    s_mov_b32 s53, 0
    s_add_u32 s54, s52, 32
    s_bfm_b64 exec, 1, 0
poll_56:
    buffer_load_dword v17, v16, s[56:59], 0 offen sc1
    s_waitcnt vmcnt(0)
    v_cmp_eq_u32 vcc, s54, v17
    s_nop 0
    s_cmp_eq_u64 vcc, exec
    s_cbranch_scc1 pok_57
    s_sleep 5
    s_add_u32 s53, s53, 1
    s_cmp_lt_u32 s53, s61
    s_cbranch_scc1 poll_56
    s_mov_b32 s61, 0
pok_57:
    s_mov_b64 exec, -1
fok_55:
    s_add_u32 s24, s4, 0x1420000
    s_addc_u32 s25, s5, 0
    s_mov_b32 s26, 0x38000
    s_mov_b32 s27, 0x20000
    s_cmp_eq_u32 s60, 0
    s_cselect_b32 s26, s26, 0
    s_and_b32 s36, s30, 1
    s_mul_i32 s36, s36, 448
    s_mul_i32 s37, s29, 896
    s_add_u32 s37, s36, s37
    v_lshrrev_b32 v13, 5, v1
    v_mul_u32_u24 v13, 14336, v13
    v_and_b32 v6, 496, v2
    v_add_u32 v13, v13, v6
    buffer_load_dwordx4 v[54:57], v13, s[24:27], s37 offen sc1
    s_add_u32 s37, s37, 28672
    buffer_load_dwordx4 v[58:61], v13, s[24:27], s37 offen sc1
    s_add_u32 s37, s37, 28672
    buffer_load_dwordx4 v[62:65], v13, s[24:27], s37 offen sc1
    s_add_u32 s37, s37, 28672
    buffer_load_dwordx4 v[66:69], v13, s[24:27], s37 offen sc1
    s_add_u32 s37, s37, 28672
    buffer_load_dwordx4 v[70:73], v13, s[24:27], s37 offen sc1
    s_add_u32 s37, s37, 28672
    buffer_load_dwordx4 v[74:77], v13, s[24:27], s37 offen sc1
    s_add_u32 s37, s37, 28672
    buffer_load_dwordx4 v[78:81], v13, s[24:27], s37 offen sc1
    s_add_u32 s37, s37, 28672
    buffer_load_dwordx4 v[82:85], v13, s[24:27], s37 offen sc1
    s_add_u32 s37, s37, 28672
    s_waitcnt vmcnt(24)
    s_barrier
    buffer_load_dwordx4 v2, s[12:15], s39 offen sc1 lds
    buffer_load_dwordx4 v2, s[12:15], s39 offen offset:1024 sc1 lds
    s_call_b64 s[76:77], PREP_a_issue_3
    s_add_u32 m0, m0, 2048
    s_add_u32 s39, s39, 65536
    buffer_load_dwordx4 v2, s[12:15], s39 offen sc1 lds
    buffer_load_dwordx4 v2, s[12:15], s39 offen offset:1024 sc1 lds
    s_add_u32 m0, m0, 2048
    s_add_u32 s39, s39, 65536
    buffer_load_dwordx4 v2, s[12:15], s39 offen sc1 lds
    buffer_load_dwordx4 v2, s[12:15], s39 offen offset:1024 sc1 lds
    s_add_u32 m0, m0, 2048
    s_add_u32 s39, s39, 65536
    buffer_load_dwordx4 v2, s[12:15], s39 offen sc1 lds
    buffer_load_dwordx4 v2, s[12:15], s39 offen offset:1024 sc1 lds
    s_mov_b32 m0, s19
    s_mov_b32 s39, s16
    s_waitcnt vmcnt(24)
    v_pk_add_f32 v[18:19], v[18:19], v[34:35]
    v_pk_add_f32 v[20:21], v[20:21], v[36:37]
    v_pk_add_f32 v[22:23], v[22:23], v[38:39]
    v_pk_add_f32 v[24:25], v[24:25], v[40:41]
    v_pk_add_f32 v[26:27], v[26:27], v[42:43]
    v_pk_add_f32 v[28:29], v[28:29], v[44:45]
    v_pk_add_f32 v[30:31], v[30:31], v[46:47]
    v_pk_add_f32 v[32:33], v[32:33], v[48:49]
    v_pk_add_f32 v[18:19], v[18:19], v[26:27]
    v_pk_add_f32 v[20:21], v[20:21], v[28:29]
    v_pk_add_f32 v[22:23], v[22:23], v[30:31]
    v_pk_add_f32 v[24:25], v[24:25], v[32:33]
    s_waitcnt vmcnt(16)
    s_barrier
    buffer_load_dwordx4 v2, s[12:15], s39 offen sc1 lds
    buffer_load_dwordx4 v2, s[12:15], s39 offen offset:1024 sc1 lds
    s_call_b64 s[76:77], PREP_a_issue_3
    s_add_u32 m0, m0, 2048
    s_add_u32 s39, s39, 65536
    buffer_load_dwordx4 v2, s[12:15], s39 offen sc1 lds
    buffer_load_dwordx4 v2, s[12:15], s39 offen offset:1024 sc1 lds
    s_add_u32 m0, m0, 2048
    s_add_u32 s39, s39, 65536
    buffer_load_dwordx4 v2, s[12:15], s39 offen sc1 lds
    buffer_load_dwordx4 v2, s[12:15], s39 offen offset:1024 sc1 lds
    s_add_u32 m0, m0, 2048
    s_add_u32 s39, s39, 65536
    buffer_load_dwordx4 v2, s[12:15], s39 offen sc1 lds
    buffer_load_dwordx4 v2, s[12:15], s39 offen offset:1024 sc1 lds
    s_mov_b32 m0, s19
    s_mov_b32 s39, s16
    v_pk_add_f32 v[18:19], v[18:19], v[22:23]
    v_pk_add_f32 v[20:21], v[20:21], v[24:25]
    v_pk_add_f32 v[18:19], v[18:19], v[20:21]
    v_mul_f32 v52, 0x3a800000, v18
    v_mul_f32 v50, 0x3a800000, v19
    v_fma_f32 v50, -v52, v52, v50
    v_max_f32 v50, 0, v50
    v_cvt_pk_bf16_f32 v52, v52, v52
    v_lshlrev_b32 v52, 16, v52
    v_cvt_pk_bf16_f32 v50, v50, v50
    v_lshlrev_b32 v50, 16, v50
    s_waitcnt vmcnt(8)
    s_barrier
    buffer_load_dwordx4 v2, s[12:15], s39 offen sc1 lds
    buffer_load_dwordx4 v2, s[12:15], s39 offen offset:1024 sc1 lds
    s_add_u32 m0, m0, 2048
    s_add_u32 s39, s39, 65536
    buffer_load_dwordx4 v2, s[12:15], s39 offen sc1 lds
    buffer_load_dwordx4 v2, s[12:15], s39 offen offset:1024 sc1 lds
    s_add_u32 m0, m0, 2048
    s_add_u32 s39, s39, 65536
    buffer_load_dwordx4 v2, s[12:15], s39 offen sc1 lds
    buffer_load_dwordx4 v2, s[12:15], s39 offen offset:1024 sc1 lds
    s_add_u32 m0, m0, 2048
    s_add_u32 s39, s39, 65536
    buffer_load_dwordx4 v2, s[12:15], s39 offen sc1 lds
    buffer_load_dwordx4 v2, s[12:15], s39 offen offset:1024 sc1 lds
    s_waitcnt vmcnt(24)
    v_add_f32 v50, 0x3727c5ac, v50
    v_cvt_pk_bf16_f32 v50, v50, v50
    v_lshlrev_b32 v50, 16, v50
    v_sqrt_f32 v50, v50
    s_nop 0
    v_cvt_pk_bf16_f32 v50, v50, v50
    v_lshlrev_b32 v50, 16, v50
    v_rcp_f32 v53, v50
    s_add_u32 s36, s34, 160768
    v_add_u32 v51, s36, v10
    ds_write_b64 v51, v[52:53]
    s_waitcnt lgkmcnt(0)
    s_cmp_lg_u32 s60, 0
    s_cbranch_scc1 pc_61
    v_pk_add_f32 v[54:55], v[54:55], v[58:59]
    v_pk_add_f32 v[56:57], v[56:57], v[60:61]
    v_pk_add_f32 v[54:55], v[54:55], v[62:63]
    v_pk_add_f32 v[56:57], v[56:57], v[64:65]
    v_pk_add_f32 v[54:55], v[54:55], v[66:67]
    v_pk_add_f32 v[56:57], v[56:57], v[68:69]
    v_pk_add_f32 v[54:55], v[54:55], v[70:71]
    v_pk_add_f32 v[56:57], v[56:57], v[72:73]
pc_61:
    s_waitcnt vmcnt(8)
    s_barrier
    s_cmp_lg_u32 s60, 0
    s_cbranch_scc1 pc_62
    v_pk_add_f32 v[54:55], v[54:55], v[74:75]
    v_pk_add_f32 v[56:57], v[56:57], v[76:77]
    v_pk_add_f32 v[54:55], v[54:55], v[78:79]
    v_pk_add_f32 v[56:57], v[56:57], v[80:81]
    v_pk_add_f32 v[54:55], v[54:55], v[82:83]
    v_pk_add_f32 v[56:57], v[56:57], v[84:85]
    v_mov_b32 v58, v54
    v_mov_b32 v59, v55
    v_mov_b32 v60, v56
    v_mov_b32 v61, v57
    v_permlane32_swap_b32 v54, v58
    v_permlane32_swap_b32 v55, v59
    v_permlane32_swap_b32 v56, v60
    v_permlane32_swap_b32 v57, v61
    v_pk_add_f32 v[54:55], v[54:55], v[58:59]
    v_pk_add_f32 v[56:57], v[56:57], v[60:61]
    s_and_b32 s36, s30, 1
    s_mul_i32 s36, s36, 448
    s_add_u32 s36, s36, 159744
    v_add_u32 v6, s36, v2
    s_bfm_b64 exec, 28, 0
    ds_write_b128 v6, v[54:57]
    s_mov_b64 exec, -1
    s_waitcnt lgkmcnt(0)
pc_62:
    s_waitcnt vmcnt(0)
    s_barrier
    s_cmp_lg_u32 s60, 0
    s_cbranch_scc1 tw4_63
    s_mov_b64 s[48:49], s[74:75]
    s_lshl_b32 s45, s2, 1
    s_and_b32 s50, s30, 1
    s_add_u32 s45, s45, s50
    s_mul_i32 s45, s45, 14336
    s_mov_b32 s50, 7340032
    s_mov_b32 s51, 0x20000
    buffer_load_dwordx4 v[60:63], v2, s[48:51], s45 offen offset:0
    buffer_load_dwordx4 v[60:63], v2, s[48:51], s45 offen offset:1024
    buffer_load_dwordx4 v[60:63], v2, s[48:51], s45 offen offset:2048
    buffer_load_dwordx4 v[60:63], v2, s[48:51], s45 offen offset:3072
    s_add_u32 s45, s45, 4096
    buffer_load_dwordx4 v[60:63], v2, s[48:51], s45 offen offset:0
    buffer_load_dwordx4 v[60:63], v2, s[48:51], s45 offen offset:1024
    buffer_load_dwordx4 v[60:63], v2, s[48:51], s45 offen offset:2048
    buffer_load_dwordx4 v[60:63], v2, s[48:51], s45 offen offset:3072
    s_add_u32 s45, s45, 4096
    buffer_load_dwordx4 v[60:63], v2, s[48:51], s45 offen offset:0
    buffer_load_dwordx4 v[60:63], v2, s[48:51], s45 offen offset:1024
    buffer_load_dwordx4 v[60:63], v2, s[48:51], s45 offen offset:2048
    buffer_load_dwordx4 v[60:63], v2, s[48:51], s45 offen offset:3072
    s_add_u32 s45, s45, 4096
    buffer_load_dwordx4 v[60:63], v2, s[48:51], s45 offen offset:0
    buffer_load_dwordx4 v[60:63], v2, s[48:51], s45 offen offset:1024
tw4_63:
    s_barrier
    s_and_b32 s35, s30, 1
    s_mov_b32 s12, s62
    s_mov_b32 s13, s63
    s_mov_b32 s14, 0x1be000
    s_mov_b32 s15, 0x20000
    s_mul_i32 s38, s35, 917504
    s_mul_i32 s36, s31, 114688
    s_add_u32 s38, s38, s36
    s_lshl_b32 s41, s35, 13
    s_mov_b32 s42, 0
    s_mov_b32 s44, 0
    s_add_u32 s54, s55, 0x700
    s_lshl_b32 s53, s31, 7
    s_add_u32 s54, s54, s53
    v_mov_b32 v9, s54
    s_add_u32 s54, s55, 0x600
    s_lshl_b32 s53, s31, 7
    s_add_u32 s54, s54, s53
    v_mov_b32 v10, s54
    s_add_u32 s54, s55, 0x300
    s_lshl_b32 s53, s31, 7
    s_add_u32 s54, s54, s53
    v_mov_b32 v12, s54
    s_lshl_b32 s54, s60, 1
    s_add_u32 s54, s54, 1
    v_mov_b32 v14, 162872
spin_64:
    s_sleep 8
    ds_read_b32 v15, v14
    s_waitcnt lgkmcnt(0)
    v_readfirstlane_b32 s53, v15
    s_nop 0
    s_cmp_ge_u32 s53, s54
    s_cbranch_scc0 spin_64
    s_mov_b32 s53, 0
    s_add_u32 s54, s52, 8
    s_bfm_b64 exec, 1, 0
poll_65:
    buffer_load_dword v8, v9, s[56:59], 0 offen sc1
    s_waitcnt vmcnt(0)
    v_cmp_eq_u32 vcc, s54, v8
    s_nop 0
    s_cmp_eq_u64 vcc, exec
    s_cbranch_scc1 pok_66
    s_sleep 5
    s_add_u32 s53, s53, 1
    s_cmp_lt_u32 s53, s61
    s_cbranch_scc1 poll_65
    s_mov_b32 s61, 0
pok_66:
    s_mov_b64 exec, -1
    s_mov_b32 s44, 3
    s_call_b64 s[76:77], PREP_a_issue_4
    s_mov_b32 m0, s19
    s_mov_b32 s39, s16
    s_mov_b32 s40, s17
    s_waitcnt vmcnt(16)
    s_barrier
    s_waitcnt vmcnt(8)
    s_barrier
    buffer_load_dwordx4 v2, s[12:15], s39 offen sc1 lds
    s_add_u32 m0, m0, 1024
    s_nop 0
    buffer_load_dwordx4 v2, s[12:15], s40 offen sc1 lds
    s_mov_b32 s43, 1
ld_67:
    s_add_u32 s19, s41, s42
    s_lshl_b32 s45, s44, 1
    s_add_u32 s45, s45, 0
    s_sub_u32 s45, s45, 32
    s_mul_i32 s46, s45, 86
    s_lshr_b32 s46, s46, 8
    s_mul_i32 s47, s46, 3
    s_sub_u32 s47, s45, s47
    s_lshl_b32 s47, s47, 2
    s_lshr_b32 s47, 0x362, s47
    s_and_b32 s47, s47, 7
    s_cmp_ge_u32 s44, 10
    s_cselect_b32 s45, 9, 2
    s_cselect_b32 s51, 1, 0
    s_sub_u32 s45, s44, s45
    s_cmp_lt_u32 s44, 3
    s_cselect_b32 s45, 0, s45
    s_cselect_b32 s51, s44, s51
    s_lshl2_add_u32 s51, 0, s51
    s_cmp_lt_u32 s44, 17
    s_cselect_b32 s47, s51, s47
    s_cselect_b32 s46, s45, s46
    s_add_u32 s46, s46, s33
    s_and_b32 s46, s46, 7
    s_mul_i32 s46, s46, 7
    s_add_u32 s16, s46, s47
    s_lshr_b32 s53, s16, 3
    s_lshl_b32 s53, s53, 14
    s_and_b32 s16, s16, 7
    s_lshl_b32 s16, s16, 10
    s_add_u32 s16, s16, s53
    s_add_u32 s16, s16, s38
    s_lshl_b32 s45, s44, 1
    s_add_u32 s45, s45, 1
    s_sub_u32 s45, s45, 32
    s_mul_i32 s46, s45, 86
    s_lshr_b32 s46, s46, 8
    s_mul_i32 s47, s46, 3
    s_sub_u32 s47, s45, s47
    s_lshl_b32 s47, s47, 2
    s_lshr_b32 s47, 0x362, s47
    s_and_b32 s47, s47, 7
    s_cmp_ge_u32 s44, 10
    s_cselect_b32 s45, 9, 2
    s_cselect_b32 s51, 1, 0
    s_sub_u32 s45, s44, s45
    s_cmp_lt_u32 s44, 3
    s_cselect_b32 s45, 0, s45
    s_cselect_b32 s51, s44, s51
    s_lshl2_add_u32 s51, 1, s51
    s_cmp_lt_u32 s44, 17
    s_cselect_b32 s47, s51, s47
    s_cselect_b32 s46, s45, s46
    s_add_u32 s46, s46, s33
    s_and_b32 s46, s46, 7
    s_mul_i32 s46, s46, 7
    s_add_u32 s17, s46, s47
    s_lshr_b32 s53, s17, 3
    s_lshl_b32 s53, s53, 14
    s_and_b32 s17, s17, 7
    s_lshl_b32 s17, s17, 10
    s_add_u32 s17, s17, s53
    s_add_u32 s17, s17, s38
    s_add_u32 s44, s44, 1
    s_add_u32 s42, s42, 16384
    s_cmp_eq_u32 s42, 49152
    s_cselect_b32 s42, 0, s42
    s_add_u32 m0, m0, 1024
    s_add_u32 s39, s39, 229376
    buffer_load_dwordx4 v2, s[12:15], s39 offen sc1 lds
    s_add_u32 m0, m0, 1024
    s_add_u32 s40, s40, 229376
    buffer_load_dwordx4 v2, s[12:15], s40 offen sc1 lds
    s_add_u32 m0, m0, 1024
    s_add_u32 s39, s39, 229376
    buffer_load_dwordx4 v2, s[12:15], s39 offen sc1 lds
    s_add_u32 m0, m0, 1024
    s_add_u32 s40, s40, 229376
    buffer_load_dwordx4 v2, s[12:15], s40 offen sc1 lds
    s_add_u32 m0, m0, 1024
    s_add_u32 s39, s39, 229376
    buffer_load_dwordx4 v2, s[12:15], s39 offen sc1 lds
    s_add_u32 m0, m0, 1024
    s_add_u32 s40, s40, 229376
    buffer_load_dwordx4 v2, s[12:15], s40 offen sc1 lds
    s_mov_b32 m0, s19
    s_mov_b32 s39, s16
    s_mov_b32 s40, s17
    s_waitcnt vmcnt(8)
    s_barrier
    buffer_load_dwordx4 v2, s[12:15], s39 offen sc1 lds
    s_add_u32 m0, m0, 1024
    s_nop 0
    buffer_load_dwordx4 v2, s[12:15], s40 offen sc1 lds
    s_add_u32 s43, s43, 1
    s_cmp_lt_u32 s43, 4
    s_cbranch_scc1 ld_67
    s_call_b64 s[76:77], PREP_a_issue_4
    s_add_u32 m0, m0, 1024
    s_add_u32 s39, s39, 229376
    buffer_load_dwordx4 v2, s[12:15], s39 offen sc1 lds
    s_add_u32 m0, m0, 1024
    s_add_u32 s40, s40, 229376
    buffer_load_dwordx4 v2, s[12:15], s40 offen sc1 lds
    s_add_u32 m0, m0, 1024
    s_add_u32 s39, s39, 229376
    buffer_load_dwordx4 v2, s[12:15], s39 offen sc1 lds
    s_add_u32 m0, m0, 1024
    s_add_u32 s40, s40, 229376
    buffer_load_dwordx4 v2, s[12:15], s40 offen sc1 lds
    s_add_u32 m0, m0, 1024
    s_add_u32 s39, s39, 229376
    buffer_load_dwordx4 v2, s[12:15], s39 offen sc1 lds
    s_add_u32 m0, m0, 1024
    s_add_u32 s40, s40, 229376
    buffer_load_dwordx4 v2, s[12:15], s40 offen sc1 lds
    s_mov_b32 m0, s19
    s_mov_b32 s39, s16
    s_mov_b32 s40, s17
    s_waitcnt vmcnt(8)
    s_barrier
    buffer_load_dwordx4 v2, s[12:15], s39 offen sc1 lds
    s_add_u32 m0, m0, 1024
    s_nop 0
    buffer_load_dwordx4 v2, s[12:15], s40 offen sc1 lds
    s_mov_b64 exec, 1
    buffer_load_dword v11, v10, s[56:59], 0 offen sc1
    s_mov_b64 exec, -1
    s_call_b64 s[76:77], PREP_a_issue_4
    s_add_u32 m0, m0, 1024
    s_add_u32 s39, s39, 229376
    buffer_load_dwordx4 v2, s[12:15], s39 offen sc1 lds
    s_add_u32 m0, m0, 1024
    s_add_u32 s40, s40, 229376
    buffer_load_dwordx4 v2, s[12:15], s40 offen sc1 lds
    s_add_u32 m0, m0, 1024
    s_add_u32 s39, s39, 229376
    buffer_load_dwordx4 v2, s[12:15], s39 offen sc1 lds
    s_add_u32 m0, m0, 1024
    s_add_u32 s40, s40, 229376
    buffer_load_dwordx4 v2, s[12:15], s40 offen sc1 lds
    s_add_u32 m0, m0, 1024
    s_add_u32 s39, s39, 229376
    buffer_load_dwordx4 v2, s[12:15], s39 offen sc1 lds
    s_add_u32 m0, m0, 1024
    s_add_u32 s40, s40, 229376
    buffer_load_dwordx4 v2, s[12:15], s40 offen sc1 lds
    s_mov_b32 m0, s19
    s_mov_b32 s39, s16
    s_mov_b32 s40, s17
    s_waitcnt vmcnt(9)
    s_barrier
    buffer_load_dwordx4 v2, s[12:15], s39 offen sc1 lds
    s_add_u32 m0, m0, 1024
    s_nop 0
    buffer_load_dwordx4 v2, s[12:15], s40 offen sc1 lds
    s_call_b64 s[76:77], PREP_a_issue_4
    s_add_u32 m0, m0, 1024
    s_add_u32 s39, s39, 229376
    buffer_load_dwordx4 v2, s[12:15], s39 offen sc1 lds
    s_add_u32 m0, m0, 1024
    s_add_u32 s40, s40, 229376
    buffer_load_dwordx4 v2, s[12:15], s40 offen sc1 lds
    s_add_u32 m0, m0, 1024
    s_add_u32 s39, s39, 229376
    buffer_load_dwordx4 v2, s[12:15], s39 offen sc1 lds
    s_add_u32 m0, m0, 1024
    s_add_u32 s40, s40, 229376
    buffer_load_dwordx4 v2, s[12:15], s40 offen sc1 lds
    s_add_u32 m0, m0, 1024
    s_add_u32 s39, s39, 229376
    buffer_load_dwordx4 v2, s[12:15], s39 offen sc1 lds
    s_add_u32 m0, m0, 1024
    s_add_u32 s40, s40, 229376
    buffer_load_dwordx4 v2, s[12:15], s40 offen sc1 lds
    s_mov_b32 m0, s19
    s_mov_b32 s39, s16
    s_mov_b32 s40, s17
    s_waitcnt vmcnt(8)
    s_barrier
    buffer_load_dwordx4 v2, s[12:15], s39 offen sc1 lds
    s_add_u32 m0, m0, 1024
    s_nop 0
    buffer_load_dwordx4 v2, s[12:15], s40 offen sc1 lds
    s_waitcnt vmcnt(16)
    v_readfirstlane_b32 s53, v11
    s_add_u32 s54, s52, 8
    s_cmp_eq_u32 s53, s54
    s_cbranch_scc1 fok_68
    s_mov_b32 s53, 0
    s_add_u32 s54, s52, 8
    s_bfm_b64 exec, 1, 0
poll_69:
    buffer_load_dword v11, v10, s[56:59], 0 offen sc1
    s_waitcnt vmcnt(0)
    v_cmp_eq_u32 vcc, s54, v11
    s_nop 0
    s_cmp_eq_u64 vcc, exec
    s_cbranch_scc1 pok_70
    s_sleep 5
    s_add_u32 s53, s53, 1
    s_cmp_lt_u32 s53, s61
    s_cbranch_scc1 poll_69
    s_mov_b32 s61, 0
pok_70:
    s_mov_b64 exec, -1
fok_68:
    s_call_b64 s[76:77], PREP_a_issue_4
    s_add_u32 m0, m0, 1024
    s_add_u32 s39, s39, 229376
    buffer_load_dwordx4 v2, s[12:15], s39 offen sc1 lds
    s_add_u32 m0, m0, 1024
    s_add_u32 s40, s40, 229376
    buffer_load_dwordx4 v2, s[12:15], s40 offen sc1 lds
    s_add_u32 m0, m0, 1024
    s_add_u32 s39, s39, 229376
    buffer_load_dwordx4 v2, s[12:15], s39 offen sc1 lds
    s_add_u32 m0, m0, 1024
    s_add_u32 s40, s40, 229376
    buffer_load_dwordx4 v2, s[12:15], s40 offen sc1 lds
    s_add_u32 m0, m0, 1024
    s_add_u32 s39, s39, 229376
    buffer_load_dwordx4 v2, s[12:15], s39 offen sc1 lds
    s_add_u32 m0, m0, 1024
    s_add_u32 s40, s40, 229376
    buffer_load_dwordx4 v2, s[12:15], s40 offen sc1 lds
    s_mov_b32 m0, s19
    s_mov_b32 s39, s16
    s_mov_b32 s40, s17
    s_waitcnt vmcnt(8)
    s_barrier
    buffer_load_dwordx4 v2, s[12:15], s39 offen sc1 lds
    s_add_u32 m0, m0, 1024
    s_nop 0
    buffer_load_dwordx4 v2, s[12:15], s40 offen sc1 lds
    s_mov_b32 s43, 1
ld_71:
    s_add_u32 s19, s41, s42
    s_lshl_b32 s45, s44, 1
    s_add_u32 s45, s45, 0
    s_sub_u32 s45, s45, 32
    s_mul_i32 s46, s45, 86
    s_lshr_b32 s46, s46, 8
    s_mul_i32 s47, s46, 3
    s_sub_u32 s47, s45, s47
    s_lshl_b32 s47, s47, 2
    s_lshr_b32 s47, 0x362, s47
    s_and_b32 s47, s47, 7
    s_cmp_ge_u32 s44, 10
    s_cselect_b32 s45, 9, 2
    s_cselect_b32 s51, 1, 0
    s_sub_u32 s45, s44, s45
    s_cmp_lt_u32 s44, 3
    s_cselect_b32 s45, 0, s45
    s_cselect_b32 s51, s44, s51
    s_lshl2_add_u32 s51, 0, s51
    s_cmp_lt_u32 s44, 17
    s_cselect_b32 s47, s51, s47
    s_cselect_b32 s46, s45, s46
    s_add_u32 s46, s46, s33
    s_and_b32 s46, s46, 7
    s_mul_i32 s46, s46, 7
    s_add_u32 s16, s46, s47
    s_lshr_b32 s53, s16, 3
    s_lshl_b32 s53, s53, 14
    s_and_b32 s16, s16, 7
    s_lshl_b32 s16, s16, 10
    s_add_u32 s16, s16, s53
    s_add_u32 s16, s16, s38
    s_lshl_b32 s45, s44, 1
    s_add_u32 s45, s45, 1
    s_sub_u32 s45, s45, 32
    s_mul_i32 s46, s45, 86
    s_lshr_b32 s46, s46, 8
    s_mul_i32 s47, s46, 3
    s_sub_u32 s47, s45, s47
    s_lshl_b32 s47, s47, 2
    s_lshr_b32 s47, 0x362, s47
    s_and_b32 s47, s47, 7
    s_cmp_ge_u32 s44, 10
    s_cselect_b32 s45, 9, 2
    s_cselect_b32 s51, 1, 0
    s_sub_u32 s45, s44, s45
    s_cmp_lt_u32 s44, 3
    s_cselect_b32 s45, 0, s45
    s_cselect_b32 s51, s44, s51
    s_lshl2_add_u32 s51, 1, s51
    s_cmp_lt_u32 s44, 17
    s_cselect_b32 s47, s51, s47
    s_cselect_b32 s46, s45, s46
    s_add_u32 s46, s46, s33
    s_and_b32 s46, s46, 7
    s_mul_i32 s46, s46, 7
    s_add_u32 s17, s46, s47
    s_lshr_b32 s53, s17, 3
    s_lshl_b32 s53, s53, 14
    s_and_b32 s17, s17, 7
    s_lshl_b32 s17, s17, 10
    s_add_u32 s17, s17, s53
    s_add_u32 s17, s17, s38
    s_add_u32 s44, s44, 1
    s_add_u32 s42, s42, 16384
    s_cmp_eq_u32 s42, 49152
    s_cselect_b32 s42, 0, s42
    s_add_u32 m0, m0, 1024
    s_add_u32 s39, s39, 229376
    buffer_load_dwordx4 v2, s[12:15], s39 offen sc1 lds
    s_add_u32 m0, m0, 1024
    s_add_u32 s40, s40, 229376
    buffer_load_dwordx4 v2, s[12:15], s40 offen sc1 lds
    s_add_u32 m0, m0, 1024
    s_add_u32 s39, s39, 229376
    buffer_load_dwordx4 v2, s[12:15], s39 offen sc1 lds
    s_add_u32 m0, m0, 1024
    s_add_u32 s40, s40, 229376
    buffer_load_dwordx4 v2, s[12:15], s40 offen sc1 lds
    s_add_u32 m0, m0, 1024
    s_add_u32 s39, s39, 229376
    buffer_load_dwordx4 v2, s[12:15], s39 offen sc1 lds
    s_add_u32 m0, m0, 1024
    s_add_u32 s40, s40, 229376
    buffer_load_dwordx4 v2, s[12:15], s40 offen sc1 lds
    s_mov_b32 m0, s19
    s_mov_b32 s39, s16
    s_mov_b32 s40, s17
    s_waitcnt vmcnt(8)
    s_barrier
    buffer_load_dwordx4 v2, s[12:15], s39 offen sc1 lds
    s_add_u32 m0, m0, 1024
    s_nop 0
    buffer_load_dwordx4 v2, s[12:15], s40 offen sc1 lds
    s_add_u32 s43, s43, 1
    s_cmp_lt_u32 s43, 4
    s_cbranch_scc1 ld_71
    s_call_b64 s[76:77], PREP_a_issue_4
    s_add_u32 m0, m0, 1024
    s_add_u32 s39, s39, 229376
    buffer_load_dwordx4 v2, s[12:15], s39 offen sc1 lds
    s_add_u32 m0, m0, 1024
    s_add_u32 s40, s40, 229376
    buffer_load_dwordx4 v2, s[12:15], s40 offen sc1 lds
    s_add_u32 m0, m0, 1024
    s_add_u32 s39, s39, 229376
    buffer_load_dwordx4 v2, s[12:15], s39 offen sc1 lds
    s_add_u32 m0, m0, 1024
    s_add_u32 s40, s40, 229376
    buffer_load_dwordx4 v2, s[12:15], s40 offen sc1 lds
    s_add_u32 m0, m0, 1024
    s_add_u32 s39, s39, 229376
    buffer_load_dwordx4 v2, s[12:15], s39 offen sc1 lds
    s_add_u32 m0, m0, 1024
    s_add_u32 s40, s40, 229376
    buffer_load_dwordx4 v2, s[12:15], s40 offen sc1 lds
    s_mov_b32 m0, s19
    s_mov_b32 s39, s16
    s_mov_b32 s40, s17
    s_waitcnt vmcnt(8)
    s_barrier
    buffer_load_dwordx4 v2, s[12:15], s39 offen sc1 lds
    s_add_u32 m0, m0, 1024
    s_nop 0
    buffer_load_dwordx4 v2, s[12:15], s40 offen sc1 lds
    s_mov_b64 exec, 1
    buffer_load_dword v11, v12, s[56:59], 0 offen sc1
    s_mov_b64 exec, -1
    s_call_b64 s[76:77], PREP_a_issue_4
    s_add_u32 m0, m0, 1024
    s_add_u32 s39, s39, 229376
    buffer_load_dwordx4 v2, s[12:15], s39 offen sc1 lds
    s_add_u32 m0, m0, 1024
    s_add_u32 s40, s40, 229376
    buffer_load_dwordx4 v2, s[12:15], s40 offen sc1 lds
    s_add_u32 m0, m0, 1024
    s_add_u32 s39, s39, 229376
    buffer_load_dwordx4 v2, s[12:15], s39 offen sc1 lds
    s_add_u32 m0, m0, 1024
    s_add_u32 s40, s40, 229376
    buffer_load_dwordx4 v2, s[12:15], s40 offen sc1 lds
    s_add_u32 m0, m0, 1024
    s_add_u32 s39, s39, 229376
    buffer_load_dwordx4 v2, s[12:15], s39 offen sc1 lds
    s_add_u32 m0, m0, 1024
    s_add_u32 s40, s40, 229376
    buffer_load_dwordx4 v2, s[12:15], s40 offen sc1 lds
    s_mov_b32 m0, s19
    s_mov_b32 s39, s16
    s_mov_b32 s40, s17
    s_waitcnt vmcnt(9)
    s_barrier
    buffer_load_dwordx4 v2, s[12:15], s39 offen sc1 lds
    s_add_u32 m0, m0, 1024
    s_nop 0
    buffer_load_dwordx4 v2, s[12:15], s40 offen sc1 lds
    s_call_b64 s[76:77], PREP_a_issue_4
    s_add_u32 m0, m0, 1024
    s_add_u32 s39, s39, 229376
    buffer_load_dwordx4 v2, s[12:15], s39 offen sc1 lds
    s_add_u32 m0, m0, 1024
    s_add_u32 s40, s40, 229376
    buffer_load_dwordx4 v2, s[12:15], s40 offen sc1 lds
    s_add_u32 m0, m0, 1024
    s_add_u32 s39, s39, 229376
    buffer_load_dwordx4 v2, s[12:15], s39 offen sc1 lds
    s_add_u32 m0, m0, 1024
    s_add_u32 s40, s40, 229376
    buffer_load_dwordx4 v2, s[12:15], s40 offen sc1 lds
    s_add_u32 m0, m0, 1024
    s_add_u32 s39, s39, 229376
    buffer_load_dwordx4 v2, s[12:15], s39 offen sc1 lds
    s_add_u32 m0, m0, 1024
    s_add_u32 s40, s40, 229376
    buffer_load_dwordx4 v2, s[12:15], s40 offen sc1 lds
    s_mov_b32 m0, s19
    s_mov_b32 s39, s16
    s_mov_b32 s40, s17
    s_waitcnt vmcnt(8)
    s_barrier
    buffer_load_dwordx4 v2, s[12:15], s39 offen sc1 lds
    s_add_u32 m0, m0, 1024
    s_nop 0
    buffer_load_dwordx4 v2, s[12:15], s40 offen sc1 lds
    s_waitcnt vmcnt(16)
    v_readfirstlane_b32 s53, v11
    s_add_u32 s54, s52, 8
    s_cmp_eq_u32 s53, s54
    s_cbranch_scc1 fok_72
    s_mov_b32 s53, 0
    s_add_u32 s54, s52, 8
    s_bfm_b64 exec, 1, 0
poll_73:
    buffer_load_dword v11, v12, s[56:59], 0 offen sc1
    s_waitcnt vmcnt(0)
    v_cmp_eq_u32 vcc, s54, v11
    s_nop 0
    s_cmp_eq_u64 vcc, exec
    s_cbranch_scc1 pok_74
    s_sleep 5
    s_add_u32 s53, s53, 1
    s_cmp_lt_u32 s53, s61
    s_cbranch_scc1 poll_73
    s_mov_b32 s61, 0
pok_74:
    s_mov_b64 exec, -1
fok_72:
    s_call_b64 s[76:77], PREP_a_issue_4
    s_add_u32 m0, m0, 1024
    s_add_u32 s39, s39, 229376
    buffer_load_dwordx4 v2, s[12:15], s39 offen sc1 lds
    s_add_u32 m0, m0, 1024
    s_add_u32 s40, s40, 229376
    buffer_load_dwordx4 v2, s[12:15], s40 offen sc1 lds
    s_add_u32 m0, m0, 1024
    s_add_u32 s39, s39, 229376
    buffer_load_dwordx4 v2, s[12:15], s39 offen sc1 lds
    s_add_u32 m0, m0, 1024
    s_add_u32 s40, s40, 229376
    buffer_load_dwordx4 v2, s[12:15], s40 offen sc1 lds
    s_add_u32 m0, m0, 1024
    s_add_u32 s39, s39, 229376
    buffer_load_dwordx4 v2, s[12:15], s39 offen sc1 lds
    s_add_u32 m0, m0, 1024
    s_add_u32 s40, s40, 229376
    buffer_load_dwordx4 v2, s[12:15], s40 offen sc1 lds
    s_mov_b32 m0, s19
    s_mov_b32 s39, s16
    s_mov_b32 s40, s17
    s_waitcnt vmcnt(8)
    s_barrier
    buffer_load_dwordx4 v2, s[12:15], s39 offen sc1 lds
    s_add_u32 m0, m0, 1024
    s_nop 0
    buffer_load_dwordx4 v2, s[12:15], s40 offen sc1 lds
    s_mov_b32 s43, 1
ld_75:
    s_add_u32 s19, s41, s42
    s_lshl_b32 s45, s44, 1
    s_add_u32 s45, s45, 0
    s_sub_u32 s45, s45, 32
    s_mul_i32 s46, s45, 86
    s_lshr_b32 s46, s46, 8
    s_mul_i32 s47, s46, 3
    s_sub_u32 s47, s45, s47
    s_lshl_b32 s47, s47, 2
    s_lshr_b32 s47, 0x362, s47
    s_and_b32 s47, s47, 7
    s_cmp_ge_u32 s44, 10
    s_cselect_b32 s45, 9, 2
    s_cselect_b32 s51, 1, 0
    s_sub_u32 s45, s44, s45
    s_cmp_lt_u32 s44, 3
    s_cselect_b32 s45, 0, s45
    s_cselect_b32 s51, s44, s51
    s_lshl2_add_u32 s51, 0, s51
    s_cmp_lt_u32 s44, 17
    s_cselect_b32 s47, s51, s47
    s_cselect_b32 s46, s45, s46
    s_add_u32 s46, s46, s33
    s_and_b32 s46, s46, 7
    s_mul_i32 s46, s46, 7
    s_add_u32 s16, s46, s47
    s_lshr_b32 s53, s16, 3
    s_lshl_b32 s53, s53, 14
    s_and_b32 s16, s16, 7
    s_lshl_b32 s16, s16, 10
    s_add_u32 s16, s16, s53
    s_add_u32 s16, s16, s38
    s_lshl_b32 s45, s44, 1
    s_add_u32 s45, s45, 1
    s_sub_u32 s45, s45, 32
    s_mul_i32 s46, s45, 86
    s_lshr_b32 s46, s46, 8
    s_mul_i32 s47, s46, 3
    s_sub_u32 s47, s45, s47
    s_lshl_b32 s47, s47, 2
    s_lshr_b32 s47, 0x362, s47
    s_and_b32 s47, s47, 7
    s_cmp_ge_u32 s44, 10
    s_cselect_b32 s45, 9, 2
    s_cselect_b32 s51, 1, 0
    s_sub_u32 s45, s44, s45
    s_cmp_lt_u32 s44, 3
    s_cselect_b32 s45, 0, s45
    s_cselect_b32 s51, s44, s51
    s_lshl2_add_u32 s51, 1, s51
    s_cmp_lt_u32 s44, 17
    s_cselect_b32 s47, s51, s47
    s_cselect_b32 s46, s45, s46
    s_add_u32 s46, s46, s33
    s_and_b32 s46, s46, 7
    s_mul_i32 s46, s46, 7
    s_add_u32 s17, s46, s47
    s_lshr_b32 s53, s17, 3
    s_lshl_b32 s53, s53, 14
    s_and_b32 s17, s17, 7
    s_lshl_b32 s17, s17, 10
    s_add_u32 s17, s17, s53
    s_add_u32 s17, s17, s38
    s_add_u32 s44, s44, 1
    s_add_u32 s42, s42, 16384
    s_cmp_eq_u32 s42, 49152
    s_cselect_b32 s42, 0, s42
    s_add_u32 m0, m0, 1024
    s_add_u32 s39, s39, 229376
    buffer_load_dwordx4 v2, s[12:15], s39 offen sc1 lds
    s_add_u32 m0, m0, 1024
    s_add_u32 s40, s40, 229376
    buffer_load_dwordx4 v2, s[12:15], s40 offen sc1 lds
    s_add_u32 m0, m0, 1024
    s_add_u32 s39, s39, 229376
    buffer_load_dwordx4 v2, s[12:15], s39 offen sc1 lds
    s_add_u32 m0, m0, 1024
    s_add_u32 s40, s40, 229376
    buffer_load_dwordx4 v2, s[12:15], s40 offen sc1 lds
    s_add_u32 m0, m0, 1024
    s_add_u32 s39, s39, 229376
    buffer_load_dwordx4 v2, s[12:15], s39 offen sc1 lds
    s_add_u32 m0, m0, 1024
    s_add_u32 s40, s40, 229376
    buffer_load_dwordx4 v2, s[12:15], s40 offen sc1 lds
    s_mov_b32 m0, s19
    s_mov_b32 s39, s16
    s_mov_b32 s40, s17
    s_waitcnt vmcnt(8)
    s_barrier
    buffer_load_dwordx4 v2, s[12:15], s39 offen sc1 lds
    s_add_u32 m0, m0, 1024
    s_nop 0
    buffer_load_dwordx4 v2, s[12:15], s40 offen sc1 lds
    s_add_u32 s43, s43, 1
    s_cmp_lt_u32 s43, 10
    s_cbranch_scc1 ld_75
    s_call_b64 s[76:77], PREP_a_issue_4
    s_add_u32 m0, m0, 1024
    s_add_u32 s39, s39, 229376
    buffer_load_dwordx4 v2, s[12:15], s39 offen sc1 lds
    s_add_u32 m0, m0, 1024
    s_add_u32 s40, s40, 229376
    buffer_load_dwordx4 v2, s[12:15], s40 offen sc1 lds
    s_add_u32 m0, m0, 1024
    s_add_u32 s39, s39, 229376
    buffer_load_dwordx4 v2, s[12:15], s39 offen sc1 lds
    s_add_u32 m0, m0, 1024
    s_add_u32 s40, s40, 229376
    buffer_load_dwordx4 v2, s[12:15], s40 offen sc1 lds
    s_add_u32 m0, m0, 1024
    s_add_u32 s39, s39, 229376
    buffer_load_dwordx4 v2, s[12:15], s39 offen sc1 lds
    s_add_u32 m0, m0, 1024
    s_add_u32 s40, s40, 229376
    buffer_load_dwordx4 v2, s[12:15], s40 offen sc1 lds
    s_mov_b32 m0, s19
    s_mov_b32 s39, s16
    s_mov_b32 s40, s17
    s_waitcnt vmcnt(8)
    s_barrier
    buffer_load_dwordx4 v2, s[12:15], s39 offen sc1 lds
    s_add_u32 m0, m0, 1024
    s_nop 0
    buffer_load_dwordx4 v2, s[12:15], s40 offen sc1 lds
    s_add_u32 m0, m0, 1024
    s_add_u32 s39, s39, 229376
    buffer_load_dwordx4 v2, s[12:15], s39 offen sc1 lds
    s_add_u32 m0, m0, 1024
    s_add_u32 s40, s40, 229376
    buffer_load_dwordx4 v2, s[12:15], s40 offen sc1 lds
    s_add_u32 m0, m0, 1024
    s_add_u32 s39, s39, 229376
    buffer_load_dwordx4 v2, s[12:15], s39 offen sc1 lds
    s_add_u32 m0, m0, 1024
    s_add_u32 s40, s40, 229376
    buffer_load_dwordx4 v2, s[12:15], s40 offen sc1 lds
    s_add_u32 m0, m0, 1024
    s_add_u32 s39, s39, 229376
    buffer_load_dwordx4 v2, s[12:15], s39 offen sc1 lds
    s_add_u32 m0, m0, 1024
    s_add_u32 s40, s40, 229376
    buffer_load_dwordx4 v2, s[12:15], s40 offen sc1 lds
    s_waitcnt vmcnt(8)
    s_barrier
    s_waitcnt vmcnt(0)
    s_barrier
    s_cmp_eq_u32 s60, 1
    s_cbranch_scc1 K_fin
    v_and_b32 v81, 7, v0
    v_lshrrev_b32 v84, 6, v0
    v_lshlrev_b32 v84, 4, v84
    v_bfe_u32 v85, v0, 3, 3
    v_add_u32 v84, v84, v85
    s_lshr_b32 s78, s29, 1
    s_lshl_b32 s78, s78, 16
    s_and_b32 s79, s29, 1
    s_lshl_b32 s79, s79, 7
    s_add_u32 s78, s78, s79
    s_lshr_b32 s79, s30, 1
    s_lshl_b32 s79, s79, 13
    s_add_u32 s78, s78, s79
    v_lshlrev_b32 v78, 8, v84
    v_lshl_add_u32 v78, v81, 4, v78
    v_add_u32 v78, s78, v78
    s_lshl_b32 s78, s28, 7
    s_lshl_b32 s79, s29, 3
    s_add_u32 s78, s78, s79
    v_add_u32 v79, s78, v81
    v_lshlrev_b32 v80, 11, v79
    v_and_b32 v85, 3, v79
    v_lshrrev_b32 v82, 2, v79
    v_lshlrev_b32 v82, 14, v82
    v_lshl_add_u32 v82, v85, 11, v82
    v_lshl_add_u32 v82, v84, 4, v82
    v_lshrrev_b32 v85, 2, v84
    v_lshlrev_b32 v85, 3, v85
    v_and_b32 v84, 3, v84
    v_add_u32 v84, v84, v85
    v_lshl_add_u32 v80, v84, 3, v80
    v_lshlrev_b32 v79, 3, v79
    v_lshl_add_u32 v79, v84, 14, v79
    s_lshl_b32 s86, s60, 24
    s_lshl_b32 s87, s94, 13
    s_add_u32 s86, s86, s87
    s_add_u32 s86, s86, 167772160
    s_add_u32 s84, s4, s86
    s_addc_u32 s85, s5, 0
    s_mov_b32 s86, 8380416
    s_mov_b32 s87, 0x20000
    s_add_u32 s88, s62, 0x480000
    s_addc_u32 s89, s63, 0
    s_mov_b32 s90, 0x7e000
    s_mov_b32 s91, 0x20000
    buffer_load_dwordx4 v[86:89], v82, s[84:87], 0 offen offset:0 sc1
    buffer_load_dwordx4 v[94:97], v78, s[88:91], 0 offen offset:0 sc1
    buffer_load_dwordx4 v[90:93], v82, s[84:87], 0 offen offset:128 sc1
    buffer_load_dwordx4 v[98:101], v78, s[88:91], 0 offen offset:2048 sc1
    s_add_u32 s80, s4, 0x1c00000
    s_addc_u32 s81, s5, 0
    s_mov_b32 s82, 0x400000
    s_mov_b32 s83, 0x20000
    s_mov_b32 s78, 0
    buffer_load_dwordx2 v[110:111], v79, s[80:83], s78 offen sc1
    s_mov_b32 s78, 65536
    buffer_load_dwordx2 v[112:113], v79, s[80:83], s78 offen sc1
    s_mov_b32 s78, 262144
    buffer_load_dwordx2 v[114:115], v79, s[80:83], s78 offen sc1
    s_mov_b32 s78, 327680
    buffer_load_dwordx2 v[116:117], v79, s[80:83], s78 offen sc1
    s_barrier
    s_branch NEXT
WLOAD:
    s_mov_b64 s[12:13], s[72:73]
    s_mov_b32 s14, 7340032
    s_mov_b32 s15, 0x20000
    s_and_b32 s35, s30, 1
    s_mul_i32 s38, s29, 448
    s_mul_i32 s41, s35, 229376
    s_add_u32 s38, s38, s41
    s_mul_i32 s41, s35, 14336
    s_add_u32 s41, s41, 49152
    s_mov_b32 s42, 0
    s_mov_b32 s44, s29
    s_add_u32 s44, s44, 1
    s_and_b32 s44, s44, 15
    s_add_u32 s44, s44, 1
    s_and_b32 s44, s44, 15
    s_add_u32 s46, s29, 1
    s_and_b32 s46, s46, 15
    s_cmp_eq_u32 s28, s29
    s_cselect_b32 s47, s46, s28
    s_mov_b32 s42, 57344
    s_call_b64 s[76:77], PREP_w_issue_3
    s_mov_b32 m0, s19
    s_mov_b32 s39, s16
    s_waitcnt vmcnt(0)
    s_and_b32 s36, s30, 3
    s_lshl_b32 s36, s36, 7
    s_add_u32 s36, s36, s55
    s_add_u32 s36, s36, 256
    v_mov_b32 v14, 1
    v_mov_b32 v15, 162816
    v_mov_b32 v17, 0
    s_mov_b64 exec, 1
    buffer_atomic_add v14, v17, s[56:59], s36 offen sc1
pub_76:
    s_mov_b64 exec, -1
    s_call_b64 s[76:77], SUB_rest_2
    s_waitcnt lgkmcnt(0)
    buffer_load_dwordx4 v121, s[12:15], s39 offen lds
    s_add_u32 m0, m0, 1024
    s_nop 0
    buffer_load_dwordx4 v122, s[12:15], s39 offen lds
    s_add_u32 m0, m0, 1024
    s_nop 0
    buffer_load_dwordx4 v123, s[12:15], s39 offen lds
    s_call_b64 s[76:77], PREP_w_issue_3
    s_add_u32 m0, m0, 1024
    s_nop 0
    buffer_load_dwordx4 v124, s[12:15], s39 offen lds
    s_add_u32 m0, m0, 1024
    s_nop 0
    buffer_load_dwordx4 v125, s[12:15], s39 offen lds
    s_add_u32 m0, m0, 1024
    s_nop 0
    buffer_load_dwordx4 v126, s[12:15], s39 offen lds
    s_add_u32 m0, m0, 1024
    s_nop 0
    buffer_load_dwordx4 v127, s[12:15], s39 offen lds
    s_add_u32 m0, m0, 1024
    s_add_u32 s39, s39, 114688
    buffer_load_dwordx4 v121, s[12:15], s39 offen lds
    s_add_u32 m0, m0, 1024
    s_nop 0
    buffer_load_dwordx4 v122, s[12:15], s39 offen lds
    s_add_u32 m0, m0, 1024
    s_nop 0
    buffer_load_dwordx4 v123, s[12:15], s39 offen lds
    s_add_u32 m0, m0, 1024
    s_nop 0
    buffer_load_dwordx4 v124, s[12:15], s39 offen lds
    s_add_u32 m0, m0, 1024
    s_nop 0
    buffer_load_dwordx4 v125, s[12:15], s39 offen lds
    s_add_u32 m0, m0, 1024
    s_nop 0
    buffer_load_dwordx4 v126, s[12:15], s39 offen lds
    s_add_u32 m0, m0, 1024
    s_nop 0
    buffer_load_dwordx4 v127, s[12:15], s39 offen lds
    s_mov_b32 m0, s19
    s_mov_b32 s39, s16
    s_cmp_lg_u32 s60, 0
    s_cbranch_scc1 cs_77
    s_and_b32 s35, s30, 1
    v_lshrrev_b32 v112, 2, v1
    v_mul_u32_u24 v104, 448, v112
    v_and_b32 v113, 3, v1
    v_lshl_add_u32 v104, v113, 3, v104
    v_add_u32 v104, 49152, v104
    s_mul_i32 s36, s35, 224
    v_add_u32 v104, s36, v104
    v_bfe_u32 v112, v1, 4, 1
    v_lshlrev_b32 v112, 5, v112
    s_cmp_eq_u32 s35, 0
    s_cselect_b32 s36, 1, -1
    v_mul_lo_u32 v112, v112, s36
    v_sub_u32 v105, v104, v112
    v_add_u32 v104, v104, v112
    s_cmp_eq_u32 s28, s29
    s_cselect_b32 s36, 0, 28672
    v_add_u32 v104, s36, v104
    v_add_u32 v105, s36, v105
    ds_read_b64_tr_b16 v[48:49], v104 offset:0
    ds_read_b64_tr_b16 v[50:51], v104 offset:7168
    ds_read_b64_tr_b16 v[52:53], v104 offset:14336
    ds_read_b64_tr_b16 v[54:55], v104 offset:21504
    ds_read_b64_tr_b16 v[56:57], v105 offset:32
    ds_read_b64_tr_b16 v[58:59], v105 offset:7200
    ds_read_b64_tr_b16 v[60:61], v105 offset:14368
    ds_read_b64_tr_b16 v[62:63], v105 offset:21536
    ds_read_b64_tr_b16 v[64:65], v104 offset:64
    ds_read_b64_tr_b16 v[66:67], v104 offset:7232
    ds_read_b64_tr_b16 v[68:69], v104 offset:14400
    ds_read_b64_tr_b16 v[70:71], v104 offset:21568
    ds_read_b64_tr_b16 v[72:73], v105 offset:96
    ds_read_b64_tr_b16 v[74:75], v105 offset:7264
    ds_read_b64_tr_b16 v[76:77], v105 offset:14432
    ds_read_b64_tr_b16 v[78:79], v105 offset:21600
    ds_read_b64_tr_b16 v[80:81], v104 offset:128
    ds_read_b64_tr_b16 v[82:83], v104 offset:7296
    ds_read_b64_tr_b16 v[84:85], v104 offset:14464
    ds_read_b64_tr_b16 v[86:87], v104 offset:21632
    ds_read_b64_tr_b16 v[88:89], v105 offset:160
    ds_read_b64_tr_b16 v[90:91], v105 offset:7328
    ds_read_b64_tr_b16 v[92:93], v105 offset:14496
    ds_read_b64_tr_b16 v[94:95], v105 offset:21664
    ds_read_b64_tr_b16 v[96:97], v104 offset:192
    ds_read_b64_tr_b16 v[98:99], v104 offset:7360
    ds_read_b64_tr_b16 v[100:101], v104 offset:14528
    ds_read_b64_tr_b16 v[102:103], v104 offset:21696
    v_and_b32 v112, 15, v1
    v_mov_b32 v113, 0x3f803f80
    v_cmp_eq_u32 vcc, 0, v112
    s_nop 1
    v_cndmask_b32 v20, 0, v113, vcc
    v_cndmask_b32 v21, 0, v113, vcc
    v_cndmask_b32 v22, 0, v113, vcc
    v_cndmask_b32 v23, 0, v113, vcc
    v_cmp_eq_u32 vcc, 1, v112
    s_nop 1
    v_cndmask_b32 v24, 0, v113, vcc
    v_cndmask_b32 v25, 0, v113, vcc
    v_cndmask_b32 v26, 0, v113, vcc
    v_cndmask_b32 v27, 0, v113, vcc
    v_cmp_eq_u32 vcc, 2, v112
    s_nop 1
    v_cndmask_b32 v28, 0, v113, vcc
    v_cndmask_b32 v29, 0, v113, vcc
    v_cndmask_b32 v30, 0, v113, vcc
    v_cndmask_b32 v31, 0, v113, vcc
    v_cmp_eq_u32 vcc, 3, v112
    s_nop 1
    v_cndmask_b32 v32, 0, v113, vcc
    v_cndmask_b32 v33, 0, v113, vcc
    v_cndmask_b32 v34, 0, v113, vcc
    v_cndmask_b32 v35, 0, v113, vcc
    v_cmp_eq_u32 vcc, 4, v112
    s_nop 1
    v_cndmask_b32 v36, 0, v113, vcc
    v_cndmask_b32 v37, 0, v113, vcc
    v_cndmask_b32 v38, 0, v113, vcc
    v_cndmask_b32 v39, 0, v113, vcc
    v_cmp_eq_u32 vcc, 5, v112
    s_nop 1
    v_cndmask_b32 v40, 0, v113, vcc
    v_cndmask_b32 v41, 0, v113, vcc
    v_cndmask_b32 v42, 0, v113, vcc
    v_cndmask_b32 v43, 0, v113, vcc
    v_cmp_eq_u32 vcc, 6, v112
    s_nop 1
    v_cndmask_b32 v44, 0, v113, vcc
    v_cndmask_b32 v45, 0, v113, vcc
    v_cndmask_b32 v46, 0, v113, vcc
    v_cndmask_b32 v47, 0, v113, vcc
    v_and_b32 v114, 48, v1
    v_lshl_add_u32 v114, v112, 6, v114
    v_mov_b32 v113, 0x7f000000
    v_cmp_gt_u32 vcc, 7, v112
    s_nop 1
    v_cndmask_b32 v114, v113, v114, vcc
    s_add_u32 s20, s4, 0x1420000
    s_addc_u32 s21, s5, 0
    s_mov_b32 s22, 0x38000
    s_mov_b32 s23, 0x20000
    s_mul_i32 s36, s28, 14336
    s_lshl1_add_u32 s35, s29, s35
    s_mul_i32 s35, s35, 448
    s_add_u32 s35, s35, s36
    s_waitcnt lgkmcnt(0)
    v_mfma_f32_16x16x32_bf16 v[108:111], v[48:51], v[20:23], 0
    v_mfma_f32_16x16x32_bf16 v[108:111], v[52:55], v[20:23], v[108:111]
    v_mfma_f32_16x16x32_bf16 v[108:111], v[56:59], v[24:27], v[108:111]
    v_mfma_f32_16x16x32_bf16 v[108:111], v[60:63], v[24:27], v[108:111]
    v_mfma_f32_16x16x32_bf16 v[108:111], v[64:67], v[28:31], v[108:111]
    v_mfma_f32_16x16x32_bf16 v[108:111], v[68:71], v[28:31], v[108:111]
    v_mfma_f32_16x16x32_bf16 v[108:111], v[72:75], v[32:35], v[108:111]
    v_mfma_f32_16x16x32_bf16 v[108:111], v[76:79], v[32:35], v[108:111]
    v_mfma_f32_16x16x32_bf16 v[108:111], v[80:83], v[36:39], v[108:111]
    v_mfma_f32_16x16x32_bf16 v[108:111], v[84:87], v[36:39], v[108:111]
    v_mfma_f32_16x16x32_bf16 v[108:111], v[88:91], v[40:43], v[108:111]
    v_mfma_f32_16x16x32_bf16 v[108:111], v[92:95], v[40:43], v[108:111]
    v_mfma_f32_16x16x32_bf16 v[108:111], v[96:99], v[44:47], v[108:111]
    v_mfma_f32_16x16x32_bf16 v[108:111], v[100:103], v[44:47], v[108:111]
    s_nop 7
    buffer_store_dwordx4 v[108:111], v114, s[20:23], s35 offen sc1
cs_77:
    s_waitcnt vmcnt(15)
    s_barrier
    buffer_load_dwordx4 v121, s[12:15], s39 offen lds
    s_add_u32 m0, m0, 1024
    s_nop 0
    buffer_load_dwordx4 v122, s[12:15], s39 offen lds
    s_add_u32 m0, m0, 1024
    s_nop 0
    buffer_load_dwordx4 v123, s[12:15], s39 offen lds
    s_call_b64 s[76:77], PREP_w_issue_3
    s_add_u32 m0, m0, 1024
    s_nop 0
    buffer_load_dwordx4 v124, s[12:15], s39 offen lds
    s_add_u32 m0, m0, 1024
    s_nop 0
    buffer_load_dwordx4 v125, s[12:15], s39 offen lds
    s_add_u32 m0, m0, 1024
    s_nop 0
    buffer_load_dwordx4 v126, s[12:15], s39 offen lds
    s_add_u32 m0, m0, 1024
    s_nop 0
    buffer_load_dwordx4 v127, s[12:15], s39 offen lds
    s_add_u32 m0, m0, 1024
    s_add_u32 s39, s39, 114688
    buffer_load_dwordx4 v121, s[12:15], s39 offen lds
    s_add_u32 m0, m0, 1024
    s_nop 0
    buffer_load_dwordx4 v122, s[12:15], s39 offen lds
    s_add_u32 m0, m0, 1024
    s_nop 0
    buffer_load_dwordx4 v123, s[12:15], s39 offen lds
    s_add_u32 m0, m0, 1024
    s_nop 0
    buffer_load_dwordx4 v124, s[12:15], s39 offen lds
    s_add_u32 m0, m0, 1024
    s_nop 0
    buffer_load_dwordx4 v125, s[12:15], s39 offen lds
    s_add_u32 m0, m0, 1024
    s_nop 0
    buffer_load_dwordx4 v126, s[12:15], s39 offen lds
    s_add_u32 m0, m0, 1024
    s_nop 0
    buffer_load_dwordx4 v127, s[12:15], s39 offen lds
    s_mov_b32 m0, s19
    s_mov_b32 s39, s16
    s_waitcnt vmcnt(14)
    s_barrier
    buffer_load_dwordx4 v121, s[12:15], s39 offen lds
    s_add_u32 m0, m0, 1024
    s_nop 0
    buffer_load_dwordx4 v122, s[12:15], s39 offen lds
    s_add_u32 m0, m0, 1024
    s_nop 0
    buffer_load_dwordx4 v123, s[12:15], s39 offen lds
    s_call_b64 s[76:77], PREP_w_issue_3
    s_add_u32 m0, m0, 1024
    s_nop 0
    buffer_load_dwordx4 v124, s[12:15], s39 offen lds
    s_add_u32 m0, m0, 1024
    s_nop 0
    buffer_load_dwordx4 v125, s[12:15], s39 offen lds
    s_add_u32 m0, m0, 1024
    s_nop 0
    buffer_load_dwordx4 v126, s[12:15], s39 offen lds
    s_add_u32 m0, m0, 1024
    s_nop 0
    buffer_load_dwordx4 v127, s[12:15], s39 offen lds
    s_add_u32 m0, m0, 1024
    s_add_u32 s39, s39, 114688
    buffer_load_dwordx4 v121, s[12:15], s39 offen lds
    s_add_u32 m0, m0, 1024
    s_nop 0
    buffer_load_dwordx4 v122, s[12:15], s39 offen lds
    s_add_u32 m0, m0, 1024
    s_nop 0
    buffer_load_dwordx4 v123, s[12:15], s39 offen lds
    s_add_u32 m0, m0, 1024
    s_nop 0
    buffer_load_dwordx4 v124, s[12:15], s39 offen lds
    s_add_u32 m0, m0, 1024
    s_nop 0
    buffer_load_dwordx4 v125, s[12:15], s39 offen lds
    s_add_u32 m0, m0, 1024
    s_nop 0
    buffer_load_dwordx4 v126, s[12:15], s39 offen lds
    s_add_u32 m0, m0, 1024
    s_nop 0
    buffer_load_dwordx4 v127, s[12:15], s39 offen lds
    s_mov_b32 m0, s19
    s_mov_b32 s39, s16
    s_waitcnt vmcnt(14)
    s_barrier
    buffer_load_dwordx4 v121, s[12:15], s39 offen lds
    s_add_u32 m0, m0, 1024
    s_nop 0
    buffer_load_dwordx4 v122, s[12:15], s39 offen lds
    s_add_u32 m0, m0, 1024
    s_nop 0
    buffer_load_dwordx4 v123, s[12:15], s39 offen lds
    s_call_b64 s[76:77], PREP_w_issue_3
    s_add_u32 m0, m0, 1024
    s_nop 0
    buffer_load_dwordx4 v124, s[12:15], s39 offen lds
    s_add_u32 m0, m0, 1024
    s_nop 0
    buffer_load_dwordx4 v125, s[12:15], s39 offen lds
    s_add_u32 m0, m0, 1024
    s_nop 0
    buffer_load_dwordx4 v126, s[12:15], s39 offen lds
    s_add_u32 m0, m0, 1024
    s_nop 0
    buffer_load_dwordx4 v127, s[12:15], s39 offen lds
    s_add_u32 m0, m0, 1024
    s_add_u32 s39, s39, 114688
    buffer_load_dwordx4 v121, s[12:15], s39 offen lds
    s_add_u32 m0, m0, 1024
    s_nop 0
    buffer_load_dwordx4 v122, s[12:15], s39 offen lds
    s_add_u32 m0, m0, 1024
    s_nop 0
    buffer_load_dwordx4 v123, s[12:15], s39 offen lds
    s_add_u32 m0, m0, 1024
    s_nop 0
    buffer_load_dwordx4 v124, s[12:15], s39 offen lds
    s_add_u32 m0, m0, 1024
    s_nop 0
    buffer_load_dwordx4 v125, s[12:15], s39 offen lds
    s_add_u32 m0, m0, 1024
    s_nop 0
    buffer_load_dwordx4 v126, s[12:15], s39 offen lds
    s_add_u32 m0, m0, 1024
    s_nop 0
    buffer_load_dwordx4 v127, s[12:15], s39 offen lds
    s_mov_b32 m0, s19
    s_mov_b32 s39, s16
    s_waitcnt vmcnt(28)
    s_cmp_lg_u32 s60, 0
    s_cbranch_scc1 cs_78
    s_lshl_b32 s36, s29, 7
    s_add_u32 s36, s36, 23068672
    v_mov_b32 v14, 1
    v_mov_b32 v15, 162816
    v_mov_b32 v17, 0
    s_mov_b64 exec, 1
    buffer_atomic_add v14, v17, s[56:59], s36 offen sc1
pub_79:
    s_mov_b64 exec, -1
cs_78:
    s_waitcnt vmcnt(14)
    s_barrier
    buffer_load_dwordx4 v121, s[12:15], s39 offen lds
    s_add_u32 m0, m0, 1024
    s_nop 0
    buffer_load_dwordx4 v122, s[12:15], s39 offen lds
    s_add_u32 m0, m0, 1024
    s_nop 0
    buffer_load_dwordx4 v123, s[12:15], s39 offen lds
    s_mov_b32 s43, 1
ld_80:
    s_add_u32 s19, s41, s42
    s_cmp_eq_u32 s44, s47
    s_cselect_b32 s16, s46, s44
    s_mul_i32 s16, s16, 458752
    s_add_u32 s16, s16, s38
    s_add_u32 s44, s44, 1
    s_and_b32 s44, s44, 15
    s_add_u32 s42, s42, 28672
    s_cmp_eq_u32 s42, 86016
    s_cselect_b32 s42, 0, s42
    s_add_u32 m0, m0, 1024
    s_nop 0
    buffer_load_dwordx4 v124, s[12:15], s39 offen lds
    s_add_u32 m0, m0, 1024
    s_nop 0
    buffer_load_dwordx4 v125, s[12:15], s39 offen lds
    s_add_u32 m0, m0, 1024
    s_nop 0
    buffer_load_dwordx4 v126, s[12:15], s39 offen lds
    s_add_u32 m0, m0, 1024
    s_nop 0
    buffer_load_dwordx4 v127, s[12:15], s39 offen lds
    s_add_u32 m0, m0, 1024
    s_add_u32 s39, s39, 114688
    buffer_load_dwordx4 v121, s[12:15], s39 offen lds
    s_add_u32 m0, m0, 1024
    s_nop 0
    buffer_load_dwordx4 v122, s[12:15], s39 offen lds
    s_add_u32 m0, m0, 1024
    s_nop 0
    buffer_load_dwordx4 v123, s[12:15], s39 offen lds
    s_add_u32 m0, m0, 1024
    s_nop 0
    buffer_load_dwordx4 v124, s[12:15], s39 offen lds
    s_add_u32 m0, m0, 1024
    s_nop 0
    buffer_load_dwordx4 v125, s[12:15], s39 offen lds
    s_add_u32 m0, m0, 1024
    s_nop 0
    buffer_load_dwordx4 v126, s[12:15], s39 offen lds
    s_add_u32 m0, m0, 1024
    s_nop 0
    buffer_load_dwordx4 v127, s[12:15], s39 offen lds
    s_mov_b32 m0, s19
    s_mov_b32 s39, s16
    s_waitcnt vmcnt(14)
    s_barrier
    buffer_load_dwordx4 v121, s[12:15], s39 offen lds
    s_add_u32 m0, m0, 1024
    s_nop 0
    buffer_load_dwordx4 v122, s[12:15], s39 offen lds
    s_add_u32 m0, m0, 1024
    s_nop 0
    buffer_load_dwordx4 v123, s[12:15], s39 offen lds
    s_add_u32 s43, s43, 1
    s_cmp_lt_u32 s43, 9
    s_cbranch_scc1 ld_80
    s_call_b64 s[76:77], PREP_w_issue_3
    s_add_u32 m0, m0, 1024
    s_nop 0
    buffer_load_dwordx4 v124, s[12:15], s39 offen lds
    s_add_u32 m0, m0, 1024
    s_nop 0
    buffer_load_dwordx4 v125, s[12:15], s39 offen lds
    s_add_u32 m0, m0, 1024
    s_nop 0
    buffer_load_dwordx4 v126, s[12:15], s39 offen lds
    s_add_u32 m0, m0, 1024
    s_nop 0
    buffer_load_dwordx4 v127, s[12:15], s39 offen lds
    s_add_u32 m0, m0, 1024
    s_add_u32 s39, s39, 114688
    buffer_load_dwordx4 v121, s[12:15], s39 offen lds
    s_add_u32 m0, m0, 1024
    s_nop 0
    buffer_load_dwordx4 v122, s[12:15], s39 offen lds
    s_add_u32 m0, m0, 1024
    s_nop 0
    buffer_load_dwordx4 v123, s[12:15], s39 offen lds
    s_add_u32 m0, m0, 1024
    s_nop 0
    buffer_load_dwordx4 v124, s[12:15], s39 offen lds
    s_add_u32 m0, m0, 1024
    s_nop 0
    buffer_load_dwordx4 v125, s[12:15], s39 offen lds
    s_add_u32 m0, m0, 1024
    s_nop 0
    buffer_load_dwordx4 v126, s[12:15], s39 offen lds
    s_add_u32 m0, m0, 1024
    s_nop 0
    buffer_load_dwordx4 v127, s[12:15], s39 offen lds
    s_mov_b32 m0, s19
    s_mov_b32 s39, s16
    s_waitcnt vmcnt(14)
    s_barrier
    buffer_load_dwordx4 v121, s[12:15], s39 offen lds
    s_add_u32 m0, m0, 1024
    s_nop 0
    buffer_load_dwordx4 v122, s[12:15], s39 offen lds
    s_add_u32 m0, m0, 1024
    s_nop 0
    buffer_load_dwordx4 v123, s[12:15], s39 offen lds
    s_add_u32 m0, m0, 1024
    s_nop 0
    buffer_load_dwordx4 v124, s[12:15], s39 offen lds
    s_add_u32 m0, m0, 1024
    s_nop 0
    buffer_load_dwordx4 v125, s[12:15], s39 offen lds
    s_add_u32 m0, m0, 1024
    s_nop 0
    buffer_load_dwordx4 v126, s[12:15], s39 offen lds
    s_add_u32 m0, m0, 1024
    s_nop 0
    buffer_load_dwordx4 v127, s[12:15], s39 offen lds
    s_add_u32 m0, m0, 1024
    s_add_u32 s39, s39, 114688
    buffer_load_dwordx4 v121, s[12:15], s39 offen lds
    s_add_u32 m0, m0, 1024
    s_nop 0
    buffer_load_dwordx4 v122, s[12:15], s39 offen lds
    s_add_u32 m0, m0, 1024
    s_nop 0
    buffer_load_dwordx4 v123, s[12:15], s39 offen lds
    s_add_u32 m0, m0, 1024
    s_nop 0
    buffer_load_dwordx4 v124, s[12:15], s39 offen lds
    s_add_u32 m0, m0, 1024
    s_nop 0
    buffer_load_dwordx4 v125, s[12:15], s39 offen lds
    s_add_u32 m0, m0, 1024
    s_nop 0
    buffer_load_dwordx4 v126, s[12:15], s39 offen lds
    s_add_u32 m0, m0, 1024
    s_nop 0
    buffer_load_dwordx4 v127, s[12:15], s39 offen lds
    s_waitcnt vmcnt(14)
    s_barrier
    s_waitcnt vmcnt(0)
    s_barrier
    s_barrier
    s_mov_b64 s[12:13], s[74:75]
    s_mov_b32 s14, 7340032
    s_mov_b32 s15, 0x20000
    s_and_b32 s35, s30, 1
    s_mul_i32 s38, s33, 256
    s_mul_i32 s41, s31, 3670016
    s_add_u32 s38, s38, s41
    s_mul_i32 s41, s35, 8192
    s_add_u32 s41, s41, 49152
    s_mov_b32 s42, 0
    s_mov_b32 s44, 0
    s_mov_b32 s49, s44
    s_and_b32 s43, s28, 3
    s_mul_i32 s43, s43, 6
    s_lshr_b32 s43, s43, 2
    s_mov_b32 s50, 0
wpre_81:
    s_mul_i32 s42, s43, 16384
    s_add_u32 s44, s49, s43
    s_add_u32 s19, s41, s42
    s_and_b32 s40, s30, 1
    s_lshl_b32 s45, s44, 1
    s_add_u32 s45, s45, s40
    s_sub_u32 s45, s45, 32
    s_mul_i32 s46, s45, 86
    s_lshr_b32 s46, s46, 8
    s_mul_i32 s47, s46, 3
    s_sub_u32 s47, s45, s47
    s_lshl_b32 s47, s47, 2
    s_lshr_b32 s47, 0x362, s47
    s_and_b32 s47, s47, 7
    s_cmp_ge_u32 s44, 10
    s_cselect_b32 s45, 9, 2
    s_cselect_b32 s51, 1, 0
    s_sub_u32 s45, s44, s45
    s_cmp_lt_u32 s44, 3
    s_cselect_b32 s45, 0, s45
    s_cselect_b32 s51, s44, s51
    s_lshl2_add_u32 s51, s40, s51
    s_cmp_lt_u32 s44, 17
    s_cselect_b32 s47, s51, s47
    s_cselect_b32 s46, s45, s46
    s_add_u32 s46, s46, s33
    s_and_b32 s46, s46, 7
    s_mul_i32 s46, s46, 7
    s_add_u32 s16, s46, s47
    s_mul_i32 s16, s16, 65536
    s_add_u32 s16, s16, s38
    s_cmp_eq_u32 s47, 3
    s_cselect_b32 s17, 8, 4
    s_cselect_b32 s18, -20, 4
    s_lshl_b32 s17, s17, 11
    s_lshl_b32 s18, s18, 11
    s_add_u32 s44, s44, 1
    s_add_u32 s42, s42, 16384
    s_cmp_eq_u32 s42, 98304
    s_cselect_b32 s42, 0, s42
    s_mov_b32 m0, s19
    s_mov_b32 s39, s16
    s_mov_b32 s32, s17
    s_mov_b32 s3, s18
    buffer_load_dwordx4 v119, s[12:15], s39 offen lds
    s_add_u32 m0, m0, 1024
    s_add_u32 s39, s39, s32
    buffer_load_dwordx4 v120, s[12:15], s39 offen lds
    s_add_u32 m0, m0, 1024
    s_add_u32 s39, s39, s32
    buffer_load_dwordx4 v119, s[12:15], s39 offen lds
    s_add_u32 m0, m0, 1024
    s_add_u32 s39, s39, s32
    buffer_load_dwordx4 v120, s[12:15], s39 offen lds
    s_waitcnt vmcnt(4)
    s_add_u32 m0, m0, 1024
    s_add_u32 s39, s39, s3
    buffer_load_dwordx4 v119, s[12:15], s39 offen lds
    s_add_u32 m0, m0, 1024
    s_add_u32 s39, s39, s32
    buffer_load_dwordx4 v120, s[12:15], s39 offen lds
    s_add_u32 m0, m0, 1024
    s_add_u32 s39, s39, s32
    buffer_load_dwordx4 v119, s[12:15], s39 offen lds
    s_add_u32 m0, m0, 1024
    s_add_u32 s39, s39, s32
    buffer_load_dwordx4 v120, s[12:15], s39 offen lds
    s_waitcnt vmcnt(4)
    s_add_u32 s43, s43, 1
    s_cmp_eq_u32 s43, 6
    s_cselect_b32 s43, 0, s43
    s_add_u32 s50, s50, 1
    s_cmp_lt_u32 s50, 6
    s_cbranch_scc1 wpre_81
    s_mov_b32 s42, 0
    s_add_u32 s44, s49, 6
    s_cmp_eq_u32 s60, 1
    s_cbranch_scc1 WL_t1
    s_call_b64 s[76:77], PREP_w_issue_4
    s_mov_b32 m0, s19
    s_mov_b32 s39, s16
    s_mov_b32 s32, s17
    s_mov_b32 s3, s18
    s_waitcnt vmcnt(0)
    s_barrier
    s_waitcnt vmcnt(0)
    s_barrier
    buffer_load_dwordx4 v119, s[12:15], s39 offen lds
    s_add_u32 m0, m0, 1024
    s_add_u32 s39, s39, s32
    buffer_load_dwordx4 v120, s[12:15], s39 offen lds
    s_call_b64 s[76:77], PREP_w_issue_4
    s_add_u32 m0, m0, 1024
    s_add_u32 s39, s39, s32
    buffer_load_dwordx4 v119, s[12:15], s39 offen lds
    s_add_u32 m0, m0, 1024
    s_add_u32 s39, s39, s32
    buffer_load_dwordx4 v120, s[12:15], s39 offen lds
    s_add_u32 m0, m0, 1024
    s_add_u32 s39, s39, s3
    buffer_load_dwordx4 v119, s[12:15], s39 offen lds
    s_add_u32 m0, m0, 1024
    s_add_u32 s39, s39, s32
    buffer_load_dwordx4 v120, s[12:15], s39 offen lds
    s_add_u32 m0, m0, 1024
    s_add_u32 s39, s39, s32
    buffer_load_dwordx4 v119, s[12:15], s39 offen lds
    s_add_u32 m0, m0, 1024
    s_add_u32 s39, s39, s32
    buffer_load_dwordx4 v120, s[12:15], s39 offen lds
    s_mov_b32 m0, s19
    s_mov_b32 s39, s16
    s_mov_b32 s32, s17
    s_mov_b32 s3, s18
    s_waitcnt vmcnt(8)
    s_barrier
    buffer_load_dwordx4 v119, s[12:15], s39 offen lds
    s_add_u32 m0, m0, 1024
    s_add_u32 s39, s39, s32
    buffer_load_dwordx4 v120, s[12:15], s39 offen lds
    s_call_b64 s[76:77], PREP_w_issue_4
    s_add_u32 m0, m0, 1024
    s_add_u32 s39, s39, s32
    buffer_load_dwordx4 v119, s[12:15], s39 offen lds
    s_add_u32 m0, m0, 1024
    s_add_u32 s39, s39, s32
    buffer_load_dwordx4 v120, s[12:15], s39 offen lds
    s_add_u32 m0, m0, 1024
    s_add_u32 s39, s39, s3
    buffer_load_dwordx4 v119, s[12:15], s39 offen lds
    s_add_u32 m0, m0, 1024
    s_add_u32 s39, s39, s32
    buffer_load_dwordx4 v120, s[12:15], s39 offen lds
    s_add_u32 m0, m0, 1024
    s_add_u32 s39, s39, s32
    buffer_load_dwordx4 v119, s[12:15], s39 offen lds
    s_add_u32 m0, m0, 1024
    s_add_u32 s39, s39, s32
    buffer_load_dwordx4 v120, s[12:15], s39 offen lds
    s_mov_b32 m0, s19
    s_mov_b32 s39, s16
    s_mov_b32 s32, s17
    s_mov_b32 s3, s18
    s_waitcnt vmcnt(16)
    s_barrier
    buffer_load_dwordx4 v119, s[12:15], s39 offen lds
    s_add_u32 m0, m0, 1024
    s_add_u32 s39, s39, s32
    buffer_load_dwordx4 v120, s[12:15], s39 offen lds
    s_call_b64 s[76:77], PREP_w_issue_4
    s_add_u32 m0, m0, 1024
    s_add_u32 s39, s39, s32
    buffer_load_dwordx4 v119, s[12:15], s39 offen lds
    s_add_u32 m0, m0, 1024
    s_add_u32 s39, s39, s32
    buffer_load_dwordx4 v120, s[12:15], s39 offen lds
    s_add_u32 m0, m0, 1024
    s_add_u32 s39, s39, s3
    buffer_load_dwordx4 v119, s[12:15], s39 offen lds
    s_add_u32 m0, m0, 1024
    s_add_u32 s39, s39, s32
    buffer_load_dwordx4 v120, s[12:15], s39 offen lds
    s_add_u32 m0, m0, 1024
    s_add_u32 s39, s39, s32
    buffer_load_dwordx4 v119, s[12:15], s39 offen lds
    s_add_u32 m0, m0, 1024
    s_add_u32 s39, s39, s32
    buffer_load_dwordx4 v120, s[12:15], s39 offen lds
    s_mov_b32 m0, s19
    s_mov_b32 s39, s16
    s_mov_b32 s32, s17
    s_mov_b32 s3, s18
    s_waitcnt vmcnt(24)
    s_barrier
    buffer_load_dwordx4 v119, s[12:15], s39 offen lds
    s_add_u32 m0, m0, 1024
    s_add_u32 s39, s39, s32
    buffer_load_dwordx4 v120, s[12:15], s39 offen lds
    s_mov_b32 s43, 1
ld_82:
    s_add_u32 s19, s41, s42
    s_and_b32 s40, s30, 1
    s_lshl_b32 s45, s44, 1
    s_add_u32 s45, s45, s40
    s_sub_u32 s45, s45, 32
    s_mul_i32 s46, s45, 86
    s_lshr_b32 s46, s46, 8
    s_mul_i32 s47, s46, 3
    s_sub_u32 s47, s45, s47
    s_lshl_b32 s47, s47, 2
    s_lshr_b32 s47, 0x362, s47
    s_and_b32 s47, s47, 7
    s_cmp_ge_u32 s44, 10
    s_cselect_b32 s45, 9, 2
    s_cselect_b32 s51, 1, 0
    s_sub_u32 s45, s44, s45
    s_cmp_lt_u32 s44, 3
    s_cselect_b32 s45, 0, s45
    s_cselect_b32 s51, s44, s51
    s_lshl2_add_u32 s51, s40, s51
    s_cmp_lt_u32 s44, 17
    s_cselect_b32 s47, s51, s47
    s_cselect_b32 s46, s45, s46
    s_add_u32 s46, s46, s33
    s_and_b32 s46, s46, 7
    s_mul_i32 s46, s46, 7
    s_add_u32 s16, s46, s47
    s_mul_i32 s16, s16, 65536
    s_add_u32 s16, s16, s38
    s_cmp_eq_u32 s47, 3
    s_cselect_b32 s17, 8, 4
    s_cselect_b32 s18, -20, 4
    s_lshl_b32 s17, s17, 11
    s_lshl_b32 s18, s18, 11
    s_add_u32 s44, s44, 1
    s_add_u32 s42, s42, 16384
    s_cmp_eq_u32 s42, 98304
    s_cselect_b32 s42, 0, s42
    s_add_u32 m0, m0, 1024
    s_add_u32 s39, s39, s32
    buffer_load_dwordx4 v119, s[12:15], s39 offen lds
    s_add_u32 m0, m0, 1024
    s_add_u32 s39, s39, s32
    buffer_load_dwordx4 v120, s[12:15], s39 offen lds
    s_add_u32 m0, m0, 1024
    s_add_u32 s39, s39, s3
    buffer_load_dwordx4 v119, s[12:15], s39 offen lds
    s_add_u32 m0, m0, 1024
    s_add_u32 s39, s39, s32
    buffer_load_dwordx4 v120, s[12:15], s39 offen lds
    s_add_u32 m0, m0, 1024
    s_add_u32 s39, s39, s32
    buffer_load_dwordx4 v119, s[12:15], s39 offen lds
    s_add_u32 m0, m0, 1024
    s_add_u32 s39, s39, s32
    buffer_load_dwordx4 v120, s[12:15], s39 offen lds
    s_mov_b32 m0, s19
    s_mov_b32 s39, s16
    s_mov_b32 s32, s17
    s_mov_b32 s3, s18
    s_waitcnt vmcnt(32)
    s_barrier
    buffer_load_dwordx4 v119, s[12:15], s39 offen lds
    s_add_u32 m0, m0, 1024
    s_add_u32 s39, s39, s32
    buffer_load_dwordx4 v120, s[12:15], s39 offen lds
    s_add_u32 s43, s43, 1
    s_cmp_lt_u32 s43, 18
    s_cbranch_scc1 ld_82
    s_call_b64 s[76:77], PREP_w_issue_4
    s_add_u32 m0, m0, 1024
    s_add_u32 s39, s39, s32
    buffer_load_dwordx4 v119, s[12:15], s39 offen lds
    s_add_u32 m0, m0, 1024
    s_add_u32 s39, s39, s32
    buffer_load_dwordx4 v120, s[12:15], s39 offen lds
    s_add_u32 m0, m0, 1024
    s_add_u32 s39, s39, s3
    buffer_load_dwordx4 v119, s[12:15], s39 offen lds
    s_add_u32 m0, m0, 1024
    s_add_u32 s39, s39, s32
    buffer_load_dwordx4 v120, s[12:15], s39 offen lds
    s_add_u32 m0, m0, 1024
    s_add_u32 s39, s39, s32
    buffer_load_dwordx4 v119, s[12:15], s39 offen lds
    s_add_u32 m0, m0, 1024
    s_add_u32 s39, s39, s32
    buffer_load_dwordx4 v120, s[12:15], s39 offen lds
    s_mov_b32 m0, s19
    s_mov_b32 s39, s16
    s_mov_b32 s32, s17
    s_mov_b32 s3, s18
    s_waitcnt vmcnt(32)
    s_barrier
    buffer_load_dwordx4 v119, s[12:15], s39 offen lds
    s_add_u32 m0, m0, 1024
    s_add_u32 s39, s39, s32
    buffer_load_dwordx4 v120, s[12:15], s39 offen lds
    s_add_u32 m0, m0, 1024
    s_add_u32 s39, s39, s32
    buffer_load_dwordx4 v119, s[12:15], s39 offen lds
    s_add_u32 m0, m0, 1024
    s_add_u32 s39, s39, s32
    buffer_load_dwordx4 v120, s[12:15], s39 offen lds
    s_add_u32 m0, m0, 1024
    s_add_u32 s39, s39, s3
    buffer_load_dwordx4 v119, s[12:15], s39 offen lds
    s_add_u32 m0, m0, 1024
    s_add_u32 s39, s39, s32
    buffer_load_dwordx4 v120, s[12:15], s39 offen lds
    s_add_u32 m0, m0, 1024
    s_add_u32 s39, s39, s32
    buffer_load_dwordx4 v119, s[12:15], s39 offen lds
    s_add_u32 m0, m0, 1024
    s_add_u32 s39, s39, s32
    buffer_load_dwordx4 v120, s[12:15], s39 offen lds
    s_waitcnt vmcnt(32)
    s_barrier
    s_mov_b64 s[12:13], s[68:69]
    s_mov_b32 s14, 2097152
    s_mov_b32 s15, 0x20000
    s_and_b32 s35, s30, 1
    s_mul_i32 s38, s29, 128
    s_mul_i32 s41, s35, 65536
    s_add_u32 s38, s38, s41
    s_mul_i32 s41, s35, 4096
    s_mov_b32 s42, 0
    s_mov_b32 s44, 0
    s_mov_b32 s42, 114688
    s_add_u32 s44, s67, 3
    s_and_b32 s44, s44, 7
    s_or_b32 s44, s44, 8
    s_call_b64 s[76:77], SUB_w_issue_1
    s_mov_b32 s42, 122880
    s_add_u32 s44, s67, 4
    s_and_b32 s44, s44, 7
    s_or_b32 s44, s44, 8
    s_call_b64 s[76:77], SUB_w_issue_1
    s_mov_b32 s42, 147456
    s_add_u32 s44, s67, 7
    s_and_b32 s44, s44, 7
    s_or_b32 s44, s44, 8
    s_call_b64 s[76:77], SUB_w_issue_1
    s_waitcnt vmcnt(36)
    s_barrier
    s_mov_b32 s42, 131072
    s_add_u32 s44, s67, 5
    s_and_b32 s44, s44, 7
    s_or_b32 s44, s44, 8
    s_call_b64 s[76:77], SUB_w_issue_1
    s_mov_b32 s42, 139264
    s_add_u32 s44, s67, 6
    s_and_b32 s44, s44, 7
    s_or_b32 s44, s44, 8
    s_call_b64 s[76:77], SUB_w_issue_1
    s_waitcnt vmcnt(36)
    s_barrier
    s_mov_b32 s42, 49152
    s_add_u32 s44, s67, 3
    s_and_b32 s44, s44, 7
    s_call_b64 s[76:77], SUB_w_issue_1
    s_mov_b32 s42, 57344
    s_add_u32 s44, s67, 4
    s_and_b32 s44, s44, 7
    s_call_b64 s[76:77], SUB_w_issue_1
    s_waitcnt vmcnt(36)
    s_barrier
    s_mov_b32 s42, 65536
    s_add_u32 s44, s67, 5
    s_and_b32 s44, s44, 7
    s_call_b64 s[76:77], SUB_w_issue_1
    s_mov_b32 s42, 73728
    s_add_u32 s44, s67, 6
    s_and_b32 s44, s44, 7
    s_call_b64 s[76:77], SUB_w_issue_1
    s_mov_b32 s42, 24576
    s_add_u32 s44, s67, 0
    s_and_b32 s44, s44, 7
    s_call_b64 s[76:77], SUB_w_issue_1
    s_waitcnt vmcnt(40)
    s_barrier
    v_and_b32 v81, 7, v0
    v_lshrrev_b32 v84, 6, v0
    v_lshlrev_b32 v84, 4, v84
    v_bfe_u32 v85, v0, 3, 3
    v_add_u32 v84, v84, v85
    s_lshr_b32 s78, s29, 1
    s_lshl_b32 s78, s78, 16
    s_and_b32 s79, s29, 1
    s_lshl_b32 s79, s79, 7
    s_add_u32 s78, s78, s79
    s_lshr_b32 s79, s30, 1
    s_lshl_b32 s79, s79, 13
    s_add_u32 s78, s78, s79
    v_lshlrev_b32 v78, 8, v84
    v_lshl_add_u32 v78, v81, 4, v78
    v_add_u32 v78, s78, v78
    s_lshl_b32 s78, s28, 7
    s_lshl_b32 s79, s29, 3
    s_add_u32 s78, s78, s79
    v_add_u32 v79, s78, v81
    v_lshlrev_b32 v80, 11, v79
    v_and_b32 v85, 3, v79
    v_lshrrev_b32 v82, 2, v79
    v_lshlrev_b32 v82, 14, v82
    v_lshl_add_u32 v82, v85, 11, v82
    v_lshl_add_u32 v82, v84, 4, v82
    v_lshrrev_b32 v85, 2, v84
    v_lshlrev_b32 v85, 3, v85
    v_and_b32 v84, 3, v84
    v_add_u32 v84, v84, v85
    v_lshl_add_u32 v80, v84, 3, v80
    v_lshlrev_b32 v79, 3, v79
    v_lshl_add_u32 v79, v84, 14, v79
    s_lshl_b32 s86, s60, 24
    s_lshl_b32 s87, s94, 13
    s_add_u32 s86, s86, s87
    s_add_u32 s86, s86, 167772160
    s_add_u32 s84, s4, s86
    s_addc_u32 s85, s5, 0
    s_mov_b32 s86, 8380416
    s_mov_b32 s87, 0x20000
    s_add_u32 s88, s62, 0x480000
    s_addc_u32 s89, s63, 0
    s_mov_b32 s90, 0x7e000
    s_mov_b32 s91, 0x20000
    buffer_load_dwordx4 v[86:89], v82, s[84:87], 0 offen offset:0 sc1
    buffer_load_dwordx4 v[94:97], v78, s[88:91], 0 offen offset:0 sc1
    buffer_load_dwordx4 v[90:93], v82, s[84:87], 0 offen offset:128 sc1
    buffer_load_dwordx4 v[98:101], v78, s[88:91], 0 offen offset:2048 sc1
    s_add_u32 s80, s4, 0x1c00000
    s_addc_u32 s81, s5, 0
    s_mov_b32 s82, 0x400000
    s_mov_b32 s83, 0x20000
    s_mov_b32 s78, 0
    buffer_load_dwordx2 v[110:111], v79, s[80:83], s78 offen sc1
    s_mov_b32 s78, 65536
    buffer_load_dwordx2 v[112:113], v79, s[80:83], s78 offen sc1
    s_mov_b32 s78, 262144
    buffer_load_dwordx2 v[114:115], v79, s[80:83], s78 offen sc1
    s_mov_b32 s78, 327680
    buffer_load_dwordx2 v[116:117], v79, s[80:83], s78 offen sc1
    s_mov_b32 s42, 81920
    s_add_u32 s44, s67, 7
    s_and_b32 s44, s44, 7
    s_call_b64 s[76:77], SUB_w_issue_1
    s_mov_b32 s42, 90112
    s_add_u32 s44, s67, 0
    s_and_b32 s44, s44, 7
    s_or_b32 s44, s44, 8
    s_call_b64 s[76:77], SUB_w_issue_1
    s_mov_b32 s42, 32768
    s_add_u32 s44, s67, 1
    s_and_b32 s44, s44, 7
    s_call_b64 s[76:77], SUB_w_issue_1
    s_mov_b32 s42, 40960
    s_add_u32 s44, s67, 2
    s_and_b32 s44, s44, 7
    s_call_b64 s[76:77], SUB_w_issue_1
    s_barrier
    s_mov_b32 s42, 98304
    s_add_u32 s44, s67, 1
    s_and_b32 s44, s44, 7
    s_or_b32 s44, s44, 8
    s_call_b64 s[76:77], SUB_w_issue_1
    s_mov_b32 s42, 106496
    s_add_u32 s44, s67, 2
    s_and_b32 s44, s44, 7
    s_or_b32 s44, s44, 8
    s_call_b64 s[76:77], SUB_w_issue_1
    s_branch NEXT
WL_t1:
    s_call_b64 s[76:77], PREP_w_issue_4
    s_mov_b32 m0, s19
    s_mov_b32 s39, s16
    s_mov_b32 s32, s17
    s_mov_b32 s3, s18
    s_waitcnt vmcnt(0)
    s_barrier
    s_waitcnt vmcnt(0)
    s_barrier
    s_waitcnt vmcnt(0)
    s_barrier
    s_waitcnt vmcnt(0)
    s_barrier
    s_waitcnt vmcnt(0)
    s_barrier
    buffer_load_dwordx4 v119, s[12:15], s39 offen lds
    s_add_u32 m0, m0, 1024
    s_add_u32 s39, s39, s32
    buffer_load_dwordx4 v120, s[12:15], s39 offen lds
    s_mov_b32 s43, 1
ld_83:
    s_add_u32 s19, s41, s42
    s_and_b32 s40, s30, 1
    s_lshl_b32 s45, s44, 1
    s_add_u32 s45, s45, s40
    s_sub_u32 s45, s45, 32
    s_mul_i32 s46, s45, 86
    s_lshr_b32 s46, s46, 8
    s_mul_i32 s47, s46, 3
    s_sub_u32 s47, s45, s47
    s_lshl_b32 s47, s47, 2
    s_lshr_b32 s47, 0x362, s47
    s_and_b32 s47, s47, 7
    s_cmp_ge_u32 s44, 10
    s_cselect_b32 s45, 9, 2
    s_cselect_b32 s51, 1, 0
    s_sub_u32 s45, s44, s45
    s_cmp_lt_u32 s44, 3
    s_cselect_b32 s45, 0, s45
    s_cselect_b32 s51, s44, s51
    s_lshl2_add_u32 s51, s40, s51
    s_cmp_lt_u32 s44, 17
    s_cselect_b32 s47, s51, s47
    s_cselect_b32 s46, s45, s46
    s_add_u32 s46, s46, s33
    s_and_b32 s46, s46, 7
    s_mul_i32 s46, s46, 7
    s_add_u32 s16, s46, s47
    s_mul_i32 s16, s16, 65536
    s_add_u32 s16, s16, s38
    s_cmp_eq_u32 s47, 3
    s_cselect_b32 s17, 8, 4
    s_cselect_b32 s18, -20, 4
    s_lshl_b32 s17, s17, 11
    s_lshl_b32 s18, s18, 11
    s_add_u32 s44, s44, 1
    s_add_u32 s42, s42, 16384
    s_cmp_eq_u32 s42, 98304
    s_cselect_b32 s42, 0, s42
    s_add_u32 m0, m0, 1024
    s_add_u32 s39, s39, s32
    buffer_load_dwordx4 v119, s[12:15], s39 offen lds
    s_add_u32 m0, m0, 1024
    s_add_u32 s39, s39, s32
    buffer_load_dwordx4 v120, s[12:15], s39 offen lds
    s_add_u32 m0, m0, 1024
    s_add_u32 s39, s39, s3
    buffer_load_dwordx4 v119, s[12:15], s39 offen lds
    s_add_u32 m0, m0, 1024
    s_add_u32 s39, s39, s32
    buffer_load_dwordx4 v120, s[12:15], s39 offen lds
    s_add_u32 m0, m0, 1024
    s_add_u32 s39, s39, s32
    buffer_load_dwordx4 v119, s[12:15], s39 offen lds
    s_add_u32 m0, m0, 1024
    s_add_u32 s39, s39, s32
    buffer_load_dwordx4 v120, s[12:15], s39 offen lds
    s_mov_b32 m0, s19
    s_mov_b32 s39, s16
    s_mov_b32 s32, s17
    s_mov_b32 s3, s18
    s_waitcnt vmcnt(8)
    s_barrier
    buffer_load_dwordx4 v119, s[12:15], s39 offen lds
    s_add_u32 m0, m0, 1024
    s_add_u32 s39, s39, s32
    buffer_load_dwordx4 v120, s[12:15], s39 offen lds
    s_add_u32 s43, s43, 1
    s_cmp_lt_u32 s43, 21
    s_cbranch_scc1 ld_83
    s_call_b64 s[76:77], PREP_w_issue_4
    s_add_u32 m0, m0, 1024
    s_add_u32 s39, s39, s32
    buffer_load_dwordx4 v119, s[12:15], s39 offen lds
    s_add_u32 m0, m0, 1024
    s_add_u32 s39, s39, s32
    buffer_load_dwordx4 v120, s[12:15], s39 offen lds
    s_add_u32 m0, m0, 1024
    s_add_u32 s39, s39, s3
    buffer_load_dwordx4 v119, s[12:15], s39 offen lds
    s_add_u32 m0, m0, 1024
    s_add_u32 s39, s39, s32
    buffer_load_dwordx4 v120, s[12:15], s39 offen lds
    s_add_u32 m0, m0, 1024
    s_add_u32 s39, s39, s32
    buffer_load_dwordx4 v119, s[12:15], s39 offen lds
    s_add_u32 m0, m0, 1024
    s_add_u32 s39, s39, s32
    buffer_load_dwordx4 v120, s[12:15], s39 offen lds
    s_mov_b32 m0, s19
    s_mov_b32 s39, s16
    s_mov_b32 s32, s17
    s_mov_b32 s3, s18
    s_waitcnt vmcnt(8)
    s_barrier
    buffer_load_dwordx4 v119, s[12:15], s39 offen lds
    s_add_u32 m0, m0, 1024
    s_add_u32 s39, s39, s32
    buffer_load_dwordx4 v120, s[12:15], s39 offen lds
    s_add_u32 m0, m0, 1024
    s_add_u32 s39, s39, s32
    buffer_load_dwordx4 v119, s[12:15], s39 offen lds
    s_add_u32 m0, m0, 1024
    s_add_u32 s39, s39, s32
    buffer_load_dwordx4 v120, s[12:15], s39 offen lds
    s_add_u32 m0, m0, 1024
    s_add_u32 s39, s39, s3
    buffer_load_dwordx4 v119, s[12:15], s39 offen lds
    s_add_u32 m0, m0, 1024
    s_add_u32 s39, s39, s32
    buffer_load_dwordx4 v120, s[12:15], s39 offen lds
    s_add_u32 m0, m0, 1024
    s_add_u32 s39, s39, s32
    buffer_load_dwordx4 v119, s[12:15], s39 offen lds
    s_add_u32 m0, m0, 1024
    s_add_u32 s39, s39, s32
    buffer_load_dwordx4 v120, s[12:15], s39 offen lds
    s_waitcnt vmcnt(8)
    s_barrier
    s_waitcnt vmcnt(0)
    s_barrier
    s_branch K_fin
NEXT:
    s_setprio 0
    s_add_u32 s60, s60, 1
    s_add_u32 s55, s55, 67108864
    s_add_u32 s62, s62, 67108864
    s_addc_u32 s63, s63, 0
    s_branch LAYER
K_fin:
    s_endpgm
SUB_w3_sub_3:
    s_mov_b64 s[8:9], s[72:73]
    s_mov_b32 s10, 7340032
    s_mov_b32 s11, 0x20000
    s_add_u32 s36, s29, s88
    s_and_b32 s36, s36, 15
    s_cmp_lg_u32 s28, s29
    s_cselect_b32 s89, s88, 0
    s_cmp_eq_u32 s89, 1
    s_cselect_b32 s36, s28, s36
    s_and_b32 s89, s30, 3
    s_lshl2_add_u32 s36, s36, s89
    s_mul_i32 s90, s36, 114688
    s_mul_i32 s36, s29, 448
    s_add_u32 s90, s90, s36
    s_lshl2_add_u32 s89, s88, s89
    s_mul_i32 s89, s89, 7168
    s_add_u32 m0, s89, 49152
    s_nop 0
    buffer_load_dwordx4 v121, s[8:11], s90 offen lds
    s_add_u32 m0, m0, 1024
    s_nop 0
    buffer_load_dwordx4 v122, s[8:11], s90 offen lds
    s_add_u32 m0, m0, 1024
    s_nop 0
    buffer_load_dwordx4 v123, s[8:11], s90 offen lds
    s_add_u32 m0, m0, 1024
    s_nop 0
    buffer_load_dwordx4 v124, s[8:11], s90 offen lds
    s_add_u32 m0, m0, 1024
    s_nop 0
    buffer_load_dwordx4 v125, s[8:11], s90 offen lds
    s_add_u32 m0, m0, 1024
    s_nop 0
    buffer_load_dwordx4 v126, s[8:11], s90 offen lds
    s_add_u32 m0, m0, 1024
    s_nop 0
    buffer_load_dwordx4 v127, s[8:11], s90 offen lds
    s_setpc_b64 s[76:77]
PREP_a_issue_3:
    s_add_u32 s19, s41, s42
    s_cmp_eq_u32 s44, s47
    s_cselect_b32 s16, s46, s44
    s_cmp_eq_u32 s44, s46
    s_cselect_b32 s16, s47, s16
    s_lshr_b32 s45, s16, 2
    s_lshl_b32 s45, s45, 14
    s_and_b32 s16, s16, 3
    s_lshl_b32 s16, s16, 11
    s_add_u32 s16, s16, s45
    s_add_u32 s16, s16, s38
    s_add_u32 s44, s44, 1
    s_and_b32 s44, s44, 15
    s_add_u32 s42, s42, 16384
    s_cmp_eq_u32 s42, 49152
    s_cselect_b32 s42, 0, s42
    s_setpc_b64 s[76:77]
SUB_rest_2:
    v_lshlrev_b32 v108, 16, v20
    v_and_b32 v109, 0xffff0000, v20
    v_lshlrev_b32 v110, 16, v21
    v_and_b32 v111, 0xffff0000, v21
    v_lshlrev_b32 v112, 16, v22
    v_and_b32 v113, 0xffff0000, v22
    v_lshlrev_b32 v114, 16, v23
    v_and_b32 v115, 0xffff0000, v23
    v_pk_add_f32 v[24:25], v[108:109], v[110:111]
    v_pk_mul_f32 v[26:27], v[108:109], v[108:109]
    v_pk_fma_f32 v[26:27], v[110:111], v[110:111], v[26:27]
    v_pk_add_f32 v[24:25], v[24:25], v[112:113]
    v_pk_fma_f32 v[26:27], v[112:113], v[112:113], v[26:27]
    v_pk_add_f32 v[24:25], v[24:25], v[114:115]
    v_pk_fma_f32 v[26:27], v[114:115], v[114:115], v[26:27]
    v_add_f32 v100, v24, v25
    v_add_f32 v101, v26, v27
    v_lshlrev_b32 v108, 16, v28
    v_and_b32 v109, 0xffff0000, v28
    v_lshlrev_b32 v110, 16, v29
    v_and_b32 v111, 0xffff0000, v29
    v_lshlrev_b32 v112, 16, v30
    v_and_b32 v113, 0xffff0000, v30
    v_lshlrev_b32 v114, 16, v31
    v_and_b32 v115, 0xffff0000, v31
    v_pk_add_f32 v[32:33], v[108:109], v[110:111]
    v_pk_mul_f32 v[34:35], v[108:109], v[108:109]
    v_pk_fma_f32 v[34:35], v[110:111], v[110:111], v[34:35]
    v_pk_add_f32 v[32:33], v[32:33], v[112:113]
    v_pk_fma_f32 v[34:35], v[112:113], v[112:113], v[34:35]
    v_pk_add_f32 v[32:33], v[32:33], v[114:115]
    v_pk_fma_f32 v[34:35], v[114:115], v[114:115], v[34:35]
    v_add_f32 v102, v32, v33
    v_add_f32 v103, v34, v35
    v_lshlrev_b32 v108, 16, v36
    v_and_b32 v109, 0xffff0000, v36
    v_lshlrev_b32 v110, 16, v37
    v_and_b32 v111, 0xffff0000, v37
    v_lshlrev_b32 v112, 16, v38
    v_and_b32 v113, 0xffff0000, v38
    v_lshlrev_b32 v114, 16, v39
    v_and_b32 v115, 0xffff0000, v39
    v_pk_add_f32 v[40:41], v[108:109], v[110:111]
    v_pk_mul_f32 v[42:43], v[108:109], v[108:109]
    v_pk_fma_f32 v[42:43], v[110:111], v[110:111], v[42:43]
    v_pk_add_f32 v[40:41], v[40:41], v[112:113]
    v_pk_fma_f32 v[42:43], v[112:113], v[112:113], v[42:43]
    v_pk_add_f32 v[40:41], v[40:41], v[114:115]
    v_pk_fma_f32 v[42:43], v[114:115], v[114:115], v[42:43]
    v_add_f32 v104, v40, v41
    v_add_f32 v105, v42, v43
    v_lshlrev_b32 v108, 16, v44
    v_and_b32 v109, 0xffff0000, v44
    v_lshlrev_b32 v110, 16, v45
    v_and_b32 v111, 0xffff0000, v45
    v_lshlrev_b32 v112, 16, v46
    v_and_b32 v113, 0xffff0000, v46
    v_lshlrev_b32 v114, 16, v47
    v_and_b32 v115, 0xffff0000, v47
    v_pk_add_f32 v[48:49], v[108:109], v[110:111]
    v_pk_mul_f32 v[50:51], v[108:109], v[108:109]
    v_pk_fma_f32 v[50:51], v[110:111], v[110:111], v[50:51]
    v_pk_add_f32 v[48:49], v[48:49], v[112:113]
    v_pk_fma_f32 v[50:51], v[112:113], v[112:113], v[50:51]
    v_pk_add_f32 v[48:49], v[48:49], v[114:115]
    v_pk_fma_f32 v[50:51], v[114:115], v[114:115], v[50:51]
    v_add_f32 v106, v48, v49
    v_add_f32 v107, v50, v51
    s_and_b32 s36, s30, 3
    s_lshl_b32 s36, s36, 10
    s_add_u32 s36, s36, 155648
    v_lshlrev_b32 v6, 3, v1
    v_add_u32 v6, s36, v6
    v_permlane32_swap_b32 v100, v102
    v_permlane32_swap_b32 v104, v106
    v_permlane32_swap_b32 v101, v103
    v_permlane32_swap_b32 v105, v107
    v_pk_add_f32 v[100:101], v[100:101], v[102:103]
    v_pk_add_f32 v[104:105], v[104:105], v[106:107]
    ds_write_b64 v6, v[100:101] offset:0
    ds_write_b64 v6, v[104:105] offset:512
    s_setpc_b64 s[76:77]
PREP_a_issue_4:
    s_add_u32 s19, s41, s42
    s_lshl_b32 s45, s44, 1
    s_add_u32 s45, s45, 0
    s_sub_u32 s45, s45, 32
    s_mul_i32 s46, s45, 86
    s_lshr_b32 s46, s46, 8
    s_mul_i32 s47, s46, 3
    s_sub_u32 s47, s45, s47
    s_lshl_b32 s47, s47, 2
    s_lshr_b32 s47, 0x362, s47
    s_and_b32 s47, s47, 7
    s_cmp_ge_u32 s44, 10
    s_cselect_b32 s45, 9, 2
    s_cselect_b32 s51, 1, 0
    s_sub_u32 s45, s44, s45
    s_cmp_lt_u32 s44, 3
    s_cselect_b32 s45, 0, s45
    s_cselect_b32 s51, s44, s51
    s_lshl2_add_u32 s51, 0, s51
    s_cmp_lt_u32 s44, 17
    s_cselect_b32 s47, s51, s47
    s_cselect_b32 s46, s45, s46
    s_add_u32 s46, s46, s33
    s_and_b32 s46, s46, 7
    s_mul_i32 s46, s46, 7
    s_add_u32 s16, s46, s47
    s_lshr_b32 s53, s16, 3
    s_lshl_b32 s53, s53, 14
    s_and_b32 s16, s16, 7
    s_lshl_b32 s16, s16, 10
    s_add_u32 s16, s16, s53
    s_add_u32 s16, s16, s38
    s_lshl_b32 s45, s44, 1
    s_add_u32 s45, s45, 1
    s_sub_u32 s45, s45, 32
    s_mul_i32 s46, s45, 86
    s_lshr_b32 s46, s46, 8
    s_mul_i32 s47, s46, 3
    s_sub_u32 s47, s45, s47
    s_lshl_b32 s47, s47, 2
    s_lshr_b32 s47, 0x362, s47
    s_and_b32 s47, s47, 7
    s_cmp_ge_u32 s44, 10
    s_cselect_b32 s45, 9, 2
    s_cselect_b32 s51, 1, 0
    s_sub_u32 s45, s44, s45
    s_cmp_lt_u32 s44, 3
    s_cselect_b32 s45, 0, s45
    s_cselect_b32 s51, s44, s51
    s_lshl2_add_u32 s51, 1, s51
    s_cmp_lt_u32 s44, 17
    s_cselect_b32 s47, s51, s47
    s_cselect_b32 s46, s45, s46
    s_add_u32 s46, s46, s33
    s_and_b32 s46, s46, 7
    s_mul_i32 s46, s46, 7
    s_add_u32 s17, s46, s47
    s_lshr_b32 s53, s17, 3
    s_lshl_b32 s53, s53, 14
    s_and_b32 s17, s17, 7
    s_lshl_b32 s17, s17, 10
    s_add_u32 s17, s17, s53
    s_add_u32 s17, s17, s38
    s_add_u32 s44, s44, 1
    s_add_u32 s42, s42, 16384
    s_cmp_eq_u32 s42, 49152
    s_cselect_b32 s42, 0, s42
    s_setpc_b64 s[76:77]
PREP_w_issue_3:
    s_add_u32 s19, s41, s42
    s_cmp_eq_u32 s44, s47
    s_cselect_b32 s16, s46, s44
    s_mul_i32 s16, s16, 458752
    s_add_u32 s16, s16, s38
    s_add_u32 s44, s44, 1
    s_and_b32 s44, s44, 15
    s_add_u32 s42, s42, 28672
    s_cmp_eq_u32 s42, 86016
    s_cselect_b32 s42, 0, s42
    s_setpc_b64 s[76:77]
PREP_w_issue_4:
    s_add_u32 s19, s41, s42
    s_and_b32 s40, s30, 1
    s_lshl_b32 s45, s44, 1
    s_add_u32 s45, s45, s40
    s_sub_u32 s45, s45, 32
    s_mul_i32 s46, s45, 86
    s_lshr_b32 s46, s46, 8
    s_mul_i32 s47, s46, 3
    s_sub_u32 s47, s45, s47
    s_lshl_b32 s47, s47, 2
    s_lshr_b32 s47, 0x362, s47
    s_and_b32 s47, s47, 7
    s_cmp_ge_u32 s44, 10
    s_cselect_b32 s45, 9, 2
    s_cselect_b32 s51, 1, 0
    s_sub_u32 s45, s44, s45
    s_cmp_lt_u32 s44, 3
    s_cselect_b32 s45, 0, s45
    s_cselect_b32 s51, s44, s51
    s_lshl2_add_u32 s51, s40, s51
    s_cmp_lt_u32 s44, 17
    s_cselect_b32 s47, s51, s47
    s_cselect_b32 s46, s45, s46
    s_add_u32 s46, s46, s33
    s_and_b32 s46, s46, 7
    s_mul_i32 s46, s46, 7
    s_add_u32 s16, s46, s47
    s_mul_i32 s16, s16, 65536
    s_add_u32 s16, s16, s38
    s_cmp_eq_u32 s47, 3
    s_cselect_b32 s17, 8, 4
    s_cselect_b32 s18, -20, 4
    s_lshl_b32 s17, s17, 11
    s_lshl_b32 s18, s18, 11
    s_add_u32 s44, s44, 1
    s_add_u32 s42, s42, 16384
    s_cmp_eq_u32 s42, 98304
    s_cselect_b32 s42, 0, s42
    s_setpc_b64 s[76:77]
SUB_w_issue_1:
    s_add_u32 s19, s41, s42
    s_mul_i32 s16, s44, 131072
    s_add_u32 s16, s16, s38
    s_mov_b32 m0, s19
    s_mov_b32 s39, s16
    buffer_load_dwordx4 v118, s[12:15], s39 offen lds
    s_add_u32 m0, m0, 1024
    s_add_u32 s39, s39, 16384
    buffer_load_dwordx4 v118, s[12:15], s39 offen lds
    s_add_u32 m0, m0, 1024
    s_add_u32 s39, s39, 16384
    buffer_load_dwordx4 v118, s[12:15], s39 offen lds
    s_add_u32 m0, m0, 1024
    s_add_u32 s39, s39, 16384
    buffer_load_dwordx4 v118, s[12:15], s39 offen lds
    s_setpc_b64 s[76:77]
K_end:
    s_endpgm
.section .rodata,"a"
.p2align 6
.amdhsa_kernel interleave_layers__ssm_conv_h3__mixer_s_mlp__prompt_kernel
  .amdhsa_next_free_vgpr 256
  .amdhsa_next_free_sgpr 102
  .amdhsa_accum_offset 256
  .amdhsa_group_segment_fixed_size 0
  .amdhsa_kernarg_size 112
  .amdhsa_user_sgpr_count 2
  .amdhsa_user_sgpr_kernarg_segment_ptr 1
  .amdhsa_system_sgpr_workgroup_id_x 1
  .amdhsa_float_denorm_mode_32 3
.end_amdhsa_kernel
```

```asm
; @launch grid=(256,1,1) block=(512,1,1) lds=163840
.amdgcn_target "amdgcn-amd-amdhsa--gfx950"
.text
.globl interleave_layers__ssm_conv_h3__mixer_s_mlp__prompt_kernel
.p2align 8
.type interleave_layers__ssm_conv_h3__mixer_s_mlp__prompt_kernel,@function
interleave_layers__ssm_conv_h3__mixer_s_mlp__prompt_kernel:
    s_cmp_ge_u32 s2, 256
    s_cbranch_scc1 K_end
    s_load_dwordx8 s[8:15], s[0:1], 8
    s_load_dwordx2 s[6:7], s[0:1], 0
    s_load_dwordx8 s[68:75], s[0:1], 56
    s_load_dwordx2 s[4:5], s[0:1], 104
    s_load_dwordx2 s[84:85], s[0:1], 96
    s_memrealtime s[46:47]
    v_lshrrev_b32 v1, 6, v0
    s_nop 0
    v_readfirstlane_b32 s30, v1
    s_getpc_b64 s[48:49]
K_pc:
    s_lshr_b32 s36, s2, 3
    s_lshl_b32 s36, s36, 12
    v_lshlrev_b32 v252, 3, v0
    v_add_u32 v252, s36, v252
    v_cmp_gt_u32 vcc, K_end-K_pc-8, v252
    s_nop 0
    s_and_saveexec_b64 s[36:37], vcc
    s_cbranch_execz K_3
    v_mov_b32 v253, s49
    v_add_co_u32 v252, vcc, s48, v252
    s_nop 1
    v_addc_co_u32 v253, vcc, 0, v253, vcc
    global_load_dword v250, v[252:253], off
K_3:
    s_mov_b64 exec, -1
    v_bfe_u32 v8, v0, 4, 2
    v_and_b32 v9, 15, v0
    v_lshlrev_b32 v6, 11, v8
    v_lshlrev_b32 v8, 1, v8
    v_xor_b32 v8, v8, v9
    v_lshl_add_u32 v8, v8, 4, v6
    s_and_b32 s34, s2, 7
    s_lshr_b32 s35, s2, 3
    s_lshl_b32 s36, s35, 17
    s_lshl_b32 s37, s34, 8
    s_add_u32 s36, s36, s37
    s_lshl_b32 s37, s30, 6
    s_and_b32 s38, s37, 128
    s_add_u32 s37, s37, 64
    s_and_b32 s37, s37, 128
    v_xor_b32 v6, s38, v8
    v_xor_b32 v7, s37, v8
    s_lshl_b32 s37, s30, 14
    s_add_u32 s37, s37, s36
    s_add_u32 s38, s37, 8192
    s_lshl_b32 s39, s30, 11
    s_mov_b32 s18, 4194304
    s_mov_b32 s19, 0x20000
    s_mov_b32 s22, s18
    s_mov_b32 s23, s19
    s_add_u32 m0, s39, 99328
    s_waitcnt lgkmcnt(0)
    s_mov_b64 s[16:17], s[8:9]
    s_mov_b64 s[20:21], s[10:11]
    buffer_load_dwordx4 v6, s[16:19], s37 offen nt lds
    s_add_u32 m0, m0, 1024
    s_nop 0
    buffer_load_dwordx4 v7, s[16:19], s38 offen nt lds
    s_add_u32 m0, s39, 115712
    s_nop 0
    buffer_load_dwordx4 v6, s[20:23], s37 offen nt lds
    s_add_u32 m0, m0, 1024
    s_nop 0
    buffer_load_dwordx4 v6, s[20:23], s38 offen nt lds
    s_mov_b32 s86, 256
    s_mov_b32 s87, 0x20000
    v_mov_b32 v10, 0
    s_cmp_lg_u32 s30, 0
    s_cbranch_scc1 KV_t0
    s_sub_u32 s36, s36, 8192
    v_add_u32 v8, s36, v8
    s_mov_b32 m0, 98304
    s_nop 0
    buffer_load_dwordx4 v8, s[16:19], 0 offen nt lds
    s_cmp_lg_u32 s2, 0
    s_cbranch_scc1 KV_t0
    s_lshl_b32 s44, s46, 6
    s_or_b32 s44, s44, 1
    v_mov_b32 v9, s44
    s_mov_b64 exec, 1
    buffer_store_dword v9, v10, s[84:87], 0 offen sc1
    s_mov_b64 exec, -1
KV_t0:
    s_lshl_b32 s37, s34, 10
    s_lshl_b32 s38, s30, 7
    s_add_u32 s37, s37, s38
    v_and_b32 v9, 15, v0
    v_lshlrev_b32 v9, 3, v9
    s_mov_b32 s24, s12
    s_mov_b32 s25, s13
    s_mov_b32 s26, 0x2000
    s_mov_b32 s27, 0x20000
    buffer_load_dwordx2 v[12:13], v9, s[24:27], s37 offen
    v_and_b32 v1, 63, v0
    v_lshlrev_b32 v2, 4, v1
    v_lshlrev_b32 v3, 2, v1
    s_and_b32 s32, s2, 7
    s_lshr_b32 s33, s2, 3
    s_and_b32 s28, s32, 2
    s_lshr_b32 s34, s32, 2
    s_or_b32 s28, s28, s34
    s_lshl_b32 s28, s28, 2
    s_and_b32 s34, s33, 3
    s_add_u32 s28, s28, s34
    s_and_b32 s31, s32, 1
    s_lshr_b32 s33, s33, 2
    s_lshl_b32 s29, s31, 3
    s_add_u32 s29, s29, s33
    s_and_b32 s67, s33, 4
    s_mov_b32 s60, 0
    s_mov_b32 s61, 40000
    s_mov_b32 s52, 0
    s_mov_b32 s55, 0
    s_mov_b32 s92, 0
    s_mov_b32 s93, 0
    s_mov_b32 s94, 0
    s_mov_b32 s56, s4
    s_mov_b32 s57, s5
    s_mov_b32 s58, 0xa000000
    s_mov_b32 s59, 0x20000
    s_add_u32 s62, s4, 33554432
    s_addc_u32 s63, s5, 0
    s_cmp_lg_u32 s30, 4
    s_cbranch_scc1 HB_1
    v_add_u32 v14, 162816, v3
    ds_write_b32 v14, v10
HB_1:
    s_mov_b64 s[88:89], s[70:71]
    s_mov_b32 s90, 2097152
    s_mov_b32 s91, 0x20000
    s_lshl3_add_u32 s36, s2, s30
    s_lshl_b32 s36, s36, 10
    s_mov_b64 s[80:81], s[68:69]
    s_mov_b32 s82, 2097152
    s_mov_b32 s83, 0x20000
    s_mov_b32 s50, s36
    v_lshrrev_b32 v14, 3, v1
    v_lshlrev_b32 v118, 11, v14
    v_and_b32 v14, 6, v14
    v_and_b32 v15, 7, v1
    v_xor_b32 v14, v14, v15
    v_lshl_add_u32 v118, v14, 4, v118
    s_lshl_b32 s48, s29, 7
    s_lshl_b32 s36, s30, 14
    s_add_u32 s48, s48, s36
    s_lshl_b32 s49, s30, 10
    s_add_u32 s48, s48, 1048576
    s_and_b32 s41, s30, 3
    s_and_b32 s38, s2, 7
    s_lshl_b32 s38, s38, 5
    s_lshr_b32 s39, s2, 3
    s_add_u32 s38, s38, s39
    s_lshl_b32 s39, s38, 2
    s_add_u32 s39, s39, s41
    s_mul_i32 s40, s41, 24576
    s_lshl_b32 s36, s39, 12
    s_add_u32 s12, s14, s36
    s_addc_u32 s13, s15, 0
    s_mov_b32 s14, 4096
    s_mov_b32 s15, 0x20000
    s_lshr_b32 s45, s30, 2
    s_lshl_b32 s45, s45, 11
    s_add_u32 s36, s45, 0xffffffc0
    v_add_u32 v22, s36, v2
    v_add_u32 v23, 16, v22
    s_add_u32 s36, s45, 0x3c0
    v_add_u32 v24, s36, v2
    v_add_u32 v25, 16, v24
    s_mov_b32 s36, 4032
    v_add_u32 v26, s36, v2
    v_add_u32 v27, 16, v26
    v_add_u32 v19, s40, v2
    v_add_u32 v20, s45, v19
    s_load_dwordx2 s[34:35], s[0:1], 40
    s_lshl_b32 s36, s38, 14
    s_add_u32 s36, s36, 25165824
    s_add_u32 s20, s4, s36
    s_addc_u32 s21, s5, 0
    s_mov_b32 s22, 16384
    s_mov_b32 s23, 0x20000
    s_lshl_b32 s36, s30, 6
    v_add_u32 v216, 0, v1
    v_mul_u32_u24 v217, 171, v216
    v_lshrrev_b32 v217, 10, v217
    v_lshlrev_b32 v219, 8, v217
    v_mul_u32_u24 v217, 6, v217
    v_sub_u32 v216, v216, v217
    v_lshl_add_u32 v219, v216, 4, v219
    v_and_b32 v216, 4, v216
    v_lshl_add_u32 v219, v216, 20, v219
    v_add_u32 v219, s36, v219
    v_add_u32 v216, 64, v1
    v_mul_u32_u24 v217, 171, v216
    v_lshrrev_b32 v217, 10, v217
    v_lshlrev_b32 v220, 8, v217
    v_mul_u32_u24 v217, 6, v217
    v_sub_u32 v216, v216, v217
    v_lshl_add_u32 v220, v216, 4, v220
    v_and_b32 v216, 4, v216
    v_lshl_add_u32 v220, v216, 20, v220
    v_add_u32 v220, s36, v220
    v_add_u32 v216, 128, v1
    v_mul_u32_u24 v217, 171, v216
    v_lshrrev_b32 v217, 10, v217
    v_lshlrev_b32 v221, 8, v217
    v_mul_u32_u24 v217, 6, v217
    v_sub_u32 v216, v216, v217
    v_lshl_add_u32 v221, v216, 4, v221
    v_and_b32 v216, 4, v216
    v_lshl_add_u32 v221, v216, 20, v221
    v_add_u32 v221, s36, v221
    s_waitcnt lgkmcnt(0)
    s_lshr_b32 s36, s39, 1
    s_lshl_b32 s36, s36, 2
    s_load_dword s41, s[34:35], s36
    v_and_b32 v224, 15, v1
    v_lshrrev_b32 v225, 4, v1
    v_and_b32 v216, 3, v224
    v_mul_u32_u24 v222, 4160, v216
    v_lshl_add_u32 v222, v225, 4, v222
    v_lshrrev_b32 v216, 2, v224
    v_lshl_add_u32 v222, v216, 3, v222
    v_add_u32 v222, s40, v222
    v_sub_u32 v216, 15, v224
    v_mul_u32_u24 v223, 96, v216
    v_add_u32 v223, s40, v223
    v_lshl_add_u32 v223, v225, 4, v223
    s_lshr_b32 s36, s38, 2
    s_lshl_b32 s36, s36, 12
    s_add_u32 s36, s36, 23330816
    v_lshlrev_b32 v226, 7, v1
    v_add_u32 v226, s36, v226
    v_lshrrev_b32 v14, 2, v1
    v_lshlrev_b32 v74, 7, v14
    v_bfe_u32 v14, v14, 1, 2
    s_and_b32 s35, s30, 2
    v_and_b32 v15, 1, v1
    v_or_b32 v15, s35, v15
    v_xor_b32 v14, v14, v15
    v_lshl_add_u32 v74, v14, 5, v74
    v_and_b32 v14, 2, v1
    v_lshl_add_u32 v74, v14, 2, v74
    s_and_b32 s35, s30, 1
    s_lshl_b32 s35, s35, 4
    s_add_u32 s35, s35, 24576
    v_add_u32 v74, s35, v74
    v_add_u32 v75, 65536, v74
    v_and_b32 v81, 7, v0
    v_lshrrev_b32 v84, 6, v0
    v_lshlrev_b32 v84, 4, v84
    v_bfe_u32 v85, v0, 3, 3
    v_add_u32 v84, v84, v85
    s_lshr_b32 s78, s29, 1
    s_lshl_b32 s78, s78, 16
    s_and_b32 s79, s29, 1
    s_lshl_b32 s79, s79, 7
    s_add_u32 s78, s78, s79
    s_lshr_b32 s79, s30, 1
    s_lshl_b32 s79, s79, 13
    s_add_u32 s78, s78, s79
    v_lshlrev_b32 v78, 8, v84
    v_lshl_add_u32 v78, v81, 4, v78
    v_add_u32 v78, s78, v78
    s_lshl_b32 s78, s28, 7
    s_lshl_b32 s79, s29, 3
    s_add_u32 s78, s78, s79
    v_add_u32 v79, s78, v81
    v_lshlrev_b32 v80, 11, v79
    v_and_b32 v85, 3, v79
    v_lshrrev_b32 v82, 2, v79
    v_lshlrev_b32 v82, 14, v82
    v_lshl_add_u32 v82, v85, 11, v82
    v_lshl_add_u32 v82, v84, 4, v82
    v_lshrrev_b32 v85, 2, v84
    v_lshlrev_b32 v85, 3, v85
    v_and_b32 v84, 3, v84
    v_add_u32 v84, v84, v85
    v_lshl_add_u32 v80, v84, 3, v80
    v_lshlrev_b32 v79, 3, v79
    v_lshl_add_u32 v79, v84, 14, v79
    v_lshrrev_b32 v14, 4, v1
    v_lshlrev_b32 v119, 11, v14
    v_add_u32 v14, 0, v14
    v_lshlrev_b32 v14, 1, v14
    v_and_b32 v15, 15, v1
    v_xor_b32 v14, v14, v15
    v_lshl_add_u32 v119, v14, 4, v119
    v_lshrrev_b32 v14, 4, v1
    v_lshlrev_b32 v120, 11, v14
    v_add_u32 v14, 4, v14
    v_lshlrev_b32 v14, 1, v14
    v_and_b32 v15, 15, v1
    v_xor_b32 v14, v14, v15
    v_lshl_add_u32 v120, v14, 4, v120
    v_add_u32 v15, 0, v1
    v_mul_u32_u24 v14, 2341, v15
    v_lshrrev_b32 v14, 16, v14
    v_mul_u32_u24 v121, 28, v14
    v_sub_u32 v15, v15, v121
    v_mul_u32_u24 v121, 7168, v14
    v_lshrrev_b32 v14, 1, v14
    v_and_b32 v14, 2, v14
    v_xor_b32 v15, v15, v14
    v_lshl_add_u32 v121, v15, 4, v121
    v_add_u32 v15, 64, v1
    v_mul_u32_u24 v14, 2341, v15
    v_lshrrev_b32 v14, 16, v14
    v_mul_u32_u24 v122, 28, v14
    v_sub_u32 v15, v15, v122
    v_mul_u32_u24 v122, 7168, v14
    v_lshrrev_b32 v14, 1, v14
    v_and_b32 v14, 2, v14
    v_xor_b32 v15, v15, v14
    v_lshl_add_u32 v122, v15, 4, v122
    v_add_u32 v15, 128, v1
    v_mul_u32_u24 v14, 2341, v15
    v_lshrrev_b32 v14, 16, v14
    v_mul_u32_u24 v123, 28, v14
    v_sub_u32 v15, v15, v123
    v_mul_u32_u24 v123, 7168, v14
    v_lshrrev_b32 v14, 1, v14
    v_and_b32 v14, 2, v14
    v_xor_b32 v15, v15, v14
    v_lshl_add_u32 v123, v15, 4, v123
    v_add_u32 v15, 192, v1
    v_mul_u32_u24 v14, 2341, v15
    v_lshrrev_b32 v14, 16, v14
    v_mul_u32_u24 v124, 28, v14
    v_sub_u32 v15, v15, v124
    v_mul_u32_u24 v124, 7168, v14
    v_lshrrev_b32 v14, 1, v14
    v_and_b32 v14, 2, v14
    v_xor_b32 v15, v15, v14
    v_lshl_add_u32 v124, v15, 4, v124
    v_add_u32 v15, 256, v1
    v_mul_u32_u24 v14, 2341, v15
    v_lshrrev_b32 v14, 16, v14
    v_mul_u32_u24 v125, 28, v14
    v_sub_u32 v15, v15, v125
    v_mul_u32_u24 v125, 7168, v14
    v_lshrrev_b32 v14, 1, v14
    v_and_b32 v14, 2, v14
    v_xor_b32 v15, v15, v14
    v_lshl_add_u32 v125, v15, 4, v125
    v_add_u32 v15, 320, v1
    v_mul_u32_u24 v14, 2341, v15
    v_lshrrev_b32 v14, 16, v14
    v_mul_u32_u24 v126, 28, v14
    v_sub_u32 v15, v15, v126
    v_mul_u32_u24 v126, 7168, v14
    v_lshrrev_b32 v14, 1, v14
    v_and_b32 v14, 2, v14
    v_xor_b32 v15, v15, v14
    v_lshl_add_u32 v126, v15, 4, v126
    v_add_u32 v15, 384, v1
    v_mul_u32_u24 v14, 2341, v15
    v_lshrrev_b32 v14, 16, v14
    v_mul_u32_u24 v127, 28, v14
    v_sub_u32 v15, v15, v127
    v_mul_u32_u24 v127, 7168, v14
    v_lshrrev_b32 v14, 1, v14
    v_and_b32 v14, 2, v14
    v_xor_b32 v15, v15, v14
    v_lshl_add_u32 v127, v15, 4, v127
    buffer_load_dwordx4 v[28:31], v22, s[12:15], 0 offen nt
    buffer_load_dwordx2 v[32:33], v23, s[12:15], 0 offen nt
    buffer_load_dwordx4 v[34:37], v24, s[12:15], 0 offen nt
    buffer_load_dwordx2 v[38:39], v25, s[12:15], 0 offen nt
    buffer_load_dwordx4 v[40:43], v26, s[12:15], 0 offen nt
    buffer_load_dwordx2 v[44:45], v27, s[12:15], 0 offen nt
    buffer_load_dwordx4 v[240:243], v2, s[88:91], s50 offen
    buffer_load_dwordx4 v[240:243], v2, s[80:83], s50 offen
    s_waitcnt lgkmcnt(0)
    s_bitcmp1_b32 s39, 0
    s_cselect_b32 s36, 0, 16
    s_lshl_b32 s41, s41, s36
    s_and_b32 s41, s41, 0xffff0000
    s_lshr_b32 s42, s41, 16
    v_lshl_add_u32 v216, v225, 3, v224
    v_sub_u32 v216, 31, v216
    v_and_b32 v217, 1, v216
    v_cmp_eq_u32 vcc, 1, v217
    v_mov_b32 v217, s42
    v_mov_b32 v218, s41
    v_cndmask_b32 v217, v217, v218, vcc
    v_ashrrev_i32 v216, 1, v216
    v_cmp_eq_u32 vcc, 0, v216
    s_nop 1
    v_cndmask_b32 v228, 0, v217, vcc
    v_cmp_eq_u32 vcc, 1, v216
    s_nop 1
    v_cndmask_b32 v229, 0, v217, vcc
    v_cmp_eq_u32 vcc, 2, v216
    s_nop 1
    v_cndmask_b32 v230, 0, v217, vcc
    v_cmp_eq_u32 vcc, 3, v216
    s_nop 1
    v_cndmask_b32 v231, 0, v217, vcc
    v_cmp_eq_u32 vcc, 8, v216
    s_nop 1
    v_cndmask_b32 v232, 0, v217, vcc
    v_cmp_eq_u32 vcc, 9, v216
    s_nop 1
    v_cndmask_b32 v233, 0, v217, vcc
    v_cmp_eq_u32 vcc, 10, v216
    s_nop 1
    v_cndmask_b32 v234, 0, v217, vcc
    v_cmp_eq_u32 vcc, 11, v216
    s_nop 1
    v_cndmask_b32 v235, 0, v217, vcc
    s_mov_b32 s8, s6
    s_mov_b32 s9, s7
    s_mov_b32 s10, 0x400000
    s_mov_b32 s11, 0x20000
    v_mov_b32 v60, 0
    v_mov_b32 v61, 0
    v_mov_b32 v62, 0
    v_mov_b32 v63, 0
    s_lshr_b32 s36, s30, 2
    s_mul_i32 s36, s36, 720
    v_add_u32 v14, s36, v19
    s_bfm_b64 exec, 45, 0
    ds_write_b128 v14, v[60:63] offset:22784
    s_mov_b64 exec, -1
    s_and_b32 s34, s2, 7
    s_lshr_b32 s35, s2, 3
    v_bfe_u32 v14, v1, 2, 3
    v_xor_b32 v14, s30, v14
    v_lshlrev_b32 v16, 5, v14
    v_and_b32 v14, 3, v1
    v_lshl_add_u32 v16, v14, 3, v16
    v_bfe_u32 v14, v1, 2, 2
    v_lshl_add_u32 v16, v14, 8, v16
    v_lshrrev_b32 v14, 4, v1
    v_lshl_add_u32 v16, v14, 12, v16
    v_add_u32 v16, 98304, v16
    v_xor_b32 v17, 128, v16
    s_add_u32 s16, s4, 0x1800000
    s_addc_u32 s17, s5, 0
    s_mov_b32 s18, 0x400000
    s_mov_b32 s19, 0x20000
    v_bfe_u32 v18, v1, 2, 2
    v_lshlrev_b32 v18, 14, v18
    v_and_b32 v14, 3, v1
    v_lshl_add_u32 v18, v14, 6, v18
    v_bfe_u32 v14, v1, 4, 1
    v_lshrrev_b32 v15, 5, v1
    v_lshl_add_u32 v14, v14, 1, v15
    v_xor_b32 v14, 3, v14
    v_lshl_add_u32 v18, v14, 4, v18
    s_lshl3_add_u32 s42, s34, s30
    s_lshl_b32 s43, s42, 16
    s_sub_u32 s37, 31, s35
    s_lshl_b32 s37, s37, 9
    s_add_u32 s43, s43, s37
    s_lshl_b32 s44, s42, 5
    s_add_u32 s44, s44, s35
    s_lshl_b32 s44, s44, 7
    s_add_u32 s44, s44, 23330816
    s_waitcnt vmcnt(8) lgkmcnt(0)
    s_barrier
    ds_read_b64_tr_b16 v[128:129], v16 offset:0
    ds_read_b64_tr_b16 v[130:131], v16 offset:1024
    ds_read_b64_tr_b16 v[132:133], v16 offset:2048
    ds_read_b64_tr_b16 v[134:135], v16 offset:3072
    ds_read_b64_tr_b16 v[136:137], v17 offset:4096
    ds_read_b64_tr_b16 v[138:139], v16 offset:17408
    ds_read_b64_tr_b16 v[140:141], v16 offset:18432
    ds_read_b64_tr_b16 v[142:143], v16 offset:19456
    ds_read_b64_tr_b16 v[144:145], v16 offset:20480
    s_load_dword s52, s[84:85], 0
    v_lshlrev_b32 v46, 16, v12
    v_and_b32 v47, 0xffff0000, v12
    v_lshlrev_b32 v48, 16, v13
    v_and_b32 v49, 0xffff0000, v13
    s_waitcnt lgkmcnt(0)
    v_lshlrev_b32 v146, 16, v128
    v_and_b32 v147, 0xffff0000, v128
    v_lshlrev_b32 v148, 16, v129
    v_and_b32 v149, 0xffff0000, v129
    v_lshlrev_b32 v150, 16, v130
    v_and_b32 v151, 0xffff0000, v130
    v_lshlrev_b32 v152, 16, v131
    v_and_b32 v153, 0xffff0000, v131
    v_lshlrev_b32 v154, 16, v132
    v_and_b32 v155, 0xffff0000, v132
    v_lshlrev_b32 v156, 16, v133
    v_and_b32 v157, 0xffff0000, v133
    v_lshlrev_b32 v158, 16, v134
    v_and_b32 v159, 0xffff0000, v134
    v_lshlrev_b32 v160, 16, v135
    v_and_b32 v161, 0xffff0000, v135
    v_lshlrev_b32 v162, 16, v136
    v_and_b32 v163, 0xffff0000, v136
    v_lshlrev_b32 v164, 16, v137
    v_and_b32 v165, 0xffff0000, v137
    v_mul_f32 v166, v147, v49
    v_mul_f32 v167, v148, v49
    v_mul_f32 v168, v149, v49
    v_mul_f32 v169, v150, v49
    v_mul_f32 v170, v151, v49
    v_mul_f32 v171, v152, v49
    v_mul_f32 v172, v153, v49
    v_mul_f32 v173, v154, v49
    v_mul_f32 v174, v155, v49
    v_mul_f32 v175, v156, v49
    v_mul_f32 v176, v157, v49
    v_mul_f32 v177, v158, v49
    v_mul_f32 v178, v159, v49
    v_mul_f32 v179, v160, v49
    v_mul_f32 v180, v161, v49
    v_mul_f32 v181, v162, v49
    v_fmac_f32 v166, v148, v48
    v_fmac_f32 v167, v149, v48
    v_fmac_f32 v168, v150, v48
    v_fmac_f32 v169, v151, v48
    v_fmac_f32 v170, v152, v48
    v_fmac_f32 v171, v153, v48
    v_fmac_f32 v172, v154, v48
    v_fmac_f32 v173, v155, v48
    v_fmac_f32 v174, v156, v48
    v_fmac_f32 v175, v157, v48
    v_fmac_f32 v176, v158, v48
    v_fmac_f32 v177, v159, v48
    v_fmac_f32 v178, v160, v48
    v_fmac_f32 v179, v161, v48
    v_fmac_f32 v180, v162, v48
    v_fmac_f32 v181, v163, v48
    v_fmac_f32 v166, v149, v47
    v_fmac_f32 v167, v150, v47
    v_fmac_f32 v168, v151, v47
    v_fmac_f32 v169, v152, v47
    v_fmac_f32 v170, v153, v47
    v_fmac_f32 v171, v154, v47
    v_fmac_f32 v172, v155, v47
    v_fmac_f32 v173, v156, v47
    v_fmac_f32 v174, v157, v47
    v_fmac_f32 v175, v158, v47
    v_fmac_f32 v176, v159, v47
    v_fmac_f32 v177, v160, v47
    v_fmac_f32 v178, v161, v47
    v_fmac_f32 v179, v162, v47
    v_fmac_f32 v180, v163, v47
    v_fmac_f32 v181, v164, v47
    v_fmac_f32 v166, v150, v46
    v_fmac_f32 v167, v151, v46
    v_fmac_f32 v168, v152, v46
    v_fmac_f32 v169, v153, v46
    v_fmac_f32 v170, v154, v46
    v_fmac_f32 v171, v155, v46
    v_fmac_f32 v172, v156, v46
    v_fmac_f32 v173, v157, v46
    v_fmac_f32 v174, v158, v46
    v_fmac_f32 v175, v159, v46
    v_fmac_f32 v176, v160, v46
    v_fmac_f32 v177, v161, v46
    v_fmac_f32 v178, v162, v46
    v_fmac_f32 v179, v163, v46
    v_fmac_f32 v180, v164, v46
    v_fmac_f32 v181, v165, v46
    v_lshlrev_b32 v146, 16, v138
    v_and_b32 v147, 0xffff0000, v138
    v_lshlrev_b32 v148, 16, v139
    v_and_b32 v149, 0xffff0000, v139
    v_lshlrev_b32 v150, 16, v140
    v_and_b32 v151, 0xffff0000, v140
    v_lshlrev_b32 v152, 16, v141
    v_and_b32 v153, 0xffff0000, v141
    v_lshlrev_b32 v154, 16, v142
    v_and_b32 v155, 0xffff0000, v142
    v_lshlrev_b32 v156, 16, v143
    v_and_b32 v157, 0xffff0000, v143
    v_lshlrev_b32 v158, 16, v144
    v_and_b32 v159, 0xffff0000, v144
    v_lshlrev_b32 v160, 16, v145
    v_and_b32 v161, 0xffff0000, v145
    v_mul_f32 v166, v166, v146
    v_mul_f32 v167, v167, v147
    v_mul_f32 v168, v168, v148
    v_mul_f32 v169, v169, v149
    v_mul_f32 v170, v170, v150
    v_mul_f32 v171, v171, v151
    v_mul_f32 v172, v172, v152
    v_mul_f32 v173, v173, v153
    v_mul_f32 v174, v174, v154
    v_mul_f32 v175, v175, v155
    v_mul_f32 v176, v176, v156
    v_mul_f32 v177, v177, v157
    v_mul_f32 v178, v178, v158
    v_mul_f32 v179, v179, v159
    v_mul_f32 v180, v180, v160
    v_mul_f32 v181, v181, v161
    v_add_u32 v167, 0x10000, v167
    v_and_b32 v167, 0xfffe0000, v167
    v_add_u32 v169, 0x10000, v169
    v_and_b32 v169, 0xfffe0000, v169
    v_add_u32 v171, 0x10000, v171
    v_and_b32 v171, 0xfffe0000, v171
    v_add_u32 v173, 0x10000, v173
    v_and_b32 v173, 0xfffe0000, v173
    v_add_u32 v175, 0x10000, v175
    v_and_b32 v175, 0xfffe0000, v175
    v_add_u32 v177, 0x10000, v177
    v_and_b32 v177, 0xfffe0000, v177
    v_add_u32 v179, 0x10000, v179
    v_and_b32 v179, 0xfffe0000, v179
    v_add_u32 v181, 0x10000, v181
    v_and_b32 v181, 0xfffe0000, v181
    v_cvt_pk_bf16_f32 v52, v173, v172
    v_cvt_pk_bf16_f32 v53, v171, v170
    v_cvt_pk_bf16_f32 v54, v169, v168
    v_cvt_pk_bf16_f32 v55, v167, v166
    v_cvt_pk_bf16_f32 v56, v181, v180
    v_cvt_pk_bf16_f32 v57, v179, v178
    v_cvt_pk_bf16_f32 v58, v177, v176
    v_cvt_pk_bf16_f32 v59, v175, v174
    s_cmp_lg_u32 s52, 0
    s_cbranch_scc1 HB_q
    s_mov_b32 s53, 0
HB_p:
    buffer_load_dword v14, v10, s[84:87], 0 offen sc1
    s_waitcnt vmcnt(0)
    v_readfirstlane_b32 s52, v14
    s_nop 0
    s_cmp_lg_u32 s52, 0
    s_cbranch_scc1 HB_q
    s_add_u32 s53, s53, 1
    s_cmp_lt_u32 s53, s61
    s_cbranch_scc1 HB_p
    s_mov_b32 s52, 1
    s_mov_b32 s61, 0
HB_q:
    v_permlane32_swap_b32 v52, v56
    v_permlane32_swap_b32 v53, v57
    v_permlane32_swap_b32 v54, v58
    v_permlane32_swap_b32 v55, v59
    v_mov_b32 v14, s52
    buffer_store_dwordx4 v[52:55], v18, s[16:19], s43 offen offset:256 sc1
    buffer_store_dwordx4 v[56:59], v18, s[16:19], s43 offen offset:0 sc1
    s_lshl_b32 s37, s42, 7
    s_lshl_b32 s53, s35, 13
    s_add_u32 s37, s37, s53
    s_add_u32 s37, s37, 23592960
    s_cmp_ge_u32 s35, 16
    s_cbranch_scc1 KV_ni
    s_mov_b64 exec, 1
    buffer_store_dword v14, v10, s[56:59], s37 offen sc1
    s_mov_b64 exec, -1
KV_ni:
    s_waitcnt vmcnt(4)
    v_alignbit_b32 v128, v29, v28, 16
    v_mov_b32 v132, v29
    v_alignbit_b32 v136, v30, v29, 16
    v_alignbit_b32 v129, v30, v29, 16
    v_mov_b32 v133, v30
    v_alignbit_b32 v137, v31, v30, 16
    v_alignbit_b32 v130, v31, v30, 16
    v_mov_b32 v134, v31
    v_alignbit_b32 v138, v32, v31, 16
    v_alignbit_b32 v131, v32, v31, 16
    v_mov_b32 v135, v32
    v_alignbit_b32 v139, v33, v32, 16
    ds_write_b128 v20, v[128:131] offset:0
    ds_write_b128 v20, v[132:135] offset:4160
    ds_write_b128 v20, v[136:139] offset:8320
    ds_write_b128 v20, v[30:33] offset:12480
    s_waitcnt vmcnt(0)
    s_mov_b64 exec, 1
    buffer_store_dword v14, v10, s[56:59], s44 offen sc1
    s_mov_b64 exec, -1
    v_alignbit_b32 v140, v35, v34, 16
    v_mov_b32 v144, v35
    v_alignbit_b32 v148, v36, v35, 16
    v_alignbit_b32 v141, v36, v35, 16
    v_mov_b32 v145, v36
    v_alignbit_b32 v149, v37, v36, 16
    v_alignbit_b32 v142, v37, v36, 16
    v_mov_b32 v146, v37
    v_alignbit_b32 v150, v38, v37, 16
    v_alignbit_b32 v143, v38, v37, 16
    v_mov_b32 v147, v38
    v_alignbit_b32 v151, v39, v38, 16
    ds_write_b128 v20, v[140:143] offset:1024
    ds_write_b128 v20, v[144:147] offset:5184
    ds_write_b128 v20, v[148:151] offset:9344
    ds_write_b128 v20, v[36:39] offset:13504
    v_alignbit_b32 v152, v41, v40, 16
    v_mov_b32 v156, v41
    v_alignbit_b32 v160, v42, v41, 16
    v_alignbit_b32 v153, v42, v41, 16
    v_mov_b32 v157, v42
    v_alignbit_b32 v161, v43, v42, 16
    v_alignbit_b32 v154, v43, v42, 16
    v_mov_b32 v158, v43
    v_alignbit_b32 v162, v44, v43, 16
    v_alignbit_b32 v155, v44, v43, 16
    v_mov_b32 v159, v44
    v_alignbit_b32 v163, v45, v44, 16
    s_mov_b64 exec, 0xf
    ds_write_b128 v19, v[152:155] offset:4096
    ds_write_b128 v19, v[156:159] offset:8256
    ds_write_b128 v19, v[160:163] offset:12416
    ds_write_b128 v19, v[42:45] offset:16576
    s_mov_b64 exec, -1
    s_waitcnt lgkmcnt(0)
    s_barrier
    s_add_u32 s36, s67, 1
    s_and_b32 s36, s36, 7
    s_lshl_b32 s36, s36, 17
    s_add_u32 s36, s36, s48
    s_add_u32 m0, s49, 98304
    s_nop 0
    buffer_load_dwordx4 v118, s[88:91], s36 offen lds
    s_add_u32 s36, s67, 2
    s_and_b32 s36, s36, 7
    s_lshl_b32 s36, s36, 17
    s_add_u32 s36, s36, s48
    s_add_u32 m0, s49, 106496
    s_nop 0
    buffer_load_dwordx4 v118, s[88:91], s36 offen lds
    s_add_u32 s36, s67, 3
    s_and_b32 s36, s36, 7
    s_lshl_b32 s36, s36, 17
    s_add_u32 s36, s36, s48
    s_add_u32 m0, s49, 114688
    s_nop 0
    buffer_load_dwordx4 v118, s[88:91], s36 offen lds
    s_add_u32 s36, s67, 4
    s_and_b32 s36, s36, 7
    s_lshl_b32 s36, s36, 17
    s_add_u32 s36, s36, s48
    s_add_u32 m0, s49, 122880
    s_nop 0
    buffer_load_dwordx4 v118, s[88:91], s36 offen lds
    s_add_u32 s36, s67, 5
    s_and_b32 s36, s36, 7
    s_lshl_b32 s36, s36, 17
    s_add_u32 s36, s36, s48
    s_add_u32 m0, s49, 131072
    s_nop 0
    buffer_load_dwordx4 v118, s[88:91], s36 offen lds
    s_add_u32 s36, s67, 6
    s_and_b32 s36, s36, 7
    s_lshl_b32 s36, s36, 17
    s_add_u32 s36, s36, s48
    s_add_u32 m0, s49, 139264
    s_nop 0
    buffer_load_dwordx4 v118, s[88:91], s36 offen lds
    s_add_u32 s36, s67, 7
    s_and_b32 s36, s36, 7
    s_lshl_b32 s36, s36, 17
    s_add_u32 s36, s36, s48
    s_add_u32 m0, s49, 147456
    s_nop 0
    buffer_load_dwordx4 v118, s[88:91], s36 offen lds
    s_cmp_ge_u32 s30, 4
    s_cbranch_scc1 FR_b
    s_cmp_lg_u32 s30, 0
    s_cbranch_scc1 CV_w
    s_mov_b32 s53, 0
    s_add_u32 s54, s52, 0
    s_bfm_b64 exec, 32, 0
poll_1:
    buffer_load_dword v8, v226, s[56:59], 0 offen sc1
    s_waitcnt vmcnt(0)
    v_cmp_eq_u32 vcc, s54, v8
    s_nop 0
    s_cmp_eq_u64 vcc, exec
    s_cbranch_scc1 pok_2
    s_sleep 5
    s_add_u32 s53, s53, 1
    s_cmp_lt_u32 s53, s61
    s_cbranch_scc1 poll_1
    s_mov_b32 s61, 0
pok_2:
    s_mov_b64 exec, -1
    v_mov_b32 v8, 162832
    v_mov_b32 v9, 1
    s_waitcnt lgkmcnt(0)
    ds_write_b32 v8, v9
CV_w:
    s_add_u32 m0, s40, 16640
    s_movk_i32 s36, 8192
    v_mov_b32 v8, 162832
spin_3:
    ds_read_b32 v9, v8
    s_waitcnt lgkmcnt(0)
    v_readfirstlane_b32 s53, v9
    s_nop 0
    s_cmp_ge_u32 s53, 1
    s_cbranch_scc0 spin_3
    buffer_load_dwordx4 v219, s[20:23], 0 offen sc1 lds
    s_add_u32 m0, m0, 1024
    s_nop 0
    buffer_load_dwordx4 v220, s[20:23], 0 offen sc1 lds
    s_add_u32 m0, m0, 1024
    s_nop 0
    buffer_load_dwordx4 v221, s[20:23], 0 offen sc1 lds
    s_add_u32 m0, m0, 1024
    s_nop 0
    buffer_load_dwordx4 v219, s[20:23], s36 offen sc1 lds
    s_add_u32 m0, m0, 1024
    s_nop 0
    buffer_load_dwordx4 v220, s[20:23], s36 offen sc1 lds
    s_add_u32 m0, m0, 1024
    s_nop 0
    buffer_load_dwordx4 v221, s[20:23], s36 offen sc1 lds
    s_waitcnt vmcnt(0)
    s_barrier
    buffer_load_dwordx2 v[86:87], v80, s[8:11], 0 offen offset:0 nt
    buffer_load_dwordx2 v[88:89], v80, s[8:11], 0 offen offset:32 nt
    buffer_load_dwordx2 v[90:91], v80, s[8:11], 0 offen offset:128 nt
    buffer_load_dwordx2 v[92:93], v80, s[8:11], 0 offen offset:160 nt
    ds_read_b128 v[184:187], v223 offset:21248
    ds_read_b128 v[188:191], v223 offset:19712
    ds_read_b128 v[192:195], v223 offset:18176
    ds_read_b128 v[196:199], v223 offset:16640
    ds_read_b64 v[120:121], v222 offset:0
    ds_read_b64 v[122:123], v222 offset:8
    ds_read_b64 v[124:125], v222 offset:32
    ds_read_b64 v[126:127], v222 offset:40
    ds_read_b64 v[128:129], v222 offset:1024
    ds_read_b64 v[130:131], v222 offset:1032
    ds_read_b64 v[132:133], v222 offset:1056
    ds_read_b64 v[134:135], v222 offset:1064
    ds_read_b64 v[136:137], v222 offset:2048
    ds_read_b64 v[138:139], v222 offset:2056
    ds_read_b64 v[140:141], v222 offset:2080
    ds_read_b64 v[142:143], v222 offset:2088
    ds_read_b64 v[144:145], v222 offset:3072
    ds_read_b64 v[146:147], v222 offset:3080
    ds_read_b64 v[148:149], v222 offset:3104
    ds_read_b64 v[150:151], v222 offset:3112
    s_waitcnt lgkmcnt(15)
    v_mfma_f32_16x16x32_bf16 v[20:23], v[228:231], v[184:187], 0
    v_mfma_f32_16x16x32_bf16 v[24:27], v[232:235], v[184:187], 0
    v_mfma_f32_16x16x32_bf16 v[28:31], v[228:231], v[188:191], 0
    v_mfma_f32_16x16x32_bf16 v[32:35], v[232:235], v[188:191], 0
    v_mfma_f32_16x16x32_bf16 v[36:39], v[228:231], v[192:195], 0
    v_mfma_f32_16x16x32_bf16 v[40:43], v[232:235], v[192:195], 0
    v_mfma_f32_16x16x32_bf16 v[44:47], v[228:231], v[196:199], 0
    v_mfma_f32_16x16x32_bf16 v[48:51], v[232:235], v[196:199], 0
    s_mov_b32 s43, 0
CV_r:
    s_waitcnt lgkmcnt(0)
    v_mfma_f32_16x16x32_bf16 v[20:23], v[120:123], v[184:187], v[20:23]
    v_mfma_f32_16x16x32_bf16 v[28:31], v[120:123], v[188:191], v[28:31]
    v_mfma_f32_16x16x32_bf16 v[36:39], v[120:123], v[192:195], v[36:39]
    v_mfma_f32_16x16x32_bf16 v[44:47], v[120:123], v[196:199], v[44:47]
    v_mfma_f32_16x16x32_bf16 v[24:27], v[124:127], v[184:187], v[24:27]
    v_mfma_f32_16x16x32_bf16 v[32:35], v[124:127], v[188:191], v[32:35]
    v_mfma_f32_16x16x32_bf16 v[40:43], v[124:127], v[192:195], v[40:43]
    v_mfma_f32_16x16x32_bf16 v[48:51], v[124:127], v[196:199], v[48:51]
    v_mfma_f32_16x16x32_bf16 v[28:31], v[128:131], v[184:187], v[28:31]
    v_mfma_f32_16x16x32_bf16 v[36:39], v[128:131], v[188:191], v[36:39]
    v_mfma_f32_16x16x32_bf16 v[44:47], v[128:131], v[192:195], v[44:47]
    v_mfma_f32_16x16x32_bf16 v[32:35], v[132:135], v[184:187], v[32:35]
    v_mfma_f32_16x16x32_bf16 v[40:43], v[132:135], v[188:191], v[40:43]
    v_mfma_f32_16x16x32_bf16 v[48:51], v[132:135], v[192:195], v[48:51]
    v_mfma_f32_16x16x32_bf16 v[36:39], v[136:139], v[184:187], v[36:39]
    v_mfma_f32_16x16x32_bf16 v[44:47], v[136:139], v[188:191], v[44:47]
    v_mfma_f32_16x16x32_bf16 v[40:43], v[140:143], v[184:187], v[40:43]
    v_mfma_f32_16x16x32_bf16 v[48:51], v[140:143], v[188:191], v[48:51]
    v_mfma_f32_16x16x32_bf16 v[44:47], v[144:147], v[184:187], v[44:47]
    v_mfma_f32_16x16x32_bf16 v[48:51], v[148:151], v[184:187], v[48:51]
    ds_read_b128 v[200:203], v223 offset:21344
    ds_read_b128 v[204:207], v223 offset:19808
    ds_read_b128 v[208:211], v223 offset:18272
    ds_read_b128 v[212:215], v223 offset:16736
    ds_read_b64 v[152:153], v222 offset:64
    ds_read_b64 v[154:155], v222 offset:72
    ds_read_b64 v[156:157], v222 offset:96
    ds_read_b64 v[158:159], v222 offset:104
    ds_read_b64 v[160:161], v222 offset:1088
    ds_read_b64 v[162:163], v222 offset:1096
    ds_read_b64 v[164:165], v222 offset:1120
    ds_read_b64 v[166:167], v222 offset:1128
    ds_read_b64 v[168:169], v222 offset:2112
    ds_read_b64 v[170:171], v222 offset:2120
    ds_read_b64 v[172:173], v222 offset:2144
    ds_read_b64 v[174:175], v222 offset:2152
    ds_read_b64 v[176:177], v222 offset:3136
    ds_read_b64 v[178:179], v222 offset:3144
    ds_read_b64 v[180:181], v222 offset:3168
    ds_read_b64 v[182:183], v222 offset:3176
    s_waitcnt lgkmcnt(0)
    v_mfma_f32_16x16x32_bf16 v[20:23], v[152:155], v[200:203], v[20:23]
    v_mfma_f32_16x16x32_bf16 v[28:31], v[152:155], v[204:207], v[28:31]
    v_mfma_f32_16x16x32_bf16 v[36:39], v[152:155], v[208:211], v[36:39]
    v_mfma_f32_16x16x32_bf16 v[44:47], v[152:155], v[212:215], v[44:47]
    v_mfma_f32_16x16x32_bf16 v[24:27], v[156:159], v[200:203], v[24:27]
    v_mfma_f32_16x16x32_bf16 v[32:35], v[156:159], v[204:207], v[32:35]
    v_mfma_f32_16x16x32_bf16 v[40:43], v[156:159], v[208:211], v[40:43]
    v_mfma_f32_16x16x32_bf16 v[48:51], v[156:159], v[212:215], v[48:51]
    v_mfma_f32_16x16x32_bf16 v[28:31], v[160:163], v[200:203], v[28:31]
    v_mfma_f32_16x16x32_bf16 v[36:39], v[160:163], v[204:207], v[36:39]
    v_mfma_f32_16x16x32_bf16 v[44:47], v[160:163], v[208:211], v[44:47]
    v_mfma_f32_16x16x32_bf16 v[32:35], v[164:167], v[200:203], v[32:35]
    v_mfma_f32_16x16x32_bf16 v[40:43], v[164:167], v[204:207], v[40:43]
    v_mfma_f32_16x16x32_bf16 v[48:51], v[164:167], v[208:211], v[48:51]
    v_mfma_f32_16x16x32_bf16 v[36:39], v[168:171], v[200:203], v[36:39]
    v_mfma_f32_16x16x32_bf16 v[44:47], v[168:171], v[204:207], v[44:47]
    v_mfma_f32_16x16x32_bf16 v[40:43], v[172:175], v[200:203], v[40:43]
    v_mfma_f32_16x16x32_bf16 v[48:51], v[172:175], v[204:207], v[48:51]
    v_mfma_f32_16x16x32_bf16 v[44:47], v[176:179], v[200:203], v[44:47]
    v_mfma_f32_16x16x32_bf16 v[48:51], v[180:183], v[200:203], v[48:51]
    ds_read_b128 v[184:187], v223 offset:21440
    ds_read_b128 v[188:191], v223 offset:19904
    ds_read_b128 v[192:195], v223 offset:18368
    ds_read_b128 v[196:199], v223 offset:16832
    ds_read_b64 v[120:121], v222 offset:128
    ds_read_b64 v[122:123], v222 offset:136
    ds_read_b64 v[124:125], v222 offset:160
    ds_read_b64 v[126:127], v222 offset:168
    ds_read_b64 v[128:129], v222 offset:1152
    ds_read_b64 v[130:131], v222 offset:1160
    ds_read_b64 v[132:133], v222 offset:1184
    ds_read_b64 v[134:135], v222 offset:1192
    ds_read_b64 v[136:137], v222 offset:2176
    ds_read_b64 v[138:139], v222 offset:2184
    ds_read_b64 v[140:141], v222 offset:2208
    ds_read_b64 v[142:143], v222 offset:2216
    ds_read_b64 v[144:145], v222 offset:3200
    ds_read_b64 v[146:147], v222 offset:3208
    ds_read_b64 v[148:149], v222 offset:3232
    ds_read_b64 v[150:151], v222 offset:3240
    v_add_u32 v222, 128, v222
    v_add_u32 v223, 192, v223
    s_add_u32 s43, s43, 1
    s_cmp_lt_u32 s43, 3
    s_cbranch_scc1 CV_r
CV_l:
    s_waitcnt lgkmcnt(0)
    v_mfma_f32_16x16x32_bf16 v[20:23], v[120:123], v[184:187], v[20:23]
    ds_read_b128 v[200:203], v223 offset:21344
    ds_read_b128 v[204:207], v223 offset:19808
    v_mfma_f32_16x16x32_bf16 v[28:31], v[120:123], v[188:191], v[28:31]
    ds_read_b128 v[208:211], v223 offset:18272
    v_mfma_f32_16x16x32_bf16 v[36:39], v[120:123], v[192:195], v[36:39]
    ds_read_b128 v[212:215], v223 offset:16736
    v_mfma_f32_16x16x32_bf16 v[44:47], v[120:123], v[196:199], v[44:47]
    ds_read_b64 v[152:153], v222 offset:64
    ds_read_b64 v[154:155], v222 offset:72
    v_mfma_f32_16x16x32_bf16 v[24:27], v[124:127], v[184:187], v[24:27]
    ds_read_b64 v[156:157], v222 offset:96
    v_mfma_f32_16x16x32_bf16 v[32:35], v[124:127], v[188:191], v[32:35]
    ds_read_b64 v[158:159], v222 offset:104
    v_mfma_f32_16x16x32_bf16 v[40:43], v[124:127], v[192:195], v[40:43]
    ds_read_b64 v[160:161], v222 offset:1088
    ds_read_b64 v[162:163], v222 offset:1096
    v_mfma_f32_16x16x32_bf16 v[48:51], v[124:127], v[196:199], v[48:51]
    ds_read_b64 v[164:165], v222 offset:1120
    v_mfma_f32_16x16x32_bf16 v[28:31], v[128:131], v[184:187], v[28:31]
    ds_read_b64 v[166:167], v222 offset:1128
    v_mfma_f32_16x16x32_bf16 v[36:39], v[128:131], v[188:191], v[36:39]
    ds_read_b64 v[168:169], v222 offset:2112
    ds_read_b64 v[170:171], v222 offset:2120
    v_mfma_f32_16x16x32_bf16 v[44:47], v[128:131], v[192:195], v[44:47]
    ds_read_b64 v[172:173], v222 offset:2144
    v_mfma_f32_16x16x32_bf16 v[32:35], v[132:135], v[184:187], v[32:35]
    ds_read_b64 v[174:175], v222 offset:2152
    v_mfma_f32_16x16x32_bf16 v[40:43], v[132:135], v[188:191], v[40:43]
    ds_read_b64 v[176:177], v222 offset:3136
    ds_read_b64 v[178:179], v222 offset:3144
    v_mfma_f32_16x16x32_bf16 v[48:51], v[132:135], v[192:195], v[48:51]
    ds_read_b64 v[180:181], v222 offset:3168
    v_mfma_f32_16x16x32_bf16 v[36:39], v[136:139], v[184:187], v[36:39]
    ds_read_b64 v[182:183], v222 offset:3176
    v_mfma_f32_16x16x32_bf16 v[44:47], v[136:139], v[188:191], v[44:47]
    v_mfma_f32_16x16x32_bf16 v[40:43], v[140:143], v[184:187], v[40:43]
    v_mfma_f32_16x16x32_bf16 v[48:51], v[140:143], v[188:191], v[48:51]
    v_mfma_f32_16x16x32_bf16 v[44:47], v[144:147], v[184:187], v[44:47]
    v_mfma_f32_16x16x32_bf16 v[48:51], v[148:151], v[184:187], v[48:51]
    s_waitcnt lgkmcnt(0)
    v_mfma_f32_16x16x32_bf16 v[20:23], v[152:155], v[200:203], v[20:23]
    ds_read_b128 v[184:187], v223 offset:21440
    ds_read_b128 v[188:191], v223 offset:19904
    v_mfma_f32_16x16x32_bf16 v[28:31], v[152:155], v[204:207], v[28:31]
    ds_read_b128 v[192:195], v223 offset:18368
    v_mfma_f32_16x16x32_bf16 v[36:39], v[152:155], v[208:211], v[36:39]
    ds_read_b128 v[196:199], v223 offset:16832
    v_mfma_f32_16x16x32_bf16 v[44:47], v[152:155], v[212:215], v[44:47]
    ds_read_b64 v[120:121], v222 offset:128
    ds_read_b64 v[122:123], v222 offset:136
    v_mfma_f32_16x16x32_bf16 v[24:27], v[156:159], v[200:203], v[24:27]
    ds_read_b64 v[124:125], v222 offset:160
    v_mfma_f32_16x16x32_bf16 v[32:35], v[156:159], v[204:207], v[32:35]
    ds_read_b64 v[126:127], v222 offset:168
    v_mfma_f32_16x16x32_bf16 v[40:43], v[156:159], v[208:211], v[40:43]
    ds_read_b64 v[128:129], v222 offset:1152
    ds_read_b64 v[130:131], v222 offset:1160
    v_mfma_f32_16x16x32_bf16 v[48:51], v[156:159], v[212:215], v[48:51]
    ds_read_b64 v[132:133], v222 offset:1184
    v_mfma_f32_16x16x32_bf16 v[28:31], v[160:163], v[200:203], v[28:31]
    ds_read_b64 v[134:135], v222 offset:1192
    v_mfma_f32_16x16x32_bf16 v[36:39], v[160:163], v[204:207], v[36:39]
    ds_read_b64 v[136:137], v222 offset:2176
    ds_read_b64 v[138:139], v222 offset:2184
    v_mfma_f32_16x16x32_bf16 v[44:47], v[160:163], v[208:211], v[44:47]
    ds_read_b64 v[140:141], v222 offset:2208
    v_mfma_f32_16x16x32_bf16 v[32:35], v[164:167], v[200:203], v[32:35]
    ds_read_b64 v[142:143], v222 offset:2216
    v_mfma_f32_16x16x32_bf16 v[40:43], v[164:167], v[204:207], v[40:43]
    ds_read_b64 v[144:145], v222 offset:3200
    ds_read_b64 v[146:147], v222 offset:3208
    v_mfma_f32_16x16x32_bf16 v[48:51], v[164:167], v[208:211], v[48:51]
    ds_read_b64 v[148:149], v222 offset:3232
    v_mfma_f32_16x16x32_bf16 v[36:39], v[168:171], v[200:203], v[36:39]
    ds_read_b64 v[150:151], v222 offset:3240
    v_mfma_f32_16x16x32_bf16 v[44:47], v[168:171], v[204:207], v[44:47]
    v_add_u32 v222, 128, v222
    v_add_u32 v223, 192, v223
    v_mfma_f32_16x16x32_bf16 v[40:43], v[172:175], v[200:203], v[40:43]
    s_add_u32 s43, s43, 1
    v_mfma_f32_16x16x32_bf16 v[48:51], v[172:175], v[204:207], v[48:51]
    s_cmp_lt_u32 s43, 8
    v_mfma_f32_16x16x32_bf16 v[44:47], v[176:179], v[200:203], v[44:47]
    v_mfma_f32_16x16x32_bf16 v[48:51], v[180:183], v[200:203], v[48:51]
    s_cbranch_scc1 CV_l
    s_mul_i32 s36, s30, 24640
    v_mul_u32_u24 v12, 72, v224
    v_lshl_add_u32 v12, v225, 2, v12
    v_add_u32 v12, s36, v12
    v_add_u32 v13, 1152, v12
    v_add_u32 v14, 2304, v12
    v_add_u32 v15, 3456, v12
    v_bfe_u32 v6, v1, 2, 2
    v_mul_u32_u24 v16, 24640, v6
    v_mul_u32_u24 v6, 72, v225
    v_add_u32 v16, v16, v6
    v_and_b32 v6, 3, v1
    v_lshl_add_u32 v16, v6, 3, v16
    s_mul_i32 s36, s30, 1152
    v_add_u32 v16, s36, v16
    s_waitcnt lgkmcnt(0)
    v_cvt_pk_bf16_f32 v20, v20, v22
    v_cvt_pk_bf16_f32 v21, v21, v23
    ds_write2_b32 v12, v20, v21 offset0:0 offset1:8
    v_cvt_pk_bf16_f32 v24, v24, v26
    v_cvt_pk_bf16_f32 v25, v25, v27
    ds_write2_b32 v12, v24, v25 offset0:4 offset1:12
    v_cvt_pk_bf16_f32 v28, v28, v30
    v_cvt_pk_bf16_f32 v29, v29, v31
    ds_write2_b32 v13, v28, v29 offset0:0 offset1:8
    v_cvt_pk_bf16_f32 v32, v32, v34
    v_cvt_pk_bf16_f32 v33, v33, v35
    ds_write2_b32 v13, v32, v33 offset0:4 offset1:12
    v_cvt_pk_bf16_f32 v36, v36, v38
    v_cvt_pk_bf16_f32 v37, v37, v39
    ds_write2_b32 v14, v36, v37 offset0:0 offset1:8
    v_cvt_pk_bf16_f32 v40, v40, v42
    v_cvt_pk_bf16_f32 v41, v41, v43
    ds_write2_b32 v14, v40, v41 offset0:4 offset1:12
    v_cvt_pk_bf16_f32 v44, v44, v46
    v_cvt_pk_bf16_f32 v45, v45, v47
    ds_write2_b32 v15, v44, v45 offset0:0 offset1:8
    v_cvt_pk_bf16_f32 v48, v48, v50
    v_cvt_pk_bf16_f32 v49, v49, v51
    ds_write2_b32 v15, v48, v49 offset0:4 offset1:12
    s_add_u32 s12, s4, 0x1c00000
    s_addc_u32 s13, s5, 0
    s_mov_b32 s14, 0x400000
    s_mov_b32 s15, 0x20000
    s_lshl_b32 s36, s38, 14
    s_lshl_b32 s37, s30, 12
    s_add_u32 s36, s36, s37
    v_mov_b32 v8, 162824
    v_mov_b32 v9, 1
    s_waitcnt lgkmcnt(0)
    s_mov_b64 exec, 1
    ds_add_u32 v8, v9
    s_mov_b64 exec, -1
    v_mov_b32 v8, 162824
spin_4:
    ds_read_b32 v9, v8
    s_waitcnt lgkmcnt(0)
    v_readfirstlane_b32 s53, v9
    s_nop 0
    s_cmp_ge_u32 s53, 4
    s_cbranch_scc0 spin_4
    ds_read_b64_tr_b16 v[120:121], v16 offset:0
    ds_read_b64_tr_b16 v[122:123], v16 offset:32
    ds_read_b64_tr_b16 v[124:125], v16 offset:288
    ds_read_b64_tr_b16 v[126:127], v16 offset:320
    ds_read_b64_tr_b16 v[128:129], v16 offset:576
    ds_read_b64_tr_b16 v[130:131], v16 offset:608
    ds_read_b64_tr_b16 v[132:133], v16 offset:864
    ds_read_b64_tr_b16 v[134:135], v16 offset:896
    s_waitcnt lgkmcnt(6)
    buffer_store_dwordx4 v[120:123], v2, s[12:15], s36 offen offset:0 sc1
    s_waitcnt lgkmcnt(4)
    buffer_store_dwordx4 v[124:127], v2, s[12:15], s36 offen offset:1024 sc1
    s_waitcnt lgkmcnt(2)
    buffer_store_dwordx4 v[128:131], v2, s[12:15], s36 offen offset:2048 sc1
    s_waitcnt lgkmcnt(0)
    buffer_store_dwordx4 v[132:135], v2, s[12:15], s36 offen offset:3072 sc1
    v_mov_b32 v6, 162840
    v_mov_b32 v7, 1
    s_waitcnt lgkmcnt(0)
    s_mov_b64 exec, 1
    ds_add_u32 v6, v7
    s_mov_b64 exec, -1
    s_and_b32 s36, s2, 7
    s_lshr_b32 s53, s2, 5
    s_lshl3_add_u32 s36, s36, s53
    s_lshl_b32 s36, s36, 7
    s_add_u32 s36, s36, 23592960
    v_mov_b32 v6, 1
    v_mov_b32 v7, 162820
    v_lshlrev_b32 v9, 13, v1
    s_mov_b64 exec, 1
    s_waitcnt vmcnt(0)
    s_waitcnt lgkmcnt(0)
    ds_add_rtn_u32 v8, v7, v6
    ds_read_b32 v10, v7 offset:28
    s_waitcnt lgkmcnt(0)
    v_readfirstlane_b32 s54, v8
    v_readfirstlane_b32 s53, v10
    s_cmp_lg_u32 s54, 7
    s_cbranch_scc1 fa_5
    s_mov_b64 exec, 0xffff
    s_or_b32 s53, s53, 1
    v_mov_b32 v6, s53
    buffer_atomic_add v6, v9, s[56:59], s36 offen sc1
fa_5:
    s_mov_b64 exec, -1
    s_branch FR_end
FR_b:
    s_and_b32 s36, s30, 3
    s_lshl_b32 s36, s36, 14
    s_lshl_b32 s48, s29, 7
    s_add_u32 s48, s48, s36
    s_waitcnt vmcnt(0)
    s_barrier
    ds_read_b64_tr_b16 v[148:149], v75 offset:8192
    ds_read_b64_tr_b16 v[150:151], v75 offset:10240
    ds_read_b64_tr_b16 v[156:157], v75 offset:12288
    ds_read_b64_tr_b16 v[158:159], v75 offset:14336
    ds_read_b64_tr_b16 v[164:165], v75 offset:16384
    ds_read_b64_tr_b16 v[166:167], v75 offset:18432
    ds_read_b64_tr_b16 v[172:173], v75 offset:20480
    ds_read_b64_tr_b16 v[174:175], v75 offset:22528
    ds_read_b64_tr_b16 v[180:181], v75 offset:24576
    ds_read_b64_tr_b16 v[182:183], v75 offset:26624
    ds_read_b64_tr_b16 v[188:189], v75 offset:28672
    ds_read_b64_tr_b16 v[190:191], v75 offset:30720
    ds_read_b64_tr_b16 v[196:197], v75 offset:32768
    ds_read_b64_tr_b16 v[198:199], v75 offset:34816
    ds_read_b64_tr_b16 v[204:205], v75 offset:36864
    ds_read_b64_tr_b16 v[206:207], v75 offset:38912
    ds_read_b64_tr_b16 v[212:213], v75 offset:40960
    ds_read_b64_tr_b16 v[214:215], v75 offset:43008
    ds_read_b64_tr_b16 v[220:221], v75 offset:45056
    ds_read_b64_tr_b16 v[222:223], v75 offset:47104
    ds_read_b64_tr_b16 v[228:229], v75 offset:49152
    ds_read_b64_tr_b16 v[230:231], v75 offset:51200
    ds_read_b64_tr_b16 v[236:237], v75 offset:53248
    ds_read_b64_tr_b16 v[238:239], v75 offset:55296
    ds_read_b64_tr_b16 v[244:245], v75 offset:57344
    ds_read_b64_tr_b16 v[246:247], v75 offset:59392
    ds_read_b64_tr_b16 v[252:253], v75 offset:61440
    ds_read_b64_tr_b16 v[254:255], v75 offset:63488
    s_cmp_lg_u32 s30, 4
    s_cbranch_scc1 FB_ni
    v_mov_b32 v8, s52
    s_lshr_b32 s53, s28, 3
    s_lshl_b32 s53, s53, 2
    s_and_b32 s54, s28, 3
    s_add_u32 s53, s53, s54
    s_lshl_b32 s53, s53, 23
    s_lshr_b32 s54, s28, 2
    s_xor_b32 s54, s54, s94
    s_and_b32 s54, s54, 1
    s_lshl_b32 s54, s54, 13
    s_add_u32 s37, s53, s54
    s_add_u32 s37, s37, 33554432
    s_andn2_b32 s37, s37, 0x2000
    s_lshl_b32 s53, s29, 7
    s_add_u32 s37, s37, s53
    s_add_u32 s37, s37, 1835008
    v_and_b32 v9, 1, v1
    v_lshlrev_b32 v9, 13, v9
    v_bfe_u32 v10, v1, 1, 1
    v_lshl_add_u32 v9, v10, 26, v9
    v_lshrrev_b32 v10, 2, v1
    v_lshl_add_u32 v9, v10, 11, v9
    s_mov_b64 exec, 0xfff
    buffer_store_dword v8, v9, s[56:59], s37 offen sc1
    s_cmp_lg_u32 s28, 0
    s_cbranch_scc1 FB_n2
    s_add_u32 s37, s53, 23068672
    s_mov_b64 exec, 3
    buffer_store_dword v8, v9, s[56:59], s37 offen sc1
FB_n2:
    s_mov_b64 exec, -1
FB_ni:
    s_cmp_ge_u32 s2, 255
    s_cbranch_scc1 KV_n3
    s_cmp_lg_u32 s30, 5
    s_cbranch_scc1 KV_n3
    s_and_b32 s42, s2, 31
    s_lshl_b32 s42, s42, 8
    s_lshr_b32 s43, s2, 5
    s_lshl_b32 s43, s43, 14
    s_add_u32 s42, s42, s43
    s_add_u32 s42, s42, 35520512
    v_and_b32 v8, 1, v1
    v_lshlrev_b32 v8, 13, v8
    v_lshrrev_b32 v9, 1, v1
    v_lshl_add_u32 v8, v9, 7, v8
    s_mov_b64 exec, 0xf
    buffer_store_dword v8, v8, s[56:59], s42 offen sc1
    s_mov_b64 exec, -1
KV_n3:
    buffer_load_dwordx2 v[86:87], v80, s[8:11], 0 offen offset:0 nt
    buffer_load_dwordx2 v[88:89], v80, s[8:11], 0 offen offset:32 nt
    buffer_load_dwordx2 v[90:91], v80, s[8:11], 0 offen offset:128 nt
    buffer_load_dwordx2 v[92:93], v80, s[8:11], 0 offen offset:160 nt
    s_add_u32 s36, s67, 0
    s_and_b32 s36, s36, 7
    s_lshl_b32 s36, s36, 17
    s_add_u32 s36, s36, s48
    buffer_load_dwordx4 v[128:131], v118, s[88:91], s36 offen
    s_add_u32 s36, s36, 65536
    buffer_load_dwordx4 v[136:139], v118, s[88:91], s36 offen
    s_add_u32 s36, s67, 1
    s_and_b32 s36, s36, 7
    s_lshl_b32 s36, s36, 17
    s_add_u32 s36, s36, s48
    buffer_load_dwordx4 v[144:147], v118, s[88:91], s36 offen
    s_add_u32 s36, s36, 65536
    buffer_load_dwordx4 v[152:155], v118, s[88:91], s36 offen
    s_add_u32 s36, s67, 2
    s_and_b32 s36, s36, 7
    s_lshl_b32 s36, s36, 17
    s_add_u32 s36, s36, s48
    buffer_load_dwordx4 v[160:163], v118, s[88:91], s36 offen
    s_add_u32 s36, s36, 65536
    buffer_load_dwordx4 v[168:171], v118, s[88:91], s36 offen
    s_add_u32 s36, s67, 3
    s_and_b32 s36, s36, 7
    s_lshl_b32 s36, s36, 17
    s_add_u32 s36, s36, s48
    buffer_load_dwordx4 v[176:179], v118, s[88:91], s36 offen
    s_add_u32 s36, s36, 65536
    buffer_load_dwordx4 v[184:187], v118, s[88:91], s36 offen
    s_add_u32 s36, s67, 4
    s_and_b32 s36, s36, 7
    s_lshl_b32 s36, s36, 17
    s_add_u32 s36, s36, s48
    buffer_load_dwordx4 v[192:195], v118, s[88:91], s36 offen
    s_add_u32 s36, s36, 65536
    buffer_load_dwordx4 v[200:203], v118, s[88:91], s36 offen
    s_add_u32 s36, s67, 5
    s_and_b32 s36, s36, 7
    s_lshl_b32 s36, s36, 17
    s_add_u32 s36, s36, s48
    buffer_load_dwordx4 v[208:211], v118, s[88:91], s36 offen
    s_add_u32 s36, s36, 65536
    buffer_load_dwordx4 v[216:219], v118, s[88:91], s36 offen
    s_add_u32 s36, s67, 6
    s_and_b32 s36, s36, 7
    s_lshl_b32 s36, s36, 17
    s_add_u32 s36, s36, s48
    buffer_load_dwordx4 v[224:227], v118, s[88:91], s36 offen
    s_add_u32 s36, s36, 65536
    buffer_load_dwordx4 v[232:235], v118, s[88:91], s36 offen
    s_add_u32 s36, s67, 7
    s_and_b32 s36, s36, 7
    s_lshl_b32 s36, s36, 17
    s_add_u32 s36, s36, s48
    buffer_load_dwordx4 v[240:243], v118, s[88:91], s36 offen
    s_add_u32 s36, s36, 65536
    buffer_load_dwordx4 v[248:251], v118, s[88:91], s36 offen
    s_add_u32 s36, s67, 0
    s_and_b32 s36, s36, 7
    s_lshl_b32 s36, s36, 17
    s_add_u32 s36, s36, s48
    s_add_u32 s36, s36, 1048576
    buffer_load_dwordx4 v[132:135], v118, s[88:91], s36 offen
    s_add_u32 s36, s36, 65536
    buffer_load_dwordx4 v[140:143], v118, s[88:91], s36 offen
    v_mov_b32 v6, 162836
    v_mov_b32 v7, 1
    s_waitcnt lgkmcnt(0)
    s_mov_b64 exec, 1
    ds_add_u32 v6, v7
    s_mov_b64 exec, -1
    s_add_u32 s36, s67, 0
    s_and_b32 s36, s36, 7
    s_lshl_b32 s36, s36, 17
    s_add_u32 s36, s36, s48
    buffer_load_dwordx4 v[12:15], v118, s[80:83], s36 offen
    s_add_u32 s36, s36, 65536
    buffer_load_dwordx4 v[16:19], v118, s[80:83], s36 offen
    s_add_u32 s36, s67, 1
    s_and_b32 s36, s36, 7
    s_lshl_b32 s36, s36, 17
    s_add_u32 s36, s36, s48
    buffer_load_dwordx4 v[20:23], v118, s[80:83], s36 offen
    s_add_u32 s36, s36, 65536
    buffer_load_dwordx4 v[24:27], v118, s[80:83], s36 offen
    s_add_u32 s36, s67, 2
    s_and_b32 s36, s36, 7
    s_lshl_b32 s36, s36, 17
    s_add_u32 s36, s36, s48
    buffer_load_dwordx4 v[28:31], v118, s[80:83], s36 offen
    s_add_u32 s36, s36, 65536
    buffer_load_dwordx4 v[32:35], v118, s[80:83], s36 offen
    s_add_u32 s36, s67, 3
    s_and_b32 s36, s36, 7
    s_lshl_b32 s36, s36, 17
    s_add_u32 s36, s36, s48
    buffer_load_dwordx4 v[36:39], v118, s[80:83], s36 offen
    s_add_u32 s36, s36, 65536
    buffer_load_dwordx4 v[40:43], v118, s[80:83], s36 offen
    s_add_u32 s36, s67, 4
    s_and_b32 s36, s36, 7
    s_lshl_b32 s36, s36, 17
    s_add_u32 s36, s36, s48
    buffer_load_dwordx4 v[44:47], v118, s[80:83], s36 offen
    s_add_u32 s36, s36, 65536
    buffer_load_dwordx4 v[48:51], v118, s[80:83], s36 offen
    s_add_u32 s36, s67, 5
    s_and_b32 s36, s36, 7
    s_lshl_b32 s36, s36, 17
    s_add_u32 s36, s36, s48
    buffer_load_dwordx4 v[52:55], v118, s[80:83], s36 offen
    s_add_u32 s36, s36, 65536
    buffer_load_dwordx4 v[56:59], v118, s[80:83], s36 offen
    s_add_u32 s36, s67, 6
    s_and_b32 s36, s36, 7
    s_lshl_b32 s36, s36, 17
    s_add_u32 s36, s36, s48
    buffer_load_dwordx4 v[60:63], v118, s[80:83], s36 offen
    s_add_u32 s36, s36, 65536
    buffer_load_dwordx4 v[64:67], v118, s[80:83], s36 offen
    s_add_u32 s36, s67, 7
    s_and_b32 s36, s36, 7
    s_lshl_b32 s36, s36, 17
    s_add_u32 s36, s36, s48
    buffer_load_dwordx4 v[68:71], v118, s[80:83], s36 offen
    s_add_u32 s36, s36, 65536
    buffer_load_dwordx4 v[94:97], v118, s[80:83], s36 offen
    s_add_u32 s36, s67, 0
    s_and_b32 s36, s36, 7
    s_lshl_b32 s36, s36, 17
    s_add_u32 s36, s36, s48
    s_add_u32 s36, s36, 1048576
    buffer_load_dwordx4 v[98:101], v118, s[80:83], s36 offen
    s_add_u32 s36, s36, 65536
    buffer_load_dwordx4 v[102:105], v118, s[80:83], s36 offen
    s_waitcnt vmcnt(40)
    s_cmp_ge_u32 s2, 255
    s_cbranch_scc1 FB_np
    s_cmp_lg_u32 s30, 5
    s_cbranch_scc1 FB_np
    s_and_b32 s42, s2, 31
    s_lshl_b32 s42, s42, 8
    s_lshr_b32 s43, s2, 5
    s_lshl_b32 s43, s43, 14
    s_add_u32 s42, s42, s43
    s_add_u32 s42, s42, 35520512
    s_mov_b32 s46, -1
    s_mov_b32 s47, -1
    s_mov_b32 s43, 0
FB_ml:
    s_memtime s[34:35]
    s_waitcnt lgkmcnt(0)
    s_load_dword s32, s[4:5], s42 offset:0 glc
    s_waitcnt lgkmcnt(0)
    s_memtime s[36:37]
    s_waitcnt lgkmcnt(0)
    s_sub_u32 s36, s36, s34
    s_min_u32 s46, s46, s36
    s_memtime s[34:35]
    s_waitcnt lgkmcnt(0)
    s_load_dword s32, s[4:5], s42 offset:8192 glc
    s_waitcnt lgkmcnt(0)
    s_memtime s[36:37]
    s_waitcnt lgkmcnt(0)
    s_sub_u32 s36, s36, s34
    s_min_u32 s47, s47, s36
    s_add_u32 s42, s42, 128
    s_add_u32 s43, s43, 1
    s_cmp_lt_u32 s43, 1
    s_cbranch_scc1 FB_ml
    s_cmp_lt_u32 s47, s46
    s_cselect_b32 s45, 1, 0
    s_lshr_b32 s46, s28, 2
    s_xor_b32 s45, s45, s46
    s_and_b32 s45, s45, 1
    s_lshl_b32 s45, s45, 8
    v_mov_b32 v6, 162848
    v_mov_b32 v7, s45
    s_waitcnt lgkmcnt(0)
    ds_write_b32 v6, v7
FB_np:
    s_and_b32 s36, s2, 7
    s_lshr_b32 s53, s2, 5
    s_lshl3_add_u32 s36, s36, s53
    s_lshl_b32 s36, s36, 7
    s_add_u32 s36, s36, 23592960
    v_mov_b32 v6, 1
    v_mov_b32 v7, 162820
    v_lshlrev_b32 v9, 13, v1
    s_mov_b64 exec, 1
    s_waitcnt lgkmcnt(0)
    ds_add_rtn_u32 v8, v7, v6
    ds_read_b32 v10, v7 offset:28
    s_waitcnt lgkmcnt(0)
    v_readfirstlane_b32 s54, v8
    v_readfirstlane_b32 s53, v10
    s_cmp_lg_u32 s54, 7
    s_cbranch_scc1 fa_6
    s_mov_b64 exec, 0xffff
    s_or_b32 s53, s53, 1
    v_mov_b32 v6, s53
    buffer_atomic_add v6, v9, s[56:59], s36 offen sc1
fa_6:
    s_mov_b64 exec, -1
    v_mov_b32 v6, 162836
spin_7:
    ds_read_b32 v7, v6
    s_waitcnt lgkmcnt(0)
    v_readfirstlane_b32 s53, v7
    s_nop 0
    s_cmp_ge_u32 s53, 4
    s_cbranch_scc0 spin_7
    s_and_b32 s49, s30, 3
    s_lshl_b32 s36, s49, 14
    s_lshl_b32 s48, s29, 7
    s_add_u32 s48, s48, s36
    s_lshl_b32 s49, s49, 10
    s_add_u32 s36, s67, 1
    s_and_b32 s36, s36, 7
    s_lshl_b32 s36, s36, 17
    s_add_u32 s36, s36, s48
    s_add_u32 s36, s36, 1048576
    s_add_u32 m0, s49, 98304
    s_nop 0
    buffer_load_dwordx4 v118, s[80:83], s36 offen lds
    s_add_u32 s36, s36, 65536
    s_add_u32 m0, s49, 102400
    s_nop 0
    buffer_load_dwordx4 v118, s[80:83], s36 offen lds
    s_add_u32 s36, s67, 2
    s_and_b32 s36, s36, 7
    s_lshl_b32 s36, s36, 17
    s_add_u32 s36, s36, s48
    s_add_u32 s36, s36, 1048576
    s_add_u32 m0, s49, 106496
    s_nop 0
    buffer_load_dwordx4 v118, s[80:83], s36 offen lds
    s_add_u32 s36, s36, 65536
    s_add_u32 m0, s49, 110592
    s_nop 0
    buffer_load_dwordx4 v118, s[80:83], s36 offen lds
    s_add_u32 s36, s67, 3
    s_and_b32 s36, s36, 7
    s_lshl_b32 s36, s36, 17
    s_add_u32 s36, s36, s48
    s_add_u32 s36, s36, 1048576
    s_add_u32 m0, s49, 114688
    s_nop 0
    buffer_load_dwordx4 v118, s[80:83], s36 offen lds
    s_add_u32 s36, s36, 65536
    s_add_u32 m0, s49, 118784
    s_nop 0
    buffer_load_dwordx4 v118, s[80:83], s36 offen lds
    s_add_u32 s36, s67, 4
    s_and_b32 s36, s36, 7
    s_lshl_b32 s36, s36, 17
    s_add_u32 s36, s36, s48
    s_add_u32 s36, s36, 1048576
    s_add_u32 m0, s49, 122880
    s_nop 0
    buffer_load_dwordx4 v118, s[80:83], s36 offen lds
    s_add_u32 s36, s36, 65536
    s_add_u32 m0, s49, 126976
    s_nop 0
    buffer_load_dwordx4 v118, s[80:83], s36 offen lds
    s_add_u32 s36, s67, 5
    s_and_b32 s36, s36, 7
    s_lshl_b32 s36, s36, 17
    s_add_u32 s36, s36, s48
    s_add_u32 s36, s36, 1048576
    s_add_u32 m0, s49, 131072
    s_nop 0
    buffer_load_dwordx4 v118, s[80:83], s36 offen lds
    s_add_u32 s36, s36, 65536
    s_add_u32 m0, s49, 135168
    s_nop 0
    buffer_load_dwordx4 v118, s[80:83], s36 offen lds
    s_add_u32 s36, s67, 6
    s_and_b32 s36, s36, 7
    s_lshl_b32 s36, s36, 17
    s_add_u32 s36, s36, s48
    s_add_u32 s36, s36, 1048576
    s_add_u32 m0, s49, 139264
    s_nop 0
    buffer_load_dwordx4 v118, s[80:83], s36 offen lds
    s_add_u32 s36, s36, 65536
    s_add_u32 m0, s49, 143360
    s_nop 0
    buffer_load_dwordx4 v118, s[80:83], s36 offen lds
    s_add_u32 s36, s67, 7
    s_and_b32 s36, s36, 7
    s_lshl_b32 s36, s36, 17
    s_add_u32 s36, s36, s48
    s_add_u32 s36, s36, 1048576
    s_add_u32 m0, s49, 147456
    s_nop 0
    buffer_load_dwordx4 v118, s[80:83], s36 offen lds
    s_add_u32 s36, s36, 65536
    s_add_u32 m0, s49, 151552
    s_nop 0
    buffer_load_dwordx4 v118, s[80:83], s36 offen lds
    s_waitcnt vmcnt(0)
    v_mov_b32 v6, 162840
spin_8:
    s_sleep 2
    ds_read_b32 v7, v6
    s_waitcnt lgkmcnt(0)
    v_readfirstlane_b32 s53, v7
    s_nop 0
    s_cmp_ge_u32 s53, 4
    s_cbranch_scc0 spin_8
    s_and_b32 s36, s30, 3
    s_lshl_b32 s36, s36, 10
    s_add_u32 s36, s36, 24576
    v_add_u32 v8, s36, v2
    v_add_u32 v9, 65536, v8
    ds_write_b128 v8, v[12:15] offset:0
    ds_write_b128 v8, v[16:19] offset:4096
    ds_write_b128 v8, v[20:23] offset:8192
    ds_write_b128 v8, v[24:27] offset:12288
    ds_write_b128 v8, v[28:31] offset:16384
    ds_write_b128 v8, v[32:35] offset:20480
    ds_write_b128 v8, v[36:39] offset:24576
    ds_write_b128 v8, v[40:43] offset:28672
    ds_write_b128 v8, v[44:47] offset:32768
    ds_write_b128 v8, v[48:51] offset:36864
    ds_write_b128 v8, v[52:55] offset:40960
    ds_write_b128 v8, v[56:59] offset:45056
    ds_write_b128 v8, v[60:63] offset:49152
    ds_write_b128 v8, v[64:67] offset:53248
    ds_write_b128 v8, v[68:71] offset:57344
    ds_write_b128 v8, v[94:97] offset:61440
    ds_write_b128 v9, v[98:101] offset:0
    ds_write_b128 v9, v[102:105] offset:4096
    v_mov_b32 v6, 162836
    v_mov_b32 v7, 1
    s_waitcnt lgkmcnt(0)
    s_mov_b64 exec, 1
    ds_add_u32 v6, v7
    s_mov_b64 exec, -1
FR_end:
LAYER:
    v_lshlrev_b32 v72, 6, v81
    v_add_u32 v72, 161792, v72
    s_lshl_b32 s35, s30, 3
    v_add_u32 v71, s35, v72
    v_lshrrev_b32 v6, 2, v1
    v_lshlrev_b32 v74, 7, v6
    v_bfe_u32 v6, v6, 1, 2
    s_and_b32 s35, s30, 2
    v_and_b32 v7, 1, v1
    v_or_b32 v7, s35, v7
    v_xor_b32 v6, v6, v7
    v_lshl_add_u32 v74, v6, 5, v74
    v_and_b32 v6, 2, v1
    v_lshl_add_u32 v74, v6, 2, v74
    s_and_b32 s35, s30, 1
    s_lshl_b32 s35, s35, 4
    s_add_u32 s35, s35, 24576
    v_add_u32 v74, s35, v74
    v_add_u32 v75, 65536, v74
    s_cmp_eq_u32 s60, 0
    s_cbranch_scc1 R_l0
    s_sub_u32 s8, s62, 0x3c00000
    s_subb_u32 s9, s63, 0
    s_mov_b32 s10, 0x7e000
    s_mov_b32 s11, 0x20000
    s_lshr_b32 s37, s28, 3
    s_and_b32 s36, s28, 3
    s_lshl2_add_u32 s36, s37, s36
    s_lshl_b32 s36, s36, 19
    s_xor_b32 s37, s37, s94
    s_lshl_b32 s37, s37, 2
    s_xor_b32 s37, s37, s28
    s_and_b32 s37, s37, 4
    s_lshl_b32 s37, s37, 11
    s_add_u32 s36, s36, s37
    s_add_u32 s36, s36, 25165824
    s_add_u32 s12, s4, s36
    s_addc_u32 s13, s5, 0
    s_mov_b32 s14, 516096
    s_mov_b32 s15, 0x20000
    v_lshlrev_b32 v102, 16, v110
    v_and_b32 v103, 0xffff0000, v110
    v_lshlrev_b32 v52, 16, v86
    v_and_b32 v53, 0xffff0000, v86
    v_lshlrev_b32 v28, 16, v94
    v_and_b32 v29, 0xffff0000, v94
    v_pk_add_f32 v[52:53], v[52:53], v[28:29]
    v_lshlrev_b32 v104, 16, v111
    v_and_b32 v105, 0xffff0000, v111
    v_lshlrev_b32 v54, 16, v87
    v_and_b32 v55, 0xffff0000, v87
    v_lshlrev_b32 v30, 16, v95
    v_and_b32 v31, 0xffff0000, v95
    v_pk_add_f32 v[54:55], v[54:55], v[30:31]
    v_lshlrev_b32 v106, 16, v112
    v_and_b32 v107, 0xffff0000, v112
    v_lshlrev_b32 v56, 16, v88
    v_and_b32 v57, 0xffff0000, v88
    v_lshlrev_b32 v32, 16, v96
    v_and_b32 v33, 0xffff0000, v96
    v_pk_add_f32 v[56:57], v[56:57], v[32:33]
    v_lshlrev_b32 v108, 16, v113
    v_and_b32 v109, 0xffff0000, v113
    v_lshlrev_b32 v58, 16, v89
    v_and_b32 v59, 0xffff0000, v89
    v_lshlrev_b32 v34, 16, v97
    v_and_b32 v35, 0xffff0000, v97
    v_pk_add_f32 v[58:59], v[58:59], v[34:35]
    v_lshlrev_b32 v110, 16, v114
    v_and_b32 v111, 0xffff0000, v114
    v_lshlrev_b32 v60, 16, v90
    v_and_b32 v61, 0xffff0000, v90
    v_lshlrev_b32 v36, 16, v98
    v_and_b32 v37, 0xffff0000, v98
    v_pk_add_f32 v[60:61], v[60:61], v[36:37]
    v_lshlrev_b32 v112, 16, v115
    v_and_b32 v113, 0xffff0000, v115
    v_lshlrev_b32 v62, 16, v91
    v_and_b32 v63, 0xffff0000, v91
    v_lshlrev_b32 v38, 16, v99
    v_and_b32 v39, 0xffff0000, v99
    v_pk_add_f32 v[62:63], v[62:63], v[38:39]
    v_lshlrev_b32 v114, 16, v116
    v_and_b32 v115, 0xffff0000, v116
    v_lshlrev_b32 v64, 16, v92
    v_and_b32 v65, 0xffff0000, v92
    v_lshlrev_b32 v40, 16, v100
    v_and_b32 v41, 0xffff0000, v100
    v_pk_add_f32 v[64:65], v[64:65], v[40:41]
    v_lshlrev_b32 v116, 16, v117
    v_and_b32 v117, 0xffff0000, v117
    v_lshlrev_b32 v66, 16, v93
    v_and_b32 v67, 0xffff0000, v93
    v_lshlrev_b32 v42, 16, v101
    v_and_b32 v43, 0xffff0000, v101
    v_pk_add_f32 v[66:67], v[66:67], v[42:43]
    buffer_load_dwordx4 v[86:89], v78, s[8:11], 0 offen offset:0 sc1
    buffer_load_dwordx4 v[94:97], v78, s[12:15], 0 offen offset:0 sc1
    buffer_load_dwordx4 v[90:93], v78, s[8:11], 0 offen offset:2048 sc1
    buffer_load_dwordx4 v[98:101], v78, s[12:15], 0 offen offset:2048 sc1
    s_cmp_ge_u32 s30, 4
    s_cbranch_scc1 w1in_11
    ds_read_b64_tr_b16 v[180:181], v75 offset:24576
    ds_read_b64_tr_b16 v[182:183], v75 offset:26624
    ds_read_b64_tr_b16 v[188:189], v75 offset:28672
    ds_read_b64_tr_b16 v[190:191], v75 offset:30720
    ds_read_b64_tr_b16 v[196:197], v75 offset:32768
    ds_read_b64_tr_b16 v[198:199], v75 offset:34816
    ds_read_b64_tr_b16 v[204:205], v75 offset:36864
    ds_read_b64_tr_b16 v[206:207], v75 offset:38912
    ds_read_b64_tr_b16 v[244:245], v75 offset:57344
    ds_read_b64_tr_b16 v[246:247], v75 offset:59392
    ds_read_b64_tr_b16 v[252:253], v75 offset:61440
    ds_read_b64_tr_b16 v[254:255], v75 offset:63488
    ds_read_b64_tr_b16 v[212:213], v75 offset:40960
    ds_read_b64_tr_b16 v[214:215], v75 offset:43008
    ds_read_b64_tr_b16 v[220:221], v75 offset:45056
    ds_read_b64_tr_b16 v[222:223], v75 offset:47104
    ds_read_b64_tr_b16 v[228:229], v75 offset:49152
    ds_read_b64_tr_b16 v[230:231], v75 offset:51200
    ds_read_b64_tr_b16 v[236:237], v75 offset:53248
    ds_read_b64_tr_b16 v[238:239], v75 offset:55296
    ds_read_b64_tr_b16 v[176:177], v74 offset:24576
    ds_read_b64_tr_b16 v[178:179], v74 offset:26624
    ds_read_b64_tr_b16 v[184:185], v74 offset:28672
    ds_read_b64_tr_b16 v[186:187], v74 offset:30720
    ds_read_b64_tr_b16 v[192:193], v74 offset:32768
    ds_read_b64_tr_b16 v[194:195], v74 offset:34816
    ds_read_b64_tr_b16 v[200:201], v74 offset:36864
    ds_read_b64_tr_b16 v[202:203], v74 offset:38912
    ds_read_b64_tr_b16 v[208:209], v74 offset:40960
    ds_read_b64_tr_b16 v[210:211], v74 offset:43008
    ds_read_b64_tr_b16 v[216:217], v74 offset:45056
    ds_read_b64_tr_b16 v[218:219], v74 offset:47104
    ds_read_b64_tr_b16 v[224:225], v74 offset:49152
    ds_read_b64_tr_b16 v[226:227], v74 offset:51200
    ds_read_b64_tr_b16 v[232:233], v74 offset:53248
    ds_read_b64_tr_b16 v[234:235], v74 offset:55296
    ds_read_b64_tr_b16 v[128:129], v74 offset:0
    ds_read_b64_tr_b16 v[130:131], v74 offset:2048
    ds_read_b64_tr_b16 v[136:137], v74 offset:4096
    ds_read_b64_tr_b16 v[138:139], v74 offset:6144
w1in_11:
    s_mov_b32 s53, 0
dw_9:
    s_waitcnt vmcnt(0)
    v_and_b32 v6, v86, v87
    v_and_b32 v7, v94, v95
    v_bitop3_b32 v6, v88, v89, v6 bitop3:0x80
    v_bitop3_b32 v7, v96, v97, v7 bitop3:0x80
    v_bitop3_b32 v6, v90, v91, v6 bitop3:0x80
    v_bitop3_b32 v7, v98, v99, v7 bitop3:0x80
    v_bitop3_b32 v6, v92, v93, v6 bitop3:0x80
    v_bitop3_b32 v7, v100, v101, v7 bitop3:0x80
    v_bitop3_b32 v6, v6, v7, 1 bitop3:0x80
    v_cmp_eq_u32 vcc, 0, v6
    s_nop 0
    s_cmp_eq_u64 vcc, 0
    s_cbranch_scc1 dok_10
    s_sleep 2
    buffer_load_dwordx4 v[86:89], v78, s[8:11], 0 offen offset:0 sc1
    buffer_load_dwordx4 v[94:97], v78, s[12:15], 0 offen offset:0 sc1
    buffer_load_dwordx4 v[90:93], v78, s[8:11], 0 offen offset:2048 sc1
    buffer_load_dwordx4 v[98:101], v78, s[12:15], 0 offen offset:2048 sc1
    s_add_u32 s53, s53, 1
    s_cmp_lt_u32 s53, s61
    s_cbranch_scc1 dw_9
    s_mov_b32 s61, 0
    s_waitcnt vmcnt(0)
dok_10:
    v_lshlrev_b32 v12, 16, v86
    v_and_b32 v13, 0xffff0000, v86
    v_lshlrev_b32 v28, 16, v94
    v_and_b32 v29, 0xffff0000, v94
    v_pk_add_f32 v[12:13], v[12:13], v[28:29]
    v_pk_add_f32 v[12:13], v[12:13], v[52:53]
    v_lshlrev_b32 v14, 16, v87
    v_and_b32 v15, 0xffff0000, v87
    v_lshlrev_b32 v30, 16, v95
    v_and_b32 v31, 0xffff0000, v95
    v_pk_add_f32 v[14:15], v[14:15], v[30:31]
    v_pk_add_f32 v[14:15], v[14:15], v[54:55]
    v_lshlrev_b32 v16, 16, v88
    v_and_b32 v17, 0xffff0000, v88
    v_lshlrev_b32 v32, 16, v96
    v_and_b32 v33, 0xffff0000, v96
    v_pk_add_f32 v[16:17], v[16:17], v[32:33]
    v_pk_add_f32 v[16:17], v[16:17], v[56:57]
    v_lshlrev_b32 v18, 16, v89
    v_and_b32 v19, 0xffff0000, v89
    v_lshlrev_b32 v34, 16, v97
    v_and_b32 v35, 0xffff0000, v97
    v_pk_add_f32 v[18:19], v[18:19], v[34:35]
    v_pk_add_f32 v[18:19], v[18:19], v[58:59]
    v_lshlrev_b32 v20, 16, v90
    v_and_b32 v21, 0xffff0000, v90
    v_lshlrev_b32 v36, 16, v98
    v_and_b32 v37, 0xffff0000, v98
    v_pk_add_f32 v[20:21], v[20:21], v[36:37]
    v_pk_add_f32 v[20:21], v[20:21], v[60:61]
    v_lshlrev_b32 v22, 16, v91
    v_and_b32 v23, 0xffff0000, v91
    v_lshlrev_b32 v38, 16, v99
    v_and_b32 v39, 0xffff0000, v99
    v_pk_add_f32 v[22:23], v[22:23], v[38:39]
    v_pk_add_f32 v[22:23], v[22:23], v[62:63]
    v_lshlrev_b32 v24, 16, v92
    v_and_b32 v25, 0xffff0000, v92
    v_lshlrev_b32 v40, 16, v100
    v_and_b32 v41, 0xffff0000, v100
    v_pk_add_f32 v[24:25], v[24:25], v[40:41]
    v_pk_add_f32 v[24:25], v[24:25], v[64:65]
    v_lshlrev_b32 v26, 16, v93
    v_and_b32 v27, 0xffff0000, v93
    v_lshlrev_b32 v42, 16, v101
    v_and_b32 v43, 0xffff0000, v101
    v_pk_add_f32 v[26:27], v[26:27], v[42:43]
    v_pk_add_f32 v[26:27], v[26:27], v[66:67]
    v_pk_add_f32 v[48:49], v[12:13], v[14:15]
    v_pk_mul_f32 v[50:51], v[12:13], v[12:13]
    v_pk_fma_f32 v[50:51], v[14:15], v[14:15], v[50:51]
    v_pk_add_f32 v[48:49], v[48:49], v[16:17]
    v_pk_fma_f32 v[50:51], v[16:17], v[16:17], v[50:51]
    v_pk_add_f32 v[48:49], v[48:49], v[18:19]
    v_pk_fma_f32 v[50:51], v[18:19], v[18:19], v[50:51]
    v_pk_add_f32 v[48:49], v[48:49], v[20:21]
    v_pk_fma_f32 v[50:51], v[20:21], v[20:21], v[50:51]
    v_pk_add_f32 v[48:49], v[48:49], v[22:23]
    v_pk_fma_f32 v[50:51], v[22:23], v[22:23], v[50:51]
    v_pk_add_f32 v[48:49], v[48:49], v[24:25]
    v_pk_fma_f32 v[50:51], v[24:25], v[24:25], v[50:51]
    v_pk_add_f32 v[48:49], v[48:49], v[26:27]
    v_pk_fma_f32 v[50:51], v[26:27], v[26:27], v[50:51]
    v_add_f32 v46, v48, v49
    v_add_f32 v47, v50, v51
    s_nop 0
    v_add_f32_dpp v46, v46, v46 row_ror:8 row_mask:0xf bank_mask:0xf
    v_add_f32_dpp v47, v47, v47 row_ror:8 row_mask:0xf bank_mask:0xf
    v_mov_b32 v48, v46
    v_mov_b32 v49, v47
    s_nop 0
    v_permlane16_swap_b32 v46, v48
    v_permlane16_swap_b32 v47, v49
    v_pk_add_f32 v[46:47], v[46:47], v[48:49]
    v_mov_b32 v48, v46
    v_mov_b32 v49, v47
    s_nop 0
    v_permlane32_swap_b32 v46, v48
    v_permlane32_swap_b32 v47, v49
    v_pk_add_f32 v[46:47], v[46:47], v[48:49]
    ds_write_b64 v71, v[46:47] offset:0
    s_lshl_b32 s22, s60, 24
    s_lshl_b32 s23, s94, 13
    s_add_u32 s22, s22, s23
    s_add_u32 s22, s22, 167772160
    s_add_u32 s20, s4, s22
    s_addc_u32 s21, s5, 0
    s_mov_b32 s22, 8380416
    s_mov_b32 s23, 0x20000
    s_waitcnt lgkmcnt(0)
    s_barrier
    ds_read_b128 v[52:55], v72 offset:0
    ds_read_b128 v[56:59], v72 offset:16
    ds_read_b128 v[60:63], v72 offset:32
    ds_read_b128 v[64:67], v72 offset:48
    s_waitcnt lgkmcnt(0)
    v_pk_add_f32 v[52:53], v[52:53], v[54:55]
    v_pk_add_f32 v[56:57], v[56:57], v[58:59]
    v_pk_add_f32 v[60:61], v[60:61], v[62:63]
    v_pk_add_f32 v[64:65], v[64:65], v[66:67]
    v_pk_add_f32 v[52:53], v[52:53], v[56:57]
    v_pk_add_f32 v[60:61], v[60:61], v[64:65]
    v_pk_add_f32 v[52:53], v[52:53], v[60:61]
    v_mul_f32 v68, 0x3a800000, v52
    v_mul_f32 v70, 0x3a800000, v53
    v_fma_f32 v70, -v68, v68, v70
    v_max_f32 v70, 0, v70
    v_cvt_pk_bf16_f32 v68, v68, v68
    v_lshlrev_b32 v68, 16, v68
    v_cvt_pk_bf16_f32 v70, v70, v70
    v_lshlrev_b32 v70, 16, v70
    v_add_f32 v70, 0x3727c5ac, v70
    v_cvt_pk_bf16_f32 v70, v70, v70
    v_lshlrev_b32 v70, 16, v70
    v_sqrt_f32 v70, v70
    s_nop 0
    v_cvt_pk_bf16_f32 v70, v70, v70
    v_lshlrev_b32 v70, 16, v70
    v_rcp_f32 v69, v70
    s_nop 0
    v_mul_f32 v68, -v68, v69
    v_pk_fma_f32 v[28:29], v[12:13], v[68:69], v[68:69] op_sel:[0,1,0] op_sel_hi:[1,1,0]
    v_pk_fma_f32 v[30:31], v[14:15], v[68:69], v[68:69] op_sel:[0,1,0] op_sel_hi:[1,1,0]
    v_pk_fma_f32 v[32:33], v[16:17], v[68:69], v[68:69] op_sel:[0,1,0] op_sel_hi:[1,1,0]
    v_pk_fma_f32 v[34:35], v[18:19], v[68:69], v[68:69] op_sel:[0,1,0] op_sel_hi:[1,1,0]
    v_pk_fma_f32 v[36:37], v[20:21], v[68:69], v[68:69] op_sel:[0,1,0] op_sel_hi:[1,1,0]
    v_pk_fma_f32 v[38:39], v[22:23], v[68:69], v[68:69] op_sel:[0,1,0] op_sel_hi:[1,1,0]
    v_pk_fma_f32 v[40:41], v[24:25], v[68:69], v[68:69] op_sel:[0,1,0] op_sel_hi:[1,1,0]
    v_pk_fma_f32 v[42:43], v[26:27], v[68:69], v[68:69] op_sel:[0,1,0] op_sel_hi:[1,1,0]
    s_branch R_s2
R_l0:
    v_lshlrev_b32 v12, 16, v86
    v_and_b32 v13, 0xffff0000, v86
    v_lshlrev_b32 v14, 16, v87
    v_and_b32 v15, 0xffff0000, v87
    v_lshlrev_b32 v16, 16, v88
    v_and_b32 v17, 0xffff0000, v88
    v_lshlrev_b32 v18, 16, v89
    v_and_b32 v19, 0xffff0000, v89
    v_lshlrev_b32 v20, 16, v90
    v_and_b32 v21, 0xffff0000, v90
    v_lshlrev_b32 v22, 16, v91
    v_and_b32 v23, 0xffff0000, v91
    v_lshlrev_b32 v24, 16, v92
    v_and_b32 v25, 0xffff0000, v92
    v_lshlrev_b32 v26, 16, v93
    v_and_b32 v27, 0xffff0000, v93
    v_pk_add_f32 v[48:49], v[12:13], v[14:15]
    v_pk_mul_f32 v[50:51], v[12:13], v[12:13]
    v_pk_fma_f32 v[50:51], v[14:15], v[14:15], v[50:51]
    v_pk_add_f32 v[48:49], v[48:49], v[16:17]
    v_pk_fma_f32 v[50:51], v[16:17], v[16:17], v[50:51]
    v_pk_add_f32 v[48:49], v[48:49], v[18:19]
    v_pk_fma_f32 v[50:51], v[18:19], v[18:19], v[50:51]
    v_pk_add_f32 v[48:49], v[48:49], v[20:21]
    v_pk_fma_f32 v[50:51], v[20:21], v[20:21], v[50:51]
    v_pk_add_f32 v[48:49], v[48:49], v[22:23]
    v_pk_fma_f32 v[50:51], v[22:23], v[22:23], v[50:51]
    v_pk_add_f32 v[48:49], v[48:49], v[24:25]
    v_pk_fma_f32 v[50:51], v[24:25], v[24:25], v[50:51]
    v_pk_add_f32 v[48:49], v[48:49], v[26:27]
    v_pk_fma_f32 v[50:51], v[26:27], v[26:27], v[50:51]
    v_add_f32 v46, v48, v49
    v_add_f32 v47, v50, v51
    s_nop 0
    v_add_f32_dpp v46, v46, v46 row_ror:8 row_mask:0xf bank_mask:0xf
    v_add_f32_dpp v47, v47, v47 row_ror:8 row_mask:0xf bank_mask:0xf
    v_mov_b32 v48, v46
    v_mov_b32 v49, v47
    s_nop 0
    v_permlane16_swap_b32 v46, v48
    v_permlane16_swap_b32 v47, v49
    v_pk_add_f32 v[46:47], v[46:47], v[48:49]
    v_mov_b32 v48, v46
    v_mov_b32 v49, v47
    s_nop 0
    v_permlane32_swap_b32 v46, v48
    v_permlane32_swap_b32 v47, v49
    v_pk_add_f32 v[46:47], v[46:47], v[48:49]
    ds_write_b64 v71, v[46:47] offset:0
    s_cmp_ge_u32 s30, 4
    s_cbranch_scc1 w1in_12
    v_mov_b32 v6, 162836
spin_13:
    s_sleep 2
    ds_read_b32 v7, v6
    s_waitcnt lgkmcnt(0)
    v_readfirstlane_b32 s53, v7
    s_nop 0
    s_cmp_ge_u32 s53, 8
    s_cbranch_scc0 spin_13
    ds_read_b64_tr_b16 v[128:129], v74 offset:0
    ds_read_b64_tr_b16 v[130:131], v74 offset:2048
    ds_read_b64_tr_b16 v[136:137], v74 offset:4096
    ds_read_b64_tr_b16 v[138:139], v74 offset:6144
    ds_read_b64_tr_b16 v[144:145], v74 offset:8192
    ds_read_b64_tr_b16 v[146:147], v74 offset:10240
    ds_read_b64_tr_b16 v[152:153], v74 offset:12288
    ds_read_b64_tr_b16 v[154:155], v74 offset:14336
    ds_read_b64_tr_b16 v[160:161], v74 offset:16384
    ds_read_b64_tr_b16 v[162:163], v74 offset:18432
    ds_read_b64_tr_b16 v[168:169], v74 offset:20480
    ds_read_b64_tr_b16 v[170:171], v74 offset:22528
    ds_read_b64_tr_b16 v[176:177], v74 offset:24576
    ds_read_b64_tr_b16 v[178:179], v74 offset:26624
    ds_read_b64_tr_b16 v[184:185], v74 offset:28672
    ds_read_b64_tr_b16 v[186:187], v74 offset:30720
    ds_read_b64_tr_b16 v[192:193], v74 offset:32768
    ds_read_b64_tr_b16 v[194:195], v74 offset:34816
    ds_read_b64_tr_b16 v[200:201], v74 offset:36864
    ds_read_b64_tr_b16 v[202:203], v74 offset:38912
    ds_read_b64_tr_b16 v[208:209], v74 offset:40960
    ds_read_b64_tr_b16 v[210:211], v74 offset:43008
    ds_read_b64_tr_b16 v[216:217], v74 offset:45056
    ds_read_b64_tr_b16 v[218:219], v74 offset:47104
    ds_read_b64_tr_b16 v[224:225], v74 offset:49152
    ds_read_b64_tr_b16 v[226:227], v74 offset:51200
    ds_read_b64_tr_b16 v[232:233], v74 offset:53248
    ds_read_b64_tr_b16 v[234:235], v74 offset:55296
    ds_read_b64_tr_b16 v[240:241], v74 offset:57344
    ds_read_b64_tr_b16 v[242:243], v74 offset:59392
    ds_read_b64_tr_b16 v[248:249], v74 offset:61440
    ds_read_b64_tr_b16 v[250:251], v74 offset:63488
    ds_read_b64_tr_b16 v[132:133], v75 offset:0
    ds_read_b64_tr_b16 v[134:135], v75 offset:2048
    ds_read_b64_tr_b16 v[140:141], v75 offset:4096
    ds_read_b64_tr_b16 v[142:143], v75 offset:6144
    ds_read_b64_tr_b16 v[148:149], v75 offset:8192
    ds_read_b64_tr_b16 v[150:151], v75 offset:10240
    ds_read_b64_tr_b16 v[156:157], v75 offset:12288
    ds_read_b64_tr_b16 v[158:159], v75 offset:14336
    ds_read_b64_tr_b16 v[164:165], v75 offset:16384
    ds_read_b64_tr_b16 v[166:167], v75 offset:18432
    ds_read_b64_tr_b16 v[172:173], v75 offset:20480
    ds_read_b64_tr_b16 v[174:175], v75 offset:22528
    ds_read_b64_tr_b16 v[180:181], v75 offset:24576
    ds_read_b64_tr_b16 v[182:183], v75 offset:26624
    ds_read_b64_tr_b16 v[188:189], v75 offset:28672
    ds_read_b64_tr_b16 v[190:191], v75 offset:30720
    ds_read_b64_tr_b16 v[196:197], v75 offset:32768
    ds_read_b64_tr_b16 v[198:199], v75 offset:34816
    ds_read_b64_tr_b16 v[204:205], v75 offset:36864
    ds_read_b64_tr_b16 v[206:207], v75 offset:38912
    ds_read_b64_tr_b16 v[212:213], v75 offset:40960
    ds_read_b64_tr_b16 v[214:215], v75 offset:43008
    ds_read_b64_tr_b16 v[220:221], v75 offset:45056
    ds_read_b64_tr_b16 v[222:223], v75 offset:47104
    ds_read_b64_tr_b16 v[228:229], v75 offset:49152
    ds_read_b64_tr_b16 v[230:231], v75 offset:51200
    ds_read_b64_tr_b16 v[236:237], v75 offset:53248
    ds_read_b64_tr_b16 v[238:239], v75 offset:55296
    ds_read_b64_tr_b16 v[244:245], v75 offset:57344
    ds_read_b64_tr_b16 v[246:247], v75 offset:59392
    ds_read_b64_tr_b16 v[252:253], v75 offset:61440
    ds_read_b64_tr_b16 v[254:255], v75 offset:63488
    v_mov_b32 v52, 0x3f803f80
    v_mov_b32 v53, 0x3f803f80
    v_mov_b32 v54, 0x3f803f80
    v_mov_b32 v55, 0x3f803f80
    s_lshl_b32 s35, s30, 6
    s_add_u32 s35, s35, 163072
    v_and_b32 v64, 48, v1
    v_add_u32 v64, s35, v64
    s_waitcnt lgkmcnt(0)
    v_mfma_f32_16x16x32_bf16 v[56:59], v[128:131], v[52:55], 0
    v_mfma_f32_16x16x32_bf16 v[56:59], v[132:135], v[52:55], v[56:59]
    v_mfma_f32_16x16x32_bf16 v[56:59], v[136:139], v[52:55], v[56:59]
    v_mfma_f32_16x16x32_bf16 v[56:59], v[140:143], v[52:55], v[56:59]
    v_mfma_f32_16x16x32_bf16 v[56:59], v[144:147], v[52:55], v[56:59]
    v_mfma_f32_16x16x32_bf16 v[56:59], v[148:151], v[52:55], v[56:59]
    v_mfma_f32_16x16x32_bf16 v[56:59], v[152:155], v[52:55], v[56:59]
    v_mfma_f32_16x16x32_bf16 v[56:59], v[156:159], v[52:55], v[56:59]
    v_mfma_f32_16x16x32_bf16 v[56:59], v[160:163], v[52:55], v[56:59]
    v_mfma_f32_16x16x32_bf16 v[56:59], v[164:167], v[52:55], v[56:59]
    v_mfma_f32_16x16x32_bf16 v[56:59], v[168:171], v[52:55], v[56:59]
    v_mfma_f32_16x16x32_bf16 v[56:59], v[172:175], v[52:55], v[56:59]
    v_mfma_f32_16x16x32_bf16 v[56:59], v[176:179], v[52:55], v[56:59]
    v_mfma_f32_16x16x32_bf16 v[56:59], v[180:183], v[52:55], v[56:59]
    v_mfma_f32_16x16x32_bf16 v[56:59], v[184:187], v[52:55], v[56:59]
    v_mfma_f32_16x16x32_bf16 v[56:59], v[188:191], v[52:55], v[56:59]
    v_mfma_f32_16x16x32_bf16 v[56:59], v[192:195], v[52:55], v[56:59]
    v_mfma_f32_16x16x32_bf16 v[56:59], v[196:199], v[52:55], v[56:59]
    v_mfma_f32_16x16x32_bf16 v[56:59], v[200:203], v[52:55], v[56:59]
    v_mfma_f32_16x16x32_bf16 v[56:59], v[204:207], v[52:55], v[56:59]
    v_mfma_f32_16x16x32_bf16 v[56:59], v[208:211], v[52:55], v[56:59]
    v_mfma_f32_16x16x32_bf16 v[56:59], v[212:215], v[52:55], v[56:59]
    v_mfma_f32_16x16x32_bf16 v[56:59], v[216:219], v[52:55], v[56:59]
    v_mfma_f32_16x16x32_bf16 v[56:59], v[220:223], v[52:55], v[56:59]
    v_mfma_f32_16x16x32_bf16 v[56:59], v[224:227], v[52:55], v[56:59]
    v_mfma_f32_16x16x32_bf16 v[56:59], v[228:231], v[52:55], v[56:59]
    v_mfma_f32_16x16x32_bf16 v[56:59], v[232:235], v[52:55], v[56:59]
    v_mfma_f32_16x16x32_bf16 v[56:59], v[236:239], v[52:55], v[56:59]
    v_mfma_f32_16x16x32_bf16 v[56:59], v[240:243], v[52:55], v[56:59]
    v_mfma_f32_16x16x32_bf16 v[56:59], v[244:247], v[52:55], v[56:59]
    v_mfma_f32_16x16x32_bf16 v[56:59], v[248:251], v[52:55], v[56:59]
    v_mfma_f32_16x16x32_bf16 v[56:59], v[252:255], v[52:55], v[56:59]
    s_mov_b32 exec_lo, 0x10001
    s_mov_b32 exec_hi, 0x10001
    s_nop 5
    ds_write_b128 v64, v[56:59]
    s_mov_b64 exec, -1
    s_waitcnt lgkmcnt(0)
w1in_12:
    s_cmp_lg_u32 s30, 0
    s_cbranch_scc1 R_fw
    s_lshl_b32 s36, s28, 13
    s_add_u32 s36, s36, 23592960
    v_lshlrev_b32 v56, 7, v1
    v_add_u32 v56, s36, v56
    s_mov_b32 s53, 0
R_fp:
    buffer_load_dword v52, v56, s[56:59], 0 offen sc1
    s_waitcnt vmcnt(0)
    v_subrev_u32 v52, s52, v52
    v_and_b32 v53, 0xfffff8ff, v52
    v_cmp_eq_u32 vcc, 4, v53
    s_nop 0
    s_cmp_eq_u64 vcc, exec
    s_cbranch_scc1 R_fq
    s_sleep 3
    s_add_u32 s53, s53, 1
    s_cmp_lt_u32 s53, s61
    s_cbranch_scc1 R_fp
    s_mov_b32 s61, 0
R_fq:
    v_lshrrev_b32 v52, 8, v52
    v_mov_b32 v53, 162844
    ds_add_u32 v53, v52
R_fw:
    s_waitcnt lgkmcnt(0)
    s_barrier
    s_add_u32 s80, s4, 0x1c00000
    s_addc_u32 s81, s5, 0
    s_mov_b32 s82, 0x400000
    s_mov_b32 s83, 0x20000
    s_mov_b32 s78, 0
    buffer_load_dwordx2 v[110:111], v79, s[80:83], s78 offen sc1
    s_mov_b32 s78, 65536
    buffer_load_dwordx2 v[112:113], v79, s[80:83], s78 offen sc1
    s_mov_b32 s78, 262144
    buffer_load_dwordx2 v[114:115], v79, s[80:83], s78 offen sc1
    s_mov_b32 s78, 327680
    buffer_load_dwordx2 v[116:117], v79, s[80:83], s78 offen sc1
    v_mov_b32 v6, 162844
    ds_read_b32 v7, v6
    ds_read_b128 v[52:55], v72 offset:0
    ds_read_b128 v[56:59], v72 offset:16
    ds_read_b128 v[60:63], v72 offset:32
    ds_read_b128 v[64:67], v72 offset:48
    s_waitcnt lgkmcnt(0)
    v_pk_add_f32 v[52:53], v[52:53], v[54:55]
    v_pk_add_f32 v[56:57], v[56:57], v[58:59]
    v_pk_add_f32 v[60:61], v[60:61], v[62:63]
    v_pk_add_f32 v[64:65], v[64:65], v[66:67]
    v_pk_add_f32 v[52:53], v[52:53], v[56:57]
    v_pk_add_f32 v[60:61], v[60:61], v[64:65]
    v_pk_add_f32 v[52:53], v[52:53], v[60:61]
    v_mul_f32 v68, 0x3a800000, v52
    v_mul_f32 v70, 0x3a800000, v53
    v_fma_f32 v70, -v68, v68, v70
    v_max_f32 v70, 0, v70
    s_cmp_lt_u32 s30, 4
    s_cbranch_scc1 R_f2
    s_and_b32 s36, s30, 3
    s_lshl_b32 s36, s36, 10
    s_add_u32 s36, s36, 24576
    v_add_u32 v8, s36, v2
    v_add_u32 v9, 65536, v8
    ds_write_b128 v8, v[128:131] offset:0
    ds_write_b128 v8, v[136:139] offset:4096
    ds_write_b128 v8, v[144:147] offset:8192
    ds_write_b128 v8, v[152:155] offset:12288
    ds_write_b128 v8, v[160:163] offset:16384
    ds_write_b128 v8, v[168:171] offset:20480
    ds_write_b128 v8, v[176:179] offset:24576
    ds_write_b128 v8, v[184:187] offset:28672
    ds_write_b128 v8, v[192:195] offset:32768
    ds_write_b128 v8, v[200:203] offset:36864
    ds_write_b128 v8, v[208:211] offset:40960
    ds_write_b128 v8, v[216:219] offset:45056
    ds_write_b128 v8, v[224:227] offset:49152
    ds_write_b128 v8, v[232:235] offset:53248
    ds_write_b128 v8, v[240:243] offset:57344
    ds_write_b128 v8, v[248:251] offset:61440
    ds_write_b128 v9, v[132:135] offset:0
    ds_write_b128 v9, v[140:143] offset:4096
R_f2:
    v_cvt_pk_bf16_f32 v68, v68, v68
    v_lshlrev_b32 v68, 16, v68
    v_cvt_pk_bf16_f32 v70, v70, v70
    v_lshlrev_b32 v70, 16, v70
    v_add_f32 v70, 0x3727c5ac, v70
    v_cvt_pk_bf16_f32 v70, v70, v70
    v_lshlrev_b32 v70, 16, v70
    v_sqrt_f32 v70, v70
    s_nop 0
    v_cvt_pk_bf16_f32 v70, v70, v70
    v_lshlrev_b32 v70, 16, v70
    v_rcp_f32 v69, v70
    s_nop 0
    v_mul_f32 v68, -v68, v69
    v_pk_fma_f32 v[28:29], v[12:13], v[68:69], v[68:69] op_sel:[0,1,0] op_sel_hi:[1,1,0]
    v_pk_fma_f32 v[30:31], v[14:15], v[68:69], v[68:69] op_sel:[0,1,0] op_sel_hi:[1,1,0]
    v_pk_fma_f32 v[32:33], v[16:17], v[68:69], v[68:69] op_sel:[0,1,0] op_sel_hi:[1,1,0]
    v_pk_fma_f32 v[34:35], v[18:19], v[68:69], v[68:69] op_sel:[0,1,0] op_sel_hi:[1,1,0]
    v_pk_fma_f32 v[36:37], v[20:21], v[68:69], v[68:69] op_sel:[0,1,0] op_sel_hi:[1,1,0]
    v_pk_fma_f32 v[38:39], v[22:23], v[68:69], v[68:69] op_sel:[0,1,0] op_sel_hi:[1,1,0]
    v_pk_fma_f32 v[40:41], v[24:25], v[68:69], v[68:69] op_sel:[0,1,0] op_sel_hi:[1,1,0]
    v_pk_fma_f32 v[42:43], v[26:27], v[68:69], v[68:69] op_sel:[0,1,0] op_sel_hi:[1,1,0]
    v_readfirstlane_b32 s94, v7
    s_nop 0
    s_cmp_gt_u32 s94, 127
    s_cselect_b32 s94, 1, 0
    s_lshr_b32 s53, s28, 3
    s_lshl_b32 s53, s53, 2
    s_and_b32 s54, s28, 3
    s_add_u32 s53, s53, s54
    s_lshl_b32 s53, s53, 23
    s_lshr_b32 s54, s28, 2
    s_xor_b32 s54, s54, s94
    s_and_b32 s54, s54, 1
    s_lshl_b32 s54, s54, 13
    s_add_u32 s55, s53, s54
    s_add_u32 s55, s55, 33554432
    s_add_u32 s62, s4, s55
    s_addc_u32 s63, s5, 0
    s_sub_u32 s36, s28, 1
    s_max_i32 s36, s36, 0
    s_lshr_b32 s53, s36, 3
    s_lshl_b32 s53, s53, 2
    s_and_b32 s54, s36, 3
    s_add_u32 s53, s53, s54
    s_lshl_b32 s53, s53, 23
    s_lshr_b32 s54, s36, 2
    s_xor_b32 s54, s54, s94
    s_and_b32 s54, s54, 1
    s_lshl_b32 s54, s54, 13
    s_add_u32 s92, s53, s54
    s_add_u32 s92, s92, 33554432
    s_sub_u32 s92, s92, s55
    s_add_u32 s36, s28, 1
    s_min_u32 s36, s36, 15
    s_lshr_b32 s53, s36, 3
    s_lshl_b32 s53, s53, 2
    s_and_b32 s54, s36, 3
    s_add_u32 s53, s53, s54
    s_lshl_b32 s53, s53, 23
    s_lshr_b32 s54, s36, 2
    s_xor_b32 s54, s54, s94
    s_and_b32 s54, s54, 1
    s_lshl_b32 s54, s54, 13
    s_add_u32 s93, s53, s54
    s_add_u32 s93, s93, 33554432
    s_sub_u32 s93, s93, s55
    s_add_u32 s55, s55, 1835008
    s_lshl_b32 s22, s60, 24
    s_lshl_b32 s23, s94, 13
    s_add_u32 s22, s22, s23
    s_add_u32 s22, s22, 167772160
    s_add_u32 s20, s4, s22
    s_addc_u32 s21, s5, 0
    s_mov_b32 s22, 8380416
    s_mov_b32 s23, 0x20000
    s_waitcnt vmcnt(0)
    v_lshlrev_b32 v102, 16, v110
    v_and_b32 v103, 0xffff0000, v110
    v_lshlrev_b32 v104, 16, v111
    v_and_b32 v105, 0xffff0000, v111
    v_lshlrev_b32 v106, 16, v112
    v_and_b32 v107, 0xffff0000, v112
    v_lshlrev_b32 v108, 16, v113
    v_and_b32 v109, 0xffff0000, v113
    v_lshlrev_b32 v110, 16, v114
    v_and_b32 v111, 0xffff0000, v114
    v_lshlrev_b32 v112, 16, v115
    v_and_b32 v113, 0xffff0000, v115
    v_lshlrev_b32 v114, 16, v116
    v_and_b32 v115, 0xffff0000, v116
    v_lshlrev_b32 v116, 16, v117
    v_and_b32 v117, 0xffff0000, v117
R_s2:
    v_pk_fma_f32 v[12:13], v[28:29], v[102:103], v[12:13]
    v_pk_fma_f32 v[14:15], v[30:31], v[104:105], v[14:15]
    v_pk_fma_f32 v[16:17], v[32:33], v[106:107], v[16:17]
    v_pk_fma_f32 v[18:19], v[34:35], v[108:109], v[18:19]
    v_cvt_pk_bf16_f32 v86, v12, v13
    v_cvt_pk_bf16_f32 v87, v14, v15
    v_cvt_pk_bf16_f32 v88, v16, v17
    v_cvt_pk_bf16_f32 v89, v18, v19
    buffer_store_dwordx4 v[86:89], v82, s[20:23], 0 offen offset:0 sc1
    v_pk_fma_f32 v[20:21], v[36:37], v[110:111], v[20:21]
    v_pk_fma_f32 v[22:23], v[38:39], v[112:113], v[22:23]
    v_pk_fma_f32 v[24:25], v[40:41], v[114:115], v[24:25]
    v_pk_fma_f32 v[26:27], v[42:43], v[116:117], v[26:27]
    v_cvt_pk_bf16_f32 v90, v20, v21
    v_cvt_pk_bf16_f32 v91, v22, v23
    v_cvt_pk_bf16_f32 v92, v24, v25
    v_cvt_pk_bf16_f32 v93, v26, v27
    buffer_store_dwordx4 v[90:93], v82, s[20:23], 0 offen offset:128 sc1
    v_pk_add_f32 v[48:49], v[12:13], v[14:15]
    v_pk_mul_f32 v[50:51], v[12:13], v[12:13]
    v_pk_fma_f32 v[50:51], v[14:15], v[14:15], v[50:51]
    v_pk_add_f32 v[48:49], v[48:49], v[16:17]
    v_pk_fma_f32 v[50:51], v[16:17], v[16:17], v[50:51]
    v_pk_add_f32 v[48:49], v[48:49], v[18:19]
    v_pk_fma_f32 v[50:51], v[18:19], v[18:19], v[50:51]
    v_pk_add_f32 v[48:49], v[48:49], v[20:21]
    v_pk_fma_f32 v[50:51], v[20:21], v[20:21], v[50:51]
    v_pk_add_f32 v[48:49], v[48:49], v[22:23]
    v_pk_fma_f32 v[50:51], v[22:23], v[22:23], v[50:51]
    v_pk_add_f32 v[48:49], v[48:49], v[24:25]
    v_pk_fma_f32 v[50:51], v[24:25], v[24:25], v[50:51]
    v_pk_add_f32 v[48:49], v[48:49], v[26:27]
    v_pk_fma_f32 v[50:51], v[26:27], v[26:27], v[50:51]
    v_add_f32 v46, v48, v49
    v_add_f32 v47, v50, v51
    s_nop 0
    v_add_f32_dpp v46, v46, v46 row_ror:8 row_mask:0xf bank_mask:0xf
    v_add_f32_dpp v47, v47, v47 row_ror:8 row_mask:0xf bank_mask:0xf
    v_mov_b32 v48, v46
    v_mov_b32 v49, v47
    s_nop 0
    v_permlane16_swap_b32 v46, v48
    v_permlane16_swap_b32 v47, v49
    v_pk_add_f32 v[46:47], v[46:47], v[48:49]
    v_mov_b32 v48, v46
    v_mov_b32 v49, v47
    s_nop 0
    v_permlane32_swap_b32 v46, v48
    v_permlane32_swap_b32 v47, v49
    v_pk_add_f32 v[46:47], v[46:47], v[48:49]
    ds_write_b64 v71, v[46:47] offset:1536
    s_waitcnt lgkmcnt(0)
    s_barrier
    s_cmp_ge_u32 s30, 4
    s_cbranch_scc1 LOADERS
    s_cmp_lg_u32 s30, 3
    s_cbranch_scc1 R_nl
    ds_read_b128 v[52:55], v72 offset:1536
    ds_read_b128 v[56:59], v72 offset:1552
    ds_read_b128 v[60:63], v72 offset:1568
    ds_read_b128 v[64:67], v72 offset:1584
    s_waitcnt lgkmcnt(0)
    v_pk_add_f32 v[52:53], v[52:53], v[54:55]
    v_pk_add_f32 v[56:57], v[56:57], v[58:59]
    v_pk_add_f32 v[60:61], v[60:61], v[62:63]
    v_pk_add_f32 v[64:65], v[64:65], v[66:67]
    v_pk_add_f32 v[52:53], v[52:53], v[56:57]
    v_pk_add_f32 v[60:61], v[60:61], v[64:65]
    v_pk_add_f32 v[52:53], v[52:53], v[60:61]
    v_mul_f32 v68, 0x3a800000, v52
    v_mul_f32 v70, 0x3a800000, v53
    v_fma_f32 v70, -v68, v68, v70
    v_max_f32 v70, 0, v70
    v_mov_b32 v32, v68
    v_mov_b32 v33, v70
    v_cvt_pk_bf16_f32 v68, v68, v68
    v_lshlrev_b32 v68, 16, v68
    v_cvt_pk_bf16_f32 v70, v70, v70
    v_lshlrev_b32 v70, 16, v70
    v_add_f32 v70, 0x3727c5ac, v70
    v_cvt_pk_bf16_f32 v70, v70, v70
    v_lshlrev_b32 v70, 16, v70
    v_sqrt_f32 v70, v70
    s_nop 0
    v_cvt_pk_bf16_f32 v70, v70, v70
    v_lshlrev_b32 v70, 16, v70
    v_rcp_f32 v69, v70
    v_sub_f32 v32, v32, v68
    v_mul_f32 v32, v32, v69
    v_mul_f32 v33, v33, v69
    v_mul_f32 v33, v33, v69
    v_cvt_pk_bf16_f32 v32, v32, v32
    v_lshlrev_b32 v32, 16, v32
    v_cvt_pk_bf16_f32 v33, v33, v33
    v_lshlrev_b32 v33, 16, v33
    v_add_f32 v33, 0x3727c5ac, v33
    v_cvt_pk_bf16_f32 v33, v33, v33
    v_lshlrev_b32 v33, 16, v33
    v_sqrt_f32 v33, v33
    s_nop 0
    v_cvt_pk_bf16_f32 v33, v33, v33
    v_lshlrev_b32 v33, 16, v33
    v_cvt_pk_bf16_f32 v28, v68, v70
    v_cvt_pk_bf16_f32 v30, v32, v33
    v_mov_b32 v29, s52
    v_mov_b32 v31, s52
    s_lshl_b32 s26, s60, 15
    s_add_u32 s26, s26, 23199744
    s_add_u32 s24, s4, s26
    s_addc_u32 s25, s5, 0
    s_mov_b32 s26, 32768
    s_mov_b32 s27, 0x20000
    s_lshl_b32 s36, s28, 4
    s_add_u32 s36, s36, s29
    s_lshl_b32 s36, s36, 7
    s_mov_b64 exec, 0xff
    buffer_store_dwordx4 v[28:31], v2, s[24:27], s36 offen sc1
    s_mov_b64 exec, -1
R_nl:
    v_mov_b32 v6, 1
    v_mov_b32 v7, 0
    s_cmp_eq_u32 s30, 3
    s_waitcnt vmcnt(1)
    s_cbranch_scc1 R_n2
    s_waitcnt vmcnt(0)
R_n2:
    s_barrier
    s_cmp_lg_u32 s30, 0
    s_cbranch_scc1 R_n3
    s_mov_b64 exec, 1
    buffer_atomic_add v6, v7, s[56:59], s55 offen sc1
    s_mov_b64 exec, -1
R_n3:
    v_and_b32 v8, 15, v1
    v_lshrrev_b32 v9, 4, v1
    s_lshl_b32 s36, s30, 6
    s_add_u32 s36, s36, 163072
    v_lshlrev_b32 v6, 4, v9
    v_add_u32 v6, s36, v6
    ds_read_b128 v[84:87], v6
    v_xor_b32 v6, v9, v8
    v_lshlrev_b32 v7, 8, v8
    v_xor_b32 v10, 0, v6
    v_lshl_add_u32 v10, v10, 4, v7
    v_add_u32 v14, 106496, v10
    v_xor_b32 v11, 4, v6
    v_lshl_add_u32 v11, v11, 4, v7
    v_add_u32 v15, 106496, v11
    v_xor_b32 v12, 8, v6
    v_lshl_add_u32 v12, v12, 4, v7
    v_add_u32 v16, 106496, v12
    v_xor_b32 v13, 12, v6
    v_lshl_add_u32 v13, v13, 4, v7
    v_add_u32 v17, 106496, v13
    v_lshlrev_b32 v18, 4, v8
    v_add_u32 v18, 155648, v18
    s_add_u32 s16, s62, 0x400000
    s_addc_u32 s17, s63, 0
    s_mov_b32 s18, 0x7e000
    s_mov_b32 s19, 0x20000
    v_and_b32 v6, 1, v9
    v_lshlrev_b32 v114, 16, v6
    v_lshrrev_b32 v6, 1, v9
    v_lshl_add_u32 v114, v6, 8, v114
    v_lshl_add_u32 v114, v8, 4, v114
    s_bfe_u32 s36, s30, 0x10001
    s_lshl1_add_u32 s36, s29, s36
    s_lshr_b32 s53, s36, 3
    s_lshl_b32 s53, s53, 14
    s_and_b32 s39, s36, 7
    s_lshl_b32 s39, s39, 10
    s_add_u32 s39, s39, s53
    s_and_b32 s36, s30, 1
    s_lshl_b32 s36, s36, 9
    s_add_u32 s39, s39, s36
    s_and_b32 s12, s30, 3
    s_lshl_b32 s12, s12, 15
    s_add_u32 s53, s67, 0
    s_and_b32 s8, s53, 4
    s_and_b32 s53, s53, 2
    s_lshl_b32 s8, s8, 12
    s_lshl_b32 s53, s53, 11
    s_add_u32 s8, s8, s53
    s_add_u32 s8, s8, s12
    s_add_u32 s53, s67, 2
    s_and_b32 s9, s53, 4
    s_and_b32 s53, s53, 2
    s_lshl_b32 s9, s9, 12
    s_lshl_b32 s53, s53, 11
    s_add_u32 s9, s9, s53
    s_add_u32 s9, s9, s12
    s_add_u32 s53, s67, 4
    s_and_b32 s10, s53, 4
    s_and_b32 s53, s53, 2
    s_lshl_b32 s10, s10, 12
    s_lshl_b32 s53, s53, 11
    s_add_u32 s10, s10, s53
    s_add_u32 s10, s10, s12
    s_add_u32 s53, s67, 6
    s_and_b32 s11, s53, 4
    s_and_b32 s53, s53, 2
    s_lshl_b32 s11, s11, 12
    s_lshl_b32 s53, s53, 11
    s_add_u32 s11, s11, s53
    s_add_u32 s11, s11, s12
    s_and_b32 s53, s30, 2
    s_lshl_b32 s53, s53, 11
    s_and_b32 s12, s30, 1
    s_lshl_b32 s12, s12, 13
    s_add_u32 s12, s12, s53
    s_and_b32 s20, s30, 1
    s_lshl_b32 s20, s20, 8
    s_add_u32 s20, s20, s55
    s_add_u32 s21, s52, 16
    v_mov_b32 v112, 0x7f000000
    v_writelane_b32 v112, 0, 0
    v_mov_b32 v113, 1
    s_and_b32 s40, s30, 1
    s_lshl1_add_u32 s40, s31, s40
    s_lshl_b32 s40, s40, 7
    s_add_u32 s40, s40, s55
    s_barrier
    s_cmp_eq_u32 s60, 0
    s_cbranch_scc1 WX_1
    ds_read_b64_tr_b16 v[240:241], v74 offset:57344
    ds_read_b64_tr_b16 v[242:243], v74 offset:59392
    ds_read_b64_tr_b16 v[248:249], v74 offset:61440
    ds_read_b64_tr_b16 v[250:251], v74 offset:63488
    ds_read_b64_tr_b16 v[132:133], v75 offset:0
    ds_read_b64_tr_b16 v[134:135], v75 offset:2048
    ds_read_b64_tr_b16 v[140:141], v75 offset:4096
    ds_read_b64_tr_b16 v[142:143], v75 offset:6144
    ds_read_b64_tr_b16 v[144:145], v74 offset:8192
    ds_read_b64_tr_b16 v[146:147], v74 offset:10240
    ds_read_b64_tr_b16 v[152:153], v74 offset:12288
    ds_read_b64_tr_b16 v[154:155], v74 offset:14336
    ds_read_b64_tr_b16 v[160:161], v74 offset:16384
    ds_read_b64_tr_b16 v[162:163], v74 offset:18432
    ds_read_b64_tr_b16 v[168:169], v74 offset:20480
    ds_read_b64_tr_b16 v[170:171], v74 offset:22528
    ds_read_b64_tr_b16 v[148:149], v75 offset:8192
    ds_read_b64_tr_b16 v[150:151], v75 offset:10240
    ds_read_b64_tr_b16 v[156:157], v75 offset:12288
    ds_read_b64_tr_b16 v[158:159], v75 offset:14336
    ds_read_b64_tr_b16 v[164:165], v75 offset:16384
    ds_read_b64_tr_b16 v[166:167], v75 offset:18432
    ds_read_b64_tr_b16 v[172:173], v75 offset:20480
    ds_read_b64_tr_b16 v[174:175], v75 offset:22528
WX_1:
    s_cmp_lg_u32 s30, 0
    s_cbranch_scc1 pdone_14
    s_add_u32 s54, s55, 0
    s_bitcmp1_b32 s29, 2
    s_cselect_b32 s53, s93, s92
    s_add_u32 s53, s53, s54
    v_mov_b32 v105, s54
    v_writelane_b32 v105, s53, 1
    s_mov_b32 s53, 0
    s_add_u32 s54, s52, 16
    s_bfm_b64 exec, 2, 0
poll_15:
    buffer_load_dword v104, v105, s[56:59], 0 offen sc1
    s_waitcnt vmcnt(0)
    v_cmp_eq_u32 vcc, s54, v104
    s_nop 0
    s_cmp_eq_u64 vcc, exec
    s_cbranch_scc1 pok_16
    s_sleep 3
    s_add_u32 s53, s53, 1
    s_cmp_lt_u32 s53, s61
    s_cbranch_scc1 poll_15
    s_mov_b32 s61, 0
pok_16:
    s_mov_b64 exec, -1
pdone_14:
    s_waitcnt lgkmcnt(0)
    s_barrier
    s_barrier
    ds_read_b128 v[36:39], v10 offset:16384
    ds_read_b128 v[40:43], v10 offset:20480
    ds_read_b128 v[44:47], v10 offset:24576
    ds_read_b128 v[48:51], v10 offset:28672
    ds_read_b128 v[52:55], v11 offset:16384
    ds_read_b128 v[56:59], v11 offset:20480
    ds_read_b128 v[60:63], v11 offset:24576
    ds_read_b128 v[64:67], v11 offset:28672
    s_waitcnt lgkmcnt(4)
    v_mfma_f32_16x16x32_bf16 v[20:23], v[128:131], v[36:39], 0
    ds_read_b128 v[68:71], v12 offset:16384
    v_mfma_f32_16x16x32_bf16 v[24:27], v[128:131], v[40:43], 0
    ds_read_b128 v[72:75], v12 offset:20480
    v_mfma_f32_16x16x32_bf16 v[24:27], v[132:135], v[48:51], v[24:27]
    ds_read_b128 v[76:79], v12 offset:24576
    v_mfma_f32_16x16x32_bf16 v[20:23], v[132:135], v[44:47], v[20:23]
    ds_read_b128 v[80:83], v12 offset:28672
    s_waitcnt lgkmcnt(4)
    v_mfma_f32_16x16x32_bf16 v[20:23], v[136:139], v[52:55], v[20:23]
    ds_read_b128 v[36:39], v13 offset:16384
    v_mfma_f32_16x16x32_bf16 v[24:27], v[136:139], v[56:59], v[24:27]
    ds_read_b128 v[40:43], v13 offset:20480
    v_mfma_f32_16x16x32_bf16 v[24:27], v[140:143], v[64:67], v[24:27]
    ds_read_b128 v[44:47], v13 offset:24576
    v_mfma_f32_16x16x32_bf16 v[20:23], v[140:143], v[60:63], v[20:23]
    ds_read_b128 v[48:51], v13 offset:28672
    s_barrier
    s_waitcnt lgkmcnt(4)
    v_mfma_f32_16x16x32_bf16 v[20:23], v[144:147], v[68:71], v[20:23]
    ds_read_b128 v[52:55], v10 offset:32768
    v_mfma_f32_16x16x32_bf16 v[24:27], v[144:147], v[72:75], v[24:27]
    ds_read_b128 v[56:59], v10 offset:36864
    v_mfma_f32_16x16x32_bf16 v[24:27], v[148:151], v[80:83], v[24:27]
    ds_read_b128 v[60:63], v10 offset:40960
    v_mfma_f32_16x16x32_bf16 v[20:23], v[148:151], v[76:79], v[20:23]
    ds_read_b128 v[64:67], v10 offset:45056
    s_waitcnt lgkmcnt(4)
    v_mfma_f32_16x16x32_bf16 v[20:23], v[152:155], v[36:39], v[20:23]
    ds_read_b128 v[68:71], v11 offset:32768
    v_mfma_f32_16x16x32_bf16 v[24:27], v[152:155], v[40:43], v[24:27]
    ds_read_b128 v[72:75], v11 offset:36864
    v_mfma_f32_16x16x32_bf16 v[24:27], v[156:159], v[48:51], v[24:27]
    ds_read_b128 v[76:79], v11 offset:40960
    v_mfma_f32_16x16x32_bf16 v[20:23], v[156:159], v[44:47], v[20:23]
    ds_read_b128 v[80:83], v11 offset:45056
    s_waitcnt lgkmcnt(4)
    v_mfma_f32_16x16x32_bf16 v[20:23], v[160:163], v[52:55], v[20:23]
    ds_read_b128 v[36:39], v12 offset:32768
    v_mfma_f32_16x16x32_bf16 v[24:27], v[160:163], v[56:59], v[24:27]
    ds_read_b128 v[40:43], v12 offset:36864
    v_mfma_f32_16x16x32_bf16 v[24:27], v[164:167], v[64:67], v[24:27]
    ds_read_b128 v[44:47], v12 offset:40960
    v_mfma_f32_16x16x32_bf16 v[20:23], v[164:167], v[60:63], v[20:23]
    ds_read_b128 v[48:51], v12 offset:45056
    s_waitcnt lgkmcnt(4)
    v_mfma_f32_16x16x32_bf16 v[20:23], v[168:171], v[68:71], v[20:23]
    ds_read_b128 v[52:55], v13 offset:32768
    v_mfma_f32_16x16x32_bf16 v[24:27], v[168:171], v[72:75], v[24:27]
    ds_read_b128 v[56:59], v13 offset:36864
    v_mfma_f32_16x16x32_bf16 v[24:27], v[172:175], v[80:83], v[24:27]
    ds_read_b128 v[60:63], v13 offset:40960
    v_mfma_f32_16x16x32_bf16 v[20:23], v[172:175], v[76:79], v[20:23]
    ds_read_b128 v[64:67], v13 offset:45056
    s_barrier
    s_waitcnt lgkmcnt(4)
    v_mfma_f32_16x16x32_bf16 v[20:23], v[176:179], v[36:39], v[20:23]
    ds_read_b128 v[68:71], v14 offset:0
    v_mfma_f32_16x16x32_bf16 v[24:27], v[176:179], v[40:43], v[24:27]
    ds_read_b128 v[72:75], v14 offset:4096
    v_mfma_f32_16x16x32_bf16 v[24:27], v[180:183], v[48:51], v[24:27]
    ds_read_b128 v[76:79], v14 offset:8192
    v_mfma_f32_16x16x32_bf16 v[20:23], v[180:183], v[44:47], v[20:23]
    ds_read_b128 v[80:83], v14 offset:12288
    s_waitcnt lgkmcnt(4)
    v_mfma_f32_16x16x32_bf16 v[20:23], v[184:187], v[52:55], v[20:23]
    ds_read_b128 v[36:39], v15 offset:0
    v_mfma_f32_16x16x32_bf16 v[24:27], v[184:187], v[56:59], v[24:27]
    ds_read_b128 v[40:43], v15 offset:4096
    v_mfma_f32_16x16x32_bf16 v[24:27], v[188:191], v[64:67], v[24:27]
    ds_read_b128 v[44:47], v15 offset:8192
    v_mfma_f32_16x16x32_bf16 v[20:23], v[188:191], v[60:63], v[20:23]
    ds_read_b128 v[48:51], v15 offset:12288
    s_waitcnt lgkmcnt(4)
    v_mfma_f32_16x16x32_bf16 v[20:23], v[192:195], v[68:71], v[20:23]
    ds_read_b128 v[52:55], v16 offset:0
    v_mfma_f32_16x16x32_bf16 v[24:27], v[192:195], v[72:75], v[24:27]
    ds_read_b128 v[56:59], v16 offset:4096
    v_mfma_f32_16x16x32_bf16 v[24:27], v[196:199], v[80:83], v[24:27]
    ds_read_b128 v[60:63], v16 offset:8192
    v_mfma_f32_16x16x32_bf16 v[20:23], v[196:199], v[76:79], v[20:23]
    ds_read_b128 v[64:67], v16 offset:12288
    s_waitcnt lgkmcnt(4)
    v_mfma_f32_16x16x32_bf16 v[20:23], v[200:203], v[36:39], v[20:23]
    ds_read_b128 v[68:71], v17 offset:0
    v_mfma_f32_16x16x32_bf16 v[24:27], v[200:203], v[40:43], v[24:27]
    ds_read_b128 v[72:75], v17 offset:4096
    v_mfma_f32_16x16x32_bf16 v[24:27], v[204:207], v[48:51], v[24:27]
    ds_read_b128 v[76:79], v17 offset:8192
    v_mfma_f32_16x16x32_bf16 v[20:23], v[204:207], v[44:47], v[20:23]
    ds_read_b128 v[80:83], v17 offset:12288
    s_barrier
    s_waitcnt lgkmcnt(4)
    v_mfma_f32_16x16x32_bf16 v[20:23], v[208:211], v[52:55], v[20:23]
    ds_read_b128 v[36:39], v14 offset:16384
    v_mfma_f32_16x16x32_bf16 v[24:27], v[208:211], v[56:59], v[24:27]
    ds_read_b128 v[40:43], v14 offset:20480
    v_mfma_f32_16x16x32_bf16 v[24:27], v[212:215], v[64:67], v[24:27]
    ds_read_b128 v[44:47], v14 offset:24576
    v_mfma_f32_16x16x32_bf16 v[20:23], v[212:215], v[60:63], v[20:23]
    ds_read_b128 v[48:51], v14 offset:28672
    s_waitcnt lgkmcnt(4)
    v_mfma_f32_16x16x32_bf16 v[20:23], v[216:219], v[68:71], v[20:23]
    ds_read_b128 v[52:55], v15 offset:16384
    v_mfma_f32_16x16x32_bf16 v[24:27], v[216:219], v[72:75], v[24:27]
    ds_read_b128 v[56:59], v15 offset:20480
    v_mfma_f32_16x16x32_bf16 v[24:27], v[220:223], v[80:83], v[24:27]
    ds_read_b128 v[60:63], v15 offset:24576
    v_mfma_f32_16x16x32_bf16 v[20:23], v[220:223], v[76:79], v[20:23]
    ds_read_b128 v[64:67], v15 offset:28672
    s_waitcnt lgkmcnt(4)
    v_mfma_f32_16x16x32_bf16 v[20:23], v[224:227], v[36:39], v[20:23]
    ds_read_b128 v[68:71], v16 offset:16384
    v_mfma_f32_16x16x32_bf16 v[24:27], v[224:227], v[40:43], v[24:27]
    ds_read_b128 v[72:75], v16 offset:20480
    v_mfma_f32_16x16x32_bf16 v[24:27], v[228:231], v[48:51], v[24:27]
    ds_read_b128 v[76:79], v16 offset:24576
    v_mfma_f32_16x16x32_bf16 v[20:23], v[228:231], v[44:47], v[20:23]
    ds_read_b128 v[80:83], v16 offset:28672
    s_waitcnt lgkmcnt(4)
    v_mfma_f32_16x16x32_bf16 v[20:23], v[232:235], v[52:55], v[20:23]
    ds_read_b128 v[36:39], v17 offset:16384
    v_mfma_f32_16x16x32_bf16 v[24:27], v[232:235], v[56:59], v[24:27]
    ds_read_b128 v[40:43], v17 offset:20480
    v_mfma_f32_16x16x32_bf16 v[24:27], v[236:239], v[64:67], v[24:27]
    ds_read_b128 v[44:47], v17 offset:24576
    v_mfma_f32_16x16x32_bf16 v[20:23], v[236:239], v[60:63], v[20:23]
    ds_read_b128 v[48:51], v17 offset:28672
    s_barrier
    ds_read_b128 v[88:91], v18 offset:0
    ds_read_b128 v[92:95], v18 offset:2048
    ds_read_b128 v[96:99], v18 offset:256
    ds_read_b128 v[100:103], v18 offset:2304
    s_waitcnt lgkmcnt(8)
    v_mfma_f32_16x16x32_bf16 v[20:23], v[240:243], v[68:71], v[20:23]
    ds_read_b128 v[52:55], v14 offset:32768
    v_mfma_f32_16x16x32_bf16 v[24:27], v[240:243], v[72:75], v[24:27]
    ds_read_b128 v[56:59], v14 offset:36864
    v_mfma_f32_16x16x32_bf16 v[24:27], v[244:247], v[80:83], v[24:27]
    ds_read_b128 v[60:63], v14 offset:40960
    v_mfma_f32_16x16x32_bf16 v[20:23], v[244:247], v[76:79], v[20:23]
    ds_read_b128 v[64:67], v14 offset:45056
    s_waitcnt lgkmcnt(8)
    v_mfma_f32_16x16x32_bf16 v[20:23], v[248:251], v[36:39], v[20:23]
    ds_read_b128 v[68:71], v15 offset:32768
    v_mfma_f32_16x16x32_bf16 v[24:27], v[248:251], v[40:43], v[24:27]
    ds_read_b128 v[72:75], v15 offset:36864
    v_mfma_f32_16x16x32_bf16 v[24:27], v[252:255], v[48:51], v[24:27]
    ds_read_b128 v[76:79], v15 offset:40960
    v_mfma_f32_16x16x32_bf16 v[20:23], v[252:255], v[44:47], v[20:23]
    ds_read_b128 v[80:83], v15 offset:45056
    s_waitcnt lgkmcnt(4)
    v_mfma_f32_16x16x32_bf16 v[28:31], v[128:131], v[52:55], 0
    ds_read_b128 v[36:39], v16 offset:32768
    v_mfma_f32_16x16x32_bf16 v[32:35], v[128:131], v[56:59], 0
    ds_read_b128 v[40:43], v16 offset:36864
    v_mfma_f32_16x16x32_bf16 v[32:35], v[132:135], v[64:67], v[32:35]
    ds_read_b128 v[44:47], v16 offset:40960
    v_mfma_f32_16x16x32_bf16 v[28:31], v[132:135], v[60:63], v[28:31]
    ds_read_b128 v[48:51], v16 offset:45056
    v_pk_fma_f32 v[20:21], v[88:89], v[84:85], v[20:21]
    v_pk_fma_f32 v[22:23], v[88:89], v[86:87], v[22:23]
    v_pk_fma_f32 v[24:25], v[96:97], v[84:85], v[24:25]
    v_pk_fma_f32 v[26:27], v[96:97], v[86:87], v[26:27]
    v_pk_mul_f32 v[104:105], v[20:21], v[20:21]
    v_pk_mul_f32 v[106:107], v[22:23], v[22:23]
    v_pk_mul_f32 v[108:109], v[24:25], v[24:25]
    v_pk_mul_f32 v[110:111], v[26:27], v[26:27]
    v_pk_fma_f32 v[104:105], v[104:105], v[92:93], v[90:91]
    v_pk_fma_f32 v[106:107], v[106:107], v[92:93], v[90:91]
    v_pk_fma_f32 v[108:109], v[108:109], v[100:101], v[98:99]
    v_pk_fma_f32 v[110:111], v[110:111], v[100:101], v[98:99]
    v_pk_mul_f32 v[104:105], v[104:105], v[20:21]
    v_pk_mul_f32 v[106:107], v[106:107], v[22:23]
    v_pk_mul_f32 v[108:109], v[108:109], v[24:25]
    v_pk_mul_f32 v[110:111], v[110:111], v[26:27]
    v_exp_f32 v104, v104
    v_exp_f32 v105, v105
    v_exp_f32 v106, v106
    v_exp_f32 v107, v107
    v_exp_f32 v108, v108
    v_exp_f32 v109, v109
    v_exp_f32 v110, v110
    v_exp_f32 v111, v111
    v_pk_fma_f32 v[104:105], v[104:105], v[94:95], v[94:95]
    v_pk_fma_f32 v[106:107], v[106:107], v[94:95], v[94:95]
    v_pk_fma_f32 v[108:109], v[108:109], v[102:103], v[102:103]
    v_pk_fma_f32 v[110:111], v[110:111], v[102:103], v[102:103]
    v_rcp_f32 v104, v104
    v_rcp_f32 v105, v105
    v_rcp_f32 v106, v106
    v_rcp_f32 v107, v107
    v_rcp_f32 v108, v108
    v_rcp_f32 v109, v109
    v_rcp_f32 v110, v110
    v_rcp_f32 v111, v111
    v_pk_mul_f32 v[20:21], v[20:21], v[104:105]
    v_pk_mul_f32 v[22:23], v[22:23], v[106:107]
    v_pk_mul_f32 v[24:25], v[24:25], v[108:109]
    v_pk_mul_f32 v[26:27], v[26:27], v[110:111]
    v_add_u32 v20, 0x10000, v20
    v_add_u32 v22, 0x10000, v22
    v_add_u32 v24, 0x10000, v24
    v_add_u32 v26, 0x10000, v26
    v_and_b32 v20, 0xfffe0000, v20
    v_and_b32 v22, 0xfffe0000, v22
    v_and_b32 v24, 0xfffe0000, v24
    v_and_b32 v26, 0xfffe0000, v26
    v_cvt_pk_bf16_f32 v104, v20, v21
    v_cvt_pk_bf16_f32 v105, v22, v23
    v_cvt_pk_bf16_f32 v106, v24, v25
    v_cvt_pk_bf16_f32 v107, v26, v27
    s_add_u32 s36, s39, 0
    v_permlane16_swap_b32 v104, v106
    v_permlane16_swap_b32 v105, v107
    buffer_store_dwordx4 v[104:107], v114, s[16:19], s36 offen sc1
    s_waitcnt lgkmcnt(4)
    v_mfma_f32_16x16x32_bf16 v[28:31], v[136:139], v[68:71], v[28:31]
    ds_read_b128 v[52:55], v17 offset:32768
    v_mfma_f32_16x16x32_bf16 v[32:35], v[136:139], v[72:75], v[32:35]
    ds_read_b128 v[56:59], v17 offset:36864
    v_mfma_f32_16x16x32_bf16 v[32:35], v[140:143], v[80:83], v[32:35]
    ds_read_b128 v[60:63], v17 offset:40960
    v_mfma_f32_16x16x32_bf16 v[28:31], v[140:143], v[76:79], v[28:31]
    ds_read_b128 v[64:67], v17 offset:45056
    s_barrier
    s_waitcnt lgkmcnt(4)
    v_mfma_f32_16x16x32_bf16 v[28:31], v[144:147], v[36:39], v[28:31]
    ds_read_b128 v[68:71], v10 offset:16384
    v_mfma_f32_16x16x32_bf16 v[32:35], v[144:147], v[40:43], v[32:35]
    ds_read_b128 v[72:75], v10 offset:20480
    v_mfma_f32_16x16x32_bf16 v[32:35], v[148:151], v[48:51], v[32:35]
    ds_read_b128 v[76:79], v10 offset:24576
    v_mfma_f32_16x16x32_bf16 v[28:31], v[148:151], v[44:47], v[28:31]
    ds_read_b128 v[80:83], v10 offset:28672
    s_waitcnt lgkmcnt(4)
    v_mfma_f32_16x16x32_bf16 v[28:31], v[152:155], v[52:55], v[28:31]
    ds_read_b128 v[36:39], v11 offset:16384
    v_mfma_f32_16x16x32_bf16 v[32:35], v[152:155], v[56:59], v[32:35]
    ds_read_b128 v[40:43], v11 offset:20480
    v_mfma_f32_16x16x32_bf16 v[32:35], v[156:159], v[64:67], v[32:35]
    ds_read_b128 v[44:47], v11 offset:24576
    v_mfma_f32_16x16x32_bf16 v[28:31], v[156:159], v[60:63], v[28:31]
    ds_read_b128 v[48:51], v11 offset:28672
    s_waitcnt lgkmcnt(4)
    v_mfma_f32_16x16x32_bf16 v[28:31], v[160:163], v[68:71], v[28:31]
    ds_read_b128 v[52:55], v12 offset:16384
    v_mfma_f32_16x16x32_bf16 v[32:35], v[160:163], v[72:75], v[32:35]
    ds_read_b128 v[56:59], v12 offset:20480
    v_mfma_f32_16x16x32_bf16 v[32:35], v[164:167], v[80:83], v[32:35]
    ds_read_b128 v[60:63], v12 offset:24576
    v_mfma_f32_16x16x32_bf16 v[28:31], v[164:167], v[76:79], v[28:31]
    ds_read_b128 v[64:67], v12 offset:28672
    s_waitcnt lgkmcnt(4)
    v_mfma_f32_16x16x32_bf16 v[28:31], v[168:171], v[36:39], v[28:31]
    ds_read_b128 v[68:71], v13 offset:16384
    v_mfma_f32_16x16x32_bf16 v[32:35], v[168:171], v[40:43], v[32:35]
    ds_read_b128 v[72:75], v13 offset:20480
    v_mfma_f32_16x16x32_bf16 v[32:35], v[172:175], v[48:51], v[32:35]
    ds_read_b128 v[76:79], v13 offset:24576
    v_mfma_f32_16x16x32_bf16 v[28:31], v[172:175], v[44:47], v[28:31]
    ds_read_b128 v[80:83], v13 offset:28672
    s_barrier
    s_waitcnt lgkmcnt(4)
    v_mfma_f32_16x16x32_bf16 v[28:31], v[176:179], v[52:55], v[28:31]
    ds_read_b128 v[36:39], v10 offset:32768
    v_mfma_f32_16x16x32_bf16 v[32:35], v[176:179], v[56:59], v[32:35]
    ds_read_b128 v[40:43], v10 offset:36864
    v_mfma_f32_16x16x32_bf16 v[32:35], v[180:183], v[64:67], v[32:35]
    ds_read_b128 v[44:47], v10 offset:40960
    v_mfma_f32_16x16x32_bf16 v[28:31], v[180:183], v[60:63], v[28:31]
    ds_read_b128 v[48:51], v10 offset:45056
    s_waitcnt lgkmcnt(4)
    v_mfma_f32_16x16x32_bf16 v[28:31], v[184:187], v[68:71], v[28:31]
    ds_read_b128 v[52:55], v11 offset:32768
    v_mfma_f32_16x16x32_bf16 v[32:35], v[184:187], v[72:75], v[32:35]
    ds_read_b128 v[56:59], v11 offset:36864
    v_mfma_f32_16x16x32_bf16 v[32:35], v[188:191], v[80:83], v[32:35]
    ds_read_b128 v[60:63], v11 offset:40960
    v_mfma_f32_16x16x32_bf16 v[28:31], v[188:191], v[76:79], v[28:31]
    ds_read_b128 v[64:67], v11 offset:45056
    s_waitcnt lgkmcnt(4)
    v_mfma_f32_16x16x32_bf16 v[28:31], v[192:195], v[36:39], v[28:31]
    ds_read_b128 v[68:71], v12 offset:32768
    v_mfma_f32_16x16x32_bf16 v[32:35], v[192:195], v[40:43], v[32:35]
    ds_read_b128 v[72:75], v12 offset:36864
    v_mfma_f32_16x16x32_bf16 v[32:35], v[196:199], v[48:51], v[32:35]
    ds_read_b128 v[76:79], v12 offset:40960
    v_mfma_f32_16x16x32_bf16 v[28:31], v[196:199], v[44:47], v[28:31]
    ds_read_b128 v[80:83], v12 offset:45056
    s_waitcnt lgkmcnt(4)
    v_mfma_f32_16x16x32_bf16 v[28:31], v[200:203], v[52:55], v[28:31]
    ds_read_b128 v[36:39], v13 offset:32768
    v_mfma_f32_16x16x32_bf16 v[32:35], v[200:203], v[56:59], v[32:35]
    ds_read_b128 v[40:43], v13 offset:36864
    v_mfma_f32_16x16x32_bf16 v[32:35], v[204:207], v[64:67], v[32:35]
    ds_read_b128 v[44:47], v13 offset:40960
    v_mfma_f32_16x16x32_bf16 v[28:31], v[204:207], v[60:63], v[28:31]
    ds_read_b128 v[48:51], v13 offset:45056
    s_barrier
    s_waitcnt lgkmcnt(4)
    v_mfma_f32_16x16x32_bf16 v[28:31], v[208:211], v[68:71], v[28:31]
    ds_read_b128 v[52:55], v14 offset:0
    v_mfma_f32_16x16x32_bf16 v[32:35], v[208:211], v[72:75], v[32:35]
    ds_read_b128 v[56:59], v14 offset:4096
    v_mfma_f32_16x16x32_bf16 v[32:35], v[212:215], v[80:83], v[32:35]
    ds_read_b128 v[60:63], v14 offset:8192
    v_mfma_f32_16x16x32_bf16 v[28:31], v[212:215], v[76:79], v[28:31]
    ds_read_b128 v[64:67], v14 offset:12288
    s_waitcnt lgkmcnt(4)
    v_mfma_f32_16x16x32_bf16 v[28:31], v[216:219], v[36:39], v[28:31]
    ds_read_b128 v[68:71], v15 offset:0
    v_mfma_f32_16x16x32_bf16 v[32:35], v[216:219], v[40:43], v[32:35]
    ds_read_b128 v[72:75], v15 offset:4096
    v_mfma_f32_16x16x32_bf16 v[32:35], v[220:223], v[48:51], v[32:35]
    ds_read_b128 v[76:79], v15 offset:8192
    v_mfma_f32_16x16x32_bf16 v[28:31], v[220:223], v[44:47], v[28:31]
    ds_read_b128 v[80:83], v15 offset:12288
    s_waitcnt lgkmcnt(4)
    v_mfma_f32_16x16x32_bf16 v[28:31], v[224:227], v[52:55], v[28:31]
    ds_read_b128 v[36:39], v16 offset:0
    v_mfma_f32_16x16x32_bf16 v[32:35], v[224:227], v[56:59], v[32:35]
    ds_read_b128 v[40:43], v16 offset:4096
    v_mfma_f32_16x16x32_bf16 v[32:35], v[228:231], v[64:67], v[32:35]
    ds_read_b128 v[44:47], v16 offset:8192
    v_mfma_f32_16x16x32_bf16 v[28:31], v[228:231], v[60:63], v[28:31]
    ds_read_b128 v[48:51], v16 offset:12288
    s_waitcnt lgkmcnt(4)
    v_mfma_f32_16x16x32_bf16 v[28:31], v[232:235], v[68:71], v[28:31]
    ds_read_b128 v[52:55], v17 offset:0
    v_mfma_f32_16x16x32_bf16 v[32:35], v[232:235], v[72:75], v[32:35]
    ds_read_b128 v[56:59], v17 offset:4096
    v_mfma_f32_16x16x32_bf16 v[32:35], v[236:239], v[80:83], v[32:35]
    ds_read_b128 v[60:63], v17 offset:8192
    v_mfma_f32_16x16x32_bf16 v[28:31], v[236:239], v[76:79], v[28:31]
    ds_read_b128 v[64:67], v17 offset:12288
    s_barrier
    ds_read_b128 v[88:91], v18 offset:512
    ds_read_b128 v[92:95], v18 offset:2560
    ds_read_b128 v[96:99], v18 offset:768
    ds_read_b128 v[100:103], v18 offset:2816
    s_waitcnt vmcnt(0)
    buffer_atomic_add v113, v112, s[56:59], s40 offen offset:2048 sc1
    s_waitcnt lgkmcnt(8)
    v_mfma_f32_16x16x32_bf16 v[28:31], v[240:243], v[36:39], v[28:31]
    ds_read_b128 v[68:71], v14 offset:16384
    v_mfma_f32_16x16x32_bf16 v[32:35], v[240:243], v[40:43], v[32:35]
    ds_read_b128 v[72:75], v14 offset:20480
    v_mfma_f32_16x16x32_bf16 v[32:35], v[244:247], v[48:51], v[32:35]
    ds_read_b128 v[76:79], v14 offset:24576
    v_mfma_f32_16x16x32_bf16 v[28:31], v[244:247], v[44:47], v[28:31]
    ds_read_b128 v[80:83], v14 offset:28672
    s_waitcnt lgkmcnt(8)
    v_mfma_f32_16x16x32_bf16 v[28:31], v[248:251], v[52:55], v[28:31]
    ds_read_b128 v[36:39], v15 offset:16384
    v_mfma_f32_16x16x32_bf16 v[32:35], v[248:251], v[56:59], v[32:35]
    ds_read_b128 v[40:43], v15 offset:20480
    v_mfma_f32_16x16x32_bf16 v[32:35], v[252:255], v[64:67], v[32:35]
    ds_read_b128 v[44:47], v15 offset:24576
    v_mfma_f32_16x16x32_bf16 v[28:31], v[252:255], v[60:63], v[28:31]
    ds_read_b128 v[48:51], v15 offset:28672
    s_waitcnt lgkmcnt(4)
    v_mfma_f32_16x16x32_bf16 v[20:23], v[128:131], v[68:71], 0
    ds_read_b128 v[52:55], v16 offset:16384
    v_mfma_f32_16x16x32_bf16 v[24:27], v[128:131], v[72:75], 0
    ds_read_b128 v[56:59], v16 offset:20480
    v_mfma_f32_16x16x32_bf16 v[24:27], v[132:135], v[80:83], v[24:27]
    ds_read_b128 v[60:63], v16 offset:24576
    v_mfma_f32_16x16x32_bf16 v[20:23], v[132:135], v[76:79], v[20:23]
    ds_read_b128 v[64:67], v16 offset:28672
    v_pk_fma_f32 v[28:29], v[88:89], v[84:85], v[28:29]
    v_pk_fma_f32 v[30:31], v[88:89], v[86:87], v[30:31]
    v_pk_fma_f32 v[32:33], v[96:97], v[84:85], v[32:33]
    v_pk_fma_f32 v[34:35], v[96:97], v[86:87], v[34:35]
    v_pk_mul_f32 v[104:105], v[28:29], v[28:29]
    v_pk_mul_f32 v[106:107], v[30:31], v[30:31]
    v_pk_mul_f32 v[108:109], v[32:33], v[32:33]
    v_pk_mul_f32 v[110:111], v[34:35], v[34:35]
    v_pk_fma_f32 v[104:105], v[104:105], v[92:93], v[90:91]
    v_pk_fma_f32 v[106:107], v[106:107], v[92:93], v[90:91]
    v_pk_fma_f32 v[108:109], v[108:109], v[100:101], v[98:99]
    v_pk_fma_f32 v[110:111], v[110:111], v[100:101], v[98:99]
    v_pk_mul_f32 v[104:105], v[104:105], v[28:29]
    v_pk_mul_f32 v[106:107], v[106:107], v[30:31]
    v_pk_mul_f32 v[108:109], v[108:109], v[32:33]
    v_pk_mul_f32 v[110:111], v[110:111], v[34:35]
    v_exp_f32 v104, v104
    v_exp_f32 v105, v105
    v_exp_f32 v106, v106
    v_exp_f32 v107, v107
    v_exp_f32 v108, v108
    v_exp_f32 v109, v109
    v_exp_f32 v110, v110
    v_exp_f32 v111, v111
    v_pk_fma_f32 v[104:105], v[104:105], v[94:95], v[94:95]
    v_pk_fma_f32 v[106:107], v[106:107], v[94:95], v[94:95]
    v_pk_fma_f32 v[108:109], v[108:109], v[102:103], v[102:103]
    v_pk_fma_f32 v[110:111], v[110:111], v[102:103], v[102:103]
    v_rcp_f32 v104, v104
    v_rcp_f32 v105, v105
    v_rcp_f32 v106, v106
    v_rcp_f32 v107, v107
    v_rcp_f32 v108, v108
    v_rcp_f32 v109, v109
    v_rcp_f32 v110, v110
    v_rcp_f32 v111, v111
    v_pk_mul_f32 v[28:29], v[28:29], v[104:105]
    v_pk_mul_f32 v[30:31], v[30:31], v[106:107]
    v_pk_mul_f32 v[32:33], v[32:33], v[108:109]
    v_pk_mul_f32 v[34:35], v[34:35], v[110:111]
    v_add_u32 v28, 0x10000, v28
    v_add_u32 v30, 0x10000, v30
    v_add_u32 v32, 0x10000, v32
    v_add_u32 v34, 0x10000, v34
    v_and_b32 v28, 0xfffe0000, v28
    v_and_b32 v30, 0xfffe0000, v30
    v_and_b32 v32, 0xfffe0000, v32
    v_and_b32 v34, 0xfffe0000, v34
    v_cvt_pk_bf16_f32 v104, v28, v29
    v_cvt_pk_bf16_f32 v105, v30, v31
    v_cvt_pk_bf16_f32 v106, v32, v33
    v_cvt_pk_bf16_f32 v107, v34, v35
    s_add_u32 s36, s39, 131072
    v_permlane16_swap_b32 v104, v106
    v_permlane16_swap_b32 v105, v107
    buffer_store_dwordx4 v[104:107], v114, s[16:19], s36 offen sc1
    s_waitcnt lgkmcnt(4)
    v_mfma_f32_16x16x32_bf16 v[20:23], v[136:139], v[36:39], v[20:23]
    ds_read_b128 v[68:71], v17 offset:16384
    v_mfma_f32_16x16x32_bf16 v[24:27], v[136:139], v[40:43], v[24:27]
    ds_read_b128 v[72:75], v17 offset:20480
    v_mfma_f32_16x16x32_bf16 v[24:27], v[140:143], v[48:51], v[24:27]
    ds_read_b128 v[76:79], v17 offset:24576
    v_mfma_f32_16x16x32_bf16 v[20:23], v[140:143], v[44:47], v[20:23]
    ds_read_b128 v[80:83], v17 offset:28672
    s_barrier
    s_waitcnt lgkmcnt(4)
    v_mfma_f32_16x16x32_bf16 v[20:23], v[144:147], v[52:55], v[20:23]
    ds_read_b128 v[36:39], v14 offset:32768
    v_mfma_f32_16x16x32_bf16 v[24:27], v[144:147], v[56:59], v[24:27]
    ds_read_b128 v[40:43], v14 offset:36864
    v_mfma_f32_16x16x32_bf16 v[24:27], v[148:151], v[64:67], v[24:27]
    ds_read_b128 v[44:47], v14 offset:40960
    v_mfma_f32_16x16x32_bf16 v[20:23], v[148:151], v[60:63], v[20:23]
    ds_read_b128 v[48:51], v14 offset:45056
    s_waitcnt lgkmcnt(4)
    v_mfma_f32_16x16x32_bf16 v[20:23], v[152:155], v[68:71], v[20:23]
    ds_read_b128 v[52:55], v15 offset:32768
    v_mfma_f32_16x16x32_bf16 v[24:27], v[152:155], v[72:75], v[24:27]
    ds_read_b128 v[56:59], v15 offset:36864
    v_mfma_f32_16x16x32_bf16 v[24:27], v[156:159], v[80:83], v[24:27]
    ds_read_b128 v[60:63], v15 offset:40960
    v_mfma_f32_16x16x32_bf16 v[20:23], v[156:159], v[76:79], v[20:23]
    ds_read_b128 v[64:67], v15 offset:45056
    s_waitcnt lgkmcnt(4)
    v_mfma_f32_16x16x32_bf16 v[20:23], v[160:163], v[36:39], v[20:23]
    ds_read_b128 v[68:71], v16 offset:32768
    v_mfma_f32_16x16x32_bf16 v[24:27], v[160:163], v[40:43], v[24:27]
    ds_read_b128 v[72:75], v16 offset:36864
    v_mfma_f32_16x16x32_bf16 v[24:27], v[164:167], v[48:51], v[24:27]
    ds_read_b128 v[76:79], v16 offset:40960
    v_mfma_f32_16x16x32_bf16 v[20:23], v[164:167], v[44:47], v[20:23]
    ds_read_b128 v[80:83], v16 offset:45056
    s_waitcnt lgkmcnt(4)
    v_mfma_f32_16x16x32_bf16 v[20:23], v[168:171], v[52:55], v[20:23]
    ds_read_b128 v[36:39], v17 offset:32768
    v_mfma_f32_16x16x32_bf16 v[24:27], v[168:171], v[56:59], v[24:27]
    ds_read_b128 v[40:43], v17 offset:36864
    v_mfma_f32_16x16x32_bf16 v[24:27], v[172:175], v[64:67], v[24:27]
    ds_read_b128 v[44:47], v17 offset:40960
    v_mfma_f32_16x16x32_bf16 v[20:23], v[172:175], v[60:63], v[20:23]
    ds_read_b128 v[48:51], v17 offset:45056
    s_barrier
    s_waitcnt lgkmcnt(4)
    v_mfma_f32_16x16x32_bf16 v[20:23], v[176:179], v[68:71], v[20:23]
    ds_read_b128 v[52:55], v10 offset:16384
    v_mfma_f32_16x16x32_bf16 v[24:27], v[176:179], v[72:75], v[24:27]
    ds_read_b128 v[56:59], v10 offset:20480
    v_mfma_f32_16x16x32_bf16 v[24:27], v[180:183], v[80:83], v[24:27]
    ds_read_b128 v[60:63], v10 offset:24576
    v_mfma_f32_16x16x32_bf16 v[20:23], v[180:183], v[76:79], v[20:23]
    ds_read_b128 v[64:67], v10 offset:28672
    s_waitcnt lgkmcnt(4)
    v_mfma_f32_16x16x32_bf16 v[20:23], v[184:187], v[36:39], v[20:23]
    ds_read_b128 v[68:71], v11 offset:16384
    v_mfma_f32_16x16x32_bf16 v[24:27], v[184:187], v[40:43], v[24:27]
    ds_read_b128 v[72:75], v11 offset:20480
    v_mfma_f32_16x16x32_bf16 v[24:27], v[188:191], v[48:51], v[24:27]
    ds_read_b128 v[76:79], v11 offset:24576
    v_mfma_f32_16x16x32_bf16 v[20:23], v[188:191], v[44:47], v[20:23]
    ds_read_b128 v[80:83], v11 offset:28672
    s_waitcnt lgkmcnt(4)
    v_mfma_f32_16x16x32_bf16 v[20:23], v[192:195], v[52:55], v[20:23]
    ds_read_b128 v[36:39], v12 offset:16384
    v_mfma_f32_16x16x32_bf16 v[24:27], v[192:195], v[56:59], v[24:27]
    ds_read_b128 v[40:43], v12 offset:20480
    v_mfma_f32_16x16x32_bf16 v[24:27], v[196:199], v[64:67], v[24:27]
    ds_read_b128 v[44:47], v12 offset:24576
    v_mfma_f32_16x16x32_bf16 v[20:23], v[196:199], v[60:63], v[20:23]
    ds_read_b128 v[48:51], v12 offset:28672
    s_waitcnt lgkmcnt(4)
    v_mfma_f32_16x16x32_bf16 v[20:23], v[200:203], v[68:71], v[20:23]
    ds_read_b128 v[52:55], v13 offset:16384
    v_mfma_f32_16x16x32_bf16 v[24:27], v[200:203], v[72:75], v[24:27]
    ds_read_b128 v[56:59], v13 offset:20480
    v_mfma_f32_16x16x32_bf16 v[24:27], v[204:207], v[80:83], v[24:27]
    ds_read_b128 v[60:63], v13 offset:24576
    v_mfma_f32_16x16x32_bf16 v[20:23], v[204:207], v[76:79], v[20:23]
    ds_read_b128 v[64:67], v13 offset:28672
    s_barrier
    s_waitcnt lgkmcnt(4)
    v_mfma_f32_16x16x32_bf16 v[20:23], v[208:211], v[36:39], v[20:23]
    ds_read_b128 v[68:71], v10 offset:32768
    v_mfma_f32_16x16x32_bf16 v[24:27], v[208:211], v[40:43], v[24:27]
    ds_read_b128 v[72:75], v10 offset:36864
    v_mfma_f32_16x16x32_bf16 v[24:27], v[212:215], v[48:51], v[24:27]
    ds_read_b128 v[76:79], v10 offset:40960
    v_mfma_f32_16x16x32_bf16 v[20:23], v[212:215], v[44:47], v[20:23]
    ds_read_b128 v[80:83], v10 offset:45056
    s_waitcnt lgkmcnt(4)
    v_mfma_f32_16x16x32_bf16 v[20:23], v[216:219], v[52:55], v[20:23]
    ds_read_b128 v[36:39], v11 offset:32768
    v_mfma_f32_16x16x32_bf16 v[24:27], v[216:219], v[56:59], v[24:27]
    ds_read_b128 v[40:43], v11 offset:36864
    v_mfma_f32_16x16x32_bf16 v[24:27], v[220:223], v[64:67], v[24:27]
    ds_read_b128 v[44:47], v11 offset:40960
    v_mfma_f32_16x16x32_bf16 v[20:23], v[220:223], v[60:63], v[20:23]
    ds_read_b128 v[48:51], v11 offset:45056
    s_waitcnt lgkmcnt(4)
    v_mfma_f32_16x16x32_bf16 v[20:23], v[224:227], v[68:71], v[20:23]
    ds_read_b128 v[52:55], v12 offset:32768
    v_mfma_f32_16x16x32_bf16 v[24:27], v[224:227], v[72:75], v[24:27]
    ds_read_b128 v[56:59], v12 offset:36864
    v_mfma_f32_16x16x32_bf16 v[24:27], v[228:231], v[80:83], v[24:27]
    ds_read_b128 v[60:63], v12 offset:40960
    v_mfma_f32_16x16x32_bf16 v[20:23], v[228:231], v[76:79], v[20:23]
    ds_read_b128 v[64:67], v12 offset:45056
    s_waitcnt lgkmcnt(4)
    v_mfma_f32_16x16x32_bf16 v[20:23], v[232:235], v[36:39], v[20:23]
    ds_read_b128 v[68:71], v13 offset:32768
    v_mfma_f32_16x16x32_bf16 v[24:27], v[232:235], v[40:43], v[24:27]
    ds_read_b128 v[72:75], v13 offset:36864
    v_mfma_f32_16x16x32_bf16 v[24:27], v[236:239], v[48:51], v[24:27]
    ds_read_b128 v[76:79], v13 offset:40960
    v_mfma_f32_16x16x32_bf16 v[20:23], v[236:239], v[44:47], v[20:23]
    ds_read_b128 v[80:83], v13 offset:45056
    s_barrier
    ds_read_b128 v[88:91], v18 offset:1024
    ds_read_b128 v[92:95], v18 offset:3072
    ds_read_b128 v[96:99], v18 offset:1280
    ds_read_b128 v[100:103], v18 offset:3328
    s_waitcnt vmcnt(0)
    buffer_atomic_add v113, v112, s[56:59], s40 offen offset:2560 sc1
    s_waitcnt lgkmcnt(8)
    v_mfma_f32_16x16x32_bf16 v[20:23], v[240:243], v[52:55], v[20:23]
    ds_read_b128 v[36:39], v14 offset:0
    v_mfma_f32_16x16x32_bf16 v[24:27], v[240:243], v[56:59], v[24:27]
    ds_read_b128 v[40:43], v14 offset:4096
    v_mfma_f32_16x16x32_bf16 v[24:27], v[244:247], v[64:67], v[24:27]
    ds_read_b128 v[44:47], v14 offset:8192
    v_mfma_f32_16x16x32_bf16 v[20:23], v[244:247], v[60:63], v[20:23]
    ds_read_b128 v[48:51], v14 offset:12288
    s_waitcnt lgkmcnt(8)
    v_mfma_f32_16x16x32_bf16 v[20:23], v[248:251], v[68:71], v[20:23]
    ds_read_b128 v[52:55], v15 offset:0
    v_mfma_f32_16x16x32_bf16 v[24:27], v[248:251], v[72:75], v[24:27]
    ds_read_b128 v[56:59], v15 offset:4096
    v_mfma_f32_16x16x32_bf16 v[24:27], v[252:255], v[80:83], v[24:27]
    ds_read_b128 v[60:63], v15 offset:8192
    v_mfma_f32_16x16x32_bf16 v[20:23], v[252:255], v[76:79], v[20:23]
    ds_read_b128 v[64:67], v15 offset:12288
    s_waitcnt lgkmcnt(4)
    v_mfma_f32_16x16x32_bf16 v[28:31], v[128:131], v[36:39], 0
    ds_read_b128 v[68:71], v16 offset:0
    v_mfma_f32_16x16x32_bf16 v[32:35], v[128:131], v[40:43], 0
    ds_read_b128 v[72:75], v16 offset:4096
    v_mfma_f32_16x16x32_bf16 v[32:35], v[132:135], v[48:51], v[32:35]
    ds_read_b128 v[76:79], v16 offset:8192
    v_mfma_f32_16x16x32_bf16 v[28:31], v[132:135], v[44:47], v[28:31]
    ds_read_b128 v[80:83], v16 offset:12288
    v_pk_fma_f32 v[20:21], v[88:89], v[84:85], v[20:21]
    v_pk_fma_f32 v[22:23], v[88:89], v[86:87], v[22:23]
    v_pk_fma_f32 v[24:25], v[96:97], v[84:85], v[24:25]
    v_pk_fma_f32 v[26:27], v[96:97], v[86:87], v[26:27]
    v_pk_mul_f32 v[104:105], v[20:21], v[20:21]
    v_pk_mul_f32 v[106:107], v[22:23], v[22:23]
    v_pk_mul_f32 v[108:109], v[24:25], v[24:25]
    v_pk_mul_f32 v[110:111], v[26:27], v[26:27]
    v_pk_fma_f32 v[104:105], v[104:105], v[92:93], v[90:91]
    v_pk_fma_f32 v[106:107], v[106:107], v[92:93], v[90:91]
    v_pk_fma_f32 v[108:109], v[108:109], v[100:101], v[98:99]
    v_pk_fma_f32 v[110:111], v[110:111], v[100:101], v[98:99]
    v_pk_mul_f32 v[104:105], v[104:105], v[20:21]
    v_pk_mul_f32 v[106:107], v[106:107], v[22:23]
    v_pk_mul_f32 v[108:109], v[108:109], v[24:25]
    v_pk_mul_f32 v[110:111], v[110:111], v[26:27]
    v_exp_f32 v104, v104
    v_exp_f32 v105, v105
    v_exp_f32 v106, v106
    v_exp_f32 v107, v107
    v_exp_f32 v108, v108
    v_exp_f32 v109, v109
    v_exp_f32 v110, v110
    v_exp_f32 v111, v111
    v_pk_fma_f32 v[104:105], v[104:105], v[94:95], v[94:95]
    v_pk_fma_f32 v[106:107], v[106:107], v[94:95], v[94:95]
    v_pk_fma_f32 v[108:109], v[108:109], v[102:103], v[102:103]
    v_pk_fma_f32 v[110:111], v[110:111], v[102:103], v[102:103]
    v_rcp_f32 v104, v104
    v_rcp_f32 v105, v105
    v_rcp_f32 v106, v106
    v_rcp_f32 v107, v107
    v_rcp_f32 v108, v108
    v_rcp_f32 v109, v109
    v_rcp_f32 v110, v110
    v_rcp_f32 v111, v111
    v_pk_mul_f32 v[20:21], v[20:21], v[104:105]
    v_pk_mul_f32 v[22:23], v[22:23], v[106:107]
    v_pk_mul_f32 v[24:25], v[24:25], v[108:109]
    v_pk_mul_f32 v[26:27], v[26:27], v[110:111]
    v_add_u32 v20, 0x10000, v20
    v_add_u32 v22, 0x10000, v22
    v_add_u32 v24, 0x10000, v24
    v_add_u32 v26, 0x10000, v26
    v_and_b32 v20, 0xfffe0000, v20
    v_and_b32 v22, 0xfffe0000, v22
    v_and_b32 v24, 0xfffe0000, v24
    v_and_b32 v26, 0xfffe0000, v26
    v_cvt_pk_bf16_f32 v104, v20, v21
    v_cvt_pk_bf16_f32 v105, v22, v23
    v_cvt_pk_bf16_f32 v106, v24, v25
    v_cvt_pk_bf16_f32 v107, v26, v27
    s_add_u32 s36, s39, 262144
    v_permlane16_swap_b32 v104, v106
    v_permlane16_swap_b32 v105, v107
    buffer_store_dwordx4 v[104:107], v114, s[16:19], s36 offen sc1
    s_waitcnt lgkmcnt(4)
    v_mfma_f32_16x16x32_bf16 v[28:31], v[136:139], v[52:55], v[28:31]
    ds_read_b128 v[36:39], v17 offset:0
    v_mfma_f32_16x16x32_bf16 v[32:35], v[136:139], v[56:59], v[32:35]
    ds_read_b128 v[40:43], v17 offset:4096
    v_mfma_f32_16x16x32_bf16 v[32:35], v[140:143], v[64:67], v[32:35]
    ds_read_b128 v[44:47], v17 offset:8192
    v_mfma_f32_16x16x32_bf16 v[28:31], v[140:143], v[60:63], v[28:31]
    ds_read_b128 v[48:51], v17 offset:12288
    s_barrier
    s_waitcnt lgkmcnt(4)
    v_mfma_f32_16x16x32_bf16 v[28:31], v[144:147], v[68:71], v[28:31]
    ds_read_b128 v[52:55], v14 offset:16384
    v_mfma_f32_16x16x32_bf16 v[32:35], v[144:147], v[72:75], v[32:35]
    ds_read_b128 v[56:59], v14 offset:20480
    v_mfma_f32_16x16x32_bf16 v[32:35], v[148:151], v[80:83], v[32:35]
    ds_read_b128 v[60:63], v14 offset:24576
    v_mfma_f32_16x16x32_bf16 v[28:31], v[148:151], v[76:79], v[28:31]
    ds_read_b128 v[64:67], v14 offset:28672
    s_waitcnt lgkmcnt(4)
    v_mfma_f32_16x16x32_bf16 v[28:31], v[152:155], v[36:39], v[28:31]
    ds_read_b128 v[68:71], v15 offset:16384
    v_mfma_f32_16x16x32_bf16 v[32:35], v[152:155], v[40:43], v[32:35]
    ds_read_b128 v[72:75], v15 offset:20480
    v_mfma_f32_16x16x32_bf16 v[32:35], v[156:159], v[48:51], v[32:35]
    ds_read_b128 v[76:79], v15 offset:24576
    v_mfma_f32_16x16x32_bf16 v[28:31], v[156:159], v[44:47], v[28:31]
    ds_read_b128 v[80:83], v15 offset:28672
    s_waitcnt lgkmcnt(4)
    v_mfma_f32_16x16x32_bf16 v[28:31], v[160:163], v[52:55], v[28:31]
    ds_read_b128 v[36:39], v16 offset:16384
    v_mfma_f32_16x16x32_bf16 v[32:35], v[160:163], v[56:59], v[32:35]
    ds_read_b128 v[40:43], v16 offset:20480
    v_mfma_f32_16x16x32_bf16 v[32:35], v[164:167], v[64:67], v[32:35]
    ds_read_b128 v[44:47], v16 offset:24576
    v_mfma_f32_16x16x32_bf16 v[28:31], v[164:167], v[60:63], v[28:31]
    ds_read_b128 v[48:51], v16 offset:28672
    s_waitcnt lgkmcnt(4)
    v_mfma_f32_16x16x32_bf16 v[28:31], v[168:171], v[68:71], v[28:31]
    ds_read_b128 v[52:55], v17 offset:16384
    v_mfma_f32_16x16x32_bf16 v[32:35], v[168:171], v[72:75], v[32:35]
    ds_read_b128 v[56:59], v17 offset:20480
    v_mfma_f32_16x16x32_bf16 v[32:35], v[172:175], v[80:83], v[32:35]
    ds_read_b128 v[60:63], v17 offset:24576
    v_mfma_f32_16x16x32_bf16 v[28:31], v[172:175], v[76:79], v[28:31]
    ds_read_b128 v[64:67], v17 offset:28672
    s_barrier
    s_waitcnt lgkmcnt(4)
    v_mfma_f32_16x16x32_bf16 v[28:31], v[176:179], v[36:39], v[28:31]
    ds_read_b128 v[68:71], v14 offset:32768
    v_mfma_f32_16x16x32_bf16 v[32:35], v[176:179], v[40:43], v[32:35]
    ds_read_b128 v[72:75], v14 offset:36864
    v_mfma_f32_16x16x32_bf16 v[32:35], v[180:183], v[48:51], v[32:35]
    ds_read_b128 v[76:79], v14 offset:40960
    v_mfma_f32_16x16x32_bf16 v[28:31], v[180:183], v[44:47], v[28:31]
    ds_read_b128 v[80:83], v14 offset:45056
    s_waitcnt lgkmcnt(4)
    v_mfma_f32_16x16x32_bf16 v[28:31], v[184:187], v[52:55], v[28:31]
    ds_read_b128 v[36:39], v15 offset:32768
    v_mfma_f32_16x16x32_bf16 v[32:35], v[184:187], v[56:59], v[32:35]
    ds_read_b128 v[40:43], v15 offset:36864
    v_mfma_f32_16x16x32_bf16 v[32:35], v[188:191], v[64:67], v[32:35]
    ds_read_b128 v[44:47], v15 offset:40960
    v_mfma_f32_16x16x32_bf16 v[28:31], v[188:191], v[60:63], v[28:31]
    ds_read_b128 v[48:51], v15 offset:45056
    s_waitcnt lgkmcnt(4)
    v_mfma_f32_16x16x32_bf16 v[28:31], v[192:195], v[68:71], v[28:31]
    ds_read_b128 v[52:55], v16 offset:32768
    v_mfma_f32_16x16x32_bf16 v[32:35], v[192:195], v[72:75], v[32:35]
    ds_read_b128 v[56:59], v16 offset:36864
    v_mfma_f32_16x16x32_bf16 v[32:35], v[196:199], v[80:83], v[32:35]
    ds_read_b128 v[60:63], v16 offset:40960
    v_mfma_f32_16x16x32_bf16 v[28:31], v[196:199], v[76:79], v[28:31]
    ds_read_b128 v[64:67], v16 offset:45056
    s_waitcnt lgkmcnt(4)
    v_mfma_f32_16x16x32_bf16 v[28:31], v[200:203], v[36:39], v[28:31]
    ds_read_b128 v[68:71], v17 offset:32768
    v_mfma_f32_16x16x32_bf16 v[32:35], v[200:203], v[40:43], v[32:35]
    ds_read_b128 v[72:75], v17 offset:36864
    v_mfma_f32_16x16x32_bf16 v[32:35], v[204:207], v[48:51], v[32:35]
    ds_read_b128 v[76:79], v17 offset:40960
    v_mfma_f32_16x16x32_bf16 v[28:31], v[204:207], v[44:47], v[28:31]
    ds_read_b128 v[80:83], v17 offset:45056
    s_barrier
    s_waitcnt lgkmcnt(4)
    v_mfma_f32_16x16x32_bf16 v[28:31], v[208:211], v[52:55], v[28:31]
    ds_read_b128 v[36:39], v10 offset:16384
    v_mfma_f32_16x16x32_bf16 v[32:35], v[208:211], v[56:59], v[32:35]
    ds_read_b128 v[40:43], v10 offset:20480
    v_mfma_f32_16x16x32_bf16 v[32:35], v[212:215], v[64:67], v[32:35]
    ds_read_b128 v[44:47], v10 offset:24576
    v_mfma_f32_16x16x32_bf16 v[28:31], v[212:215], v[60:63], v[28:31]
    ds_read_b128 v[48:51], v10 offset:28672
    s_waitcnt lgkmcnt(4)
    v_mfma_f32_16x16x32_bf16 v[28:31], v[216:219], v[68:71], v[28:31]
    ds_read_b128 v[52:55], v11 offset:16384
    v_mfma_f32_16x16x32_bf16 v[32:35], v[216:219], v[72:75], v[32:35]
    ds_read_b128 v[56:59], v11 offset:20480
    v_mfma_f32_16x16x32_bf16 v[32:35], v[220:223], v[80:83], v[32:35]
    ds_read_b128 v[60:63], v11 offset:24576
    v_mfma_f32_16x16x32_bf16 v[28:31], v[220:223], v[76:79], v[28:31]
    ds_read_b128 v[64:67], v11 offset:28672
    s_waitcnt vmcnt(0)
    buffer_atomic_add v113, v112, s[56:59], s40 offen offset:3072 sc1
    s_waitcnt lgkmcnt(4)
    v_mfma_f32_16x16x32_bf16 v[28:31], v[224:227], v[36:39], v[28:31]
    ds_read_b128 v[68:71], v12 offset:16384
    v_mfma_f32_16x16x32_bf16 v[32:35], v[224:227], v[40:43], v[32:35]
    ds_read_b128 v[72:75], v12 offset:20480
    v_mfma_f32_16x16x32_bf16 v[32:35], v[228:231], v[48:51], v[32:35]
    ds_read_b128 v[76:79], v12 offset:24576
    v_mfma_f32_16x16x32_bf16 v[28:31], v[228:231], v[44:47], v[28:31]
    ds_read_b128 v[80:83], v12 offset:28672
    s_waitcnt lgkmcnt(4)
    v_mfma_f32_16x16x32_bf16 v[28:31], v[232:235], v[52:55], v[28:31]
    ds_read_b128 v[36:39], v13 offset:16384
    v_mfma_f32_16x16x32_bf16 v[32:35], v[232:235], v[56:59], v[32:35]
    ds_read_b128 v[40:43], v13 offset:20480
    v_mfma_f32_16x16x32_bf16 v[32:35], v[236:239], v[64:67], v[32:35]
    ds_read_b128 v[44:47], v13 offset:24576
    v_mfma_f32_16x16x32_bf16 v[28:31], v[236:239], v[60:63], v[28:31]
    ds_read_b128 v[48:51], v13 offset:28672
    s_barrier
    ds_read_b128 v[88:91], v18 offset:1536
    ds_read_b128 v[92:95], v18 offset:3584
    ds_read_b128 v[96:99], v18 offset:1792
    ds_read_b128 v[100:103], v18 offset:3840
    s_waitcnt lgkmcnt(8)
    v_mfma_f32_16x16x32_bf16 v[28:31], v[240:243], v[68:71], v[28:31]
    v_mfma_f32_16x16x32_bf16 v[32:35], v[240:243], v[72:75], v[32:35]
    v_mfma_f32_16x16x32_bf16 v[32:35], v[244:247], v[80:83], v[32:35]
    v_mfma_f32_16x16x32_bf16 v[28:31], v[244:247], v[76:79], v[28:31]
    s_waitcnt lgkmcnt(4)
    v_mfma_f32_16x16x32_bf16 v[28:31], v[248:251], v[36:39], v[28:31]
    v_mfma_f32_16x16x32_bf16 v[32:35], v[248:251], v[40:43], v[32:35]
    v_mfma_f32_16x16x32_bf16 v[32:35], v[252:255], v[48:51], v[32:35]
    v_mfma_f32_16x16x32_bf16 v[28:31], v[252:255], v[44:47], v[28:31]
    s_setprio 1
    s_waitcnt lgkmcnt(0)
    s_load_dword s32, s[4:5], s20 offset:2560
    s_load_dword s3, s[4:5], s20 offset:2688
    s_add_u32 m0, s12, 139264
    s_add_u32 s49, s11, 0
    buffer_load_dwordx4 v2, s[16:19], s49 offen offset:0 sc1 lds
    buffer_load_dwordx4 v2, s[16:19], s49 offen offset:1024 sc1 lds
    buffer_load_dwordx4 v2, s[16:19], s49 offen offset:2048 sc1 lds
    buffer_load_dwordx4 v2, s[16:19], s49 offen offset:3072 sc1 lds
    v_pk_fma_f32 v[28:29], v[88:89], v[84:85], v[28:29]
    v_pk_fma_f32 v[30:31], v[88:89], v[86:87], v[30:31]
    v_pk_fma_f32 v[32:33], v[96:97], v[84:85], v[32:33]
    v_pk_fma_f32 v[34:35], v[96:97], v[86:87], v[34:35]
    v_pk_mul_f32 v[104:105], v[28:29], v[28:29]
    v_pk_mul_f32 v[106:107], v[30:31], v[30:31]
    v_pk_mul_f32 v[108:109], v[32:33], v[32:33]
    v_pk_mul_f32 v[110:111], v[34:35], v[34:35]
    v_pk_fma_f32 v[104:105], v[104:105], v[92:93], v[90:91]
    v_pk_fma_f32 v[106:107], v[106:107], v[92:93], v[90:91]
    v_pk_fma_f32 v[108:109], v[108:109], v[100:101], v[98:99]
    v_pk_fma_f32 v[110:111], v[110:111], v[100:101], v[98:99]
    v_pk_mul_f32 v[104:105], v[104:105], v[28:29]
    v_pk_mul_f32 v[106:107], v[106:107], v[30:31]
    v_pk_mul_f32 v[108:109], v[108:109], v[32:33]
    v_pk_mul_f32 v[110:111], v[110:111], v[34:35]
    v_exp_f32 v104, v104
    v_exp_f32 v105, v105
    v_exp_f32 v106, v106
    v_exp_f32 v107, v107
    v_exp_f32 v108, v108
    v_exp_f32 v109, v109
    v_exp_f32 v110, v110
    v_exp_f32 v111, v111
    v_pk_fma_f32 v[104:105], v[104:105], v[94:95], v[94:95]
    v_pk_fma_f32 v[106:107], v[106:107], v[94:95], v[94:95]
    v_pk_fma_f32 v[108:109], v[108:109], v[102:103], v[102:103]
    v_pk_fma_f32 v[110:111], v[110:111], v[102:103], v[102:103]
    v_rcp_f32 v104, v104
    v_rcp_f32 v105, v105
    v_rcp_f32 v106, v106
    v_rcp_f32 v107, v107
    v_rcp_f32 v108, v108
    v_rcp_f32 v109, v109
    v_rcp_f32 v110, v110
    v_rcp_f32 v111, v111
    v_pk_mul_f32 v[28:29], v[28:29], v[104:105]
    v_pk_mul_f32 v[30:31], v[30:31], v[106:107]
    v_pk_mul_f32 v[32:33], v[32:33], v[108:109]
    v_pk_mul_f32 v[34:35], v[34:35], v[110:111]
    v_add_u32 v28, 0x10000, v28
    v_add_u32 v30, 0x10000, v30
    v_add_u32 v32, 0x10000, v32
    v_add_u32 v34, 0x10000, v34
    v_and_b32 v28, 0xfffe0000, v28
    v_and_b32 v30, 0xfffe0000, v30
    v_and_b32 v32, 0xfffe0000, v32
    v_and_b32 v34, 0xfffe0000, v34
    v_cvt_pk_bf16_f32 v104, v28, v29
    v_cvt_pk_bf16_f32 v105, v30, v31
    v_cvt_pk_bf16_f32 v106, v32, v33
    v_cvt_pk_bf16_f32 v107, v34, v35
    s_add_u32 s36, s39, 393216
    v_permlane16_swap_b32 v104, v106
    v_permlane16_swap_b32 v105, v107
    buffer_store_dwordx4 v[104:107], v114, s[16:19], s36 offen sc1
    s_add_u32 m0, s12, 16384
    s_add_u32 s49, s8, 131072
    s_barrier
    s_waitcnt lgkmcnt(0)
    s_cmp_eq_u32 s32, s21
    s_cselect_b32 s32, s3, 0
    s_cmp_eq_u32 s32, s21
    s_cbranch_scc1 hok_17
    s_add_u32 s53, s20, 2560
    v_lshlrev_b32 v85, 7, v1
    v_add_u32 v85, s53, v85
    s_mov_b32 s53, 0
    s_add_u32 s54, s52, 16
    s_bfm_b64 exec, 2, 0
poll_18:
    buffer_load_dword v84, v85, s[56:59], 0 offen sc1
    s_waitcnt vmcnt(0)
    v_cmp_eq_u32 vcc, s54, v84
    s_nop 0
    s_cmp_eq_u64 vcc, exec
    s_cbranch_scc1 pok_19
    s_sleep 8
    s_add_u32 s53, s53, 1
    s_cmp_lt_u32 s53, s61
    s_cbranch_scc1 poll_18
    s_mov_b32 s61, 0
pok_19:
    s_mov_b64 exec, -1
hok_17:
    buffer_load_dwordx4 v2, s[16:19], s49 offen offset:0 sc1 lds
    buffer_load_dwordx4 v2, s[16:19], s49 offen offset:1024 sc1 lds
    buffer_load_dwordx4 v2, s[16:19], s49 offen offset:2048 sc1 lds
    buffer_load_dwordx4 v2, s[16:19], s49 offen offset:3072 sc1 lds
    s_add_u32 m0, s12, 32768
    s_add_u32 s49, s9, 131072
    s_barrier
    buffer_load_dwordx4 v2, s[16:19], s49 offen offset:0 sc1 lds
    buffer_load_dwordx4 v2, s[16:19], s49 offen offset:1024 sc1 lds
    buffer_load_dwordx4 v2, s[16:19], s49 offen offset:2048 sc1 lds
    buffer_load_dwordx4 v2, s[16:19], s49 offen offset:3072 sc1 lds
    s_add_u32 m0, s12, 106496
    s_add_u32 s49, s10, 131072
    s_waitcnt vmcnt(9)
    s_barrier
    s_waitcnt vmcnt(8)
    buffer_atomic_add v113, v112, s[56:59], s40 offen offset:3584 sc1
    buffer_load_dwordx4 v2, s[16:19], s49 offen offset:0 sc1 lds
    buffer_load_dwordx4 v2, s[16:19], s49 offen offset:1024 sc1 lds
    buffer_load_dwordx4 v2, s[16:19], s49 offen offset:2048 sc1 lds
    buffer_load_dwordx4 v2, s[16:19], s49 offen offset:3072 sc1 lds
    s_add_u32 m0, s12, 122880
    s_add_u32 s49, s11, 131072
    s_waitcnt vmcnt(9)
    s_barrier
    s_load_dword s32, s[4:5], s20 offset:3072
    s_load_dword s3, s[4:5], s20 offset:3200
    buffer_load_dwordx4 v2, s[16:19], s49 offen offset:0 sc1 lds
    buffer_load_dwordx4 v2, s[16:19], s49 offen offset:1024 sc1 lds
    buffer_load_dwordx4 v2, s[16:19], s49 offen offset:2048 sc1 lds
    buffer_load_dwordx4 v2, s[16:19], s49 offen offset:3072 sc1 lds
    s_add_u32 m0, s12, 139264
    s_add_u32 s49, s8, 262144
    s_waitcnt vmcnt(9)
    s_barrier
    s_waitcnt lgkmcnt(0)
    s_cmp_eq_u32 s32, s21
    s_cselect_b32 s32, s3, 0
    s_cmp_eq_u32 s32, s21
    s_cbranch_scc1 hok_20
    s_add_u32 s53, s20, 3072
    v_lshlrev_b32 v85, 7, v1
    v_add_u32 v85, s53, v85
    s_mov_b32 s53, 0
    s_add_u32 s54, s52, 16
    s_bfm_b64 exec, 2, 0
poll_21:
    buffer_load_dword v84, v85, s[56:59], 0 offen sc1
    s_waitcnt vmcnt(0)
    v_cmp_eq_u32 vcc, s54, v84
    s_nop 0
    s_cmp_eq_u64 vcc, exec
    s_cbranch_scc1 pok_22
    s_sleep 8
    s_add_u32 s53, s53, 1
    s_cmp_lt_u32 s53, s61
    s_cbranch_scc1 poll_21
    s_mov_b32 s61, 0
pok_22:
    s_mov_b64 exec, -1
hok_20:
    buffer_load_dwordx4 v2, s[16:19], s49 offen offset:0 sc1 lds
    buffer_load_dwordx4 v2, s[16:19], s49 offen offset:1024 sc1 lds
    buffer_load_dwordx4 v2, s[16:19], s49 offen offset:2048 sc1 lds
    buffer_load_dwordx4 v2, s[16:19], s49 offen offset:3072 sc1 lds
    s_add_u32 m0, s12, 16384
    s_add_u32 s49, s9, 262144
    s_waitcnt vmcnt(8)
    s_barrier
    buffer_load_dwordx4 v2, s[16:19], s49 offen offset:0 sc1 lds
    buffer_load_dwordx4 v2, s[16:19], s49 offen offset:1024 sc1 lds
    buffer_load_dwordx4 v2, s[16:19], s49 offen offset:2048 sc1 lds
    buffer_load_dwordx4 v2, s[16:19], s49 offen offset:3072 sc1 lds
    s_add_u32 m0, s12, 32768
    s_add_u32 s49, s10, 262144
    s_waitcnt vmcnt(8)
    s_barrier
    buffer_load_dwordx4 v2, s[16:19], s49 offen offset:0 sc1 lds
    buffer_load_dwordx4 v2, s[16:19], s49 offen offset:1024 sc1 lds
    buffer_load_dwordx4 v2, s[16:19], s49 offen offset:2048 sc1 lds
    buffer_load_dwordx4 v2, s[16:19], s49 offen offset:3072 sc1 lds
    s_add_u32 m0, s12, 106496
    s_add_u32 s49, s11, 262144
    s_waitcnt vmcnt(8)
    s_barrier
    s_load_dword s32, s[4:5], s20 offset:3584
    s_load_dword s3, s[4:5], s20 offset:3712
    buffer_load_dwordx4 v2, s[16:19], s49 offen offset:0 sc1 lds
    buffer_load_dwordx4 v2, s[16:19], s49 offen offset:1024 sc1 lds
    buffer_load_dwordx4 v2, s[16:19], s49 offen offset:2048 sc1 lds
    buffer_load_dwordx4 v2, s[16:19], s49 offen offset:3072 sc1 lds
    s_add_u32 m0, s12, 122880
    s_add_u32 s49, s8, 393216
    s_waitcnt vmcnt(8)
    s_barrier
    s_waitcnt lgkmcnt(0)
    s_cmp_eq_u32 s32, s21
    s_cselect_b32 s32, s3, 0
    s_cmp_eq_u32 s32, s21
    s_cbranch_scc1 hok_23
    s_add_u32 s53, s20, 3584
    v_lshlrev_b32 v85, 7, v1
    v_add_u32 v85, s53, v85
    s_mov_b32 s53, 0
    s_add_u32 s54, s52, 16
    s_bfm_b64 exec, 2, 0
poll_24:
    buffer_load_dword v84, v85, s[56:59], 0 offen sc1
    s_waitcnt vmcnt(0)
    v_cmp_eq_u32 vcc, s54, v84
    s_nop 0
    s_cmp_eq_u64 vcc, exec
    s_cbranch_scc1 pok_25
    s_sleep 8
    s_add_u32 s53, s53, 1
    s_cmp_lt_u32 s53, s61
    s_cbranch_scc1 poll_24
    s_mov_b32 s61, 0
pok_25:
    s_mov_b64 exec, -1
hok_23:
    buffer_load_dwordx4 v2, s[16:19], s49 offen offset:0 sc1 lds
    buffer_load_dwordx4 v2, s[16:19], s49 offen offset:1024 sc1 lds
    buffer_load_dwordx4 v2, s[16:19], s49 offen offset:2048 sc1 lds
    buffer_load_dwordx4 v2, s[16:19], s49 offen offset:3072 sc1 lds
    s_add_u32 m0, s12, 139264
    s_add_u32 s49, s9, 393216
    s_waitcnt vmcnt(8)
    s_barrier
    buffer_load_dwordx4 v2, s[16:19], s49 offen offset:0 sc1 lds
    buffer_load_dwordx4 v2, s[16:19], s49 offen offset:1024 sc1 lds
    buffer_load_dwordx4 v2, s[16:19], s49 offen offset:2048 sc1 lds
    buffer_load_dwordx4 v2, s[16:19], s49 offen offset:3072 sc1 lds
    s_add_u32 m0, s12, 16384
    s_add_u32 s49, s10, 393216
    s_waitcnt vmcnt(8)
    s_barrier
    buffer_load_dwordx4 v2, s[16:19], s49 offen offset:0 sc1 lds
    buffer_load_dwordx4 v2, s[16:19], s49 offen offset:1024 sc1 lds
    buffer_load_dwordx4 v2, s[16:19], s49 offen offset:2048 sc1 lds
    buffer_load_dwordx4 v2, s[16:19], s49 offen offset:3072 sc1 lds
    s_add_u32 m0, s12, 32768
    s_add_u32 s49, s11, 393216
    s_waitcnt vmcnt(8)
    s_barrier
    buffer_load_dwordx4 v2, s[16:19], s49 offen offset:0 sc1 lds
    buffer_load_dwordx4 v2, s[16:19], s49 offen offset:1024 sc1 lds
    buffer_load_dwordx4 v2, s[16:19], s49 offen offset:2048 sc1 lds
    buffer_load_dwordx4 v2, s[16:19], s49 offen offset:3072 sc1 lds
    s_waitcnt vmcnt(8)
    s_barrier
    s_lshr_b32 s34, s30, 1
    s_and_b32 s35, s30, 1
    v_and_b32 v22, 15, v1
    v_lshrrev_b32 v23, 4, v1
    s_mul_i32 s37, s34, 4
    s_mul_i32 s38, s29, 14
    s_mul_i32 s36, s35, 7
    s_add_u32 s38, s38, s36
    s_mul_i32 s36, s34, 8192
    v_add_u32 v12, s36, v2
    v_lshrrev_b32 v6, 2, v1
    v_mul_u32_u24 v13, 448, v6
    v_and_b32 v7, 3, v1
    v_lshl_add_u32 v13, v7, 3, v13
    v_add_u32 v13, 49152, v13
    s_mul_i32 s36, s35, 224
    v_add_u32 v13, s36, v13
    v_bfe_u32 v6, v1, 4, 1
    v_lshlrev_b32 v6, 5, v6
    s_cmp_eq_u32 s35, 0
    s_cselect_b32 s36, 1, -1
    v_mul_lo_u32 v6, v6, s36
    v_sub_u32 v14, v13, v6
    v_add_u32 v13, v13, v6
    s_mov_b32 s42, 0
    s_mov_b32 s43, 0
    s_mov_b32 s48, 0
    v_mov_b32 v17, v12
    v_mov_b32 v18, v13
    v_mov_b32 v19, v14
    s_waitcnt vmcnt(4)
    s_barrier
    s_waitcnt vmcnt(0)
    s_barrier
    s_setprio 0
    s_waitcnt lgkmcnt(0)
    s_barrier
    ds_read_b128 v[136:139], v17 offset:0
    ds_read_b128 v[140:143], v17 offset:2048
    ds_read_b128 v[144:147], v17 offset:4096
    ds_read_b128 v[148:151], v17 offset:6144
    ds_read_b64_tr_b16 v[152:153], v18 offset:0
    ds_read_b64_tr_b16 v[154:155], v18 offset:7168
    ds_read_b64_tr_b16 v[156:157], v19 offset:32
    ds_read_b64_tr_b16 v[158:159], v19 offset:7200
    ds_read_b64_tr_b16 v[160:161], v18 offset:64
    ds_read_b64_tr_b16 v[162:163], v18 offset:7232
    ds_read_b64_tr_b16 v[164:165], v19 offset:96
    ds_read_b64_tr_b16 v[166:167], v19 offset:7264
    ds_read_b64_tr_b16 v[168:169], v18 offset:128
    ds_read_b64_tr_b16 v[170:171], v18 offset:7296
    ds_read_b64_tr_b16 v[172:173], v19 offset:160
    ds_read_b64_tr_b16 v[174:175], v19 offset:7328
    ds_read_b64_tr_b16 v[176:177], v18 offset:192
    ds_read_b64_tr_b16 v[178:179], v18 offset:7360
    s_waitcnt lgkmcnt(0)
    v_mfma_f32_16x16x32_bf16 v[24:27], v[152:155], v[136:139], 0
    ds_read_b128 v[180:183], v17 offset:1024
    v_mfma_f32_16x16x32_bf16 v[52:55], v[152:155], v[140:143], 0
    ds_read_b128 v[184:187], v17 offset:3072
    v_mfma_f32_16x16x32_bf16 v[80:83], v[152:155], v[144:147], 0
    ds_read_b128 v[188:191], v17 offset:5120
    v_mfma_f32_16x16x32_bf16 v[108:111], v[152:155], v[148:151], 0
    ds_read_b128 v[192:195], v17 offset:7168
    v_mfma_f32_16x16x32_bf16 v[112:115], v[156:159], v[148:151], 0
    ds_read_b64_tr_b16 v[196:197], v18 offset:14336
    v_mfma_f32_16x16x32_bf16 v[84:87], v[156:159], v[144:147], 0
    ds_read_b64_tr_b16 v[198:199], v18 offset:21504
    v_mfma_f32_16x16x32_bf16 v[56:59], v[156:159], v[140:143], 0
    v_mfma_f32_16x16x32_bf16 v[28:31], v[156:159], v[136:139], 0
    ds_read_b64_tr_b16 v[200:201], v19 offset:14368
    v_mfma_f32_16x16x32_bf16 v[32:35], v[160:163], v[136:139], 0
    ds_read_b64_tr_b16 v[202:203], v19 offset:21536
    v_mfma_f32_16x16x32_bf16 v[60:63], v[160:163], v[140:143], 0
    ds_read_b64_tr_b16 v[204:205], v18 offset:14400
    v_mfma_f32_16x16x32_bf16 v[88:91], v[160:163], v[144:147], 0
    ds_read_b64_tr_b16 v[206:207], v18 offset:21568
    v_mfma_f32_16x16x32_bf16 v[116:119], v[160:163], v[148:151], 0
    ds_read_b64_tr_b16 v[208:209], v19 offset:14432
    v_mfma_f32_16x16x32_bf16 v[120:123], v[164:167], v[148:151], 0
    ds_read_b64_tr_b16 v[210:211], v19 offset:21600
    v_mfma_f32_16x16x32_bf16 v[92:95], v[164:167], v[144:147], 0
    v_mfma_f32_16x16x32_bf16 v[64:67], v[164:167], v[140:143], 0
    ds_read_b64_tr_b16 v[212:213], v18 offset:14464
    v_mfma_f32_16x16x32_bf16 v[36:39], v[164:167], v[136:139], 0
    ds_read_b64_tr_b16 v[214:215], v18 offset:21632
    v_mfma_f32_16x16x32_bf16 v[40:43], v[168:171], v[136:139], 0
    ds_read_b64_tr_b16 v[216:217], v19 offset:14496
    v_mfma_f32_16x16x32_bf16 v[68:71], v[168:171], v[140:143], 0
    ds_read_b64_tr_b16 v[218:219], v19 offset:21664
    v_mfma_f32_16x16x32_bf16 v[96:99], v[168:171], v[144:147], 0
    ds_read_b64_tr_b16 v[220:221], v18 offset:14528
    v_mfma_f32_16x16x32_bf16 v[124:127], v[168:171], v[148:151], 0
    ds_read_b64_tr_b16 v[222:223], v18 offset:21696
    v_mfma_f32_16x16x32_bf16 v[128:131], v[172:175], v[148:151], 0
    s_add_u32 s42, s42, 16384
    s_cmp_eq_u32 s42, 49152
    v_mfma_f32_16x16x32_bf16 v[100:103], v[172:175], v[144:147], 0
    s_cselect_b32 s42, 0, s42
    s_add_u32 s48, s48, 28672
    v_mfma_f32_16x16x32_bf16 v[72:75], v[172:175], v[140:143], 0
    s_cmp_eq_u32 s48, 86016
    s_cselect_b32 s48, 0, s48
    v_mfma_f32_16x16x32_bf16 v[44:47], v[172:175], v[136:139], 0
    v_add_u32 v17, s42, v12
    v_add_u32 v18, s48, v13
    v_mfma_f32_16x16x32_bf16 v[48:51], v[176:179], v[136:139], 0
    v_add_u32 v19, s48, v14
    v_mfma_f32_16x16x32_bf16 v[76:79], v[176:179], v[140:143], 0
    v_mfma_f32_16x16x32_bf16 v[104:107], v[176:179], v[144:147], 0
    v_mfma_f32_16x16x32_bf16 v[132:135], v[176:179], v[148:151], 0
    s_waitcnt lgkmcnt(0)
    v_mfma_f32_16x16x32_bf16 v[24:27], v[196:199], v[180:183], v[24:27]
    v_mfma_f32_16x16x32_bf16 v[52:55], v[196:199], v[184:187], v[52:55]
    v_mfma_f32_16x16x32_bf16 v[80:83], v[196:199], v[188:191], v[80:83]
    v_mfma_f32_16x16x32_bf16 v[108:111], v[196:199], v[192:195], v[108:111]
    v_mfma_f32_16x16x32_bf16 v[112:115], v[200:203], v[192:195], v[112:115]
    v_mfma_f32_16x16x32_bf16 v[84:87], v[200:203], v[188:191], v[84:87]
    v_mfma_f32_16x16x32_bf16 v[56:59], v[200:203], v[184:187], v[56:59]
    v_mfma_f32_16x16x32_bf16 v[28:31], v[200:203], v[180:183], v[28:31]
    v_mfma_f32_16x16x32_bf16 v[32:35], v[204:207], v[180:183], v[32:35]
    v_mfma_f32_16x16x32_bf16 v[60:63], v[204:207], v[184:187], v[60:63]
    v_mfma_f32_16x16x32_bf16 v[88:91], v[204:207], v[188:191], v[88:91]
    v_mfma_f32_16x16x32_bf16 v[116:119], v[204:207], v[192:195], v[116:119]
    v_mfma_f32_16x16x32_bf16 v[120:123], v[208:211], v[192:195], v[120:123]
    v_mfma_f32_16x16x32_bf16 v[92:95], v[208:211], v[188:191], v[92:95]
    v_mfma_f32_16x16x32_bf16 v[64:67], v[208:211], v[184:187], v[64:67]
    v_mfma_f32_16x16x32_bf16 v[36:39], v[208:211], v[180:183], v[36:39]
    v_mfma_f32_16x16x32_bf16 v[40:43], v[212:215], v[180:183], v[40:43]
    v_mfma_f32_16x16x32_bf16 v[68:71], v[212:215], v[184:187], v[68:71]
    v_mfma_f32_16x16x32_bf16 v[96:99], v[212:215], v[188:191], v[96:99]
    v_mfma_f32_16x16x32_bf16 v[124:127], v[212:215], v[192:195], v[124:127]
    v_mfma_f32_16x16x32_bf16 v[128:131], v[216:219], v[192:195], v[128:131]
    s_add_u32 s43, s43, 1
    v_mfma_f32_16x16x32_bf16 v[100:103], v[216:219], v[188:191], v[100:103]
    v_mfma_f32_16x16x32_bf16 v[72:75], v[216:219], v[184:187], v[72:75]
    v_mfma_f32_16x16x32_bf16 v[44:47], v[216:219], v[180:183], v[44:47]
    v_mfma_f32_16x16x32_bf16 v[48:51], v[220:223], v[180:183], v[48:51]
    v_mfma_f32_16x16x32_bf16 v[76:79], v[220:223], v[184:187], v[76:79]
    v_mfma_f32_16x16x32_bf16 v[104:107], v[220:223], v[188:191], v[104:107]
    v_mfma_f32_16x16x32_bf16 v[132:135], v[220:223], v[192:195], v[132:135]
    s_barrier
    ds_read_b128 v[136:139], v17 offset:0
    ds_read_b128 v[140:143], v17 offset:2048
    ds_read_b128 v[144:147], v17 offset:4096
    ds_read_b128 v[148:151], v17 offset:6144
    ds_read_b64_tr_b16 v[152:153], v18 offset:0
    ds_read_b64_tr_b16 v[154:155], v18 offset:7168
    ds_read_b64_tr_b16 v[156:157], v19 offset:32
    ds_read_b64_tr_b16 v[158:159], v19 offset:7200
    ds_read_b64_tr_b16 v[160:161], v18 offset:64
    ds_read_b64_tr_b16 v[162:163], v18 offset:7232
    ds_read_b64_tr_b16 v[164:165], v19 offset:96
    ds_read_b64_tr_b16 v[166:167], v19 offset:7264
    ds_read_b64_tr_b16 v[168:169], v18 offset:128
    ds_read_b64_tr_b16 v[170:171], v18 offset:7296
    ds_read_b64_tr_b16 v[172:173], v19 offset:160
    ds_read_b64_tr_b16 v[174:175], v19 offset:7328
    ds_read_b64_tr_b16 v[176:177], v18 offset:192
    ds_read_b64_tr_b16 v[178:179], v18 offset:7360
mm_26:
    s_waitcnt lgkmcnt(0)
    v_mfma_f32_16x16x32_bf16 v[24:27], v[152:155], v[136:139], v[24:27]
    ds_read_b128 v[180:183], v17 offset:1024
    v_mfma_f32_16x16x32_bf16 v[52:55], v[152:155], v[140:143], v[52:55]
    ds_read_b128 v[184:187], v17 offset:3072
    v_mfma_f32_16x16x32_bf16 v[80:83], v[152:155], v[144:147], v[80:83]
    ds_read_b128 v[188:191], v17 offset:5120
    v_mfma_f32_16x16x32_bf16 v[108:111], v[152:155], v[148:151], v[108:111]
    ds_read_b128 v[192:195], v17 offset:7168
    v_mfma_f32_16x16x32_bf16 v[112:115], v[156:159], v[148:151], v[112:115]
    ds_read_b64_tr_b16 v[196:197], v18 offset:14336
    v_mfma_f32_16x16x32_bf16 v[84:87], v[156:159], v[144:147], v[84:87]
    ds_read_b64_tr_b16 v[198:199], v18 offset:21504
    v_mfma_f32_16x16x32_bf16 v[56:59], v[156:159], v[140:143], v[56:59]
    v_mfma_f32_16x16x32_bf16 v[28:31], v[156:159], v[136:139], v[28:31]
    ds_read_b64_tr_b16 v[200:201], v19 offset:14368
    v_mfma_f32_16x16x32_bf16 v[32:35], v[160:163], v[136:139], v[32:35]
    ds_read_b64_tr_b16 v[202:203], v19 offset:21536
    v_mfma_f32_16x16x32_bf16 v[60:63], v[160:163], v[140:143], v[60:63]
    ds_read_b64_tr_b16 v[204:205], v18 offset:14400
    v_mfma_f32_16x16x32_bf16 v[88:91], v[160:163], v[144:147], v[88:91]
    ds_read_b64_tr_b16 v[206:207], v18 offset:21568
    v_mfma_f32_16x16x32_bf16 v[116:119], v[160:163], v[148:151], v[116:119]
    ds_read_b64_tr_b16 v[208:209], v19 offset:14432
    v_mfma_f32_16x16x32_bf16 v[120:123], v[164:167], v[148:151], v[120:123]
    ds_read_b64_tr_b16 v[210:211], v19 offset:21600
    v_mfma_f32_16x16x32_bf16 v[92:95], v[164:167], v[144:147], v[92:95]
    v_mfma_f32_16x16x32_bf16 v[64:67], v[164:167], v[140:143], v[64:67]
    ds_read_b64_tr_b16 v[212:213], v18 offset:14464
    v_mfma_f32_16x16x32_bf16 v[36:39], v[164:167], v[136:139], v[36:39]
    ds_read_b64_tr_b16 v[214:215], v18 offset:21632
    v_mfma_f32_16x16x32_bf16 v[40:43], v[168:171], v[136:139], v[40:43]
    ds_read_b64_tr_b16 v[216:217], v19 offset:14496
    v_mfma_f32_16x16x32_bf16 v[68:71], v[168:171], v[140:143], v[68:71]
    ds_read_b64_tr_b16 v[218:219], v19 offset:21664
    v_mfma_f32_16x16x32_bf16 v[96:99], v[168:171], v[144:147], v[96:99]
    ds_read_b64_tr_b16 v[220:221], v18 offset:14528
    v_mfma_f32_16x16x32_bf16 v[124:127], v[168:171], v[148:151], v[124:127]
    ds_read_b64_tr_b16 v[222:223], v18 offset:21696
    v_mfma_f32_16x16x32_bf16 v[128:131], v[172:175], v[148:151], v[128:131]
    s_add_u32 s42, s42, 16384
    s_cmp_eq_u32 s42, 49152
    v_mfma_f32_16x16x32_bf16 v[100:103], v[172:175], v[144:147], v[100:103]
    s_cselect_b32 s42, 0, s42
    s_add_u32 s48, s48, 28672
    v_mfma_f32_16x16x32_bf16 v[72:75], v[172:175], v[140:143], v[72:75]
    s_cmp_eq_u32 s48, 86016
    s_cselect_b32 s48, 0, s48
    v_mfma_f32_16x16x32_bf16 v[44:47], v[172:175], v[136:139], v[44:47]
    v_add_u32 v17, s42, v12
    v_add_u32 v18, s48, v13
    v_mfma_f32_16x16x32_bf16 v[48:51], v[176:179], v[136:139], v[48:51]
    v_add_u32 v19, s48, v14
    v_mfma_f32_16x16x32_bf16 v[76:79], v[176:179], v[140:143], v[76:79]
    v_mfma_f32_16x16x32_bf16 v[104:107], v[176:179], v[144:147], v[104:107]
    v_mfma_f32_16x16x32_bf16 v[132:135], v[176:179], v[148:151], v[132:135]
    s_waitcnt lgkmcnt(0)
    s_barrier
    v_mfma_f32_16x16x32_bf16 v[24:27], v[196:199], v[180:183], v[24:27]
    ds_read_b128 v[136:139], v17 offset:0
    v_mfma_f32_16x16x32_bf16 v[52:55], v[196:199], v[184:187], v[52:55]
    ds_read_b128 v[140:143], v17 offset:2048
    v_mfma_f32_16x16x32_bf16 v[80:83], v[196:199], v[188:191], v[80:83]
    ds_read_b128 v[144:147], v17 offset:4096
    v_mfma_f32_16x16x32_bf16 v[108:111], v[196:199], v[192:195], v[108:111]
    ds_read_b128 v[148:151], v17 offset:6144
    v_mfma_f32_16x16x32_bf16 v[112:115], v[200:203], v[192:195], v[112:115]
    ds_read_b64_tr_b16 v[152:153], v18 offset:0
    v_mfma_f32_16x16x32_bf16 v[84:87], v[200:203], v[188:191], v[84:87]
    ds_read_b64_tr_b16 v[154:155], v18 offset:7168
    v_mfma_f32_16x16x32_bf16 v[56:59], v[200:203], v[184:187], v[56:59]
    v_mfma_f32_16x16x32_bf16 v[28:31], v[200:203], v[180:183], v[28:31]
    ds_read_b64_tr_b16 v[156:157], v19 offset:32
    v_mfma_f32_16x16x32_bf16 v[32:35], v[204:207], v[180:183], v[32:35]
    ds_read_b64_tr_b16 v[158:159], v19 offset:7200
    v_mfma_f32_16x16x32_bf16 v[60:63], v[204:207], v[184:187], v[60:63]
    ds_read_b64_tr_b16 v[160:161], v18 offset:64
    v_mfma_f32_16x16x32_bf16 v[88:91], v[204:207], v[188:191], v[88:91]
    ds_read_b64_tr_b16 v[162:163], v18 offset:7232
    v_mfma_f32_16x16x32_bf16 v[116:119], v[204:207], v[192:195], v[116:119]
    ds_read_b64_tr_b16 v[164:165], v19 offset:96
    v_mfma_f32_16x16x32_bf16 v[120:123], v[208:211], v[192:195], v[120:123]
    ds_read_b64_tr_b16 v[166:167], v19 offset:7264
    v_mfma_f32_16x16x32_bf16 v[92:95], v[208:211], v[188:191], v[92:95]
    v_mfma_f32_16x16x32_bf16 v[64:67], v[208:211], v[184:187], v[64:67]
    ds_read_b64_tr_b16 v[168:169], v18 offset:128
    v_mfma_f32_16x16x32_bf16 v[36:39], v[208:211], v[180:183], v[36:39]
    ds_read_b64_tr_b16 v[170:171], v18 offset:7296
    v_mfma_f32_16x16x32_bf16 v[40:43], v[212:215], v[180:183], v[40:43]
    ds_read_b64_tr_b16 v[172:173], v19 offset:160
    v_mfma_f32_16x16x32_bf16 v[68:71], v[212:215], v[184:187], v[68:71]
    ds_read_b64_tr_b16 v[174:175], v19 offset:7328
    v_mfma_f32_16x16x32_bf16 v[96:99], v[212:215], v[188:191], v[96:99]
    ds_read_b64_tr_b16 v[176:177], v18 offset:192
    v_mfma_f32_16x16x32_bf16 v[124:127], v[212:215], v[192:195], v[124:127]
    ds_read_b64_tr_b16 v[178:179], v18 offset:7360
    v_mfma_f32_16x16x32_bf16 v[128:131], v[216:219], v[192:195], v[128:131]
    s_add_u32 s43, s43, 1
    v_mfma_f32_16x16x32_bf16 v[100:103], v[216:219], v[188:191], v[100:103]
    s_cmp_lt_u32 s43, 15
    v_mfma_f32_16x16x32_bf16 v[72:75], v[216:219], v[184:187], v[72:75]
    v_mfma_f32_16x16x32_bf16 v[44:47], v[216:219], v[180:183], v[44:47]
    v_mfma_f32_16x16x32_bf16 v[48:51], v[220:223], v[180:183], v[48:51]
    v_mfma_f32_16x16x32_bf16 v[76:79], v[220:223], v[184:187], v[76:79]
    v_mfma_f32_16x16x32_bf16 v[104:107], v[220:223], v[188:191], v[104:107]
    v_mfma_f32_16x16x32_bf16 v[132:135], v[220:223], v[192:195], v[132:135]
    s_cbranch_scc1 mm_26
    s_waitcnt lgkmcnt(0)
    v_mfma_f32_16x16x32_bf16 v[24:27], v[152:155], v[136:139], v[24:27]
    ds_read_b128 v[180:183], v17 offset:1024
    v_mfma_f32_16x16x32_bf16 v[52:55], v[152:155], v[140:143], v[52:55]
    ds_read_b128 v[184:187], v17 offset:3072
    v_mfma_f32_16x16x32_bf16 v[80:83], v[152:155], v[144:147], v[80:83]
    ds_read_b128 v[188:191], v17 offset:5120
    v_mfma_f32_16x16x32_bf16 v[108:111], v[152:155], v[148:151], v[108:111]
    ds_read_b128 v[192:195], v17 offset:7168
    v_mfma_f32_16x16x32_bf16 v[112:115], v[156:159], v[148:151], v[112:115]
    ds_read_b64_tr_b16 v[196:197], v18 offset:14336
    v_mfma_f32_16x16x32_bf16 v[84:87], v[156:159], v[144:147], v[84:87]
    ds_read_b64_tr_b16 v[198:199], v18 offset:21504
    v_mfma_f32_16x16x32_bf16 v[56:59], v[156:159], v[140:143], v[56:59]
    v_mfma_f32_16x16x32_bf16 v[28:31], v[156:159], v[136:139], v[28:31]
    ds_read_b64_tr_b16 v[200:201], v19 offset:14368
    v_mfma_f32_16x16x32_bf16 v[32:35], v[160:163], v[136:139], v[32:35]
    ds_read_b64_tr_b16 v[202:203], v19 offset:21536
    v_mfma_f32_16x16x32_bf16 v[60:63], v[160:163], v[140:143], v[60:63]
    ds_read_b64_tr_b16 v[204:205], v18 offset:14400
    v_mfma_f32_16x16x32_bf16 v[88:91], v[160:163], v[144:147], v[88:91]
    ds_read_b64_tr_b16 v[206:207], v18 offset:21568
    v_mfma_f32_16x16x32_bf16 v[116:119], v[160:163], v[148:151], v[116:119]
    ds_read_b64_tr_b16 v[208:209], v19 offset:14432
    v_mfma_f32_16x16x32_bf16 v[120:123], v[164:167], v[148:151], v[120:123]
    ds_read_b64_tr_b16 v[210:211], v19 offset:21600
    v_mfma_f32_16x16x32_bf16 v[92:95], v[164:167], v[144:147], v[92:95]
    v_mfma_f32_16x16x32_bf16 v[64:67], v[164:167], v[140:143], v[64:67]
    ds_read_b64_tr_b16 v[212:213], v18 offset:14464
    v_mfma_f32_16x16x32_bf16 v[36:39], v[164:167], v[136:139], v[36:39]
    ds_read_b64_tr_b16 v[214:215], v18 offset:21632
    v_mfma_f32_16x16x32_bf16 v[40:43], v[168:171], v[136:139], v[40:43]
    ds_read_b64_tr_b16 v[216:217], v19 offset:14496
    v_mfma_f32_16x16x32_bf16 v[68:71], v[168:171], v[140:143], v[68:71]
    ds_read_b64_tr_b16 v[218:219], v19 offset:21664
    v_mfma_f32_16x16x32_bf16 v[96:99], v[168:171], v[144:147], v[96:99]
    ds_read_b64_tr_b16 v[220:221], v18 offset:14528
    v_mfma_f32_16x16x32_bf16 v[124:127], v[168:171], v[148:151], v[124:127]
    ds_read_b64_tr_b16 v[222:223], v18 offset:21696
    v_mfma_f32_16x16x32_bf16 v[128:131], v[172:175], v[148:151], v[128:131]
    v_mfma_f32_16x16x32_bf16 v[100:103], v[172:175], v[144:147], v[100:103]
    v_mfma_f32_16x16x32_bf16 v[72:75], v[172:175], v[140:143], v[72:75]
    v_mfma_f32_16x16x32_bf16 v[44:47], v[172:175], v[136:139], v[44:47]
    v_mfma_f32_16x16x32_bf16 v[48:51], v[176:179], v[136:139], v[48:51]
    v_mfma_f32_16x16x32_bf16 v[76:79], v[176:179], v[140:143], v[76:79]
    v_mfma_f32_16x16x32_bf16 v[104:107], v[176:179], v[144:147], v[104:107]
    v_mfma_f32_16x16x32_bf16 v[132:135], v[176:179], v[148:151], v[132:135]
    s_waitcnt lgkmcnt(0)
    s_barrier
    v_mfma_f32_16x16x32_bf16 v[24:27], v[196:199], v[180:183], v[24:27]
    s_mul_i32 s36, s35, 448
    s_add_u32 s36, s36, 159744
    v_lshlrev_b32 v6, 4, v23
    v_add_u32 v6, s36, v6
    v_mfma_f32_16x16x32_bf16 v[52:55], v[196:199], v[184:187], v[52:55]
    ds_read_b128 v[136:139], v6 offset:0
    ds_read_b128 v[140:143], v6 offset:64
    ds_read_b128 v[144:147], v6 offset:128
    v_mfma_f32_16x16x32_bf16 v[80:83], v[196:199], v[188:191], v[80:83]
    ds_read_b128 v[148:151], v6 offset:192
    ds_read_b128 v[152:155], v6 offset:256
    ds_read_b128 v[156:159], v6 offset:320
    v_mfma_f32_16x16x32_bf16 v[108:111], v[196:199], v[192:195], v[108:111]
    ds_read_b128 v[160:163], v6 offset:384
    s_lshl_b32 s36, s34, 9
    s_add_u32 s36, s36, 160768
    v_mfma_f32_16x16x32_bf16 v[112:115], v[200:203], v[192:195], v[112:115]
    v_lshlrev_b32 v7, 3, v22
    v_add_u32 v7, s36, v7
    ds_read_b64 v[164:165], v7 offset:0
    v_mfma_f32_16x16x32_bf16 v[84:87], v[200:203], v[188:191], v[84:87]
    ds_read_b64 v[166:167], v7 offset:128
    ds_read_b64 v[168:169], v7 offset:256
    ds_read_b64 v[170:171], v7 offset:384
    v_mfma_f32_16x16x32_bf16 v[56:59], v[200:203], v[184:187], v[56:59]
    s_mov_b32 s16, s62
    s_mov_b32 s17, s63
    s_mov_b32 s18, 0x1be000
    v_mfma_f32_16x16x32_bf16 v[28:31], v[200:203], v[180:183], v[28:31]
    s_mov_b32 s19, 0x20000
    s_mul_i32 s39, s37, 229376
    s_lshr_b32 s36, s38, 1
    v_mfma_f32_16x16x32_bf16 v[32:35], v[204:207], v[180:183], v[32:35]
    s_add_u32 s36, s36, 0
    s_lshr_b32 s53, s36, 3
    s_lshl_b32 s53, s53, 14
    v_mfma_f32_16x16x32_bf16 v[60:63], v[204:207], v[184:187], v[60:63]
    s_and_b32 s44, s36, 7
    s_lshl_b32 s44, s44, 10
    s_add_u32 s44, s44, s53
    v_mfma_f32_16x16x32_bf16 v[88:91], v[204:207], v[188:191], v[88:91]
    s_add_u32 s44, s44, s39
    s_lshr_b32 s36, s38, 1
    s_add_u32 s36, s36, 1
    s_lshr_b32 s53, s36, 3
    v_mfma_f32_16x16x32_bf16 v[116:119], v[204:207], v[192:195], v[116:119]
    s_lshl_b32 s53, s53, 14
    s_and_b32 s45, s36, 7
    s_lshl_b32 s45, s45, 10
    v_mfma_f32_16x16x32_bf16 v[120:123], v[208:211], v[192:195], v[120:123]
    s_add_u32 s45, s45, s53
    s_add_u32 s45, s45, s39
    s_lshr_b32 s36, s38, 1
    v_mfma_f32_16x16x32_bf16 v[92:95], v[208:211], v[188:191], v[92:95]
    s_add_u32 s36, s36, 2
    s_lshr_b32 s53, s36, 3
    s_lshl_b32 s53, s53, 14
    v_mfma_f32_16x16x32_bf16 v[64:67], v[208:211], v[184:187], v[64:67]
    s_and_b32 s46, s36, 7
    s_lshl_b32 s46, s46, 10
    s_add_u32 s46, s46, s53
    v_mfma_f32_16x16x32_bf16 v[36:39], v[208:211], v[180:183], v[36:39]
    s_add_u32 s46, s46, s39
    s_lshr_b32 s36, s38, 1
    s_add_u32 s36, s36, 3
    v_mfma_f32_16x16x32_bf16 v[40:43], v[212:215], v[180:183], v[40:43]
    s_lshr_b32 s53, s36, 3
    s_lshl_b32 s53, s53, 14
    s_and_b32 s47, s36, 7
    v_mfma_f32_16x16x32_bf16 v[68:71], v[212:215], v[184:187], v[68:71]
    s_lshl_b32 s47, s47, 10
    s_add_u32 s47, s47, s53
    s_add_u32 s47, s47, s39
    v_mfma_f32_16x16x32_bf16 v[96:99], v[212:215], v[188:191], v[96:99]
    s_lshl_b32 s36, s37, 1
    s_add_u32 s36, s36, s35
    s_lshl_b32 s36, s36, 10
    v_mfma_f32_16x16x32_bf16 v[124:127], v[212:215], v[192:195], v[124:127]
    v_add_u32 v12, s36, v2
    v_lshrrev_b32 v254, 1, v23
    v_lshlrev_b32 v254, 8, v254
    v_mfma_f32_16x16x32_bf16 v[128:131], v[216:219], v[192:195], v[128:131]
    v_lshl_add_u32 v254, v22, 4, v254
    v_and_b32 v224, 1, v23
    v_lshl_add_u32 v254, v224, 3, v254
    v_mfma_f32_16x16x32_bf16 v[100:103], v[216:219], v[188:191], v[100:103]
    v_mfma_f32_16x16x32_bf16 v[72:75], v[216:219], v[184:187], v[72:75]
    v_mfma_f32_16x16x32_bf16 v[44:47], v[216:219], v[180:183], v[44:47]
    v_mfma_f32_16x16x32_bf16 v[48:51], v[220:223], v[180:183], v[48:51]
    v_mfma_f32_16x16x32_bf16 v[76:79], v[220:223], v[184:187], v[76:79]
    v_mfma_f32_16x16x32_bf16 v[104:107], v[220:223], v[188:191], v[104:107]
    v_mfma_f32_16x16x32_bf16 v[132:135], v[220:223], v[192:195], v[132:135]
    s_waitcnt lgkmcnt(0)
    v_mul_f32 v184, 0xc0135761, v165
    v_mul_f32 v185, v165, v165
    v_mul_f32 v185, v185, v184
    v_mul_f32 v185, 0x3d372713, v185
    v_rcp_f32 v165, v165
    v_mul_f32 v186, 0xc0135761, v167
    v_mul_f32 v187, v167, v167
    v_mul_f32 v187, v187, v186
    v_mul_f32 v187, 0x3d372713, v187
    v_rcp_f32 v167, v167
    v_mul_f32 v188, 0xc0135761, v169
    v_mul_f32 v189, v169, v169
    v_mul_f32 v189, v189, v188
    v_mul_f32 v189, 0x3d372713, v189
    v_rcp_f32 v169, v169
    v_mul_f32 v190, 0xc0135761, v171
    v_mul_f32 v191, v171, v171
    v_mul_f32 v191, v191, v190
    v_mul_f32 v191, 0x3d372713, v191
    v_rcp_f32 v171, v171
    s_cmp_eq_u32 s35, 1
    s_cbranch_scc1 G3_e1
    v_pk_fma_f32 v[24:25], v[164:165], v[136:137], v[24:25] op_sel_hi:[0,1,1] neg_lo:[1,0,0] neg_hi:[1,0,0]
    v_pk_fma_f32 v[26:27], v[164:165], v[138:139], v[26:27] op_sel_hi:[0,1,1] neg_lo:[1,0,0] neg_hi:[1,0,0]
    v_pk_fma_f32 v[28:29], v[164:165], v[140:141], v[28:29] op_sel_hi:[0,1,1] neg_lo:[1,0,0] neg_hi:[1,0,0]
    v_pk_fma_f32 v[30:31], v[164:165], v[142:143], v[30:31] op_sel_hi:[0,1,1] neg_lo:[1,0,0] neg_hi:[1,0,0]
    v_pk_mul_f32 v[192:193], v[24:25], v[24:25]
    v_pk_mul_f32 v[194:195], v[26:27], v[26:27]
    v_pk_mul_f32 v[196:197], v[28:29], v[28:29]
    v_pk_mul_f32 v[198:199], v[30:31], v[30:31]
    v_pk_fma_f32 v[192:193], v[192:193], v[184:185], v[184:185] op_sel:[0,1,0] op_sel_hi:[1,1,0]
    v_pk_fma_f32 v[194:195], v[194:195], v[184:185], v[184:185] op_sel:[0,1,0] op_sel_hi:[1,1,0]
    v_pk_fma_f32 v[196:197], v[196:197], v[184:185], v[184:185] op_sel:[0,1,0] op_sel_hi:[1,1,0]
    v_pk_fma_f32 v[198:199], v[198:199], v[184:185], v[184:185] op_sel:[0,1,0] op_sel_hi:[1,1,0]
    v_pk_mul_f32 v[192:193], v[192:193], v[24:25]
    v_pk_mul_f32 v[194:195], v[194:195], v[26:27]
    v_pk_mul_f32 v[196:197], v[196:197], v[28:29]
    v_pk_mul_f32 v[198:199], v[198:199], v[30:31]
    v_exp_f32 v192, v192
    v_exp_f32 v193, v193
    v_exp_f32 v194, v194
    v_exp_f32 v195, v195
    v_exp_f32 v196, v196
    v_exp_f32 v197, v197
    v_exp_f32 v198, v198
    v_exp_f32 v199, v199
    v_pk_fma_f32 v[192:193], v[192:193], v[164:165], v[164:165] op_sel:[0,1,1] op_sel_hi:[1,1,1]
    v_pk_fma_f32 v[194:195], v[194:195], v[164:165], v[164:165] op_sel:[0,1,1] op_sel_hi:[1,1,1]
    v_pk_fma_f32 v[196:197], v[196:197], v[164:165], v[164:165] op_sel:[0,1,1] op_sel_hi:[1,1,1]
    v_pk_fma_f32 v[198:199], v[198:199], v[164:165], v[164:165] op_sel:[0,1,1] op_sel_hi:[1,1,1]
    v_rcp_f32 v192, v192
    v_rcp_f32 v193, v193
    v_rcp_f32 v194, v194
    v_rcp_f32 v195, v195
    v_rcp_f32 v196, v196
    v_rcp_f32 v197, v197
    v_rcp_f32 v198, v198
    v_rcp_f32 v199, v199
    v_pk_mul_f32 v[24:25], v[24:25], v[192:193]
    v_pk_mul_f32 v[26:27], v[26:27], v[194:195]
    v_pk_mul_f32 v[28:29], v[28:29], v[196:197]
    v_pk_mul_f32 v[30:31], v[30:31], v[198:199]
    v_cvt_pk_bf16_f32 v24, v24, v25
    v_cvt_pk_bf16_f32 v25, v26, v27
    v_cvt_pk_bf16_f32 v26, v28, v29
    v_cvt_pk_bf16_f32 v27, v30, v31
    ds_write_b128 v12, v[24:27] offset:0
    s_add_u32 s36, s44, 0
    buffer_store_dwordx4 v[24:27], v2, s[16:19], s36 offen sc1
    v_pk_fma_f32 v[52:53], v[166:167], v[136:137], v[52:53] op_sel_hi:[0,1,1] neg_lo:[1,0,0] neg_hi:[1,0,0]
    v_pk_fma_f32 v[54:55], v[166:167], v[138:139], v[54:55] op_sel_hi:[0,1,1] neg_lo:[1,0,0] neg_hi:[1,0,0]
    v_pk_fma_f32 v[56:57], v[166:167], v[140:141], v[56:57] op_sel_hi:[0,1,1] neg_lo:[1,0,0] neg_hi:[1,0,0]
    v_pk_fma_f32 v[58:59], v[166:167], v[142:143], v[58:59] op_sel_hi:[0,1,1] neg_lo:[1,0,0] neg_hi:[1,0,0]
    v_pk_mul_f32 v[192:193], v[52:53], v[52:53]
    v_pk_mul_f32 v[194:195], v[54:55], v[54:55]
    v_pk_mul_f32 v[196:197], v[56:57], v[56:57]
    v_pk_mul_f32 v[198:199], v[58:59], v[58:59]
    v_pk_fma_f32 v[192:193], v[192:193], v[186:187], v[186:187] op_sel:[0,1,0] op_sel_hi:[1,1,0]
    v_pk_fma_f32 v[194:195], v[194:195], v[186:187], v[186:187] op_sel:[0,1,0] op_sel_hi:[1,1,0]
    v_pk_fma_f32 v[196:197], v[196:197], v[186:187], v[186:187] op_sel:[0,1,0] op_sel_hi:[1,1,0]
    v_pk_fma_f32 v[198:199], v[198:199], v[186:187], v[186:187] op_sel:[0,1,0] op_sel_hi:[1,1,0]
    v_pk_mul_f32 v[192:193], v[192:193], v[52:53]
    v_pk_mul_f32 v[194:195], v[194:195], v[54:55]
    v_pk_mul_f32 v[196:197], v[196:197], v[56:57]
    v_pk_mul_f32 v[198:199], v[198:199], v[58:59]
    v_exp_f32 v192, v192
    v_exp_f32 v193, v193
    v_exp_f32 v194, v194
    v_exp_f32 v195, v195
    v_exp_f32 v196, v196
    v_exp_f32 v197, v197
    v_exp_f32 v198, v198
    v_exp_f32 v199, v199
    v_pk_fma_f32 v[192:193], v[192:193], v[166:167], v[166:167] op_sel:[0,1,1] op_sel_hi:[1,1,1]
    v_pk_fma_f32 v[194:195], v[194:195], v[166:167], v[166:167] op_sel:[0,1,1] op_sel_hi:[1,1,1]
    v_pk_fma_f32 v[196:197], v[196:197], v[166:167], v[166:167] op_sel:[0,1,1] op_sel_hi:[1,1,1]
    v_pk_fma_f32 v[198:199], v[198:199], v[166:167], v[166:167] op_sel:[0,1,1] op_sel_hi:[1,1,1]
    v_rcp_f32 v192, v192
    v_rcp_f32 v193, v193
    v_rcp_f32 v194, v194
    v_rcp_f32 v195, v195
    v_rcp_f32 v196, v196
    v_rcp_f32 v197, v197
    v_rcp_f32 v198, v198
    v_rcp_f32 v199, v199
    v_pk_mul_f32 v[52:53], v[52:53], v[192:193]
    v_pk_mul_f32 v[54:55], v[54:55], v[194:195]
    v_pk_mul_f32 v[56:57], v[56:57], v[196:197]
    v_pk_mul_f32 v[58:59], v[58:59], v[198:199]
    v_cvt_pk_bf16_f32 v52, v52, v53
    v_cvt_pk_bf16_f32 v53, v54, v55
    v_cvt_pk_bf16_f32 v54, v56, v57
    v_cvt_pk_bf16_f32 v55, v58, v59
    ds_write_b128 v12, v[52:55] offset:2048
    s_add_u32 s36, s44, 229376
    buffer_store_dwordx4 v[52:55], v2, s[16:19], s36 offen sc1
    v_pk_fma_f32 v[80:81], v[168:169], v[136:137], v[80:81] op_sel_hi:[0,1,1] neg_lo:[1,0,0] neg_hi:[1,0,0]
    v_pk_fma_f32 v[82:83], v[168:169], v[138:139], v[82:83] op_sel_hi:[0,1,1] neg_lo:[1,0,0] neg_hi:[1,0,0]
    v_pk_fma_f32 v[84:85], v[168:169], v[140:141], v[84:85] op_sel_hi:[0,1,1] neg_lo:[1,0,0] neg_hi:[1,0,0]
    v_pk_fma_f32 v[86:87], v[168:169], v[142:143], v[86:87] op_sel_hi:[0,1,1] neg_lo:[1,0,0] neg_hi:[1,0,0]
    v_pk_mul_f32 v[192:193], v[80:81], v[80:81]
    v_pk_mul_f32 v[194:195], v[82:83], v[82:83]
    v_pk_mul_f32 v[196:197], v[84:85], v[84:85]
    v_pk_mul_f32 v[198:199], v[86:87], v[86:87]
    v_pk_fma_f32 v[192:193], v[192:193], v[188:189], v[188:189] op_sel:[0,1,0] op_sel_hi:[1,1,0]
    v_pk_fma_f32 v[194:195], v[194:195], v[188:189], v[188:189] op_sel:[0,1,0] op_sel_hi:[1,1,0]
    v_pk_fma_f32 v[196:197], v[196:197], v[188:189], v[188:189] op_sel:[0,1,0] op_sel_hi:[1,1,0]
    v_pk_fma_f32 v[198:199], v[198:199], v[188:189], v[188:189] op_sel:[0,1,0] op_sel_hi:[1,1,0]
    v_pk_mul_f32 v[192:193], v[192:193], v[80:81]
    v_pk_mul_f32 v[194:195], v[194:195], v[82:83]
    v_pk_mul_f32 v[196:197], v[196:197], v[84:85]
    v_pk_mul_f32 v[198:199], v[198:199], v[86:87]
    v_exp_f32 v192, v192
    v_exp_f32 v193, v193
    v_exp_f32 v194, v194
    v_exp_f32 v195, v195
    v_exp_f32 v196, v196
    v_exp_f32 v197, v197
    v_exp_f32 v198, v198
    v_exp_f32 v199, v199
    v_pk_fma_f32 v[192:193], v[192:193], v[168:169], v[168:169] op_sel:[0,1,1] op_sel_hi:[1,1,1]
    v_pk_fma_f32 v[194:195], v[194:195], v[168:169], v[168:169] op_sel:[0,1,1] op_sel_hi:[1,1,1]
    v_pk_fma_f32 v[196:197], v[196:197], v[168:169], v[168:169] op_sel:[0,1,1] op_sel_hi:[1,1,1]
    v_pk_fma_f32 v[198:199], v[198:199], v[168:169], v[168:169] op_sel:[0,1,1] op_sel_hi:[1,1,1]
    v_rcp_f32 v192, v192
    v_rcp_f32 v193, v193
    v_rcp_f32 v194, v194
    v_rcp_f32 v195, v195
    v_rcp_f32 v196, v196
    v_rcp_f32 v197, v197
    v_rcp_f32 v198, v198
    v_rcp_f32 v199, v199
    v_pk_mul_f32 v[80:81], v[80:81], v[192:193]
    v_pk_mul_f32 v[82:83], v[82:83], v[194:195]
    v_pk_mul_f32 v[84:85], v[84:85], v[196:197]
    v_pk_mul_f32 v[86:87], v[86:87], v[198:199]
    v_cvt_pk_bf16_f32 v80, v80, v81
    v_cvt_pk_bf16_f32 v81, v82, v83
    v_cvt_pk_bf16_f32 v82, v84, v85
    v_cvt_pk_bf16_f32 v83, v86, v87
    ds_write_b128 v12, v[80:83] offset:4096
    s_add_u32 s36, s44, 458752
    buffer_store_dwordx4 v[80:83], v2, s[16:19], s36 offen sc1
    v_pk_fma_f32 v[108:109], v[170:171], v[136:137], v[108:109] op_sel_hi:[0,1,1] neg_lo:[1,0,0] neg_hi:[1,0,0]
    v_pk_fma_f32 v[110:111], v[170:171], v[138:139], v[110:111] op_sel_hi:[0,1,1] neg_lo:[1,0,0] neg_hi:[1,0,0]
    v_pk_fma_f32 v[112:113], v[170:171], v[140:141], v[112:113] op_sel_hi:[0,1,1] neg_lo:[1,0,0] neg_hi:[1,0,0]
    v_pk_fma_f32 v[114:115], v[170:171], v[142:143], v[114:115] op_sel_hi:[0,1,1] neg_lo:[1,0,0] neg_hi:[1,0,0]
    v_pk_mul_f32 v[192:193], v[108:109], v[108:109]
    v_pk_mul_f32 v[194:195], v[110:111], v[110:111]
    v_pk_mul_f32 v[196:197], v[112:113], v[112:113]
    v_pk_mul_f32 v[198:199], v[114:115], v[114:115]
    v_pk_fma_f32 v[192:193], v[192:193], v[190:191], v[190:191] op_sel:[0,1,0] op_sel_hi:[1,1,0]
    v_pk_fma_f32 v[194:195], v[194:195], v[190:191], v[190:191] op_sel:[0,1,0] op_sel_hi:[1,1,0]
    v_pk_fma_f32 v[196:197], v[196:197], v[190:191], v[190:191] op_sel:[0,1,0] op_sel_hi:[1,1,0]
    v_pk_fma_f32 v[198:199], v[198:199], v[190:191], v[190:191] op_sel:[0,1,0] op_sel_hi:[1,1,0]
    v_pk_mul_f32 v[192:193], v[192:193], v[108:109]
    v_pk_mul_f32 v[194:195], v[194:195], v[110:111]
    v_pk_mul_f32 v[196:197], v[196:197], v[112:113]
    v_pk_mul_f32 v[198:199], v[198:199], v[114:115]
    v_exp_f32 v192, v192
    v_exp_f32 v193, v193
    v_exp_f32 v194, v194
    v_exp_f32 v195, v195
    v_exp_f32 v196, v196
    v_exp_f32 v197, v197
    v_exp_f32 v198, v198
    v_exp_f32 v199, v199
    v_pk_fma_f32 v[192:193], v[192:193], v[170:171], v[170:171] op_sel:[0,1,1] op_sel_hi:[1,1,1]
    v_pk_fma_f32 v[194:195], v[194:195], v[170:171], v[170:171] op_sel:[0,1,1] op_sel_hi:[1,1,1]
    v_pk_fma_f32 v[196:197], v[196:197], v[170:171], v[170:171] op_sel:[0,1,1] op_sel_hi:[1,1,1]
    v_pk_fma_f32 v[198:199], v[198:199], v[170:171], v[170:171] op_sel:[0,1,1] op_sel_hi:[1,1,1]
    v_rcp_f32 v192, v192
    v_rcp_f32 v193, v193
    v_rcp_f32 v194, v194
    v_rcp_f32 v195, v195
    v_rcp_f32 v196, v196
    v_rcp_f32 v197, v197
    v_rcp_f32 v198, v198
    v_rcp_f32 v199, v199
    v_pk_mul_f32 v[108:109], v[108:109], v[192:193]
    v_pk_mul_f32 v[110:111], v[110:111], v[194:195]
    v_pk_mul_f32 v[112:113], v[112:113], v[196:197]
    v_pk_mul_f32 v[114:115], v[114:115], v[198:199]
    v_cvt_pk_bf16_f32 v108, v108, v109
    v_cvt_pk_bf16_f32 v109, v110, v111
    v_cvt_pk_bf16_f32 v110, v112, v113
    v_cvt_pk_bf16_f32 v111, v114, v115
    ds_write_b128 v12, v[108:111] offset:6144
    s_add_u32 s36, s44, 688128
    buffer_store_dwordx4 v[108:111], v2, s[16:19], s36 offen sc1
    v_pk_fma_f32 v[32:33], v[164:165], v[144:145], v[32:33] op_sel_hi:[0,1,1] neg_lo:[1,0,0] neg_hi:[1,0,0]
    v_pk_fma_f32 v[34:35], v[164:165], v[146:147], v[34:35] op_sel_hi:[0,1,1] neg_lo:[1,0,0] neg_hi:[1,0,0]
    v_pk_fma_f32 v[36:37], v[164:165], v[148:149], v[36:37] op_sel_hi:[0,1,1] neg_lo:[1,0,0] neg_hi:[1,0,0]
    v_pk_fma_f32 v[38:39], v[164:165], v[150:151], v[38:39] op_sel_hi:[0,1,1] neg_lo:[1,0,0] neg_hi:[1,0,0]
    v_pk_mul_f32 v[192:193], v[32:33], v[32:33]
    v_pk_mul_f32 v[194:195], v[34:35], v[34:35]
    v_pk_mul_f32 v[196:197], v[36:37], v[36:37]
    v_pk_mul_f32 v[198:199], v[38:39], v[38:39]
    v_pk_fma_f32 v[192:193], v[192:193], v[184:185], v[184:185] op_sel:[0,1,0] op_sel_hi:[1,1,0]
    v_pk_fma_f32 v[194:195], v[194:195], v[184:185], v[184:185] op_sel:[0,1,0] op_sel_hi:[1,1,0]
    v_pk_fma_f32 v[196:197], v[196:197], v[184:185], v[184:185] op_sel:[0,1,0] op_sel_hi:[1,1,0]
    v_pk_fma_f32 v[198:199], v[198:199], v[184:185], v[184:185] op_sel:[0,1,0] op_sel_hi:[1,1,0]
    v_pk_mul_f32 v[192:193], v[192:193], v[32:33]
    v_pk_mul_f32 v[194:195], v[194:195], v[34:35]
    v_pk_mul_f32 v[196:197], v[196:197], v[36:37]
    v_pk_mul_f32 v[198:199], v[198:199], v[38:39]
    v_exp_f32 v192, v192
    v_exp_f32 v193, v193
    v_exp_f32 v194, v194
    v_exp_f32 v195, v195
    v_exp_f32 v196, v196
    v_exp_f32 v197, v197
    v_exp_f32 v198, v198
    v_exp_f32 v199, v199
    v_pk_fma_f32 v[192:193], v[192:193], v[164:165], v[164:165] op_sel:[0,1,1] op_sel_hi:[1,1,1]
    v_pk_fma_f32 v[194:195], v[194:195], v[164:165], v[164:165] op_sel:[0,1,1] op_sel_hi:[1,1,1]
    v_pk_fma_f32 v[196:197], v[196:197], v[164:165], v[164:165] op_sel:[0,1,1] op_sel_hi:[1,1,1]
    v_pk_fma_f32 v[198:199], v[198:199], v[164:165], v[164:165] op_sel:[0,1,1] op_sel_hi:[1,1,1]
    v_rcp_f32 v192, v192
    v_rcp_f32 v193, v193
    v_rcp_f32 v194, v194
    v_rcp_f32 v195, v195
    v_rcp_f32 v196, v196
    v_rcp_f32 v197, v197
    v_rcp_f32 v198, v198
    v_rcp_f32 v199, v199
    v_pk_mul_f32 v[32:33], v[32:33], v[192:193]
    v_pk_mul_f32 v[34:35], v[34:35], v[194:195]
    v_pk_mul_f32 v[36:37], v[36:37], v[196:197]
    v_pk_mul_f32 v[38:39], v[38:39], v[198:199]
    v_cvt_pk_bf16_f32 v32, v32, v33
    v_cvt_pk_bf16_f32 v33, v34, v35
    v_cvt_pk_bf16_f32 v34, v36, v37
    v_cvt_pk_bf16_f32 v35, v38, v39
    ds_write_b128 v12, v[32:35] offset:16384
    v_pk_fma_f32 v[60:61], v[166:167], v[144:145], v[60:61] op_sel_hi:[0,1,1] neg_lo:[1,0,0] neg_hi:[1,0,0]
    v_pk_fma_f32 v[62:63], v[166:167], v[146:147], v[62:63] op_sel_hi:[0,1,1] neg_lo:[1,0,0] neg_hi:[1,0,0]
    v_pk_fma_f32 v[64:65], v[166:167], v[148:149], v[64:65] op_sel_hi:[0,1,1] neg_lo:[1,0,0] neg_hi:[1,0,0]
    v_pk_fma_f32 v[66:67], v[166:167], v[150:151], v[66:67] op_sel_hi:[0,1,1] neg_lo:[1,0,0] neg_hi:[1,0,0]
    v_pk_mul_f32 v[192:193], v[60:61], v[60:61]
    v_pk_mul_f32 v[194:195], v[62:63], v[62:63]
    v_pk_mul_f32 v[196:197], v[64:65], v[64:65]
    v_pk_mul_f32 v[198:199], v[66:67], v[66:67]
    v_pk_fma_f32 v[192:193], v[192:193], v[186:187], v[186:187] op_sel:[0,1,0] op_sel_hi:[1,1,0]
    v_pk_fma_f32 v[194:195], v[194:195], v[186:187], v[186:187] op_sel:[0,1,0] op_sel_hi:[1,1,0]
    v_pk_fma_f32 v[196:197], v[196:197], v[186:187], v[186:187] op_sel:[0,1,0] op_sel_hi:[1,1,0]
    v_pk_fma_f32 v[198:199], v[198:199], v[186:187], v[186:187] op_sel:[0,1,0] op_sel_hi:[1,1,0]
    v_pk_mul_f32 v[192:193], v[192:193], v[60:61]
    v_pk_mul_f32 v[194:195], v[194:195], v[62:63]
    v_pk_mul_f32 v[196:197], v[196:197], v[64:65]
    v_pk_mul_f32 v[198:199], v[198:199], v[66:67]
    v_exp_f32 v192, v192
    v_exp_f32 v193, v193
    v_exp_f32 v194, v194
    v_exp_f32 v195, v195
    v_exp_f32 v196, v196
    v_exp_f32 v197, v197
    v_exp_f32 v198, v198
    v_exp_f32 v199, v199
    v_pk_fma_f32 v[192:193], v[192:193], v[166:167], v[166:167] op_sel:[0,1,1] op_sel_hi:[1,1,1]
    v_pk_fma_f32 v[194:195], v[194:195], v[166:167], v[166:167] op_sel:[0,1,1] op_sel_hi:[1,1,1]
    v_pk_fma_f32 v[196:197], v[196:197], v[166:167], v[166:167] op_sel:[0,1,1] op_sel_hi:[1,1,1]
    v_pk_fma_f32 v[198:199], v[198:199], v[166:167], v[166:167] op_sel:[0,1,1] op_sel_hi:[1,1,1]
    v_rcp_f32 v192, v192
    v_rcp_f32 v193, v193
    v_rcp_f32 v194, v194
    v_rcp_f32 v195, v195
    v_rcp_f32 v196, v196
    v_rcp_f32 v197, v197
    v_rcp_f32 v198, v198
    v_rcp_f32 v199, v199
    v_pk_mul_f32 v[60:61], v[60:61], v[192:193]
    v_pk_mul_f32 v[62:63], v[62:63], v[194:195]
    v_pk_mul_f32 v[64:65], v[64:65], v[196:197]
    v_pk_mul_f32 v[66:67], v[66:67], v[198:199]
    v_cvt_pk_bf16_f32 v60, v60, v61
    v_cvt_pk_bf16_f32 v61, v62, v63
    v_cvt_pk_bf16_f32 v62, v64, v65
    v_cvt_pk_bf16_f32 v63, v66, v67
    ds_write_b128 v12, v[60:63] offset:18432
    v_pk_fma_f32 v[88:89], v[168:169], v[144:145], v[88:89] op_sel_hi:[0,1,1] neg_lo:[1,0,0] neg_hi:[1,0,0]
    v_pk_fma_f32 v[90:91], v[168:169], v[146:147], v[90:91] op_sel_hi:[0,1,1] neg_lo:[1,0,0] neg_hi:[1,0,0]
    v_pk_fma_f32 v[92:93], v[168:169], v[148:149], v[92:93] op_sel_hi:[0,1,1] neg_lo:[1,0,0] neg_hi:[1,0,0]
    v_pk_fma_f32 v[94:95], v[168:169], v[150:151], v[94:95] op_sel_hi:[0,1,1] neg_lo:[1,0,0] neg_hi:[1,0,0]
    v_pk_mul_f32 v[192:193], v[88:89], v[88:89]
    v_pk_mul_f32 v[194:195], v[90:91], v[90:91]
    v_pk_mul_f32 v[196:197], v[92:93], v[92:93]
    v_pk_mul_f32 v[198:199], v[94:95], v[94:95]
    v_pk_fma_f32 v[192:193], v[192:193], v[188:189], v[188:189] op_sel:[0,1,0] op_sel_hi:[1,1,0]
    v_pk_fma_f32 v[194:195], v[194:195], v[188:189], v[188:189] op_sel:[0,1,0] op_sel_hi:[1,1,0]
    v_pk_fma_f32 v[196:197], v[196:197], v[188:189], v[188:189] op_sel:[0,1,0] op_sel_hi:[1,1,0]
    v_pk_fma_f32 v[198:199], v[198:199], v[188:189], v[188:189] op_sel:[0,1,0] op_sel_hi:[1,1,0]
    v_pk_mul_f32 v[192:193], v[192:193], v[88:89]
    v_pk_mul_f32 v[194:195], v[194:195], v[90:91]
    v_pk_mul_f32 v[196:197], v[196:197], v[92:93]
    v_pk_mul_f32 v[198:199], v[198:199], v[94:95]
    v_exp_f32 v192, v192
    v_exp_f32 v193, v193
    v_exp_f32 v194, v194
    v_exp_f32 v195, v195
    v_exp_f32 v196, v196
    v_exp_f32 v197, v197
    v_exp_f32 v198, v198
    v_exp_f32 v199, v199
    v_pk_fma_f32 v[192:193], v[192:193], v[168:169], v[168:169] op_sel:[0,1,1] op_sel_hi:[1,1,1]
    v_pk_fma_f32 v[194:195], v[194:195], v[168:169], v[168:169] op_sel:[0,1,1] op_sel_hi:[1,1,1]
    v_pk_fma_f32 v[196:197], v[196:197], v[168:169], v[168:169] op_sel:[0,1,1] op_sel_hi:[1,1,1]
    v_pk_fma_f32 v[198:199], v[198:199], v[168:169], v[168:169] op_sel:[0,1,1] op_sel_hi:[1,1,1]
    v_rcp_f32 v192, v192
    v_rcp_f32 v193, v193
    v_rcp_f32 v194, v194
    v_rcp_f32 v195, v195
    v_rcp_f32 v196, v196
    v_rcp_f32 v197, v197
    v_rcp_f32 v198, v198
    v_rcp_f32 v199, v199
    v_pk_mul_f32 v[88:89], v[88:89], v[192:193]
    v_pk_mul_f32 v[90:91], v[90:91], v[194:195]
    v_pk_mul_f32 v[92:93], v[92:93], v[196:197]
    v_pk_mul_f32 v[94:95], v[94:95], v[198:199]
    v_cvt_pk_bf16_f32 v88, v88, v89
    v_cvt_pk_bf16_f32 v89, v90, v91
    v_cvt_pk_bf16_f32 v90, v92, v93
    v_cvt_pk_bf16_f32 v91, v94, v95
    ds_write_b128 v12, v[88:91] offset:20480
    s_lshr_b32 s53, s30, 1
    s_lshl1_add_u32 s53, s31, s53
    s_lshl_b32 s53, s53, 7
    s_add_u32 s53, s53, s55
    s_add_u32 s53, s53, 0x1000
    v_mov_b32 v8, 1
    v_mov_b32 v9, 0
    s_mov_b64 exec, 1
    s_waitcnt vmcnt(0)
    buffer_atomic_add v8, v9, s[56:59], s53 offen sc1
    s_mov_b64 exec, -1
    v_pk_fma_f32 v[116:117], v[170:171], v[144:145], v[116:117] op_sel_hi:[0,1,1] neg_lo:[1,0,0] neg_hi:[1,0,0]
    v_pk_fma_f32 v[118:119], v[170:171], v[146:147], v[118:119] op_sel_hi:[0,1,1] neg_lo:[1,0,0] neg_hi:[1,0,0]
    v_pk_fma_f32 v[120:121], v[170:171], v[148:149], v[120:121] op_sel_hi:[0,1,1] neg_lo:[1,0,0] neg_hi:[1,0,0]
    v_pk_fma_f32 v[122:123], v[170:171], v[150:151], v[122:123] op_sel_hi:[0,1,1] neg_lo:[1,0,0] neg_hi:[1,0,0]
    v_pk_mul_f32 v[192:193], v[116:117], v[116:117]
    v_pk_mul_f32 v[194:195], v[118:119], v[118:119]
    v_pk_mul_f32 v[196:197], v[120:121], v[120:121]
    v_pk_mul_f32 v[198:199], v[122:123], v[122:123]
    v_pk_fma_f32 v[192:193], v[192:193], v[190:191], v[190:191] op_sel:[0,1,0] op_sel_hi:[1,1,0]
    v_pk_fma_f32 v[194:195], v[194:195], v[190:191], v[190:191] op_sel:[0,1,0] op_sel_hi:[1,1,0]
    v_pk_fma_f32 v[196:197], v[196:197], v[190:191], v[190:191] op_sel:[0,1,0] op_sel_hi:[1,1,0]
    v_pk_fma_f32 v[198:199], v[198:199], v[190:191], v[190:191] op_sel:[0,1,0] op_sel_hi:[1,1,0]
    v_pk_mul_f32 v[192:193], v[192:193], v[116:117]
    v_pk_mul_f32 v[194:195], v[194:195], v[118:119]
    v_pk_mul_f32 v[196:197], v[196:197], v[120:121]
    v_pk_mul_f32 v[198:199], v[198:199], v[122:123]
    v_exp_f32 v192, v192
    v_exp_f32 v193, v193
    v_exp_f32 v194, v194
    v_exp_f32 v195, v195
    v_exp_f32 v196, v196
    v_exp_f32 v197, v197
    v_exp_f32 v198, v198
    v_exp_f32 v199, v199
    v_pk_fma_f32 v[192:193], v[192:193], v[170:171], v[170:171] op_sel:[0,1,1] op_sel_hi:[1,1,1]
    v_pk_fma_f32 v[194:195], v[194:195], v[170:171], v[170:171] op_sel:[0,1,1] op_sel_hi:[1,1,1]
    v_pk_fma_f32 v[196:197], v[196:197], v[170:171], v[170:171] op_sel:[0,1,1] op_sel_hi:[1,1,1]
    v_pk_fma_f32 v[198:199], v[198:199], v[170:171], v[170:171] op_sel:[0,1,1] op_sel_hi:[1,1,1]
    v_rcp_f32 v192, v192
    v_rcp_f32 v193, v193
    v_rcp_f32 v194, v194
    v_rcp_f32 v195, v195
    v_rcp_f32 v196, v196
    v_rcp_f32 v197, v197
    v_rcp_f32 v198, v198
    v_rcp_f32 v199, v199
    v_pk_mul_f32 v[116:117], v[116:117], v[192:193]
    v_pk_mul_f32 v[118:119], v[118:119], v[194:195]
    v_pk_mul_f32 v[120:121], v[120:121], v[196:197]
    v_pk_mul_f32 v[122:123], v[122:123], v[198:199]
    v_cvt_pk_bf16_f32 v116, v116, v117
    v_cvt_pk_bf16_f32 v117, v118, v119
    v_cvt_pk_bf16_f32 v118, v120, v121
    v_cvt_pk_bf16_f32 v119, v122, v123
    ds_write_b128 v12, v[116:119] offset:22528
    v_pk_fma_f32 v[40:41], v[164:165], v[152:153], v[40:41] op_sel_hi:[0,1,1] neg_lo:[1,0,0] neg_hi:[1,0,0]
    v_pk_fma_f32 v[42:43], v[164:165], v[154:155], v[42:43] op_sel_hi:[0,1,1] neg_lo:[1,0,0] neg_hi:[1,0,0]
    v_pk_fma_f32 v[44:45], v[164:165], v[156:157], v[44:45] op_sel_hi:[0,1,1] neg_lo:[1,0,0] neg_hi:[1,0,0]
    v_pk_fma_f32 v[46:47], v[164:165], v[158:159], v[46:47] op_sel_hi:[0,1,1] neg_lo:[1,0,0] neg_hi:[1,0,0]
    v_pk_mul_f32 v[192:193], v[40:41], v[40:41]
    v_pk_mul_f32 v[194:195], v[42:43], v[42:43]
    v_pk_mul_f32 v[196:197], v[44:45], v[44:45]
    v_pk_mul_f32 v[198:199], v[46:47], v[46:47]
    v_pk_fma_f32 v[192:193], v[192:193], v[184:185], v[184:185] op_sel:[0,1,0] op_sel_hi:[1,1,0]
    v_pk_fma_f32 v[194:195], v[194:195], v[184:185], v[184:185] op_sel:[0,1,0] op_sel_hi:[1,1,0]
    v_pk_fma_f32 v[196:197], v[196:197], v[184:185], v[184:185] op_sel:[0,1,0] op_sel_hi:[1,1,0]
    v_pk_fma_f32 v[198:199], v[198:199], v[184:185], v[184:185] op_sel:[0,1,0] op_sel_hi:[1,1,0]
    v_pk_mul_f32 v[192:193], v[192:193], v[40:41]
    v_pk_mul_f32 v[194:195], v[194:195], v[42:43]
    v_pk_mul_f32 v[196:197], v[196:197], v[44:45]
    v_pk_mul_f32 v[198:199], v[198:199], v[46:47]
    v_exp_f32 v192, v192
    v_exp_f32 v193, v193
    v_exp_f32 v194, v194
    v_exp_f32 v195, v195
    v_exp_f32 v196, v196
    v_exp_f32 v197, v197
    v_exp_f32 v198, v198
    v_exp_f32 v199, v199
    v_pk_fma_f32 v[192:193], v[192:193], v[164:165], v[164:165] op_sel:[0,1,1] op_sel_hi:[1,1,1]
    v_pk_fma_f32 v[194:195], v[194:195], v[164:165], v[164:165] op_sel:[0,1,1] op_sel_hi:[1,1,1]
    v_pk_fma_f32 v[196:197], v[196:197], v[164:165], v[164:165] op_sel:[0,1,1] op_sel_hi:[1,1,1]
    v_pk_fma_f32 v[198:199], v[198:199], v[164:165], v[164:165] op_sel:[0,1,1] op_sel_hi:[1,1,1]
    v_rcp_f32 v192, v192
    v_rcp_f32 v193, v193
    v_rcp_f32 v194, v194
    v_rcp_f32 v195, v195
    v_rcp_f32 v196, v196
    v_rcp_f32 v197, v197
    v_rcp_f32 v198, v198
    v_rcp_f32 v199, v199
    v_pk_mul_f32 v[40:41], v[40:41], v[192:193]
    v_pk_mul_f32 v[42:43], v[42:43], v[194:195]
    v_pk_mul_f32 v[44:45], v[44:45], v[196:197]
    v_pk_mul_f32 v[46:47], v[46:47], v[198:199]
    v_cvt_pk_bf16_f32 v230, v40, v41
    v_cvt_pk_bf16_f32 v231, v42, v43
    v_cvt_pk_bf16_f32 v232, v44, v45
    v_cvt_pk_bf16_f32 v233, v46, v47
    ds_write_b128 v12, v[230:233] offset:32768
    v_pk_fma_f32 v[68:69], v[166:167], v[152:153], v[68:69] op_sel_hi:[0,1,1] neg_lo:[1,0,0] neg_hi:[1,0,0]
    v_pk_fma_f32 v[70:71], v[166:167], v[154:155], v[70:71] op_sel_hi:[0,1,1] neg_lo:[1,0,0] neg_hi:[1,0,0]
    v_pk_fma_f32 v[72:73], v[166:167], v[156:157], v[72:73] op_sel_hi:[0,1,1] neg_lo:[1,0,0] neg_hi:[1,0,0]
    v_pk_fma_f32 v[74:75], v[166:167], v[158:159], v[74:75] op_sel_hi:[0,1,1] neg_lo:[1,0,0] neg_hi:[1,0,0]
    v_pk_mul_f32 v[192:193], v[68:69], v[68:69]
    v_pk_mul_f32 v[194:195], v[70:71], v[70:71]
    v_pk_mul_f32 v[196:197], v[72:73], v[72:73]
    v_pk_mul_f32 v[198:199], v[74:75], v[74:75]
    v_pk_fma_f32 v[192:193], v[192:193], v[186:187], v[186:187] op_sel:[0,1,0] op_sel_hi:[1,1,0]
    v_pk_fma_f32 v[194:195], v[194:195], v[186:187], v[186:187] op_sel:[0,1,0] op_sel_hi:[1,1,0]
    v_pk_fma_f32 v[196:197], v[196:197], v[186:187], v[186:187] op_sel:[0,1,0] op_sel_hi:[1,1,0]
    v_pk_fma_f32 v[198:199], v[198:199], v[186:187], v[186:187] op_sel:[0,1,0] op_sel_hi:[1,1,0]
    v_pk_mul_f32 v[192:193], v[192:193], v[68:69]
    v_pk_mul_f32 v[194:195], v[194:195], v[70:71]
    v_pk_mul_f32 v[196:197], v[196:197], v[72:73]
    v_pk_mul_f32 v[198:199], v[198:199], v[74:75]
    v_exp_f32 v192, v192
    v_exp_f32 v193, v193
    v_exp_f32 v194, v194
    v_exp_f32 v195, v195
    v_exp_f32 v196, v196
    v_exp_f32 v197, v197
    v_exp_f32 v198, v198
    v_exp_f32 v199, v199
    v_pk_fma_f32 v[192:193], v[192:193], v[166:167], v[166:167] op_sel:[0,1,1] op_sel_hi:[1,1,1]
    v_pk_fma_f32 v[194:195], v[194:195], v[166:167], v[166:167] op_sel:[0,1,1] op_sel_hi:[1,1,1]
    v_pk_fma_f32 v[196:197], v[196:197], v[166:167], v[166:167] op_sel:[0,1,1] op_sel_hi:[1,1,1]
    v_pk_fma_f32 v[198:199], v[198:199], v[166:167], v[166:167] op_sel:[0,1,1] op_sel_hi:[1,1,1]
    v_rcp_f32 v192, v192
    v_rcp_f32 v193, v193
    v_rcp_f32 v194, v194
    v_rcp_f32 v195, v195
    v_rcp_f32 v196, v196
    v_rcp_f32 v197, v197
    v_rcp_f32 v198, v198
    v_rcp_f32 v199, v199
    v_pk_mul_f32 v[68:69], v[68:69], v[192:193]
    v_pk_mul_f32 v[70:71], v[70:71], v[194:195]
    v_pk_mul_f32 v[72:73], v[72:73], v[196:197]
    v_pk_mul_f32 v[74:75], v[74:75], v[198:199]
    v_cvt_pk_bf16_f32 v234, v68, v69
    v_cvt_pk_bf16_f32 v235, v70, v71
    v_cvt_pk_bf16_f32 v236, v72, v73
    v_cvt_pk_bf16_f32 v237, v74, v75
    ds_write_b128 v12, v[234:237] offset:34816
    v_pk_fma_f32 v[96:97], v[168:169], v[152:153], v[96:97] op_sel_hi:[0,1,1] neg_lo:[1,0,0] neg_hi:[1,0,0]
    v_pk_fma_f32 v[98:99], v[168:169], v[154:155], v[98:99] op_sel_hi:[0,1,1] neg_lo:[1,0,0] neg_hi:[1,0,0]
    v_pk_fma_f32 v[100:101], v[168:169], v[156:157], v[100:101] op_sel_hi:[0,1,1] neg_lo:[1,0,0] neg_hi:[1,0,0]
    v_pk_fma_f32 v[102:103], v[168:169], v[158:159], v[102:103] op_sel_hi:[0,1,1] neg_lo:[1,0,0] neg_hi:[1,0,0]
    v_pk_mul_f32 v[192:193], v[96:97], v[96:97]
    v_pk_mul_f32 v[194:195], v[98:99], v[98:99]
    v_pk_mul_f32 v[196:197], v[100:101], v[100:101]
    v_pk_mul_f32 v[198:199], v[102:103], v[102:103]
    v_pk_fma_f32 v[192:193], v[192:193], v[188:189], v[188:189] op_sel:[0,1,0] op_sel_hi:[1,1,0]
    v_pk_fma_f32 v[194:195], v[194:195], v[188:189], v[188:189] op_sel:[0,1,0] op_sel_hi:[1,1,0]
    v_pk_fma_f32 v[196:197], v[196:197], v[188:189], v[188:189] op_sel:[0,1,0] op_sel_hi:[1,1,0]
    v_pk_fma_f32 v[198:199], v[198:199], v[188:189], v[188:189] op_sel:[0,1,0] op_sel_hi:[1,1,0]
    v_pk_mul_f32 v[192:193], v[192:193], v[96:97]
    v_pk_mul_f32 v[194:195], v[194:195], v[98:99]
    v_pk_mul_f32 v[196:197], v[196:197], v[100:101]
    v_pk_mul_f32 v[198:199], v[198:199], v[102:103]
    v_exp_f32 v192, v192
    v_exp_f32 v193, v193
    v_exp_f32 v194, v194
    v_exp_f32 v195, v195
    v_exp_f32 v196, v196
    v_exp_f32 v197, v197
    v_exp_f32 v198, v198
    v_exp_f32 v199, v199
    v_pk_fma_f32 v[192:193], v[192:193], v[168:169], v[168:169] op_sel:[0,1,1] op_sel_hi:[1,1,1]
    v_pk_fma_f32 v[194:195], v[194:195], v[168:169], v[168:169] op_sel:[0,1,1] op_sel_hi:[1,1,1]
    v_pk_fma_f32 v[196:197], v[196:197], v[168:169], v[168:169] op_sel:[0,1,1] op_sel_hi:[1,1,1]
    v_pk_fma_f32 v[198:199], v[198:199], v[168:169], v[168:169] op_sel:[0,1,1] op_sel_hi:[1,1,1]
    v_rcp_f32 v192, v192
    v_rcp_f32 v193, v193
    v_rcp_f32 v194, v194
    v_rcp_f32 v195, v195
    v_rcp_f32 v196, v196
    v_rcp_f32 v197, v197
    v_rcp_f32 v198, v198
    v_rcp_f32 v199, v199
    v_pk_mul_f32 v[96:97], v[96:97], v[192:193]
    v_pk_mul_f32 v[98:99], v[98:99], v[194:195]
    v_pk_mul_f32 v[100:101], v[100:101], v[196:197]
    v_pk_mul_f32 v[102:103], v[102:103], v[198:199]
    v_cvt_pk_bf16_f32 v238, v96, v97
    v_cvt_pk_bf16_f32 v239, v98, v99
    v_cvt_pk_bf16_f32 v240, v100, v101
    v_cvt_pk_bf16_f32 v241, v102, v103
    ds_write_b128 v12, v[238:241] offset:36864
    v_pk_fma_f32 v[124:125], v[170:171], v[152:153], v[124:125] op_sel_hi:[0,1,1] neg_lo:[1,0,0] neg_hi:[1,0,0]
    v_pk_fma_f32 v[126:127], v[170:171], v[154:155], v[126:127] op_sel_hi:[0,1,1] neg_lo:[1,0,0] neg_hi:[1,0,0]
    v_pk_fma_f32 v[128:129], v[170:171], v[156:157], v[128:129] op_sel_hi:[0,1,1] neg_lo:[1,0,0] neg_hi:[1,0,0]
    v_pk_fma_f32 v[130:131], v[170:171], v[158:159], v[130:131] op_sel_hi:[0,1,1] neg_lo:[1,0,0] neg_hi:[1,0,0]
    v_pk_mul_f32 v[192:193], v[124:125], v[124:125]
    v_pk_mul_f32 v[194:195], v[126:127], v[126:127]
    v_pk_mul_f32 v[196:197], v[128:129], v[128:129]
    v_pk_mul_f32 v[198:199], v[130:131], v[130:131]
    v_pk_fma_f32 v[192:193], v[192:193], v[190:191], v[190:191] op_sel:[0,1,0] op_sel_hi:[1,1,0]
    v_pk_fma_f32 v[194:195], v[194:195], v[190:191], v[190:191] op_sel:[0,1,0] op_sel_hi:[1,1,0]
    v_pk_fma_f32 v[196:197], v[196:197], v[190:191], v[190:191] op_sel:[0,1,0] op_sel_hi:[1,1,0]
    v_pk_fma_f32 v[198:199], v[198:199], v[190:191], v[190:191] op_sel:[0,1,0] op_sel_hi:[1,1,0]
    v_pk_mul_f32 v[192:193], v[192:193], v[124:125]
    v_pk_mul_f32 v[194:195], v[194:195], v[126:127]
    v_pk_mul_f32 v[196:197], v[196:197], v[128:129]
    v_pk_mul_f32 v[198:199], v[198:199], v[130:131]
    v_exp_f32 v192, v192
    v_exp_f32 v193, v193
    v_exp_f32 v194, v194
    v_exp_f32 v195, v195
    v_exp_f32 v196, v196
    v_exp_f32 v197, v197
    v_exp_f32 v198, v198
    v_exp_f32 v199, v199
    v_pk_fma_f32 v[192:193], v[192:193], v[170:171], v[170:171] op_sel:[0,1,1] op_sel_hi:[1,1,1]
    v_pk_fma_f32 v[194:195], v[194:195], v[170:171], v[170:171] op_sel:[0,1,1] op_sel_hi:[1,1,1]
    v_pk_fma_f32 v[196:197], v[196:197], v[170:171], v[170:171] op_sel:[0,1,1] op_sel_hi:[1,1,1]
    v_pk_fma_f32 v[198:199], v[198:199], v[170:171], v[170:171] op_sel:[0,1,1] op_sel_hi:[1,1,1]
    v_rcp_f32 v192, v192
    v_rcp_f32 v193, v193
    v_rcp_f32 v194, v194
    v_rcp_f32 v195, v195
    v_rcp_f32 v196, v196
    v_rcp_f32 v197, v197
    v_rcp_f32 v198, v198
    v_rcp_f32 v199, v199
    v_pk_mul_f32 v[124:125], v[124:125], v[192:193]
    v_pk_mul_f32 v[126:127], v[126:127], v[194:195]
    v_pk_mul_f32 v[128:129], v[128:129], v[196:197]
    v_pk_mul_f32 v[130:131], v[130:131], v[198:199]
    v_cvt_pk_bf16_f32 v242, v124, v125
    v_cvt_pk_bf16_f32 v243, v126, v127
    v_cvt_pk_bf16_f32 v244, v128, v129
    v_cvt_pk_bf16_f32 v245, v130, v131
    ds_write_b128 v12, v[242:245] offset:38912
    v_pk_fma_f32 v[48:49], v[164:165], v[160:161], v[48:49] op_sel_hi:[0,1,1] neg_lo:[1,0,0] neg_hi:[1,0,0]
    v_pk_fma_f32 v[50:51], v[164:165], v[162:163], v[50:51] op_sel_hi:[0,1,1] neg_lo:[1,0,0] neg_hi:[1,0,0]
    v_pk_fma_f32 v[76:77], v[166:167], v[160:161], v[76:77] op_sel_hi:[0,1,1] neg_lo:[1,0,0] neg_hi:[1,0,0]
    v_pk_fma_f32 v[78:79], v[166:167], v[162:163], v[78:79] op_sel_hi:[0,1,1] neg_lo:[1,0,0] neg_hi:[1,0,0]
    v_pk_mul_f32 v[192:193], v[48:49], v[48:49]
    v_pk_mul_f32 v[194:195], v[50:51], v[50:51]
    v_pk_mul_f32 v[196:197], v[76:77], v[76:77]
    v_pk_mul_f32 v[198:199], v[78:79], v[78:79]
    v_pk_fma_f32 v[192:193], v[192:193], v[184:185], v[184:185] op_sel:[0,1,0] op_sel_hi:[1,1,0]
    v_pk_fma_f32 v[194:195], v[194:195], v[184:185], v[184:185] op_sel:[0,1,0] op_sel_hi:[1,1,0]
    v_pk_fma_f32 v[196:197], v[196:197], v[186:187], v[186:187] op_sel:[0,1,0] op_sel_hi:[1,1,0]
    v_pk_fma_f32 v[198:199], v[198:199], v[186:187], v[186:187] op_sel:[0,1,0] op_sel_hi:[1,1,0]
    v_pk_mul_f32 v[192:193], v[192:193], v[48:49]
    v_pk_mul_f32 v[194:195], v[194:195], v[50:51]
    v_pk_mul_f32 v[196:197], v[196:197], v[76:77]
    v_pk_mul_f32 v[198:199], v[198:199], v[78:79]
    v_exp_f32 v192, v192
    v_exp_f32 v193, v193
    v_exp_f32 v194, v194
    v_exp_f32 v195, v195
    v_exp_f32 v196, v196
    v_exp_f32 v197, v197
    v_exp_f32 v198, v198
    v_exp_f32 v199, v199
    v_pk_fma_f32 v[192:193], v[192:193], v[164:165], v[164:165] op_sel:[0,1,1] op_sel_hi:[1,1,1]
    v_pk_fma_f32 v[194:195], v[194:195], v[164:165], v[164:165] op_sel:[0,1,1] op_sel_hi:[1,1,1]
    v_pk_fma_f32 v[196:197], v[196:197], v[166:167], v[166:167] op_sel:[0,1,1] op_sel_hi:[1,1,1]
    v_pk_fma_f32 v[198:199], v[198:199], v[166:167], v[166:167] op_sel:[0,1,1] op_sel_hi:[1,1,1]
    v_rcp_f32 v192, v192
    v_rcp_f32 v193, v193
    v_rcp_f32 v194, v194
    v_rcp_f32 v195, v195
    v_rcp_f32 v196, v196
    v_rcp_f32 v197, v197
    v_rcp_f32 v198, v198
    v_rcp_f32 v199, v199
    v_pk_mul_f32 v[48:49], v[48:49], v[192:193]
    v_pk_mul_f32 v[50:51], v[50:51], v[194:195]
    v_pk_mul_f32 v[76:77], v[76:77], v[196:197]
    v_pk_mul_f32 v[78:79], v[78:79], v[198:199]
    v_cvt_pk_bf16_f32 v246, v48, v49
    v_cvt_pk_bf16_f32 v247, v50, v51
    s_add_u32 s36, s45, 0
    buffer_store_dwordx4 v[32:35], v2, s[16:19], s36 offen sc1
    v_cvt_pk_bf16_f32 v248, v76, v77
    v_cvt_pk_bf16_f32 v249, v78, v79
    s_add_u32 s36, s45, 229376
    buffer_store_dwordx4 v[60:63], v2, s[16:19], s36 offen sc1
    v_pk_fma_f32 v[104:105], v[168:169], v[160:161], v[104:105] op_sel_hi:[0,1,1] neg_lo:[1,0,0] neg_hi:[1,0,0]
    v_pk_fma_f32 v[106:107], v[168:169], v[162:163], v[106:107] op_sel_hi:[0,1,1] neg_lo:[1,0,0] neg_hi:[1,0,0]
    v_pk_fma_f32 v[132:133], v[170:171], v[160:161], v[132:133] op_sel_hi:[0,1,1] neg_lo:[1,0,0] neg_hi:[1,0,0]
    v_pk_fma_f32 v[134:135], v[170:171], v[162:163], v[134:135] op_sel_hi:[0,1,1] neg_lo:[1,0,0] neg_hi:[1,0,0]
    v_pk_mul_f32 v[192:193], v[104:105], v[104:105]
    v_pk_mul_f32 v[194:195], v[106:107], v[106:107]
    v_pk_mul_f32 v[196:197], v[132:133], v[132:133]
    v_pk_mul_f32 v[198:199], v[134:135], v[134:135]
    v_pk_fma_f32 v[192:193], v[192:193], v[188:189], v[188:189] op_sel:[0,1,0] op_sel_hi:[1,1,0]
    v_pk_fma_f32 v[194:195], v[194:195], v[188:189], v[188:189] op_sel:[0,1,0] op_sel_hi:[1,1,0]
    v_pk_fma_f32 v[196:197], v[196:197], v[190:191], v[190:191] op_sel:[0,1,0] op_sel_hi:[1,1,0]
    v_pk_fma_f32 v[198:199], v[198:199], v[190:191], v[190:191] op_sel:[0,1,0] op_sel_hi:[1,1,0]
    v_pk_mul_f32 v[192:193], v[192:193], v[104:105]
    v_pk_mul_f32 v[194:195], v[194:195], v[106:107]
    v_pk_mul_f32 v[196:197], v[196:197], v[132:133]
    v_pk_mul_f32 v[198:199], v[198:199], v[134:135]
    v_exp_f32 v192, v192
    v_exp_f32 v193, v193
    v_exp_f32 v194, v194
    v_exp_f32 v195, v195
    v_exp_f32 v196, v196
    v_exp_f32 v197, v197
    v_exp_f32 v198, v198
    v_exp_f32 v199, v199
    v_pk_fma_f32 v[192:193], v[192:193], v[168:169], v[168:169] op_sel:[0,1,1] op_sel_hi:[1,1,1]
    v_pk_fma_f32 v[194:195], v[194:195], v[168:169], v[168:169] op_sel:[0,1,1] op_sel_hi:[1,1,1]
    v_pk_fma_f32 v[196:197], v[196:197], v[170:171], v[170:171] op_sel:[0,1,1] op_sel_hi:[1,1,1]
    v_pk_fma_f32 v[198:199], v[198:199], v[170:171], v[170:171] op_sel:[0,1,1] op_sel_hi:[1,1,1]
    v_rcp_f32 v192, v192
    v_rcp_f32 v193, v193
    v_rcp_f32 v194, v194
    v_rcp_f32 v195, v195
    v_rcp_f32 v196, v196
    v_rcp_f32 v197, v197
    v_rcp_f32 v198, v198
    v_rcp_f32 v199, v199
    v_pk_mul_f32 v[104:105], v[104:105], v[192:193]
    v_pk_mul_f32 v[106:107], v[106:107], v[194:195]
    v_pk_mul_f32 v[132:133], v[132:133], v[196:197]
    v_pk_mul_f32 v[134:135], v[134:135], v[198:199]
    v_cvt_pk_bf16_f32 v250, v104, v105
    v_cvt_pk_bf16_f32 v251, v106, v107
    s_add_u32 s36, s45, 458752
    buffer_store_dwordx4 v[88:91], v2, s[16:19], s36 offen sc1
    v_cvt_pk_bf16_f32 v252, v132, v133
    v_cvt_pk_bf16_f32 v253, v134, v135
    s_add_u32 s36, s45, 688128
    buffer_store_dwordx4 v[116:119], v2, s[16:19], s36 offen sc1
    s_waitcnt lgkmcnt(0)
    s_mov_b32 s44, s46
    s_mov_b32 s45, s47
    s_branch G3_e2
G3_e1:
    v_pk_fma_f32 v[28:29], v[164:165], v[140:141], v[28:29] op_sel_hi:[0,1,1] neg_lo:[1,0,0] neg_hi:[1,0,0]
    v_pk_fma_f32 v[30:31], v[164:165], v[142:143], v[30:31] op_sel_hi:[0,1,1] neg_lo:[1,0,0] neg_hi:[1,0,0]
    v_pk_fma_f32 v[32:33], v[164:165], v[144:145], v[32:33] op_sel_hi:[0,1,1] neg_lo:[1,0,0] neg_hi:[1,0,0]
    v_pk_fma_f32 v[34:35], v[164:165], v[146:147], v[34:35] op_sel_hi:[0,1,1] neg_lo:[1,0,0] neg_hi:[1,0,0]
    v_pk_mul_f32 v[192:193], v[28:29], v[28:29]
    v_pk_mul_f32 v[194:195], v[30:31], v[30:31]
    v_pk_mul_f32 v[196:197], v[32:33], v[32:33]
    v_pk_mul_f32 v[198:199], v[34:35], v[34:35]
    v_pk_fma_f32 v[192:193], v[192:193], v[184:185], v[184:185] op_sel:[0,1,0] op_sel_hi:[1,1,0]
    v_pk_fma_f32 v[194:195], v[194:195], v[184:185], v[184:185] op_sel:[0,1,0] op_sel_hi:[1,1,0]
    v_pk_fma_f32 v[196:197], v[196:197], v[184:185], v[184:185] op_sel:[0,1,0] op_sel_hi:[1,1,0]
    v_pk_fma_f32 v[198:199], v[198:199], v[184:185], v[184:185] op_sel:[0,1,0] op_sel_hi:[1,1,0]
    v_pk_mul_f32 v[192:193], v[192:193], v[28:29]
    v_pk_mul_f32 v[194:195], v[194:195], v[30:31]
    v_pk_mul_f32 v[196:197], v[196:197], v[32:33]
    v_pk_mul_f32 v[198:199], v[198:199], v[34:35]
    v_exp_f32 v192, v192
    v_exp_f32 v193, v193
    v_exp_f32 v194, v194
    v_exp_f32 v195, v195
    v_exp_f32 v196, v196
    v_exp_f32 v197, v197
    v_exp_f32 v198, v198
    v_exp_f32 v199, v199
    v_pk_fma_f32 v[192:193], v[192:193], v[164:165], v[164:165] op_sel:[0,1,1] op_sel_hi:[1,1,1]
    v_pk_fma_f32 v[194:195], v[194:195], v[164:165], v[164:165] op_sel:[0,1,1] op_sel_hi:[1,1,1]
    v_pk_fma_f32 v[196:197], v[196:197], v[164:165], v[164:165] op_sel:[0,1,1] op_sel_hi:[1,1,1]
    v_pk_fma_f32 v[198:199], v[198:199], v[164:165], v[164:165] op_sel:[0,1,1] op_sel_hi:[1,1,1]
    v_rcp_f32 v192, v192
    v_rcp_f32 v193, v193
    v_rcp_f32 v194, v194
    v_rcp_f32 v195, v195
    v_rcp_f32 v196, v196
    v_rcp_f32 v197, v197
    v_rcp_f32 v198, v198
    v_rcp_f32 v199, v199
    v_pk_mul_f32 v[28:29], v[28:29], v[192:193]
    v_pk_mul_f32 v[30:31], v[30:31], v[194:195]
    v_pk_mul_f32 v[32:33], v[32:33], v[196:197]
    v_pk_mul_f32 v[34:35], v[34:35], v[198:199]
    v_cvt_pk_bf16_f32 v28, v28, v29
    v_cvt_pk_bf16_f32 v29, v30, v31
    v_cvt_pk_bf16_f32 v30, v32, v33
    v_cvt_pk_bf16_f32 v31, v34, v35
    ds_write_b128 v12, v[28:31] offset:0
    s_add_u32 s36, s45, 0
    buffer_store_dwordx4 v[28:31], v2, s[16:19], s36 offen sc1
    v_pk_fma_f32 v[56:57], v[166:167], v[140:141], v[56:57] op_sel_hi:[0,1,1] neg_lo:[1,0,0] neg_hi:[1,0,0]
    v_pk_fma_f32 v[58:59], v[166:167], v[142:143], v[58:59] op_sel_hi:[0,1,1] neg_lo:[1,0,0] neg_hi:[1,0,0]
    v_pk_fma_f32 v[60:61], v[166:167], v[144:145], v[60:61] op_sel_hi:[0,1,1] neg_lo:[1,0,0] neg_hi:[1,0,0]
    v_pk_fma_f32 v[62:63], v[166:167], v[146:147], v[62:63] op_sel_hi:[0,1,1] neg_lo:[1,0,0] neg_hi:[1,0,0]
    v_pk_mul_f32 v[192:193], v[56:57], v[56:57]
    v_pk_mul_f32 v[194:195], v[58:59], v[58:59]
    v_pk_mul_f32 v[196:197], v[60:61], v[60:61]
    v_pk_mul_f32 v[198:199], v[62:63], v[62:63]
    v_pk_fma_f32 v[192:193], v[192:193], v[186:187], v[186:187] op_sel:[0,1,0] op_sel_hi:[1,1,0]
    v_pk_fma_f32 v[194:195], v[194:195], v[186:187], v[186:187] op_sel:[0,1,0] op_sel_hi:[1,1,0]
    v_pk_fma_f32 v[196:197], v[196:197], v[186:187], v[186:187] op_sel:[0,1,0] op_sel_hi:[1,1,0]
    v_pk_fma_f32 v[198:199], v[198:199], v[186:187], v[186:187] op_sel:[0,1,0] op_sel_hi:[1,1,0]
    v_pk_mul_f32 v[192:193], v[192:193], v[56:57]
    v_pk_mul_f32 v[194:195], v[194:195], v[58:59]
    v_pk_mul_f32 v[196:197], v[196:197], v[60:61]
    v_pk_mul_f32 v[198:199], v[198:199], v[62:63]
    v_exp_f32 v192, v192
    v_exp_f32 v193, v193
    v_exp_f32 v194, v194
    v_exp_f32 v195, v195
    v_exp_f32 v196, v196
    v_exp_f32 v197, v197
    v_exp_f32 v198, v198
    v_exp_f32 v199, v199
    v_pk_fma_f32 v[192:193], v[192:193], v[166:167], v[166:167] op_sel:[0,1,1] op_sel_hi:[1,1,1]
    v_pk_fma_f32 v[194:195], v[194:195], v[166:167], v[166:167] op_sel:[0,1,1] op_sel_hi:[1,1,1]
    v_pk_fma_f32 v[196:197], v[196:197], v[166:167], v[166:167] op_sel:[0,1,1] op_sel_hi:[1,1,1]
    v_pk_fma_f32 v[198:199], v[198:199], v[166:167], v[166:167] op_sel:[0,1,1] op_sel_hi:[1,1,1]
    v_rcp_f32 v192, v192
    v_rcp_f32 v193, v193
    v_rcp_f32 v194, v194
    v_rcp_f32 v195, v195
    v_rcp_f32 v196, v196
    v_rcp_f32 v197, v197
    v_rcp_f32 v198, v198
    v_rcp_f32 v199, v199
    v_pk_mul_f32 v[56:57], v[56:57], v[192:193]
    v_pk_mul_f32 v[58:59], v[58:59], v[194:195]
    v_pk_mul_f32 v[60:61], v[60:61], v[196:197]
    v_pk_mul_f32 v[62:63], v[62:63], v[198:199]
    v_cvt_pk_bf16_f32 v56, v56, v57
    v_cvt_pk_bf16_f32 v57, v58, v59
    v_cvt_pk_bf16_f32 v58, v60, v61
    v_cvt_pk_bf16_f32 v59, v62, v63
    ds_write_b128 v12, v[56:59] offset:2048
    s_add_u32 s36, s45, 229376
    buffer_store_dwordx4 v[56:59], v2, s[16:19], s36 offen sc1
    v_pk_fma_f32 v[84:85], v[168:169], v[140:141], v[84:85] op_sel_hi:[0,1,1] neg_lo:[1,0,0] neg_hi:[1,0,0]
    v_pk_fma_f32 v[86:87], v[168:169], v[142:143], v[86:87] op_sel_hi:[0,1,1] neg_lo:[1,0,0] neg_hi:[1,0,0]
    v_pk_fma_f32 v[88:89], v[168:169], v[144:145], v[88:89] op_sel_hi:[0,1,1] neg_lo:[1,0,0] neg_hi:[1,0,0]
    v_pk_fma_f32 v[90:91], v[168:169], v[146:147], v[90:91] op_sel_hi:[0,1,1] neg_lo:[1,0,0] neg_hi:[1,0,0]
    v_pk_mul_f32 v[192:193], v[84:85], v[84:85]
    v_pk_mul_f32 v[194:195], v[86:87], v[86:87]
    v_pk_mul_f32 v[196:197], v[88:89], v[88:89]
    v_pk_mul_f32 v[198:199], v[90:91], v[90:91]
    v_pk_fma_f32 v[192:193], v[192:193], v[188:189], v[188:189] op_sel:[0,1,0] op_sel_hi:[1,1,0]
    v_pk_fma_f32 v[194:195], v[194:195], v[188:189], v[188:189] op_sel:[0,1,0] op_sel_hi:[1,1,0]
    v_pk_fma_f32 v[196:197], v[196:197], v[188:189], v[188:189] op_sel:[0,1,0] op_sel_hi:[1,1,0]
    v_pk_fma_f32 v[198:199], v[198:199], v[188:189], v[188:189] op_sel:[0,1,0] op_sel_hi:[1,1,0]
    v_pk_mul_f32 v[192:193], v[192:193], v[84:85]
    v_pk_mul_f32 v[194:195], v[194:195], v[86:87]
    v_pk_mul_f32 v[196:197], v[196:197], v[88:89]
    v_pk_mul_f32 v[198:199], v[198:199], v[90:91]
    v_exp_f32 v192, v192
    v_exp_f32 v193, v193
    v_exp_f32 v194, v194
    v_exp_f32 v195, v195
    v_exp_f32 v196, v196
    v_exp_f32 v197, v197
    v_exp_f32 v198, v198
    v_exp_f32 v199, v199
    v_pk_fma_f32 v[192:193], v[192:193], v[168:169], v[168:169] op_sel:[0,1,1] op_sel_hi:[1,1,1]
    v_pk_fma_f32 v[194:195], v[194:195], v[168:169], v[168:169] op_sel:[0,1,1] op_sel_hi:[1,1,1]
    v_pk_fma_f32 v[196:197], v[196:197], v[168:169], v[168:169] op_sel:[0,1,1] op_sel_hi:[1,1,1]
    v_pk_fma_f32 v[198:199], v[198:199], v[168:169], v[168:169] op_sel:[0,1,1] op_sel_hi:[1,1,1]
    v_rcp_f32 v192, v192
    v_rcp_f32 v193, v193
    v_rcp_f32 v194, v194
    v_rcp_f32 v195, v195
    v_rcp_f32 v196, v196
    v_rcp_f32 v197, v197
    v_rcp_f32 v198, v198
    v_rcp_f32 v199, v199
    v_pk_mul_f32 v[84:85], v[84:85], v[192:193]
    v_pk_mul_f32 v[86:87], v[86:87], v[194:195]
    v_pk_mul_f32 v[88:89], v[88:89], v[196:197]
    v_pk_mul_f32 v[90:91], v[90:91], v[198:199]
    v_cvt_pk_bf16_f32 v84, v84, v85
    v_cvt_pk_bf16_f32 v85, v86, v87
    v_cvt_pk_bf16_f32 v86, v88, v89
    v_cvt_pk_bf16_f32 v87, v90, v91
    ds_write_b128 v12, v[84:87] offset:4096
    s_add_u32 s36, s45, 458752
    buffer_store_dwordx4 v[84:87], v2, s[16:19], s36 offen sc1
    v_pk_fma_f32 v[112:113], v[170:171], v[140:141], v[112:113] op_sel_hi:[0,1,1] neg_lo:[1,0,0] neg_hi:[1,0,0]
    v_pk_fma_f32 v[114:115], v[170:171], v[142:143], v[114:115] op_sel_hi:[0,1,1] neg_lo:[1,0,0] neg_hi:[1,0,0]
    v_pk_fma_f32 v[116:117], v[170:171], v[144:145], v[116:117] op_sel_hi:[0,1,1] neg_lo:[1,0,0] neg_hi:[1,0,0]
    v_pk_fma_f32 v[118:119], v[170:171], v[146:147], v[118:119] op_sel_hi:[0,1,1] neg_lo:[1,0,0] neg_hi:[1,0,0]
    v_pk_mul_f32 v[192:193], v[112:113], v[112:113]
    v_pk_mul_f32 v[194:195], v[114:115], v[114:115]
    v_pk_mul_f32 v[196:197], v[116:117], v[116:117]
    v_pk_mul_f32 v[198:199], v[118:119], v[118:119]
    v_pk_fma_f32 v[192:193], v[192:193], v[190:191], v[190:191] op_sel:[0,1,0] op_sel_hi:[1,1,0]
    v_pk_fma_f32 v[194:195], v[194:195], v[190:191], v[190:191] op_sel:[0,1,0] op_sel_hi:[1,1,0]
    v_pk_fma_f32 v[196:197], v[196:197], v[190:191], v[190:191] op_sel:[0,1,0] op_sel_hi:[1,1,0]
    v_pk_fma_f32 v[198:199], v[198:199], v[190:191], v[190:191] op_sel:[0,1,0] op_sel_hi:[1,1,0]
    v_pk_mul_f32 v[192:193], v[192:193], v[112:113]
    v_pk_mul_f32 v[194:195], v[194:195], v[114:115]
    v_pk_mul_f32 v[196:197], v[196:197], v[116:117]
    v_pk_mul_f32 v[198:199], v[198:199], v[118:119]
    v_exp_f32 v192, v192
    v_exp_f32 v193, v193
    v_exp_f32 v194, v194
    v_exp_f32 v195, v195
    v_exp_f32 v196, v196
    v_exp_f32 v197, v197
    v_exp_f32 v198, v198
    v_exp_f32 v199, v199
    v_pk_fma_f32 v[192:193], v[192:193], v[170:171], v[170:171] op_sel:[0,1,1] op_sel_hi:[1,1,1]
    v_pk_fma_f32 v[194:195], v[194:195], v[170:171], v[170:171] op_sel:[0,1,1] op_sel_hi:[1,1,1]
    v_pk_fma_f32 v[196:197], v[196:197], v[170:171], v[170:171] op_sel:[0,1,1] op_sel_hi:[1,1,1]
    v_pk_fma_f32 v[198:199], v[198:199], v[170:171], v[170:171] op_sel:[0,1,1] op_sel_hi:[1,1,1]
    v_rcp_f32 v192, v192
    v_rcp_f32 v193, v193
    v_rcp_f32 v194, v194
    v_rcp_f32 v195, v195
    v_rcp_f32 v196, v196
    v_rcp_f32 v197, v197
    v_rcp_f32 v198, v198
    v_rcp_f32 v199, v199
    v_pk_mul_f32 v[112:113], v[112:113], v[192:193]
    v_pk_mul_f32 v[114:115], v[114:115], v[194:195]
    v_pk_mul_f32 v[116:117], v[116:117], v[196:197]
    v_pk_mul_f32 v[118:119], v[118:119], v[198:199]
    v_cvt_pk_bf16_f32 v112, v112, v113
    v_cvt_pk_bf16_f32 v113, v114, v115
    v_cvt_pk_bf16_f32 v114, v116, v117
    v_cvt_pk_bf16_f32 v115, v118, v119
    ds_write_b128 v12, v[112:115] offset:6144
    s_add_u32 s36, s45, 688128
    buffer_store_dwordx4 v[112:115], v2, s[16:19], s36 offen sc1
    v_pk_fma_f32 v[36:37], v[164:165], v[148:149], v[36:37] op_sel_hi:[0,1,1] neg_lo:[1,0,0] neg_hi:[1,0,0]
    v_pk_fma_f32 v[38:39], v[164:165], v[150:151], v[38:39] op_sel_hi:[0,1,1] neg_lo:[1,0,0] neg_hi:[1,0,0]
    v_pk_fma_f32 v[40:41], v[164:165], v[152:153], v[40:41] op_sel_hi:[0,1,1] neg_lo:[1,0,0] neg_hi:[1,0,0]
    v_pk_fma_f32 v[42:43], v[164:165], v[154:155], v[42:43] op_sel_hi:[0,1,1] neg_lo:[1,0,0] neg_hi:[1,0,0]
    v_pk_mul_f32 v[192:193], v[36:37], v[36:37]
    v_pk_mul_f32 v[194:195], v[38:39], v[38:39]
    v_pk_mul_f32 v[196:197], v[40:41], v[40:41]
    v_pk_mul_f32 v[198:199], v[42:43], v[42:43]
    v_pk_fma_f32 v[192:193], v[192:193], v[184:185], v[184:185] op_sel:[0,1,0] op_sel_hi:[1,1,0]
    v_pk_fma_f32 v[194:195], v[194:195], v[184:185], v[184:185] op_sel:[0,1,0] op_sel_hi:[1,1,0]
    v_pk_fma_f32 v[196:197], v[196:197], v[184:185], v[184:185] op_sel:[0,1,0] op_sel_hi:[1,1,0]
    v_pk_fma_f32 v[198:199], v[198:199], v[184:185], v[184:185] op_sel:[0,1,0] op_sel_hi:[1,1,0]
    v_pk_mul_f32 v[192:193], v[192:193], v[36:37]
    v_pk_mul_f32 v[194:195], v[194:195], v[38:39]
    v_pk_mul_f32 v[196:197], v[196:197], v[40:41]
    v_pk_mul_f32 v[198:199], v[198:199], v[42:43]
    v_exp_f32 v192, v192
    v_exp_f32 v193, v193
    v_exp_f32 v194, v194
    v_exp_f32 v195, v195
    v_exp_f32 v196, v196
    v_exp_f32 v197, v197
    v_exp_f32 v198, v198
    v_exp_f32 v199, v199
    v_pk_fma_f32 v[192:193], v[192:193], v[164:165], v[164:165] op_sel:[0,1,1] op_sel_hi:[1,1,1]
    v_pk_fma_f32 v[194:195], v[194:195], v[164:165], v[164:165] op_sel:[0,1,1] op_sel_hi:[1,1,1]
    v_pk_fma_f32 v[196:197], v[196:197], v[164:165], v[164:165] op_sel:[0,1,1] op_sel_hi:[1,1,1]
    v_pk_fma_f32 v[198:199], v[198:199], v[164:165], v[164:165] op_sel:[0,1,1] op_sel_hi:[1,1,1]
    v_rcp_f32 v192, v192
    v_rcp_f32 v193, v193
    v_rcp_f32 v194, v194
    v_rcp_f32 v195, v195
    v_rcp_f32 v196, v196
    v_rcp_f32 v197, v197
    v_rcp_f32 v198, v198
    v_rcp_f32 v199, v199
    v_pk_mul_f32 v[36:37], v[36:37], v[192:193]
    v_pk_mul_f32 v[38:39], v[38:39], v[194:195]
    v_pk_mul_f32 v[40:41], v[40:41], v[196:197]
    v_pk_mul_f32 v[42:43], v[42:43], v[198:199]
    v_cvt_pk_bf16_f32 v36, v36, v37
    v_cvt_pk_bf16_f32 v37, v38, v39
    v_cvt_pk_bf16_f32 v38, v40, v41
    v_cvt_pk_bf16_f32 v39, v42, v43
    ds_write_b128 v12, v[36:39] offset:16384
    v_pk_fma_f32 v[64:65], v[166:167], v[148:149], v[64:65] op_sel_hi:[0,1,1] neg_lo:[1,0,0] neg_hi:[1,0,0]
    v_pk_fma_f32 v[66:67], v[166:167], v[150:151], v[66:67] op_sel_hi:[0,1,1] neg_lo:[1,0,0] neg_hi:[1,0,0]
    v_pk_fma_f32 v[68:69], v[166:167], v[152:153], v[68:69] op_sel_hi:[0,1,1] neg_lo:[1,0,0] neg_hi:[1,0,0]
    v_pk_fma_f32 v[70:71], v[166:167], v[154:155], v[70:71] op_sel_hi:[0,1,1] neg_lo:[1,0,0] neg_hi:[1,0,0]
    v_pk_mul_f32 v[192:193], v[64:65], v[64:65]
    v_pk_mul_f32 v[194:195], v[66:67], v[66:67]
    v_pk_mul_f32 v[196:197], v[68:69], v[68:69]
    v_pk_mul_f32 v[198:199], v[70:71], v[70:71]
    v_pk_fma_f32 v[192:193], v[192:193], v[186:187], v[186:187] op_sel:[0,1,0] op_sel_hi:[1,1,0]
    v_pk_fma_f32 v[194:195], v[194:195], v[186:187], v[186:187] op_sel:[0,1,0] op_sel_hi:[1,1,0]
    v_pk_fma_f32 v[196:197], v[196:197], v[186:187], v[186:187] op_sel:[0,1,0] op_sel_hi:[1,1,0]
    v_pk_fma_f32 v[198:199], v[198:199], v[186:187], v[186:187] op_sel:[0,1,0] op_sel_hi:[1,1,0]
    v_pk_mul_f32 v[192:193], v[192:193], v[64:65]
    v_pk_mul_f32 v[194:195], v[194:195], v[66:67]
    v_pk_mul_f32 v[196:197], v[196:197], v[68:69]
    v_pk_mul_f32 v[198:199], v[198:199], v[70:71]
    v_exp_f32 v192, v192
    v_exp_f32 v193, v193
    v_exp_f32 v194, v194
    v_exp_f32 v195, v195
    v_exp_f32 v196, v196
    v_exp_f32 v197, v197
    v_exp_f32 v198, v198
    v_exp_f32 v199, v199
    v_pk_fma_f32 v[192:193], v[192:193], v[166:167], v[166:167] op_sel:[0,1,1] op_sel_hi:[1,1,1]
    v_pk_fma_f32 v[194:195], v[194:195], v[166:167], v[166:167] op_sel:[0,1,1] op_sel_hi:[1,1,1]
    v_pk_fma_f32 v[196:197], v[196:197], v[166:167], v[166:167] op_sel:[0,1,1] op_sel_hi:[1,1,1]
    v_pk_fma_f32 v[198:199], v[198:199], v[166:167], v[166:167] op_sel:[0,1,1] op_sel_hi:[1,1,1]
    v_rcp_f32 v192, v192
    v_rcp_f32 v193, v193
    v_rcp_f32 v194, v194
    v_rcp_f32 v195, v195
    v_rcp_f32 v196, v196
    v_rcp_f32 v197, v197
    v_rcp_f32 v198, v198
    v_rcp_f32 v199, v199
    v_pk_mul_f32 v[64:65], v[64:65], v[192:193]
    v_pk_mul_f32 v[66:67], v[66:67], v[194:195]
    v_pk_mul_f32 v[68:69], v[68:69], v[196:197]
    v_pk_mul_f32 v[70:71], v[70:71], v[198:199]
    v_cvt_pk_bf16_f32 v64, v64, v65
    v_cvt_pk_bf16_f32 v65, v66, v67
    v_cvt_pk_bf16_f32 v66, v68, v69
    v_cvt_pk_bf16_f32 v67, v70, v71
    ds_write_b128 v12, v[64:67] offset:18432
    v_pk_fma_f32 v[92:93], v[168:169], v[148:149], v[92:93] op_sel_hi:[0,1,1] neg_lo:[1,0,0] neg_hi:[1,0,0]
    v_pk_fma_f32 v[94:95], v[168:169], v[150:151], v[94:95] op_sel_hi:[0,1,1] neg_lo:[1,0,0] neg_hi:[1,0,0]
    v_pk_fma_f32 v[96:97], v[168:169], v[152:153], v[96:97] op_sel_hi:[0,1,1] neg_lo:[1,0,0] neg_hi:[1,0,0]
    v_pk_fma_f32 v[98:99], v[168:169], v[154:155], v[98:99] op_sel_hi:[0,1,1] neg_lo:[1,0,0] neg_hi:[1,0,0]
    v_pk_mul_f32 v[192:193], v[92:93], v[92:93]
    v_pk_mul_f32 v[194:195], v[94:95], v[94:95]
    v_pk_mul_f32 v[196:197], v[96:97], v[96:97]
    v_pk_mul_f32 v[198:199], v[98:99], v[98:99]
    v_pk_fma_f32 v[192:193], v[192:193], v[188:189], v[188:189] op_sel:[0,1,0] op_sel_hi:[1,1,0]
    v_pk_fma_f32 v[194:195], v[194:195], v[188:189], v[188:189] op_sel:[0,1,0] op_sel_hi:[1,1,0]
    v_pk_fma_f32 v[196:197], v[196:197], v[188:189], v[188:189] op_sel:[0,1,0] op_sel_hi:[1,1,0]
    v_pk_fma_f32 v[198:199], v[198:199], v[188:189], v[188:189] op_sel:[0,1,0] op_sel_hi:[1,1,0]
    v_pk_mul_f32 v[192:193], v[192:193], v[92:93]
    v_pk_mul_f32 v[194:195], v[194:195], v[94:95]
    v_pk_mul_f32 v[196:197], v[196:197], v[96:97]
    v_pk_mul_f32 v[198:199], v[198:199], v[98:99]
    v_exp_f32 v192, v192
    v_exp_f32 v193, v193
    v_exp_f32 v194, v194
    v_exp_f32 v195, v195
    v_exp_f32 v196, v196
    v_exp_f32 v197, v197
    v_exp_f32 v198, v198
    v_exp_f32 v199, v199
    v_pk_fma_f32 v[192:193], v[192:193], v[168:169], v[168:169] op_sel:[0,1,1] op_sel_hi:[1,1,1]
    v_pk_fma_f32 v[194:195], v[194:195], v[168:169], v[168:169] op_sel:[0,1,1] op_sel_hi:[1,1,1]
    v_pk_fma_f32 v[196:197], v[196:197], v[168:169], v[168:169] op_sel:[0,1,1] op_sel_hi:[1,1,1]
    v_pk_fma_f32 v[198:199], v[198:199], v[168:169], v[168:169] op_sel:[0,1,1] op_sel_hi:[1,1,1]
    v_rcp_f32 v192, v192
    v_rcp_f32 v193, v193
    v_rcp_f32 v194, v194
    v_rcp_f32 v195, v195
    v_rcp_f32 v196, v196
    v_rcp_f32 v197, v197
    v_rcp_f32 v198, v198
    v_rcp_f32 v199, v199
    v_pk_mul_f32 v[92:93], v[92:93], v[192:193]
    v_pk_mul_f32 v[94:95], v[94:95], v[194:195]
    v_pk_mul_f32 v[96:97], v[96:97], v[196:197]
    v_pk_mul_f32 v[98:99], v[98:99], v[198:199]
    v_cvt_pk_bf16_f32 v92, v92, v93
    v_cvt_pk_bf16_f32 v93, v94, v95
    v_cvt_pk_bf16_f32 v94, v96, v97
    v_cvt_pk_bf16_f32 v95, v98, v99
    ds_write_b128 v12, v[92:95] offset:20480
    s_lshr_b32 s53, s30, 1
    s_lshl1_add_u32 s53, s31, s53
    s_lshl_b32 s53, s53, 7
    s_add_u32 s53, s53, s55
    s_add_u32 s53, s53, 0x1000
    v_mov_b32 v8, 1
    v_mov_b32 v9, 0
    s_mov_b64 exec, 1
    s_waitcnt vmcnt(0)
    buffer_atomic_add v8, v9, s[56:59], s53 offen sc1
    s_mov_b64 exec, -1
    v_pk_fma_f32 v[120:121], v[170:171], v[148:149], v[120:121] op_sel_hi:[0,1,1] neg_lo:[1,0,0] neg_hi:[1,0,0]
    v_pk_fma_f32 v[122:123], v[170:171], v[150:151], v[122:123] op_sel_hi:[0,1,1] neg_lo:[1,0,0] neg_hi:[1,0,0]
    v_pk_fma_f32 v[124:125], v[170:171], v[152:153], v[124:125] op_sel_hi:[0,1,1] neg_lo:[1,0,0] neg_hi:[1,0,0]
    v_pk_fma_f32 v[126:127], v[170:171], v[154:155], v[126:127] op_sel_hi:[0,1,1] neg_lo:[1,0,0] neg_hi:[1,0,0]
    v_pk_mul_f32 v[192:193], v[120:121], v[120:121]
    v_pk_mul_f32 v[194:195], v[122:123], v[122:123]
    v_pk_mul_f32 v[196:197], v[124:125], v[124:125]
    v_pk_mul_f32 v[198:199], v[126:127], v[126:127]
    v_pk_fma_f32 v[192:193], v[192:193], v[190:191], v[190:191] op_sel:[0,1,0] op_sel_hi:[1,1,0]
    v_pk_fma_f32 v[194:195], v[194:195], v[190:191], v[190:191] op_sel:[0,1,0] op_sel_hi:[1,1,0]
    v_pk_fma_f32 v[196:197], v[196:197], v[190:191], v[190:191] op_sel:[0,1,0] op_sel_hi:[1,1,0]
    v_pk_fma_f32 v[198:199], v[198:199], v[190:191], v[190:191] op_sel:[0,1,0] op_sel_hi:[1,1,0]
    v_pk_mul_f32 v[192:193], v[192:193], v[120:121]
    v_pk_mul_f32 v[194:195], v[194:195], v[122:123]
    v_pk_mul_f32 v[196:197], v[196:197], v[124:125]
    v_pk_mul_f32 v[198:199], v[198:199], v[126:127]
    v_exp_f32 v192, v192
    v_exp_f32 v193, v193
    v_exp_f32 v194, v194
    v_exp_f32 v195, v195
    v_exp_f32 v196, v196
    v_exp_f32 v197, v197
    v_exp_f32 v198, v198
    v_exp_f32 v199, v199
    v_pk_fma_f32 v[192:193], v[192:193], v[170:171], v[170:171] op_sel:[0,1,1] op_sel_hi:[1,1,1]
    v_pk_fma_f32 v[194:195], v[194:195], v[170:171], v[170:171] op_sel:[0,1,1] op_sel_hi:[1,1,1]
    v_pk_fma_f32 v[196:197], v[196:197], v[170:171], v[170:171] op_sel:[0,1,1] op_sel_hi:[1,1,1]
    v_pk_fma_f32 v[198:199], v[198:199], v[170:171], v[170:171] op_sel:[0,1,1] op_sel_hi:[1,1,1]
    v_rcp_f32 v192, v192
    v_rcp_f32 v193, v193
    v_rcp_f32 v194, v194
    v_rcp_f32 v195, v195
    v_rcp_f32 v196, v196
    v_rcp_f32 v197, v197
    v_rcp_f32 v198, v198
    v_rcp_f32 v199, v199
    v_pk_mul_f32 v[120:121], v[120:121], v[192:193]
    v_pk_mul_f32 v[122:123], v[122:123], v[194:195]
    v_pk_mul_f32 v[124:125], v[124:125], v[196:197]
    v_pk_mul_f32 v[126:127], v[126:127], v[198:199]
    v_cvt_pk_bf16_f32 v120, v120, v121
    v_cvt_pk_bf16_f32 v121, v122, v123
    v_cvt_pk_bf16_f32 v122, v124, v125
    v_cvt_pk_bf16_f32 v123, v126, v127
    ds_write_b128 v12, v[120:123] offset:22528
    v_pk_fma_f32 v[44:45], v[164:165], v[156:157], v[44:45] op_sel_hi:[0,1,1] neg_lo:[1,0,0] neg_hi:[1,0,0]
    v_pk_fma_f32 v[46:47], v[164:165], v[158:159], v[46:47] op_sel_hi:[0,1,1] neg_lo:[1,0,0] neg_hi:[1,0,0]
    v_pk_fma_f32 v[48:49], v[164:165], v[160:161], v[48:49] op_sel_hi:[0,1,1] neg_lo:[1,0,0] neg_hi:[1,0,0]
    v_pk_fma_f32 v[50:51], v[164:165], v[162:163], v[50:51] op_sel_hi:[0,1,1] neg_lo:[1,0,0] neg_hi:[1,0,0]
    v_pk_mul_f32 v[192:193], v[44:45], v[44:45]
    v_pk_mul_f32 v[194:195], v[46:47], v[46:47]
    v_pk_mul_f32 v[196:197], v[48:49], v[48:49]
    v_pk_mul_f32 v[198:199], v[50:51], v[50:51]
    v_pk_fma_f32 v[192:193], v[192:193], v[184:185], v[184:185] op_sel:[0,1,0] op_sel_hi:[1,1,0]
    v_pk_fma_f32 v[194:195], v[194:195], v[184:185], v[184:185] op_sel:[0,1,0] op_sel_hi:[1,1,0]
    v_pk_fma_f32 v[196:197], v[196:197], v[184:185], v[184:185] op_sel:[0,1,0] op_sel_hi:[1,1,0]
    v_pk_fma_f32 v[198:199], v[198:199], v[184:185], v[184:185] op_sel:[0,1,0] op_sel_hi:[1,1,0]
    v_pk_mul_f32 v[192:193], v[192:193], v[44:45]
    v_pk_mul_f32 v[194:195], v[194:195], v[46:47]
    v_pk_mul_f32 v[196:197], v[196:197], v[48:49]
    v_pk_mul_f32 v[198:199], v[198:199], v[50:51]
    v_exp_f32 v192, v192
    v_exp_f32 v193, v193
    v_exp_f32 v194, v194
    v_exp_f32 v195, v195
    v_exp_f32 v196, v196
    v_exp_f32 v197, v197
    v_exp_f32 v198, v198
    v_exp_f32 v199, v199
    v_pk_fma_f32 v[192:193], v[192:193], v[164:165], v[164:165] op_sel:[0,1,1] op_sel_hi:[1,1,1]
    v_pk_fma_f32 v[194:195], v[194:195], v[164:165], v[164:165] op_sel:[0,1,1] op_sel_hi:[1,1,1]
    v_pk_fma_f32 v[196:197], v[196:197], v[164:165], v[164:165] op_sel:[0,1,1] op_sel_hi:[1,1,1]
    v_pk_fma_f32 v[198:199], v[198:199], v[164:165], v[164:165] op_sel:[0,1,1] op_sel_hi:[1,1,1]
    v_rcp_f32 v192, v192
    v_rcp_f32 v193, v193
    v_rcp_f32 v194, v194
    v_rcp_f32 v195, v195
    v_rcp_f32 v196, v196
    v_rcp_f32 v197, v197
    v_rcp_f32 v198, v198
    v_rcp_f32 v199, v199
    v_pk_mul_f32 v[44:45], v[44:45], v[192:193]
    v_pk_mul_f32 v[46:47], v[46:47], v[194:195]
    v_pk_mul_f32 v[48:49], v[48:49], v[196:197]
    v_pk_mul_f32 v[50:51], v[50:51], v[198:199]
    v_cvt_pk_bf16_f32 v230, v44, v45
    v_cvt_pk_bf16_f32 v231, v46, v47
    v_cvt_pk_bf16_f32 v232, v48, v49
    v_cvt_pk_bf16_f32 v233, v50, v51
    ds_write_b128 v12, v[230:233] offset:32768
    v_pk_fma_f32 v[72:73], v[166:167], v[156:157], v[72:73] op_sel_hi:[0,1,1] neg_lo:[1,0,0] neg_hi:[1,0,0]
    v_pk_fma_f32 v[74:75], v[166:167], v[158:159], v[74:75] op_sel_hi:[0,1,1] neg_lo:[1,0,0] neg_hi:[1,0,0]
    v_pk_fma_f32 v[76:77], v[166:167], v[160:161], v[76:77] op_sel_hi:[0,1,1] neg_lo:[1,0,0] neg_hi:[1,0,0]
    v_pk_fma_f32 v[78:79], v[166:167], v[162:163], v[78:79] op_sel_hi:[0,1,1] neg_lo:[1,0,0] neg_hi:[1,0,0]
    v_pk_mul_f32 v[192:193], v[72:73], v[72:73]
    v_pk_mul_f32 v[194:195], v[74:75], v[74:75]
    v_pk_mul_f32 v[196:197], v[76:77], v[76:77]
    v_pk_mul_f32 v[198:199], v[78:79], v[78:79]
    v_pk_fma_f32 v[192:193], v[192:193], v[186:187], v[186:187] op_sel:[0,1,0] op_sel_hi:[1,1,0]
    v_pk_fma_f32 v[194:195], v[194:195], v[186:187], v[186:187] op_sel:[0,1,0] op_sel_hi:[1,1,0]
    v_pk_fma_f32 v[196:197], v[196:197], v[186:187], v[186:187] op_sel:[0,1,0] op_sel_hi:[1,1,0]
    v_pk_fma_f32 v[198:199], v[198:199], v[186:187], v[186:187] op_sel:[0,1,0] op_sel_hi:[1,1,0]
    v_pk_mul_f32 v[192:193], v[192:193], v[72:73]
    v_pk_mul_f32 v[194:195], v[194:195], v[74:75]
    v_pk_mul_f32 v[196:197], v[196:197], v[76:77]
    v_pk_mul_f32 v[198:199], v[198:199], v[78:79]
    v_exp_f32 v192, v192
    v_exp_f32 v193, v193
    v_exp_f32 v194, v194
    v_exp_f32 v195, v195
    v_exp_f32 v196, v196
    v_exp_f32 v197, v197
    v_exp_f32 v198, v198
    v_exp_f32 v199, v199
    v_pk_fma_f32 v[192:193], v[192:193], v[166:167], v[166:167] op_sel:[0,1,1] op_sel_hi:[1,1,1]
    v_pk_fma_f32 v[194:195], v[194:195], v[166:167], v[166:167] op_sel:[0,1,1] op_sel_hi:[1,1,1]
    v_pk_fma_f32 v[196:197], v[196:197], v[166:167], v[166:167] op_sel:[0,1,1] op_sel_hi:[1,1,1]
    v_pk_fma_f32 v[198:199], v[198:199], v[166:167], v[166:167] op_sel:[0,1,1] op_sel_hi:[1,1,1]
    v_rcp_f32 v192, v192
    v_rcp_f32 v193, v193
    v_rcp_f32 v194, v194
    v_rcp_f32 v195, v195
    v_rcp_f32 v196, v196
    v_rcp_f32 v197, v197
    v_rcp_f32 v198, v198
    v_rcp_f32 v199, v199
    v_pk_mul_f32 v[72:73], v[72:73], v[192:193]
    v_pk_mul_f32 v[74:75], v[74:75], v[194:195]
    v_pk_mul_f32 v[76:77], v[76:77], v[196:197]
    v_pk_mul_f32 v[78:79], v[78:79], v[198:199]
    v_cvt_pk_bf16_f32 v234, v72, v73
    v_cvt_pk_bf16_f32 v235, v74, v75
    v_cvt_pk_bf16_f32 v236, v76, v77
    v_cvt_pk_bf16_f32 v237, v78, v79
    ds_write_b128 v12, v[234:237] offset:34816
    v_pk_fma_f32 v[100:101], v[168:169], v[156:157], v[100:101] op_sel_hi:[0,1,1] neg_lo:[1,0,0] neg_hi:[1,0,0]
    v_pk_fma_f32 v[102:103], v[168:169], v[158:159], v[102:103] op_sel_hi:[0,1,1] neg_lo:[1,0,0] neg_hi:[1,0,0]
    v_pk_fma_f32 v[104:105], v[168:169], v[160:161], v[104:105] op_sel_hi:[0,1,1] neg_lo:[1,0,0] neg_hi:[1,0,0]
    v_pk_fma_f32 v[106:107], v[168:169], v[162:163], v[106:107] op_sel_hi:[0,1,1] neg_lo:[1,0,0] neg_hi:[1,0,0]
    v_pk_mul_f32 v[192:193], v[100:101], v[100:101]
    v_pk_mul_f32 v[194:195], v[102:103], v[102:103]
    v_pk_mul_f32 v[196:197], v[104:105], v[104:105]
    v_pk_mul_f32 v[198:199], v[106:107], v[106:107]
    v_pk_fma_f32 v[192:193], v[192:193], v[188:189], v[188:189] op_sel:[0,1,0] op_sel_hi:[1,1,0]
    v_pk_fma_f32 v[194:195], v[194:195], v[188:189], v[188:189] op_sel:[0,1,0] op_sel_hi:[1,1,0]
    v_pk_fma_f32 v[196:197], v[196:197], v[188:189], v[188:189] op_sel:[0,1,0] op_sel_hi:[1,1,0]
    v_pk_fma_f32 v[198:199], v[198:199], v[188:189], v[188:189] op_sel:[0,1,0] op_sel_hi:[1,1,0]
    v_pk_mul_f32 v[192:193], v[192:193], v[100:101]
    v_pk_mul_f32 v[194:195], v[194:195], v[102:103]
    v_pk_mul_f32 v[196:197], v[196:197], v[104:105]
    v_pk_mul_f32 v[198:199], v[198:199], v[106:107]
    v_exp_f32 v192, v192
    v_exp_f32 v193, v193
    v_exp_f32 v194, v194
    v_exp_f32 v195, v195
    v_exp_f32 v196, v196
    v_exp_f32 v197, v197
    v_exp_f32 v198, v198
    v_exp_f32 v199, v199
    v_pk_fma_f32 v[192:193], v[192:193], v[168:169], v[168:169] op_sel:[0,1,1] op_sel_hi:[1,1,1]
    v_pk_fma_f32 v[194:195], v[194:195], v[168:169], v[168:169] op_sel:[0,1,1] op_sel_hi:[1,1,1]
    v_pk_fma_f32 v[196:197], v[196:197], v[168:169], v[168:169] op_sel:[0,1,1] op_sel_hi:[1,1,1]
    v_pk_fma_f32 v[198:199], v[198:199], v[168:169], v[168:169] op_sel:[0,1,1] op_sel_hi:[1,1,1]
    v_rcp_f32 v192, v192
    v_rcp_f32 v193, v193
    v_rcp_f32 v194, v194
    v_rcp_f32 v195, v195
    v_rcp_f32 v196, v196
    v_rcp_f32 v197, v197
    v_rcp_f32 v198, v198
    v_rcp_f32 v199, v199
    v_pk_mul_f32 v[100:101], v[100:101], v[192:193]
    v_pk_mul_f32 v[102:103], v[102:103], v[194:195]
    v_pk_mul_f32 v[104:105], v[104:105], v[196:197]
    v_pk_mul_f32 v[106:107], v[106:107], v[198:199]
    v_cvt_pk_bf16_f32 v238, v100, v101
    v_cvt_pk_bf16_f32 v239, v102, v103
    v_cvt_pk_bf16_f32 v240, v104, v105
    v_cvt_pk_bf16_f32 v241, v106, v107
    ds_write_b128 v12, v[238:241] offset:36864
    v_pk_fma_f32 v[128:129], v[170:171], v[156:157], v[128:129] op_sel_hi:[0,1,1] neg_lo:[1,0,0] neg_hi:[1,0,0]
    v_pk_fma_f32 v[130:131], v[170:171], v[158:159], v[130:131] op_sel_hi:[0,1,1] neg_lo:[1,0,0] neg_hi:[1,0,0]
    v_pk_fma_f32 v[132:133], v[170:171], v[160:161], v[132:133] op_sel_hi:[0,1,1] neg_lo:[1,0,0] neg_hi:[1,0,0]
    v_pk_fma_f32 v[134:135], v[170:171], v[162:163], v[134:135] op_sel_hi:[0,1,1] neg_lo:[1,0,0] neg_hi:[1,0,0]
    v_pk_mul_f32 v[192:193], v[128:129], v[128:129]
    v_pk_mul_f32 v[194:195], v[130:131], v[130:131]
    v_pk_mul_f32 v[196:197], v[132:133], v[132:133]
    v_pk_mul_f32 v[198:199], v[134:135], v[134:135]
    v_pk_fma_f32 v[192:193], v[192:193], v[190:191], v[190:191] op_sel:[0,1,0] op_sel_hi:[1,1,0]
    v_pk_fma_f32 v[194:195], v[194:195], v[190:191], v[190:191] op_sel:[0,1,0] op_sel_hi:[1,1,0]
    v_pk_fma_f32 v[196:197], v[196:197], v[190:191], v[190:191] op_sel:[0,1,0] op_sel_hi:[1,1,0]
    v_pk_fma_f32 v[198:199], v[198:199], v[190:191], v[190:191] op_sel:[0,1,0] op_sel_hi:[1,1,0]
    v_pk_mul_f32 v[192:193], v[192:193], v[128:129]
    v_pk_mul_f32 v[194:195], v[194:195], v[130:131]
    v_pk_mul_f32 v[196:197], v[196:197], v[132:133]
    v_pk_mul_f32 v[198:199], v[198:199], v[134:135]
    v_exp_f32 v192, v192
    v_exp_f32 v193, v193
    v_exp_f32 v194, v194
    v_exp_f32 v195, v195
    v_exp_f32 v196, v196
    v_exp_f32 v197, v197
    v_exp_f32 v198, v198
    v_exp_f32 v199, v199
    v_pk_fma_f32 v[192:193], v[192:193], v[170:171], v[170:171] op_sel:[0,1,1] op_sel_hi:[1,1,1]
    v_pk_fma_f32 v[194:195], v[194:195], v[170:171], v[170:171] op_sel:[0,1,1] op_sel_hi:[1,1,1]
    v_pk_fma_f32 v[196:197], v[196:197], v[170:171], v[170:171] op_sel:[0,1,1] op_sel_hi:[1,1,1]
    v_pk_fma_f32 v[198:199], v[198:199], v[170:171], v[170:171] op_sel:[0,1,1] op_sel_hi:[1,1,1]
    v_rcp_f32 v192, v192
    v_rcp_f32 v193, v193
    v_rcp_f32 v194, v194
    v_rcp_f32 v195, v195
    v_rcp_f32 v196, v196
    v_rcp_f32 v197, v197
    v_rcp_f32 v198, v198
    v_rcp_f32 v199, v199
    v_pk_mul_f32 v[128:129], v[128:129], v[192:193]
    v_pk_mul_f32 v[130:131], v[130:131], v[194:195]
    v_pk_mul_f32 v[132:133], v[132:133], v[196:197]
    v_pk_mul_f32 v[134:135], v[134:135], v[198:199]
    v_cvt_pk_bf16_f32 v242, v128, v129
    v_cvt_pk_bf16_f32 v243, v130, v131
    v_cvt_pk_bf16_f32 v244, v132, v133
    v_cvt_pk_bf16_f32 v245, v134, v135
    ds_write_b128 v12, v[242:245] offset:38912
    v_pk_fma_f32 v[24:25], v[164:165], v[136:137], v[24:25] op_sel_hi:[0,1,1] neg_lo:[1,0,0] neg_hi:[1,0,0]
    v_pk_fma_f32 v[26:27], v[164:165], v[138:139], v[26:27] op_sel_hi:[0,1,1] neg_lo:[1,0,0] neg_hi:[1,0,0]
    v_pk_fma_f32 v[52:53], v[166:167], v[136:137], v[52:53] op_sel_hi:[0,1,1] neg_lo:[1,0,0] neg_hi:[1,0,0]
    v_pk_fma_f32 v[54:55], v[166:167], v[138:139], v[54:55] op_sel_hi:[0,1,1] neg_lo:[1,0,0] neg_hi:[1,0,0]
    v_pk_mul_f32 v[192:193], v[24:25], v[24:25]
    v_pk_mul_f32 v[194:195], v[26:27], v[26:27]
    v_pk_mul_f32 v[196:197], v[52:53], v[52:53]
    v_pk_mul_f32 v[198:199], v[54:55], v[54:55]
    v_pk_fma_f32 v[192:193], v[192:193], v[184:185], v[184:185] op_sel:[0,1,0] op_sel_hi:[1,1,0]
    v_pk_fma_f32 v[194:195], v[194:195], v[184:185], v[184:185] op_sel:[0,1,0] op_sel_hi:[1,1,0]
    v_pk_fma_f32 v[196:197], v[196:197], v[186:187], v[186:187] op_sel:[0,1,0] op_sel_hi:[1,1,0]
    v_pk_fma_f32 v[198:199], v[198:199], v[186:187], v[186:187] op_sel:[0,1,0] op_sel_hi:[1,1,0]
    v_pk_mul_f32 v[192:193], v[192:193], v[24:25]
    v_pk_mul_f32 v[194:195], v[194:195], v[26:27]
    v_pk_mul_f32 v[196:197], v[196:197], v[52:53]
    v_pk_mul_f32 v[198:199], v[198:199], v[54:55]
    v_exp_f32 v192, v192
    v_exp_f32 v193, v193
    v_exp_f32 v194, v194
    v_exp_f32 v195, v195
    v_exp_f32 v196, v196
    v_exp_f32 v197, v197
    v_exp_f32 v198, v198
    v_exp_f32 v199, v199
    v_pk_fma_f32 v[192:193], v[192:193], v[164:165], v[164:165] op_sel:[0,1,1] op_sel_hi:[1,1,1]
    v_pk_fma_f32 v[194:195], v[194:195], v[164:165], v[164:165] op_sel:[0,1,1] op_sel_hi:[1,1,1]
    v_pk_fma_f32 v[196:197], v[196:197], v[166:167], v[166:167] op_sel:[0,1,1] op_sel_hi:[1,1,1]
    v_pk_fma_f32 v[198:199], v[198:199], v[166:167], v[166:167] op_sel:[0,1,1] op_sel_hi:[1,1,1]
    v_rcp_f32 v192, v192
    v_rcp_f32 v193, v193
    v_rcp_f32 v194, v194
    v_rcp_f32 v195, v195
    v_rcp_f32 v196, v196
    v_rcp_f32 v197, v197
    v_rcp_f32 v198, v198
    v_rcp_f32 v199, v199
    v_pk_mul_f32 v[24:25], v[24:25], v[192:193]
    v_pk_mul_f32 v[26:27], v[26:27], v[194:195]
    v_pk_mul_f32 v[52:53], v[52:53], v[196:197]
    v_pk_mul_f32 v[54:55], v[54:55], v[198:199]
    v_cvt_pk_bf16_f32 v246, v24, v25
    v_cvt_pk_bf16_f32 v247, v26, v27
    s_add_u32 s36, s46, 0
    buffer_store_dwordx4 v[36:39], v2, s[16:19], s36 offen sc1
    v_cvt_pk_bf16_f32 v248, v52, v53
    v_cvt_pk_bf16_f32 v249, v54, v55
    s_add_u32 s36, s46, 229376
    buffer_store_dwordx4 v[64:67], v2, s[16:19], s36 offen sc1
    v_pk_fma_f32 v[80:81], v[168:169], v[136:137], v[80:81] op_sel_hi:[0,1,1] neg_lo:[1,0,0] neg_hi:[1,0,0]
    v_pk_fma_f32 v[82:83], v[168:169], v[138:139], v[82:83] op_sel_hi:[0,1,1] neg_lo:[1,0,0] neg_hi:[1,0,0]
    v_pk_fma_f32 v[108:109], v[170:171], v[136:137], v[108:109] op_sel_hi:[0,1,1] neg_lo:[1,0,0] neg_hi:[1,0,0]
    v_pk_fma_f32 v[110:111], v[170:171], v[138:139], v[110:111] op_sel_hi:[0,1,1] neg_lo:[1,0,0] neg_hi:[1,0,0]
    v_pk_mul_f32 v[192:193], v[80:81], v[80:81]
    v_pk_mul_f32 v[194:195], v[82:83], v[82:83]
    v_pk_mul_f32 v[196:197], v[108:109], v[108:109]
    v_pk_mul_f32 v[198:199], v[110:111], v[110:111]
    v_pk_fma_f32 v[192:193], v[192:193], v[188:189], v[188:189] op_sel:[0,1,0] op_sel_hi:[1,1,0]
    v_pk_fma_f32 v[194:195], v[194:195], v[188:189], v[188:189] op_sel:[0,1,0] op_sel_hi:[1,1,0]
    v_pk_fma_f32 v[196:197], v[196:197], v[190:191], v[190:191] op_sel:[0,1,0] op_sel_hi:[1,1,0]
    v_pk_fma_f32 v[198:199], v[198:199], v[190:191], v[190:191] op_sel:[0,1,0] op_sel_hi:[1,1,0]
    v_pk_mul_f32 v[192:193], v[192:193], v[80:81]
    v_pk_mul_f32 v[194:195], v[194:195], v[82:83]
    v_pk_mul_f32 v[196:197], v[196:197], v[108:109]
    v_pk_mul_f32 v[198:199], v[198:199], v[110:111]
    v_exp_f32 v192, v192
    v_exp_f32 v193, v193
    v_exp_f32 v194, v194
    v_exp_f32 v195, v195
    v_exp_f32 v196, v196
    v_exp_f32 v197, v197
    v_exp_f32 v198, v198
    v_exp_f32 v199, v199
    v_pk_fma_f32 v[192:193], v[192:193], v[168:169], v[168:169] op_sel:[0,1,1] op_sel_hi:[1,1,1]
    v_pk_fma_f32 v[194:195], v[194:195], v[168:169], v[168:169] op_sel:[0,1,1] op_sel_hi:[1,1,1]
    v_pk_fma_f32 v[196:197], v[196:197], v[170:171], v[170:171] op_sel:[0,1,1] op_sel_hi:[1,1,1]
    v_pk_fma_f32 v[198:199], v[198:199], v[170:171], v[170:171] op_sel:[0,1,1] op_sel_hi:[1,1,1]
    v_rcp_f32 v192, v192
    v_rcp_f32 v193, v193
    v_rcp_f32 v194, v194
    v_rcp_f32 v195, v195
    v_rcp_f32 v196, v196
    v_rcp_f32 v197, v197
    v_rcp_f32 v198, v198
    v_rcp_f32 v199, v199
    v_pk_mul_f32 v[80:81], v[80:81], v[192:193]
    v_pk_mul_f32 v[82:83], v[82:83], v[194:195]
    v_pk_mul_f32 v[108:109], v[108:109], v[196:197]
    v_pk_mul_f32 v[110:111], v[110:111], v[198:199]
    v_cvt_pk_bf16_f32 v250, v80, v81
    v_cvt_pk_bf16_f32 v251, v82, v83
    s_add_u32 s36, s46, 458752
    buffer_store_dwordx4 v[92:95], v2, s[16:19], s36 offen sc1
    v_cvt_pk_bf16_f32 v252, v108, v109
    v_cvt_pk_bf16_f32 v253, v110, v111
    s_add_u32 s36, s46, 688128
    buffer_store_dwordx4 v[120:123], v2, s[16:19], s36 offen sc1
    s_waitcnt lgkmcnt(0)
    s_add_u32 s45, s44, 512
    s_mov_b32 s44, s47
G3_e2:
    s_lshr_b32 s34, s30, 1
    s_and_b32 s35, s30, 1
    v_and_b32 v22, 15, v1
    v_lshrrev_b32 v23, 4, v1
    s_mul_i32 s37, s34, 4
    s_mul_i32 s38, s33, 8
    s_mul_i32 s36, s35, 4
    s_add_u32 s38, s38, s36
    s_lshr_b32 s36, s38, 1
    s_lshr_b32 s53, s36, 3
    s_lshl_b32 s53, s53, 14
    s_and_b32 s39, s36, 7
    s_lshl_b32 s39, s39, 10
    s_add_u32 s39, s39, s53
    s_lshl_b32 s36, s37, 16
    s_add_u32 s39, s39, s36
    s_mul_i32 s36, s34, 8192
    v_add_u32 v12, s36, v2
    v_lshrrev_b32 v6, 2, v1
    v_mul_u32_u24 v13, 256, v6
    v_and_b32 v7, 3, v1
    v_lshl_add_u32 v13, v7, 3, v13
    v_add_u32 v13, 49152, v13
    v_and_b32 v6, 7, v6
    s_mul_i32 s36, s35, 4
    s_add_u32 s36, s36, 3
    v_xor_b32 v7, s36, v6
    v_lshl_add_u32 v16, v7, 5, v13
    s_mul_i32 s36, s35, 4
    s_add_u32 s36, s36, 2
    v_xor_b32 v7, s36, v6
    v_lshl_add_u32 v15, v7, 5, v13
    s_mul_i32 s36, s35, 4
    s_add_u32 s36, s36, 1
    v_xor_b32 v7, s36, v6
    v_lshl_add_u32 v14, v7, 5, v13
    s_mul_i32 s36, s35, 4
    s_add_u32 s36, s36, 0
    v_xor_b32 v7, s36, v6
    v_lshl_add_u32 v13, v7, 5, v13
    s_mov_b32 s42, 0
    s_mov_b32 s43, 0
    s_mov_b32 s48, 0
    v_mov_b32 v17, v12
    v_mov_b32 v18, v13
    v_mov_b32 v19, v14
    v_mov_b32 v20, v15
    v_mov_b32 v21, v16
    s_waitcnt lgkmcnt(0)
    s_barrier
    ds_read_b128 v[24:27], v17 offset:0
    ds_read_b128 v[28:31], v17 offset:2048
    ds_read_b128 v[32:35], v17 offset:4096
    ds_read_b128 v[36:39], v17 offset:6144
    ds_read_b64_tr_b16 v[40:41], v18 offset:0
    ds_read_b64_tr_b16 v[42:43], v18 offset:4096
    ds_read_b64_tr_b16 v[44:45], v19 offset:0
    ds_read_b64_tr_b16 v[46:47], v19 offset:4096
    ds_read_b64_tr_b16 v[48:49], v20 offset:0
    ds_read_b64_tr_b16 v[50:51], v20 offset:4096
    ds_read_b64_tr_b16 v[52:53], v21 offset:0
    ds_read_b64_tr_b16 v[54:55], v21 offset:4096
    s_waitcnt lgkmcnt(0)
    v_mfma_f32_16x16x32_bf16 v[120:123], v[40:43], v[24:27], 0
    ds_read_b128 v[184:187], v17 offset:1024
    ds_read_b128 v[188:191], v17 offset:3072
    v_mfma_f32_16x16x32_bf16 v[136:139], v[40:43], v[28:31], 0
    ds_read_b128 v[192:195], v17 offset:5120
    v_mfma_f32_16x16x32_bf16 v[152:155], v[40:43], v[32:35], 0
    ds_read_b128 v[196:199], v17 offset:7168
    v_mfma_f32_16x16x32_bf16 v[168:171], v[40:43], v[36:39], 0
    s_add_u32 s36, s44, 0
    buffer_store_dwordx4 v[230:233], v2, s[16:19], s36 offen sc1
    v_mfma_f32_16x16x32_bf16 v[172:175], v[44:47], v[36:39], 0
    ds_read_b64_tr_b16 v[200:201], v18 offset:8192
    v_mfma_f32_16x16x32_bf16 v[156:159], v[44:47], v[32:35], 0
    ds_read_b64_tr_b16 v[202:203], v18 offset:12288
    v_mfma_f32_16x16x32_bf16 v[140:143], v[44:47], v[28:31], 0
    ds_read_b64_tr_b16 v[204:205], v19 offset:8192
    s_add_u32 s36, s45, 0
    buffer_store_dwordx2 v[246:247], v254, s[16:19], s36 offen sc1
    v_mfma_f32_16x16x32_bf16 v[124:127], v[44:47], v[24:27], 0
    ds_read_b64_tr_b16 v[206:207], v19 offset:12288
    v_mfma_f32_16x16x32_bf16 v[128:131], v[48:51], v[24:27], 0
    ds_read_b64_tr_b16 v[208:209], v20 offset:8192
    v_mfma_f32_16x16x32_bf16 v[144:147], v[48:51], v[28:31], 0
    ds_read_b64_tr_b16 v[210:211], v20 offset:12288
    v_mfma_f32_16x16x32_bf16 v[160:163], v[48:51], v[32:35], 0
    ds_read_b64_tr_b16 v[212:213], v21 offset:8192
    v_mfma_f32_16x16x32_bf16 v[176:179], v[48:51], v[36:39], 0
    ds_read_b64_tr_b16 v[214:215], v21 offset:12288
    s_add_u32 s42, s42, 16384
    s_cmp_eq_u32 s42, 49152
    s_cselect_b32 s42, 0, s42
    v_mfma_f32_16x16x32_bf16 v[180:183], v[52:55], v[36:39], 0
    s_add_u32 s48, s48, 16384
    s_cmp_eq_u32 s48, 98304
    s_cselect_b32 s48, 0, s48
    v_mfma_f32_16x16x32_bf16 v[164:167], v[52:55], v[32:35], 0
    v_add_u32 v17, s42, v12
    v_add_u32 v18, s48, v13
    v_add_u32 v19, s48, v14
    v_mfma_f32_16x16x32_bf16 v[148:151], v[52:55], v[28:31], 0
    v_add_u32 v20, s48, v15
    v_add_u32 v21, s48, v16
    v_mfma_f32_16x16x32_bf16 v[132:135], v[52:55], v[24:27], 0
    s_waitcnt lgkmcnt(0)
    s_barrier
    v_mfma_f32_16x16x32_bf16 v[120:123], v[200:203], v[184:187], v[120:123]
    ds_read_b128 v[24:27], v17 offset:0
    ds_read_b128 v[28:31], v17 offset:2048
    v_mfma_f32_16x16x32_bf16 v[136:139], v[200:203], v[188:191], v[136:139]
    ds_read_b128 v[32:35], v17 offset:4096
    v_mfma_f32_16x16x32_bf16 v[152:155], v[200:203], v[192:195], v[152:155]
    ds_read_b128 v[36:39], v17 offset:6144
    v_mfma_f32_16x16x32_bf16 v[168:171], v[200:203], v[196:199], v[168:171]
    s_add_u32 s36, s44, 229376
    buffer_store_dwordx4 v[234:237], v2, s[16:19], s36 offen sc1
    v_mfma_f32_16x16x32_bf16 v[172:175], v[204:207], v[196:199], v[172:175]
    ds_read_b64_tr_b16 v[40:41], v18 offset:0
    v_mfma_f32_16x16x32_bf16 v[156:159], v[204:207], v[192:195], v[156:159]
    ds_read_b64_tr_b16 v[42:43], v18 offset:4096
    v_mfma_f32_16x16x32_bf16 v[140:143], v[204:207], v[188:191], v[140:143]
    ds_read_b64_tr_b16 v[44:45], v19 offset:0
    s_add_u32 s36, s45, 229376
    buffer_store_dwordx2 v[248:249], v254, s[16:19], s36 offen sc1
    v_mfma_f32_16x16x32_bf16 v[124:127], v[204:207], v[184:187], v[124:127]
    ds_read_b64_tr_b16 v[46:47], v19 offset:4096
    v_mfma_f32_16x16x32_bf16 v[128:131], v[208:211], v[184:187], v[128:131]
    ds_read_b64_tr_b16 v[48:49], v20 offset:0
    v_mfma_f32_16x16x32_bf16 v[144:147], v[208:211], v[188:191], v[144:147]
    ds_read_b64_tr_b16 v[50:51], v20 offset:4096
    v_mfma_f32_16x16x32_bf16 v[160:163], v[208:211], v[192:195], v[160:163]
    ds_read_b64_tr_b16 v[52:53], v21 offset:0
    v_mfma_f32_16x16x32_bf16 v[176:179], v[208:211], v[196:199], v[176:179]
    ds_read_b64_tr_b16 v[54:55], v21 offset:4096
    s_add_u32 s43, s43, 1
    v_mfma_f32_16x16x32_bf16 v[180:183], v[212:215], v[196:199], v[180:183]
    s_cmp_lt_u32 s43, 27
    v_mfma_f32_16x16x32_bf16 v[164:167], v[212:215], v[192:195], v[164:167]
    v_mfma_f32_16x16x32_bf16 v[148:151], v[212:215], v[188:191], v[148:151]
    v_mfma_f32_16x16x32_bf16 v[132:135], v[212:215], v[184:187], v[132:135]
    s_waitcnt lgkmcnt(0)
    v_mfma_f32_16x16x32_bf16 v[120:123], v[40:43], v[24:27], v[120:123]
    ds_read_b128 v[184:187], v17 offset:1024
    ds_read_b128 v[188:191], v17 offset:3072
    v_mfma_f32_16x16x32_bf16 v[136:139], v[40:43], v[28:31], v[136:139]
    ds_read_b128 v[192:195], v17 offset:5120
    v_mfma_f32_16x16x32_bf16 v[152:155], v[40:43], v[32:35], v[152:155]
    ds_read_b128 v[196:199], v17 offset:7168
    v_mfma_f32_16x16x32_bf16 v[168:171], v[40:43], v[36:39], v[168:171]
    s_add_u32 s36, s44, 458752
    buffer_store_dwordx4 v[238:241], v2, s[16:19], s36 offen sc1
    v_mfma_f32_16x16x32_bf16 v[172:175], v[44:47], v[36:39], v[172:175]
    ds_read_b64_tr_b16 v[200:201], v18 offset:8192
    v_mfma_f32_16x16x32_bf16 v[156:159], v[44:47], v[32:35], v[156:159]
    ds_read_b64_tr_b16 v[202:203], v18 offset:12288
    v_mfma_f32_16x16x32_bf16 v[140:143], v[44:47], v[28:31], v[140:143]
    ds_read_b64_tr_b16 v[204:205], v19 offset:8192
    s_add_u32 s36, s45, 458752
    buffer_store_dwordx2 v[250:251], v254, s[16:19], s36 offen sc1
    v_mfma_f32_16x16x32_bf16 v[124:127], v[44:47], v[24:27], v[124:127]
    ds_read_b64_tr_b16 v[206:207], v19 offset:12288
    v_mfma_f32_16x16x32_bf16 v[128:131], v[48:51], v[24:27], v[128:131]
    ds_read_b64_tr_b16 v[208:209], v20 offset:8192
    v_mfma_f32_16x16x32_bf16 v[144:147], v[48:51], v[28:31], v[144:147]
    ds_read_b64_tr_b16 v[210:211], v20 offset:12288
    v_mfma_f32_16x16x32_bf16 v[160:163], v[48:51], v[32:35], v[160:163]
    ds_read_b64_tr_b16 v[212:213], v21 offset:8192
    v_mfma_f32_16x16x32_bf16 v[176:179], v[48:51], v[36:39], v[176:179]
    ds_read_b64_tr_b16 v[214:215], v21 offset:12288
    s_add_u32 s42, s42, 16384
    s_cmp_eq_u32 s42, 49152
    s_cselect_b32 s42, 0, s42
    v_mfma_f32_16x16x32_bf16 v[180:183], v[52:55], v[36:39], v[180:183]
    s_add_u32 s48, s48, 16384
    s_cmp_eq_u32 s48, 98304
    s_cselect_b32 s48, 0, s48
    v_mfma_f32_16x16x32_bf16 v[164:167], v[52:55], v[32:35], v[164:167]
    v_add_u32 v17, s42, v12
    v_add_u32 v18, s48, v13
    v_add_u32 v19, s48, v14
    v_mfma_f32_16x16x32_bf16 v[148:151], v[52:55], v[28:31], v[148:151]
    v_add_u32 v20, s48, v15
    v_add_u32 v21, s48, v16
    v_mfma_f32_16x16x32_bf16 v[132:135], v[52:55], v[24:27], v[132:135]
    s_waitcnt lgkmcnt(0)
    s_barrier
    v_mfma_f32_16x16x32_bf16 v[120:123], v[200:203], v[184:187], v[120:123]
    ds_read_b128 v[24:27], v17 offset:0
    ds_read_b128 v[28:31], v17 offset:2048
    v_mfma_f32_16x16x32_bf16 v[136:139], v[200:203], v[188:191], v[136:139]
    ds_read_b128 v[32:35], v17 offset:4096
    v_mfma_f32_16x16x32_bf16 v[152:155], v[200:203], v[192:195], v[152:155]
    ds_read_b128 v[36:39], v17 offset:6144
    v_mfma_f32_16x16x32_bf16 v[168:171], v[200:203], v[196:199], v[168:171]
    s_add_u32 s36, s44, 688128
    buffer_store_dwordx4 v[242:245], v2, s[16:19], s36 offen sc1
    v_mfma_f32_16x16x32_bf16 v[172:175], v[204:207], v[196:199], v[172:175]
    ds_read_b64_tr_b16 v[40:41], v18 offset:0
    v_mfma_f32_16x16x32_bf16 v[156:159], v[204:207], v[192:195], v[156:159]
    ds_read_b64_tr_b16 v[42:43], v18 offset:4096
    v_mfma_f32_16x16x32_bf16 v[140:143], v[204:207], v[188:191], v[140:143]
    ds_read_b64_tr_b16 v[44:45], v19 offset:0
    s_add_u32 s36, s45, 688128
    buffer_store_dwordx2 v[252:253], v254, s[16:19], s36 offen sc1
    v_mfma_f32_16x16x32_bf16 v[124:127], v[204:207], v[184:187], v[124:127]
    ds_read_b64_tr_b16 v[46:47], v19 offset:4096
    v_mfma_f32_16x16x32_bf16 v[128:131], v[208:211], v[184:187], v[128:131]
    ds_read_b64_tr_b16 v[48:49], v20 offset:0
    v_mfma_f32_16x16x32_bf16 v[144:147], v[208:211], v[188:191], v[144:147]
    ds_read_b64_tr_b16 v[50:51], v20 offset:4096
    v_mfma_f32_16x16x32_bf16 v[160:163], v[208:211], v[192:195], v[160:163]
    ds_read_b64_tr_b16 v[52:53], v21 offset:0
    v_mfma_f32_16x16x32_bf16 v[176:179], v[208:211], v[196:199], v[176:179]
    ds_read_b64_tr_b16 v[54:55], v21 offset:4096
    s_add_u32 s43, s43, 1
    v_mfma_f32_16x16x32_bf16 v[180:183], v[212:215], v[196:199], v[180:183]
    s_cmp_lt_u32 s43, 27
    v_mfma_f32_16x16x32_bf16 v[164:167], v[212:215], v[192:195], v[164:167]
    v_mfma_f32_16x16x32_bf16 v[148:151], v[212:215], v[188:191], v[148:151]
    v_mfma_f32_16x16x32_bf16 v[132:135], v[212:215], v[184:187], v[132:135]
    s_lshr_b32 s53, s30, 1
    s_lshl1_add_u32 s53, s31, s53
    s_lshl_b32 s53, s53, 7
    s_add_u32 s53, s53, s55
    s_add_u32 s53, s53, 0x1200
    v_mov_b32 v8, 1
    v_mov_b32 v9, 0
    s_mov_b64 exec, 1
    s_waitcnt vmcnt(8)
    buffer_atomic_add v8, v9, s[56:59], s53 offen sc1
    s_mov_b64 exec, -1
mm_27:
    s_waitcnt lgkmcnt(0)
    v_mfma_f32_16x16x32_bf16 v[120:123], v[40:43], v[24:27], v[120:123]
    ds_read_b128 v[184:187], v17 offset:1024
    v_mfma_f32_16x16x32_bf16 v[136:139], v[40:43], v[28:31], v[136:139]
    ds_read_b128 v[188:191], v17 offset:3072
    v_mfma_f32_16x16x32_bf16 v[152:155], v[40:43], v[32:35], v[152:155]
    ds_read_b128 v[192:195], v17 offset:5120
    v_mfma_f32_16x16x32_bf16 v[168:171], v[40:43], v[36:39], v[168:171]
    ds_read_b128 v[196:199], v17 offset:7168
    v_mfma_f32_16x16x32_bf16 v[172:175], v[44:47], v[36:39], v[172:175]
    ds_read_b64_tr_b16 v[200:201], v18 offset:8192
    v_mfma_f32_16x16x32_bf16 v[156:159], v[44:47], v[32:35], v[156:159]
    ds_read_b64_tr_b16 v[202:203], v18 offset:12288
    v_mfma_f32_16x16x32_bf16 v[140:143], v[44:47], v[28:31], v[140:143]
    ds_read_b64_tr_b16 v[204:205], v19 offset:8192
    v_mfma_f32_16x16x32_bf16 v[124:127], v[44:47], v[24:27], v[124:127]
    ds_read_b64_tr_b16 v[206:207], v19 offset:12288
    v_mfma_f32_16x16x32_bf16 v[128:131], v[48:51], v[24:27], v[128:131]
    ds_read_b64_tr_b16 v[208:209], v20 offset:8192
    v_mfma_f32_16x16x32_bf16 v[144:147], v[48:51], v[28:31], v[144:147]
    ds_read_b64_tr_b16 v[210:211], v20 offset:12288
    v_mfma_f32_16x16x32_bf16 v[160:163], v[48:51], v[32:35], v[160:163]
    ds_read_b64_tr_b16 v[212:213], v21 offset:8192
    v_mfma_f32_16x16x32_bf16 v[176:179], v[48:51], v[36:39], v[176:179]
    ds_read_b64_tr_b16 v[214:215], v21 offset:12288
    s_add_u32 s42, s42, 16384
    s_cmp_eq_u32 s42, 49152
    s_cselect_b32 s42, 0, s42
    v_mfma_f32_16x16x32_bf16 v[180:183], v[52:55], v[36:39], v[180:183]
    s_add_u32 s48, s48, 16384
    s_cmp_eq_u32 s48, 98304
    s_cselect_b32 s48, 0, s48
    v_mfma_f32_16x16x32_bf16 v[164:167], v[52:55], v[32:35], v[164:167]
    v_add_u32 v17, s42, v12
    v_add_u32 v18, s48, v13
    v_add_u32 v19, s48, v14
    v_mfma_f32_16x16x32_bf16 v[148:151], v[52:55], v[28:31], v[148:151]
    v_add_u32 v20, s48, v15
    v_add_u32 v21, s48, v16
    v_mfma_f32_16x16x32_bf16 v[132:135], v[52:55], v[24:27], v[132:135]
    s_waitcnt lgkmcnt(0)
    s_barrier
    v_mfma_f32_16x16x32_bf16 v[120:123], v[200:203], v[184:187], v[120:123]
    ds_read_b128 v[24:27], v17 offset:0
    v_mfma_f32_16x16x32_bf16 v[136:139], v[200:203], v[188:191], v[136:139]
    ds_read_b128 v[28:31], v17 offset:2048
    v_mfma_f32_16x16x32_bf16 v[152:155], v[200:203], v[192:195], v[152:155]
    ds_read_b128 v[32:35], v17 offset:4096
    v_mfma_f32_16x16x32_bf16 v[168:171], v[200:203], v[196:199], v[168:171]
    ds_read_b128 v[36:39], v17 offset:6144
    v_mfma_f32_16x16x32_bf16 v[172:175], v[204:207], v[196:199], v[172:175]
    ds_read_b64_tr_b16 v[40:41], v18 offset:0
    v_mfma_f32_16x16x32_bf16 v[156:159], v[204:207], v[192:195], v[156:159]
    ds_read_b64_tr_b16 v[42:43], v18 offset:4096
    v_mfma_f32_16x16x32_bf16 v[140:143], v[204:207], v[188:191], v[140:143]
    ds_read_b64_tr_b16 v[44:45], v19 offset:0
    v_mfma_f32_16x16x32_bf16 v[124:127], v[204:207], v[184:187], v[124:127]
    ds_read_b64_tr_b16 v[46:47], v19 offset:4096
    v_mfma_f32_16x16x32_bf16 v[128:131], v[208:211], v[184:187], v[128:131]
    ds_read_b64_tr_b16 v[48:49], v20 offset:0
    v_mfma_f32_16x16x32_bf16 v[144:147], v[208:211], v[188:191], v[144:147]
    ds_read_b64_tr_b16 v[50:51], v20 offset:4096
    v_mfma_f32_16x16x32_bf16 v[160:163], v[208:211], v[192:195], v[160:163]
    ds_read_b64_tr_b16 v[52:53], v21 offset:0
    v_mfma_f32_16x16x32_bf16 v[176:179], v[208:211], v[196:199], v[176:179]
    ds_read_b64_tr_b16 v[54:55], v21 offset:4096
    s_add_u32 s43, s43, 1
    v_mfma_f32_16x16x32_bf16 v[180:183], v[212:215], v[196:199], v[180:183]
    s_cmp_lt_u32 s43, 4
    v_mfma_f32_16x16x32_bf16 v[164:167], v[212:215], v[192:195], v[164:167]
    v_mfma_f32_16x16x32_bf16 v[148:151], v[212:215], v[188:191], v[148:151]
    v_mfma_f32_16x16x32_bf16 v[132:135], v[212:215], v[184:187], v[132:135]
    s_cbranch_scc1 mm_27
    s_lshr_b32 s53, s30, 1
    s_lshl1_add_u32 s53, s31, s53
    s_lshl_b32 s53, s53, 7
    s_add_u32 s53, s53, s55
    s_add_u32 s53, s53, 0x1400
    v_mov_b32 v8, 1
    v_mov_b32 v9, 0
    s_mov_b64 exec, 1
    s_waitcnt vmcnt(0)
    buffer_atomic_add v8, v9, s[56:59], s53 offen sc1
    s_mov_b64 exec, -1
mm_28:
    s_waitcnt lgkmcnt(0)
    v_mfma_f32_16x16x32_bf16 v[120:123], v[40:43], v[24:27], v[120:123]
    ds_read_b128 v[184:187], v17 offset:1024
    v_mfma_f32_16x16x32_bf16 v[136:139], v[40:43], v[28:31], v[136:139]
    ds_read_b128 v[188:191], v17 offset:3072
    v_mfma_f32_16x16x32_bf16 v[152:155], v[40:43], v[32:35], v[152:155]
    ds_read_b128 v[192:195], v17 offset:5120
    v_mfma_f32_16x16x32_bf16 v[168:171], v[40:43], v[36:39], v[168:171]
    ds_read_b128 v[196:199], v17 offset:7168
    v_mfma_f32_16x16x32_bf16 v[172:175], v[44:47], v[36:39], v[172:175]
    ds_read_b64_tr_b16 v[200:201], v18 offset:8192
    v_mfma_f32_16x16x32_bf16 v[156:159], v[44:47], v[32:35], v[156:159]
    ds_read_b64_tr_b16 v[202:203], v18 offset:12288
    v_mfma_f32_16x16x32_bf16 v[140:143], v[44:47], v[28:31], v[140:143]
    ds_read_b64_tr_b16 v[204:205], v19 offset:8192
    v_mfma_f32_16x16x32_bf16 v[124:127], v[44:47], v[24:27], v[124:127]
    ds_read_b64_tr_b16 v[206:207], v19 offset:12288
    v_mfma_f32_16x16x32_bf16 v[128:131], v[48:51], v[24:27], v[128:131]
    ds_read_b64_tr_b16 v[208:209], v20 offset:8192
    v_mfma_f32_16x16x32_bf16 v[144:147], v[48:51], v[28:31], v[144:147]
    ds_read_b64_tr_b16 v[210:211], v20 offset:12288
    v_mfma_f32_16x16x32_bf16 v[160:163], v[48:51], v[32:35], v[160:163]
    ds_read_b64_tr_b16 v[212:213], v21 offset:8192
    v_mfma_f32_16x16x32_bf16 v[176:179], v[48:51], v[36:39], v[176:179]
    ds_read_b64_tr_b16 v[214:215], v21 offset:12288
    s_add_u32 s42, s42, 16384
    s_cmp_eq_u32 s42, 49152
    s_cselect_b32 s42, 0, s42
    v_mfma_f32_16x16x32_bf16 v[180:183], v[52:55], v[36:39], v[180:183]
    s_add_u32 s48, s48, 16384
    s_cmp_eq_u32 s48, 98304
    s_cselect_b32 s48, 0, s48
    v_mfma_f32_16x16x32_bf16 v[164:167], v[52:55], v[32:35], v[164:167]
    v_add_u32 v17, s42, v12
    v_add_u32 v18, s48, v13
    v_add_u32 v19, s48, v14
    v_mfma_f32_16x16x32_bf16 v[148:151], v[52:55], v[28:31], v[148:151]
    v_add_u32 v20, s48, v15
    v_add_u32 v21, s48, v16
    v_mfma_f32_16x16x32_bf16 v[132:135], v[52:55], v[24:27], v[132:135]
    s_waitcnt lgkmcnt(0)
    s_barrier
    v_mfma_f32_16x16x32_bf16 v[120:123], v[200:203], v[184:187], v[120:123]
    ds_read_b128 v[24:27], v17 offset:0
    v_mfma_f32_16x16x32_bf16 v[136:139], v[200:203], v[188:191], v[136:139]
    ds_read_b128 v[28:31], v17 offset:2048
    v_mfma_f32_16x16x32_bf16 v[152:155], v[200:203], v[192:195], v[152:155]
    ds_read_b128 v[32:35], v17 offset:4096
    v_mfma_f32_16x16x32_bf16 v[168:171], v[200:203], v[196:199], v[168:171]
    ds_read_b128 v[36:39], v17 offset:6144
    v_mfma_f32_16x16x32_bf16 v[172:175], v[204:207], v[196:199], v[172:175]
    ds_read_b64_tr_b16 v[40:41], v18 offset:0
    v_mfma_f32_16x16x32_bf16 v[156:159], v[204:207], v[192:195], v[156:159]
    ds_read_b64_tr_b16 v[42:43], v18 offset:4096
    v_mfma_f32_16x16x32_bf16 v[140:143], v[204:207], v[188:191], v[140:143]
    ds_read_b64_tr_b16 v[44:45], v19 offset:0
    v_mfma_f32_16x16x32_bf16 v[124:127], v[204:207], v[184:187], v[124:127]
    ds_read_b64_tr_b16 v[46:47], v19 offset:4096
    v_mfma_f32_16x16x32_bf16 v[128:131], v[208:211], v[184:187], v[128:131]
    ds_read_b64_tr_b16 v[48:49], v20 offset:0
    v_mfma_f32_16x16x32_bf16 v[144:147], v[208:211], v[188:191], v[144:147]
    ds_read_b64_tr_b16 v[50:51], v20 offset:4096
    v_mfma_f32_16x16x32_bf16 v[160:163], v[208:211], v[192:195], v[160:163]
    ds_read_b64_tr_b16 v[52:53], v21 offset:0
    v_mfma_f32_16x16x32_bf16 v[176:179], v[208:211], v[196:199], v[176:179]
    ds_read_b64_tr_b16 v[54:55], v21 offset:4096
    s_add_u32 s43, s43, 1
    v_mfma_f32_16x16x32_bf16 v[180:183], v[212:215], v[196:199], v[180:183]
    s_cmp_lt_u32 s43, 27
    v_mfma_f32_16x16x32_bf16 v[164:167], v[212:215], v[192:195], v[164:167]
    v_mfma_f32_16x16x32_bf16 v[148:151], v[212:215], v[188:191], v[148:151]
    v_mfma_f32_16x16x32_bf16 v[132:135], v[212:215], v[184:187], v[132:135]
    s_cbranch_scc1 mm_28
    s_waitcnt lgkmcnt(0)
    s_cmp_eq_u32 s60, 1
    s_cbranch_scc1 G4_last
    v_mfma_f32_16x16x32_bf16 v[120:123], v[40:43], v[24:27], v[120:123]
    ds_read_b128 v[184:187], v17 offset:1024
    ds_read_b128 v[188:191], v17 offset:3072
    ds_read_b128 v[192:195], v17 offset:5120
    ds_read_b128 v[196:199], v17 offset:7168
    ds_read_b64_tr_b16 v[200:201], v18 offset:8192
    ds_read_b64_tr_b16 v[202:203], v18 offset:12288
    ds_read_b64_tr_b16 v[204:205], v19 offset:8192
    v_mfma_f32_16x16x32_bf16 v[136:139], v[40:43], v[28:31], v[136:139]
    ds_read_b64_tr_b16 v[206:207], v19 offset:12288
    ds_read_b64_tr_b16 v[208:209], v20 offset:8192
    ds_read_b64_tr_b16 v[210:211], v20 offset:12288
    ds_read_b64_tr_b16 v[212:213], v21 offset:8192
    ds_read_b64_tr_b16 v[214:215], v21 offset:12288
    v_and_b32 v81, 7, v0
    v_mfma_f32_16x16x32_bf16 v[152:155], v[40:43], v[32:35], v[152:155]
    v_lshrrev_b32 v84, 6, v0
    v_lshlrev_b32 v84, 4, v84
    v_bfe_u32 v85, v0, 3, 3
    v_add_u32 v84, v84, v85
    s_lshr_b32 s78, s29, 1
    s_lshl_b32 s78, s78, 16
    v_mfma_f32_16x16x32_bf16 v[168:171], v[40:43], v[36:39], v[168:171]
    s_and_b32 s79, s29, 1
    s_lshl_b32 s79, s79, 7
    s_add_u32 s78, s78, s79
    s_lshr_b32 s79, s30, 1
    s_lshl_b32 s79, s79, 13
    s_add_u32 s78, s78, s79
    v_mfma_f32_16x16x32_bf16 v[172:175], v[44:47], v[36:39], v[172:175]
    v_lshlrev_b32 v78, 8, v84
    v_lshl_add_u32 v78, v81, 4, v78
    v_add_u32 v78, s78, v78
    s_lshl_b32 s78, s28, 7
    s_lshl_b32 s79, s29, 3
    s_add_u32 s78, s78, s79
    v_mfma_f32_16x16x32_bf16 v[156:159], v[44:47], v[32:35], v[156:159]
    v_add_u32 v79, s78, v81
    v_lshlrev_b32 v80, 11, v79
    v_and_b32 v85, 3, v79
    v_lshrrev_b32 v82, 2, v79
    v_lshlrev_b32 v82, 14, v82
    v_lshl_add_u32 v82, v85, 11, v82
    v_mfma_f32_16x16x32_bf16 v[140:143], v[44:47], v[28:31], v[140:143]
    v_lshl_add_u32 v82, v84, 4, v82
    v_lshrrev_b32 v85, 2, v84
    v_lshlrev_b32 v85, 3, v85
    v_and_b32 v84, 3, v84
    v_add_u32 v84, v84, v85
    v_lshl_add_u32 v80, v84, 3, v80
    v_mfma_f32_16x16x32_bf16 v[124:127], v[44:47], v[24:27], v[124:127]
    v_lshlrev_b32 v79, 3, v79
    v_lshl_add_u32 v79, v84, 14, v79
    s_lshl_b32 s86, s60, 24
    s_lshl_b32 s87, s94, 13
    s_add_u32 s86, s86, s87
    s_add_u32 s86, s86, 167772160
    v_mfma_f32_16x16x32_bf16 v[128:131], v[48:51], v[24:27], v[128:131]
    s_add_u32 s84, s4, s86
    s_addc_u32 s85, s5, 0
    s_mov_b32 s86, 8380416
    s_mov_b32 s87, 0x20000
    s_add_u32 s88, s62, 0x480000
    s_addc_u32 s89, s63, 0
    v_mfma_f32_16x16x32_bf16 v[144:147], v[48:51], v[28:31], v[144:147]
    s_mov_b32 s90, 0x7e000
    s_mov_b32 s91, 0x20000
    buffer_load_dwordx4 v[86:89], v82, s[84:87], 0 offen offset:0 sc1
    buffer_load_dwordx4 v[94:97], v78, s[88:91], 0 offen offset:0 sc1
    buffer_load_dwordx4 v[90:93], v82, s[84:87], 0 offen offset:128 sc1
    buffer_load_dwordx4 v[98:101], v78, s[88:91], 0 offen offset:2048 sc1
    v_mfma_f32_16x16x32_bf16 v[160:163], v[48:51], v[32:35], v[160:163]
    s_add_u32 s80, s4, 0x1c00000
    s_addc_u32 s81, s5, 0
    s_mov_b32 s82, 0x400000
    s_mov_b32 s83, 0x20000
    s_mov_b32 s78, 0
    buffer_load_dwordx2 v[110:111], v79, s[80:83], s78 offen sc1
    v_mfma_f32_16x16x32_bf16 v[176:179], v[48:51], v[36:39], v[176:179]
    s_mov_b32 s78, 65536
    buffer_load_dwordx2 v[112:113], v79, s[80:83], s78 offen sc1
    s_mov_b32 s78, 262144
    buffer_load_dwordx2 v[114:115], v79, s[80:83], s78 offen sc1
    s_mov_b32 s78, 327680
    buffer_load_dwordx2 v[116:117], v79, s[80:83], s78 offen sc1
    v_mfma_f32_16x16x32_bf16 v[180:183], v[52:55], v[36:39], v[180:183]
    v_mfma_f32_16x16x32_bf16 v[164:167], v[52:55], v[32:35], v[164:167]
    v_mfma_f32_16x16x32_bf16 v[148:151], v[52:55], v[28:31], v[148:151]
    v_mfma_f32_16x16x32_bf16 v[132:135], v[52:55], v[24:27], v[132:135]
    s_waitcnt lgkmcnt(0)
    v_mfma_f32_16x16x32_bf16 v[120:123], v[200:203], v[184:187], v[120:123]
    s_lshr_b32 s40, s28, 3
    s_and_b32 s36, s28, 3
    v_mfma_f32_16x16x32_bf16 v[136:139], v[200:203], v[188:191], v[136:139]
    s_lshl2_add_u32 s36, s40, s36
    v_mfma_f32_16x16x32_bf16 v[152:155], v[200:203], v[192:195], v[152:155]
    s_lshl_b32 s36, s36, 19
    s_xor_b32 s40, s40, s94
    v_mfma_f32_16x16x32_bf16 v[168:171], v[200:203], v[196:199], v[168:171]
    s_lshl_b32 s40, s40, 2
    v_mfma_f32_16x16x32_bf16 v[172:175], v[204:207], v[196:199], v[172:175]
    s_xor_b32 s40, s40, s28
    s_and_b32 s40, s40, 4
    v_mfma_f32_16x16x32_bf16 v[156:159], v[204:207], v[192:195], v[156:159]
    s_lshl_b32 s40, s40, 11
    v_mfma_f32_16x16x32_bf16 v[140:143], v[204:207], v[188:191], v[140:143]
    s_add_u32 s36, s36, s40
    s_add_u32 s36, s36, 25165824
    v_mfma_f32_16x16x32_bf16 v[124:127], v[204:207], v[184:187], v[124:127]
    s_add_u32 s40, s55, 2359296
    v_mfma_f32_16x16x32_bf16 v[128:131], v[208:211], v[184:187], v[128:131]
    s_cmp_eq_u32 s31, 0
    s_cselect_b32 s36, s40, s36
    s_mov_b32 s40, 0xffff0000
    v_mfma_f32_16x16x32_bf16 v[144:147], v[208:211], v[188:191], v[144:147]
    v_mov_b32 v56, 0x10000
    v_mfma_f32_16x16x32_bf16 v[160:163], v[208:211], v[192:195], v[160:163]
    s_add_u32 s16, s4, s36
    s_addc_u32 s17, s5, 0
    s_mov_b32 s18, 516096
    v_mfma_f32_16x16x32_bf16 v[176:179], v[208:211], v[196:199], v[176:179]
    s_mov_b32 s19, 0x20000
    v_mfma_f32_16x16x32_bf16 v[180:183], v[212:215], v[196:199], v[180:183]
    v_mfma_f32_16x16x32_bf16 v[164:167], v[212:215], v[192:195], v[164:167]
    v_mfma_f32_16x16x32_bf16 v[148:151], v[212:215], v[188:191], v[148:151]
    v_mfma_f32_16x16x32_bf16 v[132:135], v[212:215], v[184:187], v[132:135]
    s_add_u32 s36, s39, 0
    v_and_or_b32 v120, v120, s40, v56
    v_and_or_b32 v122, v122, s40, v56
    v_and_or_b32 v124, v124, s40, v56
    v_and_or_b32 v126, v126, s40, v56
    v_cvt_pk_bf16_f32 v120, v120, v121
    v_cvt_pk_bf16_f32 v121, v122, v123
    v_cvt_pk_bf16_f32 v122, v124, v125
    v_cvt_pk_bf16_f32 v123, v126, v127
    buffer_store_dwordx4 v[120:123], v2, s[16:19], s36 offen offset:0 sc1
    v_and_or_b32 v128, v128, s40, v56
    v_and_or_b32 v130, v130, s40, v56
    v_and_or_b32 v132, v132, s40, v56
    v_and_or_b32 v134, v134, s40, v56
    v_cvt_pk_bf16_f32 v128, v128, v129
    v_cvt_pk_bf16_f32 v129, v130, v131
    v_cvt_pk_bf16_f32 v130, v132, v133
    v_cvt_pk_bf16_f32 v131, v134, v135
    buffer_store_dwordx4 v[128:131], v2, s[16:19], s36 offen offset:1024 sc1
    s_add_u32 s36, s39, 65536
    v_and_or_b32 v136, v136, s40, v56
    v_and_or_b32 v138, v138, s40, v56
    v_and_or_b32 v140, v140, s40, v56
    v_and_or_b32 v142, v142, s40, v56
    v_cvt_pk_bf16_f32 v136, v136, v137
    v_cvt_pk_bf16_f32 v137, v138, v139
    v_cvt_pk_bf16_f32 v138, v140, v141
    v_cvt_pk_bf16_f32 v139, v142, v143
    buffer_store_dwordx4 v[136:139], v2, s[16:19], s36 offen offset:0 sc1
    v_and_or_b32 v144, v144, s40, v56
    v_and_or_b32 v146, v146, s40, v56
    v_and_or_b32 v148, v148, s40, v56
    v_and_or_b32 v150, v150, s40, v56
    v_cvt_pk_bf16_f32 v144, v144, v145
    v_cvt_pk_bf16_f32 v145, v146, v147
    v_cvt_pk_bf16_f32 v146, v148, v149
    v_cvt_pk_bf16_f32 v147, v150, v151
    buffer_store_dwordx4 v[144:147], v2, s[16:19], s36 offen offset:1024 sc1
    s_add_u32 s36, s39, 131072
    v_and_or_b32 v152, v152, s40, v56
    v_and_or_b32 v154, v154, s40, v56
    v_and_or_b32 v156, v156, s40, v56
    v_and_or_b32 v158, v158, s40, v56
    v_cvt_pk_bf16_f32 v152, v152, v153
    v_cvt_pk_bf16_f32 v153, v154, v155
    v_cvt_pk_bf16_f32 v154, v156, v157
    v_cvt_pk_bf16_f32 v155, v158, v159
    buffer_store_dwordx4 v[152:155], v2, s[16:19], s36 offen offset:0 sc1
    v_and_or_b32 v160, v160, s40, v56
    v_and_or_b32 v162, v162, s40, v56
    v_and_or_b32 v164, v164, s40, v56
    v_and_or_b32 v166, v166, s40, v56
    v_cvt_pk_bf16_f32 v160, v160, v161
    v_cvt_pk_bf16_f32 v161, v162, v163
    v_cvt_pk_bf16_f32 v162, v164, v165
    v_cvt_pk_bf16_f32 v163, v166, v167
    buffer_store_dwordx4 v[160:163], v2, s[16:19], s36 offen offset:1024 sc1
    s_add_u32 s36, s39, 196608
    v_and_or_b32 v168, v168, s40, v56
    v_and_or_b32 v170, v170, s40, v56
    v_and_or_b32 v172, v172, s40, v56
    v_and_or_b32 v174, v174, s40, v56
    v_cvt_pk_bf16_f32 v168, v168, v169
    v_cvt_pk_bf16_f32 v169, v170, v171
    v_cvt_pk_bf16_f32 v170, v172, v173
    v_cvt_pk_bf16_f32 v171, v174, v175
    buffer_store_dwordx4 v[168:171], v2, s[16:19], s36 offen offset:0 sc1
    v_and_or_b32 v176, v176, s40, v56
    v_and_or_b32 v178, v178, s40, v56
    v_and_or_b32 v180, v180, s40, v56
    v_and_or_b32 v182, v182, s40, v56
    v_cvt_pk_bf16_f32 v176, v176, v177
    v_cvt_pk_bf16_f32 v177, v178, v179
    v_cvt_pk_bf16_f32 v178, v180, v181
    v_cvt_pk_bf16_f32 v179, v182, v183
    buffer_store_dwordx4 v[176:179], v2, s[16:19], s36 offen offset:1024 sc1
    s_waitcnt vmcnt(8)
    s_barrier
    s_branch NEXT
G4_last:
    v_mfma_f32_16x16x32_bf16 v[120:123], v[40:43], v[24:27], v[120:123]
    ds_read_b128 v[184:187], v17 offset:1024
    ds_read_b128 v[188:191], v17 offset:3072
    ds_read_b128 v[192:195], v17 offset:5120
    ds_read_b128 v[196:199], v17 offset:7168
    ds_read_b64_tr_b16 v[200:201], v18 offset:8192
    v_mfma_f32_16x16x32_bf16 v[136:139], v[40:43], v[28:31], v[136:139]
    ds_read_b64_tr_b16 v[202:203], v18 offset:12288
    ds_read_b64_tr_b16 v[204:205], v19 offset:8192
    ds_read_b64_tr_b16 v[206:207], v19 offset:12288
    ds_read_b64_tr_b16 v[208:209], v20 offset:8192
    v_mfma_f32_16x16x32_bf16 v[152:155], v[40:43], v[32:35], v[152:155]
    ds_read_b64_tr_b16 v[210:211], v20 offset:12288
    ds_read_b64_tr_b16 v[212:213], v21 offset:8192
    ds_read_b64_tr_b16 v[214:215], v21 offset:12288
    s_load_dwordx2 s[6:7], s[0:1], 88
    s_lshl_b32 s86, s60, 24
    v_mfma_f32_16x16x32_bf16 v[168:171], v[40:43], v[36:39], v[168:171]
    s_lshl_b32 s87, s94, 13
    s_add_u32 s86, s86, s87
    s_add_u32 s86, s86, 167772160
    s_add_u32 s84, s4, s86
    v_mfma_f32_16x16x32_bf16 v[172:175], v[44:47], v[36:39], v[172:175]
    s_addc_u32 s85, s5, 0
    s_mov_b32 s86, 8380416
    s_mov_b32 s87, 0x20000
    s_add_u32 s88, s62, 0x480000
    s_addc_u32 s89, s63, 0
    v_mfma_f32_16x16x32_bf16 v[156:159], v[44:47], v[32:35], v[156:159]
    s_mov_b32 s90, 0x7e000
    s_mov_b32 s91, 0x20000
    s_lshl_b32 s40, s31, 17
    s_add_u32 s40, s40, s39
    v_mfma_f32_16x16x32_bf16 v[140:143], v[44:47], v[28:31], v[140:143]
    s_xor_b32 s41, s31, 1
    s_lshl_b32 s41, s41, 17
    s_add_u32 s41, s41, s39
    v_and_b32 v60, 3, v22
    v_mfma_f32_16x16x32_bf16 v[124:127], v[44:47], v[24:27], v[124:127]
    v_lshrrev_b32 v62, 2, v22
    v_lshlrev_b32 v62, 14, v62
    v_lshl_add_u32 v62, v60, 11, v62
    v_lshl_add_u32 v62, v23, 4, v62
    s_lshl_b32 s46, s28, 3
    v_mfma_f32_16x16x32_bf16 v[128:131], v[48:51], v[24:27], v[128:131]
    s_add_u32 s46, s46, s37
    s_lshl_b32 s47, s31, 1
    s_add_u32 s46, s46, s47
    s_lshl_b32 s49, s46, 16
    v_mfma_f32_16x16x32_bf16 v[144:147], v[48:51], v[28:31], v[144:147]
    s_lshl_b32 s47, s38, 5
    s_add_u32 s49, s49, s47
    s_add_u32 s36, s40, 0
    buffer_load_dwordx4 v[80:83], v62, s[84:87], s49 offen offset:0 sc1
    buffer_load_dwordx4 v[84:87], v2, s[88:91], s36 offen offset:0 sc1
    v_mfma_f32_16x16x32_bf16 v[160:163], v[48:51], v[32:35], v[160:163]
    buffer_load_dwordx4 v[88:91], v62, s[84:87], s49 offen offset:64 sc1
    buffer_load_dwordx4 v[92:95], v2, s[88:91], s36 offen offset:1024 sc1
    s_add_u32 s36, s40, 65536
    s_add_u32 s49, s49, 65536
    v_mfma_f32_16x16x32_bf16 v[176:179], v[48:51], v[36:39], v[176:179]
    buffer_load_dwordx4 v[96:99], v62, s[84:87], s49 offen offset:0 sc1
    buffer_load_dwordx4 v[100:103], v2, s[88:91], s36 offen offset:0 sc1
    buffer_load_dwordx4 v[104:107], v62, s[84:87], s49 offen offset:64 sc1
    buffer_load_dwordx4 v[108:111], v2, s[88:91], s36 offen offset:1024 sc1
    v_mfma_f32_16x16x32_bf16 v[180:183], v[52:55], v[36:39], v[180:183]
    v_mfma_f32_16x16x32_bf16 v[164:167], v[52:55], v[32:35], v[164:167]
    v_mfma_f32_16x16x32_bf16 v[148:151], v[52:55], v[28:31], v[148:151]
    v_mfma_f32_16x16x32_bf16 v[132:135], v[52:55], v[24:27], v[132:135]
    s_waitcnt lgkmcnt(0)
    v_mfma_f32_16x16x32_bf16 v[120:123], v[200:203], v[184:187], v[120:123]
    s_add_u32 s16, s62, 0x400000
    s_addc_u32 s17, s63, 0
    v_mfma_f32_16x16x32_bf16 v[136:139], v[200:203], v[188:191], v[136:139]
    s_mov_b32 s18, 0x7e000
    s_mov_b32 s19, 0x20000
    v_mfma_f32_16x16x32_bf16 v[152:155], v[200:203], v[192:195], v[152:155]
    s_mov_b32 s45, 0xffff0000
    v_mov_b32 v56, 0x10000
    v_mfma_f32_16x16x32_bf16 v[168:171], v[200:203], v[196:199], v[168:171]
    s_mov_b32 s20, s6
    s_mov_b32 s21, s7
    v_mfma_f32_16x16x32_bf16 v[172:175], v[204:207], v[196:199], v[172:175]
    s_mov_b32 s22, 0x400000
    s_mov_b32 s23, 0x20000
    v_mfma_f32_16x16x32_bf16 v[156:159], v[204:207], v[192:195], v[156:159]
    s_add_u32 s44, s40, 65536
    s_lshl_b32 s46, s46, 15
    v_mfma_f32_16x16x32_bf16 v[140:143], v[204:207], v[188:191], v[140:143]
    s_add_u32 s46, s46, s47
    s_add_u32 s47, s46, 32768
    v_mfma_f32_16x16x32_bf16 v[124:127], v[204:207], v[184:187], v[124:127]
    v_and_b32 v61, 1, v23
    v_lshlrev_b32 v60, 11, v22
    v_mfma_f32_16x16x32_bf16 v[128:131], v[208:211], v[184:187], v[128:131]
    v_lshl_add_u32 v60, v61, 5, v60
    v_lshrrev_b32 v61, 1, v23
    v_mfma_f32_16x16x32_bf16 v[144:147], v[208:211], v[188:191], v[144:147]
    v_lshl_add_u32 v60, v61, 4, v60
    v_cmp_gt_u32 s[48:49], 8, v22
    v_mfma_f32_16x16x32_bf16 v[160:163], v[208:211], v[192:195], v[160:163]
    v_lshrrev_b32 v61, 3, v22
    v_mul_u32_u24 v61, 16320, v61
    v_mfma_f32_16x16x32_bf16 v[176:179], v[208:211], v[196:199], v[176:179]
    v_sub_u32 v60, v60, v61
    v_add_u32 v61, 16384, v60
    v_mfma_f32_16x16x32_bf16 v[180:183], v[212:215], v[196:199], v[180:183]
    v_mfma_f32_16x16x32_bf16 v[164:167], v[212:215], v[192:195], v[164:167]
    v_mfma_f32_16x16x32_bf16 v[148:151], v[212:215], v[188:191], v[148:151]
    v_mfma_f32_16x16x32_bf16 v[132:135], v[212:215], v[184:187], v[132:135]
    s_cmp_eq_u32 s31, 0
    s_cbranch_scc1 G4_k0
    v_swap_b32 v120, v152
    v_swap_b32 v121, v153
    v_swap_b32 v122, v154
    v_swap_b32 v123, v155
    v_swap_b32 v124, v156
    v_swap_b32 v125, v157
    v_swap_b32 v126, v158
    v_swap_b32 v127, v159
    v_swap_b32 v128, v160
    v_swap_b32 v129, v161
    v_swap_b32 v130, v162
    v_swap_b32 v131, v163
    v_swap_b32 v132, v164
    v_swap_b32 v133, v165
    v_swap_b32 v134, v166
    v_swap_b32 v135, v167
    v_swap_b32 v136, v168
    v_swap_b32 v137, v169
    v_swap_b32 v138, v170
    v_swap_b32 v139, v171
    v_swap_b32 v140, v172
    v_swap_b32 v141, v173
    v_swap_b32 v142, v174
    v_swap_b32 v143, v175
    v_swap_b32 v144, v176
    v_swap_b32 v145, v177
    v_swap_b32 v146, v178
    v_swap_b32 v147, v179
    v_swap_b32 v148, v180
    v_swap_b32 v149, v181
    v_swap_b32 v150, v182
    v_swap_b32 v151, v183
G4_k0:
    s_add_u32 s36, s41, 0
    v_and_or_b32 v152, v152, s45, v56
    v_and_or_b32 v154, v154, s45, v56
    v_and_or_b32 v156, v156, s45, v56
    v_and_or_b32 v158, v158, s45, v56
    v_cvt_pk_bf16_f32 v152, v152, v153
    v_cvt_pk_bf16_f32 v153, v154, v155
    v_cvt_pk_bf16_f32 v154, v156, v157
    v_cvt_pk_bf16_f32 v155, v158, v159
    buffer_store_dwordx4 v[152:155], v2, s[16:19], s36 offen offset:0 sc1
    v_and_or_b32 v160, v160, s45, v56
    v_and_or_b32 v162, v162, s45, v56
    v_and_or_b32 v164, v164, s45, v56
    v_and_or_b32 v166, v166, s45, v56
    v_cvt_pk_bf16_f32 v160, v160, v161
    v_cvt_pk_bf16_f32 v161, v162, v163
    v_cvt_pk_bf16_f32 v162, v164, v165
    v_cvt_pk_bf16_f32 v163, v166, v167
    buffer_store_dwordx4 v[160:163], v2, s[16:19], s36 offen offset:1024 sc1
    s_add_u32 s36, s41, 65536
    v_and_or_b32 v168, v168, s45, v56
    v_and_or_b32 v170, v170, s45, v56
    v_and_or_b32 v172, v172, s45, v56
    v_and_or_b32 v174, v174, s45, v56
    v_cvt_pk_bf16_f32 v168, v168, v169
    v_cvt_pk_bf16_f32 v169, v170, v171
    v_cvt_pk_bf16_f32 v170, v172, v173
    v_cvt_pk_bf16_f32 v171, v174, v175
    buffer_store_dwordx4 v[168:171], v2, s[16:19], s36 offen offset:0 sc1
    v_and_or_b32 v176, v176, s45, v56
    v_and_or_b32 v178, v178, s45, v56
    v_and_or_b32 v180, v180, s45, v56
    v_and_or_b32 v182, v182, s45, v56
    v_cvt_pk_bf16_f32 v176, v176, v177
    v_cvt_pk_bf16_f32 v177, v178, v179
    v_cvt_pk_bf16_f32 v178, v180, v181
    v_cvt_pk_bf16_f32 v179, v182, v183
    buffer_store_dwordx4 v[176:179], v2, s[16:19], s36 offen offset:1024 sc1
    s_waitcnt vmcnt(4)
    v_lshlrev_b32 v56, 16, v80
    v_and_b32 v57, 0xffff0000, v80
    v_pk_add_f32 v[120:121], v[120:121], v[56:57]
    v_lshlrev_b32 v58, 16, v81
    v_and_b32 v59, 0xffff0000, v81
    v_pk_add_f32 v[122:123], v[122:123], v[58:59]
    v_lshlrev_b32 v56, 16, v82
    v_and_b32 v57, 0xffff0000, v82
    v_pk_add_f32 v[124:125], v[124:125], v[56:57]
    v_lshlrev_b32 v58, 16, v83
    v_and_b32 v59, 0xffff0000, v83
    v_pk_add_f32 v[126:127], v[126:127], v[58:59]
    v_lshlrev_b32 v56, 16, v88
    v_and_b32 v57, 0xffff0000, v88
    v_pk_add_f32 v[128:129], v[128:129], v[56:57]
    v_lshlrev_b32 v58, 16, v89
    v_and_b32 v59, 0xffff0000, v89
    v_pk_add_f32 v[130:131], v[130:131], v[58:59]
    v_lshlrev_b32 v56, 16, v90
    v_and_b32 v57, 0xffff0000, v90
    v_pk_add_f32 v[132:133], v[132:133], v[56:57]
    v_lshlrev_b32 v58, 16, v91
    v_and_b32 v59, 0xffff0000, v91
    v_pk_add_f32 v[134:135], v[134:135], v[58:59]
    v_lshlrev_b32 v56, 16, v96
    v_and_b32 v57, 0xffff0000, v96
    v_pk_add_f32 v[136:137], v[136:137], v[56:57]
    v_lshlrev_b32 v58, 16, v97
    v_and_b32 v59, 0xffff0000, v97
    v_pk_add_f32 v[138:139], v[138:139], v[58:59]
    v_lshlrev_b32 v56, 16, v98
    v_and_b32 v57, 0xffff0000, v98
    v_pk_add_f32 v[140:141], v[140:141], v[56:57]
    v_lshlrev_b32 v58, 16, v99
    v_and_b32 v59, 0xffff0000, v99
    v_pk_add_f32 v[142:143], v[142:143], v[58:59]
    v_lshlrev_b32 v56, 16, v104
    v_and_b32 v57, 0xffff0000, v104
    v_pk_add_f32 v[144:145], v[144:145], v[56:57]
    v_lshlrev_b32 v58, 16, v105
    v_and_b32 v59, 0xffff0000, v105
    v_pk_add_f32 v[146:147], v[146:147], v[58:59]
    v_lshlrev_b32 v56, 16, v106
    v_and_b32 v57, 0xffff0000, v106
    v_pk_add_f32 v[148:149], v[148:149], v[56:57]
    v_lshlrev_b32 v58, 16, v107
    v_and_b32 v59, 0xffff0000, v107
    v_pk_add_f32 v[150:151], v[150:151], v[58:59]
    buffer_load_dwordx4 v[24:27], v2, s[16:19], s40 offen offset:0 sc1
    buffer_load_dwordx4 v[28:31], v2, s[16:19], s40 offen offset:1024 sc1
    buffer_load_dwordx4 v[32:35], v2, s[16:19], s44 offen offset:0 sc1
    buffer_load_dwordx4 v[36:39], v2, s[16:19], s44 offen offset:1024 sc1
    v_lshlrev_b32 v56, 16, v84
    v_and_b32 v57, 0xffff0000, v84
    v_pk_add_f32 v[120:121], v[120:121], v[56:57]
    v_lshlrev_b32 v58, 16, v85
    v_and_b32 v59, 0xffff0000, v85
    v_pk_add_f32 v[122:123], v[122:123], v[58:59]
    v_lshlrev_b32 v56, 16, v86
    v_and_b32 v57, 0xffff0000, v86
    v_pk_add_f32 v[124:125], v[124:125], v[56:57]
    v_lshlrev_b32 v58, 16, v87
    v_and_b32 v59, 0xffff0000, v87
    v_pk_add_f32 v[126:127], v[126:127], v[58:59]
    v_lshlrev_b32 v56, 16, v92
    v_and_b32 v57, 0xffff0000, v92
    v_pk_add_f32 v[128:129], v[128:129], v[56:57]
    v_lshlrev_b32 v58, 16, v93
    v_and_b32 v59, 0xffff0000, v93
    v_pk_add_f32 v[130:131], v[130:131], v[58:59]
    v_lshlrev_b32 v56, 16, v94
    v_and_b32 v57, 0xffff0000, v94
    v_pk_add_f32 v[132:133], v[132:133], v[56:57]
    v_lshlrev_b32 v58, 16, v95
    v_and_b32 v59, 0xffff0000, v95
    v_pk_add_f32 v[134:135], v[134:135], v[58:59]
    v_lshlrev_b32 v56, 16, v100
    v_and_b32 v57, 0xffff0000, v100
    v_pk_add_f32 v[136:137], v[136:137], v[56:57]
    v_lshlrev_b32 v58, 16, v101
    v_and_b32 v59, 0xffff0000, v101
    v_pk_add_f32 v[138:139], v[138:139], v[58:59]
    v_lshlrev_b32 v56, 16, v102
    v_and_b32 v57, 0xffff0000, v102
    v_pk_add_f32 v[140:141], v[140:141], v[56:57]
    v_lshlrev_b32 v58, 16, v103
    v_and_b32 v59, 0xffff0000, v103
    v_pk_add_f32 v[142:143], v[142:143], v[58:59]
    v_lshlrev_b32 v56, 16, v108
    v_and_b32 v57, 0xffff0000, v108
    v_pk_add_f32 v[144:145], v[144:145], v[56:57]
    v_lshlrev_b32 v58, 16, v109
    v_and_b32 v59, 0xffff0000, v109
    v_pk_add_f32 v[146:147], v[146:147], v[58:59]
    v_lshlrev_b32 v56, 16, v110
    v_and_b32 v57, 0xffff0000, v110
    v_pk_add_f32 v[148:149], v[148:149], v[56:57]
    v_lshlrev_b32 v58, 16, v111
    v_and_b32 v59, 0xffff0000, v111
    v_pk_add_f32 v[150:151], v[150:151], v[58:59]
    s_mov_b32 s53, 0
dw_29:
    s_waitcnt vmcnt(0)
    v_and_b32 v8, v24, v25
    v_and_b32 v9, v32, v33
    v_bitop3_b32 v8, v26, v27, v8 bitop3:0x80
    v_bitop3_b32 v9, v34, v35, v9 bitop3:0x80
    v_bitop3_b32 v8, v28, v29, v8 bitop3:0x80
    v_bitop3_b32 v9, v36, v37, v9 bitop3:0x80
    v_bitop3_b32 v8, v30, v31, v8 bitop3:0x80
    v_bitop3_b32 v9, v38, v39, v9 bitop3:0x80
    v_bitop3_b32 v8, v8, v9, 1 bitop3:0x80
    v_cmp_eq_u32 vcc, 0, v8
    s_nop 0
    s_cmp_eq_u64 vcc, 0
    s_cbranch_scc1 dok_30
    s_sleep 1
    buffer_load_dwordx4 v[24:27], v2, s[16:19], s40 offen offset:0 sc1
    buffer_load_dwordx4 v[28:31], v2, s[16:19], s40 offen offset:1024 sc1
    buffer_load_dwordx4 v[32:35], v2, s[16:19], s44 offen offset:0 sc1
    buffer_load_dwordx4 v[36:39], v2, s[16:19], s44 offen offset:1024 sc1
    s_add_u32 s53, s53, 1
    s_cmp_lt_u32 s53, s61
    s_cbranch_scc1 dw_29
    s_mov_b32 s61, 0
    s_waitcnt vmcnt(0)
dok_30:
    v_lshlrev_b32 v56, 16, v24
    v_and_b32 v57, 0xffff0000, v24
    v_pk_add_f32 v[120:121], v[120:121], v[56:57]
    v_lshlrev_b32 v58, 16, v25
    v_and_b32 v59, 0xffff0000, v25
    v_pk_add_f32 v[122:123], v[122:123], v[58:59]
    v_lshlrev_b32 v56, 16, v26
    v_and_b32 v57, 0xffff0000, v26
    v_pk_add_f32 v[124:125], v[124:125], v[56:57]
    v_lshlrev_b32 v58, 16, v27
    v_and_b32 v59, 0xffff0000, v27
    v_pk_add_f32 v[126:127], v[126:127], v[58:59]
    v_cvt_pk_bf16_f32 v120, v120, v121
    v_cvt_pk_bf16_f32 v121, v122, v123
    v_cvt_pk_bf16_f32 v122, v124, v125
    v_cvt_pk_bf16_f32 v123, v126, v127
    s_nop 0
    v_permlane16_swap_b32 v120, v122
    v_permlane16_swap_b32 v121, v123
    v_lshlrev_b32 v56, 16, v28
    v_and_b32 v57, 0xffff0000, v28
    v_pk_add_f32 v[128:129], v[128:129], v[56:57]
    v_lshlrev_b32 v58, 16, v29
    v_and_b32 v59, 0xffff0000, v29
    v_pk_add_f32 v[130:131], v[130:131], v[58:59]
    v_lshlrev_b32 v56, 16, v30
    v_and_b32 v57, 0xffff0000, v30
    v_pk_add_f32 v[132:133], v[132:133], v[56:57]
    v_lshlrev_b32 v58, 16, v31
    v_and_b32 v59, 0xffff0000, v31
    v_pk_add_f32 v[134:135], v[134:135], v[58:59]
    v_cvt_pk_bf16_f32 v128, v128, v129
    v_cvt_pk_bf16_f32 v129, v130, v131
    v_cvt_pk_bf16_f32 v130, v132, v133
    v_cvt_pk_bf16_f32 v131, v134, v135
    s_nop 0
    v_permlane16_swap_b32 v128, v130
    v_permlane16_swap_b32 v129, v131
    v_cndmask_b32 v132, v120, v128, s[48:49]
    v_cndmask_b32 v133, v121, v129, s[48:49]
    v_cndmask_b32 v134, v122, v130, s[48:49]
    v_cndmask_b32 v135, v123, v131, s[48:49]
    v_mov_b32_dpp v124, v132 row_ror:8 row_mask:0xf bank_mask:0xf
    v_mov_b32_dpp v125, v133 row_ror:8 row_mask:0xf bank_mask:0xf
    v_mov_b32_dpp v126, v134 row_ror:8 row_mask:0xf bank_mask:0xf
    v_mov_b32_dpp v127, v135 row_ror:8 row_mask:0xf bank_mask:0xf
    v_cndmask_b32 v120, v124, v120, s[48:49]
    v_cndmask_b32 v128, v128, v124, s[48:49]
    v_cndmask_b32 v121, v125, v121, s[48:49]
    v_cndmask_b32 v129, v129, v125, s[48:49]
    v_cndmask_b32 v122, v126, v122, s[48:49]
    v_cndmask_b32 v130, v130, v126, s[48:49]
    v_cndmask_b32 v123, v127, v123, s[48:49]
    v_cndmask_b32 v131, v131, v127, s[48:49]
    buffer_store_dwordx4 v[120:123], v60, s[20:23], s46 offen sc1
    buffer_store_dwordx4 v[128:131], v61, s[20:23], s46 offen sc1
    v_lshlrev_b32 v56, 16, v32
    v_and_b32 v57, 0xffff0000, v32
    v_pk_add_f32 v[136:137], v[136:137], v[56:57]
    v_lshlrev_b32 v58, 16, v33
    v_and_b32 v59, 0xffff0000, v33
    v_pk_add_f32 v[138:139], v[138:139], v[58:59]
    v_lshlrev_b32 v56, 16, v34
    v_and_b32 v57, 0xffff0000, v34
    v_pk_add_f32 v[140:141], v[140:141], v[56:57]
    v_lshlrev_b32 v58, 16, v35
    v_and_b32 v59, 0xffff0000, v35
    v_pk_add_f32 v[142:143], v[142:143], v[58:59]
    v_cvt_pk_bf16_f32 v136, v136, v137
    v_cvt_pk_bf16_f32 v137, v138, v139
    v_cvt_pk_bf16_f32 v138, v140, v141
    v_cvt_pk_bf16_f32 v139, v142, v143
    s_nop 0
    v_permlane16_swap_b32 v136, v138
    v_permlane16_swap_b32 v137, v139
    v_lshlrev_b32 v56, 16, v36
    v_and_b32 v57, 0xffff0000, v36
    v_pk_add_f32 v[144:145], v[144:145], v[56:57]
    v_lshlrev_b32 v58, 16, v37
    v_and_b32 v59, 0xffff0000, v37
    v_pk_add_f32 v[146:147], v[146:147], v[58:59]
    v_lshlrev_b32 v56, 16, v38
    v_and_b32 v57, 0xffff0000, v38
    v_pk_add_f32 v[148:149], v[148:149], v[56:57]
    v_lshlrev_b32 v58, 16, v39
    v_and_b32 v59, 0xffff0000, v39
    v_pk_add_f32 v[150:151], v[150:151], v[58:59]
    v_cvt_pk_bf16_f32 v144, v144, v145
    v_cvt_pk_bf16_f32 v145, v146, v147
    v_cvt_pk_bf16_f32 v146, v148, v149
    v_cvt_pk_bf16_f32 v147, v150, v151
    s_nop 0
    v_permlane16_swap_b32 v144, v146
    v_permlane16_swap_b32 v145, v147
    v_cndmask_b32 v148, v136, v144, s[48:49]
    v_cndmask_b32 v149, v137, v145, s[48:49]
    v_cndmask_b32 v150, v138, v146, s[48:49]
    v_cndmask_b32 v151, v139, v147, s[48:49]
    v_mov_b32_dpp v140, v148 row_ror:8 row_mask:0xf bank_mask:0xf
    v_mov_b32_dpp v141, v149 row_ror:8 row_mask:0xf bank_mask:0xf
    v_mov_b32_dpp v142, v150 row_ror:8 row_mask:0xf bank_mask:0xf
    v_mov_b32_dpp v143, v151 row_ror:8 row_mask:0xf bank_mask:0xf
    v_cndmask_b32 v136, v140, v136, s[48:49]
    v_cndmask_b32 v144, v144, v140, s[48:49]
    v_cndmask_b32 v137, v141, v137, s[48:49]
    v_cndmask_b32 v145, v145, v141, s[48:49]
    v_cndmask_b32 v138, v142, v138, s[48:49]
    v_cndmask_b32 v146, v146, v142, s[48:49]
    v_cndmask_b32 v139, v143, v139, s[48:49]
    v_cndmask_b32 v147, v147, v143, s[48:49]
    buffer_store_dwordx4 v[136:139], v60, s[20:23], s47 offen sc1
    buffer_store_dwordx4 v[144:147], v61, s[20:23], s47 offen sc1
    s_branch K_fin
LOADERS:
    s_cmp_lg_u32 s60, 0
    s_cbranch_scc1 WY_1
    ds_read_b64_tr_b16 v[128:129], v74 offset:0
    ds_read_b64_tr_b16 v[130:131], v74 offset:2048
    ds_read_b64_tr_b16 v[136:137], v74 offset:4096
    ds_read_b64_tr_b16 v[138:139], v74 offset:6144
    ds_read_b64_tr_b16 v[144:145], v74 offset:8192
    ds_read_b64_tr_b16 v[146:147], v74 offset:10240
    ds_read_b64_tr_b16 v[152:153], v74 offset:12288
    ds_read_b64_tr_b16 v[154:155], v74 offset:14336
    ds_read_b64_tr_b16 v[160:161], v74 offset:16384
    ds_read_b64_tr_b16 v[162:163], v74 offset:18432
    ds_read_b64_tr_b16 v[168:169], v74 offset:20480
    ds_read_b64_tr_b16 v[170:171], v74 offset:22528
    ds_read_b64_tr_b16 v[176:177], v74 offset:24576
    ds_read_b64_tr_b16 v[178:179], v74 offset:26624
    ds_read_b64_tr_b16 v[184:185], v74 offset:28672
    ds_read_b64_tr_b16 v[186:187], v74 offset:30720
    ds_read_b64_tr_b16 v[192:193], v74 offset:32768
    ds_read_b64_tr_b16 v[194:195], v74 offset:34816
    ds_read_b64_tr_b16 v[200:201], v74 offset:36864
    ds_read_b64_tr_b16 v[202:203], v74 offset:38912
    ds_read_b64_tr_b16 v[208:209], v74 offset:40960
    ds_read_b64_tr_b16 v[210:211], v74 offset:43008
    ds_read_b64_tr_b16 v[216:217], v74 offset:45056
    ds_read_b64_tr_b16 v[218:219], v74 offset:47104
    ds_read_b64_tr_b16 v[224:225], v74 offset:49152
    ds_read_b64_tr_b16 v[226:227], v74 offset:51200
    ds_read_b64_tr_b16 v[232:233], v74 offset:53248
    ds_read_b64_tr_b16 v[234:235], v74 offset:55296
    ds_read_b64_tr_b16 v[240:241], v74 offset:57344
    ds_read_b64_tr_b16 v[242:243], v74 offset:59392
    ds_read_b64_tr_b16 v[248:249], v74 offset:61440
    ds_read_b64_tr_b16 v[250:251], v74 offset:63488
    ds_read_b64_tr_b16 v[132:133], v75 offset:0
    ds_read_b64_tr_b16 v[134:135], v75 offset:2048
    ds_read_b64_tr_b16 v[140:141], v75 offset:4096
    ds_read_b64_tr_b16 v[142:143], v75 offset:6144
    s_waitcnt vmcnt(0)
    s_branch WY_2
WY_1:
    s_mov_b64 s[80:81], s[68:69]
    s_mov_b32 s82, 2097152
    s_mov_b32 s83, 0x20000
    s_and_b32 s49, s30, 3
    s_lshl_b32 s36, s49, 14
    s_lshl_b32 s48, s29, 7
    s_add_u32 s48, s48, s36
    s_lshl_b32 s49, s49, 10
    s_add_u32 s36, s67, 7
    s_and_b32 s36, s36, 7
    s_lshl_b32 s36, s36, 17
    s_add_u32 s36, s36, s48
    s_add_u32 m0, s49, 81920
    s_nop 0
    buffer_load_dwordx4 v118, s[80:83], s36 offen lds
    s_add_u32 s36, s36, 65536
    s_add_u32 m0, s49, 86016
    s_nop 0
    buffer_load_dwordx4 v118, s[80:83], s36 offen lds
    s_add_u32 s36, s67, 0
    s_and_b32 s36, s36, 7
    s_lshl_b32 s36, s36, 17
    s_add_u32 s36, s36, s48
    s_add_u32 s36, s36, 1048576
    s_add_u32 m0, s49, 90112
    s_nop 0
    buffer_load_dwordx4 v118, s[80:83], s36 offen lds
    s_add_u32 s36, s36, 65536
    s_add_u32 m0, s49, 94208
    s_nop 0
    buffer_load_dwordx4 v118, s[80:83], s36 offen lds
    s_add_u32 s36, s67, 1
    s_and_b32 s36, s36, 7
    s_lshl_b32 s36, s36, 17
    s_add_u32 s36, s36, s48
    s_add_u32 m0, s49, 32768
    s_nop 0
    buffer_load_dwordx4 v118, s[80:83], s36 offen lds
    s_add_u32 s36, s36, 65536
    s_add_u32 m0, s49, 36864
    s_nop 0
    buffer_load_dwordx4 v118, s[80:83], s36 offen lds
    s_add_u32 s36, s67, 2
    s_and_b32 s36, s36, 7
    s_lshl_b32 s36, s36, 17
    s_add_u32 s36, s36, s48
    s_add_u32 m0, s49, 40960
    s_nop 0
    buffer_load_dwordx4 v118, s[80:83], s36 offen lds
    s_add_u32 s36, s36, 65536
    s_add_u32 m0, s49, 45056
    s_nop 0
    buffer_load_dwordx4 v118, s[80:83], s36 offen lds
    s_add_u32 s36, s67, 1
    s_and_b32 s36, s36, 7
    s_lshl_b32 s36, s36, 17
    s_add_u32 s36, s36, s48
    s_add_u32 s36, s36, 1048576
    s_add_u32 m0, s49, 98304
    s_nop 0
    buffer_load_dwordx4 v118, s[80:83], s36 offen lds
    s_add_u32 s36, s36, 65536
    s_add_u32 m0, s49, 102400
    s_nop 0
    buffer_load_dwordx4 v118, s[80:83], s36 offen lds
    s_add_u32 s36, s67, 2
    s_and_b32 s36, s36, 7
    s_lshl_b32 s36, s36, 17
    s_add_u32 s36, s36, s48
    s_add_u32 s36, s36, 1048576
    s_add_u32 m0, s49, 106496
    s_nop 0
    buffer_load_dwordx4 v118, s[80:83], s36 offen lds
    s_add_u32 s36, s36, 65536
    s_add_u32 m0, s49, 110592
    s_nop 0
    buffer_load_dwordx4 v118, s[80:83], s36 offen lds
    s_waitcnt vmcnt(12)
WY_2:
    s_barrier
    v_and_b32 v8, 15, v1
    v_lshrrev_b32 v9, 4, v1
    s_and_b32 s34, s30, 1
    s_and_b32 s37, s30, 3
    s_lshr_b32 s38, s29, 3
    s_add_u32 s38, s38, 1
    s_sub_u32 s39, 0, s38
    s_bitcmp1_b32 s29, 2
    s_cselect_b32 s38, s38, s39
    s_lshl_b32 s48, s28, 7
    s_cmp_lt_u32 s37, 2
    s_cselect_b32 s36, s38, 0
    s_add_u32 s36, s36, s48
    s_lshl_b32 s45, s34, 6
    s_add_u32 s36, s36, s45
    v_add_u32 v72, s36, v1
    s_movk_i32 s45, 2048
    v_cmp_gt_u32 s[46:47], s45, v72
    v_lshlrev_b32 v72, 4, v72
    s_lshl_b32 s22, s60, 15
    s_add_u32 s22, s22, 23199744
    s_add_u32 s20, s4, s22
    s_addc_u32 s21, s5, 0
    s_mov_b32 s22, 32768
    s_mov_b32 s23, 0x20000
    s_lshl_b32 s36, s37, 2
    v_add_u32 v6, s36, v9
    v_xor_b32 v10, v6, v8
    s_add_u32 s36, s48, s38
    s_add_u32 s36, s36, 16
    v_add_u32 v6, s36, v6
    v_and_b32 v7, 3, v6
    v_lshrrev_b32 v11, 2, v6
    v_lshlrev_b32 v11, 14, v11
    v_lshl_add_u32 v11, v7, 11, v11
    v_lshl_add_u32 v11, v10, 4, v11
    v_subrev_u32 v10, 65536, v11
    s_add_u32 s40, s67, 0
    s_and_b32 s40, s40, 6
    s_lshl_b32 s40, s40, 7
    s_add_u32 s41, s67, 2
    s_and_b32 s41, s41, 6
    s_lshl_b32 s41, s41, 7
    s_add_u32 s42, s67, 4
    s_and_b32 s42, s42, 6
    s_lshl_b32 s42, s42, 7
    s_add_u32 s43, s67, 6
    s_and_b32 s43, s43, 6
    s_lshl_b32 s43, s43, 7
    s_lshl_b32 s44, s37, 10
    v_lshrrev_b32 v6, 3, v1
    v_and_b32 v17, 7, v1
    v_xor_b32 v17, v17, v6
    s_lshl_b32 s36, s37, 3
    s_add_u32 s36, s36, s48
    v_add_u32 v6, s36, v6
    v_and_b32 v7, 3, v6
    v_lshrrev_b32 v12, 2, v6
    v_lshlrev_b32 v12, 14, v12
    v_lshl_add_u32 v12, v7, 11, v12
    s_lshl_b32 s36, s29, 7
    v_lshl_add_u32 v12, v17, 4, v12
    v_add_u32 v12, s36, v12
    v_lshrrev_b32 v6, 1, v9
    s_lshl_b32 s36, s37, 1
    v_add_u32 v6, s36, v6
    v_and_b32 v7, 7, v8
    v_xor_b32 v6, v6, v7
    v_lshlrev_b32 v17, 7, v8
    v_lshl_add_u32 v17, v6, 4, v17
    v_and_b32 v6, 1, v9
    v_lshl_add_u32 v17, v6, 3, v17
    v_and_b32 v6, 1, v9
    v_lshlrev_b32 v13, 16, v6
    v_lshrrev_b32 v6, 1, v9
    v_lshl_add_u32 v13, v6, 8, v13
    v_lshl_add_u32 v13, v8, 4, v13
    s_bfe_u32 s36, s30, 0x10001
    s_lshl1_add_u32 s36, s29, s36
    s_lshr_b32 s53, s36, 3
    s_lshl_b32 s53, s53, 14
    s_and_b32 s39, s36, 7
    s_lshl_b32 s39, s39, 10
    s_add_u32 s39, s39, s53
    s_and_b32 s36, s30, 1
    s_lshl_b32 s36, s36, 9
    s_add_u32 s39, s39, s36
    v_mov_b32 v14, v2
    v_add_u32 v15, 106496, v2
    v_lshrrev_b32 v6, 5, v13
    v_and_b32 v6, 2048, v6
    v_and_b32 v16, 511, v13
    v_add_u32 v16, v16, v6
    s_lshl_b32 s36, s37, 9
    v_add_u32 v16, s36, v16
    s_lshl_b32 s14, s60, 24
    s_lshl_b32 s15, s94, 13
    s_add_u32 s14, s14, s15
    s_add_u32 s14, s14, 167772160
    s_add_u32 s12, s4, s14
    s_addc_u32 s13, s5, 0
    s_mov_b32 s14, 8380416
    s_mov_b32 s15, 0x20000
    s_add_u32 s16, s62, 0x400000
    s_addc_u32 s17, s63, 0
    s_mov_b32 s18, 0x7e000
    s_mov_b32 s19, 0x20000
    s_add_u32 s24, s62, 0x480000
    s_addc_u32 s25, s63, 0
    s_mov_b32 s26, 0x7e000
    s_mov_b32 s27, 0x20000
    s_and_b32 s82, s30, 3
    s_lshl_b32 s82, s82, 15
    s_add_u32 s53, s67, 0
    s_and_b32 s78, s53, 4
    s_and_b32 s53, s53, 2
    s_lshl_b32 s78, s78, 12
    s_lshl_b32 s53, s53, 11
    s_add_u32 s78, s78, s53
    s_add_u32 s78, s78, s82
    s_add_u32 s53, s67, 2
    s_and_b32 s79, s53, 4
    s_and_b32 s53, s53, 2
    s_lshl_b32 s79, s79, 12
    s_lshl_b32 s53, s53, 11
    s_add_u32 s79, s79, s53
    s_add_u32 s79, s79, s82
    s_add_u32 s53, s67, 4
    s_and_b32 s80, s53, 4
    s_and_b32 s53, s53, 2
    s_lshl_b32 s80, s80, 12
    s_lshl_b32 s53, s53, 11
    s_add_u32 s80, s80, s53
    s_add_u32 s80, s80, s82
    s_add_u32 s53, s67, 6
    s_and_b32 s81, s53, 4
    s_and_b32 s53, s53, 2
    s_lshl_b32 s81, s81, 12
    s_lshl_b32 s53, s53, 11
    s_add_u32 s81, s81, s53
    s_add_u32 s81, s81, s82
    s_and_b32 s53, s30, 2
    s_lshl_b32 s53, s53, 11
    s_and_b32 s82, s30, 1
    s_lshl_b32 s82, s82, 13
    s_add_u32 s82, s82, s53
    s_and_b32 s84, s30, 1
    s_lshl_b32 s84, s84, 8
    s_add_u32 s84, s84, s55
    s_add_u32 s85, s52, 16
    s_waitcnt vmcnt(0) lgkmcnt(0)
    s_barrier
    s_setprio 1
    s_add_u32 m0, s44, 16384
    s_add_u32 s49, s40, 0
    s_barrier
    buffer_load_dwordx4 v[52:55], v72, s[20:23], 0 offen sc1
    buffer_load_dwordx4 v10, s[12:15], s49 offen offset:0 sc1 lds
    s_add_u32 m0, s44, 23552
    s_nop 0
    buffer_load_dwordx4 v10, s[12:15], s49 offen offset:1024 sc1 lds
    s_add_u32 m0, s44, 20480
    s_nop 0
    buffer_load_dwordx4 v11, s[12:15], s49 offen offset:0 sc1 lds
    s_add_u32 m0, s44, 27648
    s_nop 0
    buffer_load_dwordx4 v11, s[12:15], s49 offen offset:1024 sc1 lds
    s_add_u32 m0, s44, 32768
    s_add_u32 s49, s41, 0
    buffer_load_dwordx4 v10, s[12:15], s49 offen offset:0 sc1 lds
    s_add_u32 m0, s44, 39936
    s_nop 0
    buffer_load_dwordx4 v10, s[12:15], s49 offen offset:1024 sc1 lds
    s_add_u32 m0, s44, 36864
    s_nop 0
    buffer_load_dwordx4 v11, s[12:15], s49 offen offset:0 sc1 lds
    s_add_u32 m0, s44, 44032
    s_nop 0
    buffer_load_dwordx4 v11, s[12:15], s49 offen offset:1024 sc1 lds
    s_waitcnt vmcnt(8)
    s_mov_b32 s53, 0
lns_31:
    v_cmp_eq_u32 vcc, s52, v53
    v_cmp_eq_u32 s[50:51], s52, v55
    s_nop 0
    s_and_b64 vcc, vcc, s[50:51]
    s_orn2_b64 vcc, vcc, s[46:47]
    s_cmp_eq_u64 vcc, -1
    s_cbranch_scc1 lnk_32
    buffer_load_dwordx4 v[52:55], v72, s[20:23], 0 offen sc1
    s_waitcnt vmcnt(0)
    s_add_u32 s53, s53, 1
    s_cmp_lt_u32 s53, s61
    s_cbranch_scc1 lns_31
    s_mov_b32 s61, 0
lnk_32:
    v_lshlrev_b32 v56, 16, v52
    v_and_b32 v57, 0xffff0000, v52
    v_lshlrev_b32 v58, 16, v54
    v_and_b32 v59, 0xffff0000, v54
    v_cndmask_b32 v57, 1.0, v57, s[46:47]
    v_cndmask_b32 v59, 1.0, v59, s[46:47]
    s_lshl_b32 s36, s34, 10
    s_add_u32 s36, s36, 155648
    v_add_u32 v6, s36, v2
    s_cmp_ge_u32 s37, 2
    s_cbranch_scc1 lnx_33
    v_mul_f32 v66, v57, v59
    v_fma_f32 v60, -v58, v57, -v56
    v_rcp_f32 v7, v66
    v_mov_b32 v67, v66
    v_mov_b32 v61, v60
    v_mul_f32 v62, 0xc0135761, v7
    v_mul_f32 v7, v7, v7
    v_mov_b32 v63, v62
    v_mul_f32 v7, 0x3d372713, v7
    v_mul_f32 v64, v7, v62
    v_mov_b32 v65, v64
    ds_write_b128 v6, v[60:63] offset:0
    ds_write_b128 v6, v[64:67] offset:2048
    s_branch lnd_34
lnx_33:
    v_rcp_f32 v60, v57
    s_nop 0
    v_mul_f32 v62, -v56, v60
    v_mov_b32 v61, v60
    v_mov_b32 v63, v62
    ds_write_b128 v6, v[60:63] offset:5120
lnd_34:
    v_lshlrev_b32 v7, 4, v8
    v_add_u32 v7, 160768, v7
    s_add_u32 m0, s44, 106496
    s_add_u32 s49, s42, 0
    buffer_load_dwordx4 v10, s[12:15], s49 offen offset:0 sc1 lds
    s_add_u32 m0, s44, 113664
    s_nop 0
    buffer_load_dwordx4 v10, s[12:15], s49 offen offset:1024 sc1 lds
    s_add_u32 m0, s44, 110592
    s_nop 0
    buffer_load_dwordx4 v11, s[12:15], s49 offen offset:0 sc1 lds
    s_add_u32 m0, s44, 117760
    s_nop 0
    buffer_load_dwordx4 v11, s[12:15], s49 offen offset:1024 sc1 lds
    s_add_u32 m0, s44, 122880
    s_add_u32 s49, s43, 0
    s_waitcnt vmcnt(8)
    s_barrier
    buffer_load_dwordx4 v10, s[12:15], s49 offen offset:0 sc1 lds
    s_add_u32 m0, s44, 130048
    s_nop 0
    buffer_load_dwordx4 v10, s[12:15], s49 offen offset:1024 sc1 lds
    s_add_u32 m0, s44, 126976
    s_nop 0
    buffer_load_dwordx4 v11, s[12:15], s49 offen offset:0 sc1 lds
    s_add_u32 m0, s44, 134144
    s_nop 0
    buffer_load_dwordx4 v11, s[12:15], s49 offen offset:1024 sc1 lds
    v_mov_b32 v10, v11
    v_add_u32 v11, 65536, v11
    s_add_u32 m0, s44, 139264
    s_add_u32 s49, s40, 65536
    s_waitcnt vmcnt(8)
    s_barrier
    buffer_load_dwordx4 v10, s[12:15], s49 offen offset:0 sc1 lds
    s_add_u32 m0, s44, 146432
    s_nop 0
    buffer_load_dwordx4 v10, s[12:15], s49 offen offset:1024 sc1 lds
    s_add_u32 m0, s44, 143360
    s_nop 0
    buffer_load_dwordx4 v11, s[12:15], s49 offen offset:0 sc1 lds
    s_add_u32 m0, s44, 150528
    s_nop 0
    buffer_load_dwordx4 v11, s[12:15], s49 offen offset:1024 sc1 lds
    s_add_u32 m0, s44, 16384
    s_add_u32 s49, s41, 65536
    s_waitcnt vmcnt(8)
    s_barrier
    buffer_load_dwordx4 v10, s[12:15], s49 offen offset:0 sc1 lds
    s_add_u32 m0, s44, 23552
    s_nop 0
    buffer_load_dwordx4 v10, s[12:15], s49 offen offset:1024 sc1 lds
    s_add_u32 m0, s44, 20480
    s_nop 0
    buffer_load_dwordx4 v11, s[12:15], s49 offen offset:0 sc1 lds
    s_add_u32 m0, s44, 27648
    s_nop 0
    buffer_load_dwordx4 v11, s[12:15], s49 offen offset:1024 sc1 lds
    s_add_u32 m0, s44, 32768
    s_add_u32 s49, s42, 65536
    s_waitcnt vmcnt(8)
    s_barrier
    buffer_load_dwordx4 v10, s[12:15], s49 offen offset:0 sc1 lds
    s_add_u32 m0, s44, 39936
    s_nop 0
    buffer_load_dwordx4 v10, s[12:15], s49 offen offset:1024 sc1 lds
    s_add_u32 m0, s44, 36864
    s_nop 0
    buffer_load_dwordx4 v11, s[12:15], s49 offen offset:0 sc1 lds
    s_add_u32 m0, s44, 44032
    s_nop 0
    buffer_load_dwordx4 v11, s[12:15], s49 offen offset:1024 sc1 lds
    s_waitcnt lgkmcnt(0)
    s_add_u32 m0, s44, 106496
    s_add_u32 s49, s43, 65536
    s_waitcnt vmcnt(8)
    s_barrier
    buffer_load_dwordx4 v10, s[12:15], s49 offen offset:0 sc1 lds
    s_add_u32 m0, s44, 113664
    s_nop 0
    buffer_load_dwordx4 v10, s[12:15], s49 offen offset:1024 sc1 lds
    s_add_u32 m0, s44, 110592
    s_nop 0
    buffer_load_dwordx4 v11, s[12:15], s49 offen offset:0 sc1 lds
    s_add_u32 m0, s44, 117760
    s_nop 0
    buffer_load_dwordx4 v11, s[12:15], s49 offen offset:1024 sc1 lds
    s_add_u32 m0, s44, 0
    s_mov_b32 s36, 0
    buffer_load_dwordx4 v12, s[12:15], s36 offen sc1 lds
    s_add_u32 m0, s44, 4096
    s_mov_b32 s36, 131072
    buffer_load_dwordx4 v12, s[12:15], s36 offen sc1 lds
    s_add_u32 m0, s44, 8192
    s_mov_b32 s36, 262144
    buffer_load_dwordx4 v12, s[12:15], s36 offen sc1 lds
    s_add_u32 m0, s44, 12288
    s_mov_b32 s36, 393216
    buffer_load_dwordx4 v12, s[12:15], s36 offen sc1 lds
    s_add_u32 m0, s44, 122880
    s_add_u32 s49, s40, 196608
    s_waitcnt vmcnt(12)
    s_barrier
    buffer_load_dwordx4 v10, s[12:15], s49 offen offset:0 sc1 lds
    s_add_u32 m0, s44, 130048
    s_nop 0
    buffer_load_dwordx4 v10, s[12:15], s49 offen offset:1024 sc1 lds
    s_add_u32 m0, s44, 126976
    s_nop 0
    buffer_load_dwordx4 v11, s[12:15], s49 offen offset:0 sc1 lds
    s_add_u32 m0, s44, 134144
    s_nop 0
    buffer_load_dwordx4 v11, s[12:15], s49 offen offset:1024 sc1 lds
    s_add_u32 m0, s44, 139264
    s_add_u32 s49, s41, 196608
    s_waitcnt vmcnt(12)
    s_barrier
    buffer_load_dwordx4 v10, s[12:15], s49 offen offset:0 sc1 lds
    s_add_u32 m0, s44, 146432
    s_nop 0
    buffer_load_dwordx4 v10, s[12:15], s49 offen offset:1024 sc1 lds
    s_add_u32 m0, s44, 143360
    s_nop 0
    buffer_load_dwordx4 v11, s[12:15], s49 offen offset:0 sc1 lds
    s_add_u32 m0, s44, 150528
    s_nop 0
    buffer_load_dwordx4 v11, s[12:15], s49 offen offset:1024 sc1 lds
    s_add_u32 m0, s44, 16384
    s_add_u32 s49, s42, 196608
    s_waitcnt vmcnt(8)
    s_barrier
    buffer_load_dwordx4 v10, s[12:15], s49 offen offset:0 sc1 lds
    s_add_u32 m0, s44, 23552
    s_nop 0
    buffer_load_dwordx4 v10, s[12:15], s49 offen offset:1024 sc1 lds
    s_add_u32 m0, s44, 20480
    s_nop 0
    buffer_load_dwordx4 v11, s[12:15], s49 offen offset:0 sc1 lds
    s_add_u32 m0, s44, 27648
    s_nop 0
    buffer_load_dwordx4 v11, s[12:15], s49 offen offset:1024 sc1 lds
    ds_read_b64 v[22:23], v17 offset:0
    ds_read_b128 v[60:63], v7 offset:0
    ds_read_b64 v[26:27], v17 offset:2048
    ds_read_b128 v[64:67], v7 offset:256
    s_add_u32 m0, s44, 32768
    s_add_u32 s49, s43, 196608
    s_waitcnt vmcnt(8)
    s_barrier
    buffer_load_dwordx4 v10, s[12:15], s49 offen offset:0 sc1 lds
    s_waitcnt lgkmcnt(0)
    v_lshlrev_b32 v20, 16, v22
    v_and_b32 v21, 0xffff0000, v22
    v_lshlrev_b32 v22, 16, v23
    v_and_b32 v23, 0xffff0000, v23
    s_add_u32 m0, s44, 39936
    s_nop 0
    buffer_load_dwordx4 v10, s[12:15], s49 offen offset:1024 sc1 lds
    v_pk_fma_f32 v[20:21], v[20:21], v[60:61], v[62:63]
    v_pk_fma_f32 v[22:23], v[22:23], v[60:61], v[62:63]
    v_lshlrev_b32 v24, 16, v26
    v_and_b32 v25, 0xffff0000, v26
    v_lshlrev_b32 v26, 16, v27
    s_add_u32 m0, s44, 36864
    s_nop 0
    buffer_load_dwordx4 v11, s[12:15], s49 offen offset:0 sc1 lds
    v_and_b32 v27, 0xffff0000, v27
    v_pk_fma_f32 v[24:25], v[24:25], v[64:65], v[66:67]
    v_pk_fma_f32 v[26:27], v[26:27], v[64:65], v[66:67]
    s_add_u32 m0, s44, 44032
    s_nop 0
    buffer_load_dwordx4 v11, s[12:15], s49 offen offset:1024 sc1 lds
    ds_read_b64 v[30:31], v17 offset:4096
    ds_read_b128 v[60:63], v7 offset:512
    ds_read_b64 v[34:35], v17 offset:6144
    ds_read_b128 v[64:67], v7 offset:768
    s_mov_b32 s88, 0
    s_call_b64 s[76:77], SUB_w3_sub_3
    s_add_u32 m0, s44, 106496
    s_add_u32 s49, s40, 327680
    s_waitcnt vmcnt(15)
    s_barrier
    buffer_load_dwordx4 v10, s[12:15], s49 offen offset:0 sc1 lds
    s_waitcnt lgkmcnt(0)
    v_lshlrev_b32 v28, 16, v30
    v_and_b32 v29, 0xffff0000, v30
    v_lshlrev_b32 v30, 16, v31
    v_and_b32 v31, 0xffff0000, v31
    s_add_u32 m0, s44, 113664
    s_nop 0
    buffer_load_dwordx4 v10, s[12:15], s49 offen offset:1024 sc1 lds
    v_pk_fma_f32 v[28:29], v[28:29], v[60:61], v[62:63]
    v_pk_fma_f32 v[30:31], v[30:31], v[60:61], v[62:63]
    v_lshlrev_b32 v32, 16, v34
    v_and_b32 v33, 0xffff0000, v34
    v_lshlrev_b32 v34, 16, v35
    s_add_u32 m0, s44, 110592
    s_nop 0
    buffer_load_dwordx4 v11, s[12:15], s49 offen offset:0 sc1 lds
    v_and_b32 v35, 0xffff0000, v35
    v_pk_fma_f32 v[32:33], v[32:33], v[64:65], v[66:67]
    v_pk_fma_f32 v[34:35], v[34:35], v[64:65], v[66:67]
    s_add_u32 m0, s44, 117760
    s_nop 0
    buffer_load_dwordx4 v11, s[12:15], s49 offen offset:1024 sc1 lds
    ds_read_b64 v[38:39], v17 offset:8192
    ds_read_b128 v[60:63], v7 offset:1024
    ds_read_b64 v[42:43], v17 offset:10240
    ds_read_b128 v[64:67], v7 offset:1280
    s_add_u32 m0, s44, 122880
    s_add_u32 s49, s41, 327680
    s_waitcnt vmcnt(15)
    s_barrier
    buffer_load_dwordx4 v10, s[12:15], s49 offen offset:0 sc1 lds
    s_waitcnt lgkmcnt(0)
    v_lshlrev_b32 v36, 16, v38
    v_and_b32 v37, 0xffff0000, v38
    v_lshlrev_b32 v38, 16, v39
    v_and_b32 v39, 0xffff0000, v39
    s_add_u32 m0, s44, 130048
    s_nop 0
    buffer_load_dwordx4 v10, s[12:15], s49 offen offset:1024 sc1 lds
    v_pk_fma_f32 v[36:37], v[36:37], v[60:61], v[62:63]
    v_pk_fma_f32 v[38:39], v[38:39], v[60:61], v[62:63]
    v_lshlrev_b32 v40, 16, v42
    v_and_b32 v41, 0xffff0000, v42
    v_lshlrev_b32 v42, 16, v43
    s_add_u32 m0, s44, 126976
    s_nop 0
    buffer_load_dwordx4 v11, s[12:15], s49 offen offset:0 sc1 lds
    v_and_b32 v43, 0xffff0000, v43
    v_pk_fma_f32 v[40:41], v[40:41], v[64:65], v[66:67]
    v_pk_fma_f32 v[42:43], v[42:43], v[64:65], v[66:67]
    s_add_u32 m0, s44, 134144
    s_nop 0
    buffer_load_dwordx4 v11, s[12:15], s49 offen offset:1024 sc1 lds
    ds_read_b64 v[46:47], v17 offset:12288
    ds_read_b128 v[60:63], v7 offset:1536
    ds_read_b64 v[50:51], v17 offset:14336
    ds_read_b128 v[64:67], v7 offset:1792
    s_add_u32 m0, s44, 139264
    s_add_u32 s49, s42, 327680
    s_waitcnt vmcnt(15)
    s_barrier
    buffer_load_dwordx4 v10, s[12:15], s49 offen offset:0 sc1 lds
    s_waitcnt lgkmcnt(0)
    v_lshlrev_b32 v44, 16, v46
    v_and_b32 v45, 0xffff0000, v46
    v_lshlrev_b32 v46, 16, v47
    v_and_b32 v47, 0xffff0000, v47
    s_add_u32 m0, s44, 146432
    s_nop 0
    buffer_load_dwordx4 v10, s[12:15], s49 offen offset:1024 sc1 lds
    v_pk_fma_f32 v[44:45], v[44:45], v[60:61], v[62:63]
    v_pk_fma_f32 v[46:47], v[46:47], v[60:61], v[62:63]
    v_lshlrev_b32 v48, 16, v50
    v_and_b32 v49, 0xffff0000, v50
    v_lshlrev_b32 v50, 16, v51
    s_add_u32 m0, s44, 143360
    s_nop 0
    buffer_load_dwordx4 v11, s[12:15], s49 offen offset:0 sc1 lds
    v_and_b32 v51, 0xffff0000, v51
    v_pk_fma_f32 v[48:49], v[48:49], v[64:65], v[66:67]
    v_pk_fma_f32 v[50:51], v[50:51], v[64:65], v[66:67]
    s_add_u32 m0, s44, 150528
    s_nop 0
    buffer_load_dwordx4 v11, s[12:15], s49 offen offset:1024 sc1 lds
    s_add_u32 m0, s44, 16384
    s_add_u32 s49, s43, 327680
    s_waitcnt vmcnt(8)
    s_barrier
    s_load_dword s32, s[4:5], s84 offset:2048
    s_load_dword s3, s[4:5], s84 offset:2176
    buffer_load_dwordx4 v10, s[12:15], s49 offen offset:0 sc1 lds
    s_add_u32 m0, s44, 23552
    s_nop 0
    buffer_load_dwordx4 v10, s[12:15], s49 offen offset:1024 sc1 lds
    s_add_u32 m0, s44, 20480
    s_nop 0
    buffer_load_dwordx4 v11, s[12:15], s49 offen offset:0 sc1 lds
    s_add_u32 m0, s44, 27648
    s_nop 0
    buffer_load_dwordx4 v11, s[12:15], s49 offen offset:1024 sc1 lds
    s_mov_b32 s88, 1
    s_call_b64 s[76:77], SUB_w3_sub_3
    s_add_u32 m0, s82, 32768
    s_add_u32 s49, s78, 0
    s_waitcnt vmcnt(15)
    s_barrier
    s_waitcnt lgkmcnt(0)
    s_cmp_eq_u32 s32, s85
    s_cselect_b32 s32, s3, 0
    s_cmp_eq_u32 s32, s85
    s_cbranch_scc1 hok_35
    s_add_u32 s53, s84, 2048
    v_lshlrev_b32 v109, 7, v1
    v_add_u32 v109, s53, v109
    s_mov_b32 s53, 0
    s_add_u32 s54, s52, 16
    s_bfm_b64 exec, 2, 0
poll_36:
    buffer_load_dword v108, v109, s[56:59], 0 offen sc1
    s_waitcnt vmcnt(0)
    v_cmp_eq_u32 vcc, s54, v108
    s_nop 0
    s_cmp_eq_u64 vcc, exec
    s_cbranch_scc1 pok_37
    s_sleep 8
    s_add_u32 s53, s53, 1
    s_cmp_lt_u32 s53, s61
    s_cbranch_scc1 poll_36
    s_mov_b32 s61, 0
pok_37:
    s_mov_b64 exec, -1
hok_35:
    buffer_load_dwordx4 v2, s[16:19], s49 offen offset:0 sc1 lds
    buffer_load_dwordx4 v2, s[16:19], s49 offen offset:1024 sc1 lds
    buffer_load_dwordx4 v2, s[16:19], s49 offen offset:2048 sc1 lds
    buffer_load_dwordx4 v2, s[16:19], s49 offen offset:3072 sc1 lds
    s_add_u32 m0, s82, 106496
    s_add_u32 s49, s79, 0
    s_waitcnt vmcnt(15)
    s_barrier
    buffer_load_dwordx4 v2, s[16:19], s49 offen offset:0 sc1 lds
    buffer_load_dwordx4 v2, s[16:19], s49 offen offset:1024 sc1 lds
    buffer_load_dwordx4 v2, s[16:19], s49 offen offset:2048 sc1 lds
    buffer_load_dwordx4 v2, s[16:19], s49 offen offset:3072 sc1 lds
    s_add_u32 m0, s82, 122880
    s_add_u32 s49, s80, 0
    s_waitcnt vmcnt(15)
    s_barrier
    buffer_load_dwordx4 v2, s[16:19], s49 offen offset:0 sc1 lds
    buffer_load_dwordx4 v2, s[16:19], s49 offen offset:1024 sc1 lds
    buffer_load_dwordx4 v2, s[16:19], s49 offen offset:2048 sc1 lds
    buffer_load_dwordx4 v2, s[16:19], s49 offen offset:3072 sc1 lds
    s_setprio 0
    s_waitcnt vmcnt(8)
    s_barrier
    ds_read_b128 v[52:55], v14 offset:32768
    ds_read_b128 v[56:59], v14 offset:36864
    ds_read_b128 v[60:63], v14 offset:40960
    ds_read_b128 v[64:67], v14 offset:45056
    ds_read_b128 v[68:71], v14 offset:33792
    ds_read_b128 v[72:75], v14 offset:37888
    ds_read_b128 v[76:79], v14 offset:41984
    ds_read_b128 v[80:83], v14 offset:46080
    s_waitcnt lgkmcnt(4)
    v_mfma_f32_16x16x32_bf16 v[20:23], v[128:131], v[52:55], v[20:23]
    ds_read_b128 v[84:87], v14 offset:34816
    v_mfma_f32_16x16x32_bf16 v[24:27], v[128:131], v[56:59], v[24:27]
    ds_read_b128 v[88:91], v14 offset:38912
    v_mfma_f32_16x16x32_bf16 v[24:27], v[132:135], v[64:67], v[24:27]
    ds_read_b128 v[92:95], v14 offset:43008
    v_mfma_f32_16x16x32_bf16 v[20:23], v[132:135], v[60:63], v[20:23]
    ds_read_b128 v[96:99], v14 offset:47104
    s_waitcnt lgkmcnt(4)
    v_mfma_f32_16x16x32_bf16 v[20:23], v[136:139], v[68:71], v[20:23]
    ds_read_b128 v[52:55], v14 offset:35840
    v_mfma_f32_16x16x32_bf16 v[24:27], v[136:139], v[72:75], v[24:27]
    ds_read_b128 v[56:59], v14 offset:39936
    v_mfma_f32_16x16x32_bf16 v[24:27], v[140:143], v[80:83], v[24:27]
    ds_read_b128 v[60:63], v14 offset:44032
    v_mfma_f32_16x16x32_bf16 v[20:23], v[140:143], v[76:79], v[20:23]
    ds_read_b128 v[64:67], v14 offset:48128
    s_waitcnt vmcnt(4)
    s_barrier
    s_waitcnt lgkmcnt(4)
    v_mfma_f32_16x16x32_bf16 v[20:23], v[144:147], v[84:87], v[20:23]
    ds_read_b128 v[68:71], v15 offset:0
    v_mfma_f32_16x16x32_bf16 v[24:27], v[144:147], v[88:91], v[24:27]
    ds_read_b128 v[72:75], v15 offset:4096
    v_mfma_f32_16x16x32_bf16 v[24:27], v[148:151], v[96:99], v[24:27]
    ds_read_b128 v[76:79], v15 offset:8192
    v_mfma_f32_16x16x32_bf16 v[20:23], v[148:151], v[92:95], v[20:23]
    ds_read_b128 v[80:83], v15 offset:12288
    s_waitcnt lgkmcnt(4)
    v_mfma_f32_16x16x32_bf16 v[20:23], v[152:155], v[52:55], v[20:23]
    ds_read_b128 v[84:87], v15 offset:1024
    v_mfma_f32_16x16x32_bf16 v[24:27], v[152:155], v[56:59], v[24:27]
    ds_read_b128 v[88:91], v15 offset:5120
    v_mfma_f32_16x16x32_bf16 v[24:27], v[156:159], v[64:67], v[24:27]
    ds_read_b128 v[92:95], v15 offset:9216
    v_mfma_f32_16x16x32_bf16 v[20:23], v[156:159], v[60:63], v[20:23]
    ds_read_b128 v[96:99], v15 offset:13312
    s_waitcnt lgkmcnt(4)
    v_mfma_f32_16x16x32_bf16 v[20:23], v[160:163], v[68:71], v[20:23]
    ds_read_b128 v[52:55], v15 offset:2048
    v_mfma_f32_16x16x32_bf16 v[24:27], v[160:163], v[72:75], v[24:27]
    ds_read_b128 v[56:59], v15 offset:6144
    v_mfma_f32_16x16x32_bf16 v[24:27], v[164:167], v[80:83], v[24:27]
    ds_read_b128 v[60:63], v15 offset:10240
    v_mfma_f32_16x16x32_bf16 v[20:23], v[164:167], v[76:79], v[20:23]
    ds_read_b128 v[64:67], v15 offset:14336
    s_waitcnt lgkmcnt(4)
    v_mfma_f32_16x16x32_bf16 v[20:23], v[168:171], v[84:87], v[20:23]
    ds_read_b128 v[68:71], v15 offset:3072
    v_mfma_f32_16x16x32_bf16 v[24:27], v[168:171], v[88:91], v[24:27]
    ds_read_b128 v[72:75], v15 offset:7168
    v_mfma_f32_16x16x32_bf16 v[24:27], v[172:175], v[96:99], v[24:27]
    ds_read_b128 v[76:79], v15 offset:11264
    v_mfma_f32_16x16x32_bf16 v[20:23], v[172:175], v[92:95], v[20:23]
    ds_read_b128 v[80:83], v15 offset:15360
    s_waitcnt vmcnt(0)
    s_barrier
    s_waitcnt lgkmcnt(4)
    v_mfma_f32_16x16x32_bf16 v[20:23], v[176:179], v[52:55], v[20:23]
    ds_read_b128 v[84:87], v15 offset:16384
    v_mfma_f32_16x16x32_bf16 v[24:27], v[176:179], v[56:59], v[24:27]
    ds_read_b128 v[88:91], v15 offset:20480
    v_mfma_f32_16x16x32_bf16 v[24:27], v[180:183], v[64:67], v[24:27]
    ds_read_b128 v[92:95], v15 offset:24576
    v_mfma_f32_16x16x32_bf16 v[20:23], v[180:183], v[60:63], v[20:23]
    ds_read_b128 v[96:99], v15 offset:28672
    s_waitcnt lgkmcnt(4)
    v_mfma_f32_16x16x32_bf16 v[20:23], v[184:187], v[68:71], v[20:23]
    ds_read_b128 v[52:55], v15 offset:17408
    v_mfma_f32_16x16x32_bf16 v[24:27], v[184:187], v[72:75], v[24:27]
    ds_read_b128 v[56:59], v15 offset:21504
    v_mfma_f32_16x16x32_bf16 v[24:27], v[188:191], v[80:83], v[24:27]
    ds_read_b128 v[60:63], v15 offset:25600
    v_mfma_f32_16x16x32_bf16 v[20:23], v[188:191], v[76:79], v[20:23]
    ds_read_b128 v[64:67], v15 offset:29696
    s_waitcnt lgkmcnt(4)
    v_mfma_f32_16x16x32_bf16 v[20:23], v[192:195], v[84:87], v[20:23]
    ds_read_b128 v[68:71], v15 offset:18432
    v_mfma_f32_16x16x32_bf16 v[24:27], v[192:195], v[88:91], v[24:27]
    ds_read_b128 v[72:75], v15 offset:22528
    v_mfma_f32_16x16x32_bf16 v[24:27], v[196:199], v[96:99], v[24:27]
    ds_read_b128 v[76:79], v15 offset:26624
    v_mfma_f32_16x16x32_bf16 v[20:23], v[196:199], v[92:95], v[20:23]
    ds_read_b128 v[80:83], v15 offset:30720
    s_waitcnt lgkmcnt(4)
    v_mfma_f32_16x16x32_bf16 v[20:23], v[200:203], v[52:55], v[20:23]
    ds_read_b128 v[84:87], v15 offset:19456
    v_mfma_f32_16x16x32_bf16 v[24:27], v[200:203], v[56:59], v[24:27]
    ds_read_b128 v[88:91], v15 offset:23552
    v_mfma_f32_16x16x32_bf16 v[24:27], v[204:207], v[64:67], v[24:27]
    ds_read_b128 v[92:95], v15 offset:27648
    v_mfma_f32_16x16x32_bf16 v[20:23], v[204:207], v[60:63], v[20:23]
    ds_read_b128 v[96:99], v15 offset:31744
    s_barrier
    s_waitcnt lgkmcnt(4)
    v_mfma_f32_16x16x32_bf16 v[20:23], v[208:211], v[68:71], v[20:23]
    ds_read_b128 v[52:55], v15 offset:32768
    v_mfma_f32_16x16x32_bf16 v[24:27], v[208:211], v[72:75], v[24:27]
    ds_read_b128 v[56:59], v15 offset:36864
    v_mfma_f32_16x16x32_bf16 v[24:27], v[212:215], v[80:83], v[24:27]
    ds_read_b128 v[60:63], v15 offset:40960
    v_mfma_f32_16x16x32_bf16 v[20:23], v[212:215], v[76:79], v[20:23]
    ds_read_b128 v[64:67], v15 offset:45056
    s_waitcnt lgkmcnt(4)
    v_mfma_f32_16x16x32_bf16 v[20:23], v[216:219], v[84:87], v[20:23]
    ds_read_b128 v[68:71], v15 offset:33792
    v_mfma_f32_16x16x32_bf16 v[24:27], v[216:219], v[88:91], v[24:27]
    ds_read_b128 v[72:75], v15 offset:37888
    v_mfma_f32_16x16x32_bf16 v[24:27], v[220:223], v[96:99], v[24:27]
    ds_read_b128 v[76:79], v15 offset:41984
    v_mfma_f32_16x16x32_bf16 v[20:23], v[220:223], v[92:95], v[20:23]
    ds_read_b128 v[80:83], v15 offset:46080
    s_waitcnt lgkmcnt(4)
    v_mfma_f32_16x16x32_bf16 v[20:23], v[224:227], v[52:55], v[20:23]
    ds_read_b128 v[84:87], v15 offset:34816
    v_mfma_f32_16x16x32_bf16 v[24:27], v[224:227], v[56:59], v[24:27]
    ds_read_b128 v[88:91], v15 offset:38912
    v_mfma_f32_16x16x32_bf16 v[24:27], v[228:231], v[64:67], v[24:27]
    ds_read_b128 v[92:95], v15 offset:43008
    v_mfma_f32_16x16x32_bf16 v[20:23], v[228:231], v[60:63], v[20:23]
    ds_read_b128 v[96:99], v15 offset:47104
    s_waitcnt lgkmcnt(4)
    v_mfma_f32_16x16x32_bf16 v[20:23], v[232:235], v[68:71], v[20:23]
    ds_read_b128 v[52:55], v15 offset:35840
    v_mfma_f32_16x16x32_bf16 v[24:27], v[232:235], v[72:75], v[24:27]
    ds_read_b128 v[56:59], v15 offset:39936
    v_mfma_f32_16x16x32_bf16 v[24:27], v[236:239], v[80:83], v[24:27]
    ds_read_b128 v[60:63], v15 offset:44032
    v_mfma_f32_16x16x32_bf16 v[20:23], v[236:239], v[76:79], v[20:23]
    ds_read_b128 v[64:67], v15 offset:48128
    s_barrier
    s_waitcnt lgkmcnt(4)
    v_mfma_f32_16x16x32_bf16 v[20:23], v[240:243], v[84:87], v[20:23]
    ds_read_b128 v[68:71], v14 offset:16384
    v_mfma_f32_16x16x32_bf16 v[24:27], v[240:243], v[88:91], v[24:27]
    ds_read_b128 v[72:75], v14 offset:20480
    v_mfma_f32_16x16x32_bf16 v[24:27], v[244:247], v[96:99], v[24:27]
    ds_read_b128 v[76:79], v14 offset:24576
    v_mfma_f32_16x16x32_bf16 v[20:23], v[244:247], v[92:95], v[20:23]
    ds_read_b128 v[80:83], v14 offset:28672
    s_waitcnt lgkmcnt(4)
    v_mfma_f32_16x16x32_bf16 v[20:23], v[248:251], v[52:55], v[20:23]
    ds_read_b128 v[84:87], v14 offset:17408
    v_mfma_f32_16x16x32_bf16 v[24:27], v[248:251], v[56:59], v[24:27]
    ds_read_b128 v[88:91], v14 offset:21504
    v_mfma_f32_16x16x32_bf16 v[24:27], v[252:255], v[64:67], v[24:27]
    ds_read_b128 v[92:95], v14 offset:25600
    v_mfma_f32_16x16x32_bf16 v[20:23], v[252:255], v[60:63], v[20:23]
    ds_read_b128 v[96:99], v14 offset:29696
    s_waitcnt lgkmcnt(4)
    v_mfma_f32_16x16x32_bf16 v[28:31], v[128:131], v[68:71], v[28:31]
    ds_read_b128 v[52:55], v14 offset:18432
    v_mfma_f32_16x16x32_bf16 v[32:35], v[128:131], v[72:75], v[32:35]
    ds_read_b128 v[56:59], v14 offset:22528
    v_mfma_f32_16x16x32_bf16 v[32:35], v[132:135], v[80:83], v[32:35]
    ds_read_b128 v[60:63], v14 offset:26624
    v_mfma_f32_16x16x32_bf16 v[28:31], v[132:135], v[76:79], v[28:31]
    ds_read_b128 v[64:67], v14 offset:30720
    v_cvt_pk_bf16_f32 v20, v20, v21
    v_cvt_pk_bf16_f32 v21, v22, v23
    v_cvt_pk_bf16_f32 v22, v24, v25
    v_cvt_pk_bf16_f32 v23, v26, v27
    s_add_u32 s36, s39, 0
    v_permlane16_swap_b32 v20, v22
    v_permlane16_swap_b32 v21, v23
    s_waitcnt lgkmcnt(4)
    v_mfma_f32_16x16x32_bf16 v[28:31], v[136:139], v[84:87], v[28:31]
    ds_read_b128 v[68:71], v14 offset:19456
    v_mfma_f32_16x16x32_bf16 v[32:35], v[136:139], v[88:91], v[32:35]
    ds_read_b128 v[72:75], v14 offset:23552
    v_mfma_f32_16x16x32_bf16 v[32:35], v[140:143], v[96:99], v[32:35]
    ds_read_b128 v[76:79], v14 offset:27648
    v_mfma_f32_16x16x32_bf16 v[28:31], v[140:143], v[92:95], v[28:31]
    ds_read_b128 v[80:83], v14 offset:31744
    s_barrier
    s_waitcnt lgkmcnt(4)
    v_mfma_f32_16x16x32_bf16 v[28:31], v[144:147], v[52:55], v[28:31]
    ds_read_b128 v[84:87], v14 offset:32768
    v_mfma_f32_16x16x32_bf16 v[32:35], v[144:147], v[56:59], v[32:35]
    ds_read_b128 v[88:91], v14 offset:36864
    v_mfma_f32_16x16x32_bf16 v[32:35], v[148:151], v[64:67], v[32:35]
    ds_read_b128 v[92:95], v14 offset:40960
    v_mfma_f32_16x16x32_bf16 v[28:31], v[148:151], v[60:63], v[28:31]
    ds_read_b128 v[96:99], v14 offset:45056
    s_waitcnt lgkmcnt(4)
    v_mfma_f32_16x16x32_bf16 v[28:31], v[152:155], v[68:71], v[28:31]
    ds_read_b128 v[52:55], v14 offset:33792
    v_mfma_f32_16x16x32_bf16 v[32:35], v[152:155], v[72:75], v[32:35]
    ds_read_b128 v[56:59], v14 offset:37888
    v_mfma_f32_16x16x32_bf16 v[32:35], v[156:159], v[80:83], v[32:35]
    ds_read_b128 v[60:63], v14 offset:41984
    v_mfma_f32_16x16x32_bf16 v[28:31], v[156:159], v[76:79], v[28:31]
    ds_read_b128 v[64:67], v14 offset:46080
    s_waitcnt lgkmcnt(4)
    v_mfma_f32_16x16x32_bf16 v[28:31], v[160:163], v[84:87], v[28:31]
    ds_read_b128 v[68:71], v14 offset:34816
    v_mfma_f32_16x16x32_bf16 v[32:35], v[160:163], v[88:91], v[32:35]
    ds_read_b128 v[72:75], v14 offset:38912
    v_mfma_f32_16x16x32_bf16 v[32:35], v[164:167], v[96:99], v[32:35]
    ds_read_b128 v[76:79], v14 offset:43008
    v_mfma_f32_16x16x32_bf16 v[28:31], v[164:167], v[92:95], v[28:31]
    ds_read_b128 v[80:83], v14 offset:47104
    s_waitcnt lgkmcnt(4)
    v_mfma_f32_16x16x32_bf16 v[28:31], v[168:171], v[52:55], v[28:31]
    ds_read_b128 v[84:87], v14 offset:35840
    v_mfma_f32_16x16x32_bf16 v[32:35], v[168:171], v[56:59], v[32:35]
    ds_read_b128 v[88:91], v14 offset:39936
    v_mfma_f32_16x16x32_bf16 v[32:35], v[172:175], v[64:67], v[32:35]
    ds_read_b128 v[92:95], v14 offset:44032
    v_mfma_f32_16x16x32_bf16 v[28:31], v[172:175], v[60:63], v[28:31]
    ds_read_b128 v[96:99], v14 offset:48128
    s_barrier
    s_waitcnt lgkmcnt(4)
    v_mfma_f32_16x16x32_bf16 v[28:31], v[176:179], v[68:71], v[28:31]
    ds_read_b128 v[52:55], v15 offset:0
    v_mfma_f32_16x16x32_bf16 v[32:35], v[176:179], v[72:75], v[32:35]
    ds_read_b128 v[56:59], v15 offset:4096
    v_mfma_f32_16x16x32_bf16 v[32:35], v[180:183], v[80:83], v[32:35]
    ds_read_b128 v[60:63], v15 offset:8192
    v_mfma_f32_16x16x32_bf16 v[28:31], v[180:183], v[76:79], v[28:31]
    ds_read_b128 v[64:67], v15 offset:12288
    s_waitcnt lgkmcnt(4)
    v_mfma_f32_16x16x32_bf16 v[28:31], v[184:187], v[84:87], v[28:31]
    ds_read_b128 v[68:71], v15 offset:1024
    v_mfma_f32_16x16x32_bf16 v[32:35], v[184:187], v[88:91], v[32:35]
    ds_read_b128 v[72:75], v15 offset:5120
    v_mfma_f32_16x16x32_bf16 v[32:35], v[188:191], v[96:99], v[32:35]
    ds_read_b128 v[76:79], v15 offset:9216
    v_mfma_f32_16x16x32_bf16 v[28:31], v[188:191], v[92:95], v[28:31]
    ds_read_b128 v[80:83], v15 offset:13312
    s_waitcnt lgkmcnt(4)
    v_mfma_f32_16x16x32_bf16 v[28:31], v[192:195], v[52:55], v[28:31]
    ds_read_b128 v[84:87], v15 offset:2048
    v_mfma_f32_16x16x32_bf16 v[32:35], v[192:195], v[56:59], v[32:35]
    ds_read_b128 v[88:91], v15 offset:6144
    v_mfma_f32_16x16x32_bf16 v[32:35], v[196:199], v[64:67], v[32:35]
    ds_read_b128 v[92:95], v15 offset:10240
    v_mfma_f32_16x16x32_bf16 v[28:31], v[196:199], v[60:63], v[28:31]
    ds_read_b128 v[96:99], v15 offset:14336
    s_waitcnt lgkmcnt(4)
    v_mfma_f32_16x16x32_bf16 v[28:31], v[200:203], v[68:71], v[28:31]
    ds_read_b128 v[52:55], v15 offset:3072
    v_mfma_f32_16x16x32_bf16 v[32:35], v[200:203], v[72:75], v[32:35]
    ds_read_b128 v[56:59], v15 offset:7168
    v_mfma_f32_16x16x32_bf16 v[32:35], v[204:207], v[80:83], v[32:35]
    ds_read_b128 v[60:63], v15 offset:11264
    v_mfma_f32_16x16x32_bf16 v[28:31], v[204:207], v[76:79], v[28:31]
    ds_read_b128 v[64:67], v15 offset:15360
    s_barrier
    s_waitcnt lgkmcnt(4)
    v_mfma_f32_16x16x32_bf16 v[28:31], v[208:211], v[84:87], v[28:31]
    ds_read_b128 v[68:71], v15 offset:16384
    v_mfma_f32_16x16x32_bf16 v[32:35], v[208:211], v[88:91], v[32:35]
    ds_read_b128 v[72:75], v15 offset:20480
    v_mfma_f32_16x16x32_bf16 v[32:35], v[212:215], v[96:99], v[32:35]
    ds_read_b128 v[76:79], v15 offset:24576
    v_mfma_f32_16x16x32_bf16 v[28:31], v[212:215], v[92:95], v[28:31]
    ds_read_b128 v[80:83], v15 offset:28672
    s_waitcnt lgkmcnt(4)
    v_mfma_f32_16x16x32_bf16 v[28:31], v[216:219], v[52:55], v[28:31]
    ds_read_b128 v[84:87], v15 offset:17408
    v_mfma_f32_16x16x32_bf16 v[32:35], v[216:219], v[56:59], v[32:35]
    ds_read_b128 v[88:91], v15 offset:21504
    v_mfma_f32_16x16x32_bf16 v[32:35], v[220:223], v[64:67], v[32:35]
    ds_read_b128 v[92:95], v15 offset:25600
    v_mfma_f32_16x16x32_bf16 v[28:31], v[220:223], v[60:63], v[28:31]
    ds_read_b128 v[96:99], v15 offset:29696
    s_waitcnt lgkmcnt(4)
    v_mfma_f32_16x16x32_bf16 v[28:31], v[224:227], v[68:71], v[28:31]
    ds_read_b128 v[52:55], v15 offset:18432
    v_mfma_f32_16x16x32_bf16 v[32:35], v[224:227], v[72:75], v[32:35]
    ds_read_b128 v[56:59], v15 offset:22528
    v_mfma_f32_16x16x32_bf16 v[32:35], v[228:231], v[80:83], v[32:35]
    ds_read_b128 v[60:63], v15 offset:26624
    v_mfma_f32_16x16x32_bf16 v[28:31], v[228:231], v[76:79], v[28:31]
    ds_read_b128 v[64:67], v15 offset:30720
    s_waitcnt lgkmcnt(4)
    v_mfma_f32_16x16x32_bf16 v[28:31], v[232:235], v[84:87], v[28:31]
    ds_read_b128 v[68:71], v15 offset:19456
    v_mfma_f32_16x16x32_bf16 v[32:35], v[232:235], v[88:91], v[32:35]
    ds_read_b128 v[72:75], v15 offset:23552
    v_mfma_f32_16x16x32_bf16 v[32:35], v[236:239], v[96:99], v[32:35]
    ds_read_b128 v[76:79], v15 offset:27648
    v_mfma_f32_16x16x32_bf16 v[28:31], v[236:239], v[92:95], v[28:31]
    ds_read_b128 v[80:83], v15 offset:31744
    s_barrier
    s_waitcnt lgkmcnt(4)
    v_mfma_f32_16x16x32_bf16 v[28:31], v[240:243], v[52:55], v[28:31]
    ds_read_b128 v[84:87], v15 offset:32768
    v_mfma_f32_16x16x32_bf16 v[32:35], v[240:243], v[56:59], v[32:35]
    ds_read_b128 v[88:91], v15 offset:36864
    v_mfma_f32_16x16x32_bf16 v[32:35], v[244:247], v[64:67], v[32:35]
    ds_read_b128 v[92:95], v15 offset:40960
    v_mfma_f32_16x16x32_bf16 v[28:31], v[244:247], v[60:63], v[28:31]
    ds_read_b128 v[96:99], v15 offset:45056
    s_waitcnt lgkmcnt(4)
    v_mfma_f32_16x16x32_bf16 v[28:31], v[248:251], v[68:71], v[28:31]
    ds_read_b128 v[52:55], v15 offset:33792
    v_mfma_f32_16x16x32_bf16 v[32:35], v[248:251], v[72:75], v[32:35]
    ds_read_b128 v[56:59], v15 offset:37888
    v_mfma_f32_16x16x32_bf16 v[32:35], v[252:255], v[80:83], v[32:35]
    ds_read_b128 v[60:63], v15 offset:41984
    v_mfma_f32_16x16x32_bf16 v[28:31], v[252:255], v[76:79], v[28:31]
    ds_read_b128 v[64:67], v15 offset:46080
    s_waitcnt lgkmcnt(4)
    v_mfma_f32_16x16x32_bf16 v[36:39], v[128:131], v[84:87], v[36:39]
    ds_read_b128 v[68:71], v15 offset:34816
    v_mfma_f32_16x16x32_bf16 v[40:43], v[128:131], v[88:91], v[40:43]
    ds_read_b128 v[72:75], v15 offset:38912
    v_mfma_f32_16x16x32_bf16 v[40:43], v[132:135], v[96:99], v[40:43]
    ds_read_b128 v[76:79], v15 offset:43008
    v_mfma_f32_16x16x32_bf16 v[36:39], v[132:135], v[92:95], v[36:39]
    ds_read_b128 v[80:83], v15 offset:47104
    v_cvt_pk_bf16_f32 v28, v28, v29
    v_cvt_pk_bf16_f32 v29, v30, v31
    v_cvt_pk_bf16_f32 v30, v32, v33
    v_cvt_pk_bf16_f32 v31, v34, v35
    s_add_u32 s36, s39, 131072
    v_permlane16_swap_b32 v28, v30
    v_permlane16_swap_b32 v29, v31
    s_waitcnt lgkmcnt(4)
    v_mfma_f32_16x16x32_bf16 v[36:39], v[136:139], v[52:55], v[36:39]
    ds_read_b128 v[84:87], v15 offset:35840
    v_mfma_f32_16x16x32_bf16 v[40:43], v[136:139], v[56:59], v[40:43]
    ds_read_b128 v[88:91], v15 offset:39936
    v_mfma_f32_16x16x32_bf16 v[40:43], v[140:143], v[64:67], v[40:43]
    ds_read_b128 v[92:95], v15 offset:44032
    v_mfma_f32_16x16x32_bf16 v[36:39], v[140:143], v[60:63], v[36:39]
    ds_read_b128 v[96:99], v15 offset:48128
    s_barrier
    s_waitcnt lgkmcnt(4)
    v_mfma_f32_16x16x32_bf16 v[36:39], v[144:147], v[68:71], v[36:39]
    ds_read_b128 v[52:55], v14 offset:16384
    v_mfma_f32_16x16x32_bf16 v[40:43], v[144:147], v[72:75], v[40:43]
    ds_read_b128 v[56:59], v14 offset:20480
    v_mfma_f32_16x16x32_bf16 v[40:43], v[148:151], v[80:83], v[40:43]
    ds_read_b128 v[60:63], v14 offset:24576
    v_mfma_f32_16x16x32_bf16 v[36:39], v[148:151], v[76:79], v[36:39]
    ds_read_b128 v[64:67], v14 offset:28672
    s_waitcnt lgkmcnt(4)
    v_mfma_f32_16x16x32_bf16 v[36:39], v[152:155], v[84:87], v[36:39]
    ds_read_b128 v[68:71], v14 offset:17408
    v_mfma_f32_16x16x32_bf16 v[40:43], v[152:155], v[88:91], v[40:43]
    ds_read_b128 v[72:75], v14 offset:21504
    v_mfma_f32_16x16x32_bf16 v[40:43], v[156:159], v[96:99], v[40:43]
    ds_read_b128 v[76:79], v14 offset:25600
    v_mfma_f32_16x16x32_bf16 v[36:39], v[156:159], v[92:95], v[36:39]
    ds_read_b128 v[80:83], v14 offset:29696
    s_waitcnt lgkmcnt(4)
    v_mfma_f32_16x16x32_bf16 v[36:39], v[160:163], v[52:55], v[36:39]
    ds_read_b128 v[84:87], v14 offset:18432
    v_mfma_f32_16x16x32_bf16 v[40:43], v[160:163], v[56:59], v[40:43]
    ds_read_b128 v[88:91], v14 offset:22528
    v_mfma_f32_16x16x32_bf16 v[40:43], v[164:167], v[64:67], v[40:43]
    ds_read_b128 v[92:95], v14 offset:26624
    v_mfma_f32_16x16x32_bf16 v[36:39], v[164:167], v[60:63], v[36:39]
    ds_read_b128 v[96:99], v14 offset:30720
    s_waitcnt lgkmcnt(4)
    v_mfma_f32_16x16x32_bf16 v[36:39], v[168:171], v[68:71], v[36:39]
    ds_read_b128 v[52:55], v14 offset:19456
    v_mfma_f32_16x16x32_bf16 v[40:43], v[168:171], v[72:75], v[40:43]
    ds_read_b128 v[56:59], v14 offset:23552
    v_mfma_f32_16x16x32_bf16 v[40:43], v[172:175], v[80:83], v[40:43]
    ds_read_b128 v[60:63], v14 offset:27648
    v_mfma_f32_16x16x32_bf16 v[36:39], v[172:175], v[76:79], v[36:39]
    ds_read_b128 v[64:67], v14 offset:31744
    s_barrier
    s_waitcnt lgkmcnt(4)
    v_mfma_f32_16x16x32_bf16 v[36:39], v[176:179], v[84:87], v[36:39]
    ds_read_b128 v[68:71], v14 offset:32768
    v_mfma_f32_16x16x32_bf16 v[40:43], v[176:179], v[88:91], v[40:43]
    ds_read_b128 v[72:75], v14 offset:36864
    v_mfma_f32_16x16x32_bf16 v[40:43], v[180:183], v[96:99], v[40:43]
    ds_read_b128 v[76:79], v14 offset:40960
    v_mfma_f32_16x16x32_bf16 v[36:39], v[180:183], v[92:95], v[36:39]
    ds_read_b128 v[80:83], v14 offset:45056
    s_waitcnt lgkmcnt(4)
    v_mfma_f32_16x16x32_bf16 v[36:39], v[184:187], v[52:55], v[36:39]
    ds_read_b128 v[84:87], v14 offset:33792
    v_mfma_f32_16x16x32_bf16 v[40:43], v[184:187], v[56:59], v[40:43]
    ds_read_b128 v[88:91], v14 offset:37888
    v_mfma_f32_16x16x32_bf16 v[40:43], v[188:191], v[64:67], v[40:43]
    ds_read_b128 v[92:95], v14 offset:41984
    v_mfma_f32_16x16x32_bf16 v[36:39], v[188:191], v[60:63], v[36:39]
    ds_read_b128 v[96:99], v14 offset:46080
    s_waitcnt lgkmcnt(4)
    v_mfma_f32_16x16x32_bf16 v[36:39], v[192:195], v[68:71], v[36:39]
    ds_read_b128 v[52:55], v14 offset:34816
    v_mfma_f32_16x16x32_bf16 v[40:43], v[192:195], v[72:75], v[40:43]
    ds_read_b128 v[56:59], v14 offset:38912
    v_mfma_f32_16x16x32_bf16 v[40:43], v[196:199], v[80:83], v[40:43]
    ds_read_b128 v[60:63], v14 offset:43008
    v_mfma_f32_16x16x32_bf16 v[36:39], v[196:199], v[76:79], v[36:39]
    ds_read_b128 v[64:67], v14 offset:47104
    s_waitcnt lgkmcnt(4)
    v_mfma_f32_16x16x32_bf16 v[36:39], v[200:203], v[84:87], v[36:39]
    ds_read_b128 v[68:71], v14 offset:35840
    v_mfma_f32_16x16x32_bf16 v[40:43], v[200:203], v[88:91], v[40:43]
    ds_read_b128 v[72:75], v14 offset:39936
    v_mfma_f32_16x16x32_bf16 v[40:43], v[204:207], v[96:99], v[40:43]
    ds_read_b128 v[76:79], v14 offset:44032
    v_mfma_f32_16x16x32_bf16 v[36:39], v[204:207], v[92:95], v[36:39]
    ds_read_b128 v[80:83], v14 offset:48128
    s_barrier
    s_waitcnt lgkmcnt(4)
    v_mfma_f32_16x16x32_bf16 v[36:39], v[208:211], v[52:55], v[36:39]
    ds_read_b128 v[84:87], v15 offset:0
    v_mfma_f32_16x16x32_bf16 v[40:43], v[208:211], v[56:59], v[40:43]
    ds_read_b128 v[88:91], v15 offset:4096
    v_mfma_f32_16x16x32_bf16 v[40:43], v[212:215], v[64:67], v[40:43]
    ds_read_b128 v[92:95], v15 offset:8192
    v_mfma_f32_16x16x32_bf16 v[36:39], v[212:215], v[60:63], v[36:39]
    ds_read_b128 v[96:99], v15 offset:12288
    s_waitcnt lgkmcnt(4)
    v_mfma_f32_16x16x32_bf16 v[36:39], v[216:219], v[68:71], v[36:39]
    ds_read_b128 v[52:55], v15 offset:1024
    v_mfma_f32_16x16x32_bf16 v[40:43], v[216:219], v[72:75], v[40:43]
    ds_read_b128 v[56:59], v15 offset:5120
    v_mfma_f32_16x16x32_bf16 v[40:43], v[220:223], v[80:83], v[40:43]
    ds_read_b128 v[60:63], v15 offset:9216
    v_mfma_f32_16x16x32_bf16 v[36:39], v[220:223], v[76:79], v[36:39]
    ds_read_b128 v[64:67], v15 offset:13312
    s_waitcnt lgkmcnt(4)
    v_mfma_f32_16x16x32_bf16 v[36:39], v[224:227], v[84:87], v[36:39]
    ds_read_b128 v[68:71], v15 offset:2048
    v_mfma_f32_16x16x32_bf16 v[40:43], v[224:227], v[88:91], v[40:43]
    ds_read_b128 v[72:75], v15 offset:6144
    v_mfma_f32_16x16x32_bf16 v[40:43], v[228:231], v[96:99], v[40:43]
    ds_read_b128 v[76:79], v15 offset:10240
    v_mfma_f32_16x16x32_bf16 v[36:39], v[228:231], v[92:95], v[36:39]
    ds_read_b128 v[80:83], v15 offset:14336
    s_waitcnt lgkmcnt(4)
    v_mfma_f32_16x16x32_bf16 v[36:39], v[232:235], v[52:55], v[36:39]
    ds_read_b128 v[84:87], v15 offset:3072
    v_mfma_f32_16x16x32_bf16 v[40:43], v[232:235], v[56:59], v[40:43]
    ds_read_b128 v[88:91], v15 offset:7168
    v_mfma_f32_16x16x32_bf16 v[40:43], v[236:239], v[64:67], v[40:43]
    ds_read_b128 v[92:95], v15 offset:11264
    v_mfma_f32_16x16x32_bf16 v[36:39], v[236:239], v[60:63], v[36:39]
    ds_read_b128 v[96:99], v15 offset:15360
    s_barrier
    s_waitcnt lgkmcnt(4)
    v_mfma_f32_16x16x32_bf16 v[36:39], v[240:243], v[68:71], v[36:39]
    ds_read_b128 v[52:55], v15 offset:16384
    v_mfma_f32_16x16x32_bf16 v[40:43], v[240:243], v[72:75], v[40:43]
    ds_read_b128 v[56:59], v15 offset:20480
    v_mfma_f32_16x16x32_bf16 v[40:43], v[244:247], v[80:83], v[40:43]
    ds_read_b128 v[60:63], v15 offset:24576
    v_mfma_f32_16x16x32_bf16 v[36:39], v[244:247], v[76:79], v[36:39]
    ds_read_b128 v[64:67], v15 offset:28672
    s_waitcnt lgkmcnt(4)
    v_mfma_f32_16x16x32_bf16 v[36:39], v[248:251], v[84:87], v[36:39]
    ds_read_b128 v[68:71], v15 offset:17408
    v_mfma_f32_16x16x32_bf16 v[40:43], v[248:251], v[88:91], v[40:43]
    ds_read_b128 v[72:75], v15 offset:21504
    v_mfma_f32_16x16x32_bf16 v[40:43], v[252:255], v[96:99], v[40:43]
    ds_read_b128 v[76:79], v15 offset:25600
    v_mfma_f32_16x16x32_bf16 v[36:39], v[252:255], v[92:95], v[36:39]
    ds_read_b128 v[80:83], v15 offset:29696
    s_waitcnt lgkmcnt(4)
    v_mfma_f32_16x16x32_bf16 v[44:47], v[128:131], v[52:55], v[44:47]
    ds_read_b128 v[84:87], v15 offset:18432
    v_mfma_f32_16x16x32_bf16 v[48:51], v[128:131], v[56:59], v[48:51]
    ds_read_b128 v[88:91], v15 offset:22528
    v_mfma_f32_16x16x32_bf16 v[48:51], v[132:135], v[64:67], v[48:51]
    ds_read_b128 v[92:95], v15 offset:26624
    v_mfma_f32_16x16x32_bf16 v[44:47], v[132:135], v[60:63], v[44:47]
    ds_read_b128 v[96:99], v15 offset:30720
    v_cvt_pk_bf16_f32 v36, v36, v37
    v_cvt_pk_bf16_f32 v37, v38, v39
    v_cvt_pk_bf16_f32 v38, v40, v41
    v_cvt_pk_bf16_f32 v39, v42, v43
    s_add_u32 s36, s39, 262144
    v_permlane16_swap_b32 v36, v38
    v_permlane16_swap_b32 v37, v39
    s_waitcnt lgkmcnt(4)
    v_mfma_f32_16x16x32_bf16 v[44:47], v[136:139], v[68:71], v[44:47]
    ds_read_b128 v[52:55], v15 offset:19456
    v_mfma_f32_16x16x32_bf16 v[48:51], v[136:139], v[72:75], v[48:51]
    ds_read_b128 v[56:59], v15 offset:23552
    v_mfma_f32_16x16x32_bf16 v[48:51], v[140:143], v[80:83], v[48:51]
    ds_read_b128 v[60:63], v15 offset:27648
    v_mfma_f32_16x16x32_bf16 v[44:47], v[140:143], v[76:79], v[44:47]
    ds_read_b128 v[64:67], v15 offset:31744
    s_barrier
    s_waitcnt lgkmcnt(4)
    v_mfma_f32_16x16x32_bf16 v[44:47], v[144:147], v[84:87], v[44:47]
    ds_read_b128 v[68:71], v15 offset:32768
    v_mfma_f32_16x16x32_bf16 v[48:51], v[144:147], v[88:91], v[48:51]
    ds_read_b128 v[72:75], v15 offset:36864
    v_mfma_f32_16x16x32_bf16 v[48:51], v[148:151], v[96:99], v[48:51]
    ds_read_b128 v[76:79], v15 offset:40960
    v_mfma_f32_16x16x32_bf16 v[44:47], v[148:151], v[92:95], v[44:47]
    ds_read_b128 v[80:83], v15 offset:45056
    s_add_u32 s36, s39, 0
    buffer_store_dwordx4 v[20:23], v13, s[24:27], s36 offen sc1
    s_waitcnt lgkmcnt(4)
    v_mfma_f32_16x16x32_bf16 v[44:47], v[152:155], v[52:55], v[44:47]
    ds_read_b128 v[84:87], v15 offset:33792
    v_mfma_f32_16x16x32_bf16 v[48:51], v[152:155], v[56:59], v[48:51]
    ds_read_b128 v[88:91], v15 offset:37888
    v_mfma_f32_16x16x32_bf16 v[48:51], v[156:159], v[64:67], v[48:51]
    ds_read_b128 v[92:95], v15 offset:41984
    v_mfma_f32_16x16x32_bf16 v[44:47], v[156:159], v[60:63], v[44:47]
    ds_read_b128 v[96:99], v15 offset:46080
    s_add_u32 s36, s39, 131072
    buffer_store_dwordx4 v[28:31], v13, s[24:27], s36 offen sc1
    s_waitcnt lgkmcnt(4)
    v_mfma_f32_16x16x32_bf16 v[44:47], v[160:163], v[68:71], v[44:47]
    ds_read_b128 v[52:55], v15 offset:34816
    v_mfma_f32_16x16x32_bf16 v[48:51], v[160:163], v[72:75], v[48:51]
    ds_read_b128 v[56:59], v15 offset:38912
    v_mfma_f32_16x16x32_bf16 v[48:51], v[164:167], v[80:83], v[48:51]
    ds_read_b128 v[60:63], v15 offset:43008
    v_mfma_f32_16x16x32_bf16 v[44:47], v[164:167], v[76:79], v[44:47]
    ds_read_b128 v[64:67], v15 offset:47104
    s_add_u32 s36, s39, 262144
    buffer_store_dwordx4 v[36:39], v13, s[24:27], s36 offen sc1
    s_waitcnt lgkmcnt(4)
    v_mfma_f32_16x16x32_bf16 v[44:47], v[168:171], v[84:87], v[44:47]
    ds_read_b128 v[68:71], v15 offset:35840
    v_mfma_f32_16x16x32_bf16 v[48:51], v[168:171], v[88:91], v[48:51]
    ds_read_b128 v[72:75], v15 offset:39936
    v_mfma_f32_16x16x32_bf16 v[48:51], v[172:175], v[96:99], v[48:51]
    ds_read_b128 v[76:79], v15 offset:44032
    v_mfma_f32_16x16x32_bf16 v[44:47], v[172:175], v[92:95], v[44:47]
    ds_read_b128 v[80:83], v15 offset:48128
    s_barrier
    s_waitcnt lgkmcnt(4)
    v_mfma_f32_16x16x32_bf16 v[44:47], v[176:179], v[52:55], v[44:47]
    ds_read_b128 v[84:87], v14 offset:16384
    v_mfma_f32_16x16x32_bf16 v[48:51], v[176:179], v[56:59], v[48:51]
    ds_read_b128 v[88:91], v14 offset:20480
    v_mfma_f32_16x16x32_bf16 v[48:51], v[180:183], v[64:67], v[48:51]
    ds_read_b128 v[92:95], v14 offset:24576
    v_mfma_f32_16x16x32_bf16 v[44:47], v[180:183], v[60:63], v[44:47]
    ds_read_b128 v[96:99], v14 offset:28672
    s_waitcnt lgkmcnt(4)
    v_mfma_f32_16x16x32_bf16 v[44:47], v[184:187], v[68:71], v[44:47]
    ds_read_b128 v[52:55], v14 offset:17408
    v_mfma_f32_16x16x32_bf16 v[48:51], v[184:187], v[72:75], v[48:51]
    ds_read_b128 v[56:59], v14 offset:21504
    v_mfma_f32_16x16x32_bf16 v[48:51], v[188:191], v[80:83], v[48:51]
    ds_read_b128 v[60:63], v14 offset:25600
    v_mfma_f32_16x16x32_bf16 v[44:47], v[188:191], v[76:79], v[44:47]
    ds_read_b128 v[64:67], v14 offset:29696
    s_waitcnt lgkmcnt(4)
    v_mfma_f32_16x16x32_bf16 v[44:47], v[192:195], v[84:87], v[44:47]
    ds_read_b128 v[68:71], v14 offset:18432
    v_mfma_f32_16x16x32_bf16 v[48:51], v[192:195], v[88:91], v[48:51]
    ds_read_b128 v[72:75], v14 offset:22528
    v_mfma_f32_16x16x32_bf16 v[48:51], v[196:199], v[96:99], v[48:51]
    ds_read_b128 v[76:79], v14 offset:26624
    v_mfma_f32_16x16x32_bf16 v[44:47], v[196:199], v[92:95], v[44:47]
    ds_read_b128 v[80:83], v14 offset:30720
    s_waitcnt lgkmcnt(4)
    v_mfma_f32_16x16x32_bf16 v[44:47], v[200:203], v[52:55], v[44:47]
    ds_read_b128 v[84:87], v14 offset:19456
    v_mfma_f32_16x16x32_bf16 v[48:51], v[200:203], v[56:59], v[48:51]
    ds_read_b128 v[88:91], v14 offset:23552
    v_mfma_f32_16x16x32_bf16 v[48:51], v[204:207], v[64:67], v[48:51]
    ds_read_b128 v[92:95], v14 offset:27648
    v_mfma_f32_16x16x32_bf16 v[44:47], v[204:207], v[60:63], v[44:47]
    ds_read_b128 v[96:99], v14 offset:31744
    s_barrier
    s_waitcnt lgkmcnt(4)
    v_mfma_f32_16x16x32_bf16 v[44:47], v[208:211], v[68:71], v[44:47]
    ds_read_b128 v[52:55], v14 offset:32768
    v_mfma_f32_16x16x32_bf16 v[48:51], v[208:211], v[72:75], v[48:51]
    ds_read_b128 v[56:59], v14 offset:36864
    v_mfma_f32_16x16x32_bf16 v[48:51], v[212:215], v[80:83], v[48:51]
    ds_read_b128 v[60:63], v14 offset:40960
    v_mfma_f32_16x16x32_bf16 v[44:47], v[212:215], v[76:79], v[44:47]
    ds_read_b128 v[64:67], v14 offset:45056
    s_waitcnt lgkmcnt(4)
    v_mfma_f32_16x16x32_bf16 v[44:47], v[216:219], v[84:87], v[44:47]
    ds_read_b128 v[68:71], v14 offset:33792
    v_mfma_f32_16x16x32_bf16 v[48:51], v[216:219], v[88:91], v[48:51]
    ds_read_b128 v[72:75], v14 offset:37888
    v_mfma_f32_16x16x32_bf16 v[48:51], v[220:223], v[96:99], v[48:51]
    ds_read_b128 v[76:79], v14 offset:41984
    v_mfma_f32_16x16x32_bf16 v[44:47], v[220:223], v[92:95], v[44:47]
    ds_read_b128 v[80:83], v14 offset:46080
    s_waitcnt lgkmcnt(4)
    v_mfma_f32_16x16x32_bf16 v[44:47], v[224:227], v[52:55], v[44:47]
    ds_read_b128 v[84:87], v14 offset:34816
    v_mfma_f32_16x16x32_bf16 v[48:51], v[224:227], v[56:59], v[48:51]
    ds_read_b128 v[88:91], v14 offset:38912
    v_mfma_f32_16x16x32_bf16 v[48:51], v[228:231], v[64:67], v[48:51]
    ds_read_b128 v[92:95], v14 offset:43008
    v_mfma_f32_16x16x32_bf16 v[44:47], v[228:231], v[60:63], v[44:47]
    ds_read_b128 v[96:99], v14 offset:47104
    s_waitcnt lgkmcnt(4)
    v_mfma_f32_16x16x32_bf16 v[44:47], v[232:235], v[68:71], v[44:47]
    ds_read_b128 v[52:55], v14 offset:35840
    v_mfma_f32_16x16x32_bf16 v[48:51], v[232:235], v[72:75], v[48:51]
    ds_read_b128 v[56:59], v14 offset:39936
    v_mfma_f32_16x16x32_bf16 v[48:51], v[236:239], v[80:83], v[48:51]
    ds_read_b128 v[60:63], v14 offset:44032
    v_mfma_f32_16x16x32_bf16 v[44:47], v[236:239], v[76:79], v[44:47]
    ds_read_b128 v[64:67], v14 offset:48128
    ds_write_b128 v16, v[20:23] offset:0
    ds_write_b128 v16, v[28:31] offset:4096
    ds_write_b128 v16, v[36:39] offset:8192
    s_waitcnt lgkmcnt(7)
    v_mfma_f32_16x16x32_bf16 v[44:47], v[240:243], v[84:87], v[44:47]
    v_mfma_f32_16x16x32_bf16 v[48:51], v[240:243], v[88:91], v[48:51]
    v_mfma_f32_16x16x32_bf16 v[48:51], v[244:247], v[96:99], v[48:51]
    v_mfma_f32_16x16x32_bf16 v[44:47], v[244:247], v[92:95], v[44:47]
    s_waitcnt lgkmcnt(3)
    v_mfma_f32_16x16x32_bf16 v[44:47], v[248:251], v[52:55], v[44:47]
    v_mfma_f32_16x16x32_bf16 v[48:51], v[248:251], v[56:59], v[48:51]
    v_mfma_f32_16x16x32_bf16 v[48:51], v[252:255], v[64:67], v[48:51]
    v_mfma_f32_16x16x32_bf16 v[44:47], v[252:255], v[60:63], v[44:47]
    s_setprio 0
    s_nop 6
    v_cvt_pk_bf16_f32 v44, v44, v45
    v_cvt_pk_bf16_f32 v45, v46, v47
    v_cvt_pk_bf16_f32 v46, v48, v49
    v_cvt_pk_bf16_f32 v47, v50, v51
    s_add_u32 s36, s39, 393216
    v_permlane16_swap_b32 v44, v46
    v_permlane16_swap_b32 v45, v47
    s_add_u32 s36, s39, 393216
    buffer_store_dwordx4 v[44:47], v13, s[24:27], s36 offen sc1
    ds_write_b128 v16, v[44:47] offset:12288
    s_waitcnt lgkmcnt(0)
    s_barrier
    s_cmp_ge_u32 s30, 6
    s_cbranch_scc1 WLOAD
    s_and_b32 s35, s30, 1
    s_add_u32 s12, s62, 0x480000
    s_addc_u32 s13, s63, 0
    s_mov_b32 s14, 0x7e000
    s_mov_b32 s15, 0x20000
    s_mul_i32 s38, s35, 262144
    s_lshl_b32 s41, s35, 13
    s_mov_b32 s42, 0
    s_mov_b32 s44, s29
    s_add_u32 s54, s55, 1024
    v_mov_b32 v9, s54
    v_lshl_add_u32 v9, v1, 7, v9
    s_add_u32 s44, s44, 1
    s_and_b32 s44, s44, 15
    s_add_u32 s46, s29, 1
    s_and_b32 s46, s46, 15
    s_cmp_eq_u32 s28, s29
    s_cselect_b32 s47, s46, s28
    s_mov_b32 s42, 16384
    s_and_b32 s35, s30, 1
    s_lshl_b32 s35, s35, 7
    s_add_u32 s35, s35, s55
    s_add_u32 s35, s35, 0x1600
    s_and_b32 s40, s30, 1
    s_lshl_b32 s40, s40, 13
    s_lshl_b32 s53, s29, 7
    s_add_u32 s40, s40, s53
    s_add_u32 s40, s40, 23068672
    v_lshlrev_b32 v10, 3, v1
    s_add_u32 s20, s62, 0x1c8000
    s_addc_u32 s21, s63, 0
    s_mov_b32 s22, 0x6000
    s_mov_b32 s23, 0x20000
    s_and_b32 s34, s30, 1
    s_lshl_b32 s34, s34, 9
    s_call_b64 s[76:77], PREP_a_issue_3
    s_mov_b32 m0, s19
    s_mov_b32 s39, s16
    s_and_b32 s53, s30, 3
    s_lshl_b32 s53, s53, 7
    s_add_u32 s53, s53, s55
    s_add_u32 s53, s53, 0x400
    v_mov_b32 v14, 1
    v_mov_b32 v15, 0
    s_mov_b64 exec, 1
    s_waitcnt vmcnt(0)
    buffer_atomic_add v14, v15, s[56:59], s53 offen sc1
    s_mov_b64 exec, -1
    s_call_b64 s[76:77], SUB_rest_2
    s_waitcnt lgkmcnt(0)
    s_mov_b32 s53, 0
    s_add_u32 s54, s52, 16
    s_bfm_b64 exec, 4, 0
poll_38:
    buffer_load_dword v8, v9, s[56:59], 0 offen sc1
    s_waitcnt vmcnt(0)
    v_cmp_eq_u32 vcc, s54, v8
    s_nop 0
    s_cmp_eq_u64 vcc, exec
    s_cbranch_scc1 pok_39
    s_sleep 5
    s_add_u32 s53, s53, 1
    s_cmp_lt_u32 s53, s61
    s_cbranch_scc1 poll_38
    s_mov_b32 s61, 0
pok_39:
    s_mov_b64 exec, -1
    buffer_load_dwordx4 v2, s[12:15], s39 offen sc1 lds
    buffer_load_dwordx4 v2, s[12:15], s39 offen offset:1024 sc1 lds
    s_call_b64 s[76:77], PREP_a_issue_3
    s_add_u32 m0, m0, 2048
    s_add_u32 s39, s39, 65536
    buffer_load_dwordx4 v2, s[12:15], s39 offen sc1 lds
    buffer_load_dwordx4 v2, s[12:15], s39 offen offset:1024 sc1 lds
    s_add_u32 m0, m0, 2048
    s_add_u32 s39, s39, 65536
    buffer_load_dwordx4 v2, s[12:15], s39 offen sc1 lds
    buffer_load_dwordx4 v2, s[12:15], s39 offen offset:1024 sc1 lds
    s_add_u32 m0, m0, 2048
    s_add_u32 s39, s39, 65536
    buffer_load_dwordx4 v2, s[12:15], s39 offen sc1 lds
    buffer_load_dwordx4 v2, s[12:15], s39 offen offset:1024 sc1 lds
    s_mov_b32 m0, s19
    s_mov_b32 s39, s16
    buffer_load_dwordx4 v2, s[12:15], s39 offen sc1 lds
    buffer_load_dwordx4 v2, s[12:15], s39 offen offset:1024 sc1 lds
    s_call_b64 s[76:77], PREP_a_issue_3
    s_add_u32 m0, m0, 2048
    s_add_u32 s39, s39, 65536
    buffer_load_dwordx4 v2, s[12:15], s39 offen sc1 lds
    buffer_load_dwordx4 v2, s[12:15], s39 offen offset:1024 sc1 lds
    s_add_u32 m0, m0, 2048
    s_add_u32 s39, s39, 65536
    buffer_load_dwordx4 v2, s[12:15], s39 offen sc1 lds
    buffer_load_dwordx4 v2, s[12:15], s39 offen offset:1024 sc1 lds
    s_add_u32 m0, m0, 2048
    s_add_u32 s39, s39, 65536
    buffer_load_dwordx4 v2, s[12:15], s39 offen sc1 lds
    buffer_load_dwordx4 v2, s[12:15], s39 offen offset:1024 sc1 lds
    s_mov_b32 m0, s19
    s_mov_b32 s39, s16
    s_waitcnt vmcnt(8)
    s_barrier
    buffer_load_dwordx4 v2, s[12:15], s39 offen sc1 lds
    buffer_load_dwordx4 v2, s[12:15], s39 offen offset:1024 sc1 lds
    s_call_b64 s[76:77], PREP_a_issue_3
    s_add_u32 m0, m0, 2048
    s_add_u32 s39, s39, 65536
    buffer_load_dwordx4 v2, s[12:15], s39 offen sc1 lds
    buffer_load_dwordx4 v2, s[12:15], s39 offen offset:1024 sc1 lds
    s_add_u32 m0, m0, 2048
    s_add_u32 s39, s39, 65536
    buffer_load_dwordx4 v2, s[12:15], s39 offen sc1 lds
    buffer_load_dwordx4 v2, s[12:15], s39 offen offset:1024 sc1 lds
    s_add_u32 m0, m0, 2048
    s_add_u32 s39, s39, 65536
    buffer_load_dwordx4 v2, s[12:15], s39 offen sc1 lds
    buffer_load_dwordx4 v2, s[12:15], s39 offen offset:1024 sc1 lds
    s_mov_b32 m0, s19
    s_mov_b32 s39, s16
    s_add_u32 s36, s34, 155648
    v_add_u32 v51, s36, v10
    ds_read_b64 v[18:19], v51 offset:0
    ds_read_b64 v[20:21], v51 offset:1024
    ds_read_b64 v[22:23], v51 offset:2048
    ds_read_b64 v[24:25], v51 offset:3072
    s_lshr_b32 s53, s29, 3
    s_lshl_b32 s53, s53, 14
    s_and_b32 s36, s29, 7
    s_lshl_b32 s36, s36, 10
    s_add_u32 s36, s36, s53
    s_add_u32 s36, s36, s34
    s_waitcnt lgkmcnt(0)
    v_pk_add_f32 v[18:19], v[18:19], v[20:21]
    v_pk_add_f32 v[18:19], v[18:19], v[22:23]
    v_pk_add_f32 v[18:19], v[18:19], v[24:25]
    buffer_store_dwordx2 v[18:19], v10, s[20:23], s36 offen sc1
    s_waitcnt vmcnt(9)
    s_barrier
    buffer_load_dwordx4 v2, s[12:15], s39 offen sc1 lds
    buffer_load_dwordx4 v2, s[12:15], s39 offen offset:1024 sc1 lds
    s_call_b64 s[76:77], PREP_a_issue_3
    s_add_u32 m0, m0, 2048
    s_add_u32 s39, s39, 65536
    buffer_load_dwordx4 v2, s[12:15], s39 offen sc1 lds
    buffer_load_dwordx4 v2, s[12:15], s39 offen offset:1024 sc1 lds
    s_add_u32 m0, m0, 2048
    s_add_u32 s39, s39, 65536
    buffer_load_dwordx4 v2, s[12:15], s39 offen sc1 lds
    buffer_load_dwordx4 v2, s[12:15], s39 offen offset:1024 sc1 lds
    s_add_u32 m0, m0, 2048
    s_add_u32 s39, s39, 65536
    buffer_load_dwordx4 v2, s[12:15], s39 offen sc1 lds
    buffer_load_dwordx4 v2, s[12:15], s39 offen offset:1024 sc1 lds
    s_mov_b32 m0, s19
    s_mov_b32 s39, s16
    s_waitcnt vmcnt(9)
    s_barrier
    buffer_load_dwordx4 v2, s[12:15], s39 offen sc1 lds
    buffer_load_dwordx4 v2, s[12:15], s39 offen offset:1024 sc1 lds
    s_call_b64 s[76:77], PREP_a_issue_3
    s_add_u32 m0, m0, 2048
    s_add_u32 s39, s39, 65536
    buffer_load_dwordx4 v2, s[12:15], s39 offen sc1 lds
    buffer_load_dwordx4 v2, s[12:15], s39 offen offset:1024 sc1 lds
    s_add_u32 m0, m0, 2048
    s_add_u32 s39, s39, 65536
    buffer_load_dwordx4 v2, s[12:15], s39 offen sc1 lds
    buffer_load_dwordx4 v2, s[12:15], s39 offen offset:1024 sc1 lds
    s_add_u32 m0, m0, 2048
    s_add_u32 s39, s39, 65536
    buffer_load_dwordx4 v2, s[12:15], s39 offen sc1 lds
    buffer_load_dwordx4 v2, s[12:15], s39 offen offset:1024 sc1 lds
    s_mov_b32 m0, s19
    s_mov_b32 s39, s16
    s_waitcnt vmcnt(16)
    s_and_b32 s53, s30, 1
    s_lshl_b32 s53, s53, 7
    s_add_u32 s53, s53, s55
    s_add_u32 s53, s53, 0x1600
    v_mov_b32 v14, 1
    v_mov_b32 v15, 0
    s_mov_b64 exec, 1
    buffer_atomic_add v14, v15, s[56:59], s53 offen sc1
    s_mov_b64 exec, -1
    s_waitcnt vmcnt(9)
    s_barrier
    buffer_load_dwordx4 v2, s[12:15], s39 offen sc1 lds
    buffer_load_dwordx4 v2, s[12:15], s39 offen offset:1024 sc1 lds
    s_call_b64 s[76:77], PREP_a_issue_3
    s_add_u32 m0, m0, 2048
    s_add_u32 s39, s39, 65536
    buffer_load_dwordx4 v2, s[12:15], s39 offen sc1 lds
    buffer_load_dwordx4 v2, s[12:15], s39 offen offset:1024 sc1 lds
    s_add_u32 m0, m0, 2048
    s_add_u32 s39, s39, 65536
    buffer_load_dwordx4 v2, s[12:15], s39 offen sc1 lds
    buffer_load_dwordx4 v2, s[12:15], s39 offen offset:1024 sc1 lds
    s_add_u32 m0, m0, 2048
    s_add_u32 s39, s39, 65536
    buffer_load_dwordx4 v2, s[12:15], s39 offen sc1 lds
    buffer_load_dwordx4 v2, s[12:15], s39 offen offset:1024 sc1 lds
    s_mov_b32 m0, s19
    s_mov_b32 s39, s16
    s_waitcnt vmcnt(9)
    s_barrier
    buffer_load_dwordx4 v2, s[12:15], s39 offen sc1 lds
    buffer_load_dwordx4 v2, s[12:15], s39 offen offset:1024 sc1 lds
    s_call_b64 s[76:77], PREP_a_issue_3
    s_add_u32 m0, m0, 2048
    s_add_u32 s39, s39, 65536
    buffer_load_dwordx4 v2, s[12:15], s39 offen sc1 lds
    buffer_load_dwordx4 v2, s[12:15], s39 offen offset:1024 sc1 lds
    s_add_u32 m0, m0, 2048
    s_add_u32 s39, s39, 65536
    buffer_load_dwordx4 v2, s[12:15], s39 offen sc1 lds
    buffer_load_dwordx4 v2, s[12:15], s39 offen offset:1024 sc1 lds
    s_add_u32 m0, m0, 2048
    s_add_u32 s39, s39, 65536
    buffer_load_dwordx4 v2, s[12:15], s39 offen sc1 lds
    buffer_load_dwordx4 v2, s[12:15], s39 offen offset:1024 sc1 lds
    s_mov_b32 m0, s19
    s_mov_b32 s39, s16
    s_waitcnt vmcnt(8)
    s_barrier
    buffer_load_dwordx4 v2, s[12:15], s39 offen sc1 lds
    buffer_load_dwordx4 v2, s[12:15], s39 offen offset:1024 sc1 lds
    s_call_b64 s[76:77], PREP_a_issue_3
    s_add_u32 m0, m0, 2048
    s_add_u32 s39, s39, 65536
    buffer_load_dwordx4 v2, s[12:15], s39 offen sc1 lds
    buffer_load_dwordx4 v2, s[12:15], s39 offen offset:1024 sc1 lds
    s_add_u32 m0, m0, 2048
    s_add_u32 s39, s39, 65536
    buffer_load_dwordx4 v2, s[12:15], s39 offen sc1 lds
    buffer_load_dwordx4 v2, s[12:15], s39 offen offset:1024 sc1 lds
    s_add_u32 m0, m0, 2048
    s_add_u32 s39, s39, 65536
    buffer_load_dwordx4 v2, s[12:15], s39 offen sc1 lds
    buffer_load_dwordx4 v2, s[12:15], s39 offen offset:1024 sc1 lds
    s_mov_b32 m0, s19
    s_mov_b32 s39, s16
    s_waitcnt vmcnt(8)
    s_barrier
    buffer_load_dwordx4 v2, s[12:15], s39 offen sc1 lds
    buffer_load_dwordx4 v2, s[12:15], s39 offen offset:1024 sc1 lds
    s_call_b64 s[76:77], PREP_a_issue_3
    s_add_u32 m0, m0, 2048
    s_add_u32 s39, s39, 65536
    buffer_load_dwordx4 v2, s[12:15], s39 offen sc1 lds
    buffer_load_dwordx4 v2, s[12:15], s39 offen offset:1024 sc1 lds
    s_add_u32 m0, m0, 2048
    s_add_u32 s39, s39, 65536
    buffer_load_dwordx4 v2, s[12:15], s39 offen sc1 lds
    buffer_load_dwordx4 v2, s[12:15], s39 offen offset:1024 sc1 lds
    s_add_u32 m0, m0, 2048
    s_add_u32 s39, s39, 65536
    buffer_load_dwordx4 v2, s[12:15], s39 offen sc1 lds
    buffer_load_dwordx4 v2, s[12:15], s39 offen offset:1024 sc1 lds
    s_mov_b32 m0, s19
    s_mov_b32 s39, s16
    s_load_dword s32, s[4:5], s35
    s_load_dword s3, s[4:5], s40
    s_waitcnt vmcnt(8)
    s_barrier
    buffer_load_dwordx4 v2, s[12:15], s39 offen sc1 lds
    buffer_load_dwordx4 v2, s[12:15], s39 offen offset:1024 sc1 lds
    s_call_b64 s[76:77], PREP_a_issue_3
    s_add_u32 m0, m0, 2048
    s_add_u32 s39, s39, 65536
    buffer_load_dwordx4 v2, s[12:15], s39 offen sc1 lds
    buffer_load_dwordx4 v2, s[12:15], s39 offen offset:1024 sc1 lds
    s_add_u32 m0, m0, 2048
    s_add_u32 s39, s39, 65536
    buffer_load_dwordx4 v2, s[12:15], s39 offen sc1 lds
    buffer_load_dwordx4 v2, s[12:15], s39 offen offset:1024 sc1 lds
    s_add_u32 m0, m0, 2048
    s_add_u32 s39, s39, 65536
    buffer_load_dwordx4 v2, s[12:15], s39 offen sc1 lds
    buffer_load_dwordx4 v2, s[12:15], s39 offen offset:1024 sc1 lds
    s_mov_b32 m0, s19
    s_mov_b32 s39, s16
    s_add_u32 s54, s52, 16
    s_waitcnt lgkmcnt(0)
    s_cmp_eq_u32 s32, s54
    s_cbranch_scc1 fok_40
    v_mov_b32 v15, s35
    s_mov_b32 s53, 0
    s_add_u32 s54, s52, 16
    s_bfm_b64 exec, 1, 0
poll_41:
    buffer_load_dword v14, v15, s[56:59], 0 offen sc1
    s_waitcnt vmcnt(0)
    v_cmp_eq_u32 vcc, s54, v14
    s_nop 0
    s_cmp_eq_u64 vcc, exec
    s_cbranch_scc1 pok_42
    s_sleep 5
    s_add_u32 s53, s53, 1
    s_cmp_lt_u32 s53, s61
    s_cbranch_scc1 poll_41
    s_mov_b32 s61, 0
pok_42:
    s_mov_b64 exec, -1
fok_40:
    s_add_u32 s36, s34, 0
    buffer_load_dwordx2 v[18:19], v10, s[20:23], s36 offen offset:0 sc1
    buffer_load_dwordx2 v[20:21], v10, s[20:23], s36 offen offset:1024 sc1
    buffer_load_dwordx2 v[22:23], v10, s[20:23], s36 offen offset:2048 sc1
    buffer_load_dwordx2 v[24:25], v10, s[20:23], s36 offen offset:3072 sc1
    s_add_u32 s36, s36, 4096
    buffer_load_dwordx2 v[26:27], v10, s[20:23], s36 offen offset:0 sc1
    buffer_load_dwordx2 v[28:29], v10, s[20:23], s36 offen offset:1024 sc1
    buffer_load_dwordx2 v[30:31], v10, s[20:23], s36 offen offset:2048 sc1
    buffer_load_dwordx2 v[32:33], v10, s[20:23], s36 offen offset:3072 sc1
    s_waitcnt vmcnt(16)
    s_barrier
    buffer_load_dwordx4 v2, s[12:15], s39 offen sc1 lds
    buffer_load_dwordx4 v2, s[12:15], s39 offen offset:1024 sc1 lds
    s_call_b64 s[76:77], PREP_a_issue_3
    s_add_u32 m0, m0, 2048
    s_add_u32 s39, s39, 65536
    buffer_load_dwordx4 v2, s[12:15], s39 offen sc1 lds
    buffer_load_dwordx4 v2, s[12:15], s39 offen offset:1024 sc1 lds
    s_add_u32 m0, m0, 2048
    s_add_u32 s39, s39, 65536
    buffer_load_dwordx4 v2, s[12:15], s39 offen sc1 lds
    buffer_load_dwordx4 v2, s[12:15], s39 offen offset:1024 sc1 lds
    s_add_u32 m0, m0, 2048
    s_add_u32 s39, s39, 65536
    buffer_load_dwordx4 v2, s[12:15], s39 offen sc1 lds
    buffer_load_dwordx4 v2, s[12:15], s39 offen offset:1024 sc1 lds
    s_mov_b32 m0, s19
    s_mov_b32 s39, s16
    s_add_u32 s36, s34, 16384
    buffer_load_dwordx2 v[34:35], v10, s[20:23], s36 offen offset:0 sc1
    buffer_load_dwordx2 v[36:37], v10, s[20:23], s36 offen offset:1024 sc1
    buffer_load_dwordx2 v[38:39], v10, s[20:23], s36 offen offset:2048 sc1
    buffer_load_dwordx2 v[40:41], v10, s[20:23], s36 offen offset:3072 sc1
    s_add_u32 s36, s36, 4096
    buffer_load_dwordx2 v[42:43], v10, s[20:23], s36 offen offset:0 sc1
    buffer_load_dwordx2 v[44:45], v10, s[20:23], s36 offen offset:1024 sc1
    buffer_load_dwordx2 v[46:47], v10, s[20:23], s36 offen offset:2048 sc1
    buffer_load_dwordx2 v[48:49], v10, s[20:23], s36 offen offset:3072 sc1
    s_waitcnt vmcnt(24)
    s_barrier
    buffer_load_dwordx4 v2, s[12:15], s39 offen sc1 lds
    buffer_load_dwordx4 v2, s[12:15], s39 offen offset:1024 sc1 lds
    s_call_b64 s[76:77], PREP_a_issue_3
    s_add_u32 m0, m0, 2048
    s_add_u32 s39, s39, 65536
    buffer_load_dwordx4 v2, s[12:15], s39 offen sc1 lds
    buffer_load_dwordx4 v2, s[12:15], s39 offen offset:1024 sc1 lds
    s_add_u32 m0, m0, 2048
    s_add_u32 s39, s39, 65536
    buffer_load_dwordx4 v2, s[12:15], s39 offen sc1 lds
    buffer_load_dwordx4 v2, s[12:15], s39 offen offset:1024 sc1 lds
    s_add_u32 m0, m0, 2048
    s_add_u32 s39, s39, 65536
    buffer_load_dwordx4 v2, s[12:15], s39 offen sc1 lds
    buffer_load_dwordx4 v2, s[12:15], s39 offen offset:1024 sc1 lds
    s_mov_b32 m0, s19
    s_mov_b32 s39, s16
    s_add_u32 s54, s52, 16
    s_waitcnt lgkmcnt(0)
    s_cmp_eq_u32 s3, s54
    s_cbranch_scc1 fok_43
    v_mov_b32 v15, s40
    s_mov_b32 s53, 0
    s_add_u32 s54, s52, 16
    s_bfm_b64 exec, 1, 0
poll_44:
    buffer_load_dword v14, v15, s[56:59], 0 offen sc1
    s_waitcnt vmcnt(0)
    v_cmp_eq_u32 vcc, s54, v14
    s_nop 0
    s_cmp_eq_u64 vcc, exec
    s_cbranch_scc1 pok_45
    s_sleep 5
    s_add_u32 s53, s53, 1
    s_cmp_lt_u32 s53, s61
    s_cbranch_scc1 poll_44
    s_mov_b32 s61, 0
pok_45:
    s_mov_b64 exec, -1
fok_43:
    s_add_u32 s24, s4, 0x1420000
    s_addc_u32 s25, s5, 0
    s_mov_b32 s26, 0x38000
    s_mov_b32 s27, 0x20000
    s_cmp_eq_u32 s60, 0
    s_cselect_b32 s26, s26, 0
    s_and_b32 s36, s30, 1
    s_mul_i32 s36, s36, 448
    s_mul_i32 s37, s29, 896
    s_add_u32 s37, s36, s37
    v_lshrrev_b32 v13, 5, v1
    v_mul_u32_u24 v13, 14336, v13
    v_and_b32 v6, 496, v2
    v_add_u32 v13, v13, v6
    buffer_load_dwordx4 v[54:57], v13, s[24:27], s37 offen sc1
    s_add_u32 s37, s37, 28672
    buffer_load_dwordx4 v[58:61], v13, s[24:27], s37 offen sc1
    s_add_u32 s37, s37, 28672
    buffer_load_dwordx4 v[62:65], v13, s[24:27], s37 offen sc1
    s_add_u32 s37, s37, 28672
    buffer_load_dwordx4 v[66:69], v13, s[24:27], s37 offen sc1
    s_add_u32 s37, s37, 28672
    buffer_load_dwordx4 v[70:73], v13, s[24:27], s37 offen sc1
    s_add_u32 s37, s37, 28672
    buffer_load_dwordx4 v[74:77], v13, s[24:27], s37 offen sc1
    s_add_u32 s37, s37, 28672
    buffer_load_dwordx4 v[78:81], v13, s[24:27], s37 offen sc1
    s_add_u32 s37, s37, 28672
    buffer_load_dwordx4 v[82:85], v13, s[24:27], s37 offen sc1
    s_add_u32 s37, s37, 28672
    s_waitcnt vmcnt(24)
    s_barrier
    buffer_load_dwordx4 v2, s[12:15], s39 offen sc1 lds
    buffer_load_dwordx4 v2, s[12:15], s39 offen offset:1024 sc1 lds
    s_call_b64 s[76:77], PREP_a_issue_3
    s_add_u32 m0, m0, 2048
    s_add_u32 s39, s39, 65536
    buffer_load_dwordx4 v2, s[12:15], s39 offen sc1 lds
    buffer_load_dwordx4 v2, s[12:15], s39 offen offset:1024 sc1 lds
    s_add_u32 m0, m0, 2048
    s_add_u32 s39, s39, 65536
    buffer_load_dwordx4 v2, s[12:15], s39 offen sc1 lds
    buffer_load_dwordx4 v2, s[12:15], s39 offen offset:1024 sc1 lds
    s_add_u32 m0, m0, 2048
    s_add_u32 s39, s39, 65536
    buffer_load_dwordx4 v2, s[12:15], s39 offen sc1 lds
    buffer_load_dwordx4 v2, s[12:15], s39 offen offset:1024 sc1 lds
    s_mov_b32 m0, s19
    s_mov_b32 s39, s16
    s_waitcnt vmcnt(24)
    v_pk_add_f32 v[18:19], v[18:19], v[34:35]
    v_pk_add_f32 v[20:21], v[20:21], v[36:37]
    v_pk_add_f32 v[22:23], v[22:23], v[38:39]
    v_pk_add_f32 v[24:25], v[24:25], v[40:41]
    v_pk_add_f32 v[26:27], v[26:27], v[42:43]
    v_pk_add_f32 v[28:29], v[28:29], v[44:45]
    v_pk_add_f32 v[30:31], v[30:31], v[46:47]
    v_pk_add_f32 v[32:33], v[32:33], v[48:49]
    v_pk_add_f32 v[18:19], v[18:19], v[26:27]
    v_pk_add_f32 v[20:21], v[20:21], v[28:29]
    v_pk_add_f32 v[22:23], v[22:23], v[30:31]
    v_pk_add_f32 v[24:25], v[24:25], v[32:33]
    s_waitcnt vmcnt(16)
    s_barrier
    buffer_load_dwordx4 v2, s[12:15], s39 offen sc1 lds
    buffer_load_dwordx4 v2, s[12:15], s39 offen offset:1024 sc1 lds
    s_call_b64 s[76:77], PREP_a_issue_3
    s_add_u32 m0, m0, 2048
    s_add_u32 s39, s39, 65536
    buffer_load_dwordx4 v2, s[12:15], s39 offen sc1 lds
    buffer_load_dwordx4 v2, s[12:15], s39 offen offset:1024 sc1 lds
    s_add_u32 m0, m0, 2048
    s_add_u32 s39, s39, 65536
    buffer_load_dwordx4 v2, s[12:15], s39 offen sc1 lds
    buffer_load_dwordx4 v2, s[12:15], s39 offen offset:1024 sc1 lds
    s_add_u32 m0, m0, 2048
    s_add_u32 s39, s39, 65536
    buffer_load_dwordx4 v2, s[12:15], s39 offen sc1 lds
    buffer_load_dwordx4 v2, s[12:15], s39 offen offset:1024 sc1 lds
    s_mov_b32 m0, s19
    s_mov_b32 s39, s16
    v_pk_add_f32 v[18:19], v[18:19], v[22:23]
    v_pk_add_f32 v[20:21], v[20:21], v[24:25]
    v_pk_add_f32 v[18:19], v[18:19], v[20:21]
    v_mul_f32 v52, 0x3a800000, v18
    v_mul_f32 v50, 0x3a800000, v19
    v_fma_f32 v50, -v52, v52, v50
    v_max_f32 v50, 0, v50
    v_cvt_pk_bf16_f32 v52, v52, v52
    v_lshlrev_b32 v52, 16, v52
    v_cvt_pk_bf16_f32 v50, v50, v50
    v_lshlrev_b32 v50, 16, v50
    s_waitcnt vmcnt(8)
    s_barrier
    buffer_load_dwordx4 v2, s[12:15], s39 offen sc1 lds
    buffer_load_dwordx4 v2, s[12:15], s39 offen offset:1024 sc1 lds
    s_add_u32 m0, m0, 2048
    s_add_u32 s39, s39, 65536
    buffer_load_dwordx4 v2, s[12:15], s39 offen sc1 lds
    buffer_load_dwordx4 v2, s[12:15], s39 offen offset:1024 sc1 lds
    s_add_u32 m0, m0, 2048
    s_add_u32 s39, s39, 65536
    buffer_load_dwordx4 v2, s[12:15], s39 offen sc1 lds
    buffer_load_dwordx4 v2, s[12:15], s39 offen offset:1024 sc1 lds
    s_add_u32 m0, m0, 2048
    s_add_u32 s39, s39, 65536
    buffer_load_dwordx4 v2, s[12:15], s39 offen sc1 lds
    buffer_load_dwordx4 v2, s[12:15], s39 offen offset:1024 sc1 lds
    s_waitcnt vmcnt(24)
    v_add_f32 v50, 0x3727c5ac, v50
    v_cvt_pk_bf16_f32 v50, v50, v50
    v_lshlrev_b32 v50, 16, v50
    v_sqrt_f32 v50, v50
    s_nop 0
    v_cvt_pk_bf16_f32 v50, v50, v50
    v_lshlrev_b32 v50, 16, v50
    v_rcp_f32 v53, v50
    s_add_u32 s36, s34, 160768
    v_add_u32 v51, s36, v10
    ds_write_b64 v51, v[52:53]
    s_waitcnt lgkmcnt(0)
    s_cmp_lg_u32 s60, 0
    s_cbranch_scc1 pc_49
    v_pk_add_f32 v[54:55], v[54:55], v[58:59]
    v_pk_add_f32 v[56:57], v[56:57], v[60:61]
    v_pk_add_f32 v[54:55], v[54:55], v[62:63]
    v_pk_add_f32 v[56:57], v[56:57], v[64:65]
    v_pk_add_f32 v[54:55], v[54:55], v[66:67]
    v_pk_add_f32 v[56:57], v[56:57], v[68:69]
    v_pk_add_f32 v[54:55], v[54:55], v[70:71]
    v_pk_add_f32 v[56:57], v[56:57], v[72:73]
pc_49:
    s_waitcnt vmcnt(8)
    s_barrier
    s_cmp_lg_u32 s60, 0
    s_cbranch_scc1 pc_50
    v_pk_add_f32 v[54:55], v[54:55], v[74:75]
    v_pk_add_f32 v[56:57], v[56:57], v[76:77]
    v_pk_add_f32 v[54:55], v[54:55], v[78:79]
    v_pk_add_f32 v[56:57], v[56:57], v[80:81]
    v_pk_add_f32 v[54:55], v[54:55], v[82:83]
    v_pk_add_f32 v[56:57], v[56:57], v[84:85]
    v_mov_b32 v58, v54
    v_mov_b32 v59, v55
    v_mov_b32 v60, v56
    v_mov_b32 v61, v57
    v_permlane32_swap_b32 v54, v58
    v_permlane32_swap_b32 v55, v59
    v_permlane32_swap_b32 v56, v60
    v_permlane32_swap_b32 v57, v61
    v_pk_add_f32 v[54:55], v[54:55], v[58:59]
    v_pk_add_f32 v[56:57], v[56:57], v[60:61]
    s_and_b32 s36, s30, 1
    s_mul_i32 s36, s36, 448
    s_add_u32 s36, s36, 159744
    v_add_u32 v6, s36, v2
    s_bfm_b64 exec, 28, 0
    ds_write_b128 v6, v[54:57]
    s_mov_b64 exec, -1
    s_waitcnt lgkmcnt(0)
pc_50:
    s_waitcnt vmcnt(0)
    s_barrier
    s_cmp_lg_u32 s60, 0
    s_cbranch_scc1 tw4_51
    s_mov_b64 s[48:49], s[74:75]
    s_lshl_b32 s45, s2, 1
    s_and_b32 s50, s30, 1
    s_add_u32 s45, s45, s50
    s_mul_i32 s45, s45, 14336
    s_mov_b32 s50, 7340032
    s_mov_b32 s51, 0x20000
    buffer_load_dwordx4 v[60:63], v2, s[48:51], s45 offen offset:0
    buffer_load_dwordx4 v[60:63], v2, s[48:51], s45 offen offset:1024
    buffer_load_dwordx4 v[60:63], v2, s[48:51], s45 offen offset:2048
    buffer_load_dwordx4 v[60:63], v2, s[48:51], s45 offen offset:3072
    s_add_u32 s45, s45, 4096
    buffer_load_dwordx4 v[60:63], v2, s[48:51], s45 offen offset:0
    buffer_load_dwordx4 v[60:63], v2, s[48:51], s45 offen offset:1024
    buffer_load_dwordx4 v[60:63], v2, s[48:51], s45 offen offset:2048
    buffer_load_dwordx4 v[60:63], v2, s[48:51], s45 offen offset:3072
    s_add_u32 s45, s45, 4096
    buffer_load_dwordx4 v[60:63], v2, s[48:51], s45 offen offset:0
    buffer_load_dwordx4 v[60:63], v2, s[48:51], s45 offen offset:1024
    buffer_load_dwordx4 v[60:63], v2, s[48:51], s45 offen offset:2048
    buffer_load_dwordx4 v[60:63], v2, s[48:51], s45 offen offset:3072
    s_add_u32 s45, s45, 4096
    buffer_load_dwordx4 v[60:63], v2, s[48:51], s45 offen offset:0
    buffer_load_dwordx4 v[60:63], v2, s[48:51], s45 offen offset:1024
tw4_51:
    s_barrier
    s_and_b32 s35, s30, 1
    s_mov_b32 s12, s62
    s_mov_b32 s13, s63
    s_mov_b32 s14, 0x1be000
    s_mov_b32 s15, 0x20000
    s_mul_i32 s38, s35, 917504
    s_mul_i32 s36, s31, 114688
    s_add_u32 s38, s38, s36
    s_lshl_b32 s41, s35, 13
    s_mov_b32 s42, 0
    s_mov_b32 s44, 0
    s_and_b32 s34, s30, 1
    s_lshl1_add_u32 s34, s31, s34
    s_lshl_b32 s34, s34, 7
    s_add_u32 s34, s34, s55
    s_add_u32 s34, s34, 0x1200
    s_and_b32 s35, s30, 1
    s_lshl1_add_u32 s35, s31, s35
    s_lshl_b32 s35, s35, 7
    s_add_u32 s35, s35, s55
    s_add_u32 s35, s35, 0x1400
    s_sub_u32 s48, s34, 512
    s_mov_b32 s44, 3
    s_call_b64 s[76:77], PREP_a_issue_4
    s_mov_b32 m0, s19
    s_mov_b32 s39, s16
    s_mov_b32 s40, s17
    s_waitcnt vmcnt(16)
    s_barrier
    s_load_dword s32, s[4:5], s48
    s_waitcnt vmcnt(8)
    s_barrier
    s_add_u32 s54, s52, 16
    s_waitcnt lgkmcnt(0)
    s_cmp_eq_u32 s32, s54
    s_cbranch_scc1 fok_52
    v_mov_b32 v9, s48
    s_mov_b32 s53, 0
    s_add_u32 s54, s52, 16
    s_bfm_b64 exec, 1, 0
poll_53:
    buffer_load_dword v8, v9, s[56:59], 0 offen sc1
    s_waitcnt vmcnt(0)
    v_cmp_eq_u32 vcc, s54, v8
    s_nop 0
    s_cmp_eq_u64 vcc, exec
    s_cbranch_scc1 pok_54
    s_sleep 5
    s_add_u32 s53, s53, 1
    s_cmp_lt_u32 s53, s61
    s_cbranch_scc1 poll_53
    s_mov_b32 s61, 0
pok_54:
    s_mov_b64 exec, -1
fok_52:
    buffer_load_dwordx4 v2, s[12:15], s39 offen sc1 lds
    s_add_u32 m0, m0, 1024
    s_nop 0
    buffer_load_dwordx4 v2, s[12:15], s40 offen sc1 lds
    s_call_b64 s[76:77], PREP_a_issue_4
    s_add_u32 m0, m0, 1024
    s_add_u32 s39, s39, 229376
    buffer_load_dwordx4 v2, s[12:15], s39 offen sc1 lds
    s_add_u32 m0, m0, 1024
    s_add_u32 s40, s40, 229376
    buffer_load_dwordx4 v2, s[12:15], s40 offen sc1 lds
    s_add_u32 m0, m0, 1024
    s_add_u32 s39, s39, 229376
    buffer_load_dwordx4 v2, s[12:15], s39 offen sc1 lds
    s_add_u32 m0, m0, 1024
    s_add_u32 s40, s40, 229376
    buffer_load_dwordx4 v2, s[12:15], s40 offen sc1 lds
    s_add_u32 m0, m0, 1024
    s_add_u32 s39, s39, 229376
    buffer_load_dwordx4 v2, s[12:15], s39 offen sc1 lds
    s_add_u32 m0, m0, 1024
    s_add_u32 s40, s40, 229376
    buffer_load_dwordx4 v2, s[12:15], s40 offen sc1 lds
    s_mov_b32 m0, s19
    s_mov_b32 s39, s16
    s_mov_b32 s40, s17
    s_waitcnt vmcnt(8)
    s_barrier
    buffer_load_dwordx4 v2, s[12:15], s39 offen sc1 lds
    s_add_u32 m0, m0, 1024
    s_nop 0
    buffer_load_dwordx4 v2, s[12:15], s40 offen sc1 lds
    s_mov_b32 s43, 1
ld_55:
    s_add_u32 s19, s41, s42
    s_lshl_b32 s45, s44, 1
    s_add_u32 s45, s45, 0
    s_sub_u32 s45, s45, 32
    s_mul_i32 s46, s45, 86
    s_lshr_b32 s46, s46, 8
    s_mul_i32 s47, s46, 3
    s_sub_u32 s47, s45, s47
    s_lshl_b32 s47, s47, 2
    s_lshr_b32 s47, 0x362, s47
    s_and_b32 s47, s47, 7
    s_cmp_ge_u32 s44, 10
    s_cselect_b32 s45, 9, 2
    s_cselect_b32 s51, 1, 0
    s_sub_u32 s45, s44, s45
    s_cmp_lt_u32 s44, 3
    s_cselect_b32 s45, 0, s45
    s_cselect_b32 s51, s44, s51
    s_lshl2_add_u32 s51, 0, s51
    s_cmp_lt_u32 s44, 17
    s_cselect_b32 s47, s51, s47
    s_cselect_b32 s46, s45, s46
    s_add_u32 s46, s46, s33
    s_and_b32 s46, s46, 7
    s_mul_i32 s46, s46, 7
    s_add_u32 s16, s46, s47
    s_lshr_b32 s53, s16, 3
    s_lshl_b32 s53, s53, 14
    s_and_b32 s16, s16, 7
    s_lshl_b32 s16, s16, 10
    s_add_u32 s16, s16, s53
    s_add_u32 s16, s16, s38
    s_lshl_b32 s45, s44, 1
    s_add_u32 s45, s45, 1
    s_sub_u32 s45, s45, 32
    s_mul_i32 s46, s45, 86
    s_lshr_b32 s46, s46, 8
    s_mul_i32 s47, s46, 3
    s_sub_u32 s47, s45, s47
    s_lshl_b32 s47, s47, 2
    s_lshr_b32 s47, 0x362, s47
    s_and_b32 s47, s47, 7
    s_cmp_ge_u32 s44, 10
    s_cselect_b32 s45, 9, 2
    s_cselect_b32 s51, 1, 0
    s_sub_u32 s45, s44, s45
    s_cmp_lt_u32 s44, 3
    s_cselect_b32 s45, 0, s45
    s_cselect_b32 s51, s44, s51
    s_lshl2_add_u32 s51, 1, s51
    s_cmp_lt_u32 s44, 17
    s_cselect_b32 s47, s51, s47
    s_cselect_b32 s46, s45, s46
    s_add_u32 s46, s46, s33
    s_and_b32 s46, s46, 7
    s_mul_i32 s46, s46, 7
    s_add_u32 s17, s46, s47
    s_lshr_b32 s53, s17, 3
    s_lshl_b32 s53, s53, 14
    s_and_b32 s17, s17, 7
    s_lshl_b32 s17, s17, 10
    s_add_u32 s17, s17, s53
    s_add_u32 s17, s17, s38
    s_add_u32 s44, s44, 1
    s_add_u32 s42, s42, 16384
    s_cmp_eq_u32 s42, 49152
    s_cselect_b32 s42, 0, s42
    s_add_u32 m0, m0, 1024
    s_add_u32 s39, s39, 229376
    buffer_load_dwordx4 v2, s[12:15], s39 offen sc1 lds
    s_add_u32 m0, m0, 1024
    s_add_u32 s40, s40, 229376
    buffer_load_dwordx4 v2, s[12:15], s40 offen sc1 lds
    s_add_u32 m0, m0, 1024
    s_add_u32 s39, s39, 229376
    buffer_load_dwordx4 v2, s[12:15], s39 offen sc1 lds
    s_add_u32 m0, m0, 1024
    s_add_u32 s40, s40, 229376
    buffer_load_dwordx4 v2, s[12:15], s40 offen sc1 lds
    s_add_u32 m0, m0, 1024
    s_add_u32 s39, s39, 229376
    buffer_load_dwordx4 v2, s[12:15], s39 offen sc1 lds
    s_add_u32 m0, m0, 1024
    s_add_u32 s40, s40, 229376
    buffer_load_dwordx4 v2, s[12:15], s40 offen sc1 lds
    s_mov_b32 m0, s19
    s_mov_b32 s39, s16
    s_mov_b32 s40, s17
    s_waitcnt vmcnt(8)
    s_barrier
    buffer_load_dwordx4 v2, s[12:15], s39 offen sc1 lds
    s_add_u32 m0, m0, 1024
    s_nop 0
    buffer_load_dwordx4 v2, s[12:15], s40 offen sc1 lds
    s_add_u32 s43, s43, 1
    s_cmp_lt_u32 s43, 4
    s_cbranch_scc1 ld_55
    s_call_b64 s[76:77], PREP_a_issue_4
    s_add_u32 m0, m0, 1024
    s_add_u32 s39, s39, 229376
    buffer_load_dwordx4 v2, s[12:15], s39 offen sc1 lds
    s_add_u32 m0, m0, 1024
    s_add_u32 s40, s40, 229376
    buffer_load_dwordx4 v2, s[12:15], s40 offen sc1 lds
    s_add_u32 m0, m0, 1024
    s_add_u32 s39, s39, 229376
    buffer_load_dwordx4 v2, s[12:15], s39 offen sc1 lds
    s_add_u32 m0, m0, 1024
    s_add_u32 s40, s40, 229376
    buffer_load_dwordx4 v2, s[12:15], s40 offen sc1 lds
    s_add_u32 m0, m0, 1024
    s_add_u32 s39, s39, 229376
    buffer_load_dwordx4 v2, s[12:15], s39 offen sc1 lds
    s_add_u32 m0, m0, 1024
    s_add_u32 s40, s40, 229376
    buffer_load_dwordx4 v2, s[12:15], s40 offen sc1 lds
    s_mov_b32 m0, s19
    s_mov_b32 s39, s16
    s_mov_b32 s40, s17
    s_waitcnt vmcnt(8)
    s_barrier
    buffer_load_dwordx4 v2, s[12:15], s39 offen sc1 lds
    s_add_u32 m0, m0, 1024
    s_nop 0
    buffer_load_dwordx4 v2, s[12:15], s40 offen sc1 lds
    s_load_dword s32, s[4:5], s34
    s_call_b64 s[76:77], PREP_a_issue_4
    s_add_u32 m0, m0, 1024
    s_add_u32 s39, s39, 229376
    buffer_load_dwordx4 v2, s[12:15], s39 offen sc1 lds
    s_add_u32 m0, m0, 1024
    s_add_u32 s40, s40, 229376
    buffer_load_dwordx4 v2, s[12:15], s40 offen sc1 lds
    s_add_u32 m0, m0, 1024
    s_add_u32 s39, s39, 229376
    buffer_load_dwordx4 v2, s[12:15], s39 offen sc1 lds
    s_add_u32 m0, m0, 1024
    s_add_u32 s40, s40, 229376
    buffer_load_dwordx4 v2, s[12:15], s40 offen sc1 lds
    s_add_u32 m0, m0, 1024
    s_add_u32 s39, s39, 229376
    buffer_load_dwordx4 v2, s[12:15], s39 offen sc1 lds
    s_add_u32 m0, m0, 1024
    s_add_u32 s40, s40, 229376
    buffer_load_dwordx4 v2, s[12:15], s40 offen sc1 lds
    s_mov_b32 m0, s19
    s_mov_b32 s39, s16
    s_mov_b32 s40, s17
    s_waitcnt vmcnt(8)
    s_barrier
    buffer_load_dwordx4 v2, s[12:15], s39 offen sc1 lds
    s_add_u32 m0, m0, 1024
    s_nop 0
    buffer_load_dwordx4 v2, s[12:15], s40 offen sc1 lds
    s_add_u32 s54, s52, 16
    s_waitcnt lgkmcnt(0)
    s_cmp_eq_u32 s32, s54
    s_cbranch_scc1 fok_56
    v_mov_b32 v9, s34
    s_mov_b32 s53, 0
    s_add_u32 s54, s52, 16
    s_bfm_b64 exec, 1, 0
poll_57:
    buffer_load_dword v8, v9, s[56:59], 0 offen sc1
    s_waitcnt vmcnt(0)
    v_cmp_eq_u32 vcc, s54, v8
    s_nop 0
    s_cmp_eq_u64 vcc, exec
    s_cbranch_scc1 pok_58
    s_sleep 5
    s_add_u32 s53, s53, 1
    s_cmp_lt_u32 s53, s61
    s_cbranch_scc1 poll_57
    s_mov_b32 s61, 0
pok_58:
    s_mov_b64 exec, -1
fok_56:
    s_call_b64 s[76:77], PREP_a_issue_4
    s_add_u32 m0, m0, 1024
    s_add_u32 s39, s39, 229376
    buffer_load_dwordx4 v2, s[12:15], s39 offen sc1 lds
    s_add_u32 m0, m0, 1024
    s_add_u32 s40, s40, 229376
    buffer_load_dwordx4 v2, s[12:15], s40 offen sc1 lds
    s_add_u32 m0, m0, 1024
    s_add_u32 s39, s39, 229376
    buffer_load_dwordx4 v2, s[12:15], s39 offen sc1 lds
    s_add_u32 m0, m0, 1024
    s_add_u32 s40, s40, 229376
    buffer_load_dwordx4 v2, s[12:15], s40 offen sc1 lds
    s_add_u32 m0, m0, 1024
    s_add_u32 s39, s39, 229376
    buffer_load_dwordx4 v2, s[12:15], s39 offen sc1 lds
    s_add_u32 m0, m0, 1024
    s_add_u32 s40, s40, 229376
    buffer_load_dwordx4 v2, s[12:15], s40 offen sc1 lds
    s_mov_b32 m0, s19
    s_mov_b32 s39, s16
    s_mov_b32 s40, s17
    s_waitcnt vmcnt(8)
    s_barrier
    buffer_load_dwordx4 v2, s[12:15], s39 offen sc1 lds
    s_add_u32 m0, m0, 1024
    s_nop 0
    buffer_load_dwordx4 v2, s[12:15], s40 offen sc1 lds
    s_mov_b32 s43, 1
ld_59:
    s_add_u32 s19, s41, s42
    s_lshl_b32 s45, s44, 1
    s_add_u32 s45, s45, 0
    s_sub_u32 s45, s45, 32
    s_mul_i32 s46, s45, 86
    s_lshr_b32 s46, s46, 8
    s_mul_i32 s47, s46, 3
    s_sub_u32 s47, s45, s47
    s_lshl_b32 s47, s47, 2
    s_lshr_b32 s47, 0x362, s47
    s_and_b32 s47, s47, 7
    s_cmp_ge_u32 s44, 10
    s_cselect_b32 s45, 9, 2
    s_cselect_b32 s51, 1, 0
    s_sub_u32 s45, s44, s45
    s_cmp_lt_u32 s44, 3
    s_cselect_b32 s45, 0, s45
    s_cselect_b32 s51, s44, s51
    s_lshl2_add_u32 s51, 0, s51
    s_cmp_lt_u32 s44, 17
    s_cselect_b32 s47, s51, s47
    s_cselect_b32 s46, s45, s46
    s_add_u32 s46, s46, s33
    s_and_b32 s46, s46, 7
    s_mul_i32 s46, s46, 7
    s_add_u32 s16, s46, s47
    s_lshr_b32 s53, s16, 3
    s_lshl_b32 s53, s53, 14
    s_and_b32 s16, s16, 7
    s_lshl_b32 s16, s16, 10
    s_add_u32 s16, s16, s53
    s_add_u32 s16, s16, s38
    s_lshl_b32 s45, s44, 1
    s_add_u32 s45, s45, 1
    s_sub_u32 s45, s45, 32
    s_mul_i32 s46, s45, 86
    s_lshr_b32 s46, s46, 8
    s_mul_i32 s47, s46, 3
    s_sub_u32 s47, s45, s47
    s_lshl_b32 s47, s47, 2
    s_lshr_b32 s47, 0x362, s47
    s_and_b32 s47, s47, 7
    s_cmp_ge_u32 s44, 10
    s_cselect_b32 s45, 9, 2
    s_cselect_b32 s51, 1, 0
    s_sub_u32 s45, s44, s45
    s_cmp_lt_u32 s44, 3
    s_cselect_b32 s45, 0, s45
    s_cselect_b32 s51, s44, s51
    s_lshl2_add_u32 s51, 1, s51
    s_cmp_lt_u32 s44, 17
    s_cselect_b32 s47, s51, s47
    s_cselect_b32 s46, s45, s46
    s_add_u32 s46, s46, s33
    s_and_b32 s46, s46, 7
    s_mul_i32 s46, s46, 7
    s_add_u32 s17, s46, s47
    s_lshr_b32 s53, s17, 3
    s_lshl_b32 s53, s53, 14
    s_and_b32 s17, s17, 7
    s_lshl_b32 s17, s17, 10
    s_add_u32 s17, s17, s53
    s_add_u32 s17, s17, s38
    s_add_u32 s44, s44, 1
    s_add_u32 s42, s42, 16384
    s_cmp_eq_u32 s42, 49152
    s_cselect_b32 s42, 0, s42
    s_add_u32 m0, m0, 1024
    s_add_u32 s39, s39, 229376
    buffer_load_dwordx4 v2, s[12:15], s39 offen sc1 lds
    s_add_u32 m0, m0, 1024
    s_add_u32 s40, s40, 229376
    buffer_load_dwordx4 v2, s[12:15], s40 offen sc1 lds
    s_add_u32 m0, m0, 1024
    s_add_u32 s39, s39, 229376
    buffer_load_dwordx4 v2, s[12:15], s39 offen sc1 lds
    s_add_u32 m0, m0, 1024
    s_add_u32 s40, s40, 229376
    buffer_load_dwordx4 v2, s[12:15], s40 offen sc1 lds
    s_add_u32 m0, m0, 1024
    s_add_u32 s39, s39, 229376
    buffer_load_dwordx4 v2, s[12:15], s39 offen sc1 lds
    s_add_u32 m0, m0, 1024
    s_add_u32 s40, s40, 229376
    buffer_load_dwordx4 v2, s[12:15], s40 offen sc1 lds
    s_mov_b32 m0, s19
    s_mov_b32 s39, s16
    s_mov_b32 s40, s17
    s_waitcnt vmcnt(8)
    s_barrier
    buffer_load_dwordx4 v2, s[12:15], s39 offen sc1 lds
    s_add_u32 m0, m0, 1024
    s_nop 0
    buffer_load_dwordx4 v2, s[12:15], s40 offen sc1 lds
    s_add_u32 s43, s43, 1
    s_cmp_lt_u32 s43, 5
    s_cbranch_scc1 ld_59
    s_call_b64 s[76:77], PREP_a_issue_4
    s_add_u32 m0, m0, 1024
    s_add_u32 s39, s39, 229376
    buffer_load_dwordx4 v2, s[12:15], s39 offen sc1 lds
    s_add_u32 m0, m0, 1024
    s_add_u32 s40, s40, 229376
    buffer_load_dwordx4 v2, s[12:15], s40 offen sc1 lds
    s_add_u32 m0, m0, 1024
    s_add_u32 s39, s39, 229376
    buffer_load_dwordx4 v2, s[12:15], s39 offen sc1 lds
    s_add_u32 m0, m0, 1024
    s_add_u32 s40, s40, 229376
    buffer_load_dwordx4 v2, s[12:15], s40 offen sc1 lds
    s_add_u32 m0, m0, 1024
    s_add_u32 s39, s39, 229376
    buffer_load_dwordx4 v2, s[12:15], s39 offen sc1 lds
    s_add_u32 m0, m0, 1024
    s_add_u32 s40, s40, 229376
    buffer_load_dwordx4 v2, s[12:15], s40 offen sc1 lds
    s_mov_b32 m0, s19
    s_mov_b32 s39, s16
    s_mov_b32 s40, s17
    s_waitcnt vmcnt(8)
    s_barrier
    buffer_load_dwordx4 v2, s[12:15], s39 offen sc1 lds
    s_add_u32 m0, m0, 1024
    s_nop 0
    buffer_load_dwordx4 v2, s[12:15], s40 offen sc1 lds
    s_load_dword s32, s[4:5], s35
    s_call_b64 s[76:77], PREP_a_issue_4
    s_add_u32 m0, m0, 1024
    s_add_u32 s39, s39, 229376
    buffer_load_dwordx4 v2, s[12:15], s39 offen sc1 lds
    s_add_u32 m0, m0, 1024
    s_add_u32 s40, s40, 229376
    buffer_load_dwordx4 v2, s[12:15], s40 offen sc1 lds
    s_add_u32 m0, m0, 1024
    s_add_u32 s39, s39, 229376
    buffer_load_dwordx4 v2, s[12:15], s39 offen sc1 lds
    s_add_u32 m0, m0, 1024
    s_add_u32 s40, s40, 229376
    buffer_load_dwordx4 v2, s[12:15], s40 offen sc1 lds
    s_add_u32 m0, m0, 1024
    s_add_u32 s39, s39, 229376
    buffer_load_dwordx4 v2, s[12:15], s39 offen sc1 lds
    s_add_u32 m0, m0, 1024
    s_add_u32 s40, s40, 229376
    buffer_load_dwordx4 v2, s[12:15], s40 offen sc1 lds
    s_mov_b32 m0, s19
    s_mov_b32 s39, s16
    s_mov_b32 s40, s17
    s_waitcnt vmcnt(8)
    s_barrier
    buffer_load_dwordx4 v2, s[12:15], s39 offen sc1 lds
    s_add_u32 m0, m0, 1024
    s_nop 0
    buffer_load_dwordx4 v2, s[12:15], s40 offen sc1 lds
    s_add_u32 s54, s52, 16
    s_waitcnt lgkmcnt(0)
    s_cmp_eq_u32 s32, s54
    s_cbranch_scc1 fok_60
    v_mov_b32 v9, s35
    s_mov_b32 s53, 0
    s_add_u32 s54, s52, 16
    s_bfm_b64 exec, 1, 0
poll_61:
    buffer_load_dword v8, v9, s[56:59], 0 offen sc1
    s_waitcnt vmcnt(0)
    v_cmp_eq_u32 vcc, s54, v8
    s_nop 0
    s_cmp_eq_u64 vcc, exec
    s_cbranch_scc1 pok_62
    s_sleep 5
    s_add_u32 s53, s53, 1
    s_cmp_lt_u32 s53, s61
    s_cbranch_scc1 poll_61
    s_mov_b32 s61, 0
pok_62:
    s_mov_b64 exec, -1
fok_60:
    s_call_b64 s[76:77], PREP_a_issue_4
    s_add_u32 m0, m0, 1024
    s_add_u32 s39, s39, 229376
    buffer_load_dwordx4 v2, s[12:15], s39 offen sc1 lds
    s_add_u32 m0, m0, 1024
    s_add_u32 s40, s40, 229376
    buffer_load_dwordx4 v2, s[12:15], s40 offen sc1 lds
    s_add_u32 m0, m0, 1024
    s_add_u32 s39, s39, 229376
    buffer_load_dwordx4 v2, s[12:15], s39 offen sc1 lds
    s_add_u32 m0, m0, 1024
    s_add_u32 s40, s40, 229376
    buffer_load_dwordx4 v2, s[12:15], s40 offen sc1 lds
    s_add_u32 m0, m0, 1024
    s_add_u32 s39, s39, 229376
    buffer_load_dwordx4 v2, s[12:15], s39 offen sc1 lds
    s_add_u32 m0, m0, 1024
    s_add_u32 s40, s40, 229376
    buffer_load_dwordx4 v2, s[12:15], s40 offen sc1 lds
    s_mov_b32 m0, s19
    s_mov_b32 s39, s16
    s_mov_b32 s40, s17
    s_waitcnt vmcnt(8)
    s_barrier
    buffer_load_dwordx4 v2, s[12:15], s39 offen sc1 lds
    s_add_u32 m0, m0, 1024
    s_nop 0
    buffer_load_dwordx4 v2, s[12:15], s40 offen sc1 lds
    s_mov_b32 s43, 1
ld_63:
    s_add_u32 s19, s41, s42
    s_lshl_b32 s45, s44, 1
    s_add_u32 s45, s45, 0
    s_sub_u32 s45, s45, 32
    s_mul_i32 s46, s45, 86
    s_lshr_b32 s46, s46, 8
    s_mul_i32 s47, s46, 3
    s_sub_u32 s47, s45, s47
    s_lshl_b32 s47, s47, 2
    s_lshr_b32 s47, 0x362, s47
    s_and_b32 s47, s47, 7
    s_cmp_ge_u32 s44, 10
    s_cselect_b32 s45, 9, 2
    s_cselect_b32 s51, 1, 0
    s_sub_u32 s45, s44, s45
    s_cmp_lt_u32 s44, 3
    s_cselect_b32 s45, 0, s45
    s_cselect_b32 s51, s44, s51
    s_lshl2_add_u32 s51, 0, s51
    s_cmp_lt_u32 s44, 17
    s_cselect_b32 s47, s51, s47
    s_cselect_b32 s46, s45, s46
    s_add_u32 s46, s46, s33
    s_and_b32 s46, s46, 7
    s_mul_i32 s46, s46, 7
    s_add_u32 s16, s46, s47
    s_lshr_b32 s53, s16, 3
    s_lshl_b32 s53, s53, 14
    s_and_b32 s16, s16, 7
    s_lshl_b32 s16, s16, 10
    s_add_u32 s16, s16, s53
    s_add_u32 s16, s16, s38
    s_lshl_b32 s45, s44, 1
    s_add_u32 s45, s45, 1
    s_sub_u32 s45, s45, 32
    s_mul_i32 s46, s45, 86
    s_lshr_b32 s46, s46, 8
    s_mul_i32 s47, s46, 3
    s_sub_u32 s47, s45, s47
    s_lshl_b32 s47, s47, 2
    s_lshr_b32 s47, 0x362, s47
    s_and_b32 s47, s47, 7
    s_cmp_ge_u32 s44, 10
    s_cselect_b32 s45, 9, 2
    s_cselect_b32 s51, 1, 0
    s_sub_u32 s45, s44, s45
    s_cmp_lt_u32 s44, 3
    s_cselect_b32 s45, 0, s45
    s_cselect_b32 s51, s44, s51
    s_lshl2_add_u32 s51, 1, s51
    s_cmp_lt_u32 s44, 17
    s_cselect_b32 s47, s51, s47
    s_cselect_b32 s46, s45, s46
    s_add_u32 s46, s46, s33
    s_and_b32 s46, s46, 7
    s_mul_i32 s46, s46, 7
    s_add_u32 s17, s46, s47
    s_lshr_b32 s53, s17, 3
    s_lshl_b32 s53, s53, 14
    s_and_b32 s17, s17, 7
    s_lshl_b32 s17, s17, 10
    s_add_u32 s17, s17, s53
    s_add_u32 s17, s17, s38
    s_add_u32 s44, s44, 1
    s_add_u32 s42, s42, 16384
    s_cmp_eq_u32 s42, 49152
    s_cselect_b32 s42, 0, s42
    s_add_u32 m0, m0, 1024
    s_add_u32 s39, s39, 229376
    buffer_load_dwordx4 v2, s[12:15], s39 offen sc1 lds
    s_add_u32 m0, m0, 1024
    s_add_u32 s40, s40, 229376
    buffer_load_dwordx4 v2, s[12:15], s40 offen sc1 lds
    s_add_u32 m0, m0, 1024
    s_add_u32 s39, s39, 229376
    buffer_load_dwordx4 v2, s[12:15], s39 offen sc1 lds
    s_add_u32 m0, m0, 1024
    s_add_u32 s40, s40, 229376
    buffer_load_dwordx4 v2, s[12:15], s40 offen sc1 lds
    s_add_u32 m0, m0, 1024
    s_add_u32 s39, s39, 229376
    buffer_load_dwordx4 v2, s[12:15], s39 offen sc1 lds
    s_add_u32 m0, m0, 1024
    s_add_u32 s40, s40, 229376
    buffer_load_dwordx4 v2, s[12:15], s40 offen sc1 lds
    s_mov_b32 m0, s19
    s_mov_b32 s39, s16
    s_mov_b32 s40, s17
    s_waitcnt vmcnt(8)
    s_barrier
    buffer_load_dwordx4 v2, s[12:15], s39 offen sc1 lds
    s_add_u32 m0, m0, 1024
    s_nop 0
    buffer_load_dwordx4 v2, s[12:15], s40 offen sc1 lds
    s_add_u32 s43, s43, 1
    s_cmp_lt_u32 s43, 10
    s_cbranch_scc1 ld_63
    s_call_b64 s[76:77], PREP_a_issue_4
    s_add_u32 m0, m0, 1024
    s_add_u32 s39, s39, 229376
    buffer_load_dwordx4 v2, s[12:15], s39 offen sc1 lds
    s_add_u32 m0, m0, 1024
    s_add_u32 s40, s40, 229376
    buffer_load_dwordx4 v2, s[12:15], s40 offen sc1 lds
    s_add_u32 m0, m0, 1024
    s_add_u32 s39, s39, 229376
    buffer_load_dwordx4 v2, s[12:15], s39 offen sc1 lds
    s_add_u32 m0, m0, 1024
    s_add_u32 s40, s40, 229376
    buffer_load_dwordx4 v2, s[12:15], s40 offen sc1 lds
    s_add_u32 m0, m0, 1024
    s_add_u32 s39, s39, 229376
    buffer_load_dwordx4 v2, s[12:15], s39 offen sc1 lds
    s_add_u32 m0, m0, 1024
    s_add_u32 s40, s40, 229376
    buffer_load_dwordx4 v2, s[12:15], s40 offen sc1 lds
    s_mov_b32 m0, s19
    s_mov_b32 s39, s16
    s_mov_b32 s40, s17
    s_waitcnt vmcnt(8)
    s_barrier
    buffer_load_dwordx4 v2, s[12:15], s39 offen sc1 lds
    s_add_u32 m0, m0, 1024
    s_nop 0
    buffer_load_dwordx4 v2, s[12:15], s40 offen sc1 lds
    s_add_u32 m0, m0, 1024
    s_add_u32 s39, s39, 229376
    buffer_load_dwordx4 v2, s[12:15], s39 offen sc1 lds
    s_add_u32 m0, m0, 1024
    s_add_u32 s40, s40, 229376
    buffer_load_dwordx4 v2, s[12:15], s40 offen sc1 lds
    s_add_u32 m0, m0, 1024
    s_add_u32 s39, s39, 229376
    buffer_load_dwordx4 v2, s[12:15], s39 offen sc1 lds
    s_add_u32 m0, m0, 1024
    s_add_u32 s40, s40, 229376
    buffer_load_dwordx4 v2, s[12:15], s40 offen sc1 lds
    s_add_u32 m0, m0, 1024
    s_add_u32 s39, s39, 229376
    buffer_load_dwordx4 v2, s[12:15], s39 offen sc1 lds
    s_add_u32 m0, m0, 1024
    s_add_u32 s40, s40, 229376
    buffer_load_dwordx4 v2, s[12:15], s40 offen sc1 lds
    s_waitcnt vmcnt(8)
    s_barrier
    s_waitcnt vmcnt(0)
    s_barrier
    s_cmp_eq_u32 s60, 1
    s_cbranch_scc1 K_fin
    v_and_b32 v81, 7, v0
    v_lshrrev_b32 v84, 6, v0
    v_lshlrev_b32 v84, 4, v84
    v_bfe_u32 v85, v0, 3, 3
    v_add_u32 v84, v84, v85
    s_lshr_b32 s78, s29, 1
    s_lshl_b32 s78, s78, 16
    s_and_b32 s79, s29, 1
    s_lshl_b32 s79, s79, 7
    s_add_u32 s78, s78, s79
    s_lshr_b32 s79, s30, 1
    s_lshl_b32 s79, s79, 13
    s_add_u32 s78, s78, s79
    v_lshlrev_b32 v78, 8, v84
    v_lshl_add_u32 v78, v81, 4, v78
    v_add_u32 v78, s78, v78
    s_lshl_b32 s78, s28, 7
    s_lshl_b32 s79, s29, 3
    s_add_u32 s78, s78, s79
    v_add_u32 v79, s78, v81
    v_lshlrev_b32 v80, 11, v79
    v_and_b32 v85, 3, v79
    v_lshrrev_b32 v82, 2, v79
    v_lshlrev_b32 v82, 14, v82
    v_lshl_add_u32 v82, v85, 11, v82
    v_lshl_add_u32 v82, v84, 4, v82
    v_lshrrev_b32 v85, 2, v84
    v_lshlrev_b32 v85, 3, v85
    v_and_b32 v84, 3, v84
    v_add_u32 v84, v84, v85
    v_lshl_add_u32 v80, v84, 3, v80
    v_lshlrev_b32 v79, 3, v79
    v_lshl_add_u32 v79, v84, 14, v79
    s_lshl_b32 s86, s60, 24
    s_lshl_b32 s87, s94, 13
    s_add_u32 s86, s86, s87
    s_add_u32 s86, s86, 167772160
    s_add_u32 s84, s4, s86
    s_addc_u32 s85, s5, 0
    s_mov_b32 s86, 8380416
    s_mov_b32 s87, 0x20000
    s_add_u32 s88, s62, 0x480000
    s_addc_u32 s89, s63, 0
    s_mov_b32 s90, 0x7e000
    s_mov_b32 s91, 0x20000
    buffer_load_dwordx4 v[86:89], v82, s[84:87], 0 offen offset:0 sc1
    buffer_load_dwordx4 v[94:97], v78, s[88:91], 0 offen offset:0 sc1
    buffer_load_dwordx4 v[90:93], v82, s[84:87], 0 offen offset:128 sc1
    buffer_load_dwordx4 v[98:101], v78, s[88:91], 0 offen offset:2048 sc1
    s_add_u32 s80, s4, 0x1c00000
    s_addc_u32 s81, s5, 0
    s_mov_b32 s82, 0x400000
    s_mov_b32 s83, 0x20000
    s_mov_b32 s78, 0
    buffer_load_dwordx2 v[110:111], v79, s[80:83], s78 offen sc1
    s_mov_b32 s78, 65536
    buffer_load_dwordx2 v[112:113], v79, s[80:83], s78 offen sc1
    s_mov_b32 s78, 262144
    buffer_load_dwordx2 v[114:115], v79, s[80:83], s78 offen sc1
    s_mov_b32 s78, 327680
    buffer_load_dwordx2 v[116:117], v79, s[80:83], s78 offen sc1
    s_waitcnt vmcnt(0)
    s_barrier
    s_branch NEXT
WLOAD:
    s_mov_b64 s[12:13], s[72:73]
    s_mov_b32 s14, 7340032
    s_mov_b32 s15, 0x20000
    s_and_b32 s35, s30, 1
    s_mul_i32 s38, s29, 448
    s_mul_i32 s41, s35, 229376
    s_add_u32 s38, s38, s41
    s_mul_i32 s41, s35, 14336
    s_add_u32 s41, s41, 49152
    s_mov_b32 s42, 0
    s_mov_b32 s44, s29
    s_add_u32 s44, s44, 1
    s_and_b32 s44, s44, 15
    s_add_u32 s44, s44, 1
    s_and_b32 s44, s44, 15
    s_add_u32 s46, s29, 1
    s_and_b32 s46, s46, 15
    s_cmp_eq_u32 s28, s29
    s_cselect_b32 s47, s46, s28
    s_mov_b32 s42, 57344
    s_call_b64 s[76:77], PREP_w_issue_3
    s_mov_b32 m0, s19
    s_mov_b32 s39, s16
    s_waitcnt vmcnt(0)
    s_and_b32 s53, s30, 3
    s_lshl_b32 s53, s53, 7
    s_add_u32 s53, s53, s55
    s_add_u32 s53, s53, 0x400
    v_mov_b32 v14, 1
    v_mov_b32 v15, 0
    s_mov_b64 exec, 1
    buffer_atomic_add v14, v15, s[56:59], s53 offen sc1
    s_mov_b64 exec, -1
    s_call_b64 s[76:77], SUB_rest_2
    s_waitcnt lgkmcnt(0)
    buffer_load_dwordx4 v121, s[12:15], s39 offen lds
    s_add_u32 m0, m0, 1024
    s_nop 0
    buffer_load_dwordx4 v122, s[12:15], s39 offen lds
    s_add_u32 m0, m0, 1024
    s_nop 0
    buffer_load_dwordx4 v123, s[12:15], s39 offen lds
    s_call_b64 s[76:77], PREP_w_issue_3
    s_add_u32 m0, m0, 1024
    s_nop 0
    buffer_load_dwordx4 v124, s[12:15], s39 offen lds
    s_add_u32 m0, m0, 1024
    s_nop 0
    buffer_load_dwordx4 v125, s[12:15], s39 offen lds
    s_add_u32 m0, m0, 1024
    s_nop 0
    buffer_load_dwordx4 v126, s[12:15], s39 offen lds
    s_add_u32 m0, m0, 1024
    s_nop 0
    buffer_load_dwordx4 v127, s[12:15], s39 offen lds
    s_add_u32 m0, m0, 1024
    s_add_u32 s39, s39, 114688
    buffer_load_dwordx4 v121, s[12:15], s39 offen lds
    s_add_u32 m0, m0, 1024
    s_nop 0
    buffer_load_dwordx4 v122, s[12:15], s39 offen lds
    s_add_u32 m0, m0, 1024
    s_nop 0
    buffer_load_dwordx4 v123, s[12:15], s39 offen lds
    s_add_u32 m0, m0, 1024
    s_nop 0
    buffer_load_dwordx4 v124, s[12:15], s39 offen lds
    s_add_u32 m0, m0, 1024
    s_nop 0
    buffer_load_dwordx4 v125, s[12:15], s39 offen lds
    s_add_u32 m0, m0, 1024
    s_nop 0
    buffer_load_dwordx4 v126, s[12:15], s39 offen lds
    s_add_u32 m0, m0, 1024
    s_nop 0
    buffer_load_dwordx4 v127, s[12:15], s39 offen lds
    s_mov_b32 m0, s19
    s_mov_b32 s39, s16
    s_cmp_lg_u32 s60, 0
    s_cbranch_scc1 cs_64
    s_and_b32 s35, s30, 1
    v_lshrrev_b32 v112, 2, v1
    v_mul_u32_u24 v104, 448, v112
    v_and_b32 v113, 3, v1
    v_lshl_add_u32 v104, v113, 3, v104
    v_add_u32 v104, 49152, v104
    s_mul_i32 s36, s35, 224
    v_add_u32 v104, s36, v104
    v_bfe_u32 v112, v1, 4, 1
    v_lshlrev_b32 v112, 5, v112
    s_cmp_eq_u32 s35, 0
    s_cselect_b32 s36, 1, -1
    v_mul_lo_u32 v112, v112, s36
    v_sub_u32 v105, v104, v112
    v_add_u32 v104, v104, v112
    s_cmp_eq_u32 s28, s29
    s_cselect_b32 s36, 0, 28672
    v_add_u32 v104, s36, v104
    v_add_u32 v105, s36, v105
    ds_read_b64_tr_b16 v[48:49], v104 offset:0
    ds_read_b64_tr_b16 v[50:51], v104 offset:7168
    ds_read_b64_tr_b16 v[52:53], v104 offset:14336
    ds_read_b64_tr_b16 v[54:55], v104 offset:21504
    ds_read_b64_tr_b16 v[56:57], v105 offset:32
    ds_read_b64_tr_b16 v[58:59], v105 offset:7200
    ds_read_b64_tr_b16 v[60:61], v105 offset:14368
    ds_read_b64_tr_b16 v[62:63], v105 offset:21536
    ds_read_b64_tr_b16 v[64:65], v104 offset:64
    ds_read_b64_tr_b16 v[66:67], v104 offset:7232
    ds_read_b64_tr_b16 v[68:69], v104 offset:14400
    ds_read_b64_tr_b16 v[70:71], v104 offset:21568
    ds_read_b64_tr_b16 v[72:73], v105 offset:96
    ds_read_b64_tr_b16 v[74:75], v105 offset:7264
    ds_read_b64_tr_b16 v[76:77], v105 offset:14432
    ds_read_b64_tr_b16 v[78:79], v105 offset:21600
    ds_read_b64_tr_b16 v[80:81], v104 offset:128
    ds_read_b64_tr_b16 v[82:83], v104 offset:7296
    ds_read_b64_tr_b16 v[84:85], v104 offset:14464
    ds_read_b64_tr_b16 v[86:87], v104 offset:21632
    ds_read_b64_tr_b16 v[88:89], v105 offset:160
    ds_read_b64_tr_b16 v[90:91], v105 offset:7328
    ds_read_b64_tr_b16 v[92:93], v105 offset:14496
    ds_read_b64_tr_b16 v[94:95], v105 offset:21664
    ds_read_b64_tr_b16 v[96:97], v104 offset:192
    ds_read_b64_tr_b16 v[98:99], v104 offset:7360
    ds_read_b64_tr_b16 v[100:101], v104 offset:14528
    ds_read_b64_tr_b16 v[102:103], v104 offset:21696
    v_and_b32 v112, 15, v1
    v_mov_b32 v113, 0x3f803f80
    v_cmp_eq_u32 vcc, 0, v112
    s_nop 1
    v_cndmask_b32 v20, 0, v113, vcc
    v_cndmask_b32 v21, 0, v113, vcc
    v_cndmask_b32 v22, 0, v113, vcc
    v_cndmask_b32 v23, 0, v113, vcc
    v_cmp_eq_u32 vcc, 1, v112
    s_nop 1
    v_cndmask_b32 v24, 0, v113, vcc
    v_cndmask_b32 v25, 0, v113, vcc
    v_cndmask_b32 v26, 0, v113, vcc
    v_cndmask_b32 v27, 0, v113, vcc
    v_cmp_eq_u32 vcc, 2, v112
    s_nop 1
    v_cndmask_b32 v28, 0, v113, vcc
    v_cndmask_b32 v29, 0, v113, vcc
    v_cndmask_b32 v30, 0, v113, vcc
    v_cndmask_b32 v31, 0, v113, vcc
    v_cmp_eq_u32 vcc, 3, v112
    s_nop 1
    v_cndmask_b32 v32, 0, v113, vcc
    v_cndmask_b32 v33, 0, v113, vcc
    v_cndmask_b32 v34, 0, v113, vcc
    v_cndmask_b32 v35, 0, v113, vcc
    v_cmp_eq_u32 vcc, 4, v112
    s_nop 1
    v_cndmask_b32 v36, 0, v113, vcc
    v_cndmask_b32 v37, 0, v113, vcc
    v_cndmask_b32 v38, 0, v113, vcc
    v_cndmask_b32 v39, 0, v113, vcc
    v_cmp_eq_u32 vcc, 5, v112
    s_nop 1
    v_cndmask_b32 v40, 0, v113, vcc
    v_cndmask_b32 v41, 0, v113, vcc
    v_cndmask_b32 v42, 0, v113, vcc
    v_cndmask_b32 v43, 0, v113, vcc
    v_cmp_eq_u32 vcc, 6, v112
    s_nop 1
    v_cndmask_b32 v44, 0, v113, vcc
    v_cndmask_b32 v45, 0, v113, vcc
    v_cndmask_b32 v46, 0, v113, vcc
    v_cndmask_b32 v47, 0, v113, vcc
    v_and_b32 v114, 48, v1
    v_lshl_add_u32 v114, v112, 6, v114
    v_mov_b32 v113, 0x7f000000
    v_cmp_gt_u32 vcc, 7, v112
    s_nop 1
    v_cndmask_b32 v114, v113, v114, vcc
    s_add_u32 s20, s4, 0x1420000
    s_addc_u32 s21, s5, 0
    s_mov_b32 s22, 0x38000
    s_mov_b32 s23, 0x20000
    s_mul_i32 s36, s28, 14336
    s_lshl1_add_u32 s35, s29, s35
    s_mul_i32 s35, s35, 448
    s_add_u32 s35, s35, s36
    s_waitcnt lgkmcnt(0)
    v_mfma_f32_16x16x32_bf16 v[108:111], v[48:51], v[20:23], 0
    v_mfma_f32_16x16x32_bf16 v[108:111], v[52:55], v[20:23], v[108:111]
    v_mfma_f32_16x16x32_bf16 v[108:111], v[56:59], v[24:27], v[108:111]
    v_mfma_f32_16x16x32_bf16 v[108:111], v[60:63], v[24:27], v[108:111]
    v_mfma_f32_16x16x32_bf16 v[108:111], v[64:67], v[28:31], v[108:111]
    v_mfma_f32_16x16x32_bf16 v[108:111], v[68:71], v[28:31], v[108:111]
    v_mfma_f32_16x16x32_bf16 v[108:111], v[72:75], v[32:35], v[108:111]
    v_mfma_f32_16x16x32_bf16 v[108:111], v[76:79], v[32:35], v[108:111]
    v_mfma_f32_16x16x32_bf16 v[108:111], v[80:83], v[36:39], v[108:111]
    v_mfma_f32_16x16x32_bf16 v[108:111], v[84:87], v[36:39], v[108:111]
    v_mfma_f32_16x16x32_bf16 v[108:111], v[88:91], v[40:43], v[108:111]
    v_mfma_f32_16x16x32_bf16 v[108:111], v[92:95], v[40:43], v[108:111]
    v_mfma_f32_16x16x32_bf16 v[108:111], v[96:99], v[44:47], v[108:111]
    v_mfma_f32_16x16x32_bf16 v[108:111], v[100:103], v[44:47], v[108:111]
    s_nop 7
    buffer_store_dwordx4 v[108:111], v114, s[20:23], s35 offen sc1
cs_64:
    s_waitcnt vmcnt(15)
    s_barrier
    buffer_load_dwordx4 v121, s[12:15], s39 offen lds
    s_add_u32 m0, m0, 1024
    s_nop 0
    buffer_load_dwordx4 v122, s[12:15], s39 offen lds
    s_add_u32 m0, m0, 1024
    s_nop 0
    buffer_load_dwordx4 v123, s[12:15], s39 offen lds
    s_call_b64 s[76:77], PREP_w_issue_3
    s_add_u32 m0, m0, 1024
    s_nop 0
    buffer_load_dwordx4 v124, s[12:15], s39 offen lds
    s_add_u32 m0, m0, 1024
    s_nop 0
    buffer_load_dwordx4 v125, s[12:15], s39 offen lds
    s_add_u32 m0, m0, 1024
    s_nop 0
    buffer_load_dwordx4 v126, s[12:15], s39 offen lds
    s_add_u32 m0, m0, 1024
    s_nop 0
    buffer_load_dwordx4 v127, s[12:15], s39 offen lds
    s_add_u32 m0, m0, 1024
    s_add_u32 s39, s39, 114688
    buffer_load_dwordx4 v121, s[12:15], s39 offen lds
    s_add_u32 m0, m0, 1024
    s_nop 0
    buffer_load_dwordx4 v122, s[12:15], s39 offen lds
    s_add_u32 m0, m0, 1024
    s_nop 0
    buffer_load_dwordx4 v123, s[12:15], s39 offen lds
    s_add_u32 m0, m0, 1024
    s_nop 0
    buffer_load_dwordx4 v124, s[12:15], s39 offen lds
    s_add_u32 m0, m0, 1024
    s_nop 0
    buffer_load_dwordx4 v125, s[12:15], s39 offen lds
    s_add_u32 m0, m0, 1024
    s_nop 0
    buffer_load_dwordx4 v126, s[12:15], s39 offen lds
    s_add_u32 m0, m0, 1024
    s_nop 0
    buffer_load_dwordx4 v127, s[12:15], s39 offen lds
    s_mov_b32 m0, s19
    s_mov_b32 s39, s16
    s_waitcnt vmcnt(14)
    s_barrier
    buffer_load_dwordx4 v121, s[12:15], s39 offen lds
    s_add_u32 m0, m0, 1024
    s_nop 0
    buffer_load_dwordx4 v122, s[12:15], s39 offen lds
    s_add_u32 m0, m0, 1024
    s_nop 0
    buffer_load_dwordx4 v123, s[12:15], s39 offen lds
    s_call_b64 s[76:77], PREP_w_issue_3
    s_add_u32 m0, m0, 1024
    s_nop 0
    buffer_load_dwordx4 v124, s[12:15], s39 offen lds
    s_add_u32 m0, m0, 1024
    s_nop 0
    buffer_load_dwordx4 v125, s[12:15], s39 offen lds
    s_add_u32 m0, m0, 1024
    s_nop 0
    buffer_load_dwordx4 v126, s[12:15], s39 offen lds
    s_add_u32 m0, m0, 1024
    s_nop 0
    buffer_load_dwordx4 v127, s[12:15], s39 offen lds
    s_add_u32 m0, m0, 1024
    s_add_u32 s39, s39, 114688
    buffer_load_dwordx4 v121, s[12:15], s39 offen lds
    s_add_u32 m0, m0, 1024
    s_nop 0
    buffer_load_dwordx4 v122, s[12:15], s39 offen lds
    s_add_u32 m0, m0, 1024
    s_nop 0
    buffer_load_dwordx4 v123, s[12:15], s39 offen lds
    s_add_u32 m0, m0, 1024
    s_nop 0
    buffer_load_dwordx4 v124, s[12:15], s39 offen lds
    s_add_u32 m0, m0, 1024
    s_nop 0
    buffer_load_dwordx4 v125, s[12:15], s39 offen lds
    s_add_u32 m0, m0, 1024
    s_nop 0
    buffer_load_dwordx4 v126, s[12:15], s39 offen lds
    s_add_u32 m0, m0, 1024
    s_nop 0
    buffer_load_dwordx4 v127, s[12:15], s39 offen lds
    s_mov_b32 m0, s19
    s_mov_b32 s39, s16
    s_waitcnt vmcnt(14)
    s_barrier
    buffer_load_dwordx4 v121, s[12:15], s39 offen lds
    s_add_u32 m0, m0, 1024
    s_nop 0
    buffer_load_dwordx4 v122, s[12:15], s39 offen lds
    s_add_u32 m0, m0, 1024
    s_nop 0
    buffer_load_dwordx4 v123, s[12:15], s39 offen lds
    s_call_b64 s[76:77], PREP_w_issue_3
    s_add_u32 m0, m0, 1024
    s_nop 0
    buffer_load_dwordx4 v124, s[12:15], s39 offen lds
    s_add_u32 m0, m0, 1024
    s_nop 0
    buffer_load_dwordx4 v125, s[12:15], s39 offen lds
    s_add_u32 m0, m0, 1024
    s_nop 0
    buffer_load_dwordx4 v126, s[12:15], s39 offen lds
    s_add_u32 m0, m0, 1024
    s_nop 0
    buffer_load_dwordx4 v127, s[12:15], s39 offen lds
    s_add_u32 m0, m0, 1024
    s_add_u32 s39, s39, 114688
    buffer_load_dwordx4 v121, s[12:15], s39 offen lds
    s_add_u32 m0, m0, 1024
    s_nop 0
    buffer_load_dwordx4 v122, s[12:15], s39 offen lds
    s_add_u32 m0, m0, 1024
    s_nop 0
    buffer_load_dwordx4 v123, s[12:15], s39 offen lds
    s_add_u32 m0, m0, 1024
    s_nop 0
    buffer_load_dwordx4 v124, s[12:15], s39 offen lds
    s_add_u32 m0, m0, 1024
    s_nop 0
    buffer_load_dwordx4 v125, s[12:15], s39 offen lds
    s_add_u32 m0, m0, 1024
    s_nop 0
    buffer_load_dwordx4 v126, s[12:15], s39 offen lds
    s_add_u32 m0, m0, 1024
    s_nop 0
    buffer_load_dwordx4 v127, s[12:15], s39 offen lds
    s_mov_b32 m0, s19
    s_mov_b32 s39, s16
    s_waitcnt vmcnt(28)
    s_cmp_lg_u32 s60, 0
    s_cbranch_scc1 cs_65
    s_and_b32 s36, s30, 1
    s_lshl_b32 s36, s36, 13
    s_lshl_b32 s53, s29, 7
    s_add_u32 s36, s36, s53
    s_add_u32 s36, s36, 23068672
    v_mov_b32 v14, 1
    v_mov_b32 v15, 0
    s_mov_b64 exec, 1
    buffer_atomic_add v14, v15, s[56:59], s36 offen sc1
    s_mov_b64 exec, -1
cs_65:
    s_waitcnt vmcnt(14)
    s_barrier
    buffer_load_dwordx4 v121, s[12:15], s39 offen lds
    s_add_u32 m0, m0, 1024
    s_nop 0
    buffer_load_dwordx4 v122, s[12:15], s39 offen lds
    s_add_u32 m0, m0, 1024
    s_nop 0
    buffer_load_dwordx4 v123, s[12:15], s39 offen lds
    s_mov_b32 s43, 1
ld_66:
    s_add_u32 s19, s41, s42
    s_cmp_eq_u32 s44, s47
    s_cselect_b32 s16, s46, s44
    s_mul_i32 s16, s16, 458752
    s_add_u32 s16, s16, s38
    s_add_u32 s44, s44, 1
    s_and_b32 s44, s44, 15
    s_add_u32 s42, s42, 28672
    s_cmp_eq_u32 s42, 86016
    s_cselect_b32 s42, 0, s42
    s_add_u32 m0, m0, 1024
    s_nop 0
    buffer_load_dwordx4 v124, s[12:15], s39 offen lds
    s_add_u32 m0, m0, 1024
    s_nop 0
    buffer_load_dwordx4 v125, s[12:15], s39 offen lds
    s_add_u32 m0, m0, 1024
    s_nop 0
    buffer_load_dwordx4 v126, s[12:15], s39 offen lds
    s_add_u32 m0, m0, 1024
    s_nop 0
    buffer_load_dwordx4 v127, s[12:15], s39 offen lds
    s_add_u32 m0, m0, 1024
    s_add_u32 s39, s39, 114688
    buffer_load_dwordx4 v121, s[12:15], s39 offen lds
    s_add_u32 m0, m0, 1024
    s_nop 0
    buffer_load_dwordx4 v122, s[12:15], s39 offen lds
    s_add_u32 m0, m0, 1024
    s_nop 0
    buffer_load_dwordx4 v123, s[12:15], s39 offen lds
    s_add_u32 m0, m0, 1024
    s_nop 0
    buffer_load_dwordx4 v124, s[12:15], s39 offen lds
    s_add_u32 m0, m0, 1024
    s_nop 0
    buffer_load_dwordx4 v125, s[12:15], s39 offen lds
    s_add_u32 m0, m0, 1024
    s_nop 0
    buffer_load_dwordx4 v126, s[12:15], s39 offen lds
    s_add_u32 m0, m0, 1024
    s_nop 0
    buffer_load_dwordx4 v127, s[12:15], s39 offen lds
    s_mov_b32 m0, s19
    s_mov_b32 s39, s16
    s_waitcnt vmcnt(14)
    s_barrier
    buffer_load_dwordx4 v121, s[12:15], s39 offen lds
    s_add_u32 m0, m0, 1024
    s_nop 0
    buffer_load_dwordx4 v122, s[12:15], s39 offen lds
    s_add_u32 m0, m0, 1024
    s_nop 0
    buffer_load_dwordx4 v123, s[12:15], s39 offen lds
    s_add_u32 s43, s43, 1
    s_cmp_lt_u32 s43, 9
    s_cbranch_scc1 ld_66
    s_call_b64 s[76:77], PREP_w_issue_3
    s_add_u32 m0, m0, 1024
    s_nop 0
    buffer_load_dwordx4 v124, s[12:15], s39 offen lds
    s_add_u32 m0, m0, 1024
    s_nop 0
    buffer_load_dwordx4 v125, s[12:15], s39 offen lds
    s_add_u32 m0, m0, 1024
    s_nop 0
    buffer_load_dwordx4 v126, s[12:15], s39 offen lds
    s_add_u32 m0, m0, 1024
    s_nop 0
    buffer_load_dwordx4 v127, s[12:15], s39 offen lds
    s_add_u32 m0, m0, 1024
    s_add_u32 s39, s39, 114688
    buffer_load_dwordx4 v121, s[12:15], s39 offen lds
    s_add_u32 m0, m0, 1024
    s_nop 0
    buffer_load_dwordx4 v122, s[12:15], s39 offen lds
    s_add_u32 m0, m0, 1024
    s_nop 0
    buffer_load_dwordx4 v123, s[12:15], s39 offen lds
    s_add_u32 m0, m0, 1024
    s_nop 0
    buffer_load_dwordx4 v124, s[12:15], s39 offen lds
    s_add_u32 m0, m0, 1024
    s_nop 0
    buffer_load_dwordx4 v125, s[12:15], s39 offen lds
    s_add_u32 m0, m0, 1024
    s_nop 0
    buffer_load_dwordx4 v126, s[12:15], s39 offen lds
    s_add_u32 m0, m0, 1024
    s_nop 0
    buffer_load_dwordx4 v127, s[12:15], s39 offen lds
    s_mov_b32 m0, s19
    s_mov_b32 s39, s16
    s_waitcnt vmcnt(14)
    s_barrier
    buffer_load_dwordx4 v121, s[12:15], s39 offen lds
    s_add_u32 m0, m0, 1024
    s_nop 0
    buffer_load_dwordx4 v122, s[12:15], s39 offen lds
    s_add_u32 m0, m0, 1024
    s_nop 0
    buffer_load_dwordx4 v123, s[12:15], s39 offen lds
    s_add_u32 m0, m0, 1024
    s_nop 0
    buffer_load_dwordx4 v124, s[12:15], s39 offen lds
    s_add_u32 m0, m0, 1024
    s_nop 0
    buffer_load_dwordx4 v125, s[12:15], s39 offen lds
    s_add_u32 m0, m0, 1024
    s_nop 0
    buffer_load_dwordx4 v126, s[12:15], s39 offen lds
    s_add_u32 m0, m0, 1024
    s_nop 0
    buffer_load_dwordx4 v127, s[12:15], s39 offen lds
    s_add_u32 m0, m0, 1024
    s_add_u32 s39, s39, 114688
    buffer_load_dwordx4 v121, s[12:15], s39 offen lds
    s_add_u32 m0, m0, 1024
    s_nop 0
    buffer_load_dwordx4 v122, s[12:15], s39 offen lds
    s_add_u32 m0, m0, 1024
    s_nop 0
    buffer_load_dwordx4 v123, s[12:15], s39 offen lds
    s_add_u32 m0, m0, 1024
    s_nop 0
    buffer_load_dwordx4 v124, s[12:15], s39 offen lds
    s_add_u32 m0, m0, 1024
    s_nop 0
    buffer_load_dwordx4 v125, s[12:15], s39 offen lds
    s_add_u32 m0, m0, 1024
    s_nop 0
    buffer_load_dwordx4 v126, s[12:15], s39 offen lds
    s_add_u32 m0, m0, 1024
    s_nop 0
    buffer_load_dwordx4 v127, s[12:15], s39 offen lds
    s_waitcnt vmcnt(14)
    s_barrier
    s_waitcnt vmcnt(0)
    s_barrier
    s_barrier
    s_mov_b64 s[12:13], s[74:75]
    s_mov_b32 s14, 7340032
    s_mov_b32 s15, 0x20000
    s_and_b32 s35, s30, 1
    s_mul_i32 s38, s33, 256
    s_mul_i32 s41, s31, 3670016
    s_add_u32 s38, s38, s41
    s_mul_i32 s41, s35, 8192
    s_add_u32 s41, s41, 49152
    s_mov_b32 s42, 0
    s_mov_b32 s44, 0
    s_mov_b32 s49, s44
    s_and_b32 s43, s28, 0
    s_mul_i32 s43, s43, 6
    s_lshr_b32 s43, s43, 2
    s_mov_b32 s50, 0
wpre_67:
    s_mul_i32 s42, s43, 16384
    s_add_u32 s44, s49, s43
    s_add_u32 s19, s41, s42
    s_and_b32 s40, s30, 1
    s_lshl_b32 s45, s44, 1
    s_add_u32 s45, s45, s40
    s_sub_u32 s45, s45, 32
    s_mul_i32 s46, s45, 86
    s_lshr_b32 s46, s46, 8
    s_mul_i32 s47, s46, 3
    s_sub_u32 s47, s45, s47
    s_lshl_b32 s47, s47, 2
    s_lshr_b32 s47, 0x362, s47
    s_and_b32 s47, s47, 7
    s_cmp_ge_u32 s44, 10
    s_cselect_b32 s45, 9, 2
    s_cselect_b32 s51, 1, 0
    s_sub_u32 s45, s44, s45
    s_cmp_lt_u32 s44, 3
    s_cselect_b32 s45, 0, s45
    s_cselect_b32 s51, s44, s51
    s_lshl2_add_u32 s51, s40, s51
    s_cmp_lt_u32 s44, 17
    s_cselect_b32 s47, s51, s47
    s_cselect_b32 s46, s45, s46
    s_add_u32 s46, s46, s33
    s_and_b32 s46, s46, 7
    s_mul_i32 s46, s46, 7
    s_add_u32 s16, s46, s47
    s_mul_i32 s16, s16, 65536
    s_add_u32 s16, s16, s38
    s_cmp_eq_u32 s47, 3
    s_cselect_b32 s17, 8, 4
    s_cselect_b32 s18, -20, 4
    s_lshl_b32 s17, s17, 11
    s_lshl_b32 s18, s18, 11
    s_add_u32 s44, s44, 1
    s_add_u32 s42, s42, 16384
    s_cmp_eq_u32 s42, 98304
    s_cselect_b32 s42, 0, s42
    s_mov_b32 m0, s19
    s_mov_b32 s39, s16
    s_mov_b32 s32, s17
    s_mov_b32 s3, s18
    buffer_load_dwordx4 v119, s[12:15], s39 offen lds
    s_add_u32 m0, m0, 1024
    s_add_u32 s39, s39, s32
    buffer_load_dwordx4 v120, s[12:15], s39 offen lds
    s_add_u32 m0, m0, 1024
    s_add_u32 s39, s39, s32
    buffer_load_dwordx4 v119, s[12:15], s39 offen lds
    s_add_u32 m0, m0, 1024
    s_add_u32 s39, s39, s32
    buffer_load_dwordx4 v120, s[12:15], s39 offen lds
    s_waitcnt vmcnt(8)
    s_add_u32 m0, m0, 1024
    s_add_u32 s39, s39, s3
    buffer_load_dwordx4 v119, s[12:15], s39 offen lds
    s_add_u32 m0, m0, 1024
    s_add_u32 s39, s39, s32
    buffer_load_dwordx4 v120, s[12:15], s39 offen lds
    s_add_u32 m0, m0, 1024
    s_add_u32 s39, s39, s32
    buffer_load_dwordx4 v119, s[12:15], s39 offen lds
    s_add_u32 m0, m0, 1024
    s_add_u32 s39, s39, s32
    buffer_load_dwordx4 v120, s[12:15], s39 offen lds
    s_waitcnt vmcnt(8)
    s_add_u32 s43, s43, 1
    s_cmp_eq_u32 s43, 6
    s_cselect_b32 s43, 0, s43
    s_add_u32 s50, s50, 1
    s_cmp_lt_u32 s50, 6
    s_cbranch_scc1 wpre_67
    s_mov_b32 s42, 0
    s_add_u32 s44, s49, 6
    s_cmp_eq_u32 s60, 1
    s_cbranch_scc1 WL_t1
    s_call_b64 s[76:77], PREP_w_issue_4
    s_mov_b32 m0, s19
    s_mov_b32 s39, s16
    s_mov_b32 s32, s17
    s_mov_b32 s3, s18
    s_waitcnt vmcnt(40)
    s_barrier
    s_waitcnt vmcnt(32)
    s_barrier
    buffer_load_dwordx4 v119, s[12:15], s39 offen lds
    s_add_u32 m0, m0, 1024
    s_add_u32 s39, s39, s32
    buffer_load_dwordx4 v120, s[12:15], s39 offen lds
    s_mov_b32 s43, 1
ld_68:
    s_add_u32 s19, s41, s42
    s_and_b32 s40, s30, 1
    s_lshl_b32 s45, s44, 1
    s_add_u32 s45, s45, s40
    s_sub_u32 s45, s45, 32
    s_mul_i32 s46, s45, 86
    s_lshr_b32 s46, s46, 8
    s_mul_i32 s47, s46, 3
    s_sub_u32 s47, s45, s47
    s_lshl_b32 s47, s47, 2
    s_lshr_b32 s47, 0x362, s47
    s_and_b32 s47, s47, 7
    s_cmp_ge_u32 s44, 10
    s_cselect_b32 s45, 9, 2
    s_cselect_b32 s51, 1, 0
    s_sub_u32 s45, s44, s45
    s_cmp_lt_u32 s44, 3
    s_cselect_b32 s45, 0, s45
    s_cselect_b32 s51, s44, s51
    s_lshl2_add_u32 s51, s40, s51
    s_cmp_lt_u32 s44, 17
    s_cselect_b32 s47, s51, s47
    s_cselect_b32 s46, s45, s46
    s_add_u32 s46, s46, s33
    s_and_b32 s46, s46, 7
    s_mul_i32 s46, s46, 7
    s_add_u32 s16, s46, s47
    s_mul_i32 s16, s16, 65536
    s_add_u32 s16, s16, s38
    s_cmp_eq_u32 s47, 3
    s_cselect_b32 s17, 8, 4
    s_cselect_b32 s18, -20, 4
    s_lshl_b32 s17, s17, 11
    s_lshl_b32 s18, s18, 11
    s_add_u32 s44, s44, 1
    s_add_u32 s42, s42, 16384
    s_cmp_eq_u32 s42, 98304
    s_cselect_b32 s42, 0, s42
    s_add_u32 m0, m0, 1024
    s_add_u32 s39, s39, s32
    buffer_load_dwordx4 v119, s[12:15], s39 offen lds
    s_add_u32 m0, m0, 1024
    s_add_u32 s39, s39, s32
    buffer_load_dwordx4 v120, s[12:15], s39 offen lds
    s_add_u32 m0, m0, 1024
    s_add_u32 s39, s39, s3
    buffer_load_dwordx4 v119, s[12:15], s39 offen lds
    s_add_u32 m0, m0, 1024
    s_add_u32 s39, s39, s32
    buffer_load_dwordx4 v120, s[12:15], s39 offen lds
    s_add_u32 m0, m0, 1024
    s_add_u32 s39, s39, s32
    buffer_load_dwordx4 v119, s[12:15], s39 offen lds
    s_add_u32 m0, m0, 1024
    s_add_u32 s39, s39, s32
    buffer_load_dwordx4 v120, s[12:15], s39 offen lds
    s_mov_b32 m0, s19
    s_mov_b32 s39, s16
    s_mov_b32 s32, s17
    s_mov_b32 s3, s18
    s_waitcnt vmcnt(32)
    s_barrier
    buffer_load_dwordx4 v119, s[12:15], s39 offen lds
    s_add_u32 m0, m0, 1024
    s_add_u32 s39, s39, s32
    buffer_load_dwordx4 v120, s[12:15], s39 offen lds
    s_add_u32 s43, s43, 1
    s_cmp_lt_u32 s43, 21
    s_cbranch_scc1 ld_68
    s_call_b64 s[76:77], PREP_w_issue_4
    s_add_u32 m0, m0, 1024
    s_add_u32 s39, s39, s32
    buffer_load_dwordx4 v119, s[12:15], s39 offen lds
    s_add_u32 m0, m0, 1024
    s_add_u32 s39, s39, s32
    buffer_load_dwordx4 v120, s[12:15], s39 offen lds
    s_add_u32 m0, m0, 1024
    s_add_u32 s39, s39, s3
    buffer_load_dwordx4 v119, s[12:15], s39 offen lds
    s_add_u32 m0, m0, 1024
    s_add_u32 s39, s39, s32
    buffer_load_dwordx4 v120, s[12:15], s39 offen lds
    s_add_u32 m0, m0, 1024
    s_add_u32 s39, s39, s32
    buffer_load_dwordx4 v119, s[12:15], s39 offen lds
    s_add_u32 m0, m0, 1024
    s_add_u32 s39, s39, s32
    buffer_load_dwordx4 v120, s[12:15], s39 offen lds
    s_mov_b32 m0, s19
    s_mov_b32 s39, s16
    s_mov_b32 s32, s17
    s_mov_b32 s3, s18
    s_waitcnt vmcnt(32)
    s_barrier
    buffer_load_dwordx4 v119, s[12:15], s39 offen lds
    s_add_u32 m0, m0, 1024
    s_add_u32 s39, s39, s32
    buffer_load_dwordx4 v120, s[12:15], s39 offen lds
    s_add_u32 m0, m0, 1024
    s_add_u32 s39, s39, s32
    buffer_load_dwordx4 v119, s[12:15], s39 offen lds
    s_add_u32 m0, m0, 1024
    s_add_u32 s39, s39, s32
    buffer_load_dwordx4 v120, s[12:15], s39 offen lds
    s_add_u32 m0, m0, 1024
    s_add_u32 s39, s39, s3
    buffer_load_dwordx4 v119, s[12:15], s39 offen lds
    s_add_u32 m0, m0, 1024
    s_add_u32 s39, s39, s32
    buffer_load_dwordx4 v120, s[12:15], s39 offen lds
    s_add_u32 m0, m0, 1024
    s_add_u32 s39, s39, s32
    buffer_load_dwordx4 v119, s[12:15], s39 offen lds
    s_add_u32 m0, m0, 1024
    s_add_u32 s39, s39, s32
    buffer_load_dwordx4 v120, s[12:15], s39 offen lds
    s_waitcnt vmcnt(32)
    s_barrier
    s_mov_b64 s[12:13], s[68:69]
    s_mov_b32 s14, 2097152
    s_mov_b32 s15, 0x20000
    s_and_b32 s35, s30, 1
    s_mul_i32 s38, s29, 128
    s_mul_i32 s41, s35, 65536
    s_add_u32 s38, s38, s41
    s_mul_i32 s41, s35, 4096
    s_mov_b32 s42, 0
    s_mov_b32 s44, 0
    s_mov_b32 s42, 114688
    s_add_u32 s44, s67, 3
    s_and_b32 s44, s44, 7
    s_or_b32 s44, s44, 8
    s_call_b64 s[76:77], SUB_w_issue_1
    s_mov_b32 s42, 122880
    s_add_u32 s44, s67, 4
    s_and_b32 s44, s44, 7
    s_or_b32 s44, s44, 8
    s_call_b64 s[76:77], SUB_w_issue_1
    s_mov_b32 s42, 147456
    s_add_u32 s44, s67, 7
    s_and_b32 s44, s44, 7
    s_or_b32 s44, s44, 8
    s_call_b64 s[76:77], SUB_w_issue_1
    s_waitcnt vmcnt(36)
    s_barrier
    s_mov_b32 s42, 131072
    s_add_u32 s44, s67, 5
    s_and_b32 s44, s44, 7
    s_or_b32 s44, s44, 8
    s_call_b64 s[76:77], SUB_w_issue_1
    s_mov_b32 s42, 139264
    s_add_u32 s44, s67, 6
    s_and_b32 s44, s44, 7
    s_or_b32 s44, s44, 8
    s_call_b64 s[76:77], SUB_w_issue_1
    s_waitcnt vmcnt(36)
    s_barrier
    s_mov_b32 s42, 49152
    s_add_u32 s44, s67, 3
    s_and_b32 s44, s44, 7
    s_call_b64 s[76:77], SUB_w_issue_1
    s_mov_b32 s42, 57344
    s_add_u32 s44, s67, 4
    s_and_b32 s44, s44, 7
    s_call_b64 s[76:77], SUB_w_issue_1
    s_waitcnt vmcnt(36)
    s_barrier
    s_mov_b32 s42, 65536
    s_add_u32 s44, s67, 5
    s_and_b32 s44, s44, 7
    s_call_b64 s[76:77], SUB_w_issue_1
    s_mov_b32 s42, 73728
    s_add_u32 s44, s67, 6
    s_and_b32 s44, s44, 7
    s_call_b64 s[76:77], SUB_w_issue_1
    s_mov_b32 s42, 24576
    s_add_u32 s44, s67, 0
    s_and_b32 s44, s44, 7
    s_call_b64 s[76:77], SUB_w_issue_1
    s_waitcnt vmcnt(40)
    s_barrier
    v_and_b32 v81, 7, v0
    v_lshrrev_b32 v84, 6, v0
    v_lshlrev_b32 v84, 4, v84
    v_bfe_u32 v85, v0, 3, 3
    v_add_u32 v84, v84, v85
    s_lshr_b32 s78, s29, 1
    s_lshl_b32 s78, s78, 16
    s_and_b32 s79, s29, 1
    s_lshl_b32 s79, s79, 7
    s_add_u32 s78, s78, s79
    s_lshr_b32 s79, s30, 1
    s_lshl_b32 s79, s79, 13
    s_add_u32 s78, s78, s79
    v_lshlrev_b32 v78, 8, v84
    v_lshl_add_u32 v78, v81, 4, v78
    v_add_u32 v78, s78, v78
    s_lshl_b32 s78, s28, 7
    s_lshl_b32 s79, s29, 3
    s_add_u32 s78, s78, s79
    v_add_u32 v79, s78, v81
    v_lshlrev_b32 v80, 11, v79
    v_and_b32 v85, 3, v79
    v_lshrrev_b32 v82, 2, v79
    v_lshlrev_b32 v82, 14, v82
    v_lshl_add_u32 v82, v85, 11, v82
    v_lshl_add_u32 v82, v84, 4, v82
    v_lshrrev_b32 v85, 2, v84
    v_lshlrev_b32 v85, 3, v85
    v_and_b32 v84, 3, v84
    v_add_u32 v84, v84, v85
    v_lshl_add_u32 v80, v84, 3, v80
    v_lshlrev_b32 v79, 3, v79
    v_lshl_add_u32 v79, v84, 14, v79
    s_lshl_b32 s86, s60, 24
    s_lshl_b32 s87, s94, 13
    s_add_u32 s86, s86, s87
    s_add_u32 s86, s86, 167772160
    s_add_u32 s84, s4, s86
    s_addc_u32 s85, s5, 0
    s_mov_b32 s86, 8380416
    s_mov_b32 s87, 0x20000
    s_add_u32 s88, s62, 0x480000
    s_addc_u32 s89, s63, 0
    s_mov_b32 s90, 0x7e000
    s_mov_b32 s91, 0x20000
    buffer_load_dwordx4 v[86:89], v82, s[84:87], 0 offen offset:0 sc1
    buffer_load_dwordx4 v[94:97], v78, s[88:91], 0 offen offset:0 sc1
    buffer_load_dwordx4 v[90:93], v82, s[84:87], 0 offen offset:128 sc1
    buffer_load_dwordx4 v[98:101], v78, s[88:91], 0 offen offset:2048 sc1
    s_add_u32 s80, s4, 0x1c00000
    s_addc_u32 s81, s5, 0
    s_mov_b32 s82, 0x400000
    s_mov_b32 s83, 0x20000
    s_mov_b32 s78, 0
    buffer_load_dwordx2 v[110:111], v79, s[80:83], s78 offen sc1
    s_mov_b32 s78, 65536
    buffer_load_dwordx2 v[112:113], v79, s[80:83], s78 offen sc1
    s_mov_b32 s78, 262144
    buffer_load_dwordx2 v[114:115], v79, s[80:83], s78 offen sc1
    s_mov_b32 s78, 327680
    buffer_load_dwordx2 v[116:117], v79, s[80:83], s78 offen sc1
    s_waitcnt vmcnt(0)
    s_barrier
    s_branch NEXT
WL_t1:
    s_call_b64 s[76:77], PREP_w_issue_4
    s_mov_b32 m0, s19
    s_mov_b32 s39, s16
    s_mov_b32 s32, s17
    s_mov_b32 s3, s18
    s_waitcnt vmcnt(40)
    s_barrier
    s_waitcnt vmcnt(32)
    s_barrier
    s_waitcnt vmcnt(24)
    s_barrier
    s_waitcnt vmcnt(16)
    s_barrier
    s_waitcnt vmcnt(8)
    s_barrier
    buffer_load_dwordx4 v119, s[12:15], s39 offen lds
    s_add_u32 m0, m0, 1024
    s_add_u32 s39, s39, s32
    buffer_load_dwordx4 v120, s[12:15], s39 offen lds
    s_mov_b32 s43, 1
ld_69:
    s_add_u32 s19, s41, s42
    s_and_b32 s40, s30, 1
    s_lshl_b32 s45, s44, 1
    s_add_u32 s45, s45, s40
    s_sub_u32 s45, s45, 32
    s_mul_i32 s46, s45, 86
    s_lshr_b32 s46, s46, 8
    s_mul_i32 s47, s46, 3
    s_sub_u32 s47, s45, s47
    s_lshl_b32 s47, s47, 2
    s_lshr_b32 s47, 0x362, s47
    s_and_b32 s47, s47, 7
    s_cmp_ge_u32 s44, 10
    s_cselect_b32 s45, 9, 2
    s_cselect_b32 s51, 1, 0
    s_sub_u32 s45, s44, s45
    s_cmp_lt_u32 s44, 3
    s_cselect_b32 s45, 0, s45
    s_cselect_b32 s51, s44, s51
    s_lshl2_add_u32 s51, s40, s51
    s_cmp_lt_u32 s44, 17
    s_cselect_b32 s47, s51, s47
    s_cselect_b32 s46, s45, s46
    s_add_u32 s46, s46, s33
    s_and_b32 s46, s46, 7
    s_mul_i32 s46, s46, 7
    s_add_u32 s16, s46, s47
    s_mul_i32 s16, s16, 65536
    s_add_u32 s16, s16, s38
    s_cmp_eq_u32 s47, 3
    s_cselect_b32 s17, 8, 4
    s_cselect_b32 s18, -20, 4
    s_lshl_b32 s17, s17, 11
    s_lshl_b32 s18, s18, 11
    s_add_u32 s44, s44, 1
    s_add_u32 s42, s42, 16384
    s_cmp_eq_u32 s42, 98304
    s_cselect_b32 s42, 0, s42
    s_add_u32 m0, m0, 1024
    s_add_u32 s39, s39, s32
    buffer_load_dwordx4 v119, s[12:15], s39 offen lds
    s_add_u32 m0, m0, 1024
    s_add_u32 s39, s39, s32
    buffer_load_dwordx4 v120, s[12:15], s39 offen lds
    s_add_u32 m0, m0, 1024
    s_add_u32 s39, s39, s3
    buffer_load_dwordx4 v119, s[12:15], s39 offen lds
    s_add_u32 m0, m0, 1024
    s_add_u32 s39, s39, s32
    buffer_load_dwordx4 v120, s[12:15], s39 offen lds
    s_add_u32 m0, m0, 1024
    s_add_u32 s39, s39, s32
    buffer_load_dwordx4 v119, s[12:15], s39 offen lds
    s_add_u32 m0, m0, 1024
    s_add_u32 s39, s39, s32
    buffer_load_dwordx4 v120, s[12:15], s39 offen lds
    s_mov_b32 m0, s19
    s_mov_b32 s39, s16
    s_mov_b32 s32, s17
    s_mov_b32 s3, s18
    s_waitcnt vmcnt(8)
    s_barrier
    buffer_load_dwordx4 v119, s[12:15], s39 offen lds
    s_add_u32 m0, m0, 1024
    s_add_u32 s39, s39, s32
    buffer_load_dwordx4 v120, s[12:15], s39 offen lds
    s_add_u32 s43, s43, 1
    s_cmp_lt_u32 s43, 21
    s_cbranch_scc1 ld_69
    s_call_b64 s[76:77], PREP_w_issue_4
    s_add_u32 m0, m0, 1024
    s_add_u32 s39, s39, s32
    buffer_load_dwordx4 v119, s[12:15], s39 offen lds
    s_add_u32 m0, m0, 1024
    s_add_u32 s39, s39, s32
    buffer_load_dwordx4 v120, s[12:15], s39 offen lds
    s_add_u32 m0, m0, 1024
    s_add_u32 s39, s39, s3
    buffer_load_dwordx4 v119, s[12:15], s39 offen lds
    s_add_u32 m0, m0, 1024
    s_add_u32 s39, s39, s32
    buffer_load_dwordx4 v120, s[12:15], s39 offen lds
    s_add_u32 m0, m0, 1024
    s_add_u32 s39, s39, s32
    buffer_load_dwordx4 v119, s[12:15], s39 offen lds
    s_add_u32 m0, m0, 1024
    s_add_u32 s39, s39, s32
    buffer_load_dwordx4 v120, s[12:15], s39 offen lds
    s_mov_b32 m0, s19
    s_mov_b32 s39, s16
    s_mov_b32 s32, s17
    s_mov_b32 s3, s18
    s_waitcnt vmcnt(8)
    s_barrier
    buffer_load_dwordx4 v119, s[12:15], s39 offen lds
    s_add_u32 m0, m0, 1024
    s_add_u32 s39, s39, s32
    buffer_load_dwordx4 v120, s[12:15], s39 offen lds
    s_add_u32 m0, m0, 1024
    s_add_u32 s39, s39, s32
    buffer_load_dwordx4 v119, s[12:15], s39 offen lds
    s_add_u32 m0, m0, 1024
    s_add_u32 s39, s39, s32
    buffer_load_dwordx4 v120, s[12:15], s39 offen lds
    s_add_u32 m0, m0, 1024
    s_add_u32 s39, s39, s3
    buffer_load_dwordx4 v119, s[12:15], s39 offen lds
    s_add_u32 m0, m0, 1024
    s_add_u32 s39, s39, s32
    buffer_load_dwordx4 v120, s[12:15], s39 offen lds
    s_add_u32 m0, m0, 1024
    s_add_u32 s39, s39, s32
    buffer_load_dwordx4 v119, s[12:15], s39 offen lds
    s_add_u32 m0, m0, 1024
    s_add_u32 s39, s39, s32
    buffer_load_dwordx4 v120, s[12:15], s39 offen lds
    s_waitcnt vmcnt(8)
    s_barrier
    s_waitcnt vmcnt(0)
    s_barrier
    s_branch K_fin
NEXT:
    s_setprio 0
    s_add_u32 s60, s60, 1
    s_add_u32 s55, s55, 67108864
    s_add_u32 s62, s62, 67108864
    s_addc_u32 s63, s63, 0
    s_branch LAYER
K_fin:
    s_endpgm
SUB_w3_sub_3:
    s_mov_b64 s[8:9], s[72:73]
    s_mov_b32 s10, 7340032
    s_mov_b32 s11, 0x20000
    s_add_u32 s36, s29, s88
    s_and_b32 s36, s36, 15
    s_cmp_lg_u32 s28, s29
    s_cselect_b32 s89, s88, 0
    s_cmp_eq_u32 s89, 1
    s_cselect_b32 s36, s28, s36
    s_and_b32 s89, s30, 3
    s_lshl2_add_u32 s36, s36, s89
    s_mul_i32 s90, s36, 114688
    s_mul_i32 s36, s29, 448
    s_add_u32 s90, s90, s36
    s_lshl2_add_u32 s89, s88, s89
    s_mul_i32 s89, s89, 7168
    s_add_u32 m0, s89, 49152
    s_nop 0
    buffer_load_dwordx4 v121, s[8:11], s90 offen lds
    s_add_u32 m0, m0, 1024
    s_nop 0
    buffer_load_dwordx4 v122, s[8:11], s90 offen lds
    s_add_u32 m0, m0, 1024
    s_nop 0
    buffer_load_dwordx4 v123, s[8:11], s90 offen lds
    s_add_u32 m0, m0, 1024
    s_nop 0
    buffer_load_dwordx4 v124, s[8:11], s90 offen lds
    s_add_u32 m0, m0, 1024
    s_nop 0
    buffer_load_dwordx4 v125, s[8:11], s90 offen lds
    s_add_u32 m0, m0, 1024
    s_nop 0
    buffer_load_dwordx4 v126, s[8:11], s90 offen lds
    s_add_u32 m0, m0, 1024
    s_nop 0
    buffer_load_dwordx4 v127, s[8:11], s90 offen lds
    s_setpc_b64 s[76:77]
PREP_a_issue_3:
    s_add_u32 s19, s41, s42
    s_cmp_eq_u32 s44, s47
    s_cselect_b32 s16, s46, s44
    s_cmp_eq_u32 s44, s46
    s_cselect_b32 s16, s47, s16
    s_lshr_b32 s45, s16, 2
    s_lshl_b32 s45, s45, 14
    s_and_b32 s16, s16, 3
    s_lshl_b32 s16, s16, 11
    s_add_u32 s16, s16, s45
    s_add_u32 s16, s16, s38
    s_add_u32 s44, s44, 1
    s_and_b32 s44, s44, 15
    s_add_u32 s42, s42, 16384
    s_cmp_eq_u32 s42, 49152
    s_cselect_b32 s42, 0, s42
    s_setpc_b64 s[76:77]
SUB_rest_2:
    v_lshlrev_b32 v108, 16, v20
    v_and_b32 v109, 0xffff0000, v20
    v_lshlrev_b32 v110, 16, v21
    v_and_b32 v111, 0xffff0000, v21
    v_lshlrev_b32 v112, 16, v22
    v_and_b32 v113, 0xffff0000, v22
    v_lshlrev_b32 v114, 16, v23
    v_and_b32 v115, 0xffff0000, v23
    v_pk_add_f32 v[24:25], v[108:109], v[110:111]
    v_pk_mul_f32 v[26:27], v[108:109], v[108:109]
    v_pk_fma_f32 v[26:27], v[110:111], v[110:111], v[26:27]
    v_pk_add_f32 v[24:25], v[24:25], v[112:113]
    v_pk_fma_f32 v[26:27], v[112:113], v[112:113], v[26:27]
    v_pk_add_f32 v[24:25], v[24:25], v[114:115]
    v_pk_fma_f32 v[26:27], v[114:115], v[114:115], v[26:27]
    v_add_f32 v100, v24, v25
    v_add_f32 v101, v26, v27
    v_lshlrev_b32 v108, 16, v28
    v_and_b32 v109, 0xffff0000, v28
    v_lshlrev_b32 v110, 16, v29
    v_and_b32 v111, 0xffff0000, v29
    v_lshlrev_b32 v112, 16, v30
    v_and_b32 v113, 0xffff0000, v30
    v_lshlrev_b32 v114, 16, v31
    v_and_b32 v115, 0xffff0000, v31
    v_pk_add_f32 v[32:33], v[108:109], v[110:111]
    v_pk_mul_f32 v[34:35], v[108:109], v[108:109]
    v_pk_fma_f32 v[34:35], v[110:111], v[110:111], v[34:35]
    v_pk_add_f32 v[32:33], v[32:33], v[112:113]
    v_pk_fma_f32 v[34:35], v[112:113], v[112:113], v[34:35]
    v_pk_add_f32 v[32:33], v[32:33], v[114:115]
    v_pk_fma_f32 v[34:35], v[114:115], v[114:115], v[34:35]
    v_add_f32 v102, v32, v33
    v_add_f32 v103, v34, v35
    v_lshlrev_b32 v108, 16, v36
    v_and_b32 v109, 0xffff0000, v36
    v_lshlrev_b32 v110, 16, v37
    v_and_b32 v111, 0xffff0000, v37
    v_lshlrev_b32 v112, 16, v38
    v_and_b32 v113, 0xffff0000, v38
    v_lshlrev_b32 v114, 16, v39
    v_and_b32 v115, 0xffff0000, v39
    v_pk_add_f32 v[40:41], v[108:109], v[110:111]
    v_pk_mul_f32 v[42:43], v[108:109], v[108:109]
    v_pk_fma_f32 v[42:43], v[110:111], v[110:111], v[42:43]
    v_pk_add_f32 v[40:41], v[40:41], v[112:113]
    v_pk_fma_f32 v[42:43], v[112:113], v[112:113], v[42:43]
    v_pk_add_f32 v[40:41], v[40:41], v[114:115]
    v_pk_fma_f32 v[42:43], v[114:115], v[114:115], v[42:43]
    v_add_f32 v104, v40, v41
    v_add_f32 v105, v42, v43
    v_lshlrev_b32 v108, 16, v44
    v_and_b32 v109, 0xffff0000, v44
    v_lshlrev_b32 v110, 16, v45
    v_and_b32 v111, 0xffff0000, v45
    v_lshlrev_b32 v112, 16, v46
    v_and_b32 v113, 0xffff0000, v46
    v_lshlrev_b32 v114, 16, v47
    v_and_b32 v115, 0xffff0000, v47
    v_pk_add_f32 v[48:49], v[108:109], v[110:111]
    v_pk_mul_f32 v[50:51], v[108:109], v[108:109]
    v_pk_fma_f32 v[50:51], v[110:111], v[110:111], v[50:51]
    v_pk_add_f32 v[48:49], v[48:49], v[112:113]
    v_pk_fma_f32 v[50:51], v[112:113], v[112:113], v[50:51]
    v_pk_add_f32 v[48:49], v[48:49], v[114:115]
    v_pk_fma_f32 v[50:51], v[114:115], v[114:115], v[50:51]
    v_add_f32 v106, v48, v49
    v_add_f32 v107, v50, v51
    s_and_b32 s36, s30, 3
    s_lshl_b32 s36, s36, 10
    s_add_u32 s36, s36, 155648
    v_lshlrev_b32 v6, 3, v1
    v_add_u32 v6, s36, v6
    v_permlane32_swap_b32 v100, v102
    v_permlane32_swap_b32 v104, v106
    v_permlane32_swap_b32 v101, v103
    v_permlane32_swap_b32 v105, v107
    v_pk_add_f32 v[100:101], v[100:101], v[102:103]
    v_pk_add_f32 v[104:105], v[104:105], v[106:107]
    ds_write_b64 v6, v[100:101] offset:0
    ds_write_b64 v6, v[104:105] offset:512
    s_setpc_b64 s[76:77]
PREP_a_issue_4:
    s_add_u32 s19, s41, s42
    s_lshl_b32 s45, s44, 1
    s_add_u32 s45, s45, 0
    s_sub_u32 s45, s45, 32
    s_mul_i32 s46, s45, 86
    s_lshr_b32 s46, s46, 8
    s_mul_i32 s47, s46, 3
    s_sub_u32 s47, s45, s47
    s_lshl_b32 s47, s47, 2
    s_lshr_b32 s47, 0x362, s47
    s_and_b32 s47, s47, 7
    s_cmp_ge_u32 s44, 10
    s_cselect_b32 s45, 9, 2
    s_cselect_b32 s51, 1, 0
    s_sub_u32 s45, s44, s45
    s_cmp_lt_u32 s44, 3
    s_cselect_b32 s45, 0, s45
    s_cselect_b32 s51, s44, s51
    s_lshl2_add_u32 s51, 0, s51
    s_cmp_lt_u32 s44, 17
    s_cselect_b32 s47, s51, s47
    s_cselect_b32 s46, s45, s46
    s_add_u32 s46, s46, s33
    s_and_b32 s46, s46, 7
    s_mul_i32 s46, s46, 7
    s_add_u32 s16, s46, s47
    s_lshr_b32 s53, s16, 3
    s_lshl_b32 s53, s53, 14
    s_and_b32 s16, s16, 7
    s_lshl_b32 s16, s16, 10
    s_add_u32 s16, s16, s53
    s_add_u32 s16, s16, s38
    s_lshl_b32 s45, s44, 1
    s_add_u32 s45, s45, 1
    s_sub_u32 s45, s45, 32
    s_mul_i32 s46, s45, 86
    s_lshr_b32 s46, s46, 8
    s_mul_i32 s47, s46, 3
    s_sub_u32 s47, s45, s47
    s_lshl_b32 s47, s47, 2
    s_lshr_b32 s47, 0x362, s47
    s_and_b32 s47, s47, 7
    s_cmp_ge_u32 s44, 10
    s_cselect_b32 s45, 9, 2
    s_cselect_b32 s51, 1, 0
    s_sub_u32 s45, s44, s45
    s_cmp_lt_u32 s44, 3
    s_cselect_b32 s45, 0, s45
    s_cselect_b32 s51, s44, s51
    s_lshl2_add_u32 s51, 1, s51
    s_cmp_lt_u32 s44, 17
    s_cselect_b32 s47, s51, s47
    s_cselect_b32 s46, s45, s46
    s_add_u32 s46, s46, s33
    s_and_b32 s46, s46, 7
    s_mul_i32 s46, s46, 7
    s_add_u32 s17, s46, s47
    s_lshr_b32 s53, s17, 3
    s_lshl_b32 s53, s53, 14
    s_and_b32 s17, s17, 7
    s_lshl_b32 s17, s17, 10
    s_add_u32 s17, s17, s53
    s_add_u32 s17, s17, s38
    s_add_u32 s44, s44, 1
    s_add_u32 s42, s42, 16384
    s_cmp_eq_u32 s42, 49152
    s_cselect_b32 s42, 0, s42
    s_setpc_b64 s[76:77]
PREP_w_issue_3:
    s_add_u32 s19, s41, s42
    s_cmp_eq_u32 s44, s47
    s_cselect_b32 s16, s46, s44
    s_mul_i32 s16, s16, 458752
    s_add_u32 s16, s16, s38
    s_add_u32 s44, s44, 1
    s_and_b32 s44, s44, 15
    s_add_u32 s42, s42, 28672
    s_cmp_eq_u32 s42, 86016
    s_cselect_b32 s42, 0, s42
    s_setpc_b64 s[76:77]
PREP_w_issue_4:
    s_add_u32 s19, s41, s42
    s_and_b32 s40, s30, 1
    s_lshl_b32 s45, s44, 1
    s_add_u32 s45, s45, s40
    s_sub_u32 s45, s45, 32
    s_mul_i32 s46, s45, 86
    s_lshr_b32 s46, s46, 8
    s_mul_i32 s47, s46, 3
    s_sub_u32 s47, s45, s47
    s_lshl_b32 s47, s47, 2
    s_lshr_b32 s47, 0x362, s47
    s_and_b32 s47, s47, 7
    s_cmp_ge_u32 s44, 10
    s_cselect_b32 s45, 9, 2
    s_cselect_b32 s51, 1, 0
    s_sub_u32 s45, s44, s45
    s_cmp_lt_u32 s44, 3
    s_cselect_b32 s45, 0, s45
    s_cselect_b32 s51, s44, s51
    s_lshl2_add_u32 s51, s40, s51
    s_cmp_lt_u32 s44, 17
    s_cselect_b32 s47, s51, s47
    s_cselect_b32 s46, s45, s46
    s_add_u32 s46, s46, s33
    s_and_b32 s46, s46, 7
    s_mul_i32 s46, s46, 7
    s_add_u32 s16, s46, s47
    s_mul_i32 s16, s16, 65536
    s_add_u32 s16, s16, s38
    s_cmp_eq_u32 s47, 3
    s_cselect_b32 s17, 8, 4
    s_cselect_b32 s18, -20, 4
    s_lshl_b32 s17, s17, 11
    s_lshl_b32 s18, s18, 11
    s_add_u32 s44, s44, 1
    s_add_u32 s42, s42, 16384
    s_cmp_eq_u32 s42, 98304
    s_cselect_b32 s42, 0, s42
    s_setpc_b64 s[76:77]
SUB_w_issue_1:
    s_add_u32 s19, s41, s42
    s_mul_i32 s16, s44, 131072
    s_add_u32 s16, s16, s38
    s_mov_b32 m0, s19
    s_mov_b32 s39, s16
    buffer_load_dwordx4 v118, s[12:15], s39 offen lds
    s_add_u32 m0, m0, 1024
    s_add_u32 s39, s39, 16384
    buffer_load_dwordx4 v118, s[12:15], s39 offen lds
    s_add_u32 m0, m0, 1024
    s_add_u32 s39, s39, 16384
    buffer_load_dwordx4 v118, s[12:15], s39 offen lds
    s_add_u32 m0, m0, 1024
    s_add_u32 s39, s39, 16384
    buffer_load_dwordx4 v118, s[12:15], s39 offen lds
    s_setpc_b64 s[76:77]
K_end:
    s_endpgm
.section .rodata,"a"
.p2align 6
.amdhsa_kernel interleave_layers__ssm_conv_h3__mixer_s_mlp__prompt_kernel
  .amdhsa_next_free_vgpr 256
  .amdhsa_next_free_sgpr 102
  .amdhsa_accum_offset 256
  .amdhsa_group_segment_fixed_size 0
  .amdhsa_kernarg_size 112
  .amdhsa_user_sgpr_count 2
  .amdhsa_user_sgpr_kernarg_segment_ptr 1
  .amdhsa_system_sgpr_workgroup_id_x 1
  .amdhsa_float_denorm_mode_32 3
.end_amdhsa_kernel
```

```asm
; @launch grid=(256,1,1) block=(512,1,1) lds=163840
.amdgcn_target "amdgcn-amd-amdhsa--gfx950"
.text
.globl interleave_layers__ssm_conv_h3__mixer_s_mlp__prompt_kernel
.p2align 8
.type interleave_layers__ssm_conv_h3__mixer_s_mlp__prompt_kernel,@function
interleave_layers__ssm_conv_h3__mixer_s_mlp__prompt_kernel:
    s_cmp_ge_u32 s2, 256
    s_cbranch_scc1 K_end
    s_load_dwordx8 s[8:15], s[0:1], 8
    s_load_dwordx2 s[6:7], s[0:1], 0
    s_load_dwordx8 s[68:75], s[0:1], 56
    s_load_dwordx2 s[4:5], s[0:1], 104
    s_load_dwordx2 s[84:85], s[0:1], 96
    s_memrealtime s[46:47]
    s_load_dwordx2 s[76:77], s[0:1], 40
    v_lshrrev_b32 v1, 6, v0
    s_nop 0
    v_readfirstlane_b32 s30, v1
    s_getpc_b64 s[48:49]
K_pc:
    s_lshr_b32 s36, s2, 3
    s_lshl_b32 s36, s36, 12
    v_lshlrev_b32 v252, 3, v0
    v_add_u32 v252, s36, v252
    v_cmp_gt_u32 vcc, K_end-K_pc-8, v252
    s_nop 0
    s_and_saveexec_b64 s[36:37], vcc
    s_cbranch_execz K_3
    v_mov_b32 v253, s49
    v_add_co_u32 v252, vcc, s48, v252
    s_nop 1
    v_addc_co_u32 v253, vcc, 0, v253, vcc
    global_load_dword v250, v[252:253], off
K_3:
    s_mov_b64 exec, -1
    v_bfe_u32 v8, v0, 4, 2
    v_and_b32 v9, 15, v0
    v_lshlrev_b32 v6, 11, v8
    v_lshlrev_b32 v8, 1, v8
    v_xor_b32 v8, v8, v9
    v_lshl_add_u32 v8, v8, 4, v6
    s_and_b32 s34, s2, 7
    s_lshr_b32 s35, s2, 3
    s_lshl_b32 s36, s35, 17
    s_lshl_b32 s37, s34, 8
    s_add_u32 s36, s36, s37
    s_lshl_b32 s37, s30, 6
    s_and_b32 s38, s37, 128
    s_add_u32 s37, s37, 64
    s_and_b32 s37, s37, 128
    v_xor_b32 v6, s38, v8
    v_xor_b32 v7, s37, v8
    s_lshl_b32 s37, s30, 14
    s_add_u32 s37, s37, s36
    s_add_u32 s38, s37, 8192
    s_lshl_b32 s39, s30, 11
    s_mov_b32 s18, 4194304
    s_mov_b32 s19, 0x20000
    s_mov_b32 s22, s18
    s_mov_b32 s23, s19
    s_add_u32 m0, s39, 99328
    s_waitcnt lgkmcnt(0)
    s_mov_b64 s[16:17], s[8:9]
    s_mov_b64 s[20:21], s[10:11]
    buffer_load_dwordx4 v6, s[16:19], s37 offen nt lds
    s_add_u32 m0, m0, 1024
    s_nop 0
    buffer_load_dwordx4 v7, s[16:19], s38 offen nt lds
    s_add_u32 m0, s39, 115712
    s_nop 0
    buffer_load_dwordx4 v6, s[20:23], s37 offen nt lds
    s_add_u32 m0, m0, 1024
    s_nop 0
    buffer_load_dwordx4 v6, s[20:23], s38 offen nt lds
    s_mov_b32 s86, 256
    s_mov_b32 s87, 0x20000
    v_mov_b32 v10, 0
    s_cmp_lg_u32 s30, 0
    s_cbranch_scc1 KV_t0
    s_sub_u32 s36, s36, 8192
    v_add_u32 v8, s36, v8
    s_mov_b32 m0, 98304
    s_nop 0
    buffer_load_dwordx4 v8, s[16:19], 0 offen nt lds
    s_cmp_lg_u32 s2, 0
    s_cbranch_scc1 KV_t0
    s_lshl_b32 s44, s46, 6
    s_or_b32 s44, s44, 1
    v_mov_b32 v9, s44
    s_mov_b64 exec, 1
    buffer_store_dword v9, v10, s[84:87], 0 offen sc1
    s_mov_b64 exec, -1
KV_t0:
    s_lshl_b32 s37, s34, 10
    s_lshl_b32 s38, s30, 7
    s_add_u32 s37, s37, s38
    v_and_b32 v9, 15, v0
    v_lshlrev_b32 v9, 3, v9
    s_mov_b32 s24, s12
    s_mov_b32 s25, s13
    s_mov_b32 s26, 0x2000
    s_mov_b32 s27, 0x20000
    buffer_load_dwordx2 v[12:13], v9, s[24:27], s37 offen
    v_and_b32 v1, 63, v0
    v_lshlrev_b32 v2, 4, v1
    v_lshlrev_b32 v3, 2, v1
    s_and_b32 s32, s2, 7
    s_lshr_b32 s33, s2, 3
    s_and_b32 s28, s32, 2
    s_lshr_b32 s34, s32, 2
    s_or_b32 s28, s28, s34
    s_lshl_b32 s28, s28, 2
    s_and_b32 s34, s33, 3
    s_add_u32 s28, s28, s34
    s_and_b32 s31, s32, 1
    s_lshr_b32 s33, s33, 2
    s_lshl_b32 s29, s31, 3
    s_add_u32 s29, s29, s33
    s_and_b32 s67, s33, 4
    s_mov_b32 s60, 0
    s_mov_b32 s61, 40000
    s_mov_b32 s52, 0
    s_mov_b32 s55, 0
    s_mov_b32 s92, 0
    s_mov_b32 s93, 0
    s_mov_b32 s94, 0
    s_mov_b32 s56, s4
    s_mov_b32 s57, s5
    s_mov_b32 s58, 0xa000000
    s_mov_b32 s59, 0x20000
    s_add_u32 s62, s4, 33554432
    s_addc_u32 s63, s5, 0
    s_cmp_lg_u32 s30, 4
    s_cbranch_scc1 HB_1
    v_add_u32 v14, 162816, v3
    ds_write_b32 v14, v10
HB_1:
    s_mov_b64 s[88:89], s[70:71]
    s_mov_b32 s90, 2097152
    s_mov_b32 s91, 0x20000
    s_lshl3_add_u32 s36, s2, s30
    s_lshl_b32 s36, s36, 10
    s_mov_b64 s[80:81], s[68:69]
    s_mov_b32 s82, 2097152
    s_mov_b32 s83, 0x20000
    s_mov_b32 s50, s36
    v_lshrrev_b32 v14, 3, v1
    v_lshlrev_b32 v118, 11, v14
    v_and_b32 v14, 6, v14
    v_and_b32 v15, 7, v1
    v_xor_b32 v14, v14, v15
    v_lshl_add_u32 v118, v14, 4, v118
    s_lshl_b32 s48, s29, 7
    s_lshl_b32 s36, s30, 14
    s_add_u32 s48, s48, s36
    s_lshl_b32 s49, s30, 10
    s_add_u32 s48, s48, 1048576
    s_and_b32 s41, s30, 3
    s_and_b32 s38, s2, 7
    s_lshl_b32 s38, s38, 5
    s_lshr_b32 s39, s2, 3
    s_add_u32 s38, s38, s39
    s_lshl_b32 s39, s38, 2
    s_add_u32 s39, s39, s41
    s_mul_i32 s40, s41, 21504
    s_lshl_b32 s36, s39, 12
    s_add_u32 s12, s14, s36
    s_addc_u32 s13, s15, 0
    s_mov_b32 s14, 4096
    s_mov_b32 s15, 0x20000
    s_lshr_b32 s45, s30, 2
    s_lshl_b32 s45, s45, 11
    s_add_u32 s36, s45, 0xffffffc0
    v_add_u32 v22, s36, v2
    v_add_u32 v23, 16, v22
    s_add_u32 s36, s45, 0x3c0
    v_add_u32 v24, s36, v2
    v_add_u32 v25, 16, v24
    s_mov_b32 s36, 4032
    v_add_u32 v26, s36, v2
    v_add_u32 v27, 16, v26
    v_add_u32 v19, s40, v2
    v_add_u32 v20, s45, v19
    s_lshl_b32 s36, s38, 14
    s_add_u32 s36, s36, 25165824
    s_add_u32 s20, s4, s36
    s_addc_u32 s21, s5, 0
    s_mov_b32 s22, 16384
    s_mov_b32 s23, 0x20000
    s_lshl_b32 s36, s30, 6
    v_lshrrev_b32 v94, 2, v1
    v_and_b32 v97, 48, v2
    v_lshl_add_u32 v97, v94, 8, v97
    v_add_u32 v97, s36, v97
    s_lshr_b32 s36, s39, 1
    s_lshl_b32 s36, s36, 2
    s_load_dword s41, s[76:77], s36
    v_and_b32 v100, 15, v1
    v_lshrrev_b32 v101, 4, v1
    v_and_b32 v94, 3, v100
    v_mul_u32_u24 v98, 4160, v94
    v_lshl_add_u32 v98, v101, 4, v98
    v_lshrrev_b32 v94, 2, v100
    v_lshl_add_u32 v98, v94, 3, v98
    v_add_u32 v98, s40, v98
    v_sub_u32 v94, 15, v100
    v_lshlrev_b32 v99, 5, v94
    v_add_u32 v99, s40, v99
    v_lshl_add_u32 v99, v101, 4, v99
    s_lshr_b32 s36, s38, 2
    s_lshl_b32 s36, s36, 12
    s_add_u32 s36, s36, 23330816
    v_lshlrev_b32 v102, 7, v1
    v_add_u32 v102, s36, v102
    v_and_b32 v81, 7, v0
    v_lshrrev_b32 v84, 6, v0
    v_lshlrev_b32 v84, 4, v84
    v_bfe_u32 v85, v0, 3, 3
    v_add_u32 v84, v84, v85
    s_lshr_b32 s78, s29, 1
    s_lshl_b32 s78, s78, 16
    s_and_b32 s79, s29, 1
    s_lshl_b32 s79, s79, 7
    s_add_u32 s78, s78, s79
    s_lshr_b32 s79, s30, 1
    s_lshl_b32 s79, s79, 13
    s_add_u32 s78, s78, s79
    v_lshlrev_b32 v78, 8, v84
    v_lshl_add_u32 v78, v81, 4, v78
    v_add_u32 v78, s78, v78
    s_lshl_b32 s78, s28, 7
    s_lshl_b32 s79, s29, 3
    s_add_u32 s78, s78, s79
    v_add_u32 v79, s78, v81
    v_lshlrev_b32 v80, 11, v79
    v_and_b32 v85, 3, v79
    v_lshrrev_b32 v82, 2, v79
    v_lshlrev_b32 v82, 14, v82
    v_lshl_add_u32 v82, v85, 11, v82
    v_lshl_add_u32 v82, v84, 4, v82
    v_lshrrev_b32 v85, 2, v84
    v_lshlrev_b32 v85, 3, v85
    v_and_b32 v84, 3, v84
    v_add_u32 v84, v84, v85
    v_lshl_add_u32 v80, v84, 3, v80
    v_lshlrev_b32 v79, 3, v79
    v_lshl_add_u32 v79, v84, 14, v79
    s_mov_b32 s8, s6
    s_mov_b32 s9, s7
    s_mov_b32 s10, 0x400000
    s_mov_b32 s11, 0x20000
    v_mov_b32 v60, 0
    v_mov_b32 v61, 0
    v_mov_b32 v62, 0
    v_mov_b32 v63, 0
    s_bfm_b64 exec, 40, 0
    ds_write_b128 v19, v[60:63] offset:20736
    s_mov_b64 exec, -1
    s_and_b32 s34, s2, 7
    s_lshr_b32 s35, s2, 3
    v_bfe_u32 v14, v1, 2, 3
    v_xor_b32 v14, s30, v14
    v_lshlrev_b32 v16, 5, v14
    v_and_b32 v14, 3, v1
    v_lshl_add_u32 v16, v14, 3, v16
    v_bfe_u32 v14, v1, 2, 2
    v_lshl_add_u32 v16, v14, 8, v16
    v_lshrrev_b32 v14, 4, v1
    v_lshl_add_u32 v16, v14, 12, v16
    v_add_u32 v16, 98304, v16
    v_xor_b32 v17, 128, v16
    s_add_u32 s16, s4, 0x1800000
    s_addc_u32 s17, s5, 0
    s_mov_b32 s18, 0x400000
    s_mov_b32 s19, 0x20000
    v_bfe_u32 v18, v1, 2, 2
    v_lshlrev_b32 v18, 14, v18
    v_and_b32 v14, 3, v1
    v_lshl_add_u32 v18, v14, 6, v18
    v_bfe_u32 v14, v1, 4, 1
    v_lshrrev_b32 v15, 5, v1
    v_lshl_add_u32 v14, v14, 1, v15
    v_xor_b32 v14, 3, v14
    v_lshl_add_u32 v18, v14, 4, v18
    s_lshl3_add_u32 s42, s34, s30
    s_lshl_b32 s43, s42, 16
    s_sub_u32 s37, 31, s35
    s_lshl_b32 s37, s37, 9
    s_add_u32 s43, s43, s37
    s_lshl_b32 s44, s42, 5
    s_add_u32 s44, s44, s35
    s_lshl_b32 s44, s44, 7
    s_add_u32 s44, s44, 23330816
    buffer_load_dwordx4 v[28:31], v22, s[12:15], 0 offen nt
    buffer_load_dwordx2 v[32:33], v23, s[12:15], 0 offen nt
    buffer_load_dwordx4 v[34:37], v24, s[12:15], 0 offen nt
    buffer_load_dwordx2 v[38:39], v25, s[12:15], 0 offen nt
    buffer_load_dwordx4 v[40:43], v26, s[12:15], 0 offen nt
    buffer_load_dwordx2 v[44:45], v27, s[12:15], 0 offen nt
    buffer_load_dwordx4 v[240:243], v2, s[88:91], s50 offen
    s_waitcnt vmcnt(7) lgkmcnt(0)
    s_barrier
    ds_read_b64_tr_b16 v[128:129], v16 offset:0
    ds_read_b64_tr_b16 v[130:131], v16 offset:1024
    ds_read_b64_tr_b16 v[132:133], v16 offset:2048
    ds_read_b64_tr_b16 v[134:135], v16 offset:3072
    ds_read_b64_tr_b16 v[136:137], v17 offset:4096
    ds_read_b64_tr_b16 v[138:139], v16 offset:17408
    ds_read_b64_tr_b16 v[140:141], v16 offset:18432
    ds_read_b64_tr_b16 v[142:143], v16 offset:19456
    ds_read_b64_tr_b16 v[144:145], v16 offset:20480
    s_load_dword s52, s[84:85], 0
    v_lshlrev_b32 v46, 16, v12
    v_and_b32 v47, 0xffff0000, v12
    v_lshlrev_b32 v48, 16, v13
    v_and_b32 v49, 0xffff0000, v13
    s_waitcnt lgkmcnt(0)
    v_lshlrev_b32 v146, 16, v128
    v_and_b32 v147, 0xffff0000, v128
    v_lshlrev_b32 v148, 16, v129
    v_and_b32 v149, 0xffff0000, v129
    v_lshlrev_b32 v150, 16, v130
    v_and_b32 v151, 0xffff0000, v130
    v_lshlrev_b32 v152, 16, v131
    v_and_b32 v153, 0xffff0000, v131
    v_lshlrev_b32 v154, 16, v132
    v_and_b32 v155, 0xffff0000, v132
    v_lshlrev_b32 v156, 16, v133
    v_and_b32 v157, 0xffff0000, v133
    v_lshlrev_b32 v158, 16, v134
    v_and_b32 v159, 0xffff0000, v134
    v_lshlrev_b32 v160, 16, v135
    v_and_b32 v161, 0xffff0000, v135
    v_lshlrev_b32 v162, 16, v136
    v_and_b32 v163, 0xffff0000, v136
    v_lshlrev_b32 v164, 16, v137
    v_and_b32 v165, 0xffff0000, v137
    v_mul_f32 v166, v147, v49
    v_mul_f32 v167, v148, v49
    v_mul_f32 v168, v149, v49
    v_mul_f32 v169, v150, v49
    v_mul_f32 v170, v151, v49
    v_mul_f32 v171, v152, v49
    v_mul_f32 v172, v153, v49
    v_mul_f32 v173, v154, v49
    v_mul_f32 v174, v155, v49
    v_mul_f32 v175, v156, v49
    v_mul_f32 v176, v157, v49
    v_mul_f32 v177, v158, v49
    v_mul_f32 v178, v159, v49
    v_mul_f32 v179, v160, v49
    v_mul_f32 v180, v161, v49
    v_mul_f32 v181, v162, v49
    v_fmac_f32 v166, v148, v48
    v_fmac_f32 v167, v149, v48
    v_fmac_f32 v168, v150, v48
    v_fmac_f32 v169, v151, v48
    v_fmac_f32 v170, v152, v48
    v_fmac_f32 v171, v153, v48
    v_fmac_f32 v172, v154, v48
    v_fmac_f32 v173, v155, v48
    v_fmac_f32 v174, v156, v48
    v_fmac_f32 v175, v157, v48
    v_fmac_f32 v176, v158, v48
    v_fmac_f32 v177, v159, v48
    v_fmac_f32 v178, v160, v48
    v_fmac_f32 v179, v161, v48
    v_fmac_f32 v180, v162, v48
    v_fmac_f32 v181, v163, v48
    v_fmac_f32 v166, v149, v47
    v_fmac_f32 v167, v150, v47
    v_fmac_f32 v168, v151, v47
    v_fmac_f32 v169, v152, v47
    v_fmac_f32 v170, v153, v47
    v_fmac_f32 v171, v154, v47
    v_fmac_f32 v172, v155, v47
    v_fmac_f32 v173, v156, v47
    v_fmac_f32 v174, v157, v47
    v_fmac_f32 v175, v158, v47
    v_fmac_f32 v176, v159, v47
    v_fmac_f32 v177, v160, v47
    v_fmac_f32 v178, v161, v47
    v_fmac_f32 v179, v162, v47
    v_fmac_f32 v180, v163, v47
    v_fmac_f32 v181, v164, v47
    v_fmac_f32 v166, v150, v46
    v_fmac_f32 v167, v151, v46
    v_fmac_f32 v168, v152, v46
    v_fmac_f32 v169, v153, v46
    v_fmac_f32 v170, v154, v46
    v_fmac_f32 v171, v155, v46
    v_fmac_f32 v172, v156, v46
    v_fmac_f32 v173, v157, v46
    v_fmac_f32 v174, v158, v46
    v_fmac_f32 v175, v159, v46
    v_fmac_f32 v176, v160, v46
    v_fmac_f32 v177, v161, v46
    v_fmac_f32 v178, v162, v46
    v_fmac_f32 v179, v163, v46
    v_fmac_f32 v180, v164, v46
    v_fmac_f32 v181, v165, v46
    v_lshlrev_b32 v146, 16, v138
    v_and_b32 v147, 0xffff0000, v138
    v_lshlrev_b32 v148, 16, v139
    v_and_b32 v149, 0xffff0000, v139
    v_lshlrev_b32 v150, 16, v140
    v_and_b32 v151, 0xffff0000, v140
    v_lshlrev_b32 v152, 16, v141
    v_and_b32 v153, 0xffff0000, v141
    v_lshlrev_b32 v154, 16, v142
    v_and_b32 v155, 0xffff0000, v142
    v_lshlrev_b32 v156, 16, v143
    v_and_b32 v157, 0xffff0000, v143
    v_lshlrev_b32 v158, 16, v144
    v_and_b32 v159, 0xffff0000, v144
    v_lshlrev_b32 v160, 16, v145
    v_and_b32 v161, 0xffff0000, v145
    v_mul_f32 v166, v166, v146
    v_mul_f32 v167, v167, v147
    v_mul_f32 v168, v168, v148
    v_mul_f32 v169, v169, v149
    v_mul_f32 v170, v170, v150
    v_mul_f32 v171, v171, v151
    v_mul_f32 v172, v172, v152
    v_mul_f32 v173, v173, v153
    v_mul_f32 v174, v174, v154
    v_mul_f32 v175, v175, v155
    v_mul_f32 v176, v176, v156
    v_mul_f32 v177, v177, v157
    v_mul_f32 v178, v178, v158
    v_mul_f32 v179, v179, v159
    v_mul_f32 v180, v180, v160
    v_mul_f32 v181, v181, v161
    v_add_u32 v167, 0x10000, v167
    v_and_b32 v167, 0xfffe0000, v167
    v_add_u32 v169, 0x10000, v169
    v_and_b32 v169, 0xfffe0000, v169
    v_add_u32 v171, 0x10000, v171
    v_and_b32 v171, 0xfffe0000, v171
    v_add_u32 v173, 0x10000, v173
    v_and_b32 v173, 0xfffe0000, v173
    v_add_u32 v175, 0x10000, v175
    v_and_b32 v175, 0xfffe0000, v175
    v_add_u32 v177, 0x10000, v177
    v_and_b32 v177, 0xfffe0000, v177
    v_add_u32 v179, 0x10000, v179
    v_and_b32 v179, 0xfffe0000, v179
    v_add_u32 v181, 0x10000, v181
    v_and_b32 v181, 0xfffe0000, v181
    v_cvt_pk_bf16_f32 v52, v173, v172
    v_cvt_pk_bf16_f32 v53, v171, v170
    v_cvt_pk_bf16_f32 v54, v169, v168
    v_cvt_pk_bf16_f32 v55, v167, v166
    v_cvt_pk_bf16_f32 v56, v181, v180
    v_cvt_pk_bf16_f32 v57, v179, v178
    v_cvt_pk_bf16_f32 v58, v177, v176
    v_cvt_pk_bf16_f32 v59, v175, v174
    s_cmp_lg_u32 s52, 0
    s_cbranch_scc1 HB_q
    s_mov_b32 s53, 0
HB_p:
    buffer_load_dword v14, v10, s[84:87], 0 offen sc1
    s_waitcnt vmcnt(0)
    v_readfirstlane_b32 s52, v14
    s_nop 0
    s_cmp_lg_u32 s52, 0
    s_cbranch_scc1 HB_q
    s_add_u32 s53, s53, 1
    s_cmp_lt_u32 s53, s61
    s_cbranch_scc1 HB_p
    s_mov_b32 s52, 1
    s_mov_b32 s61, 0
HB_q:
    v_permlane32_swap_b32 v52, v56
    v_permlane32_swap_b32 v53, v57
    v_permlane32_swap_b32 v54, v58
    v_permlane32_swap_b32 v55, v59
    v_mov_b32 v14, s52
    buffer_store_dwordx4 v[52:55], v18, s[16:19], s43 offen offset:256 sc1
    buffer_store_dwordx4 v[56:59], v18, s[16:19], s43 offen offset:0 sc1
    s_lshl_b32 s37, s42, 7
    s_lshl_b32 s53, s35, 13
    s_add_u32 s37, s37, s53
    s_add_u32 s37, s37, 23592960
    s_cmp_ge_u32 s35, 16
    s_cbranch_scc1 KV_ni
    s_mov_b64 exec, 1
    buffer_store_dword v14, v10, s[56:59], s37 offen sc1
    s_mov_b64 exec, -1
KV_ni:
    s_waitcnt vmcnt(3)
    v_alignbit_b32 v128, v29, v28, 16
    v_mov_b32 v132, v29
    v_alignbit_b32 v136, v30, v29, 16
    v_alignbit_b32 v129, v30, v29, 16
    v_mov_b32 v133, v30
    v_alignbit_b32 v137, v31, v30, 16
    v_alignbit_b32 v130, v31, v30, 16
    v_mov_b32 v134, v31
    v_alignbit_b32 v138, v32, v31, 16
    v_alignbit_b32 v131, v32, v31, 16
    v_mov_b32 v135, v32
    v_alignbit_b32 v139, v33, v32, 16
    ds_write_b128 v20, v[128:131] offset:0
    ds_write_b128 v20, v[132:135] offset:4160
    ds_write_b128 v20, v[136:139] offset:8320
    ds_write_b128 v20, v[30:33] offset:12480
    s_waitcnt vmcnt(0)
    s_mov_b64 exec, 1
    buffer_store_dword v14, v10, s[56:59], s44 offen sc1
    s_mov_b64 exec, -1
    s_cmp_lg_u32 s30, 5
    s_cbranch_scc1 KV_n3
    s_lshl_b32 s36, s2, 14
    s_add_u32 s36, s36, 29360128
    v_lshrrev_b32 v15, 3, v1
    v_mul_u32_u24 v15, 8064, v15
    v_add_u32 v15, v15, v2
    s_mov_b64 exec, 0xffff
    buffer_store_dwordx4 v[60:63], v15, s[56:59], s36 offen sc1
    s_mov_b64 exec, -1
KV_n3:
    v_alignbit_b32 v140, v35, v34, 16
    v_mov_b32 v144, v35
    v_alignbit_b32 v148, v36, v35, 16
    v_alignbit_b32 v141, v36, v35, 16
    v_mov_b32 v145, v36
    v_alignbit_b32 v149, v37, v36, 16
    v_alignbit_b32 v142, v37, v36, 16
    v_mov_b32 v146, v37
    v_alignbit_b32 v150, v38, v37, 16
    v_alignbit_b32 v143, v38, v37, 16
    v_mov_b32 v147, v38
    v_alignbit_b32 v151, v39, v38, 16
    ds_write_b128 v20, v[140:143] offset:1024
    ds_write_b128 v20, v[144:147] offset:5184
    ds_write_b128 v20, v[148:151] offset:9344
    ds_write_b128 v20, v[36:39] offset:13504
    v_alignbit_b32 v152, v41, v40, 16
    v_mov_b32 v156, v41
    v_alignbit_b32 v160, v42, v41, 16
    v_alignbit_b32 v153, v42, v41, 16
    v_mov_b32 v157, v42
    v_alignbit_b32 v161, v43, v42, 16
    v_alignbit_b32 v154, v43, v42, 16
    v_mov_b32 v158, v43
    v_alignbit_b32 v162, v44, v43, 16
    v_alignbit_b32 v155, v44, v43, 16
    v_mov_b32 v159, v44
    v_alignbit_b32 v163, v45, v44, 16
    s_mov_b64 exec, 0xf
    ds_write_b128 v19, v[152:155] offset:4096
    ds_write_b128 v19, v[156:159] offset:8256
    ds_write_b128 v19, v[160:163] offset:12416
    ds_write_b128 v19, v[42:45] offset:16576
    s_mov_b64 exec, -1
    s_waitcnt lgkmcnt(0)
    s_barrier
    s_add_u32 s36, s67, 0
    s_and_b32 s36, s36, 7
    s_lshl_b32 s36, s36, 17
    s_add_u32 s36, s36, s48
    s_add_u32 m0, s49, 90112
    s_nop 0
    buffer_load_dwordx4 v118, s[88:91], s36 offen lds
    s_add_u32 s36, s67, 1
    s_and_b32 s36, s36, 7
    s_lshl_b32 s36, s36, 17
    s_add_u32 s36, s36, s48
    s_add_u32 m0, s49, 98304
    s_nop 0
    buffer_load_dwordx4 v118, s[88:91], s36 offen lds
    s_add_u32 s36, s67, 2
    s_and_b32 s36, s36, 7
    s_lshl_b32 s36, s36, 17
    s_add_u32 s36, s36, s48
    s_add_u32 m0, s49, 106496
    s_nop 0
    buffer_load_dwordx4 v118, s[88:91], s36 offen lds
    s_add_u32 s36, s67, 3
    s_and_b32 s36, s36, 7
    s_lshl_b32 s36, s36, 17
    s_add_u32 s36, s36, s48
    s_add_u32 m0, s49, 114688
    s_nop 0
    buffer_load_dwordx4 v118, s[88:91], s36 offen lds
    s_add_u32 s36, s67, 4
    s_and_b32 s36, s36, 7
    s_lshl_b32 s36, s36, 17
    s_add_u32 s36, s36, s48
    s_add_u32 m0, s49, 122880
    s_nop 0
    buffer_load_dwordx4 v118, s[88:91], s36 offen lds
    s_add_u32 s36, s67, 5
    s_and_b32 s36, s36, 7
    s_lshl_b32 s36, s36, 17
    s_add_u32 s36, s36, s48
    s_add_u32 m0, s49, 131072
    s_nop 0
    buffer_load_dwordx4 v118, s[88:91], s36 offen lds
    s_add_u32 s36, s67, 6
    s_and_b32 s36, s36, 7
    s_lshl_b32 s36, s36, 17
    s_add_u32 s36, s36, s48
    s_add_u32 m0, s49, 139264
    s_nop 0
    buffer_load_dwordx4 v118, s[88:91], s36 offen lds
    s_add_u32 s36, s67, 7
    s_and_b32 s36, s36, 7
    s_lshl_b32 s36, s36, 17
    s_add_u32 s36, s36, s48
    s_add_u32 m0, s49, 147456
    s_nop 0
    buffer_load_dwordx4 v118, s[88:91], s36 offen lds
    s_cmp_ge_u32 s30, 4
    s_cbranch_scc1 FR_b
    s_bitcmp1_b32 s39, 0
    s_cselect_b32 s36, 0, 16
    s_lshl_b32 s41, s41, s36
    s_and_b32 s41, s41, 0xffff0000
    s_lshr_b32 s42, s41, 16
    v_lshl_add_u32 v94, v101, 3, v100
    v_sub_u32 v94, 15, v94
    v_and_b32 v95, 1, v94
    v_cmp_eq_u32 vcc, 1, v95
    v_mov_b32 v95, s42
    v_mov_b32 v96, s41
    v_cndmask_b32 v95, v95, v96, vcc
    v_ashrrev_i32 v94, 1, v94
    v_cmp_eq_u32 vcc, 0, v94
    s_nop 1
    v_cndmask_b32 v104, 0, v95, vcc
    v_cmp_eq_u32 vcc, 1, v94
    s_nop 1
    v_cndmask_b32 v105, 0, v95, vcc
    v_cmp_eq_u32 vcc, 2, v94
    s_nop 1
    v_cndmask_b32 v106, 0, v95, vcc
    v_cmp_eq_u32 vcc, 3, v94
    s_nop 1
    v_cndmask_b32 v107, 0, v95, vcc
    v_mov_b32 v119, 0
    s_mul_i32 s36, s30, 21568
    v_lshrrev_b32 v6, 1, v100
    v_mul_u32_u24 v12, 72, v6
    v_and_b32 v6, 1, v100
    v_lshl_add_u32 v12, v6, 4, v12
    v_lshl_add_u32 v12, v101, 2, v12
    v_add_u32 v12, s36, v12
    v_add_u32 v13, 1152, v12
    v_add_u32 v14, 2304, v12
    v_add_u32 v15, 3456, v12
    v_bfe_u32 v6, v1, 2, 2
    v_mul_u32_u24 v16, 21568, v6
    v_mul_u32_u24 v6, 72, v101
    v_add_u32 v16, v16, v6
    v_and_b32 v6, 3, v1
    v_lshl_add_u32 v16, v6, 3, v16
    s_mul_i32 s36, s30, 1152
    v_add_u32 v16, s36, v16
    s_lshl_b32 s44, s30, 12
    s_mov_b32 s45, 0x07060302
    s_cmp_lg_u32 s30, 0
    s_cbranch_scc1 CV_w
    s_mov_b32 s53, 0
    s_add_u32 s54, s52, 0
    s_bfm_b64 exec, 32, 0
poll_1:
    buffer_load_dword v8, v102, s[56:59], 0 offen sc1
    s_waitcnt vmcnt(0)
    v_cmp_eq_u32 vcc, s54, v8
    s_nop 0
    s_cmp_eq_u64 vcc, exec
    s_cbranch_scc1 pok_2
    s_sleep 5
    s_add_u32 s53, s53, 1
    s_cmp_lt_u32 s53, s61
    s_cbranch_scc1 poll_1
    s_mov_b32 s61, 0
pok_2:
    s_mov_b64 exec, -1
CV_w:
    s_add_u32 m0, s40, 16640
    s_mov_b32 s36, 0
    s_waitcnt vmcnt(0)
    s_barrier
    buffer_load_dwordx4 v97, s[20:23], s36 offen offset:0 sc1 lds
    s_add_u32 s36, s36, 3072
    buffer_load_dwordx4 v97, s[20:23], s36 offen offset:1024 sc1 lds
    s_add_u32 s36, s36, 3072
    buffer_load_dwordx4 v97, s[20:23], s36 offen offset:2048 sc1 lds
    s_add_u32 s36, s36, 3072
    buffer_load_dwordx4 v97, s[20:23], s36 offen offset:3072 sc1 lds
    s_barrier
    buffer_load_dwordx2 v[86:87], v80, s[8:11], 0 offen offset:0 nt
    buffer_load_dwordx2 v[88:89], v80, s[8:11], 0 offen offset:32 nt
    buffer_load_dwordx2 v[90:91], v80, s[8:11], 0 offen offset:128 nt
    buffer_load_dwordx2 v[92:93], v80, s[8:11], 0 offen offset:160 nt
    ds_read_b64 v[120:121], v98 offset:32
    ds_read_b64 v[122:123], v98 offset:40
    ds_read_b64 v[124:125], v98 offset:544
    ds_read_b64 v[126:127], v98 offset:552
    ds_read_b64 v[128:129], v98 offset:1056
    ds_read_b64 v[130:131], v98 offset:1064
    ds_read_b64 v[132:133], v98 offset:1568
    ds_read_b64 v[134:135], v98 offset:1576
    ds_read_b64 v[136:137], v98 offset:2080
    ds_read_b64 v[138:139], v98 offset:2088
    ds_read_b64 v[140:141], v98 offset:2592
    ds_read_b64 v[142:143], v98 offset:2600
    ds_read_b64 v[144:145], v98 offset:3104
    ds_read_b64 v[146:147], v98 offset:3112
    ds_read_b64 v[148:149], v98 offset:3616
    ds_read_b64 v[150:151], v98 offset:3624
    s_waitcnt vmcnt(4)
    ds_read_b128 v[184:187], v99 offset:20224
    ds_read_b128 v[188:191], v99 offset:19712
    ds_read_b128 v[192:195], v99 offset:19200
    ds_read_b128 v[196:199], v99 offset:18688
    ds_read_b128 v[200:203], v99 offset:18176
    ds_read_b128 v[204:207], v99 offset:17664
    ds_read_b128 v[208:211], v99 offset:17152
    ds_read_b128 v[212:215], v99 offset:16640
    s_waitcnt lgkmcnt(0)
    v_mfma_f32_16x16x32_bf16 v[20:23], v[104:107], v[184:187], 0
    v_mfma_f32_16x16x32_bf16 v[24:27], v[104:107], v[188:191], 0
    v_mfma_f32_16x16x32_bf16 v[28:31], v[104:107], v[192:195], 0
    v_mfma_f32_16x16x32_bf16 v[32:35], v[104:107], v[196:199], 0
    v_mfma_f32_16x16x32_bf16 v[36:39], v[104:107], v[200:203], 0
    v_mfma_f32_16x16x32_bf16 v[40:43], v[104:107], v[204:207], 0
    v_mfma_f32_16x16x32_bf16 v[44:47], v[104:107], v[208:211], 0
    v_mfma_f32_16x16x32_bf16 v[48:51], v[104:107], v[212:215], 0
    s_mov_b32 s43, 0
CV_r:
    s_waitcnt lgkmcnt(0)
    v_mfma_f32_16x16x32_bf16 v[20:23], v[120:123], v[184:187], v[20:23]
    v_mfma_f32_16x16x32_bf16 v[24:27], v[120:123], v[188:191], v[24:27]
    v_mfma_f32_16x16x32_bf16 v[28:31], v[120:123], v[192:195], v[28:31]
    v_mfma_f32_16x16x32_bf16 v[32:35], v[120:123], v[196:199], v[32:35]
    v_mfma_f32_16x16x32_bf16 v[36:39], v[120:123], v[200:203], v[36:39]
    v_mfma_f32_16x16x32_bf16 v[40:43], v[120:123], v[204:207], v[40:43]
    v_mfma_f32_16x16x32_bf16 v[44:47], v[120:123], v[208:211], v[44:47]
    v_mfma_f32_16x16x32_bf16 v[48:51], v[120:123], v[212:215], v[48:51]
    v_mfma_f32_16x16x32_bf16 v[24:27], v[124:127], v[184:187], v[24:27]
    v_mfma_f32_16x16x32_bf16 v[28:31], v[124:127], v[188:191], v[28:31]
    v_mfma_f32_16x16x32_bf16 v[32:35], v[124:127], v[192:195], v[32:35]
    v_mfma_f32_16x16x32_bf16 v[36:39], v[124:127], v[196:199], v[36:39]
    v_mfma_f32_16x16x32_bf16 v[40:43], v[124:127], v[200:203], v[40:43]
    v_mfma_f32_16x16x32_bf16 v[44:47], v[124:127], v[204:207], v[44:47]
    v_mfma_f32_16x16x32_bf16 v[48:51], v[124:127], v[208:211], v[48:51]
    v_mfma_f32_16x16x32_bf16 v[28:31], v[128:131], v[184:187], v[28:31]
    v_mfma_f32_16x16x32_bf16 v[32:35], v[128:131], v[188:191], v[32:35]
    v_mfma_f32_16x16x32_bf16 v[36:39], v[128:131], v[192:195], v[36:39]
    v_mfma_f32_16x16x32_bf16 v[40:43], v[128:131], v[196:199], v[40:43]
    v_mfma_f32_16x16x32_bf16 v[44:47], v[128:131], v[200:203], v[44:47]
    v_mfma_f32_16x16x32_bf16 v[48:51], v[128:131], v[204:207], v[48:51]
    v_mfma_f32_16x16x32_bf16 v[32:35], v[132:135], v[184:187], v[32:35]
    v_mfma_f32_16x16x32_bf16 v[36:39], v[132:135], v[188:191], v[36:39]
    v_mfma_f32_16x16x32_bf16 v[40:43], v[132:135], v[192:195], v[40:43]
    v_mfma_f32_16x16x32_bf16 v[44:47], v[132:135], v[196:199], v[44:47]
    v_mfma_f32_16x16x32_bf16 v[48:51], v[132:135], v[200:203], v[48:51]
    v_mfma_f32_16x16x32_bf16 v[36:39], v[136:139], v[184:187], v[36:39]
    v_mfma_f32_16x16x32_bf16 v[40:43], v[136:139], v[188:191], v[40:43]
    v_mfma_f32_16x16x32_bf16 v[44:47], v[136:139], v[192:195], v[44:47]
    v_mfma_f32_16x16x32_bf16 v[48:51], v[136:139], v[196:199], v[48:51]
    v_mfma_f32_16x16x32_bf16 v[40:43], v[140:143], v[184:187], v[40:43]
    v_mfma_f32_16x16x32_bf16 v[44:47], v[140:143], v[188:191], v[44:47]
    v_mfma_f32_16x16x32_bf16 v[48:51], v[140:143], v[192:195], v[48:51]
    v_mfma_f32_16x16x32_bf16 v[44:47], v[144:147], v[184:187], v[44:47]
    v_mfma_f32_16x16x32_bf16 v[48:51], v[144:147], v[188:191], v[48:51]
    v_mfma_f32_16x16x32_bf16 v[48:51], v[148:151], v[184:187], v[48:51]
    ds_read_b128 v[216:219], v99 offset:20288
    ds_read_b128 v[220:223], v99 offset:19776
    ds_read_b128 v[224:227], v99 offset:19264
    ds_read_b128 v[228:231], v99 offset:18752
    ds_read_b128 v[232:235], v99 offset:18240
    ds_read_b128 v[236:239], v99 offset:17728
    ds_read_b128 v[240:243], v99 offset:17216
    ds_read_b128 v[244:247], v99 offset:16704
    ds_read_b64 v[152:153], v98 offset:96
    ds_read_b64 v[154:155], v98 offset:104
    ds_read_b64 v[156:157], v98 offset:608
    ds_read_b64 v[158:159], v98 offset:616
    ds_read_b64 v[160:161], v98 offset:1120
    ds_read_b64 v[162:163], v98 offset:1128
    ds_read_b64 v[164:165], v98 offset:1632
    ds_read_b64 v[166:167], v98 offset:1640
    ds_read_b64 v[168:169], v98 offset:2144
    ds_read_b64 v[170:171], v98 offset:2152
    ds_read_b64 v[172:173], v98 offset:2656
    ds_read_b64 v[174:175], v98 offset:2664
    ds_read_b64 v[176:177], v98 offset:3168
    ds_read_b64 v[178:179], v98 offset:3176
    ds_read_b64 v[180:181], v98 offset:3680
    ds_read_b64 v[182:183], v98 offset:3688
    s_waitcnt lgkmcnt(0)
    v_mfma_f32_16x16x32_bf16 v[20:23], v[152:155], v[216:219], v[20:23]
    v_mfma_f32_16x16x32_bf16 v[24:27], v[152:155], v[220:223], v[24:27]
    v_mfma_f32_16x16x32_bf16 v[28:31], v[152:155], v[224:227], v[28:31]
    v_mfma_f32_16x16x32_bf16 v[32:35], v[152:155], v[228:231], v[32:35]
    v_mfma_f32_16x16x32_bf16 v[36:39], v[152:155], v[232:235], v[36:39]
    v_mfma_f32_16x16x32_bf16 v[40:43], v[152:155], v[236:239], v[40:43]
    v_mfma_f32_16x16x32_bf16 v[44:47], v[152:155], v[240:243], v[44:47]
    v_mfma_f32_16x16x32_bf16 v[48:51], v[152:155], v[244:247], v[48:51]
    v_mfma_f32_16x16x32_bf16 v[24:27], v[156:159], v[216:219], v[24:27]
    v_mfma_f32_16x16x32_bf16 v[28:31], v[156:159], v[220:223], v[28:31]
    v_mfma_f32_16x16x32_bf16 v[32:35], v[156:159], v[224:227], v[32:35]
    v_mfma_f32_16x16x32_bf16 v[36:39], v[156:159], v[228:231], v[36:39]
    v_mfma_f32_16x16x32_bf16 v[40:43], v[156:159], v[232:235], v[40:43]
    v_mfma_f32_16x16x32_bf16 v[44:47], v[156:159], v[236:239], v[44:47]
    v_mfma_f32_16x16x32_bf16 v[48:51], v[156:159], v[240:243], v[48:51]
    v_mfma_f32_16x16x32_bf16 v[28:31], v[160:163], v[216:219], v[28:31]
    v_mfma_f32_16x16x32_bf16 v[32:35], v[160:163], v[220:223], v[32:35]
    v_mfma_f32_16x16x32_bf16 v[36:39], v[160:163], v[224:227], v[36:39]
    v_mfma_f32_16x16x32_bf16 v[40:43], v[160:163], v[228:231], v[40:43]
    v_mfma_f32_16x16x32_bf16 v[44:47], v[160:163], v[232:235], v[44:47]
    v_mfma_f32_16x16x32_bf16 v[48:51], v[160:163], v[236:239], v[48:51]
    v_mfma_f32_16x16x32_bf16 v[32:35], v[164:167], v[216:219], v[32:35]
    v_mfma_f32_16x16x32_bf16 v[36:39], v[164:167], v[220:223], v[36:39]
    v_mfma_f32_16x16x32_bf16 v[40:43], v[164:167], v[224:227], v[40:43]
    v_mfma_f32_16x16x32_bf16 v[44:47], v[164:167], v[228:231], v[44:47]
    v_mfma_f32_16x16x32_bf16 v[48:51], v[164:167], v[232:235], v[48:51]
    v_mfma_f32_16x16x32_bf16 v[36:39], v[168:171], v[216:219], v[36:39]
    v_mfma_f32_16x16x32_bf16 v[40:43], v[168:171], v[220:223], v[40:43]
    v_mfma_f32_16x16x32_bf16 v[44:47], v[168:171], v[224:227], v[44:47]
    v_mfma_f32_16x16x32_bf16 v[48:51], v[168:171], v[228:231], v[48:51]
    v_mfma_f32_16x16x32_bf16 v[40:43], v[172:175], v[216:219], v[40:43]
    v_mfma_f32_16x16x32_bf16 v[44:47], v[172:175], v[220:223], v[44:47]
    v_mfma_f32_16x16x32_bf16 v[48:51], v[172:175], v[224:227], v[48:51]
    v_mfma_f32_16x16x32_bf16 v[44:47], v[176:179], v[216:219], v[44:47]
    v_mfma_f32_16x16x32_bf16 v[48:51], v[176:179], v[220:223], v[48:51]
    v_mfma_f32_16x16x32_bf16 v[48:51], v[180:183], v[216:219], v[48:51]
    ds_read_b128 v[184:187], v99 offset:20352
    ds_read_b128 v[188:191], v99 offset:19840
    ds_read_b128 v[192:195], v99 offset:19328
    ds_read_b128 v[196:199], v99 offset:18816
    ds_read_b128 v[200:203], v99 offset:18304
    ds_read_b128 v[204:207], v99 offset:17792
    ds_read_b128 v[208:211], v99 offset:17280
    ds_read_b128 v[212:215], v99 offset:16768
    ds_read_b64 v[120:121], v98 offset:160
    ds_read_b64 v[122:123], v98 offset:168
    ds_read_b64 v[124:125], v98 offset:672
    ds_read_b64 v[126:127], v98 offset:680
    ds_read_b64 v[128:129], v98 offset:1184
    ds_read_b64 v[130:131], v98 offset:1192
    ds_read_b64 v[132:133], v98 offset:1696
    ds_read_b64 v[134:135], v98 offset:1704
    ds_read_b64 v[136:137], v98 offset:2208
    ds_read_b64 v[138:139], v98 offset:2216
    ds_read_b64 v[140:141], v98 offset:2720
    ds_read_b64 v[142:143], v98 offset:2728
    ds_read_b64 v[144:145], v98 offset:3232
    ds_read_b64 v[146:147], v98 offset:3240
    ds_read_b64 v[148:149], v98 offset:3744
    ds_read_b64 v[150:151], v98 offset:3752
    v_add_u32 v98, 128, v98
    v_add_u32 v99, 128, v99
    s_add_u32 s43, s43, 1
    s_cmp_lt_u32 s43, 2
    s_cbranch_scc1 CV_r
CV_l:
    s_waitcnt lgkmcnt(0)
    v_mfma_f32_16x16x32_bf16 v[20:23], v[120:123], v[184:187], v[20:23]
    ds_read_b128 v[216:219], v99 offset:20288
    v_mfma_f32_16x16x32_bf16 v[24:27], v[120:123], v[188:191], v[24:27]
    ds_read_b128 v[220:223], v99 offset:19776
    v_mfma_f32_16x16x32_bf16 v[28:31], v[120:123], v[192:195], v[28:31]
    ds_read_b128 v[224:227], v99 offset:19264
    v_mfma_f32_16x16x32_bf16 v[32:35], v[120:123], v[196:199], v[32:35]
    ds_read_b128 v[228:231], v99 offset:18752
    v_mfma_f32_16x16x32_bf16 v[36:39], v[120:123], v[200:203], v[36:39]
    ds_read_b128 v[232:235], v99 offset:18240
    v_mfma_f32_16x16x32_bf16 v[40:43], v[120:123], v[204:207], v[40:43]
    ds_read_b128 v[236:239], v99 offset:17728
    v_mfma_f32_16x16x32_bf16 v[44:47], v[120:123], v[208:211], v[44:47]
    ds_read_b128 v[240:243], v99 offset:17216
    v_mfma_f32_16x16x32_bf16 v[48:51], v[120:123], v[212:215], v[48:51]
    ds_read_b128 v[244:247], v99 offset:16704
    v_mfma_f32_16x16x32_bf16 v[24:27], v[124:127], v[184:187], v[24:27]
    ds_read_b64 v[152:153], v98 offset:96
    v_mfma_f32_16x16x32_bf16 v[28:31], v[124:127], v[188:191], v[28:31]
    ds_read_b64 v[154:155], v98 offset:104
    v_mfma_f32_16x16x32_bf16 v[32:35], v[124:127], v[192:195], v[32:35]
    ds_read_b64 v[156:157], v98 offset:608
    v_mfma_f32_16x16x32_bf16 v[36:39], v[124:127], v[196:199], v[36:39]
    ds_read_b64 v[158:159], v98 offset:616
    v_mfma_f32_16x16x32_bf16 v[40:43], v[124:127], v[200:203], v[40:43]
    ds_read_b64 v[160:161], v98 offset:1120
    v_mfma_f32_16x16x32_bf16 v[44:47], v[124:127], v[204:207], v[44:47]
    ds_read_b64 v[162:163], v98 offset:1128
    v_mfma_f32_16x16x32_bf16 v[48:51], v[124:127], v[208:211], v[48:51]
    ds_read_b64 v[164:165], v98 offset:1632
    v_mfma_f32_16x16x32_bf16 v[28:31], v[128:131], v[184:187], v[28:31]
    ds_read_b64 v[166:167], v98 offset:1640
    v_mfma_f32_16x16x32_bf16 v[32:35], v[128:131], v[188:191], v[32:35]
    ds_read_b64 v[168:169], v98 offset:2144
    v_mfma_f32_16x16x32_bf16 v[36:39], v[128:131], v[192:195], v[36:39]
    ds_read_b64 v[170:171], v98 offset:2152
    v_mfma_f32_16x16x32_bf16 v[40:43], v[128:131], v[196:199], v[40:43]
    ds_read_b64 v[172:173], v98 offset:2656
    v_mfma_f32_16x16x32_bf16 v[44:47], v[128:131], v[200:203], v[44:47]
    ds_read_b64 v[174:175], v98 offset:2664
    v_mfma_f32_16x16x32_bf16 v[48:51], v[128:131], v[204:207], v[48:51]
    ds_read_b64 v[176:177], v98 offset:3168
    v_mfma_f32_16x16x32_bf16 v[32:35], v[132:135], v[184:187], v[32:35]
    ds_read_b64 v[178:179], v98 offset:3176
    v_mfma_f32_16x16x32_bf16 v[36:39], v[132:135], v[188:191], v[36:39]
    ds_read_b64 v[180:181], v98 offset:3680
    v_mfma_f32_16x16x32_bf16 v[40:43], v[132:135], v[192:195], v[40:43]
    ds_read_b64 v[182:183], v98 offset:3688
    v_mfma_f32_16x16x32_bf16 v[44:47], v[132:135], v[196:199], v[44:47]
    v_mfma_f32_16x16x32_bf16 v[48:51], v[132:135], v[200:203], v[48:51]
    v_mfma_f32_16x16x32_bf16 v[36:39], v[136:139], v[184:187], v[36:39]
    v_mfma_f32_16x16x32_bf16 v[40:43], v[136:139], v[188:191], v[40:43]
    v_mfma_f32_16x16x32_bf16 v[44:47], v[136:139], v[192:195], v[44:47]
    v_mfma_f32_16x16x32_bf16 v[48:51], v[136:139], v[196:199], v[48:51]
    v_mfma_f32_16x16x32_bf16 v[40:43], v[140:143], v[184:187], v[40:43]
    v_mfma_f32_16x16x32_bf16 v[44:47], v[140:143], v[188:191], v[44:47]
    v_mfma_f32_16x16x32_bf16 v[48:51], v[140:143], v[192:195], v[48:51]
    v_mfma_f32_16x16x32_bf16 v[44:47], v[144:147], v[184:187], v[44:47]
    v_mfma_f32_16x16x32_bf16 v[48:51], v[144:147], v[188:191], v[48:51]
    v_mfma_f32_16x16x32_bf16 v[48:51], v[148:151], v[184:187], v[48:51]
    s_waitcnt lgkmcnt(0)
    v_mfma_f32_16x16x32_bf16 v[20:23], v[152:155], v[216:219], v[20:23]
    ds_read_b128 v[184:187], v99 offset:20352
    v_mfma_f32_16x16x32_bf16 v[24:27], v[152:155], v[220:223], v[24:27]
    ds_read_b128 v[188:191], v99 offset:19840
    v_mfma_f32_16x16x32_bf16 v[28:31], v[152:155], v[224:227], v[28:31]
    ds_read_b128 v[192:195], v99 offset:19328
    v_mfma_f32_16x16x32_bf16 v[32:35], v[152:155], v[228:231], v[32:35]
    ds_read_b128 v[196:199], v99 offset:18816
    v_mfma_f32_16x16x32_bf16 v[36:39], v[152:155], v[232:235], v[36:39]
    ds_read_b128 v[200:203], v99 offset:18304
    v_mfma_f32_16x16x32_bf16 v[40:43], v[152:155], v[236:239], v[40:43]
    ds_read_b128 v[204:207], v99 offset:17792
    v_mfma_f32_16x16x32_bf16 v[44:47], v[152:155], v[240:243], v[44:47]
    ds_read_b128 v[208:211], v99 offset:17280
    v_mfma_f32_16x16x32_bf16 v[48:51], v[152:155], v[244:247], v[48:51]
    ds_read_b128 v[212:215], v99 offset:16768
    v_mfma_f32_16x16x32_bf16 v[24:27], v[156:159], v[216:219], v[24:27]
    ds_read_b64 v[120:121], v98 offset:160
    v_mfma_f32_16x16x32_bf16 v[28:31], v[156:159], v[220:223], v[28:31]
    ds_read_b64 v[122:123], v98 offset:168
    v_mfma_f32_16x16x32_bf16 v[32:35], v[156:159], v[224:227], v[32:35]
    ds_read_b64 v[124:125], v98 offset:672
    v_mfma_f32_16x16x32_bf16 v[36:39], v[156:159], v[228:231], v[36:39]
    ds_read_b64 v[126:127], v98 offset:680
    v_mfma_f32_16x16x32_bf16 v[40:43], v[156:159], v[232:235], v[40:43]
    ds_read_b64 v[128:129], v98 offset:1184
    v_mfma_f32_16x16x32_bf16 v[44:47], v[156:159], v[236:239], v[44:47]
    ds_read_b64 v[130:131], v98 offset:1192
    v_mfma_f32_16x16x32_bf16 v[48:51], v[156:159], v[240:243], v[48:51]
    ds_read_b64 v[132:133], v98 offset:1696
    v_mfma_f32_16x16x32_bf16 v[28:31], v[160:163], v[216:219], v[28:31]
    ds_read_b64 v[134:135], v98 offset:1704
    v_mfma_f32_16x16x32_bf16 v[32:35], v[160:163], v[220:223], v[32:35]
    ds_read_b64 v[136:137], v98 offset:2208
    v_mfma_f32_16x16x32_bf16 v[36:39], v[160:163], v[224:227], v[36:39]
    ds_read_b64 v[138:139], v98 offset:2216
    v_mfma_f32_16x16x32_bf16 v[40:43], v[160:163], v[228:231], v[40:43]
    ds_read_b64 v[140:141], v98 offset:2720
    v_mfma_f32_16x16x32_bf16 v[44:47], v[160:163], v[232:235], v[44:47]
    ds_read_b64 v[142:143], v98 offset:2728
    v_mfma_f32_16x16x32_bf16 v[48:51], v[160:163], v[236:239], v[48:51]
    ds_read_b64 v[144:145], v98 offset:3232
    v_mfma_f32_16x16x32_bf16 v[32:35], v[164:167], v[216:219], v[32:35]
    ds_read_b64 v[146:147], v98 offset:3240
    v_mfma_f32_16x16x32_bf16 v[36:39], v[164:167], v[220:223], v[36:39]
    ds_read_b64 v[148:149], v98 offset:3744
    v_mfma_f32_16x16x32_bf16 v[40:43], v[164:167], v[224:227], v[40:43]
    ds_read_b64 v[150:151], v98 offset:3752
    v_mfma_f32_16x16x32_bf16 v[44:47], v[164:167], v[228:231], v[44:47]
    v_add_u32 v98, 128, v98
    v_mfma_f32_16x16x32_bf16 v[48:51], v[164:167], v[232:235], v[48:51]
    v_add_u32 v99, 128, v99
    v_mfma_f32_16x16x32_bf16 v[36:39], v[168:171], v[216:219], v[36:39]
    s_add_u32 s43, s43, 1
    v_mfma_f32_16x16x32_bf16 v[40:43], v[168:171], v[220:223], v[40:43]
    s_cmp_lt_u32 s43, 4
    v_mfma_f32_16x16x32_bf16 v[44:47], v[168:171], v[224:227], v[44:47]
    v_mfma_f32_16x16x32_bf16 v[48:51], v[168:171], v[228:231], v[48:51]
    v_mfma_f32_16x16x32_bf16 v[40:43], v[172:175], v[216:219], v[40:43]
    v_mfma_f32_16x16x32_bf16 v[44:47], v[172:175], v[220:223], v[44:47]
    v_mfma_f32_16x16x32_bf16 v[48:51], v[172:175], v[224:227], v[48:51]
    v_mfma_f32_16x16x32_bf16 v[44:47], v[176:179], v[216:219], v[44:47]
    v_mfma_f32_16x16x32_bf16 v[48:51], v[176:179], v[220:223], v[48:51]
    v_mfma_f32_16x16x32_bf16 v[48:51], v[180:183], v[216:219], v[48:51]
    s_cbranch_scc1 CV_l
    s_bitcmp1_b32 s30, 0
    s_waitcnt lgkmcnt(0)
    s_cbranch_scc1 CV_o
    v_perm_b32 v20, v22, v20, s45
    v_perm_b32 v21, v23, v21, s45
    v_or_b32 v20, 0x10001, v20
    v_or_b32 v21, 0x10001, v21
    ds_write2_b32 v12, v20, v21 offset0:0 offset1:8
    v_perm_b32 v24, v26, v24, s45
    v_perm_b32 v25, v27, v25, s45
    v_or_b32 v24, 0x10001, v24
    v_or_b32 v25, 0x10001, v25
    ds_write2_b32 v12, v24, v25 offset0:144 offset1:152
    v_perm_b32 v28, v30, v28, s45
    v_perm_b32 v29, v31, v29, s45
    v_or_b32 v28, 0x10001, v28
    v_or_b32 v29, 0x10001, v29
    ds_write2_b32 v13, v28, v29 offset0:0 offset1:8
    v_perm_b32 v32, v34, v32, s45
    v_perm_b32 v33, v35, v33, s45
    v_or_b32 v32, 0x10001, v32
    v_or_b32 v33, 0x10001, v33
    ds_write2_b32 v13, v32, v33 offset0:144 offset1:152
    v_perm_b32 v36, v38, v36, s45
    v_perm_b32 v37, v39, v37, s45
    v_or_b32 v36, 0x10001, v36
    v_or_b32 v37, 0x10001, v37
    ds_write2_b32 v14, v36, v37 offset0:0 offset1:8
    v_perm_b32 v40, v42, v40, s45
    v_perm_b32 v41, v43, v41, s45
    v_or_b32 v40, 0x10001, v40
    v_or_b32 v41, 0x10001, v41
    ds_write2_b32 v14, v40, v41 offset0:144 offset1:152
    v_perm_b32 v44, v46, v44, s45
    v_perm_b32 v45, v47, v45, s45
    v_or_b32 v44, 0x10001, v44
    v_or_b32 v45, 0x10001, v45
    ds_write2_b32 v15, v44, v45 offset0:0 offset1:8
    v_perm_b32 v48, v50, v48, s45
    v_perm_b32 v49, v51, v49, s45
    v_or_b32 v48, 0x10001, v48
    v_or_b32 v49, 0x10001, v49
    ds_write2_b32 v15, v48, v49 offset0:144 offset1:152
    s_branch CV_e
CV_o:
    v_cvt_pk_bf16_f32 v20, v20, v22
    v_cvt_pk_bf16_f32 v21, v21, v23
    ds_write2_b32 v12, v20, v21 offset0:0 offset1:8
    v_cvt_pk_bf16_f32 v24, v24, v26
    v_cvt_pk_bf16_f32 v25, v25, v27
    ds_write2_b32 v12, v24, v25 offset0:144 offset1:152
    v_cvt_pk_bf16_f32 v28, v28, v30
    v_cvt_pk_bf16_f32 v29, v29, v31
    ds_write2_b32 v13, v28, v29 offset0:0 offset1:8
    v_cvt_pk_bf16_f32 v32, v32, v34
    v_cvt_pk_bf16_f32 v33, v33, v35
    ds_write2_b32 v13, v32, v33 offset0:144 offset1:152
    v_cvt_pk_bf16_f32 v36, v36, v38
    v_cvt_pk_bf16_f32 v37, v37, v39
    ds_write2_b32 v14, v36, v37 offset0:0 offset1:8
    v_cvt_pk_bf16_f32 v40, v40, v42
    v_cvt_pk_bf16_f32 v41, v41, v43
    ds_write2_b32 v14, v40, v41 offset0:144 offset1:152
    v_cvt_pk_bf16_f32 v44, v44, v46
    v_cvt_pk_bf16_f32 v45, v45, v47
    ds_write2_b32 v15, v44, v45 offset0:0 offset1:8
    v_cvt_pk_bf16_f32 v48, v48, v50
    v_cvt_pk_bf16_f32 v49, v49, v51
    ds_write2_b32 v15, v48, v49 offset0:144 offset1:152
CV_e:
    v_mov_b32 v8, 162824
    v_mov_b32 v9, 1
    s_waitcnt lgkmcnt(0)
    s_mov_b64 exec, 1
    ds_add_u32 v8, v9
    s_mov_b64 exec, -1
    v_mov_b32 v8, 162824
spin_3:
    ds_read_b32 v9, v8
    s_waitcnt lgkmcnt(0)
    v_readfirstlane_b32 s53, v9
    s_nop 0
    s_cmp_ge_u32 s53, 8
    s_cbranch_scc0 spin_3
    ds_read_b64_tr_b16 v[120:121], v16 offset:0
    ds_read_b64_tr_b16 v[122:123], v16 offset:32
    ds_read_b64_tr_b16 v[124:125], v16 offset:288
    ds_read_b64_tr_b16 v[126:127], v16 offset:320
    ds_read_b64_tr_b16 v[128:129], v16 offset:576
    ds_read_b64_tr_b16 v[130:131], v16 offset:608
    ds_read_b64_tr_b16 v[132:133], v16 offset:864
    ds_read_b64_tr_b16 v[134:135], v16 offset:896
    s_waitcnt lgkmcnt(6)
    buffer_store_dwordx4 v[120:123], v2, s[20:23], s44 offen offset:0 sc1
    s_waitcnt lgkmcnt(4)
    buffer_store_dwordx4 v[124:127], v2, s[20:23], s44 offen offset:1024 sc1
    s_waitcnt lgkmcnt(2)
    buffer_store_dwordx4 v[128:131], v2, s[20:23], s44 offen offset:2048 sc1
    s_waitcnt lgkmcnt(0)
    buffer_store_dwordx4 v[132:135], v2, s[20:23], s44 offen offset:3072 sc1
    s_waitcnt vmcnt(4)
    s_branch FR_end
FR_b:
    v_lshrrev_b32 v10, 2, v1
    v_lshlrev_b32 v74, 7, v10
    v_bfe_u32 v10, v10, 1, 2
    s_and_b32 s35, s30, 2
    v_and_b32 v11, 1, v1
    v_or_b32 v11, s35, v11
    v_xor_b32 v10, v10, v11
    v_lshl_add_u32 v74, v10, 5, v74
    v_and_b32 v10, 2, v1
    v_lshl_add_u32 v74, v10, 2, v74
    s_and_b32 s35, s30, 1
    s_lshl_b32 s35, s35, 4
    v_add_u32 v74, s35, v74
    v_add_u32 v75, 65536, v74
    v_add_u32 v76, 131072, v74
    s_and_b32 s36, s30, 3
    s_lshl_b32 s36, s36, 14
    s_lshl_b32 s48, s29, 7
    s_add_u32 s48, s48, s36
    v_mov_b32 v110, 0
    v_mov_b32 v111, 0
    v_mov_b32 v112, 0
    v_mov_b32 v113, 0
    s_and_b32 s44, s30, 3
    s_lshl2_add_u32 s44, s2, s44
    s_lshl_b32 s44, s44, 12
    s_add_u32 s44, s44, 29360128
    s_cmp_lg_u32 s30, 5
    s_cbranch_scc1 FB_np
    s_lshl_b32 s42, s2, 14
    s_add_u32 s42, s42, 29360128
    s_waitcnt vmcnt(8)
    s_memtime s[34:35]
    s_waitcnt lgkmcnt(0)
    s_load_dword s32, s[4:5], s42 offset:0 glc
    s_waitcnt lgkmcnt(0)
    s_memtime s[36:37]
    s_waitcnt lgkmcnt(0)
    s_sub_u32 s46, s36, s34
    s_memtime s[34:35]
    s_waitcnt lgkmcnt(0)
    s_load_dword s32, s[4:5], s42 offset:8192 glc
    s_waitcnt lgkmcnt(0)
    s_memtime s[36:37]
    s_waitcnt lgkmcnt(0)
    s_sub_u32 s47, s36, s34
    s_cmp_lt_u32 s47, s46
    s_cselect_b32 s45, 1, 0
    s_lshr_b32 s46, s28, 2
    s_xor_b32 s45, s45, s46
    s_lshr_b32 s46, s2, 7
    s_xor_b32 s45, s45, s46
    s_and_b32 s45, s45, 1
    s_lshl_b32 s45, s45, 8
FB_np:
    s_lshr_b32 s53, s28, 3
    s_lshl_b32 s53, s53, 2
    s_and_b32 s54, s28, 3
    s_add_u32 s53, s53, s54
    s_lshl_b32 s53, s53, 23
    s_lshr_b32 s54, s28, 2
    s_xor_b32 s54, s54, s94
    s_and_b32 s54, s54, 1
    s_lshl_b32 s54, s54, 13
    s_add_u32 s37, s53, s54
    s_add_u32 s37, s37, 33554432
    s_andn2_b32 s37, s37, 0x2000
    s_lshl_b32 s43, s29, 7
    s_add_u32 s37, s37, s43
    s_add_u32 s37, s37, 1835008
    s_add_u32 s43, s43, 23068672
    v_mov_b32 v102, s52
    v_and_b32 v103, 1, v1
    v_lshlrev_b32 v103, 13, v103
    v_bfe_u32 v104, v1, 1, 1
    v_lshl_add_u32 v103, v104, 26, v103
    v_lshrrev_b32 v104, 2, v1
    v_lshl_add_u32 v103, v104, 11, v103
    s_waitcnt vmcnt(0) lgkmcnt(0)
    s_barrier
    ds_read_b64_tr_b16 v[132:133], v75 offset:24576
    ds_read_b64_tr_b16 v[134:135], v75 offset:26624
    ds_read_b64_tr_b16 v[140:141], v75 offset:28672
    ds_read_b64_tr_b16 v[142:143], v75 offset:30720
    ds_read_b64_tr_b16 v[148:149], v75 offset:32768
    ds_read_b64_tr_b16 v[150:151], v75 offset:34816
    ds_read_b64_tr_b16 v[156:157], v75 offset:36864
    ds_read_b64_tr_b16 v[158:159], v75 offset:38912
    ds_read_b64_tr_b16 v[164:165], v75 offset:40960
    ds_read_b64_tr_b16 v[166:167], v75 offset:43008
    ds_read_b64_tr_b16 v[172:173], v75 offset:45056
    ds_read_b64_tr_b16 v[174:175], v75 offset:47104
    ds_read_b64_tr_b16 v[180:181], v75 offset:49152
    ds_read_b64_tr_b16 v[182:183], v75 offset:51200
    ds_read_b64_tr_b16 v[188:189], v75 offset:53248
    ds_read_b64_tr_b16 v[190:191], v75 offset:55296
    ds_read_b64_tr_b16 v[196:197], v75 offset:57344
    ds_read_b64_tr_b16 v[198:199], v75 offset:59392
    ds_read_b64_tr_b16 v[204:205], v75 offset:61440
    ds_read_b64_tr_b16 v[206:207], v75 offset:63488
    ds_read_b64_tr_b16 v[212:213], v76 offset:0
    ds_read_b64_tr_b16 v[214:215], v76 offset:2048
    ds_read_b64_tr_b16 v[220:221], v76 offset:4096
    ds_read_b64_tr_b16 v[222:223], v76 offset:6144
    ds_read_b64_tr_b16 v[228:229], v76 offset:8192
    ds_read_b64_tr_b16 v[230:231], v76 offset:10240
    ds_read_b64_tr_b16 v[236:237], v76 offset:12288
    ds_read_b64_tr_b16 v[238:239], v76 offset:14336
    ds_read_b64_tr_b16 v[244:245], v76 offset:16384
    ds_read_b64_tr_b16 v[246:247], v76 offset:18432
    ds_read_b64_tr_b16 v[252:253], v76 offset:20480
    ds_read_b64_tr_b16 v[254:255], v76 offset:22528
    s_waitcnt lgkmcnt(0)
    s_barrier
    s_cmp_lg_u32 s30, 5
    s_cbranch_scc1 FB_na
    s_and_b32 s36, s2, 7
    s_lshr_b32 s53, s2, 5
    s_lshl3_add_u32 s36, s36, s53
    s_lshl_b32 s36, s36, 7
    s_add_u32 s36, s36, 23592960
    s_or_b32 s45, s45, 1
    v_mov_b32 v8, s45
    v_lshlrev_b32 v9, 13, v1
    s_mov_b64 exec, 0xffff
    buffer_atomic_add v8, v9, s[56:59], s36 offen sc1
    s_mov_b64 exec, -1
FB_na:
    buffer_load_dwordx4 v[12:15], v2, s[80:83], s50 offen
    s_sub_u32 s50, s50, 4096
    buffer_load_dwordx4 v[12:15], v2, s[80:83], s50 offen
    s_sub_u32 s50, s50, 4096
    buffer_load_dwordx2 v[86:87], v80, s[8:11], 0 offen offset:0 nt
    buffer_load_dwordx2 v[88:89], v80, s[8:11], 0 offen offset:32 nt
    buffer_load_dwordx2 v[90:91], v80, s[8:11], 0 offen offset:128 nt
    buffer_load_dwordx2 v[92:93], v80, s[8:11], 0 offen offset:160 nt
    s_cmp_lg_u32 s30, 4
    s_cbranch_scc1 FB_ni
    s_mov_b64 exec, 0xfff
    buffer_store_dword v102, v103, s[56:59], s37 offen sc1
    s_cmp_lg_u32 s28, 0
    s_cbranch_scc1 FB_n2
    s_mov_b64 exec, 3
    buffer_store_dword v102, v103, s[56:59], s43 offen sc1
FB_n2:
    s_mov_b64 exec, -1
FB_ni:
    buffer_store_dwordx4 v[110:113], v2, s[56:59], s44 offen offset:0 sc1
    buffer_store_dwordx4 v[110:113], v2, s[56:59], s44 offen offset:1024 sc1
    buffer_store_dwordx4 v[110:113], v2, s[56:59], s44 offen offset:2048 sc1
    buffer_store_dwordx4 v[110:113], v2, s[56:59], s44 offen offset:3072 sc1
    s_add_u32 s36, s67, 0
    s_and_b32 s36, s36, 7
    s_lshl_b32 s36, s36, 17
    s_add_u32 s36, s36, s48
    buffer_load_dwordx4 v[128:131], v118, s[88:91], s36 offen
    s_add_u32 s36, s36, 65536
    buffer_load_dwordx4 v[136:139], v118, s[88:91], s36 offen
    s_add_u32 s36, s67, 1
    s_and_b32 s36, s36, 7
    s_lshl_b32 s36, s36, 17
    s_add_u32 s36, s36, s48
    buffer_load_dwordx4 v[144:147], v118, s[88:91], s36 offen
    s_add_u32 s36, s36, 65536
    buffer_load_dwordx4 v[152:155], v118, s[88:91], s36 offen
    s_and_b32 s49, s30, 3
    s_lshl_b32 s36, s49, 14
    s_lshl_b32 s48, s29, 7
    s_add_u32 s48, s48, s36
    s_lshl_b32 s49, s49, 10
    s_xor_b32 s48, s48, 128
    s_add_u32 s36, s67, 3
    s_and_b32 s36, s36, 7
    s_lshl_b32 s36, s36, 17
    s_add_u32 s36, s36, s48
    s_add_u32 s36, s36, 1048576
    s_add_u32 m0, s49, 114688
    s_nop 0
    buffer_load_dwordx4 v118, s[80:83], s36 offen lds
    s_add_u32 s36, s36, 65536
    s_add_u32 m0, s49, 118784
    s_nop 0
    buffer_load_dwordx4 v118, s[80:83], s36 offen lds
    s_add_u32 s36, s67, 4
    s_and_b32 s36, s36, 7
    s_lshl_b32 s36, s36, 17
    s_add_u32 s36, s36, s48
    s_add_u32 s36, s36, 1048576
    s_add_u32 m0, s49, 122880
    s_nop 0
    buffer_load_dwordx4 v118, s[80:83], s36 offen lds
    s_add_u32 s36, s36, 65536
    s_add_u32 m0, s49, 126976
    s_nop 0
    buffer_load_dwordx4 v118, s[80:83], s36 offen lds
    s_add_u32 s36, s67, 7
    s_and_b32 s36, s36, 7
    s_lshl_b32 s36, s36, 17
    s_add_u32 s36, s36, s48
    s_add_u32 s36, s36, 1048576
    s_add_u32 m0, s49, 147456
    s_nop 0
    buffer_load_dwordx4 v118, s[80:83], s36 offen lds
    s_add_u32 s36, s36, 65536
    s_add_u32 m0, s49, 151552
    s_nop 0
    buffer_load_dwordx4 v118, s[80:83], s36 offen lds
    s_add_u32 s36, s67, 5
    s_and_b32 s36, s36, 7
    s_lshl_b32 s36, s36, 17
    s_add_u32 s36, s36, s48
    s_add_u32 s36, s36, 1048576
    s_add_u32 m0, s49, 131072
    s_nop 0
    buffer_load_dwordx4 v118, s[80:83], s36 offen lds
    s_add_u32 s36, s36, 65536
    s_add_u32 m0, s49, 135168
    s_nop 0
    buffer_load_dwordx4 v118, s[80:83], s36 offen lds
    s_add_u32 s36, s67, 6
    s_and_b32 s36, s36, 7
    s_lshl_b32 s36, s36, 17
    s_add_u32 s36, s36, s48
    s_add_u32 s36, s36, 1048576
    s_add_u32 m0, s49, 139264
    s_nop 0
    buffer_load_dwordx4 v118, s[80:83], s36 offen lds
    s_add_u32 s36, s36, 65536
    s_add_u32 m0, s49, 143360
    s_nop 0
    buffer_load_dwordx4 v118, s[80:83], s36 offen lds
    s_waitcnt vmcnt(14)
    v_mov_b32 v6, 162824
    v_mov_b32 v7, 1
    s_waitcnt lgkmcnt(0)
    s_mov_b64 exec, 1
    ds_add_u32 v6, v7
    s_mov_b64 exec, -1
    s_add_u32 s36, s67, 3
    s_and_b32 s36, s36, 7
    s_lshl_b32 s36, s36, 17
    s_add_u32 s36, s36, s48
    buffer_load_dwordx4 v[28:31], v118, s[80:83], s36 offen
    s_add_u32 s36, s36, 65536
    buffer_load_dwordx4 v[32:35], v118, s[80:83], s36 offen
    s_add_u32 s36, s67, 4
    s_and_b32 s36, s36, 7
    s_lshl_b32 s36, s36, 17
    s_add_u32 s36, s36, s48
    buffer_load_dwordx4 v[36:39], v118, s[80:83], s36 offen
    s_add_u32 s36, s36, 65536
    buffer_load_dwordx4 v[40:43], v118, s[80:83], s36 offen
    s_add_u32 s36, s67, 5
    s_and_b32 s36, s36, 7
    s_lshl_b32 s36, s36, 17
    s_add_u32 s36, s36, s48
    buffer_load_dwordx4 v[52:55], v118, s[80:83], s36 offen
    s_add_u32 s36, s36, 65536
    buffer_load_dwordx4 v[56:59], v118, s[80:83], s36 offen
    s_add_u32 s36, s67, 6
    s_and_b32 s36, s36, 7
    s_lshl_b32 s36, s36, 17
    s_add_u32 s36, s36, s48
    buffer_load_dwordx4 v[60:63], v118, s[80:83], s36 offen
    s_add_u32 s36, s36, 65536
    buffer_load_dwordx4 v[64:67], v118, s[80:83], s36 offen
    s_add_u32 s36, s67, 0
    s_and_b32 s36, s36, 7
    s_lshl_b32 s36, s36, 17
    s_add_u32 s36, s36, s48
    buffer_load_dwordx4 v[94:97], v118, s[80:83], s36 offen
    s_add_u32 s36, s36, 65536
    buffer_load_dwordx4 v[98:101], v118, s[80:83], s36 offen
    s_xor_b32 s48, s48, 128
    s_add_u32 s36, s67, 2
    s_and_b32 s36, s36, 7
    s_lshl_b32 s36, s36, 17
    s_add_u32 s36, s36, s48
    buffer_load_dwordx4 v[160:163], v118, s[88:91], s36 offen
    s_add_u32 s36, s36, 65536
    buffer_load_dwordx4 v[168:171], v118, s[88:91], s36 offen
    s_add_u32 s36, s67, 3
    s_and_b32 s36, s36, 7
    s_lshl_b32 s36, s36, 17
    s_add_u32 s36, s36, s48
    buffer_load_dwordx4 v[176:179], v118, s[88:91], s36 offen
    s_add_u32 s36, s36, 65536
    buffer_load_dwordx4 v[184:187], v118, s[88:91], s36 offen
    s_add_u32 s36, s67, 4
    s_and_b32 s36, s36, 7
    s_lshl_b32 s36, s36, 17
    s_add_u32 s36, s36, s48
    buffer_load_dwordx4 v[192:195], v118, s[88:91], s36 offen
    s_add_u32 s36, s36, 65536
    buffer_load_dwordx4 v[200:203], v118, s[88:91], s36 offen
    s_add_u32 s36, s67, 5
    s_and_b32 s36, s36, 7
    s_lshl_b32 s36, s36, 17
    s_add_u32 s36, s36, s48
    buffer_load_dwordx4 v[208:211], v118, s[88:91], s36 offen
    s_add_u32 s36, s36, 65536
    buffer_load_dwordx4 v[216:219], v118, s[88:91], s36 offen
    s_add_u32 s36, s67, 6
    s_and_b32 s36, s36, 7
    s_lshl_b32 s36, s36, 17
    s_add_u32 s36, s36, s48
    buffer_load_dwordx4 v[224:227], v118, s[88:91], s36 offen
    s_add_u32 s36, s36, 65536
    buffer_load_dwordx4 v[232:235], v118, s[88:91], s36 offen
    s_add_u32 s36, s67, 7
    s_and_b32 s36, s36, 7
    s_lshl_b32 s36, s36, 17
    s_add_u32 s36, s36, s48
    buffer_load_dwordx4 v[240:243], v118, s[88:91], s36 offen
    s_add_u32 s36, s36, 65536
    buffer_load_dwordx4 v[248:251], v118, s[88:91], s36 offen
    v_lshrrev_b32 v10, 4, v1
    v_lshlrev_b32 v119, 11, v10
    v_add_u32 v10, 0, v10
    v_lshlrev_b32 v10, 1, v10
    v_and_b32 v11, 15, v1
    v_xor_b32 v10, v10, v11
    v_lshl_add_u32 v119, v10, 4, v119
    v_lshrrev_b32 v10, 4, v1
    v_lshlrev_b32 v120, 11, v10
    v_add_u32 v10, 4, v10
    v_lshlrev_b32 v10, 1, v10
    v_and_b32 v11, 15, v1
    v_xor_b32 v10, v10, v11
    v_lshl_add_u32 v120, v10, 4, v120
    v_add_u32 v11, 0, v1
    v_mul_u32_u24 v10, 2341, v11
    v_lshrrev_b32 v10, 16, v10
    v_mul_u32_u24 v121, 28, v10
    v_sub_u32 v11, v11, v121
    v_mul_u32_u24 v121, 7168, v10
    v_lshrrev_b32 v10, 1, v10
    v_and_b32 v10, 2, v10
    v_xor_b32 v11, v11, v10
    v_lshl_add_u32 v121, v11, 4, v121
    v_add_u32 v11, 64, v1
    v_mul_u32_u24 v10, 2341, v11
    v_lshrrev_b32 v10, 16, v10
    v_mul_u32_u24 v122, 28, v10
    v_sub_u32 v11, v11, v122
    v_mul_u32_u24 v122, 7168, v10
    v_lshrrev_b32 v10, 1, v10
    v_and_b32 v10, 2, v10
    v_xor_b32 v11, v11, v10
    v_lshl_add_u32 v122, v11, 4, v122
    v_add_u32 v11, 128, v1
    v_mul_u32_u24 v10, 2341, v11
    v_lshrrev_b32 v10, 16, v10
    v_mul_u32_u24 v123, 28, v10
    v_sub_u32 v11, v11, v123
    v_mul_u32_u24 v123, 7168, v10
    v_lshrrev_b32 v10, 1, v10
    v_and_b32 v10, 2, v10
    v_xor_b32 v11, v11, v10
    v_lshl_add_u32 v123, v11, 4, v123
    v_add_u32 v11, 192, v1
    v_mul_u32_u24 v10, 2341, v11
    v_lshrrev_b32 v10, 16, v10
    v_mul_u32_u24 v124, 28, v10
    v_sub_u32 v11, v11, v124
    v_mul_u32_u24 v124, 7168, v10
    v_lshrrev_b32 v10, 1, v10
    v_and_b32 v10, 2, v10
    v_xor_b32 v11, v11, v10
    v_lshl_add_u32 v124, v11, 4, v124
    v_add_u32 v11, 256, v1
    v_mul_u32_u24 v10, 2341, v11
    v_lshrrev_b32 v10, 16, v10
    v_mul_u32_u24 v125, 28, v10
    v_sub_u32 v11, v11, v125
    v_mul_u32_u24 v125, 7168, v10
    v_lshrrev_b32 v10, 1, v10
    v_and_b32 v10, 2, v10
    v_xor_b32 v11, v11, v10
    v_lshl_add_u32 v125, v11, 4, v125
    v_add_u32 v11, 320, v1
    v_mul_u32_u24 v10, 2341, v11
    v_lshrrev_b32 v10, 16, v10
    v_mul_u32_u24 v126, 28, v10
    v_sub_u32 v11, v11, v126
    v_mul_u32_u24 v126, 7168, v10
    v_lshrrev_b32 v10, 1, v10
    v_and_b32 v10, 2, v10
    v_xor_b32 v11, v11, v10
    v_lshl_add_u32 v126, v11, 4, v126
    v_add_u32 v11, 384, v1
    v_mul_u32_u24 v10, 2341, v11
    v_lshrrev_b32 v10, 16, v10
    v_mul_u32_u24 v127, 28, v10
    v_sub_u32 v11, v11, v127
    v_mul_u32_u24 v127, 7168, v10
    v_lshrrev_b32 v10, 1, v10
    v_and_b32 v10, 2, v10
    v_xor_b32 v11, v11, v10
    v_lshl_add_u32 v127, v11, 4, v127
    s_cmp_lg_u32 s30, 4
    s_cbranch_scc1 R_fw
    s_lshl_b32 s36, s28, 13
    s_add_u32 s36, s36, 23592960
    v_lshlrev_b32 v8, 7, v1
    v_add_u32 v8, s36, v8
    s_mov_b32 s53, 0
R_fp:
    buffer_load_dword v6, v8, s[56:59], 0 offen sc1
    s_waitcnt vmcnt(0)
    v_subrev_u32 v6, s52, v6
    v_and_b32 v7, 0xfffff8ff, v6
    v_cmp_eq_u32 vcc, 4, v7
    s_nop 0
    s_cmp_eq_u64 vcc, exec
    s_cbranch_scc1 R_fq
    s_sleep 3
    s_add_u32 s53, s53, 1
    s_cmp_lt_u32 s53, s61
    s_cbranch_scc1 R_fp
    s_mov_b32 s61, 0
R_fq:
    v_lshrrev_b32 v6, 8, v6
    v_mov_b32 v7, 162844
    ds_add_u32 v7, v6
R_fw:
    s_waitcnt vmcnt(0)
FR_end:
    v_lshlrev_b32 v72, 6, v81
    v_add_u32 v72, 161792, v72
    s_lshl_b32 s35, s30, 3
    v_add_u32 v71, s35, v72
    v_lshlrev_b32 v12, 16, v86
    v_and_b32 v13, 0xffff0000, v86
    v_lshlrev_b32 v14, 16, v87
    v_and_b32 v15, 0xffff0000, v87
    v_lshlrev_b32 v16, 16, v88
    v_and_b32 v17, 0xffff0000, v88
    v_lshlrev_b32 v18, 16, v89
    v_and_b32 v19, 0xffff0000, v89
    v_lshlrev_b32 v20, 16, v90
    v_and_b32 v21, 0xffff0000, v90
    v_lshlrev_b32 v22, 16, v91
    v_and_b32 v23, 0xffff0000, v91
    v_lshlrev_b32 v24, 16, v92
    v_and_b32 v25, 0xffff0000, v92
    v_lshlrev_b32 v26, 16, v93
    v_and_b32 v27, 0xffff0000, v93
    v_pk_add_f32 v[48:49], v[12:13], v[14:15]
    v_pk_mul_f32 v[50:51], v[12:13], v[12:13]
    v_pk_fma_f32 v[50:51], v[14:15], v[14:15], v[50:51]
    v_pk_add_f32 v[48:49], v[48:49], v[16:17]
    v_pk_fma_f32 v[50:51], v[16:17], v[16:17], v[50:51]
    v_pk_add_f32 v[48:49], v[48:49], v[18:19]
    v_pk_fma_f32 v[50:51], v[18:19], v[18:19], v[50:51]
    v_pk_add_f32 v[48:49], v[48:49], v[20:21]
    v_pk_fma_f32 v[50:51], v[20:21], v[20:21], v[50:51]
    v_pk_add_f32 v[48:49], v[48:49], v[22:23]
    v_pk_fma_f32 v[50:51], v[22:23], v[22:23], v[50:51]
    v_pk_add_f32 v[48:49], v[48:49], v[24:25]
    v_pk_fma_f32 v[50:51], v[24:25], v[24:25], v[50:51]
    v_pk_add_f32 v[48:49], v[48:49], v[26:27]
    v_pk_fma_f32 v[50:51], v[26:27], v[26:27], v[50:51]
    v_add_f32 v46, v48, v49
    v_add_f32 v47, v50, v51
    s_nop 0
    v_add_f32_dpp v46, v46, v46 row_ror:8 row_mask:0xf bank_mask:0xf
    v_add_f32_dpp v47, v47, v47 row_ror:8 row_mask:0xf bank_mask:0xf
    v_mov_b32 v48, v46
    v_mov_b32 v49, v47
    s_nop 0
    v_permlane16_swap_b32 v46, v48
    v_permlane16_swap_b32 v47, v49
    v_pk_add_f32 v[46:47], v[46:47], v[48:49]
    v_mov_b32 v48, v46
    v_mov_b32 v49, v47
    s_nop 0
    v_permlane32_swap_b32 v46, v48
    v_permlane32_swap_b32 v47, v49
    v_pk_add_f32 v[46:47], v[46:47], v[48:49]
    ds_write_b64 v71, v[46:47] offset:0
    s_waitcnt lgkmcnt(0)
    s_barrier
LAYER:
    v_lshlrev_b32 v72, 6, v81
    v_add_u32 v72, 161792, v72
    s_lshl_b32 s35, s30, 3
    v_add_u32 v71, s35, v72
    v_lshrrev_b32 v6, 2, v1
    v_lshlrev_b32 v74, 7, v6
    v_bfe_u32 v6, v6, 1, 2
    s_and_b32 s35, s30, 2
    v_and_b32 v7, 1, v1
    v_or_b32 v7, s35, v7
    v_xor_b32 v6, v6, v7
    v_lshl_add_u32 v74, v6, 5, v74
    v_and_b32 v6, 2, v1
    v_lshl_add_u32 v74, v6, 2, v74
    s_and_b32 s35, s30, 1
    s_lshl_b32 s35, s35, 4
    v_add_u32 v74, s35, v74
    v_add_u32 v75, 65536, v74
    v_add_u32 v76, 131072, v74
    s_cmp_eq_u32 s60, 0
    s_cbranch_scc1 R_l0
    s_sub_u32 s8, s62, 0x3c00000
    s_subb_u32 s9, s63, 0
    s_mov_b32 s10, 0x7e000
    s_mov_b32 s11, 0x20000
    s_lshr_b32 s37, s28, 3
    s_and_b32 s36, s28, 3
    s_lshl2_add_u32 s36, s37, s36
    s_lshl_b32 s36, s36, 19
    s_xor_b32 s37, s37, s94
    s_lshl_b32 s37, s37, 2
    s_xor_b32 s37, s37, s28
    s_and_b32 s37, s37, 4
    s_lshl_b32 s37, s37, 11
    s_add_u32 s36, s36, s37
    s_add_u32 s36, s36, 29360128
    s_add_u32 s12, s4, s36
    s_addc_u32 s13, s5, 0
    s_mov_b32 s14, 516096
    s_mov_b32 s15, 0x20000
    v_lshlrev_b32 v102, 16, v110
    v_and_b32 v103, 0xffff0000, v110
    v_lshlrev_b32 v104, 16, v111
    v_and_b32 v105, 0xffff0000, v111
    v_lshlrev_b32 v106, 16, v112
    v_and_b32 v107, 0xffff0000, v112
    v_lshlrev_b32 v108, 16, v113
    v_and_b32 v109, 0xffff0000, v113
    v_lshlrev_b32 v110, 16, v114
    v_and_b32 v111, 0xffff0000, v114
    v_lshlrev_b32 v112, 16, v115
    v_and_b32 v113, 0xffff0000, v115
    v_lshlrev_b32 v114, 16, v116
    v_and_b32 v115, 0xffff0000, v116
    v_lshlrev_b32 v116, 16, v117
    v_and_b32 v117, 0xffff0000, v117
    s_cmp_ge_u32 s30, 4
    s_cbranch_scc1 w1in_4
    ds_read_b64_tr_b16 v[180:181], v75 offset:49152
    ds_read_b64_tr_b16 v[182:183], v75 offset:51200
    ds_read_b64_tr_b16 v[188:189], v75 offset:53248
    ds_read_b64_tr_b16 v[190:191], v75 offset:55296
    ds_read_b64_tr_b16 v[196:197], v75 offset:57344
    ds_read_b64_tr_b16 v[198:199], v75 offset:59392
    ds_read_b64_tr_b16 v[204:205], v75 offset:61440
    ds_read_b64_tr_b16 v[206:207], v75 offset:63488
    ds_read_b64_tr_b16 v[244:245], v76 offset:16384
    ds_read_b64_tr_b16 v[246:247], v76 offset:18432
    ds_read_b64_tr_b16 v[252:253], v76 offset:20480
    ds_read_b64_tr_b16 v[254:255], v76 offset:22528
    ds_read_b64_tr_b16 v[212:213], v76 offset:0
    ds_read_b64_tr_b16 v[214:215], v76 offset:2048
    ds_read_b64_tr_b16 v[220:221], v76 offset:4096
    ds_read_b64_tr_b16 v[222:223], v76 offset:6144
    ds_read_b64_tr_b16 v[228:229], v76 offset:8192
    ds_read_b64_tr_b16 v[230:231], v76 offset:10240
    ds_read_b64_tr_b16 v[236:237], v76 offset:12288
    ds_read_b64_tr_b16 v[238:239], v76 offset:14336
    ds_read_b64_tr_b16 v[176:177], v74 offset:49152
    ds_read_b64_tr_b16 v[178:179], v74 offset:51200
    ds_read_b64_tr_b16 v[184:185], v74 offset:53248
    ds_read_b64_tr_b16 v[186:187], v74 offset:55296
    ds_read_b64_tr_b16 v[192:193], v74 offset:57344
    ds_read_b64_tr_b16 v[194:195], v74 offset:59392
    ds_read_b64_tr_b16 v[200:201], v74 offset:61440
    ds_read_b64_tr_b16 v[202:203], v74 offset:63488
    ds_read_b64_tr_b16 v[208:209], v75 offset:0
    ds_read_b64_tr_b16 v[210:211], v75 offset:2048
    ds_read_b64_tr_b16 v[216:217], v75 offset:4096
    ds_read_b64_tr_b16 v[218:219], v75 offset:6144
    ds_read_b64_tr_b16 v[224:225], v75 offset:8192
    ds_read_b64_tr_b16 v[226:227], v75 offset:10240
    ds_read_b64_tr_b16 v[232:233], v75 offset:12288
    ds_read_b64_tr_b16 v[234:235], v75 offset:14336
    ds_read_b64_tr_b16 v[128:129], v74 offset:24576
    ds_read_b64_tr_b16 v[130:131], v74 offset:26624
    ds_read_b64_tr_b16 v[136:137], v74 offset:28672
    ds_read_b64_tr_b16 v[138:139], v74 offset:30720
w1in_4:
    buffer_load_dwordx4 v[86:89], v78, s[8:11], 0 offen offset:0 sc1
    buffer_load_dwordx4 v[94:97], v78, s[12:15], 0 offen offset:0 sc1
    buffer_load_dwordx4 v[90:93], v78, s[8:11], 0 offen offset:2048 sc1
    buffer_load_dwordx4 v[98:101], v78, s[12:15], 0 offen offset:2048 sc1
    s_mov_b32 s53, 0
dw_5:
    s_waitcnt vmcnt(0)
    v_and_b32 v6, v86, v87
    v_and_b32 v7, v94, v95
    v_bitop3_b32 v6, v88, v89, v6 bitop3:0x80
    v_bitop3_b32 v7, v96, v97, v7 bitop3:0x80
    v_bitop3_b32 v6, v90, v91, v6 bitop3:0x80
    v_bitop3_b32 v7, v98, v99, v7 bitop3:0x80
    v_bitop3_b32 v6, v92, v93, v6 bitop3:0x80
    v_bitop3_b32 v7, v100, v101, v7 bitop3:0x80
    v_bitop3_b32 v6, v6, v7, 1 bitop3:0x80
    v_cmp_eq_u32 vcc, 0, v6
    s_nop 0
    s_cmp_eq_u64 vcc, 0
    s_cbranch_scc1 dok_6
    s_mov_b64 exec, vcc
    s_sleep 2
    buffer_load_dwordx4 v[86:89], v78, s[8:11], 0 offen offset:0 sc1
    buffer_load_dwordx4 v[94:97], v78, s[12:15], 0 offen offset:0 sc1
    buffer_load_dwordx4 v[90:93], v78, s[8:11], 0 offen offset:2048 sc1
    buffer_load_dwordx4 v[98:101], v78, s[12:15], 0 offen offset:2048 sc1
    s_add_u32 s53, s53, 1
    s_cmp_lt_u32 s53, s61
    s_cbranch_scc1 dw_5
    s_mov_b32 s61, 0
    s_waitcnt vmcnt(0)
dok_6:
    s_mov_b64 exec, -1
    v_lshlrev_b32 v12, 16, v86
    v_and_b32 v13, 0xffff0000, v86
    v_lshlrev_b32 v28, 16, v94
    v_and_b32 v29, 0xffff0000, v94
    v_pk_add_f32 v[12:13], v[12:13], v[28:29]
    v_lshlrev_b32 v14, 16, v87
    v_and_b32 v15, 0xffff0000, v87
    v_lshlrev_b32 v30, 16, v95
    v_and_b32 v31, 0xffff0000, v95
    v_pk_add_f32 v[14:15], v[14:15], v[30:31]
    v_lshlrev_b32 v16, 16, v88
    v_and_b32 v17, 0xffff0000, v88
    v_lshlrev_b32 v32, 16, v96
    v_and_b32 v33, 0xffff0000, v96
    v_pk_add_f32 v[16:17], v[16:17], v[32:33]
    v_lshlrev_b32 v18, 16, v89
    v_and_b32 v19, 0xffff0000, v89
    v_lshlrev_b32 v34, 16, v97
    v_and_b32 v35, 0xffff0000, v97
    v_pk_add_f32 v[18:19], v[18:19], v[34:35]
    v_lshlrev_b32 v20, 16, v90
    v_and_b32 v21, 0xffff0000, v90
    v_lshlrev_b32 v36, 16, v98
    v_and_b32 v37, 0xffff0000, v98
    v_pk_add_f32 v[20:21], v[20:21], v[36:37]
    v_lshlrev_b32 v22, 16, v91
    v_and_b32 v23, 0xffff0000, v91
    v_lshlrev_b32 v38, 16, v99
    v_and_b32 v39, 0xffff0000, v99
    v_pk_add_f32 v[22:23], v[22:23], v[38:39]
    v_lshlrev_b32 v24, 16, v92
    v_and_b32 v25, 0xffff0000, v92
    v_lshlrev_b32 v40, 16, v100
    v_and_b32 v41, 0xffff0000, v100
    v_pk_add_f32 v[24:25], v[24:25], v[40:41]
    v_lshlrev_b32 v26, 16, v93
    v_and_b32 v27, 0xffff0000, v93
    v_lshlrev_b32 v42, 16, v101
    v_and_b32 v43, 0xffff0000, v101
    v_pk_add_f32 v[26:27], v[26:27], v[42:43]
    v_pk_add_f32 v[48:49], v[12:13], v[14:15]
    v_pk_mul_f32 v[50:51], v[12:13], v[12:13]
    v_pk_fma_f32 v[50:51], v[14:15], v[14:15], v[50:51]
    v_pk_add_f32 v[48:49], v[48:49], v[16:17]
    v_pk_fma_f32 v[50:51], v[16:17], v[16:17], v[50:51]
    v_pk_add_f32 v[48:49], v[48:49], v[18:19]
    v_pk_fma_f32 v[50:51], v[18:19], v[18:19], v[50:51]
    v_pk_add_f32 v[48:49], v[48:49], v[20:21]
    v_pk_fma_f32 v[50:51], v[20:21], v[20:21], v[50:51]
    v_pk_add_f32 v[48:49], v[48:49], v[22:23]
    v_pk_fma_f32 v[50:51], v[22:23], v[22:23], v[50:51]
    v_pk_add_f32 v[48:49], v[48:49], v[24:25]
    v_pk_fma_f32 v[50:51], v[24:25], v[24:25], v[50:51]
    v_pk_add_f32 v[48:49], v[48:49], v[26:27]
    v_pk_fma_f32 v[50:51], v[26:27], v[26:27], v[50:51]
    v_add_f32 v46, v48, v49
    v_add_f32 v47, v50, v51
    s_nop 0
    v_add_f32_dpp v46, v46, v46 row_ror:8 row_mask:0xf bank_mask:0xf
    v_add_f32_dpp v47, v47, v47 row_ror:8 row_mask:0xf bank_mask:0xf
    v_mov_b32 v48, v46
    v_mov_b32 v49, v47
    s_nop 0
    v_permlane16_swap_b32 v46, v48
    v_permlane16_swap_b32 v47, v49
    v_pk_add_f32 v[46:47], v[46:47], v[48:49]
    v_mov_b32 v48, v46
    v_mov_b32 v49, v47
    s_nop 0
    v_permlane32_swap_b32 v46, v48
    v_permlane32_swap_b32 v47, v49
    v_pk_add_f32 v[46:47], v[46:47], v[48:49]
    ds_write_b64 v71, v[46:47] offset:0
    s_lshl_b32 s22, s60, 24
    s_lshl_b32 s23, s94, 13
    s_add_u32 s22, s22, s23
    s_add_u32 s22, s22, 167772160
    s_add_u32 s20, s4, s22
    s_addc_u32 s21, s5, 0
    s_mov_b32 s22, 8380416
    s_mov_b32 s23, 0x20000
    s_waitcnt lgkmcnt(0)
    s_barrier
    ds_read_b128 v[52:55], v72 offset:0
    ds_read_b128 v[56:59], v72 offset:16
    ds_read_b128 v[60:63], v72 offset:32
    ds_read_b128 v[64:67], v72 offset:48
    s_waitcnt lgkmcnt(0)
    v_pk_add_f32 v[52:53], v[52:53], v[54:55]
    v_pk_add_f32 v[56:57], v[56:57], v[58:59]
    v_pk_add_f32 v[60:61], v[60:61], v[62:63]
    v_pk_add_f32 v[64:65], v[64:65], v[66:67]
    v_pk_add_f32 v[52:53], v[52:53], v[56:57]
    v_pk_add_f32 v[60:61], v[60:61], v[64:65]
    v_pk_add_f32 v[52:53], v[52:53], v[60:61]
    v_mul_f32 v68, 0x3a800000, v52
    v_mul_f32 v70, 0x3a800000, v53
    v_fma_f32 v70, -v68, v68, v70
    v_max_f32 v70, 0, v70
    v_cvt_pk_bf16_f32 v68, v68, v68
    v_lshlrev_b32 v68, 16, v68
    v_cvt_pk_bf16_f32 v70, v70, v70
    v_lshlrev_b32 v70, 16, v70
    v_add_f32 v70, 0x3727c5ac, v70
    v_cvt_pk_bf16_f32 v70, v70, v70
    v_lshlrev_b32 v70, 16, v70
    v_sqrt_f32 v70, v70
    s_nop 0
    v_cvt_pk_bf16_f32 v70, v70, v70
    v_lshlrev_b32 v70, 16, v70
    v_rcp_f32 v69, v70
    s_nop 0
    v_mul_f32 v68, -v68, v69
    v_pk_fma_f32 v[28:29], v[12:13], v[68:69], v[68:69] op_sel:[0,1,0] op_sel_hi:[1,1,0]
    v_pk_fma_f32 v[30:31], v[14:15], v[68:69], v[68:69] op_sel:[0,1,0] op_sel_hi:[1,1,0]
    v_pk_fma_f32 v[32:33], v[16:17], v[68:69], v[68:69] op_sel:[0,1,0] op_sel_hi:[1,1,0]
    v_pk_fma_f32 v[34:35], v[18:19], v[68:69], v[68:69] op_sel:[0,1,0] op_sel_hi:[1,1,0]
    v_pk_fma_f32 v[36:37], v[20:21], v[68:69], v[68:69] op_sel:[0,1,0] op_sel_hi:[1,1,0]
    v_pk_fma_f32 v[38:39], v[22:23], v[68:69], v[68:69] op_sel:[0,1,0] op_sel_hi:[1,1,0]
    v_pk_fma_f32 v[40:41], v[24:25], v[68:69], v[68:69] op_sel:[0,1,0] op_sel_hi:[1,1,0]
    v_pk_fma_f32 v[42:43], v[26:27], v[68:69], v[68:69] op_sel:[0,1,0] op_sel_hi:[1,1,0]
    s_branch R_s2
R_l0:
    s_cmp_lt_u32 s30, 4
    s_cbranch_scc1 R_f2
    s_and_b32 s36, s30, 3
    s_lshl_b32 s36, s36, 10
    v_add_u32 v8, s36, v2
    v_add_u32 v9, 65536, v8
    ds_write_b128 v8, v[28:31] offset:49152
    ds_write_b128 v8, v[32:35] offset:53248
    ds_write_b128 v8, v[36:39] offset:57344
    ds_write_b128 v8, v[40:43] offset:61440
    ds_write_b128 v9, v[52:55] offset:0
    ds_write_b128 v9, v[56:59] offset:4096
    ds_write_b128 v9, v[60:63] offset:8192
    ds_write_b128 v9, v[64:67] offset:12288
    ds_write_b128 v8, v[94:97] offset:24576
    ds_write_b128 v8, v[98:101] offset:28672
R_f2:
    v_mov_b32 v6, 162844
    ds_read_b32 v7, v6
    ds_read_b128 v[52:55], v72 offset:0
    ds_read_b128 v[56:59], v72 offset:16
    ds_read_b128 v[60:63], v72 offset:32
    ds_read_b128 v[64:67], v72 offset:48
    s_waitcnt lgkmcnt(0)
    v_pk_add_f32 v[52:53], v[52:53], v[54:55]
    v_pk_add_f32 v[56:57], v[56:57], v[58:59]
    v_pk_add_f32 v[60:61], v[60:61], v[62:63]
    v_pk_add_f32 v[64:65], v[64:65], v[66:67]
    v_pk_add_f32 v[52:53], v[52:53], v[56:57]
    v_pk_add_f32 v[60:61], v[60:61], v[64:65]
    v_pk_add_f32 v[52:53], v[52:53], v[60:61]
    v_mul_f32 v68, 0x3a800000, v52
    v_mul_f32 v70, 0x3a800000, v53
    v_fma_f32 v70, -v68, v68, v70
    v_max_f32 v70, 0, v70
    v_cvt_pk_bf16_f32 v68, v68, v68
    v_lshlrev_b32 v68, 16, v68
    v_cvt_pk_bf16_f32 v70, v70, v70
    v_lshlrev_b32 v70, 16, v70
    v_add_f32 v70, 0x3727c5ac, v70
    v_cvt_pk_bf16_f32 v70, v70, v70
    v_lshlrev_b32 v70, 16, v70
    v_sqrt_f32 v70, v70
    s_nop 0
    v_cvt_pk_bf16_f32 v70, v70, v70
    v_lshlrev_b32 v70, 16, v70
    v_rcp_f32 v69, v70
    s_nop 0
    v_mul_f32 v68, -v68, v69
    v_pk_fma_f32 v[28:29], v[12:13], v[68:69], v[68:69] op_sel:[0,1,0] op_sel_hi:[1,1,0]
    v_pk_fma_f32 v[30:31], v[14:15], v[68:69], v[68:69] op_sel:[0,1,0] op_sel_hi:[1,1,0]
    v_pk_fma_f32 v[32:33], v[16:17], v[68:69], v[68:69] op_sel:[0,1,0] op_sel_hi:[1,1,0]
    v_pk_fma_f32 v[34:35], v[18:19], v[68:69], v[68:69] op_sel:[0,1,0] op_sel_hi:[1,1,0]
    v_pk_fma_f32 v[36:37], v[20:21], v[68:69], v[68:69] op_sel:[0,1,0] op_sel_hi:[1,1,0]
    v_pk_fma_f32 v[38:39], v[22:23], v[68:69], v[68:69] op_sel:[0,1,0] op_sel_hi:[1,1,0]
    v_pk_fma_f32 v[40:41], v[24:25], v[68:69], v[68:69] op_sel:[0,1,0] op_sel_hi:[1,1,0]
    v_pk_fma_f32 v[42:43], v[26:27], v[68:69], v[68:69] op_sel:[0,1,0] op_sel_hi:[1,1,0]
    v_readfirstlane_b32 s94, v7
    s_nop 0
    s_cmp_gt_u32 s94, 127
    s_cselect_b32 s94, 1, 0
    s_lshr_b32 s53, s28, 3
    s_lshl_b32 s53, s53, 2
    s_and_b32 s54, s28, 3
    s_add_u32 s53, s53, s54
    s_lshl_b32 s53, s53, 23
    s_lshr_b32 s54, s28, 2
    s_xor_b32 s54, s54, s94
    s_and_b32 s54, s54, 1
    s_lshl_b32 s54, s54, 13
    s_add_u32 s55, s53, s54
    s_add_u32 s55, s55, 33554432
    s_add_u32 s62, s4, s55
    s_addc_u32 s63, s5, 0
    s_sub_u32 s36, s28, 1
    s_max_i32 s36, s36, 0
    s_lshr_b32 s53, s36, 3
    s_lshl_b32 s53, s53, 2
    s_and_b32 s54, s36, 3
    s_add_u32 s53, s53, s54
    s_lshl_b32 s53, s53, 23
    s_lshr_b32 s54, s36, 2
    s_xor_b32 s54, s54, s94
    s_and_b32 s54, s54, 1
    s_lshl_b32 s54, s54, 13
    s_add_u32 s92, s53, s54
    s_add_u32 s92, s92, 33554432
    s_sub_u32 s92, s92, s55
    s_add_u32 s36, s28, 1
    s_min_u32 s36, s36, 15
    s_lshr_b32 s53, s36, 3
    s_lshl_b32 s53, s53, 2
    s_and_b32 s54, s36, 3
    s_add_u32 s53, s53, s54
    s_lshl_b32 s53, s53, 23
    s_lshr_b32 s54, s36, 2
    s_xor_b32 s54, s54, s94
    s_and_b32 s54, s54, 1
    s_lshl_b32 s54, s54, 13
    s_add_u32 s93, s53, s54
    s_add_u32 s93, s93, 33554432
    s_sub_u32 s93, s93, s55
    s_add_u32 s55, s55, 1835008
    s_lshl_b32 s22, s60, 24
    s_lshl_b32 s23, s94, 13
    s_add_u32 s22, s22, s23
    s_add_u32 s22, s22, 167772160
    s_add_u32 s20, s4, s22
    s_addc_u32 s21, s5, 0
    s_mov_b32 s22, 8380416
    s_mov_b32 s23, 0x20000
    s_add_u32 s80, s4, 0x1800000
    s_addc_u32 s81, s5, 0
    s_mov_b32 s82, 0x400000
    s_mov_b32 s83, 0x20000
    s_mov_b32 s78, 0
    buffer_load_dwordx2 v[110:111], v79, s[80:83], s78 offen sc1
    s_mov_b32 s78, 65536
    buffer_load_dwordx2 v[112:113], v79, s[80:83], s78 offen sc1
    s_mov_b32 s78, 262144
    buffer_load_dwordx2 v[114:115], v79, s[80:83], s78 offen sc1
    s_mov_b32 s78, 327680
    buffer_load_dwordx2 v[116:117], v79, s[80:83], s78 offen sc1
    s_cmp_lt_u32 s30, 4
    s_cbranch_scc1 R_f3
    s_and_b32 s36, s30, 3
    s_lshl_b32 s36, s36, 10
    v_add_u32 v8, s36, v2
    v_add_u32 v9, 65536, v8
    ds_write_b128 v8, v[128:131] offset:0
    ds_write_b128 v8, v[136:139] offset:4096
    ds_write_b128 v8, v[144:147] offset:8192
    ds_write_b128 v8, v[152:155] offset:12288
    ds_write_b128 v8, v[160:163] offset:16384
    ds_write_b128 v8, v[168:171] offset:20480
    ds_write_b128 v9, v[176:179] offset:16384
    ds_write_b128 v9, v[184:187] offset:20480
    ds_write_b128 v9, v[192:195] offset:24576
    ds_write_b128 v9, v[200:203] offset:28672
    ds_write_b128 v8, v[208:211] offset:32768
    ds_write_b128 v8, v[216:219] offset:36864
    ds_write_b128 v8, v[224:227] offset:40960
    ds_write_b128 v8, v[232:235] offset:45056
    ds_write_b128 v9, v[240:243] offset:32768
    ds_write_b128 v9, v[248:251] offset:36864
R_f3:
    s_mov_b32 s53, 0
dw_7:
    s_waitcnt vmcnt(0)
    v_and_b32 v6, v110, v111
    v_and_b32 v7, v114, v115
    v_bitop3_b32 v6, v112, v113, v6 bitop3:0x80
    v_bitop3_b32 v7, v116, v117, v7 bitop3:0x80
    v_bitop3_b32 v6, v6, v7, 1 bitop3:0x80
    v_cmp_eq_u32 vcc, 0, v6
    s_nop 0
    s_cmp_eq_u64 vcc, 0
    s_cbranch_scc1 dok_8
    s_mov_b64 exec, vcc
    s_sleep 4
    s_mov_b32 s78, 0
    buffer_load_dwordx2 v[110:111], v79, s[80:83], s78 offen sc1
    s_mov_b32 s78, 65536
    buffer_load_dwordx2 v[112:113], v79, s[80:83], s78 offen sc1
    s_mov_b32 s78, 262144
    buffer_load_dwordx2 v[114:115], v79, s[80:83], s78 offen sc1
    s_mov_b32 s78, 327680
    buffer_load_dwordx2 v[116:117], v79, s[80:83], s78 offen sc1
    s_add_u32 s53, s53, 1
    s_cmp_lt_u32 s53, s61
    s_cbranch_scc1 dw_7
    s_mov_b32 s61, 0
    s_waitcnt vmcnt(0)
dok_8:
    s_mov_b64 exec, -1
    v_lshlrev_b32 v102, 16, v110
    v_and_b32 v103, 0xffff0000, v110
    v_lshlrev_b32 v104, 16, v111
    v_and_b32 v105, 0xffff0000, v111
    v_lshlrev_b32 v106, 16, v112
    v_and_b32 v107, 0xffff0000, v112
    v_lshlrev_b32 v108, 16, v113
    v_and_b32 v109, 0xffff0000, v113
    v_lshlrev_b32 v110, 16, v114
    v_and_b32 v111, 0xffff0000, v114
    v_lshlrev_b32 v112, 16, v115
    v_and_b32 v113, 0xffff0000, v115
    v_lshlrev_b32 v114, 16, v116
    v_and_b32 v115, 0xffff0000, v116
    v_lshlrev_b32 v116, 16, v117
    v_and_b32 v117, 0xffff0000, v117
R_s2:
    v_pk_fma_f32 v[12:13], v[28:29], v[102:103], v[12:13]
    v_pk_fma_f32 v[14:15], v[30:31], v[104:105], v[14:15]
    v_pk_fma_f32 v[16:17], v[32:33], v[106:107], v[16:17]
    v_pk_fma_f32 v[18:19], v[34:35], v[108:109], v[18:19]
    v_cvt_pk_bf16_f32 v86, v12, v13
    v_cvt_pk_bf16_f32 v87, v14, v15
    v_cvt_pk_bf16_f32 v88, v16, v17
    v_cvt_pk_bf16_f32 v89, v18, v19
    buffer_store_dwordx4 v[86:89], v82, s[20:23], 0 offen offset:0 sc1
    v_pk_fma_f32 v[20:21], v[36:37], v[110:111], v[20:21]
    v_pk_fma_f32 v[22:23], v[38:39], v[112:113], v[22:23]
    v_pk_fma_f32 v[24:25], v[40:41], v[114:115], v[24:25]
    v_pk_fma_f32 v[26:27], v[42:43], v[116:117], v[26:27]
    v_cvt_pk_bf16_f32 v90, v20, v21
    v_cvt_pk_bf16_f32 v91, v22, v23
    v_cvt_pk_bf16_f32 v92, v24, v25
    v_cvt_pk_bf16_f32 v93, v26, v27
    buffer_store_dwordx4 v[90:93], v82, s[20:23], 0 offen offset:128 sc1
    v_pk_add_f32 v[48:49], v[12:13], v[14:15]
    v_pk_mul_f32 v[50:51], v[12:13], v[12:13]
    v_pk_fma_f32 v[50:51], v[14:15], v[14:15], v[50:51]
    v_pk_add_f32 v[48:49], v[48:49], v[16:17]
    v_pk_fma_f32 v[50:51], v[16:17], v[16:17], v[50:51]
    v_pk_add_f32 v[48:49], v[48:49], v[18:19]
    v_pk_fma_f32 v[50:51], v[18:19], v[18:19], v[50:51]
    v_pk_add_f32 v[48:49], v[48:49], v[20:21]
    v_pk_fma_f32 v[50:51], v[20:21], v[20:21], v[50:51]
    v_pk_add_f32 v[48:49], v[48:49], v[22:23]
    v_pk_fma_f32 v[50:51], v[22:23], v[22:23], v[50:51]
    v_pk_add_f32 v[48:49], v[48:49], v[24:25]
    v_pk_fma_f32 v[50:51], v[24:25], v[24:25], v[50:51]
    v_pk_add_f32 v[48:49], v[48:49], v[26:27]
    v_pk_fma_f32 v[50:51], v[26:27], v[26:27], v[50:51]
    v_add_f32 v46, v48, v49
    v_add_f32 v47, v50, v51
    s_nop 0
    v_add_f32_dpp v46, v46, v46 row_ror:8 row_mask:0xf bank_mask:0xf
    v_add_f32_dpp v47, v47, v47 row_ror:8 row_mask:0xf bank_mask:0xf
    v_mov_b32 v48, v46
    v_mov_b32 v49, v47
    s_nop 0
    v_permlane16_swap_b32 v46, v48
    v_permlane16_swap_b32 v47, v49
    v_pk_add_f32 v[46:47], v[46:47], v[48:49]
    v_mov_b32 v48, v46
    v_mov_b32 v49, v47
    s_nop 0
    v_permlane32_swap_b32 v46, v48
    v_permlane32_swap_b32 v47, v49
    v_pk_add_f32 v[46:47], v[46:47], v[48:49]
    ds_write_b64 v71, v[46:47] offset:1536
    s_waitcnt lgkmcnt(0)
    s_barrier
    s_cmp_ge_u32 s30, 4
    s_cbranch_scc1 LOADERS
    s_cmp_lg_u32 s30, 3
    s_cbranch_scc1 R_nl
    ds_read_b128 v[52:55], v72 offset:1536
    ds_read_b128 v[56:59], v72 offset:1552
    ds_read_b128 v[60:63], v72 offset:1568
    ds_read_b128 v[64:67], v72 offset:1584
    s_waitcnt lgkmcnt(0)
    v_pk_add_f32 v[52:53], v[52:53], v[54:55]
    v_pk_add_f32 v[56:57], v[56:57], v[58:59]
    v_pk_add_f32 v[60:61], v[60:61], v[62:63]
    v_pk_add_f32 v[64:65], v[64:65], v[66:67]
    v_pk_add_f32 v[52:53], v[52:53], v[56:57]
    v_pk_add_f32 v[60:61], v[60:61], v[64:65]
    v_pk_add_f32 v[52:53], v[52:53], v[60:61]
    v_mul_f32 v68, 0x3a800000, v52
    v_mul_f32 v70, 0x3a800000, v53
    v_fma_f32 v70, -v68, v68, v70
    v_max_f32 v70, 0, v70
    v_mov_b32 v32, v68
    v_mov_b32 v33, v70
    v_cvt_pk_bf16_f32 v68, v68, v68
    v_lshlrev_b32 v68, 16, v68
    v_cvt_pk_bf16_f32 v70, v70, v70
    v_lshlrev_b32 v70, 16, v70
    v_add_f32 v70, 0x3727c5ac, v70
    v_cvt_pk_bf16_f32 v70, v70, v70
    v_lshlrev_b32 v70, 16, v70
    v_sqrt_f32 v70, v70
    s_nop 0
    v_cvt_pk_bf16_f32 v70, v70, v70
    v_lshlrev_b32 v70, 16, v70
    v_rcp_f32 v69, v70
    v_sub_f32 v32, v32, v68
    v_mul_f32 v32, v32, v69
    v_mul_f32 v33, v33, v69
    v_mul_f32 v33, v33, v69
    v_cvt_pk_bf16_f32 v32, v32, v32
    v_lshlrev_b32 v32, 16, v32
    v_cvt_pk_bf16_f32 v33, v33, v33
    v_lshlrev_b32 v33, 16, v33
    v_add_f32 v33, 0x3727c5ac, v33
    v_cvt_pk_bf16_f32 v33, v33, v33
    v_lshlrev_b32 v33, 16, v33
    v_sqrt_f32 v33, v33
    s_nop 0
    v_cvt_pk_bf16_f32 v33, v33, v33
    v_lshlrev_b32 v33, 16, v33
    v_cvt_pk_bf16_f32 v28, v68, v70
    v_cvt_pk_bf16_f32 v30, v32, v33
    v_mov_b32 v29, s52
    v_mov_b32 v31, s52
    s_lshl_b32 s26, s60, 15
    s_add_u32 s26, s26, 23199744
    s_add_u32 s24, s4, s26
    s_addc_u32 s25, s5, 0
    s_mov_b32 s26, 32768
    s_mov_b32 s27, 0x20000
    s_lshl_b32 s36, s28, 4
    s_add_u32 s36, s36, s29
    s_lshl_b32 s36, s36, 7
    s_mov_b64 exec, 0xff
    buffer_store_dwordx4 v[28:31], v2, s[24:27], s36 offen sc1
    s_mov_b64 exec, -1
R_nl:
    v_mov_b32 v6, 1
    v_mov_b32 v7, 0
    s_cmp_eq_u32 s30, 3
    s_waitcnt vmcnt(1)
    s_cbranch_scc1 R_n2
    s_waitcnt vmcnt(0)
R_n2:
    s_barrier
    s_cmp_lg_u32 s30, 0
    s_cbranch_scc1 R_n3
    s_mov_b64 exec, 1
    buffer_atomic_add v6, v7, s[56:59], s55 offen sc1
    s_mov_b64 exec, -1
R_n3:
    s_cmp_lg_u32 s60, 0
    s_cbranch_scc1 R_n5
    ds_read_b64_tr_b16 v[180:181], v75 offset:49152
    ds_read_b64_tr_b16 v[182:183], v75 offset:51200
    ds_read_b64_tr_b16 v[188:189], v75 offset:53248
    ds_read_b64_tr_b16 v[190:191], v75 offset:55296
    ds_read_b64_tr_b16 v[196:197], v75 offset:57344
    ds_read_b64_tr_b16 v[198:199], v75 offset:59392
    ds_read_b64_tr_b16 v[204:205], v75 offset:61440
    ds_read_b64_tr_b16 v[206:207], v75 offset:63488
    ds_read_b64_tr_b16 v[244:245], v76 offset:16384
    ds_read_b64_tr_b16 v[246:247], v76 offset:18432
    ds_read_b64_tr_b16 v[252:253], v76 offset:20480
    ds_read_b64_tr_b16 v[254:255], v76 offset:22528
    ds_read_b64_tr_b16 v[212:213], v76 offset:0
    ds_read_b64_tr_b16 v[214:215], v76 offset:2048
    ds_read_b64_tr_b16 v[220:221], v76 offset:4096
    ds_read_b64_tr_b16 v[222:223], v76 offset:6144
    ds_read_b64_tr_b16 v[228:229], v76 offset:8192
    ds_read_b64_tr_b16 v[230:231], v76 offset:10240
    ds_read_b64_tr_b16 v[236:237], v76 offset:12288
    ds_read_b64_tr_b16 v[238:239], v76 offset:14336
    ds_read_b64_tr_b16 v[176:177], v74 offset:49152
    ds_read_b64_tr_b16 v[178:179], v74 offset:51200
    ds_read_b64_tr_b16 v[184:185], v74 offset:53248
    ds_read_b64_tr_b16 v[186:187], v74 offset:55296
    ds_read_b64_tr_b16 v[192:193], v74 offset:57344
    ds_read_b64_tr_b16 v[194:195], v74 offset:59392
    ds_read_b64_tr_b16 v[200:201], v74 offset:61440
    ds_read_b64_tr_b16 v[202:203], v74 offset:63488
    ds_read_b64_tr_b16 v[208:209], v75 offset:0
    ds_read_b64_tr_b16 v[210:211], v75 offset:2048
    ds_read_b64_tr_b16 v[216:217], v75 offset:4096
    ds_read_b64_tr_b16 v[218:219], v75 offset:6144
    ds_read_b64_tr_b16 v[224:225], v75 offset:8192
    ds_read_b64_tr_b16 v[226:227], v75 offset:10240
    ds_read_b64_tr_b16 v[232:233], v75 offset:12288
    ds_read_b64_tr_b16 v[234:235], v75 offset:14336
    ds_read_b64_tr_b16 v[128:129], v74 offset:24576
    ds_read_b64_tr_b16 v[130:131], v74 offset:26624
    ds_read_b64_tr_b16 v[136:137], v74 offset:28672
    ds_read_b64_tr_b16 v[138:139], v74 offset:30720
R_n5:
    v_and_b32 v8, 15, v1
    v_lshrrev_b32 v9, 4, v1
    v_xor_b32 v6, v9, v8
    v_lshlrev_b32 v7, 8, v8
    v_xor_b32 v10, 0, v6
    v_lshl_add_u32 v10, v10, 4, v7
    v_add_u32 v14, 106496, v10
    v_xor_b32 v11, 4, v6
    v_lshl_add_u32 v11, v11, 4, v7
    v_add_u32 v15, 106496, v11
    v_xor_b32 v12, 8, v6
    v_lshl_add_u32 v12, v12, 4, v7
    v_add_u32 v16, 106496, v12
    v_xor_b32 v13, 12, v6
    v_lshl_add_u32 v13, v13, 4, v7
    v_add_u32 v17, 106496, v13
    v_lshlrev_b32 v18, 4, v8
    v_add_u32 v18, 155648, v18
    s_add_u32 s16, s62, 0x400000
    s_addc_u32 s17, s63, 0
    s_mov_b32 s18, 0x7e000
    s_mov_b32 s19, 0x20000
    v_and_b32 v6, 1, v9
    v_lshlrev_b32 v114, 16, v6
    v_lshrrev_b32 v6, 1, v9
    v_lshl_add_u32 v114, v6, 8, v114
    v_lshl_add_u32 v114, v8, 4, v114
    s_bfe_u32 s36, s30, 0x10001
    s_lshl1_add_u32 s36, s29, s36
    s_xor_b32 s36, s36, 2
    s_lshr_b32 s53, s36, 3
    s_lshl_b32 s53, s53, 14
    s_and_b32 s39, s36, 7
    s_lshl_b32 s39, s39, 10
    s_add_u32 s39, s39, s53
    s_and_b32 s36, s30, 1
    s_lshl_b32 s36, s36, 9
    s_add_u32 s39, s39, s36
    s_and_b32 s12, s30, 3
    s_lshl_b32 s12, s12, 15
    s_add_u32 s53, s67, 0
    s_and_b32 s8, s53, 4
    s_and_b32 s53, s53, 2
    s_lshl_b32 s8, s8, 12
    s_lshl_b32 s53, s53, 11
    s_add_u32 s8, s8, s53
    s_add_u32 s8, s8, s12
    s_add_u32 s53, s67, 2
    s_and_b32 s9, s53, 4
    s_and_b32 s53, s53, 2
    s_lshl_b32 s9, s9, 12
    s_lshl_b32 s53, s53, 11
    s_add_u32 s9, s9, s53
    s_add_u32 s9, s9, s12
    s_add_u32 s53, s67, 4
    s_and_b32 s10, s53, 4
    s_and_b32 s53, s53, 2
    s_lshl_b32 s10, s10, 12
    s_lshl_b32 s53, s53, 11
    s_add_u32 s10, s10, s53
    s_add_u32 s10, s10, s12
    s_add_u32 s53, s67, 6
    s_and_b32 s11, s53, 4
    s_and_b32 s53, s53, 2
    s_lshl_b32 s11, s11, 12
    s_lshl_b32 s53, s53, 11
    s_add_u32 s11, s11, s53
    s_add_u32 s11, s11, s12
    s_and_b32 s53, s30, 2
    s_lshl_b32 s53, s53, 11
    s_and_b32 s12, s30, 1
    s_lshl_b32 s12, s12, 13
    s_add_u32 s12, s12, s53
    s_and_b32 s20, s30, 1
    s_lshl_b32 s20, s20, 8
    s_add_u32 s20, s20, s55
    s_add_u32 s21, s52, 16
    v_mov_b32 v112, 0x7f000000
    v_writelane_b32 v112, 0, 0
    v_mov_b32 v113, 1
    s_and_b32 s40, s30, 1
    s_lshl1_add_u32 s40, s31, s40
    s_lshl_b32 s40, s40, 7
    s_add_u32 s40, s40, s55
    s_barrier
    ds_read_b64_tr_b16 v[240:241], v75 offset:16384
    ds_read_b64_tr_b16 v[242:243], v75 offset:18432
    ds_read_b64_tr_b16 v[248:249], v75 offset:20480
    ds_read_b64_tr_b16 v[250:251], v75 offset:22528
    ds_read_b64_tr_b16 v[132:133], v75 offset:24576
    ds_read_b64_tr_b16 v[134:135], v75 offset:26624
    ds_read_b64_tr_b16 v[140:141], v75 offset:28672
    ds_read_b64_tr_b16 v[142:143], v75 offset:30720
    ds_read_b64_tr_b16 v[144:145], v74 offset:32768
    ds_read_b64_tr_b16 v[146:147], v74 offset:34816
    ds_read_b64_tr_b16 v[152:153], v74 offset:36864
    ds_read_b64_tr_b16 v[154:155], v74 offset:38912
    ds_read_b64_tr_b16 v[160:161], v74 offset:40960
    ds_read_b64_tr_b16 v[162:163], v74 offset:43008
    ds_read_b64_tr_b16 v[168:169], v74 offset:45056
    ds_read_b64_tr_b16 v[170:171], v74 offset:47104
    ds_read_b64_tr_b16 v[148:149], v75 offset:32768
    ds_read_b64_tr_b16 v[150:151], v75 offset:34816
    ds_read_b64_tr_b16 v[156:157], v75 offset:36864
    ds_read_b64_tr_b16 v[158:159], v75 offset:38912
    ds_read_b64_tr_b16 v[164:165], v75 offset:40960
    ds_read_b64_tr_b16 v[166:167], v75 offset:43008
    ds_read_b64_tr_b16 v[172:173], v75 offset:45056
    ds_read_b64_tr_b16 v[174:175], v75 offset:47104
    v_mov_b32 v88, 0x3f803f80
    v_mov_b32 v89, 0x3f803f80
    v_mov_b32 v90, 0x3f803f80
    v_mov_b32 v91, 0x3f803f80
    s_cmp_lg_u32 s30, 0
    s_cbranch_scc1 pdone_9
    s_add_u32 s54, s55, 0
    s_bitcmp1_b32 s29, 2
    s_cselect_b32 s53, s93, s92
    s_add_u32 s53, s53, s54
    v_mov_b32 v105, s54
    v_writelane_b32 v105, s53, 1
    s_mov_b32 s53, 0
    s_add_u32 s54, s52, 16
    s_bfm_b64 exec, 2, 0
poll_10:
    buffer_load_dword v104, v105, s[56:59], 0 offen sc1
    s_waitcnt vmcnt(0)
    v_cmp_eq_u32 vcc, s54, v104
    s_nop 0
    s_cmp_eq_u64 vcc, exec
    s_cbranch_scc1 pok_11
    s_sleep 3
    s_add_u32 s53, s53, 1
    s_cmp_lt_u32 s53, s61
    s_cbranch_scc1 poll_10
    s_mov_b32 s61, 0
pok_11:
    s_mov_b64 exec, -1
pdone_9:
    s_waitcnt lgkmcnt(0)
    s_barrier
    v_mfma_f32_16x16x32_bf16 v[84:87], v[128:131], v[88:91], 0
    v_mfma_f32_16x16x32_bf16 v[84:87], v[132:135], v[88:91], v[84:87]
    v_mfma_f32_16x16x32_bf16 v[84:87], v[136:139], v[88:91], v[84:87]
    v_mfma_f32_16x16x32_bf16 v[84:87], v[140:143], v[88:91], v[84:87]
    v_mfma_f32_16x16x32_bf16 v[84:87], v[144:147], v[88:91], v[84:87]
    v_mfma_f32_16x16x32_bf16 v[84:87], v[148:151], v[88:91], v[84:87]
    v_mfma_f32_16x16x32_bf16 v[84:87], v[152:155], v[88:91], v[84:87]
    v_mfma_f32_16x16x32_bf16 v[84:87], v[156:159], v[88:91], v[84:87]
    v_mfma_f32_16x16x32_bf16 v[84:87], v[160:163], v[88:91], v[84:87]
    v_mfma_f32_16x16x32_bf16 v[84:87], v[164:167], v[88:91], v[84:87]
    v_mfma_f32_16x16x32_bf16 v[84:87], v[168:171], v[88:91], v[84:87]
    v_mfma_f32_16x16x32_bf16 v[84:87], v[172:175], v[88:91], v[84:87]
    v_mfma_f32_16x16x32_bf16 v[84:87], v[176:179], v[88:91], v[84:87]
    v_mfma_f32_16x16x32_bf16 v[84:87], v[180:183], v[88:91], v[84:87]
    v_mfma_f32_16x16x32_bf16 v[84:87], v[184:187], v[88:91], v[84:87]
    v_mfma_f32_16x16x32_bf16 v[84:87], v[188:191], v[88:91], v[84:87]
    v_mfma_f32_16x16x32_bf16 v[84:87], v[192:195], v[88:91], v[84:87]
    v_mfma_f32_16x16x32_bf16 v[84:87], v[196:199], v[88:91], v[84:87]
    v_mfma_f32_16x16x32_bf16 v[84:87], v[200:203], v[88:91], v[84:87]
    v_mfma_f32_16x16x32_bf16 v[84:87], v[204:207], v[88:91], v[84:87]
    v_mfma_f32_16x16x32_bf16 v[84:87], v[208:211], v[88:91], v[84:87]
    v_mfma_f32_16x16x32_bf16 v[84:87], v[212:215], v[88:91], v[84:87]
    v_mfma_f32_16x16x32_bf16 v[84:87], v[216:219], v[88:91], v[84:87]
    v_mfma_f32_16x16x32_bf16 v[84:87], v[220:223], v[88:91], v[84:87]
    v_mfma_f32_16x16x32_bf16 v[84:87], v[224:227], v[88:91], v[84:87]
    v_mfma_f32_16x16x32_bf16 v[84:87], v[228:231], v[88:91], v[84:87]
    v_mfma_f32_16x16x32_bf16 v[84:87], v[232:235], v[88:91], v[84:87]
    v_mfma_f32_16x16x32_bf16 v[84:87], v[236:239], v[88:91], v[84:87]
    v_mfma_f32_16x16x32_bf16 v[84:87], v[240:243], v[88:91], v[84:87]
    v_mfma_f32_16x16x32_bf16 v[84:87], v[244:247], v[88:91], v[84:87]
    v_mfma_f32_16x16x32_bf16 v[84:87], v[248:251], v[88:91], v[84:87]
    v_mfma_f32_16x16x32_bf16 v[84:87], v[252:255], v[88:91], v[84:87]
    s_barrier
    ds_read_b128 v[36:39], v10 offset:16384
    ds_read_b128 v[40:43], v10 offset:20480
    ds_read_b128 v[44:47], v10 offset:24576
    ds_read_b128 v[48:51], v10 offset:28672
    ds_read_b128 v[52:55], v11 offset:16384
    ds_read_b128 v[56:59], v11 offset:20480
    ds_read_b128 v[60:63], v11 offset:24576
    ds_read_b128 v[64:67], v11 offset:28672
    s_waitcnt lgkmcnt(4)
    v_mfma_f32_16x16x32_bf16 v[20:23], v[128:131], v[36:39], 0
    ds_read_b128 v[68:71], v12 offset:16384
    v_mfma_f32_16x16x32_bf16 v[24:27], v[128:131], v[40:43], 0
    ds_read_b128 v[72:75], v12 offset:20480
    v_mfma_f32_16x16x32_bf16 v[24:27], v[132:135], v[48:51], v[24:27]
    ds_read_b128 v[76:79], v12 offset:24576
    v_mfma_f32_16x16x32_bf16 v[20:23], v[132:135], v[44:47], v[20:23]
    ds_read_b128 v[80:83], v12 offset:28672
    s_waitcnt lgkmcnt(4)
    v_mfma_f32_16x16x32_bf16 v[20:23], v[136:139], v[52:55], v[20:23]
    ds_read_b128 v[36:39], v13 offset:16384
    v_mfma_f32_16x16x32_bf16 v[24:27], v[136:139], v[56:59], v[24:27]
    ds_read_b128 v[40:43], v13 offset:20480
    v_mfma_f32_16x16x32_bf16 v[24:27], v[140:143], v[64:67], v[24:27]
    ds_read_b128 v[44:47], v13 offset:24576
    v_mfma_f32_16x16x32_bf16 v[20:23], v[140:143], v[60:63], v[20:23]
    ds_read_b128 v[48:51], v13 offset:28672
    s_barrier
    s_waitcnt lgkmcnt(4)
    v_mfma_f32_16x16x32_bf16 v[20:23], v[144:147], v[68:71], v[20:23]
    ds_read_b128 v[52:55], v10 offset:32768
    v_mfma_f32_16x16x32_bf16 v[24:27], v[144:147], v[72:75], v[24:27]
    ds_read_b128 v[56:59], v10 offset:36864
    v_mfma_f32_16x16x32_bf16 v[24:27], v[148:151], v[80:83], v[24:27]
    ds_read_b128 v[60:63], v10 offset:40960
    v_mfma_f32_16x16x32_bf16 v[20:23], v[148:151], v[76:79], v[20:23]
    ds_read_b128 v[64:67], v10 offset:45056
    s_waitcnt lgkmcnt(4)
    v_mfma_f32_16x16x32_bf16 v[20:23], v[152:155], v[36:39], v[20:23]
    ds_read_b128 v[68:71], v11 offset:32768
    v_mfma_f32_16x16x32_bf16 v[24:27], v[152:155], v[40:43], v[24:27]
    ds_read_b128 v[72:75], v11 offset:36864
    v_mfma_f32_16x16x32_bf16 v[24:27], v[156:159], v[48:51], v[24:27]
    ds_read_b128 v[76:79], v11 offset:40960
    v_mfma_f32_16x16x32_bf16 v[20:23], v[156:159], v[44:47], v[20:23]
    ds_read_b128 v[80:83], v11 offset:45056
    s_waitcnt lgkmcnt(4)
    v_mfma_f32_16x16x32_bf16 v[20:23], v[160:163], v[52:55], v[20:23]
    ds_read_b128 v[36:39], v12 offset:32768
    v_mfma_f32_16x16x32_bf16 v[24:27], v[160:163], v[56:59], v[24:27]
    ds_read_b128 v[40:43], v12 offset:36864
    v_mfma_f32_16x16x32_bf16 v[24:27], v[164:167], v[64:67], v[24:27]
    ds_read_b128 v[44:47], v12 offset:40960
    v_mfma_f32_16x16x32_bf16 v[20:23], v[164:167], v[60:63], v[20:23]
    ds_read_b128 v[48:51], v12 offset:45056
    s_waitcnt lgkmcnt(4)
    v_mfma_f32_16x16x32_bf16 v[20:23], v[168:171], v[68:71], v[20:23]
    ds_read_b128 v[52:55], v13 offset:32768
    v_mfma_f32_16x16x32_bf16 v[24:27], v[168:171], v[72:75], v[24:27]
    ds_read_b128 v[56:59], v13 offset:36864
    v_mfma_f32_16x16x32_bf16 v[24:27], v[172:175], v[80:83], v[24:27]
    ds_read_b128 v[60:63], v13 offset:40960
    v_mfma_f32_16x16x32_bf16 v[20:23], v[172:175], v[76:79], v[20:23]
    ds_read_b128 v[64:67], v13 offset:45056
    s_barrier
    s_waitcnt lgkmcnt(4)
    v_mfma_f32_16x16x32_bf16 v[20:23], v[176:179], v[36:39], v[20:23]
    ds_read_b128 v[68:71], v14 offset:0
    v_mfma_f32_16x16x32_bf16 v[24:27], v[176:179], v[40:43], v[24:27]
    ds_read_b128 v[72:75], v14 offset:4096
    v_mfma_f32_16x16x32_bf16 v[24:27], v[180:183], v[48:51], v[24:27]
    ds_read_b128 v[76:79], v14 offset:8192
    v_mfma_f32_16x16x32_bf16 v[20:23], v[180:183], v[44:47], v[20:23]
    ds_read_b128 v[80:83], v14 offset:12288
    s_waitcnt lgkmcnt(4)
    v_mfma_f32_16x16x32_bf16 v[20:23], v[184:187], v[52:55], v[20:23]
    ds_read_b128 v[36:39], v15 offset:0
    v_mfma_f32_16x16x32_bf16 v[24:27], v[184:187], v[56:59], v[24:27]
    ds_read_b128 v[40:43], v15 offset:4096
    v_mfma_f32_16x16x32_bf16 v[24:27], v[188:191], v[64:67], v[24:27]
    ds_read_b128 v[44:47], v15 offset:8192
    v_mfma_f32_16x16x32_bf16 v[20:23], v[188:191], v[60:63], v[20:23]
    ds_read_b128 v[48:51], v15 offset:12288
    s_waitcnt lgkmcnt(4)
    v_mfma_f32_16x16x32_bf16 v[20:23], v[192:195], v[68:71], v[20:23]
    ds_read_b128 v[52:55], v16 offset:0
    v_mfma_f32_16x16x32_bf16 v[24:27], v[192:195], v[72:75], v[24:27]
    ds_read_b128 v[56:59], v16 offset:4096
    v_mfma_f32_16x16x32_bf16 v[24:27], v[196:199], v[80:83], v[24:27]
    ds_read_b128 v[60:63], v16 offset:8192
    v_mfma_f32_16x16x32_bf16 v[20:23], v[196:199], v[76:79], v[20:23]
    ds_read_b128 v[64:67], v16 offset:12288
    s_waitcnt lgkmcnt(4)
    v_mfma_f32_16x16x32_bf16 v[20:23], v[200:203], v[36:39], v[20:23]
    ds_read_b128 v[68:71], v17 offset:0
    v_mfma_f32_16x16x32_bf16 v[24:27], v[200:203], v[40:43], v[24:27]
    ds_read_b128 v[72:75], v17 offset:4096
    v_mfma_f32_16x16x32_bf16 v[24:27], v[204:207], v[48:51], v[24:27]
    ds_read_b128 v[76:79], v17 offset:8192
    v_mfma_f32_16x16x32_bf16 v[20:23], v[204:207], v[44:47], v[20:23]
    ds_read_b128 v[80:83], v17 offset:12288
    s_barrier
    s_waitcnt lgkmcnt(4)
    v_mfma_f32_16x16x32_bf16 v[20:23], v[208:211], v[52:55], v[20:23]
    ds_read_b128 v[36:39], v14 offset:16384
    v_mfma_f32_16x16x32_bf16 v[24:27], v[208:211], v[56:59], v[24:27]
    ds_read_b128 v[40:43], v14 offset:20480
    v_mfma_f32_16x16x32_bf16 v[24:27], v[212:215], v[64:67], v[24:27]
    ds_read_b128 v[44:47], v14 offset:24576
    v_mfma_f32_16x16x32_bf16 v[20:23], v[212:215], v[60:63], v[20:23]
    ds_read_b128 v[48:51], v14 offset:28672
    s_waitcnt lgkmcnt(4)
    v_mfma_f32_16x16x32_bf16 v[20:23], v[216:219], v[68:71], v[20:23]
    ds_read_b128 v[52:55], v15 offset:16384
    v_mfma_f32_16x16x32_bf16 v[24:27], v[216:219], v[72:75], v[24:27]
    ds_read_b128 v[56:59], v15 offset:20480
    v_mfma_f32_16x16x32_bf16 v[24:27], v[220:223], v[80:83], v[24:27]
    ds_read_b128 v[60:63], v15 offset:24576
    v_mfma_f32_16x16x32_bf16 v[20:23], v[220:223], v[76:79], v[20:23]
    ds_read_b128 v[64:67], v15 offset:28672
    s_waitcnt lgkmcnt(4)
    v_mfma_f32_16x16x32_bf16 v[20:23], v[224:227], v[36:39], v[20:23]
    ds_read_b128 v[68:71], v16 offset:16384
    v_mfma_f32_16x16x32_bf16 v[24:27], v[224:227], v[40:43], v[24:27]
    ds_read_b128 v[72:75], v16 offset:20480
    v_mfma_f32_16x16x32_bf16 v[24:27], v[228:231], v[48:51], v[24:27]
    ds_read_b128 v[76:79], v16 offset:24576
    v_mfma_f32_16x16x32_bf16 v[20:23], v[228:231], v[44:47], v[20:23]
    ds_read_b128 v[80:83], v16 offset:28672
    s_waitcnt lgkmcnt(4)
    v_mfma_f32_16x16x32_bf16 v[20:23], v[232:235], v[52:55], v[20:23]
    ds_read_b128 v[36:39], v17 offset:16384
    v_mfma_f32_16x16x32_bf16 v[24:27], v[232:235], v[56:59], v[24:27]
    ds_read_b128 v[40:43], v17 offset:20480
    v_mfma_f32_16x16x32_bf16 v[24:27], v[236:239], v[64:67], v[24:27]
    ds_read_b128 v[44:47], v17 offset:24576
    v_mfma_f32_16x16x32_bf16 v[20:23], v[236:239], v[60:63], v[20:23]
    ds_read_b128 v[48:51], v17 offset:28672
    s_barrier
    ds_read_b128 v[88:91], v18 offset:0
    ds_read_b128 v[92:95], v18 offset:2048
    ds_read_b128 v[96:99], v18 offset:256
    ds_read_b128 v[100:103], v18 offset:2304
    s_waitcnt lgkmcnt(8)
    v_mfma_f32_16x16x32_bf16 v[20:23], v[240:243], v[68:71], v[20:23]
    ds_read_b128 v[52:55], v14 offset:32768
    v_mfma_f32_16x16x32_bf16 v[24:27], v[240:243], v[72:75], v[24:27]
    ds_read_b128 v[56:59], v14 offset:36864
    v_mfma_f32_16x16x32_bf16 v[24:27], v[244:247], v[80:83], v[24:27]
    ds_read_b128 v[60:63], v14 offset:40960
    v_mfma_f32_16x16x32_bf16 v[20:23], v[244:247], v[76:79], v[20:23]
    ds_read_b128 v[64:67], v14 offset:45056
    s_waitcnt lgkmcnt(8)
    v_mfma_f32_16x16x32_bf16 v[20:23], v[248:251], v[36:39], v[20:23]
    ds_read_b128 v[68:71], v15 offset:32768
    v_mfma_f32_16x16x32_bf16 v[24:27], v[248:251], v[40:43], v[24:27]
    ds_read_b128 v[72:75], v15 offset:36864
    v_mfma_f32_16x16x32_bf16 v[24:27], v[252:255], v[48:51], v[24:27]
    ds_read_b128 v[76:79], v15 offset:40960
    v_mfma_f32_16x16x32_bf16 v[20:23], v[252:255], v[44:47], v[20:23]
    ds_read_b128 v[80:83], v15 offset:45056
    s_waitcnt lgkmcnt(4)
    v_mfma_f32_16x16x32_bf16 v[28:31], v[128:131], v[52:55], 0
    ds_read_b128 v[36:39], v16 offset:32768
    v_mfma_f32_16x16x32_bf16 v[32:35], v[128:131], v[56:59], 0
    ds_read_b128 v[40:43], v16 offset:36864
    v_mfma_f32_16x16x32_bf16 v[32:35], v[132:135], v[64:67], v[32:35]
    ds_read_b128 v[44:47], v16 offset:40960
    v_mfma_f32_16x16x32_bf16 v[28:31], v[132:135], v[60:63], v[28:31]
    ds_read_b128 v[48:51], v16 offset:45056
    v_pk_fma_f32 v[20:21], v[88:89], v[84:85], v[20:21]
    v_pk_fma_f32 v[22:23], v[88:89], v[86:87], v[22:23]
    v_pk_fma_f32 v[24:25], v[96:97], v[84:85], v[24:25]
    v_pk_fma_f32 v[26:27], v[96:97], v[86:87], v[26:27]
    v_pk_mul_f32 v[104:105], v[20:21], v[20:21]
    v_pk_mul_f32 v[106:107], v[22:23], v[22:23]
    v_pk_mul_f32 v[108:109], v[24:25], v[24:25]
    v_pk_mul_f32 v[110:111], v[26:27], v[26:27]
    v_pk_fma_f32 v[104:105], v[104:105], v[92:93], v[90:91]
    v_pk_fma_f32 v[106:107], v[106:107], v[92:93], v[90:91]
    v_pk_fma_f32 v[108:109], v[108:109], v[100:101], v[98:99]
    v_pk_fma_f32 v[110:111], v[110:111], v[100:101], v[98:99]
    v_pk_mul_f32 v[104:105], v[104:105], v[20:21]
    v_pk_mul_f32 v[106:107], v[106:107], v[22:23]
    v_pk_mul_f32 v[108:109], v[108:109], v[24:25]
    v_pk_mul_f32 v[110:111], v[110:111], v[26:27]
    v_exp_f32 v104, v104
    v_exp_f32 v105, v105
    v_exp_f32 v106, v106
    v_exp_f32 v107, v107
    v_exp_f32 v108, v108
    v_exp_f32 v109, v109
    v_exp_f32 v110, v110
    v_exp_f32 v111, v111
    v_pk_fma_f32 v[104:105], v[104:105], v[94:95], v[94:95]
    v_pk_fma_f32 v[106:107], v[106:107], v[94:95], v[94:95]
    v_pk_fma_f32 v[108:109], v[108:109], v[102:103], v[102:103]
    v_pk_fma_f32 v[110:111], v[110:111], v[102:103], v[102:103]
    v_rcp_f32 v104, v104
    v_rcp_f32 v105, v105
    v_rcp_f32 v106, v106
    v_rcp_f32 v107, v107
    v_rcp_f32 v108, v108
    v_rcp_f32 v109, v109
    v_rcp_f32 v110, v110
    v_rcp_f32 v111, v111
    v_pk_mul_f32 v[20:21], v[20:21], v[104:105]
    v_pk_mul_f32 v[22:23], v[22:23], v[106:107]
    v_pk_mul_f32 v[24:25], v[24:25], v[108:109]
    v_pk_mul_f32 v[26:27], v[26:27], v[110:111]
    v_add_u32 v20, 0x10000, v20
    v_add_u32 v22, 0x10000, v22
    v_add_u32 v24, 0x10000, v24
    v_add_u32 v26, 0x10000, v26
    v_and_b32 v20, 0xfffe0000, v20
    v_and_b32 v22, 0xfffe0000, v22
    v_and_b32 v24, 0xfffe0000, v24
    v_and_b32 v26, 0xfffe0000, v26
    v_cvt_pk_bf16_f32 v104, v20, v21
    v_cvt_pk_bf16_f32 v105, v22, v23
    v_cvt_pk_bf16_f32 v106, v24, v25
    v_cvt_pk_bf16_f32 v107, v26, v27
    s_add_u32 s36, s39, 0
    v_permlane16_swap_b32 v104, v106
    v_permlane16_swap_b32 v105, v107
    buffer_store_dwordx4 v[104:107], v114, s[16:19], s36 offen sc1
    s_waitcnt lgkmcnt(4)
    v_mfma_f32_16x16x32_bf16 v[28:31], v[136:139], v[68:71], v[28:31]
    ds_read_b128 v[52:55], v17 offset:32768
    v_mfma_f32_16x16x32_bf16 v[32:35], v[136:139], v[72:75], v[32:35]
    ds_read_b128 v[56:59], v17 offset:36864
    v_mfma_f32_16x16x32_bf16 v[32:35], v[140:143], v[80:83], v[32:35]
    ds_read_b128 v[60:63], v17 offset:40960
    v_mfma_f32_16x16x32_bf16 v[28:31], v[140:143], v[76:79], v[28:31]
    ds_read_b128 v[64:67], v17 offset:45056
    s_barrier
    s_waitcnt lgkmcnt(4)
    v_mfma_f32_16x16x32_bf16 v[28:31], v[144:147], v[36:39], v[28:31]
    ds_read_b128 v[68:71], v10 offset:16384
    v_mfma_f32_16x16x32_bf16 v[32:35], v[144:147], v[40:43], v[32:35]
    ds_read_b128 v[72:75], v10 offset:20480
    v_mfma_f32_16x16x32_bf16 v[32:35], v[148:151], v[48:51], v[32:35]
    ds_read_b128 v[76:79], v10 offset:24576
    v_mfma_f32_16x16x32_bf16 v[28:31], v[148:151], v[44:47], v[28:31]
    ds_read_b128 v[80:83], v10 offset:28672
    s_waitcnt lgkmcnt(4)
    v_mfma_f32_16x16x32_bf16 v[28:31], v[152:155], v[52:55], v[28:31]
    ds_read_b128 v[36:39], v11 offset:16384
    v_mfma_f32_16x16x32_bf16 v[32:35], v[152:155], v[56:59], v[32:35]
    ds_read_b128 v[40:43], v11 offset:20480
    v_mfma_f32_16x16x32_bf16 v[32:35], v[156:159], v[64:67], v[32:35]
    ds_read_b128 v[44:47], v11 offset:24576
    v_mfma_f32_16x16x32_bf16 v[28:31], v[156:159], v[60:63], v[28:31]
    ds_read_b128 v[48:51], v11 offset:28672
    s_waitcnt lgkmcnt(4)
    v_mfma_f32_16x16x32_bf16 v[28:31], v[160:163], v[68:71], v[28:31]
    ds_read_b128 v[52:55], v12 offset:16384
    v_mfma_f32_16x16x32_bf16 v[32:35], v[160:163], v[72:75], v[32:35]
    ds_read_b128 v[56:59], v12 offset:20480
    v_mfma_f32_16x16x32_bf16 v[32:35], v[164:167], v[80:83], v[32:35]
    ds_read_b128 v[60:63], v12 offset:24576
    v_mfma_f32_16x16x32_bf16 v[28:31], v[164:167], v[76:79], v[28:31]
    ds_read_b128 v[64:67], v12 offset:28672
    s_waitcnt lgkmcnt(4)
    v_mfma_f32_16x16x32_bf16 v[28:31], v[168:171], v[36:39], v[28:31]
    ds_read_b128 v[68:71], v13 offset:16384
    v_mfma_f32_16x16x32_bf16 v[32:35], v[168:171], v[40:43], v[32:35]
    ds_read_b128 v[72:75], v13 offset:20480
    v_mfma_f32_16x16x32_bf16 v[32:35], v[172:175], v[48:51], v[32:35]
    ds_read_b128 v[76:79], v13 offset:24576
    v_mfma_f32_16x16x32_bf16 v[28:31], v[172:175], v[44:47], v[28:31]
    ds_read_b128 v[80:83], v13 offset:28672
    s_barrier
    s_waitcnt lgkmcnt(4)
    v_mfma_f32_16x16x32_bf16 v[28:31], v[176:179], v[52:55], v[28:31]
    ds_read_b128 v[36:39], v10 offset:32768
    v_mfma_f32_16x16x32_bf16 v[32:35], v[176:179], v[56:59], v[32:35]
    ds_read_b128 v[40:43], v10 offset:36864
    v_mfma_f32_16x16x32_bf16 v[32:35], v[180:183], v[64:67], v[32:35]
    ds_read_b128 v[44:47], v10 offset:40960
    v_mfma_f32_16x16x32_bf16 v[28:31], v[180:183], v[60:63], v[28:31]
    ds_read_b128 v[48:51], v10 offset:45056
    s_waitcnt lgkmcnt(4)
    v_mfma_f32_16x16x32_bf16 v[28:31], v[184:187], v[68:71], v[28:31]
    ds_read_b128 v[52:55], v11 offset:32768
    v_mfma_f32_16x16x32_bf16 v[32:35], v[184:187], v[72:75], v[32:35]
    ds_read_b128 v[56:59], v11 offset:36864
    v_mfma_f32_16x16x32_bf16 v[32:35], v[188:191], v[80:83], v[32:35]
    ds_read_b128 v[60:63], v11 offset:40960
    v_mfma_f32_16x16x32_bf16 v[28:31], v[188:191], v[76:79], v[28:31]
    ds_read_b128 v[64:67], v11 offset:45056
    s_waitcnt lgkmcnt(4)
    v_mfma_f32_16x16x32_bf16 v[28:31], v[192:195], v[36:39], v[28:31]
    ds_read_b128 v[68:71], v12 offset:32768
    v_mfma_f32_16x16x32_bf16 v[32:35], v[192:195], v[40:43], v[32:35]
    ds_read_b128 v[72:75], v12 offset:36864
    v_mfma_f32_16x16x32_bf16 v[32:35], v[196:199], v[48:51], v[32:35]
    ds_read_b128 v[76:79], v12 offset:40960
    v_mfma_f32_16x16x32_bf16 v[28:31], v[196:199], v[44:47], v[28:31]
    ds_read_b128 v[80:83], v12 offset:45056
    s_waitcnt lgkmcnt(4)
    v_mfma_f32_16x16x32_bf16 v[28:31], v[200:203], v[52:55], v[28:31]
    ds_read_b128 v[36:39], v13 offset:32768
    v_mfma_f32_16x16x32_bf16 v[32:35], v[200:203], v[56:59], v[32:35]
    ds_read_b128 v[40:43], v13 offset:36864
    v_mfma_f32_16x16x32_bf16 v[32:35], v[204:207], v[64:67], v[32:35]
    ds_read_b128 v[44:47], v13 offset:40960
    v_mfma_f32_16x16x32_bf16 v[28:31], v[204:207], v[60:63], v[28:31]
    ds_read_b128 v[48:51], v13 offset:45056
    s_barrier
    s_waitcnt lgkmcnt(4)
    v_mfma_f32_16x16x32_bf16 v[28:31], v[208:211], v[68:71], v[28:31]
    ds_read_b128 v[52:55], v14 offset:0
    v_mfma_f32_16x16x32_bf16 v[32:35], v[208:211], v[72:75], v[32:35]
    ds_read_b128 v[56:59], v14 offset:4096
    v_mfma_f32_16x16x32_bf16 v[32:35], v[212:215], v[80:83], v[32:35]
    ds_read_b128 v[60:63], v14 offset:8192
    v_mfma_f32_16x16x32_bf16 v[28:31], v[212:215], v[76:79], v[28:31]
    ds_read_b128 v[64:67], v14 offset:12288
    s_waitcnt lgkmcnt(4)
    v_mfma_f32_16x16x32_bf16 v[28:31], v[216:219], v[36:39], v[28:31]
    ds_read_b128 v[68:71], v15 offset:0
    v_mfma_f32_16x16x32_bf16 v[32:35], v[216:219], v[40:43], v[32:35]
    ds_read_b128 v[72:75], v15 offset:4096
    v_mfma_f32_16x16x32_bf16 v[32:35], v[220:223], v[48:51], v[32:35]
    ds_read_b128 v[76:79], v15 offset:8192
    v_mfma_f32_16x16x32_bf16 v[28:31], v[220:223], v[44:47], v[28:31]
    ds_read_b128 v[80:83], v15 offset:12288
    s_waitcnt lgkmcnt(4)
    v_mfma_f32_16x16x32_bf16 v[28:31], v[224:227], v[52:55], v[28:31]
    ds_read_b128 v[36:39], v16 offset:0
    v_mfma_f32_16x16x32_bf16 v[32:35], v[224:227], v[56:59], v[32:35]
    ds_read_b128 v[40:43], v16 offset:4096
    v_mfma_f32_16x16x32_bf16 v[32:35], v[228:231], v[64:67], v[32:35]
    ds_read_b128 v[44:47], v16 offset:8192
    v_mfma_f32_16x16x32_bf16 v[28:31], v[228:231], v[60:63], v[28:31]
    ds_read_b128 v[48:51], v16 offset:12288
    s_waitcnt lgkmcnt(4)
    v_mfma_f32_16x16x32_bf16 v[28:31], v[232:235], v[68:71], v[28:31]
    ds_read_b128 v[52:55], v17 offset:0
    v_mfma_f32_16x16x32_bf16 v[32:35], v[232:235], v[72:75], v[32:35]
    ds_read_b128 v[56:59], v17 offset:4096
    v_mfma_f32_16x16x32_bf16 v[32:35], v[236:239], v[80:83], v[32:35]
    ds_read_b128 v[60:63], v17 offset:8192
    v_mfma_f32_16x16x32_bf16 v[28:31], v[236:239], v[76:79], v[28:31]
    ds_read_b128 v[64:67], v17 offset:12288
    s_barrier
    ds_read_b128 v[88:91], v18 offset:512
    ds_read_b128 v[92:95], v18 offset:2560
    ds_read_b128 v[96:99], v18 offset:768
    ds_read_b128 v[100:103], v18 offset:2816
    s_waitcnt vmcnt(0)
    buffer_atomic_add v113, v112, s[56:59], s40 offen offset:2048 sc1
    s_waitcnt lgkmcnt(8)
    v_mfma_f32_16x16x32_bf16 v[28:31], v[240:243], v[36:39], v[28:31]
    ds_read_b128 v[68:71], v14 offset:16384
    v_mfma_f32_16x16x32_bf16 v[32:35], v[240:243], v[40:43], v[32:35]
    ds_read_b128 v[72:75], v14 offset:20480
    v_mfma_f32_16x16x32_bf16 v[32:35], v[244:247], v[48:51], v[32:35]
    ds_read_b128 v[76:79], v14 offset:24576
    v_mfma_f32_16x16x32_bf16 v[28:31], v[244:247], v[44:47], v[28:31]
    ds_read_b128 v[80:83], v14 offset:28672
    s_waitcnt lgkmcnt(8)
    v_mfma_f32_16x16x32_bf16 v[28:31], v[248:251], v[52:55], v[28:31]
    ds_read_b128 v[36:39], v15 offset:16384
    v_mfma_f32_16x16x32_bf16 v[32:35], v[248:251], v[56:59], v[32:35]
    ds_read_b128 v[40:43], v15 offset:20480
    v_mfma_f32_16x16x32_bf16 v[32:35], v[252:255], v[64:67], v[32:35]
    ds_read_b128 v[44:47], v15 offset:24576
    v_mfma_f32_16x16x32_bf16 v[28:31], v[252:255], v[60:63], v[28:31]
    ds_read_b128 v[48:51], v15 offset:28672
    s_waitcnt lgkmcnt(4)
    v_mfma_f32_16x16x32_bf16 v[20:23], v[128:131], v[68:71], 0
    ds_read_b128 v[52:55], v16 offset:16384
    v_mfma_f32_16x16x32_bf16 v[24:27], v[128:131], v[72:75], 0
    ds_read_b128 v[56:59], v16 offset:20480
    v_mfma_f32_16x16x32_bf16 v[24:27], v[132:135], v[80:83], v[24:27]
    ds_read_b128 v[60:63], v16 offset:24576
    v_mfma_f32_16x16x32_bf16 v[20:23], v[132:135], v[76:79], v[20:23]
    ds_read_b128 v[64:67], v16 offset:28672
    v_pk_fma_f32 v[28:29], v[88:89], v[84:85], v[28:29]
    v_pk_fma_f32 v[30:31], v[88:89], v[86:87], v[30:31]
    v_pk_fma_f32 v[32:33], v[96:97], v[84:85], v[32:33]
    v_pk_fma_f32 v[34:35], v[96:97], v[86:87], v[34:35]
    v_pk_mul_f32 v[104:105], v[28:29], v[28:29]
    v_pk_mul_f32 v[106:107], v[30:31], v[30:31]
    v_pk_mul_f32 v[108:109], v[32:33], v[32:33]
    v_pk_mul_f32 v[110:111], v[34:35], v[34:35]
    v_pk_fma_f32 v[104:105], v[104:105], v[92:93], v[90:91]
    v_pk_fma_f32 v[106:107], v[106:107], v[92:93], v[90:91]
    v_pk_fma_f32 v[108:109], v[108:109], v[100:101], v[98:99]
    v_pk_fma_f32 v[110:111], v[110:111], v[100:101], v[98:99]
    v_pk_mul_f32 v[104:105], v[104:105], v[28:29]
    v_pk_mul_f32 v[106:107], v[106:107], v[30:31]
    v_pk_mul_f32 v[108:109], v[108:109], v[32:33]
    v_pk_mul_f32 v[110:111], v[110:111], v[34:35]
    v_exp_f32 v104, v104
    v_exp_f32 v105, v105
    v_exp_f32 v106, v106
    v_exp_f32 v107, v107
    v_exp_f32 v108, v108
    v_exp_f32 v109, v109
    v_exp_f32 v110, v110
    v_exp_f32 v111, v111
    v_pk_fma_f32 v[104:105], v[104:105], v[94:95], v[94:95]
    v_pk_fma_f32 v[106:107], v[106:107], v[94:95], v[94:95]
    v_pk_fma_f32 v[108:109], v[108:109], v[102:103], v[102:103]
    v_pk_fma_f32 v[110:111], v[110:111], v[102:103], v[102:103]
    v_rcp_f32 v104, v104
    v_rcp_f32 v105, v105
    v_rcp_f32 v106, v106
    v_rcp_f32 v107, v107
    v_rcp_f32 v108, v108
    v_rcp_f32 v109, v109
    v_rcp_f32 v110, v110
    v_rcp_f32 v111, v111
    v_pk_mul_f32 v[28:29], v[28:29], v[104:105]
    v_pk_mul_f32 v[30:31], v[30:31], v[106:107]
    v_pk_mul_f32 v[32:33], v[32:33], v[108:109]
    v_pk_mul_f32 v[34:35], v[34:35], v[110:111]
    v_add_u32 v28, 0x10000, v28
    v_add_u32 v30, 0x10000, v30
    v_add_u32 v32, 0x10000, v32
    v_add_u32 v34, 0x10000, v34
    v_and_b32 v28, 0xfffe0000, v28
    v_and_b32 v30, 0xfffe0000, v30
    v_and_b32 v32, 0xfffe0000, v32
    v_and_b32 v34, 0xfffe0000, v34
    v_cvt_pk_bf16_f32 v104, v28, v29
    v_cvt_pk_bf16_f32 v105, v30, v31
    v_cvt_pk_bf16_f32 v106, v32, v33
    v_cvt_pk_bf16_f32 v107, v34, v35
    s_add_u32 s36, s39, 131072
    v_permlane16_swap_b32 v104, v106
    v_permlane16_swap_b32 v105, v107
    buffer_store_dwordx4 v[104:107], v114, s[16:19], s36 offen sc1
    s_waitcnt lgkmcnt(4)
    v_mfma_f32_16x16x32_bf16 v[20:23], v[136:139], v[36:39], v[20:23]
    ds_read_b128 v[68:71], v17 offset:16384
    v_mfma_f32_16x16x32_bf16 v[24:27], v[136:139], v[40:43], v[24:27]
    ds_read_b128 v[72:75], v17 offset:20480
    v_mfma_f32_16x16x32_bf16 v[24:27], v[140:143], v[48:51], v[24:27]
    ds_read_b128 v[76:79], v17 offset:24576
    v_mfma_f32_16x16x32_bf16 v[20:23], v[140:143], v[44:47], v[20:23]
    ds_read_b128 v[80:83], v17 offset:28672
    s_barrier
    s_waitcnt lgkmcnt(4)
    v_mfma_f32_16x16x32_bf16 v[20:23], v[144:147], v[52:55], v[20:23]
    ds_read_b128 v[36:39], v14 offset:32768
    v_mfma_f32_16x16x32_bf16 v[24:27], v[144:147], v[56:59], v[24:27]
    ds_read_b128 v[40:43], v14 offset:36864
    v_mfma_f32_16x16x32_bf16 v[24:27], v[148:151], v[64:67], v[24:27]
    ds_read_b128 v[44:47], v14 offset:40960
    v_mfma_f32_16x16x32_bf16 v[20:23], v[148:151], v[60:63], v[20:23]
    ds_read_b128 v[48:51], v14 offset:45056
    s_waitcnt lgkmcnt(4)
    v_mfma_f32_16x16x32_bf16 v[20:23], v[152:155], v[68:71], v[20:23]
    ds_read_b128 v[52:55], v15 offset:32768
    v_mfma_f32_16x16x32_bf16 v[24:27], v[152:155], v[72:75], v[24:27]
    ds_read_b128 v[56:59], v15 offset:36864
    v_mfma_f32_16x16x32_bf16 v[24:27], v[156:159], v[80:83], v[24:27]
    ds_read_b128 v[60:63], v15 offset:40960
    v_mfma_f32_16x16x32_bf16 v[20:23], v[156:159], v[76:79], v[20:23]
    ds_read_b128 v[64:67], v15 offset:45056
    s_waitcnt lgkmcnt(4)
    v_mfma_f32_16x16x32_bf16 v[20:23], v[160:163], v[36:39], v[20:23]
    ds_read_b128 v[68:71], v16 offset:32768
    v_mfma_f32_16x16x32_bf16 v[24:27], v[160:163], v[40:43], v[24:27]
    ds_read_b128 v[72:75], v16 offset:36864
    v_mfma_f32_16x16x32_bf16 v[24:27], v[164:167], v[48:51], v[24:27]
    ds_read_b128 v[76:79], v16 offset:40960
    v_mfma_f32_16x16x32_bf16 v[20:23], v[164:167], v[44:47], v[20:23]
    ds_read_b128 v[80:83], v16 offset:45056
    s_waitcnt lgkmcnt(4)
    v_mfma_f32_16x16x32_bf16 v[20:23], v[168:171], v[52:55], v[20:23]
    ds_read_b128 v[36:39], v17 offset:32768
    v_mfma_f32_16x16x32_bf16 v[24:27], v[168:171], v[56:59], v[24:27]
    ds_read_b128 v[40:43], v17 offset:36864
    v_mfma_f32_16x16x32_bf16 v[24:27], v[172:175], v[64:67], v[24:27]
    ds_read_b128 v[44:47], v17 offset:40960
    v_mfma_f32_16x16x32_bf16 v[20:23], v[172:175], v[60:63], v[20:23]
    ds_read_b128 v[48:51], v17 offset:45056
    s_barrier
    s_waitcnt lgkmcnt(4)
    v_mfma_f32_16x16x32_bf16 v[20:23], v[176:179], v[68:71], v[20:23]
    ds_read_b128 v[52:55], v10 offset:16384
    v_mfma_f32_16x16x32_bf16 v[24:27], v[176:179], v[72:75], v[24:27]
    ds_read_b128 v[56:59], v10 offset:20480
    v_mfma_f32_16x16x32_bf16 v[24:27], v[180:183], v[80:83], v[24:27]
    ds_read_b128 v[60:63], v10 offset:24576
    v_mfma_f32_16x16x32_bf16 v[20:23], v[180:183], v[76:79], v[20:23]
    ds_read_b128 v[64:67], v10 offset:28672
    s_waitcnt lgkmcnt(4)
    v_mfma_f32_16x16x32_bf16 v[20:23], v[184:187], v[36:39], v[20:23]
    ds_read_b128 v[68:71], v11 offset:16384
    v_mfma_f32_16x16x32_bf16 v[24:27], v[184:187], v[40:43], v[24:27]
    ds_read_b128 v[72:75], v11 offset:20480
    v_mfma_f32_16x16x32_bf16 v[24:27], v[188:191], v[48:51], v[24:27]
    ds_read_b128 v[76:79], v11 offset:24576
    v_mfma_f32_16x16x32_bf16 v[20:23], v[188:191], v[44:47], v[20:23]
    ds_read_b128 v[80:83], v11 offset:28672
    s_waitcnt lgkmcnt(4)
    v_mfma_f32_16x16x32_bf16 v[20:23], v[192:195], v[52:55], v[20:23]
    ds_read_b128 v[36:39], v12 offset:16384
    v_mfma_f32_16x16x32_bf16 v[24:27], v[192:195], v[56:59], v[24:27]
    ds_read_b128 v[40:43], v12 offset:20480
    v_mfma_f32_16x16x32_bf16 v[24:27], v[196:199], v[64:67], v[24:27]
    ds_read_b128 v[44:47], v12 offset:24576
    v_mfma_f32_16x16x32_bf16 v[20:23], v[196:199], v[60:63], v[20:23]
    ds_read_b128 v[48:51], v12 offset:28672
    s_waitcnt lgkmcnt(4)
    v_mfma_f32_16x16x32_bf16 v[20:23], v[200:203], v[68:71], v[20:23]
    ds_read_b128 v[52:55], v13 offset:16384
    v_mfma_f32_16x16x32_bf16 v[24:27], v[200:203], v[72:75], v[24:27]
    ds_read_b128 v[56:59], v13 offset:20480
    v_mfma_f32_16x16x32_bf16 v[24:27], v[204:207], v[80:83], v[24:27]
    ds_read_b128 v[60:63], v13 offset:24576
    v_mfma_f32_16x16x32_bf16 v[20:23], v[204:207], v[76:79], v[20:23]
    ds_read_b128 v[64:67], v13 offset:28672
    s_barrier
    s_waitcnt lgkmcnt(4)
    v_mfma_f32_16x16x32_bf16 v[20:23], v[208:211], v[36:39], v[20:23]
    ds_read_b128 v[68:71], v10 offset:32768
    v_mfma_f32_16x16x32_bf16 v[24:27], v[208:211], v[40:43], v[24:27]
    ds_read_b128 v[72:75], v10 offset:36864
    v_mfma_f32_16x16x32_bf16 v[24:27], v[212:215], v[48:51], v[24:27]
    ds_read_b128 v[76:79], v10 offset:40960
    v_mfma_f32_16x16x32_bf16 v[20:23], v[212:215], v[44:47], v[20:23]
    ds_read_b128 v[80:83], v10 offset:45056
    s_waitcnt lgkmcnt(4)
    v_mfma_f32_16x16x32_bf16 v[20:23], v[216:219], v[52:55], v[20:23]
    ds_read_b128 v[36:39], v11 offset:32768
    v_mfma_f32_16x16x32_bf16 v[24:27], v[216:219], v[56:59], v[24:27]
    ds_read_b128 v[40:43], v11 offset:36864
    v_mfma_f32_16x16x32_bf16 v[24:27], v[220:223], v[64:67], v[24:27]
    ds_read_b128 v[44:47], v11 offset:40960
    v_mfma_f32_16x16x32_bf16 v[20:23], v[220:223], v[60:63], v[20:23]
    ds_read_b128 v[48:51], v11 offset:45056
    s_waitcnt lgkmcnt(4)
    v_mfma_f32_16x16x32_bf16 v[20:23], v[224:227], v[68:71], v[20:23]
    ds_read_b128 v[52:55], v12 offset:32768
    v_mfma_f32_16x16x32_bf16 v[24:27], v[224:227], v[72:75], v[24:27]
    ds_read_b128 v[56:59], v12 offset:36864
    v_mfma_f32_16x16x32_bf16 v[24:27], v[228:231], v[80:83], v[24:27]
    ds_read_b128 v[60:63], v12 offset:40960
    v_mfma_f32_16x16x32_bf16 v[20:23], v[228:231], v[76:79], v[20:23]
    ds_read_b128 v[64:67], v12 offset:45056
    s_waitcnt lgkmcnt(4)
    v_mfma_f32_16x16x32_bf16 v[20:23], v[232:235], v[36:39], v[20:23]
    ds_read_b128 v[68:71], v13 offset:32768
    v_mfma_f32_16x16x32_bf16 v[24:27], v[232:235], v[40:43], v[24:27]
    ds_read_b128 v[72:75], v13 offset:36864
    v_mfma_f32_16x16x32_bf16 v[24:27], v[236:239], v[48:51], v[24:27]
    ds_read_b128 v[76:79], v13 offset:40960
    v_mfma_f32_16x16x32_bf16 v[20:23], v[236:239], v[44:47], v[20:23]
    ds_read_b128 v[80:83], v13 offset:45056
    s_barrier
    ds_read_b128 v[88:91], v18 offset:1024
    ds_read_b128 v[92:95], v18 offset:3072
    ds_read_b128 v[96:99], v18 offset:1280
    ds_read_b128 v[100:103], v18 offset:3328
    s_waitcnt vmcnt(0)
    buffer_atomic_add v113, v112, s[56:59], s40 offen offset:2560 sc1
    s_waitcnt lgkmcnt(8)
    v_mfma_f32_16x16x32_bf16 v[20:23], v[240:243], v[52:55], v[20:23]
    ds_read_b128 v[36:39], v14 offset:0
    v_mfma_f32_16x16x32_bf16 v[24:27], v[240:243], v[56:59], v[24:27]
    ds_read_b128 v[40:43], v14 offset:4096
    v_mfma_f32_16x16x32_bf16 v[24:27], v[244:247], v[64:67], v[24:27]
    ds_read_b128 v[44:47], v14 offset:8192
    v_mfma_f32_16x16x32_bf16 v[20:23], v[244:247], v[60:63], v[20:23]
    ds_read_b128 v[48:51], v14 offset:12288
    s_waitcnt lgkmcnt(8)
    v_mfma_f32_16x16x32_bf16 v[20:23], v[248:251], v[68:71], v[20:23]
    ds_read_b128 v[52:55], v15 offset:0
    v_mfma_f32_16x16x32_bf16 v[24:27], v[248:251], v[72:75], v[24:27]
    ds_read_b128 v[56:59], v15 offset:4096
    v_mfma_f32_16x16x32_bf16 v[24:27], v[252:255], v[80:83], v[24:27]
    ds_read_b128 v[60:63], v15 offset:8192
    v_mfma_f32_16x16x32_bf16 v[20:23], v[252:255], v[76:79], v[20:23]
    ds_read_b128 v[64:67], v15 offset:12288
    s_waitcnt lgkmcnt(4)
    v_mfma_f32_16x16x32_bf16 v[28:31], v[128:131], v[36:39], 0
    ds_read_b128 v[68:71], v16 offset:0
    v_mfma_f32_16x16x32_bf16 v[32:35], v[128:131], v[40:43], 0
    ds_read_b128 v[72:75], v16 offset:4096
    v_mfma_f32_16x16x32_bf16 v[32:35], v[132:135], v[48:51], v[32:35]
    ds_read_b128 v[76:79], v16 offset:8192
    v_mfma_f32_16x16x32_bf16 v[28:31], v[132:135], v[44:47], v[28:31]
    ds_read_b128 v[80:83], v16 offset:12288
    v_pk_fma_f32 v[20:21], v[88:89], v[84:85], v[20:21]
    v_pk_fma_f32 v[22:23], v[88:89], v[86:87], v[22:23]
    v_pk_fma_f32 v[24:25], v[96:97], v[84:85], v[24:25]
    v_pk_fma_f32 v[26:27], v[96:97], v[86:87], v[26:27]
    v_pk_mul_f32 v[104:105], v[20:21], v[20:21]
    v_pk_mul_f32 v[106:107], v[22:23], v[22:23]
    v_pk_mul_f32 v[108:109], v[24:25], v[24:25]
    v_pk_mul_f32 v[110:111], v[26:27], v[26:27]
    v_pk_fma_f32 v[104:105], v[104:105], v[92:93], v[90:91]
    v_pk_fma_f32 v[106:107], v[106:107], v[92:93], v[90:91]
    v_pk_fma_f32 v[108:109], v[108:109], v[100:101], v[98:99]
    v_pk_fma_f32 v[110:111], v[110:111], v[100:101], v[98:99]
    v_pk_mul_f32 v[104:105], v[104:105], v[20:21]
    v_pk_mul_f32 v[106:107], v[106:107], v[22:23]
    v_pk_mul_f32 v[108:109], v[108:109], v[24:25]
    v_pk_mul_f32 v[110:111], v[110:111], v[26:27]
    v_exp_f32 v104, v104
    v_exp_f32 v105, v105
    v_exp_f32 v106, v106
    v_exp_f32 v107, v107
    v_exp_f32 v108, v108
    v_exp_f32 v109, v109
    v_exp_f32 v110, v110
    v_exp_f32 v111, v111
    v_pk_fma_f32 v[104:105], v[104:105], v[94:95], v[94:95]
    v_pk_fma_f32 v[106:107], v[106:107], v[94:95], v[94:95]
    v_pk_fma_f32 v[108:109], v[108:109], v[102:103], v[102:103]
    v_pk_fma_f32 v[110:111], v[110:111], v[102:103], v[102:103]
    v_rcp_f32 v104, v104
    v_rcp_f32 v105, v105
    v_rcp_f32 v106, v106
    v_rcp_f32 v107, v107
    v_rcp_f32 v108, v108
    v_rcp_f32 v109, v109
    v_rcp_f32 v110, v110
    v_rcp_f32 v111, v111
    v_pk_mul_f32 v[20:21], v[20:21], v[104:105]
    v_pk_mul_f32 v[22:23], v[22:23], v[106:107]
    v_pk_mul_f32 v[24:25], v[24:25], v[108:109]
    v_pk_mul_f32 v[26:27], v[26:27], v[110:111]
    v_add_u32 v20, 0x10000, v20
    v_add_u32 v22, 0x10000, v22
    v_add_u32 v24, 0x10000, v24
    v_add_u32 v26, 0x10000, v26
    v_and_b32 v20, 0xfffe0000, v20
    v_and_b32 v22, 0xfffe0000, v22
    v_and_b32 v24, 0xfffe0000, v24
    v_and_b32 v26, 0xfffe0000, v26
    v_cvt_pk_bf16_f32 v104, v20, v21
    v_cvt_pk_bf16_f32 v105, v22, v23
    v_cvt_pk_bf16_f32 v106, v24, v25
    v_cvt_pk_bf16_f32 v107, v26, v27
    s_add_u32 s36, s39, 262144
    v_permlane16_swap_b32 v104, v106
    v_permlane16_swap_b32 v105, v107
    buffer_store_dwordx4 v[104:107], v114, s[16:19], s36 offen sc1
    s_waitcnt lgkmcnt(4)
    v_mfma_f32_16x16x32_bf16 v[28:31], v[136:139], v[52:55], v[28:31]
    ds_read_b128 v[36:39], v17 offset:0
    v_mfma_f32_16x16x32_bf16 v[32:35], v[136:139], v[56:59], v[32:35]
    ds_read_b128 v[40:43], v17 offset:4096
    v_mfma_f32_16x16x32_bf16 v[32:35], v[140:143], v[64:67], v[32:35]
    ds_read_b128 v[44:47], v17 offset:8192
    v_mfma_f32_16x16x32_bf16 v[28:31], v[140:143], v[60:63], v[28:31]
    ds_read_b128 v[48:51], v17 offset:12288
    s_barrier
    s_waitcnt lgkmcnt(4)
    v_mfma_f32_16x16x32_bf16 v[28:31], v[144:147], v[68:71], v[28:31]
    ds_read_b128 v[52:55], v14 offset:16384
    v_mfma_f32_16x16x32_bf16 v[32:35], v[144:147], v[72:75], v[32:35]
    ds_read_b128 v[56:59], v14 offset:20480
    v_mfma_f32_16x16x32_bf16 v[32:35], v[148:151], v[80:83], v[32:35]
    ds_read_b128 v[60:63], v14 offset:24576
    v_mfma_f32_16x16x32_bf16 v[28:31], v[148:151], v[76:79], v[28:31]
    ds_read_b128 v[64:67], v14 offset:28672
    s_waitcnt lgkmcnt(4)
    v_mfma_f32_16x16x32_bf16 v[28:31], v[152:155], v[36:39], v[28:31]
    ds_read_b128 v[68:71], v15 offset:16384
    v_mfma_f32_16x16x32_bf16 v[32:35], v[152:155], v[40:43], v[32:35]
    ds_read_b128 v[72:75], v15 offset:20480
    v_mfma_f32_16x16x32_bf16 v[32:35], v[156:159], v[48:51], v[32:35]
    ds_read_b128 v[76:79], v15 offset:24576
    v_mfma_f32_16x16x32_bf16 v[28:31], v[156:159], v[44:47], v[28:31]
    ds_read_b128 v[80:83], v15 offset:28672
    s_waitcnt lgkmcnt(4)
    v_mfma_f32_16x16x32_bf16 v[28:31], v[160:163], v[52:55], v[28:31]
    ds_read_b128 v[36:39], v16 offset:16384
    v_mfma_f32_16x16x32_bf16 v[32:35], v[160:163], v[56:59], v[32:35]
    ds_read_b128 v[40:43], v16 offset:20480
    v_mfma_f32_16x16x32_bf16 v[32:35], v[164:167], v[64:67], v[32:35]
    ds_read_b128 v[44:47], v16 offset:24576
    v_mfma_f32_16x16x32_bf16 v[28:31], v[164:167], v[60:63], v[28:31]
    ds_read_b128 v[48:51], v16 offset:28672
    s_waitcnt lgkmcnt(4)
    v_mfma_f32_16x16x32_bf16 v[28:31], v[168:171], v[68:71], v[28:31]
    ds_read_b128 v[52:55], v17 offset:16384
    v_mfma_f32_16x16x32_bf16 v[32:35], v[168:171], v[72:75], v[32:35]
    ds_read_b128 v[56:59], v17 offset:20480
    v_mfma_f32_16x16x32_bf16 v[32:35], v[172:175], v[80:83], v[32:35]
    ds_read_b128 v[60:63], v17 offset:24576
    v_mfma_f32_16x16x32_bf16 v[28:31], v[172:175], v[76:79], v[28:31]
    ds_read_b128 v[64:67], v17 offset:28672
    s_barrier
    s_waitcnt lgkmcnt(4)
    v_mfma_f32_16x16x32_bf16 v[28:31], v[176:179], v[36:39], v[28:31]
    ds_read_b128 v[68:71], v14 offset:32768
    v_mfma_f32_16x16x32_bf16 v[32:35], v[176:179], v[40:43], v[32:35]
    ds_read_b128 v[72:75], v14 offset:36864
    v_mfma_f32_16x16x32_bf16 v[32:35], v[180:183], v[48:51], v[32:35]
    ds_read_b128 v[76:79], v14 offset:40960
    v_mfma_f32_16x16x32_bf16 v[28:31], v[180:183], v[44:47], v[28:31]
    ds_read_b128 v[80:83], v14 offset:45056
    s_waitcnt lgkmcnt(4)
    v_mfma_f32_16x16x32_bf16 v[28:31], v[184:187], v[52:55], v[28:31]
    ds_read_b128 v[36:39], v15 offset:32768
    v_mfma_f32_16x16x32_bf16 v[32:35], v[184:187], v[56:59], v[32:35]
    ds_read_b128 v[40:43], v15 offset:36864
    v_mfma_f32_16x16x32_bf16 v[32:35], v[188:191], v[64:67], v[32:35]
    ds_read_b128 v[44:47], v15 offset:40960
    v_mfma_f32_16x16x32_bf16 v[28:31], v[188:191], v[60:63], v[28:31]
    ds_read_b128 v[48:51], v15 offset:45056
    s_waitcnt lgkmcnt(4)
    v_mfma_f32_16x16x32_bf16 v[28:31], v[192:195], v[68:71], v[28:31]
    ds_read_b128 v[52:55], v16 offset:32768
    v_mfma_f32_16x16x32_bf16 v[32:35], v[192:195], v[72:75], v[32:35]
    ds_read_b128 v[56:59], v16 offset:36864
    v_mfma_f32_16x16x32_bf16 v[32:35], v[196:199], v[80:83], v[32:35]
    ds_read_b128 v[60:63], v16 offset:40960
    v_mfma_f32_16x16x32_bf16 v[28:31], v[196:199], v[76:79], v[28:31]
    ds_read_b128 v[64:67], v16 offset:45056
    s_waitcnt lgkmcnt(4)
    v_mfma_f32_16x16x32_bf16 v[28:31], v[200:203], v[36:39], v[28:31]
    ds_read_b128 v[68:71], v17 offset:32768
    v_mfma_f32_16x16x32_bf16 v[32:35], v[200:203], v[40:43], v[32:35]
    ds_read_b128 v[72:75], v17 offset:36864
    v_mfma_f32_16x16x32_bf16 v[32:35], v[204:207], v[48:51], v[32:35]
    ds_read_b128 v[76:79], v17 offset:40960
    v_mfma_f32_16x16x32_bf16 v[28:31], v[204:207], v[44:47], v[28:31]
    ds_read_b128 v[80:83], v17 offset:45056
    s_barrier
    s_waitcnt lgkmcnt(4)
    v_mfma_f32_16x16x32_bf16 v[28:31], v[208:211], v[52:55], v[28:31]
    ds_read_b128 v[36:39], v10 offset:16384
    v_mfma_f32_16x16x32_bf16 v[32:35], v[208:211], v[56:59], v[32:35]
    ds_read_b128 v[40:43], v10 offset:20480
    v_mfma_f32_16x16x32_bf16 v[32:35], v[212:215], v[64:67], v[32:35]
    ds_read_b128 v[44:47], v10 offset:24576
    v_mfma_f32_16x16x32_bf16 v[28:31], v[212:215], v[60:63], v[28:31]
    ds_read_b128 v[48:51], v10 offset:28672
    s_waitcnt lgkmcnt(4)
    v_mfma_f32_16x16x32_bf16 v[28:31], v[216:219], v[68:71], v[28:31]
    ds_read_b128 v[52:55], v11 offset:16384
    v_mfma_f32_16x16x32_bf16 v[32:35], v[216:219], v[72:75], v[32:35]
    ds_read_b128 v[56:59], v11 offset:20480
    v_mfma_f32_16x16x32_bf16 v[32:35], v[220:223], v[80:83], v[32:35]
    ds_read_b128 v[60:63], v11 offset:24576
    v_mfma_f32_16x16x32_bf16 v[28:31], v[220:223], v[76:79], v[28:31]
    ds_read_b128 v[64:67], v11 offset:28672
    s_waitcnt vmcnt(0)
    buffer_atomic_add v113, v112, s[56:59], s40 offen offset:3072 sc1
    s_waitcnt lgkmcnt(4)
    v_mfma_f32_16x16x32_bf16 v[28:31], v[224:227], v[36:39], v[28:31]
    ds_read_b128 v[68:71], v12 offset:16384
    v_mfma_f32_16x16x32_bf16 v[32:35], v[224:227], v[40:43], v[32:35]
    ds_read_b128 v[72:75], v12 offset:20480
    v_mfma_f32_16x16x32_bf16 v[32:35], v[228:231], v[48:51], v[32:35]
    ds_read_b128 v[76:79], v12 offset:24576
    v_mfma_f32_16x16x32_bf16 v[28:31], v[228:231], v[44:47], v[28:31]
    ds_read_b128 v[80:83], v12 offset:28672
    s_waitcnt lgkmcnt(4)
    v_mfma_f32_16x16x32_bf16 v[28:31], v[232:235], v[52:55], v[28:31]
    ds_read_b128 v[36:39], v13 offset:16384
    v_mfma_f32_16x16x32_bf16 v[32:35], v[232:235], v[56:59], v[32:35]
    ds_read_b128 v[40:43], v13 offset:20480
    v_mfma_f32_16x16x32_bf16 v[32:35], v[236:239], v[64:67], v[32:35]
    ds_read_b128 v[44:47], v13 offset:24576
    v_mfma_f32_16x16x32_bf16 v[28:31], v[236:239], v[60:63], v[28:31]
    ds_read_b128 v[48:51], v13 offset:28672
    s_barrier
    ds_read_b128 v[88:91], v18 offset:1536
    ds_read_b128 v[92:95], v18 offset:3584
    ds_read_b128 v[96:99], v18 offset:1792
    ds_read_b128 v[100:103], v18 offset:3840
    s_waitcnt lgkmcnt(8)
    v_mfma_f32_16x16x32_bf16 v[28:31], v[240:243], v[68:71], v[28:31]
    v_mfma_f32_16x16x32_bf16 v[32:35], v[240:243], v[72:75], v[32:35]
    v_mfma_f32_16x16x32_bf16 v[32:35], v[244:247], v[80:83], v[32:35]
    v_mfma_f32_16x16x32_bf16 v[28:31], v[244:247], v[76:79], v[28:31]
    s_waitcnt lgkmcnt(4)
    v_mfma_f32_16x16x32_bf16 v[28:31], v[248:251], v[36:39], v[28:31]
    v_mfma_f32_16x16x32_bf16 v[32:35], v[248:251], v[40:43], v[32:35]
    v_mfma_f32_16x16x32_bf16 v[32:35], v[252:255], v[48:51], v[32:35]
    v_mfma_f32_16x16x32_bf16 v[28:31], v[252:255], v[44:47], v[28:31]
    s_setprio 1
    s_waitcnt lgkmcnt(0)
    s_load_dword s32, s[4:5], s20 offset:2560
    s_load_dword s3, s[4:5], s20 offset:2688
    s_add_u32 m0, s12, 139264
    s_add_u32 s49, s11, 0
    buffer_load_dwordx4 v2, s[16:19], s49 offen offset:0 sc1 lds
    buffer_load_dwordx4 v2, s[16:19], s49 offen offset:1024 sc1 lds
    buffer_load_dwordx4 v2, s[16:19], s49 offen offset:2048 sc1 lds
    buffer_load_dwordx4 v2, s[16:19], s49 offen offset:3072 sc1 lds
    v_pk_fma_f32 v[28:29], v[88:89], v[84:85], v[28:29]
    v_pk_fma_f32 v[30:31], v[88:89], v[86:87], v[30:31]
    v_pk_fma_f32 v[32:33], v[96:97], v[84:85], v[32:33]
    v_pk_fma_f32 v[34:35], v[96:97], v[86:87], v[34:35]
    v_pk_mul_f32 v[104:105], v[28:29], v[28:29]
    v_pk_mul_f32 v[106:107], v[30:31], v[30:31]
    v_pk_mul_f32 v[108:109], v[32:33], v[32:33]
    v_pk_mul_f32 v[110:111], v[34:35], v[34:35]
    v_pk_fma_f32 v[104:105], v[104:105], v[92:93], v[90:91]
    v_pk_fma_f32 v[106:107], v[106:107], v[92:93], v[90:91]
    v_pk_fma_f32 v[108:109], v[108:109], v[100:101], v[98:99]
    v_pk_fma_f32 v[110:111], v[110:111], v[100:101], v[98:99]
    v_pk_mul_f32 v[104:105], v[104:105], v[28:29]
    v_pk_mul_f32 v[106:107], v[106:107], v[30:31]
    v_pk_mul_f32 v[108:109], v[108:109], v[32:33]
    v_pk_mul_f32 v[110:111], v[110:111], v[34:35]
    v_exp_f32 v104, v104
    v_exp_f32 v105, v105
    v_exp_f32 v106, v106
    v_exp_f32 v107, v107
    v_exp_f32 v108, v108
    v_exp_f32 v109, v109
    v_exp_f32 v110, v110
    v_exp_f32 v111, v111
    v_pk_fma_f32 v[104:105], v[104:105], v[94:95], v[94:95]
    v_pk_fma_f32 v[106:107], v[106:107], v[94:95], v[94:95]
    v_pk_fma_f32 v[108:109], v[108:109], v[102:103], v[102:103]
    v_pk_fma_f32 v[110:111], v[110:111], v[102:103], v[102:103]
    v_rcp_f32 v104, v104
    v_rcp_f32 v105, v105
    v_rcp_f32 v106, v106
    v_rcp_f32 v107, v107
    v_rcp_f32 v108, v108
    v_rcp_f32 v109, v109
    v_rcp_f32 v110, v110
    v_rcp_f32 v111, v111
    v_pk_mul_f32 v[28:29], v[28:29], v[104:105]
    v_pk_mul_f32 v[30:31], v[30:31], v[106:107]
    v_pk_mul_f32 v[32:33], v[32:33], v[108:109]
    v_pk_mul_f32 v[34:35], v[34:35], v[110:111]
    v_add_u32 v28, 0x10000, v28
    v_add_u32 v30, 0x10000, v30
    v_add_u32 v32, 0x10000, v32
    v_add_u32 v34, 0x10000, v34
    v_and_b32 v28, 0xfffe0000, v28
    v_and_b32 v30, 0xfffe0000, v30
    v_and_b32 v32, 0xfffe0000, v32
    v_and_b32 v34, 0xfffe0000, v34
    v_cvt_pk_bf16_f32 v104, v28, v29
    v_cvt_pk_bf16_f32 v105, v30, v31
    v_cvt_pk_bf16_f32 v106, v32, v33
    v_cvt_pk_bf16_f32 v107, v34, v35
    s_add_u32 s36, s39, 393216
    v_permlane16_swap_b32 v104, v106
    v_permlane16_swap_b32 v105, v107
    buffer_store_dwordx4 v[104:107], v114, s[16:19], s36 offen sc1
    s_add_u32 m0, s12, 16384
    s_add_u32 s49, s8, 131072
    s_barrier
    s_waitcnt lgkmcnt(0)
    s_cmp_eq_u32 s32, s21
    s_cselect_b32 s32, s3, 0
    s_cmp_eq_u32 s32, s21
    s_cbranch_scc1 hok_12
    s_add_u32 s53, s20, 2560
    v_lshlrev_b32 v85, 7, v1
    v_add_u32 v85, s53, v85
    s_mov_b32 s53, 0
    s_add_u32 s54, s52, 16
    s_bfm_b64 exec, 2, 0
poll_13:
    buffer_load_dword v84, v85, s[56:59], 0 offen sc1
    s_waitcnt vmcnt(0)
    v_cmp_eq_u32 vcc, s54, v84
    s_nop 0
    s_cmp_eq_u64 vcc, exec
    s_cbranch_scc1 pok_14
    s_sleep 8
    s_add_u32 s53, s53, 1
    s_cmp_lt_u32 s53, s61
    s_cbranch_scc1 poll_13
    s_mov_b32 s61, 0
pok_14:
    s_mov_b64 exec, -1
hok_12:
    buffer_load_dwordx4 v2, s[16:19], s49 offen offset:0 sc1 lds
    buffer_load_dwordx4 v2, s[16:19], s49 offen offset:1024 sc1 lds
    buffer_load_dwordx4 v2, s[16:19], s49 offen offset:2048 sc1 lds
    buffer_load_dwordx4 v2, s[16:19], s49 offen offset:3072 sc1 lds
    s_add_u32 m0, s12, 32768
    s_add_u32 s49, s9, 131072
    s_barrier
    buffer_load_dwordx4 v2, s[16:19], s49 offen offset:0 sc1 lds
    buffer_load_dwordx4 v2, s[16:19], s49 offen offset:1024 sc1 lds
    buffer_load_dwordx4 v2, s[16:19], s49 offen offset:2048 sc1 lds
    buffer_load_dwordx4 v2, s[16:19], s49 offen offset:3072 sc1 lds
    s_add_u32 m0, s12, 106496
    s_add_u32 s49, s10, 131072
    s_waitcnt vmcnt(9)
    s_barrier
    s_waitcnt vmcnt(8)
    buffer_atomic_add v113, v112, s[56:59], s40 offen offset:3584 sc1
    buffer_load_dwordx4 v2, s[16:19], s49 offen offset:0 sc1 lds
    buffer_load_dwordx4 v2, s[16:19], s49 offen offset:1024 sc1 lds
    buffer_load_dwordx4 v2, s[16:19], s49 offen offset:2048 sc1 lds
    buffer_load_dwordx4 v2, s[16:19], s49 offen offset:3072 sc1 lds
    s_add_u32 m0, s12, 122880
    s_add_u32 s49, s11, 131072
    s_waitcnt vmcnt(9)
    s_barrier
    s_load_dword s32, s[4:5], s20 offset:3072
    s_load_dword s3, s[4:5], s20 offset:3200
    buffer_load_dwordx4 v2, s[16:19], s49 offen offset:0 sc1 lds
    buffer_load_dwordx4 v2, s[16:19], s49 offen offset:1024 sc1 lds
    buffer_load_dwordx4 v2, s[16:19], s49 offen offset:2048 sc1 lds
    buffer_load_dwordx4 v2, s[16:19], s49 offen offset:3072 sc1 lds
    s_add_u32 m0, s12, 139264
    s_add_u32 s49, s8, 262144
    s_waitcnt vmcnt(9)
    s_barrier
    s_waitcnt lgkmcnt(0)
    s_cmp_eq_u32 s32, s21
    s_cselect_b32 s32, s3, 0
    s_cmp_eq_u32 s32, s21
    s_cbranch_scc1 hok_15
    s_add_u32 s53, s20, 3072
    v_lshlrev_b32 v85, 7, v1
    v_add_u32 v85, s53, v85
    s_mov_b32 s53, 0
    s_add_u32 s54, s52, 16
    s_bfm_b64 exec, 2, 0
poll_16:
    buffer_load_dword v84, v85, s[56:59], 0 offen sc1
    s_waitcnt vmcnt(0)
    v_cmp_eq_u32 vcc, s54, v84
    s_nop 0
    s_cmp_eq_u64 vcc, exec
    s_cbranch_scc1 pok_17
    s_sleep 8
    s_add_u32 s53, s53, 1
    s_cmp_lt_u32 s53, s61
    s_cbranch_scc1 poll_16
    s_mov_b32 s61, 0
pok_17:
    s_mov_b64 exec, -1
hok_15:
    buffer_load_dwordx4 v2, s[16:19], s49 offen offset:0 sc1 lds
    buffer_load_dwordx4 v2, s[16:19], s49 offen offset:1024 sc1 lds
    buffer_load_dwordx4 v2, s[16:19], s49 offen offset:2048 sc1 lds
    buffer_load_dwordx4 v2, s[16:19], s49 offen offset:3072 sc1 lds
    s_add_u32 m0, s12, 16384
    s_add_u32 s49, s9, 262144
    s_waitcnt vmcnt(8)
    s_barrier
    buffer_load_dwordx4 v2, s[16:19], s49 offen offset:0 sc1 lds
    buffer_load_dwordx4 v2, s[16:19], s49 offen offset:1024 sc1 lds
    buffer_load_dwordx4 v2, s[16:19], s49 offen offset:2048 sc1 lds
    buffer_load_dwordx4 v2, s[16:19], s49 offen offset:3072 sc1 lds
    s_add_u32 m0, s12, 32768
    s_add_u32 s49, s10, 262144
    s_waitcnt vmcnt(8)
    s_barrier
    buffer_load_dwordx4 v2, s[16:19], s49 offen offset:0 sc1 lds
    buffer_load_dwordx4 v2, s[16:19], s49 offen offset:1024 sc1 lds
    buffer_load_dwordx4 v2, s[16:19], s49 offen offset:2048 sc1 lds
    buffer_load_dwordx4 v2, s[16:19], s49 offen offset:3072 sc1 lds
    s_add_u32 m0, s12, 106496
    s_add_u32 s49, s11, 262144
    s_waitcnt vmcnt(8)
    s_barrier
    s_load_dword s32, s[4:5], s20 offset:3584
    s_load_dword s3, s[4:5], s20 offset:3712
    buffer_load_dwordx4 v2, s[16:19], s49 offen offset:0 sc1 lds
    buffer_load_dwordx4 v2, s[16:19], s49 offen offset:1024 sc1 lds
    buffer_load_dwordx4 v2, s[16:19], s49 offen offset:2048 sc1 lds
    buffer_load_dwordx4 v2, s[16:19], s49 offen offset:3072 sc1 lds
    s_add_u32 m0, s12, 122880
    s_add_u32 s49, s8, 393216
    s_waitcnt vmcnt(8)
    s_barrier
    s_waitcnt lgkmcnt(0)
    s_cmp_eq_u32 s32, s21
    s_cselect_b32 s32, s3, 0
    s_cmp_eq_u32 s32, s21
    s_cbranch_scc1 hok_18
    s_add_u32 s53, s20, 3584
    v_lshlrev_b32 v85, 7, v1
    v_add_u32 v85, s53, v85
    s_mov_b32 s53, 0
    s_add_u32 s54, s52, 16
    s_bfm_b64 exec, 2, 0
poll_19:
    buffer_load_dword v84, v85, s[56:59], 0 offen sc1
    s_waitcnt vmcnt(0)
    v_cmp_eq_u32 vcc, s54, v84
    s_nop 0
    s_cmp_eq_u64 vcc, exec
    s_cbranch_scc1 pok_20
    s_sleep 8
    s_add_u32 s53, s53, 1
    s_cmp_lt_u32 s53, s61
    s_cbranch_scc1 poll_19
    s_mov_b32 s61, 0
pok_20:
    s_mov_b64 exec, -1
hok_18:
    buffer_load_dwordx4 v2, s[16:19], s49 offen offset:0 sc1 lds
    buffer_load_dwordx4 v2, s[16:19], s49 offen offset:1024 sc1 lds
    buffer_load_dwordx4 v2, s[16:19], s49 offen offset:2048 sc1 lds
    buffer_load_dwordx4 v2, s[16:19], s49 offen offset:3072 sc1 lds
    s_add_u32 m0, s12, 139264
    s_add_u32 s49, s9, 393216
    s_waitcnt vmcnt(8)
    s_barrier
    buffer_load_dwordx4 v2, s[16:19], s49 offen offset:0 sc1 lds
    buffer_load_dwordx4 v2, s[16:19], s49 offen offset:1024 sc1 lds
    buffer_load_dwordx4 v2, s[16:19], s49 offen offset:2048 sc1 lds
    buffer_load_dwordx4 v2, s[16:19], s49 offen offset:3072 sc1 lds
    s_add_u32 m0, s12, 16384
    s_add_u32 s49, s10, 393216
    s_waitcnt vmcnt(8)
    s_barrier
    buffer_load_dwordx4 v2, s[16:19], s49 offen offset:0 sc1 lds
    buffer_load_dwordx4 v2, s[16:19], s49 offen offset:1024 sc1 lds
    buffer_load_dwordx4 v2, s[16:19], s49 offen offset:2048 sc1 lds
    buffer_load_dwordx4 v2, s[16:19], s49 offen offset:3072 sc1 lds
    s_add_u32 m0, s12, 32768
    s_add_u32 s49, s11, 393216
    s_waitcnt vmcnt(8)
    s_barrier
    buffer_load_dwordx4 v2, s[16:19], s49 offen offset:0 sc1 lds
    buffer_load_dwordx4 v2, s[16:19], s49 offen offset:1024 sc1 lds
    buffer_load_dwordx4 v2, s[16:19], s49 offen offset:2048 sc1 lds
    buffer_load_dwordx4 v2, s[16:19], s49 offen offset:3072 sc1 lds
    s_waitcnt vmcnt(8)
    s_barrier
    s_lshr_b32 s34, s30, 1
    s_and_b32 s35, s30, 1
    v_and_b32 v22, 15, v1
    v_lshrrev_b32 v23, 4, v1
    s_mul_i32 s37, s34, 4
    s_mul_i32 s38, s29, 14
    s_mul_i32 s36, s35, 7
    s_add_u32 s38, s38, s36
    s_mul_i32 s36, s34, 8192
    v_add_u32 v12, s36, v2
    v_lshrrev_b32 v6, 2, v1
    v_mul_u32_u24 v13, 448, v6
    v_and_b32 v7, 3, v1
    v_lshl_add_u32 v13, v7, 3, v13
    v_add_u32 v13, 49152, v13
    v_mul_u32_u24 v15, 448, v6
    v_and_b32 v7, 2, v1
    v_lshl_add_u32 v15, v7, 2, v15
    v_bfe_u32 v6, v1, 4, 1
    v_and_b32 v7, 1, v1
    v_xor_b32 v7, v7, v6
    v_lshl_add_u32 v15, v7, 5, v15
    s_lshl_b32 s36, s35, 4
    s_add_u32 s36, s36, 49344
    v_add_u32 v15, s36, v15
    s_lshl_b32 s36, s35, 8
    v_add_u32 v13, s36, v13
    v_lshlrev_b32 v6, 5, v6
    v_sub_u32 v14, v13, v6
    v_add_u32 v13, v13, v6
    s_mov_b32 s42, 0
    s_mov_b32 s43, 0
    s_mov_b32 s48, 0
    v_mov_b32 v17, v12
    v_mov_b32 v18, v13
    v_mov_b32 v19, v14
    v_mov_b32 v20, v15
    s_waitcnt vmcnt(4)
    s_barrier
    s_waitcnt vmcnt(0)
    s_barrier
    s_setprio 0
    s_waitcnt lgkmcnt(0)
    s_barrier
    ds_read_b128 v[136:139], v17 offset:0
    ds_read_b128 v[140:143], v17 offset:2048
    ds_read_b128 v[144:147], v17 offset:4096
    ds_read_b128 v[148:151], v17 offset:6144
    ds_read_b64_tr_b16 v[152:153], v18 offset:0
    ds_read_b64_tr_b16 v[154:155], v18 offset:7168
    ds_read_b64_tr_b16 v[156:157], v19 offset:32
    ds_read_b64_tr_b16 v[158:159], v19 offset:7200
    ds_read_b64_tr_b16 v[160:161], v18 offset:64
    ds_read_b64_tr_b16 v[162:163], v18 offset:7232
    ds_read_b64_tr_b16 v[164:165], v19 offset:96
    ds_read_b64_tr_b16 v[166:167], v19 offset:7264
    ds_read_b64_tr_b16 v[168:169], v18 offset:128
    ds_read_b64_tr_b16 v[170:171], v18 offset:7296
    ds_read_b64_tr_b16 v[172:173], v19 offset:160
    ds_read_b64_tr_b16 v[174:175], v19 offset:7328
    ds_read_b64_tr_b16 v[176:177], v20 offset:0
    ds_read_b64_tr_b16 v[178:179], v20 offset:7168
    s_waitcnt lgkmcnt(0)
    v_mfma_f32_16x16x32_bf16 v[24:27], v[152:155], v[136:139], 0
    ds_read_b128 v[180:183], v17 offset:1024
    v_mfma_f32_16x16x32_bf16 v[52:55], v[152:155], v[140:143], 0
    ds_read_b128 v[184:187], v17 offset:3072
    v_mfma_f32_16x16x32_bf16 v[80:83], v[152:155], v[144:147], 0
    ds_read_b128 v[188:191], v17 offset:5120
    v_mfma_f32_16x16x32_bf16 v[108:111], v[152:155], v[148:151], 0
    ds_read_b128 v[192:195], v17 offset:7168
    v_mfma_f32_16x16x32_bf16 v[112:115], v[156:159], v[148:151], 0
    ds_read_b64_tr_b16 v[196:197], v18 offset:14336
    v_mfma_f32_16x16x32_bf16 v[84:87], v[156:159], v[144:147], 0
    ds_read_b64_tr_b16 v[198:199], v18 offset:21504
    v_mfma_f32_16x16x32_bf16 v[56:59], v[156:159], v[140:143], 0
    v_mfma_f32_16x16x32_bf16 v[28:31], v[156:159], v[136:139], 0
    ds_read_b64_tr_b16 v[200:201], v19 offset:14368
    v_mfma_f32_16x16x32_bf16 v[32:35], v[160:163], v[136:139], 0
    ds_read_b64_tr_b16 v[202:203], v19 offset:21536
    v_mfma_f32_16x16x32_bf16 v[60:63], v[160:163], v[140:143], 0
    ds_read_b64_tr_b16 v[204:205], v18 offset:14400
    v_mfma_f32_16x16x32_bf16 v[88:91], v[160:163], v[144:147], 0
    ds_read_b64_tr_b16 v[206:207], v18 offset:21568
    v_mfma_f32_16x16x32_bf16 v[116:119], v[160:163], v[148:151], 0
    ds_read_b64_tr_b16 v[208:209], v19 offset:14432
    v_mfma_f32_16x16x32_bf16 v[120:123], v[164:167], v[148:151], 0
    ds_read_b64_tr_b16 v[210:211], v19 offset:21600
    v_mfma_f32_16x16x32_bf16 v[92:95], v[164:167], v[144:147], 0
    v_mfma_f32_16x16x32_bf16 v[64:67], v[164:167], v[140:143], 0
    ds_read_b64_tr_b16 v[212:213], v18 offset:14464
    v_mfma_f32_16x16x32_bf16 v[36:39], v[164:167], v[136:139], 0
    ds_read_b64_tr_b16 v[214:215], v18 offset:21632
    v_mfma_f32_16x16x32_bf16 v[40:43], v[168:171], v[136:139], 0
    ds_read_b64_tr_b16 v[216:217], v19 offset:14496
    v_mfma_f32_16x16x32_bf16 v[68:71], v[168:171], v[140:143], 0
    ds_read_b64_tr_b16 v[218:219], v19 offset:21664
    v_mfma_f32_16x16x32_bf16 v[96:99], v[168:171], v[144:147], 0
    ds_read_b64_tr_b16 v[220:221], v20 offset:14336
    v_mfma_f32_16x16x32_bf16 v[124:127], v[168:171], v[148:151], 0
    ds_read_b64_tr_b16 v[222:223], v20 offset:21504
    v_mfma_f32_16x16x32_bf16 v[128:131], v[172:175], v[148:151], 0
    s_add_u32 s42, s42, 16384
    s_cmp_eq_u32 s42, 49152
    v_mfma_f32_16x16x32_bf16 v[100:103], v[172:175], v[144:147], 0
    s_cselect_b32 s42, 0, s42
    s_add_u32 s48, s48, 28672
    v_mfma_f32_16x16x32_bf16 v[72:75], v[172:175], v[140:143], 0
    s_cmp_eq_u32 s48, 86016
    s_cselect_b32 s48, 0, s48
    v_mfma_f32_16x16x32_bf16 v[44:47], v[172:175], v[136:139], 0
    v_add_u32 v17, s42, v12
    v_add_u32 v18, s48, v13
    v_mfma_f32_16x16x32_bf16 v[48:51], v[176:179], v[136:139], 0
    v_add_u32 v19, s48, v14
    v_add_u32 v20, s48, v15
    v_mfma_f32_16x16x32_bf16 v[76:79], v[176:179], v[140:143], 0
    v_mfma_f32_16x16x32_bf16 v[104:107], v[176:179], v[144:147], 0
    v_mfma_f32_16x16x32_bf16 v[132:135], v[176:179], v[148:151], 0
    s_waitcnt lgkmcnt(0)
    v_mfma_f32_16x16x32_bf16 v[24:27], v[196:199], v[180:183], v[24:27]
    v_mfma_f32_16x16x32_bf16 v[52:55], v[196:199], v[184:187], v[52:55]
    v_mfma_f32_16x16x32_bf16 v[80:83], v[196:199], v[188:191], v[80:83]
    v_mfma_f32_16x16x32_bf16 v[108:111], v[196:199], v[192:195], v[108:111]
    v_mfma_f32_16x16x32_bf16 v[112:115], v[200:203], v[192:195], v[112:115]
    v_mfma_f32_16x16x32_bf16 v[84:87], v[200:203], v[188:191], v[84:87]
    v_mfma_f32_16x16x32_bf16 v[56:59], v[200:203], v[184:187], v[56:59]
    v_mfma_f32_16x16x32_bf16 v[28:31], v[200:203], v[180:183], v[28:31]
    v_mfma_f32_16x16x32_bf16 v[32:35], v[204:207], v[180:183], v[32:35]
    v_mfma_f32_16x16x32_bf16 v[60:63], v[204:207], v[184:187], v[60:63]
    v_mfma_f32_16x16x32_bf16 v[88:91], v[204:207], v[188:191], v[88:91]
    v_mfma_f32_16x16x32_bf16 v[116:119], v[204:207], v[192:195], v[116:119]
    v_mfma_f32_16x16x32_bf16 v[120:123], v[208:211], v[192:195], v[120:123]
    v_mfma_f32_16x16x32_bf16 v[92:95], v[208:211], v[188:191], v[92:95]
    v_mfma_f32_16x16x32_bf16 v[64:67], v[208:211], v[184:187], v[64:67]
    v_mfma_f32_16x16x32_bf16 v[36:39], v[208:211], v[180:183], v[36:39]
    v_mfma_f32_16x16x32_bf16 v[40:43], v[212:215], v[180:183], v[40:43]
    v_mfma_f32_16x16x32_bf16 v[68:71], v[212:215], v[184:187], v[68:71]
    v_mfma_f32_16x16x32_bf16 v[96:99], v[212:215], v[188:191], v[96:99]
    v_mfma_f32_16x16x32_bf16 v[124:127], v[212:215], v[192:195], v[124:127]
    v_mfma_f32_16x16x32_bf16 v[128:131], v[216:219], v[192:195], v[128:131]
    s_add_u32 s43, s43, 1
    v_mfma_f32_16x16x32_bf16 v[100:103], v[216:219], v[188:191], v[100:103]
    v_mfma_f32_16x16x32_bf16 v[72:75], v[216:219], v[184:187], v[72:75]
    v_mfma_f32_16x16x32_bf16 v[44:47], v[216:219], v[180:183], v[44:47]
    v_mfma_f32_16x16x32_bf16 v[48:51], v[220:223], v[180:183], v[48:51]
    v_mfma_f32_16x16x32_bf16 v[76:79], v[220:223], v[184:187], v[76:79]
    v_mfma_f32_16x16x32_bf16 v[104:107], v[220:223], v[188:191], v[104:107]
    v_mfma_f32_16x16x32_bf16 v[132:135], v[220:223], v[192:195], v[132:135]
    s_barrier
    ds_read_b128 v[136:139], v17 offset:0
    ds_read_b128 v[140:143], v17 offset:2048
    ds_read_b128 v[144:147], v17 offset:4096
    ds_read_b128 v[148:151], v17 offset:6144
    ds_read_b64_tr_b16 v[152:153], v18 offset:0
    ds_read_b64_tr_b16 v[154:155], v18 offset:7168
    ds_read_b64_tr_b16 v[156:157], v19 offset:32
    ds_read_b64_tr_b16 v[158:159], v19 offset:7200
    ds_read_b64_tr_b16 v[160:161], v18 offset:64
    ds_read_b64_tr_b16 v[162:163], v18 offset:7232
    ds_read_b64_tr_b16 v[164:165], v19 offset:96
    ds_read_b64_tr_b16 v[166:167], v19 offset:7264
    ds_read_b64_tr_b16 v[168:169], v18 offset:128
    ds_read_b64_tr_b16 v[170:171], v18 offset:7296
    ds_read_b64_tr_b16 v[172:173], v19 offset:160
    ds_read_b64_tr_b16 v[174:175], v19 offset:7328
    ds_read_b64_tr_b16 v[176:177], v20 offset:0
    ds_read_b64_tr_b16 v[178:179], v20 offset:7168
mm_21:
    s_waitcnt lgkmcnt(0)
    v_mfma_f32_16x16x32_bf16 v[24:27], v[152:155], v[136:139], v[24:27]
    ds_read_b128 v[180:183], v17 offset:1024
    v_mfma_f32_16x16x32_bf16 v[52:55], v[152:155], v[140:143], v[52:55]
    ds_read_b128 v[184:187], v17 offset:3072
    v_mfma_f32_16x16x32_bf16 v[80:83], v[152:155], v[144:147], v[80:83]
    ds_read_b128 v[188:191], v17 offset:5120
    v_mfma_f32_16x16x32_bf16 v[108:111], v[152:155], v[148:151], v[108:111]
    ds_read_b128 v[192:195], v17 offset:7168
    v_mfma_f32_16x16x32_bf16 v[112:115], v[156:159], v[148:151], v[112:115]
    ds_read_b64_tr_b16 v[196:197], v18 offset:14336
    v_mfma_f32_16x16x32_bf16 v[84:87], v[156:159], v[144:147], v[84:87]
    ds_read_b64_tr_b16 v[198:199], v18 offset:21504
    v_mfma_f32_16x16x32_bf16 v[56:59], v[156:159], v[140:143], v[56:59]
    v_mfma_f32_16x16x32_bf16 v[28:31], v[156:159], v[136:139], v[28:31]
    ds_read_b64_tr_b16 v[200:201], v19 offset:14368
    v_mfma_f32_16x16x32_bf16 v[32:35], v[160:163], v[136:139], v[32:35]
    ds_read_b64_tr_b16 v[202:203], v19 offset:21536
    v_mfma_f32_16x16x32_bf16 v[60:63], v[160:163], v[140:143], v[60:63]
    ds_read_b64_tr_b16 v[204:205], v18 offset:14400
    v_mfma_f32_16x16x32_bf16 v[88:91], v[160:163], v[144:147], v[88:91]
    ds_read_b64_tr_b16 v[206:207], v18 offset:21568
    v_mfma_f32_16x16x32_bf16 v[116:119], v[160:163], v[148:151], v[116:119]
    ds_read_b64_tr_b16 v[208:209], v19 offset:14432
    v_mfma_f32_16x16x32_bf16 v[120:123], v[164:167], v[148:151], v[120:123]
    ds_read_b64_tr_b16 v[210:211], v19 offset:21600
    v_mfma_f32_16x16x32_bf16 v[92:95], v[164:167], v[144:147], v[92:95]
    v_mfma_f32_16x16x32_bf16 v[64:67], v[164:167], v[140:143], v[64:67]
    ds_read_b64_tr_b16 v[212:213], v18 offset:14464
    v_mfma_f32_16x16x32_bf16 v[36:39], v[164:167], v[136:139], v[36:39]
    ds_read_b64_tr_b16 v[214:215], v18 offset:21632
    v_mfma_f32_16x16x32_bf16 v[40:43], v[168:171], v[136:139], v[40:43]
    ds_read_b64_tr_b16 v[216:217], v19 offset:14496
    v_mfma_f32_16x16x32_bf16 v[68:71], v[168:171], v[140:143], v[68:71]
    ds_read_b64_tr_b16 v[218:219], v19 offset:21664
    v_mfma_f32_16x16x32_bf16 v[96:99], v[168:171], v[144:147], v[96:99]
    ds_read_b64_tr_b16 v[220:221], v20 offset:14336
    v_mfma_f32_16x16x32_bf16 v[124:127], v[168:171], v[148:151], v[124:127]
    ds_read_b64_tr_b16 v[222:223], v20 offset:21504
    v_mfma_f32_16x16x32_bf16 v[128:131], v[172:175], v[148:151], v[128:131]
    s_add_u32 s42, s42, 16384
    s_cmp_eq_u32 s42, 49152
    v_mfma_f32_16x16x32_bf16 v[100:103], v[172:175], v[144:147], v[100:103]
    s_cselect_b32 s42, 0, s42
    s_add_u32 s48, s48, 28672
    v_mfma_f32_16x16x32_bf16 v[72:75], v[172:175], v[140:143], v[72:75]
    s_cmp_eq_u32 s48, 86016
    s_cselect_b32 s48, 0, s48
    v_mfma_f32_16x16x32_bf16 v[44:47], v[172:175], v[136:139], v[44:47]
    v_add_u32 v17, s42, v12
    v_add_u32 v18, s48, v13
    v_mfma_f32_16x16x32_bf16 v[48:51], v[176:179], v[136:139], v[48:51]
    v_add_u32 v19, s48, v14
    v_add_u32 v20, s48, v15
    v_mfma_f32_16x16x32_bf16 v[76:79], v[176:179], v[140:143], v[76:79]
    v_mfma_f32_16x16x32_bf16 v[104:107], v[176:179], v[144:147], v[104:107]
    v_mfma_f32_16x16x32_bf16 v[132:135], v[176:179], v[148:151], v[132:135]
    s_waitcnt lgkmcnt(0)
    s_barrier
    v_mfma_f32_16x16x32_bf16 v[24:27], v[196:199], v[180:183], v[24:27]
    ds_read_b128 v[136:139], v17 offset:0
    v_mfma_f32_16x16x32_bf16 v[52:55], v[196:199], v[184:187], v[52:55]
    ds_read_b128 v[140:143], v17 offset:2048
    v_mfma_f32_16x16x32_bf16 v[80:83], v[196:199], v[188:191], v[80:83]
    ds_read_b128 v[144:147], v17 offset:4096
    v_mfma_f32_16x16x32_bf16 v[108:111], v[196:199], v[192:195], v[108:111]
    ds_read_b128 v[148:151], v17 offset:6144
    v_mfma_f32_16x16x32_bf16 v[112:115], v[200:203], v[192:195], v[112:115]
    ds_read_b64_tr_b16 v[152:153], v18 offset:0
    v_mfma_f32_16x16x32_bf16 v[84:87], v[200:203], v[188:191], v[84:87]
    ds_read_b64_tr_b16 v[154:155], v18 offset:7168
    v_mfma_f32_16x16x32_bf16 v[56:59], v[200:203], v[184:187], v[56:59]
    v_mfma_f32_16x16x32_bf16 v[28:31], v[200:203], v[180:183], v[28:31]
    ds_read_b64_tr_b16 v[156:157], v19 offset:32
    v_mfma_f32_16x16x32_bf16 v[32:35], v[204:207], v[180:183], v[32:35]
    ds_read_b64_tr_b16 v[158:159], v19 offset:7200
    v_mfma_f32_16x16x32_bf16 v[60:63], v[204:207], v[184:187], v[60:63]
    ds_read_b64_tr_b16 v[160:161], v18 offset:64
    v_mfma_f32_16x16x32_bf16 v[88:91], v[204:207], v[188:191], v[88:91]
    ds_read_b64_tr_b16 v[162:163], v18 offset:7232
    v_mfma_f32_16x16x32_bf16 v[116:119], v[204:207], v[192:195], v[116:119]
    ds_read_b64_tr_b16 v[164:165], v19 offset:96
    v_mfma_f32_16x16x32_bf16 v[120:123], v[208:211], v[192:195], v[120:123]
    ds_read_b64_tr_b16 v[166:167], v19 offset:7264
    v_mfma_f32_16x16x32_bf16 v[92:95], v[208:211], v[188:191], v[92:95]
    v_mfma_f32_16x16x32_bf16 v[64:67], v[208:211], v[184:187], v[64:67]
    ds_read_b64_tr_b16 v[168:169], v18 offset:128
    v_mfma_f32_16x16x32_bf16 v[36:39], v[208:211], v[180:183], v[36:39]
    ds_read_b64_tr_b16 v[170:171], v18 offset:7296
    v_mfma_f32_16x16x32_bf16 v[40:43], v[212:215], v[180:183], v[40:43]
    ds_read_b64_tr_b16 v[172:173], v19 offset:160
    v_mfma_f32_16x16x32_bf16 v[68:71], v[212:215], v[184:187], v[68:71]
    ds_read_b64_tr_b16 v[174:175], v19 offset:7328
    v_mfma_f32_16x16x32_bf16 v[96:99], v[212:215], v[188:191], v[96:99]
    ds_read_b64_tr_b16 v[176:177], v20 offset:0
    v_mfma_f32_16x16x32_bf16 v[124:127], v[212:215], v[192:195], v[124:127]
    ds_read_b64_tr_b16 v[178:179], v20 offset:7168
    v_mfma_f32_16x16x32_bf16 v[128:131], v[216:219], v[192:195], v[128:131]
    s_add_u32 s43, s43, 1
    v_mfma_f32_16x16x32_bf16 v[100:103], v[216:219], v[188:191], v[100:103]
    s_cmp_lt_u32 s43, 15
    v_mfma_f32_16x16x32_bf16 v[72:75], v[216:219], v[184:187], v[72:75]
    v_mfma_f32_16x16x32_bf16 v[44:47], v[216:219], v[180:183], v[44:47]
    v_mfma_f32_16x16x32_bf16 v[48:51], v[220:223], v[180:183], v[48:51]
    v_mfma_f32_16x16x32_bf16 v[76:79], v[220:223], v[184:187], v[76:79]
    v_mfma_f32_16x16x32_bf16 v[104:107], v[220:223], v[188:191], v[104:107]
    v_mfma_f32_16x16x32_bf16 v[132:135], v[220:223], v[192:195], v[132:135]
    s_cbranch_scc1 mm_21
    s_waitcnt lgkmcnt(0)
    v_mfma_f32_16x16x32_bf16 v[24:27], v[152:155], v[136:139], v[24:27]
    ds_read_b128 v[180:183], v17 offset:1024
    v_mfma_f32_16x16x32_bf16 v[52:55], v[152:155], v[140:143], v[52:55]
    ds_read_b128 v[184:187], v17 offset:3072
    v_mfma_f32_16x16x32_bf16 v[80:83], v[152:155], v[144:147], v[80:83]
    ds_read_b128 v[188:191], v17 offset:5120
    v_mfma_f32_16x16x32_bf16 v[108:111], v[152:155], v[148:151], v[108:111]
    ds_read_b128 v[192:195], v17 offset:7168
    v_mfma_f32_16x16x32_bf16 v[112:115], v[156:159], v[148:151], v[112:115]
    ds_read_b64_tr_b16 v[196:197], v18 offset:14336
    v_mfma_f32_16x16x32_bf16 v[84:87], v[156:159], v[144:147], v[84:87]
    ds_read_b64_tr_b16 v[198:199], v18 offset:21504
    v_mfma_f32_16x16x32_bf16 v[56:59], v[156:159], v[140:143], v[56:59]
    v_mfma_f32_16x16x32_bf16 v[28:31], v[156:159], v[136:139], v[28:31]
    ds_read_b64_tr_b16 v[200:201], v19 offset:14368
    v_mfma_f32_16x16x32_bf16 v[32:35], v[160:163], v[136:139], v[32:35]
    ds_read_b64_tr_b16 v[202:203], v19 offset:21536
    v_mfma_f32_16x16x32_bf16 v[60:63], v[160:163], v[140:143], v[60:63]
    ds_read_b64_tr_b16 v[204:205], v18 offset:14400
    v_mfma_f32_16x16x32_bf16 v[88:91], v[160:163], v[144:147], v[88:91]
    ds_read_b64_tr_b16 v[206:207], v18 offset:21568
    v_mfma_f32_16x16x32_bf16 v[116:119], v[160:163], v[148:151], v[116:119]
    ds_read_b64_tr_b16 v[208:209], v19 offset:14432
    v_mfma_f32_16x16x32_bf16 v[120:123], v[164:167], v[148:151], v[120:123]
    ds_read_b64_tr_b16 v[210:211], v19 offset:21600
    v_mfma_f32_16x16x32_bf16 v[92:95], v[164:167], v[144:147], v[92:95]
    v_mfma_f32_16x16x32_bf16 v[64:67], v[164:167], v[140:143], v[64:67]
    ds_read_b64_tr_b16 v[212:213], v18 offset:14464
    v_mfma_f32_16x16x32_bf16 v[36:39], v[164:167], v[136:139], v[36:39]
    ds_read_b64_tr_b16 v[214:215], v18 offset:21632
    v_mfma_f32_16x16x32_bf16 v[40:43], v[168:171], v[136:139], v[40:43]
    ds_read_b64_tr_b16 v[216:217], v19 offset:14496
    v_mfma_f32_16x16x32_bf16 v[68:71], v[168:171], v[140:143], v[68:71]
    ds_read_b64_tr_b16 v[218:219], v19 offset:21664
    v_mfma_f32_16x16x32_bf16 v[96:99], v[168:171], v[144:147], v[96:99]
    ds_read_b64_tr_b16 v[220:221], v20 offset:14336
    v_mfma_f32_16x16x32_bf16 v[124:127], v[168:171], v[148:151], v[124:127]
    ds_read_b64_tr_b16 v[222:223], v20 offset:21504
    v_mfma_f32_16x16x32_bf16 v[128:131], v[172:175], v[148:151], v[128:131]
    v_mfma_f32_16x16x32_bf16 v[100:103], v[172:175], v[144:147], v[100:103]
    v_mfma_f32_16x16x32_bf16 v[72:75], v[172:175], v[140:143], v[72:75]
    v_mfma_f32_16x16x32_bf16 v[44:47], v[172:175], v[136:139], v[44:47]
    v_mfma_f32_16x16x32_bf16 v[48:51], v[176:179], v[136:139], v[48:51]
    v_mfma_f32_16x16x32_bf16 v[76:79], v[176:179], v[140:143], v[76:79]
    v_mfma_f32_16x16x32_bf16 v[104:107], v[176:179], v[144:147], v[104:107]
    v_mfma_f32_16x16x32_bf16 v[132:135], v[176:179], v[148:151], v[132:135]
    s_waitcnt lgkmcnt(0)
    s_barrier
    v_mfma_f32_16x16x32_bf16 v[24:27], v[196:199], v[180:183], v[24:27]
    s_mul_i32 s36, s35, 448
    s_add_u32 s36, s36, 159744
    v_lshlrev_b32 v6, 4, v23
    v_add_u32 v6, s36, v6
    v_mfma_f32_16x16x32_bf16 v[52:55], v[196:199], v[184:187], v[52:55]
    ds_read_b128 v[136:139], v6 offset:0
    ds_read_b128 v[140:143], v6 offset:64
    ds_read_b128 v[144:147], v6 offset:128
    v_mfma_f32_16x16x32_bf16 v[80:83], v[196:199], v[188:191], v[80:83]
    ds_read_b128 v[148:151], v6 offset:192
    ds_read_b128 v[152:155], v6 offset:256
    ds_read_b128 v[156:159], v6 offset:320
    v_mfma_f32_16x16x32_bf16 v[108:111], v[196:199], v[192:195], v[108:111]
    ds_read_b128 v[160:163], v6 offset:384
    s_lshl_b32 s36, s34, 9
    s_add_u32 s36, s36, 160768
    v_mfma_f32_16x16x32_bf16 v[112:115], v[200:203], v[192:195], v[112:115]
    v_lshlrev_b32 v7, 3, v22
    v_add_u32 v7, s36, v7
    ds_read_b64 v[164:165], v7 offset:0
    v_mfma_f32_16x16x32_bf16 v[84:87], v[200:203], v[188:191], v[84:87]
    ds_read_b64 v[166:167], v7 offset:128
    ds_read_b64 v[168:169], v7 offset:256
    ds_read_b64 v[170:171], v7 offset:384
    s_mov_b32 s16, s62
    v_mfma_f32_16x16x32_bf16 v[56:59], v[200:203], v[184:187], v[56:59]
    s_mov_b32 s17, s63
    s_mov_b32 s18, 0x1be000
    s_mov_b32 s19, 0x20000
    v_mfma_f32_16x16x32_bf16 v[28:31], v[200:203], v[180:183], v[28:31]
    s_mul_i32 s39, s37, 229376
    s_mul_i32 s40, s29, 7
    s_lshl2_add_u32 s41, s35, s40
    v_mfma_f32_16x16x32_bf16 v[32:35], v[204:207], v[180:183], v[32:35]
    s_add_u32 s36, s41, 0
    s_lshr_b32 s53, s36, 3
    s_lshl_b32 s53, s53, 14
    v_mfma_f32_16x16x32_bf16 v[60:63], v[204:207], v[184:187], v[60:63]
    s_and_b32 s44, s36, 7
    s_lshl_b32 s44, s44, 10
    s_add_u32 s44, s44, s53
    v_mfma_f32_16x16x32_bf16 v[88:91], v[204:207], v[188:191], v[88:91]
    s_add_u32 s44, s44, s39
    s_add_u32 s36, s41, 1
    s_lshr_b32 s53, s36, 3
    s_lshl_b32 s53, s53, 14
    v_mfma_f32_16x16x32_bf16 v[116:119], v[204:207], v[192:195], v[116:119]
    s_and_b32 s45, s36, 7
    s_lshl_b32 s45, s45, 10
    s_add_u32 s45, s45, s53
    v_mfma_f32_16x16x32_bf16 v[120:123], v[208:211], v[192:195], v[120:123]
    s_add_u32 s45, s45, s39
    s_add_u32 s36, s41, 2
    s_lshr_b32 s53, s36, 3
    v_mfma_f32_16x16x32_bf16 v[92:95], v[208:211], v[188:191], v[92:95]
    s_lshl_b32 s53, s53, 14
    s_and_b32 s46, s36, 7
    s_lshl_b32 s46, s46, 10
    v_mfma_f32_16x16x32_bf16 v[64:67], v[208:211], v[184:187], v[64:67]
    s_add_u32 s46, s46, s53
    s_add_u32 s46, s46, s39
    s_add_u32 s36, s40, 3
    v_mfma_f32_16x16x32_bf16 v[36:39], v[208:211], v[180:183], v[36:39]
    s_lshr_b32 s53, s36, 3
    s_lshl_b32 s53, s53, 14
    s_and_b32 s47, s36, 7
    s_lshl_b32 s47, s47, 10
    v_mfma_f32_16x16x32_bf16 v[40:43], v[212:215], v[180:183], v[40:43]
    s_add_u32 s47, s47, s53
    s_add_u32 s47, s47, s39
    s_lshl_b32 s36, s35, 9
    v_mfma_f32_16x16x32_bf16 v[68:71], v[212:215], v[184:187], v[68:71]
    s_add_u32 s47, s47, s36
    s_lshl_b32 s36, s37, 1
    s_add_u32 s36, s36, s35
    v_mfma_f32_16x16x32_bf16 v[96:99], v[212:215], v[188:191], v[96:99]
    s_lshl2_add_u32 s36, s31, s36
    s_lshl_b32 s36, s36, 10
    v_add_u32 v12, s36, v2
    v_mfma_f32_16x16x32_bf16 v[124:127], v[212:215], v[192:195], v[124:127]
    v_xor_b32 v17, 4096, v12
    v_lshrrev_b32 v254, 1, v23
    v_lshlrev_b32 v254, 8, v254
    v_mfma_f32_16x16x32_bf16 v[128:131], v[216:219], v[192:195], v[128:131]
    v_lshl_add_u32 v254, v22, 4, v254
    v_and_b32 v224, 1, v23
    v_lshl_add_u32 v254, v224, 3, v254
    v_mfma_f32_16x16x32_bf16 v[100:103], v[216:219], v[188:191], v[100:103]
    v_mfma_f32_16x16x32_bf16 v[72:75], v[216:219], v[184:187], v[72:75]
    v_mfma_f32_16x16x32_bf16 v[44:47], v[216:219], v[180:183], v[44:47]
    v_mfma_f32_16x16x32_bf16 v[48:51], v[220:223], v[180:183], v[48:51]
    v_mfma_f32_16x16x32_bf16 v[76:79], v[220:223], v[184:187], v[76:79]
    v_mfma_f32_16x16x32_bf16 v[104:107], v[220:223], v[188:191], v[104:107]
    v_mfma_f32_16x16x32_bf16 v[132:135], v[220:223], v[192:195], v[132:135]
    s_waitcnt lgkmcnt(0)
    v_mul_f32 v184, 0xc0135761, v165
    v_mul_f32 v185, v165, v165
    v_mul_f32 v185, v185, v184
    v_mul_f32 v185, 0x3d372713, v185
    v_rcp_f32 v165, v165
    v_mul_f32 v186, 0xc0135761, v167
    v_mul_f32 v187, v167, v167
    v_mul_f32 v187, v187, v186
    v_mul_f32 v187, 0x3d372713, v187
    v_rcp_f32 v167, v167
    v_mul_f32 v188, 0xc0135761, v169
    v_mul_f32 v189, v169, v169
    v_mul_f32 v189, v189, v188
    v_mul_f32 v189, 0x3d372713, v189
    v_rcp_f32 v169, v169
    v_mul_f32 v190, 0xc0135761, v171
    v_mul_f32 v191, v171, v171
    v_mul_f32 v191, v191, v190
    v_mul_f32 v191, 0x3d372713, v191
    v_rcp_f32 v171, v171
    v_pk_fma_f32 v[24:25], v[164:165], v[136:137], v[24:25] op_sel_hi:[0,1,1] neg_lo:[1,0,0] neg_hi:[1,0,0]
    v_pk_fma_f32 v[26:27], v[164:165], v[138:139], v[26:27] op_sel_hi:[0,1,1] neg_lo:[1,0,0] neg_hi:[1,0,0]
    v_pk_fma_f32 v[28:29], v[164:165], v[140:141], v[28:29] op_sel_hi:[0,1,1] neg_lo:[1,0,0] neg_hi:[1,0,0]
    v_pk_fma_f32 v[30:31], v[164:165], v[142:143], v[30:31] op_sel_hi:[0,1,1] neg_lo:[1,0,0] neg_hi:[1,0,0]
    v_pk_mul_f32 v[192:193], v[24:25], v[24:25]
    v_pk_mul_f32 v[194:195], v[26:27], v[26:27]
    v_pk_mul_f32 v[196:197], v[28:29], v[28:29]
    v_pk_mul_f32 v[198:199], v[30:31], v[30:31]
    v_pk_fma_f32 v[192:193], v[192:193], v[184:185], v[184:185] op_sel:[0,1,0] op_sel_hi:[1,1,0]
    v_pk_fma_f32 v[194:195], v[194:195], v[184:185], v[184:185] op_sel:[0,1,0] op_sel_hi:[1,1,0]
    v_pk_fma_f32 v[196:197], v[196:197], v[184:185], v[184:185] op_sel:[0,1,0] op_sel_hi:[1,1,0]
    v_pk_fma_f32 v[198:199], v[198:199], v[184:185], v[184:185] op_sel:[0,1,0] op_sel_hi:[1,1,0]
    v_pk_mul_f32 v[192:193], v[192:193], v[24:25]
    v_pk_mul_f32 v[194:195], v[194:195], v[26:27]
    v_pk_mul_f32 v[196:197], v[196:197], v[28:29]
    v_pk_mul_f32 v[198:199], v[198:199], v[30:31]
    v_exp_f32 v192, v192
    v_exp_f32 v193, v193
    v_exp_f32 v194, v194
    v_exp_f32 v195, v195
    v_exp_f32 v196, v196
    v_exp_f32 v197, v197
    v_exp_f32 v198, v198
    v_exp_f32 v199, v199
    v_pk_fma_f32 v[192:193], v[192:193], v[164:165], v[164:165] op_sel:[0,1,1] op_sel_hi:[1,1,1]
    v_pk_fma_f32 v[194:195], v[194:195], v[164:165], v[164:165] op_sel:[0,1,1] op_sel_hi:[1,1,1]
    v_pk_fma_f32 v[196:197], v[196:197], v[164:165], v[164:165] op_sel:[0,1,1] op_sel_hi:[1,1,1]
    v_pk_fma_f32 v[198:199], v[198:199], v[164:165], v[164:165] op_sel:[0,1,1] op_sel_hi:[1,1,1]
    v_rcp_f32 v192, v192
    v_rcp_f32 v193, v193
    v_rcp_f32 v194, v194
    v_rcp_f32 v195, v195
    v_rcp_f32 v196, v196
    v_rcp_f32 v197, v197
    v_rcp_f32 v198, v198
    v_rcp_f32 v199, v199
    v_pk_mul_f32 v[24:25], v[24:25], v[192:193]
    v_pk_mul_f32 v[26:27], v[26:27], v[194:195]
    v_pk_mul_f32 v[28:29], v[28:29], v[196:197]
    v_pk_mul_f32 v[30:31], v[30:31], v[198:199]
    v_cvt_pk_bf16_f32 v24, v24, v25
    v_cvt_pk_bf16_f32 v25, v26, v27
    v_cvt_pk_bf16_f32 v26, v28, v29
    v_cvt_pk_bf16_f32 v27, v30, v31
    ds_write_b128 v12, v[24:27] offset:0
    s_add_u32 s36, s44, 0
    buffer_store_dwordx4 v[24:27], v2, s[16:19], s36 offen sc1
    v_pk_fma_f32 v[52:53], v[166:167], v[136:137], v[52:53] op_sel_hi:[0,1,1] neg_lo:[1,0,0] neg_hi:[1,0,0]
    v_pk_fma_f32 v[54:55], v[166:167], v[138:139], v[54:55] op_sel_hi:[0,1,1] neg_lo:[1,0,0] neg_hi:[1,0,0]
    v_pk_fma_f32 v[56:57], v[166:167], v[140:141], v[56:57] op_sel_hi:[0,1,1] neg_lo:[1,0,0] neg_hi:[1,0,0]
    v_pk_fma_f32 v[58:59], v[166:167], v[142:143], v[58:59] op_sel_hi:[0,1,1] neg_lo:[1,0,0] neg_hi:[1,0,0]
    v_pk_mul_f32 v[192:193], v[52:53], v[52:53]
    v_pk_mul_f32 v[194:195], v[54:55], v[54:55]
    v_pk_mul_f32 v[196:197], v[56:57], v[56:57]
    v_pk_mul_f32 v[198:199], v[58:59], v[58:59]
    v_pk_fma_f32 v[192:193], v[192:193], v[186:187], v[186:187] op_sel:[0,1,0] op_sel_hi:[1,1,0]
    v_pk_fma_f32 v[194:195], v[194:195], v[186:187], v[186:187] op_sel:[0,1,0] op_sel_hi:[1,1,0]
    v_pk_fma_f32 v[196:197], v[196:197], v[186:187], v[186:187] op_sel:[0,1,0] op_sel_hi:[1,1,0]
    v_pk_fma_f32 v[198:199], v[198:199], v[186:187], v[186:187] op_sel:[0,1,0] op_sel_hi:[1,1,0]
    v_pk_mul_f32 v[192:193], v[192:193], v[52:53]
    v_pk_mul_f32 v[194:195], v[194:195], v[54:55]
    v_pk_mul_f32 v[196:197], v[196:197], v[56:57]
    v_pk_mul_f32 v[198:199], v[198:199], v[58:59]
    v_exp_f32 v192, v192
    v_exp_f32 v193, v193
    v_exp_f32 v194, v194
    v_exp_f32 v195, v195
    v_exp_f32 v196, v196
    v_exp_f32 v197, v197
    v_exp_f32 v198, v198
    v_exp_f32 v199, v199
    v_pk_fma_f32 v[192:193], v[192:193], v[166:167], v[166:167] op_sel:[0,1,1] op_sel_hi:[1,1,1]
    v_pk_fma_f32 v[194:195], v[194:195], v[166:167], v[166:167] op_sel:[0,1,1] op_sel_hi:[1,1,1]
    v_pk_fma_f32 v[196:197], v[196:197], v[166:167], v[166:167] op_sel:[0,1,1] op_sel_hi:[1,1,1]
    v_pk_fma_f32 v[198:199], v[198:199], v[166:167], v[166:167] op_sel:[0,1,1] op_sel_hi:[1,1,1]
    v_rcp_f32 v192, v192
    v_rcp_f32 v193, v193
    v_rcp_f32 v194, v194
    v_rcp_f32 v195, v195
    v_rcp_f32 v196, v196
    v_rcp_f32 v197, v197
    v_rcp_f32 v198, v198
    v_rcp_f32 v199, v199
    v_pk_mul_f32 v[52:53], v[52:53], v[192:193]
    v_pk_mul_f32 v[54:55], v[54:55], v[194:195]
    v_pk_mul_f32 v[56:57], v[56:57], v[196:197]
    v_pk_mul_f32 v[58:59], v[58:59], v[198:199]
    v_cvt_pk_bf16_f32 v52, v52, v53
    v_cvt_pk_bf16_f32 v53, v54, v55
    v_cvt_pk_bf16_f32 v54, v56, v57
    v_cvt_pk_bf16_f32 v55, v58, v59
    ds_write_b128 v12, v[52:55] offset:2048
    s_add_u32 s36, s44, 229376
    buffer_store_dwordx4 v[52:55], v2, s[16:19], s36 offen sc1
    v_pk_fma_f32 v[80:81], v[168:169], v[136:137], v[80:81] op_sel_hi:[0,1,1] neg_lo:[1,0,0] neg_hi:[1,0,0]
    v_pk_fma_f32 v[82:83], v[168:169], v[138:139], v[82:83] op_sel_hi:[0,1,1] neg_lo:[1,0,0] neg_hi:[1,0,0]
    v_pk_fma_f32 v[84:85], v[168:169], v[140:141], v[84:85] op_sel_hi:[0,1,1] neg_lo:[1,0,0] neg_hi:[1,0,0]
    v_pk_fma_f32 v[86:87], v[168:169], v[142:143], v[86:87] op_sel_hi:[0,1,1] neg_lo:[1,0,0] neg_hi:[1,0,0]
    v_pk_mul_f32 v[192:193], v[80:81], v[80:81]
    v_pk_mul_f32 v[194:195], v[82:83], v[82:83]
    v_pk_mul_f32 v[196:197], v[84:85], v[84:85]
    v_pk_mul_f32 v[198:199], v[86:87], v[86:87]
    v_pk_fma_f32 v[192:193], v[192:193], v[188:189], v[188:189] op_sel:[0,1,0] op_sel_hi:[1,1,0]
    v_pk_fma_f32 v[194:195], v[194:195], v[188:189], v[188:189] op_sel:[0,1,0] op_sel_hi:[1,1,0]
    v_pk_fma_f32 v[196:197], v[196:197], v[188:189], v[188:189] op_sel:[0,1,0] op_sel_hi:[1,1,0]
    v_pk_fma_f32 v[198:199], v[198:199], v[188:189], v[188:189] op_sel:[0,1,0] op_sel_hi:[1,1,0]
    v_pk_mul_f32 v[192:193], v[192:193], v[80:81]
    v_pk_mul_f32 v[194:195], v[194:195], v[82:83]
    v_pk_mul_f32 v[196:197], v[196:197], v[84:85]
    v_pk_mul_f32 v[198:199], v[198:199], v[86:87]
    v_exp_f32 v192, v192
    v_exp_f32 v193, v193
    v_exp_f32 v194, v194
    v_exp_f32 v195, v195
    v_exp_f32 v196, v196
    v_exp_f32 v197, v197
    v_exp_f32 v198, v198
    v_exp_f32 v199, v199
    v_pk_fma_f32 v[192:193], v[192:193], v[168:169], v[168:169] op_sel:[0,1,1] op_sel_hi:[1,1,1]
    v_pk_fma_f32 v[194:195], v[194:195], v[168:169], v[168:169] op_sel:[0,1,1] op_sel_hi:[1,1,1]
    v_pk_fma_f32 v[196:197], v[196:197], v[168:169], v[168:169] op_sel:[0,1,1] op_sel_hi:[1,1,1]
    v_pk_fma_f32 v[198:199], v[198:199], v[168:169], v[168:169] op_sel:[0,1,1] op_sel_hi:[1,1,1]
    v_rcp_f32 v192, v192
    v_rcp_f32 v193, v193
    v_rcp_f32 v194, v194
    v_rcp_f32 v195, v195
    v_rcp_f32 v196, v196
    v_rcp_f32 v197, v197
    v_rcp_f32 v198, v198
    v_rcp_f32 v199, v199
    v_pk_mul_f32 v[80:81], v[80:81], v[192:193]
    v_pk_mul_f32 v[82:83], v[82:83], v[194:195]
    v_pk_mul_f32 v[84:85], v[84:85], v[196:197]
    v_pk_mul_f32 v[86:87], v[86:87], v[198:199]
    v_cvt_pk_bf16_f32 v80, v80, v81
    v_cvt_pk_bf16_f32 v81, v82, v83
    v_cvt_pk_bf16_f32 v82, v84, v85
    v_cvt_pk_bf16_f32 v83, v86, v87
    ds_write_b128 v17, v[80:83] offset:0
    s_add_u32 s36, s44, 458752
    buffer_store_dwordx4 v[80:83], v2, s[16:19], s36 offen sc1
    v_pk_fma_f32 v[108:109], v[170:171], v[136:137], v[108:109] op_sel_hi:[0,1,1] neg_lo:[1,0,0] neg_hi:[1,0,0]
    v_pk_fma_f32 v[110:111], v[170:171], v[138:139], v[110:111] op_sel_hi:[0,1,1] neg_lo:[1,0,0] neg_hi:[1,0,0]
    v_pk_fma_f32 v[112:113], v[170:171], v[140:141], v[112:113] op_sel_hi:[0,1,1] neg_lo:[1,0,0] neg_hi:[1,0,0]
    v_pk_fma_f32 v[114:115], v[170:171], v[142:143], v[114:115] op_sel_hi:[0,1,1] neg_lo:[1,0,0] neg_hi:[1,0,0]
    v_pk_mul_f32 v[192:193], v[108:109], v[108:109]
    v_pk_mul_f32 v[194:195], v[110:111], v[110:111]
    v_pk_mul_f32 v[196:197], v[112:113], v[112:113]
    v_pk_mul_f32 v[198:199], v[114:115], v[114:115]
    v_pk_fma_f32 v[192:193], v[192:193], v[190:191], v[190:191] op_sel:[0,1,0] op_sel_hi:[1,1,0]
    v_pk_fma_f32 v[194:195], v[194:195], v[190:191], v[190:191] op_sel:[0,1,0] op_sel_hi:[1,1,0]
    v_pk_fma_f32 v[196:197], v[196:197], v[190:191], v[190:191] op_sel:[0,1,0] op_sel_hi:[1,1,0]
    v_pk_fma_f32 v[198:199], v[198:199], v[190:191], v[190:191] op_sel:[0,1,0] op_sel_hi:[1,1,0]
    v_pk_mul_f32 v[192:193], v[192:193], v[108:109]
    v_pk_mul_f32 v[194:195], v[194:195], v[110:111]
    v_pk_mul_f32 v[196:197], v[196:197], v[112:113]
    v_pk_mul_f32 v[198:199], v[198:199], v[114:115]
    v_exp_f32 v192, v192
    v_exp_f32 v193, v193
    v_exp_f32 v194, v194
    v_exp_f32 v195, v195
    v_exp_f32 v196, v196
    v_exp_f32 v197, v197
    v_exp_f32 v198, v198
    v_exp_f32 v199, v199
    v_pk_fma_f32 v[192:193], v[192:193], v[170:171], v[170:171] op_sel:[0,1,1] op_sel_hi:[1,1,1]
    v_pk_fma_f32 v[194:195], v[194:195], v[170:171], v[170:171] op_sel:[0,1,1] op_sel_hi:[1,1,1]
    v_pk_fma_f32 v[196:197], v[196:197], v[170:171], v[170:171] op_sel:[0,1,1] op_sel_hi:[1,1,1]
    v_pk_fma_f32 v[198:199], v[198:199], v[170:171], v[170:171] op_sel:[0,1,1] op_sel_hi:[1,1,1]
    v_rcp_f32 v192, v192
    v_rcp_f32 v193, v193
    v_rcp_f32 v194, v194
    v_rcp_f32 v195, v195
    v_rcp_f32 v196, v196
    v_rcp_f32 v197, v197
    v_rcp_f32 v198, v198
    v_rcp_f32 v199, v199
    v_pk_mul_f32 v[108:109], v[108:109], v[192:193]
    v_pk_mul_f32 v[110:111], v[110:111], v[194:195]
    v_pk_mul_f32 v[112:113], v[112:113], v[196:197]
    v_pk_mul_f32 v[114:115], v[114:115], v[198:199]
    v_cvt_pk_bf16_f32 v108, v108, v109
    v_cvt_pk_bf16_f32 v109, v110, v111
    v_cvt_pk_bf16_f32 v110, v112, v113
    v_cvt_pk_bf16_f32 v111, v114, v115
    ds_write_b128 v17, v[108:111] offset:2048
    s_add_u32 s36, s44, 688128
    buffer_store_dwordx4 v[108:111], v2, s[16:19], s36 offen sc1
    v_pk_fma_f32 v[32:33], v[164:165], v[144:145], v[32:33] op_sel_hi:[0,1,1] neg_lo:[1,0,0] neg_hi:[1,0,0]
    v_pk_fma_f32 v[34:35], v[164:165], v[146:147], v[34:35] op_sel_hi:[0,1,1] neg_lo:[1,0,0] neg_hi:[1,0,0]
    v_pk_fma_f32 v[36:37], v[164:165], v[148:149], v[36:37] op_sel_hi:[0,1,1] neg_lo:[1,0,0] neg_hi:[1,0,0]
    v_pk_fma_f32 v[38:39], v[164:165], v[150:151], v[38:39] op_sel_hi:[0,1,1] neg_lo:[1,0,0] neg_hi:[1,0,0]
    v_pk_mul_f32 v[192:193], v[32:33], v[32:33]
    v_pk_mul_f32 v[194:195], v[34:35], v[34:35]
    v_pk_mul_f32 v[196:197], v[36:37], v[36:37]
    v_pk_mul_f32 v[198:199], v[38:39], v[38:39]
    v_pk_fma_f32 v[192:193], v[192:193], v[184:185], v[184:185] op_sel:[0,1,0] op_sel_hi:[1,1,0]
    v_pk_fma_f32 v[194:195], v[194:195], v[184:185], v[184:185] op_sel:[0,1,0] op_sel_hi:[1,1,0]
    v_pk_fma_f32 v[196:197], v[196:197], v[184:185], v[184:185] op_sel:[0,1,0] op_sel_hi:[1,1,0]
    v_pk_fma_f32 v[198:199], v[198:199], v[184:185], v[184:185] op_sel:[0,1,0] op_sel_hi:[1,1,0]
    v_pk_mul_f32 v[192:193], v[192:193], v[32:33]
    v_pk_mul_f32 v[194:195], v[194:195], v[34:35]
    v_pk_mul_f32 v[196:197], v[196:197], v[36:37]
    v_pk_mul_f32 v[198:199], v[198:199], v[38:39]
    v_exp_f32 v192, v192
    v_exp_f32 v193, v193
    v_exp_f32 v194, v194
    v_exp_f32 v195, v195
    v_exp_f32 v196, v196
    v_exp_f32 v197, v197
    v_exp_f32 v198, v198
    v_exp_f32 v199, v199
    v_pk_fma_f32 v[192:193], v[192:193], v[164:165], v[164:165] op_sel:[0,1,1] op_sel_hi:[1,1,1]
    v_pk_fma_f32 v[194:195], v[194:195], v[164:165], v[164:165] op_sel:[0,1,1] op_sel_hi:[1,1,1]
    v_pk_fma_f32 v[196:197], v[196:197], v[164:165], v[164:165] op_sel:[0,1,1] op_sel_hi:[1,1,1]
    v_pk_fma_f32 v[198:199], v[198:199], v[164:165], v[164:165] op_sel:[0,1,1] op_sel_hi:[1,1,1]
    v_rcp_f32 v192, v192
    v_rcp_f32 v193, v193
    v_rcp_f32 v194, v194
    v_rcp_f32 v195, v195
    v_rcp_f32 v196, v196
    v_rcp_f32 v197, v197
    v_rcp_f32 v198, v198
    v_rcp_f32 v199, v199
    v_pk_mul_f32 v[32:33], v[32:33], v[192:193]
    v_pk_mul_f32 v[34:35], v[34:35], v[194:195]
    v_pk_mul_f32 v[36:37], v[36:37], v[196:197]
    v_pk_mul_f32 v[38:39], v[38:39], v[198:199]
    v_cvt_pk_bf16_f32 v32, v32, v33
    v_cvt_pk_bf16_f32 v33, v34, v35
    v_cvt_pk_bf16_f32 v34, v36, v37
    v_cvt_pk_bf16_f32 v35, v38, v39
    ds_write_b128 v12, v[32:35] offset:16384
    v_pk_fma_f32 v[60:61], v[166:167], v[144:145], v[60:61] op_sel_hi:[0,1,1] neg_lo:[1,0,0] neg_hi:[1,0,0]
    v_pk_fma_f32 v[62:63], v[166:167], v[146:147], v[62:63] op_sel_hi:[0,1,1] neg_lo:[1,0,0] neg_hi:[1,0,0]
    v_pk_fma_f32 v[64:65], v[166:167], v[148:149], v[64:65] op_sel_hi:[0,1,1] neg_lo:[1,0,0] neg_hi:[1,0,0]
    v_pk_fma_f32 v[66:67], v[166:167], v[150:151], v[66:67] op_sel_hi:[0,1,1] neg_lo:[1,0,0] neg_hi:[1,0,0]
    v_pk_mul_f32 v[192:193], v[60:61], v[60:61]
    v_pk_mul_f32 v[194:195], v[62:63], v[62:63]
    v_pk_mul_f32 v[196:197], v[64:65], v[64:65]
    v_pk_mul_f32 v[198:199], v[66:67], v[66:67]
    v_pk_fma_f32 v[192:193], v[192:193], v[186:187], v[186:187] op_sel:[0,1,0] op_sel_hi:[1,1,0]
    v_pk_fma_f32 v[194:195], v[194:195], v[186:187], v[186:187] op_sel:[0,1,0] op_sel_hi:[1,1,0]
    v_pk_fma_f32 v[196:197], v[196:197], v[186:187], v[186:187] op_sel:[0,1,0] op_sel_hi:[1,1,0]
    v_pk_fma_f32 v[198:199], v[198:199], v[186:187], v[186:187] op_sel:[0,1,0] op_sel_hi:[1,1,0]
    v_pk_mul_f32 v[192:193], v[192:193], v[60:61]
    v_pk_mul_f32 v[194:195], v[194:195], v[62:63]
    v_pk_mul_f32 v[196:197], v[196:197], v[64:65]
    v_pk_mul_f32 v[198:199], v[198:199], v[66:67]
    v_exp_f32 v192, v192
    v_exp_f32 v193, v193
    v_exp_f32 v194, v194
    v_exp_f32 v195, v195
    v_exp_f32 v196, v196
    v_exp_f32 v197, v197
    v_exp_f32 v198, v198
    v_exp_f32 v199, v199
    v_pk_fma_f32 v[192:193], v[192:193], v[166:167], v[166:167] op_sel:[0,1,1] op_sel_hi:[1,1,1]
    v_pk_fma_f32 v[194:195], v[194:195], v[166:167], v[166:167] op_sel:[0,1,1] op_sel_hi:[1,1,1]
    v_pk_fma_f32 v[196:197], v[196:197], v[166:167], v[166:167] op_sel:[0,1,1] op_sel_hi:[1,1,1]
    v_pk_fma_f32 v[198:199], v[198:199], v[166:167], v[166:167] op_sel:[0,1,1] op_sel_hi:[1,1,1]
    v_rcp_f32 v192, v192
    v_rcp_f32 v193, v193
    v_rcp_f32 v194, v194
    v_rcp_f32 v195, v195
    v_rcp_f32 v196, v196
    v_rcp_f32 v197, v197
    v_rcp_f32 v198, v198
    v_rcp_f32 v199, v199
    v_pk_mul_f32 v[60:61], v[60:61], v[192:193]
    v_pk_mul_f32 v[62:63], v[62:63], v[194:195]
    v_pk_mul_f32 v[64:65], v[64:65], v[196:197]
    v_pk_mul_f32 v[66:67], v[66:67], v[198:199]
    v_cvt_pk_bf16_f32 v60, v60, v61
    v_cvt_pk_bf16_f32 v61, v62, v63
    v_cvt_pk_bf16_f32 v62, v64, v65
    v_cvt_pk_bf16_f32 v63, v66, v67
    ds_write_b128 v12, v[60:63] offset:18432
    v_pk_fma_f32 v[88:89], v[168:169], v[144:145], v[88:89] op_sel_hi:[0,1,1] neg_lo:[1,0,0] neg_hi:[1,0,0]
    v_pk_fma_f32 v[90:91], v[168:169], v[146:147], v[90:91] op_sel_hi:[0,1,1] neg_lo:[1,0,0] neg_hi:[1,0,0]
    v_pk_fma_f32 v[92:93], v[168:169], v[148:149], v[92:93] op_sel_hi:[0,1,1] neg_lo:[1,0,0] neg_hi:[1,0,0]
    v_pk_fma_f32 v[94:95], v[168:169], v[150:151], v[94:95] op_sel_hi:[0,1,1] neg_lo:[1,0,0] neg_hi:[1,0,0]
    v_pk_mul_f32 v[192:193], v[88:89], v[88:89]
    v_pk_mul_f32 v[194:195], v[90:91], v[90:91]
    v_pk_mul_f32 v[196:197], v[92:93], v[92:93]
    v_pk_mul_f32 v[198:199], v[94:95], v[94:95]
    v_pk_fma_f32 v[192:193], v[192:193], v[188:189], v[188:189] op_sel:[0,1,0] op_sel_hi:[1,1,0]
    v_pk_fma_f32 v[194:195], v[194:195], v[188:189], v[188:189] op_sel:[0,1,0] op_sel_hi:[1,1,0]
    v_pk_fma_f32 v[196:197], v[196:197], v[188:189], v[188:189] op_sel:[0,1,0] op_sel_hi:[1,1,0]
    v_pk_fma_f32 v[198:199], v[198:199], v[188:189], v[188:189] op_sel:[0,1,0] op_sel_hi:[1,1,0]
    v_pk_mul_f32 v[192:193], v[192:193], v[88:89]
    v_pk_mul_f32 v[194:195], v[194:195], v[90:91]
    v_pk_mul_f32 v[196:197], v[196:197], v[92:93]
    v_pk_mul_f32 v[198:199], v[198:199], v[94:95]
    v_exp_f32 v192, v192
    v_exp_f32 v193, v193
    v_exp_f32 v194, v194
    v_exp_f32 v195, v195
    v_exp_f32 v196, v196
    v_exp_f32 v197, v197
    v_exp_f32 v198, v198
    v_exp_f32 v199, v199
    v_pk_fma_f32 v[192:193], v[192:193], v[168:169], v[168:169] op_sel:[0,1,1] op_sel_hi:[1,1,1]
    v_pk_fma_f32 v[194:195], v[194:195], v[168:169], v[168:169] op_sel:[0,1,1] op_sel_hi:[1,1,1]
    v_pk_fma_f32 v[196:197], v[196:197], v[168:169], v[168:169] op_sel:[0,1,1] op_sel_hi:[1,1,1]
    v_pk_fma_f32 v[198:199], v[198:199], v[168:169], v[168:169] op_sel:[0,1,1] op_sel_hi:[1,1,1]
    v_rcp_f32 v192, v192
    v_rcp_f32 v193, v193
    v_rcp_f32 v194, v194
    v_rcp_f32 v195, v195
    v_rcp_f32 v196, v196
    v_rcp_f32 v197, v197
    v_rcp_f32 v198, v198
    v_rcp_f32 v199, v199
    v_pk_mul_f32 v[88:89], v[88:89], v[192:193]
    v_pk_mul_f32 v[90:91], v[90:91], v[194:195]
    v_pk_mul_f32 v[92:93], v[92:93], v[196:197]
    v_pk_mul_f32 v[94:95], v[94:95], v[198:199]
    v_cvt_pk_bf16_f32 v88, v88, v89
    v_cvt_pk_bf16_f32 v89, v90, v91
    v_cvt_pk_bf16_f32 v90, v92, v93
    v_cvt_pk_bf16_f32 v91, v94, v95
    ds_write_b128 v17, v[88:91] offset:16384
    s_lshr_b32 s53, s30, 1
    s_lshl1_add_u32 s53, s31, s53
    s_lshl_b32 s53, s53, 7
    s_add_u32 s53, s53, s55
    s_add_u32 s53, s53, 0x1000
    v_mov_b32 v8, 1
    v_mov_b32 v9, 0
    s_mov_b64 exec, 1
    s_waitcnt vmcnt(0)
    buffer_atomic_add v8, v9, s[56:59], s53 offen sc1
    s_mov_b64 exec, -1
    v_pk_fma_f32 v[116:117], v[170:171], v[144:145], v[116:117] op_sel_hi:[0,1,1] neg_lo:[1,0,0] neg_hi:[1,0,0]
    v_pk_fma_f32 v[118:119], v[170:171], v[146:147], v[118:119] op_sel_hi:[0,1,1] neg_lo:[1,0,0] neg_hi:[1,0,0]
    v_pk_fma_f32 v[120:121], v[170:171], v[148:149], v[120:121] op_sel_hi:[0,1,1] neg_lo:[1,0,0] neg_hi:[1,0,0]
    v_pk_fma_f32 v[122:123], v[170:171], v[150:151], v[122:123] op_sel_hi:[0,1,1] neg_lo:[1,0,0] neg_hi:[1,0,0]
    v_pk_mul_f32 v[192:193], v[116:117], v[116:117]
    v_pk_mul_f32 v[194:195], v[118:119], v[118:119]
    v_pk_mul_f32 v[196:197], v[120:121], v[120:121]
    v_pk_mul_f32 v[198:199], v[122:123], v[122:123]
    v_pk_fma_f32 v[192:193], v[192:193], v[190:191], v[190:191] op_sel:[0,1,0] op_sel_hi:[1,1,0]
    v_pk_fma_f32 v[194:195], v[194:195], v[190:191], v[190:191] op_sel:[0,1,0] op_sel_hi:[1,1,0]
    v_pk_fma_f32 v[196:197], v[196:197], v[190:191], v[190:191] op_sel:[0,1,0] op_sel_hi:[1,1,0]
    v_pk_fma_f32 v[198:199], v[198:199], v[190:191], v[190:191] op_sel:[0,1,0] op_sel_hi:[1,1,0]
    v_pk_mul_f32 v[192:193], v[192:193], v[116:117]
    v_pk_mul_f32 v[194:195], v[194:195], v[118:119]
    v_pk_mul_f32 v[196:197], v[196:197], v[120:121]
    v_pk_mul_f32 v[198:199], v[198:199], v[122:123]
    v_exp_f32 v192, v192
    v_exp_f32 v193, v193
    v_exp_f32 v194, v194
    v_exp_f32 v195, v195
    v_exp_f32 v196, v196
    v_exp_f32 v197, v197
    v_exp_f32 v198, v198
    v_exp_f32 v199, v199
    v_pk_fma_f32 v[192:193], v[192:193], v[170:171], v[170:171] op_sel:[0,1,1] op_sel_hi:[1,1,1]
    v_pk_fma_f32 v[194:195], v[194:195], v[170:171], v[170:171] op_sel:[0,1,1] op_sel_hi:[1,1,1]
    v_pk_fma_f32 v[196:197], v[196:197], v[170:171], v[170:171] op_sel:[0,1,1] op_sel_hi:[1,1,1]
    v_pk_fma_f32 v[198:199], v[198:199], v[170:171], v[170:171] op_sel:[0,1,1] op_sel_hi:[1,1,1]
    v_rcp_f32 v192, v192
    v_rcp_f32 v193, v193
    v_rcp_f32 v194, v194
    v_rcp_f32 v195, v195
    v_rcp_f32 v196, v196
    v_rcp_f32 v197, v197
    v_rcp_f32 v198, v198
    v_rcp_f32 v199, v199
    v_pk_mul_f32 v[116:117], v[116:117], v[192:193]
    v_pk_mul_f32 v[118:119], v[118:119], v[194:195]
    v_pk_mul_f32 v[120:121], v[120:121], v[196:197]
    v_pk_mul_f32 v[122:123], v[122:123], v[198:199]
    v_cvt_pk_bf16_f32 v116, v116, v117
    v_cvt_pk_bf16_f32 v117, v118, v119
    v_cvt_pk_bf16_f32 v118, v120, v121
    v_cvt_pk_bf16_f32 v119, v122, v123
    ds_write_b128 v17, v[116:119] offset:18432
    v_pk_fma_f32 v[40:41], v[164:165], v[152:153], v[40:41] op_sel_hi:[0,1,1] neg_lo:[1,0,0] neg_hi:[1,0,0]
    v_pk_fma_f32 v[42:43], v[164:165], v[154:155], v[42:43] op_sel_hi:[0,1,1] neg_lo:[1,0,0] neg_hi:[1,0,0]
    v_pk_fma_f32 v[44:45], v[164:165], v[156:157], v[44:45] op_sel_hi:[0,1,1] neg_lo:[1,0,0] neg_hi:[1,0,0]
    v_pk_fma_f32 v[46:47], v[164:165], v[158:159], v[46:47] op_sel_hi:[0,1,1] neg_lo:[1,0,0] neg_hi:[1,0,0]
    v_pk_mul_f32 v[192:193], v[40:41], v[40:41]
    v_pk_mul_f32 v[194:195], v[42:43], v[42:43]
    v_pk_mul_f32 v[196:197], v[44:45], v[44:45]
    v_pk_mul_f32 v[198:199], v[46:47], v[46:47]
    v_pk_fma_f32 v[192:193], v[192:193], v[184:185], v[184:185] op_sel:[0,1,0] op_sel_hi:[1,1,0]
    v_pk_fma_f32 v[194:195], v[194:195], v[184:185], v[184:185] op_sel:[0,1,0] op_sel_hi:[1,1,0]
    v_pk_fma_f32 v[196:197], v[196:197], v[184:185], v[184:185] op_sel:[0,1,0] op_sel_hi:[1,1,0]
    v_pk_fma_f32 v[198:199], v[198:199], v[184:185], v[184:185] op_sel:[0,1,0] op_sel_hi:[1,1,0]
    v_pk_mul_f32 v[192:193], v[192:193], v[40:41]
    v_pk_mul_f32 v[194:195], v[194:195], v[42:43]
    v_pk_mul_f32 v[196:197], v[196:197], v[44:45]
    v_pk_mul_f32 v[198:199], v[198:199], v[46:47]
    v_exp_f32 v192, v192
    v_exp_f32 v193, v193
    v_exp_f32 v194, v194
    v_exp_f32 v195, v195
    v_exp_f32 v196, v196
    v_exp_f32 v197, v197
    v_exp_f32 v198, v198
    v_exp_f32 v199, v199
    v_pk_fma_f32 v[192:193], v[192:193], v[164:165], v[164:165] op_sel:[0,1,1] op_sel_hi:[1,1,1]
    v_pk_fma_f32 v[194:195], v[194:195], v[164:165], v[164:165] op_sel:[0,1,1] op_sel_hi:[1,1,1]
    v_pk_fma_f32 v[196:197], v[196:197], v[164:165], v[164:165] op_sel:[0,1,1] op_sel_hi:[1,1,1]
    v_pk_fma_f32 v[198:199], v[198:199], v[164:165], v[164:165] op_sel:[0,1,1] op_sel_hi:[1,1,1]
    v_rcp_f32 v192, v192
    v_rcp_f32 v193, v193
    v_rcp_f32 v194, v194
    v_rcp_f32 v195, v195
    v_rcp_f32 v196, v196
    v_rcp_f32 v197, v197
    v_rcp_f32 v198, v198
    v_rcp_f32 v199, v199
    v_pk_mul_f32 v[40:41], v[40:41], v[192:193]
    v_pk_mul_f32 v[42:43], v[42:43], v[194:195]
    v_pk_mul_f32 v[44:45], v[44:45], v[196:197]
    v_pk_mul_f32 v[46:47], v[46:47], v[198:199]
    v_cvt_pk_bf16_f32 v230, v40, v41
    v_cvt_pk_bf16_f32 v231, v42, v43
    v_cvt_pk_bf16_f32 v232, v44, v45
    v_cvt_pk_bf16_f32 v233, v46, v47
    ds_write_b128 v12, v[230:233] offset:32768
    v_pk_fma_f32 v[68:69], v[166:167], v[152:153], v[68:69] op_sel_hi:[0,1,1] neg_lo:[1,0,0] neg_hi:[1,0,0]
    v_pk_fma_f32 v[70:71], v[166:167], v[154:155], v[70:71] op_sel_hi:[0,1,1] neg_lo:[1,0,0] neg_hi:[1,0,0]
    v_pk_fma_f32 v[72:73], v[166:167], v[156:157], v[72:73] op_sel_hi:[0,1,1] neg_lo:[1,0,0] neg_hi:[1,0,0]
    v_pk_fma_f32 v[74:75], v[166:167], v[158:159], v[74:75] op_sel_hi:[0,1,1] neg_lo:[1,0,0] neg_hi:[1,0,0]
    v_pk_mul_f32 v[192:193], v[68:69], v[68:69]
    v_pk_mul_f32 v[194:195], v[70:71], v[70:71]
    v_pk_mul_f32 v[196:197], v[72:73], v[72:73]
    v_pk_mul_f32 v[198:199], v[74:75], v[74:75]
    v_pk_fma_f32 v[192:193], v[192:193], v[186:187], v[186:187] op_sel:[0,1,0] op_sel_hi:[1,1,0]
    v_pk_fma_f32 v[194:195], v[194:195], v[186:187], v[186:187] op_sel:[0,1,0] op_sel_hi:[1,1,0]
    v_pk_fma_f32 v[196:197], v[196:197], v[186:187], v[186:187] op_sel:[0,1,0] op_sel_hi:[1,1,0]
    v_pk_fma_f32 v[198:199], v[198:199], v[186:187], v[186:187] op_sel:[0,1,0] op_sel_hi:[1,1,0]
    v_pk_mul_f32 v[192:193], v[192:193], v[68:69]
    v_pk_mul_f32 v[194:195], v[194:195], v[70:71]
    v_pk_mul_f32 v[196:197], v[196:197], v[72:73]
    v_pk_mul_f32 v[198:199], v[198:199], v[74:75]
    v_exp_f32 v192, v192
    v_exp_f32 v193, v193
    v_exp_f32 v194, v194
    v_exp_f32 v195, v195
    v_exp_f32 v196, v196
    v_exp_f32 v197, v197
    v_exp_f32 v198, v198
    v_exp_f32 v199, v199
    v_pk_fma_f32 v[192:193], v[192:193], v[166:167], v[166:167] op_sel:[0,1,1] op_sel_hi:[1,1,1]
    v_pk_fma_f32 v[194:195], v[194:195], v[166:167], v[166:167] op_sel:[0,1,1] op_sel_hi:[1,1,1]
    v_pk_fma_f32 v[196:197], v[196:197], v[166:167], v[166:167] op_sel:[0,1,1] op_sel_hi:[1,1,1]
    v_pk_fma_f32 v[198:199], v[198:199], v[166:167], v[166:167] op_sel:[0,1,1] op_sel_hi:[1,1,1]
    v_rcp_f32 v192, v192
    v_rcp_f32 v193, v193
    v_rcp_f32 v194, v194
    v_rcp_f32 v195, v195
    v_rcp_f32 v196, v196
    v_rcp_f32 v197, v197
    v_rcp_f32 v198, v198
    v_rcp_f32 v199, v199
    v_pk_mul_f32 v[68:69], v[68:69], v[192:193]
    v_pk_mul_f32 v[70:71], v[70:71], v[194:195]
    v_pk_mul_f32 v[72:73], v[72:73], v[196:197]
    v_pk_mul_f32 v[74:75], v[74:75], v[198:199]
    v_cvt_pk_bf16_f32 v234, v68, v69
    v_cvt_pk_bf16_f32 v235, v70, v71
    v_cvt_pk_bf16_f32 v236, v72, v73
    v_cvt_pk_bf16_f32 v237, v74, v75
    ds_write_b128 v12, v[234:237] offset:34816
    v_pk_fma_f32 v[96:97], v[168:169], v[152:153], v[96:97] op_sel_hi:[0,1,1] neg_lo:[1,0,0] neg_hi:[1,0,0]
    v_pk_fma_f32 v[98:99], v[168:169], v[154:155], v[98:99] op_sel_hi:[0,1,1] neg_lo:[1,0,0] neg_hi:[1,0,0]
    v_pk_fma_f32 v[100:101], v[168:169], v[156:157], v[100:101] op_sel_hi:[0,1,1] neg_lo:[1,0,0] neg_hi:[1,0,0]
    v_pk_fma_f32 v[102:103], v[168:169], v[158:159], v[102:103] op_sel_hi:[0,1,1] neg_lo:[1,0,0] neg_hi:[1,0,0]
    v_pk_mul_f32 v[192:193], v[96:97], v[96:97]
    v_pk_mul_f32 v[194:195], v[98:99], v[98:99]
    v_pk_mul_f32 v[196:197], v[100:101], v[100:101]
    v_pk_mul_f32 v[198:199], v[102:103], v[102:103]
    v_pk_fma_f32 v[192:193], v[192:193], v[188:189], v[188:189] op_sel:[0,1,0] op_sel_hi:[1,1,0]
    v_pk_fma_f32 v[194:195], v[194:195], v[188:189], v[188:189] op_sel:[0,1,0] op_sel_hi:[1,1,0]
    v_pk_fma_f32 v[196:197], v[196:197], v[188:189], v[188:189] op_sel:[0,1,0] op_sel_hi:[1,1,0]
    v_pk_fma_f32 v[198:199], v[198:199], v[188:189], v[188:189] op_sel:[0,1,0] op_sel_hi:[1,1,0]
    v_pk_mul_f32 v[192:193], v[192:193], v[96:97]
    v_pk_mul_f32 v[194:195], v[194:195], v[98:99]
    v_pk_mul_f32 v[196:197], v[196:197], v[100:101]
    v_pk_mul_f32 v[198:199], v[198:199], v[102:103]
    v_exp_f32 v192, v192
    v_exp_f32 v193, v193
    v_exp_f32 v194, v194
    v_exp_f32 v195, v195
    v_exp_f32 v196, v196
    v_exp_f32 v197, v197
    v_exp_f32 v198, v198
    v_exp_f32 v199, v199
    v_pk_fma_f32 v[192:193], v[192:193], v[168:169], v[168:169] op_sel:[0,1,1] op_sel_hi:[1,1,1]
    v_pk_fma_f32 v[194:195], v[194:195], v[168:169], v[168:169] op_sel:[0,1,1] op_sel_hi:[1,1,1]
    v_pk_fma_f32 v[196:197], v[196:197], v[168:169], v[168:169] op_sel:[0,1,1] op_sel_hi:[1,1,1]
    v_pk_fma_f32 v[198:199], v[198:199], v[168:169], v[168:169] op_sel:[0,1,1] op_sel_hi:[1,1,1]
    v_rcp_f32 v192, v192
    v_rcp_f32 v193, v193
    v_rcp_f32 v194, v194
    v_rcp_f32 v195, v195
    v_rcp_f32 v196, v196
    v_rcp_f32 v197, v197
    v_rcp_f32 v198, v198
    v_rcp_f32 v199, v199
    v_pk_mul_f32 v[96:97], v[96:97], v[192:193]
    v_pk_mul_f32 v[98:99], v[98:99], v[194:195]
    v_pk_mul_f32 v[100:101], v[100:101], v[196:197]
    v_pk_mul_f32 v[102:103], v[102:103], v[198:199]
    v_cvt_pk_bf16_f32 v238, v96, v97
    v_cvt_pk_bf16_f32 v239, v98, v99
    v_cvt_pk_bf16_f32 v240, v100, v101
    v_cvt_pk_bf16_f32 v241, v102, v103
    ds_write_b128 v17, v[238:241] offset:32768
    v_pk_fma_f32 v[124:125], v[170:171], v[152:153], v[124:125] op_sel_hi:[0,1,1] neg_lo:[1,0,0] neg_hi:[1,0,0]
    v_pk_fma_f32 v[126:127], v[170:171], v[154:155], v[126:127] op_sel_hi:[0,1,1] neg_lo:[1,0,0] neg_hi:[1,0,0]
    v_pk_fma_f32 v[128:129], v[170:171], v[156:157], v[128:129] op_sel_hi:[0,1,1] neg_lo:[1,0,0] neg_hi:[1,0,0]
    v_pk_fma_f32 v[130:131], v[170:171], v[158:159], v[130:131] op_sel_hi:[0,1,1] neg_lo:[1,0,0] neg_hi:[1,0,0]
    v_pk_mul_f32 v[192:193], v[124:125], v[124:125]
    v_pk_mul_f32 v[194:195], v[126:127], v[126:127]
    v_pk_mul_f32 v[196:197], v[128:129], v[128:129]
    v_pk_mul_f32 v[198:199], v[130:131], v[130:131]
    v_pk_fma_f32 v[192:193], v[192:193], v[190:191], v[190:191] op_sel:[0,1,0] op_sel_hi:[1,1,0]
    v_pk_fma_f32 v[194:195], v[194:195], v[190:191], v[190:191] op_sel:[0,1,0] op_sel_hi:[1,1,0]
    v_pk_fma_f32 v[196:197], v[196:197], v[190:191], v[190:191] op_sel:[0,1,0] op_sel_hi:[1,1,0]
    v_pk_fma_f32 v[198:199], v[198:199], v[190:191], v[190:191] op_sel:[0,1,0] op_sel_hi:[1,1,0]
    v_pk_mul_f32 v[192:193], v[192:193], v[124:125]
    v_pk_mul_f32 v[194:195], v[194:195], v[126:127]
    v_pk_mul_f32 v[196:197], v[196:197], v[128:129]
    v_pk_mul_f32 v[198:199], v[198:199], v[130:131]
    v_exp_f32 v192, v192
    v_exp_f32 v193, v193
    v_exp_f32 v194, v194
    v_exp_f32 v195, v195
    v_exp_f32 v196, v196
    v_exp_f32 v197, v197
    v_exp_f32 v198, v198
    v_exp_f32 v199, v199
    v_pk_fma_f32 v[192:193], v[192:193], v[170:171], v[170:171] op_sel:[0,1,1] op_sel_hi:[1,1,1]
    v_pk_fma_f32 v[194:195], v[194:195], v[170:171], v[170:171] op_sel:[0,1,1] op_sel_hi:[1,1,1]
    v_pk_fma_f32 v[196:197], v[196:197], v[170:171], v[170:171] op_sel:[0,1,1] op_sel_hi:[1,1,1]
    v_pk_fma_f32 v[198:199], v[198:199], v[170:171], v[170:171] op_sel:[0,1,1] op_sel_hi:[1,1,1]
    v_rcp_f32 v192, v192
    v_rcp_f32 v193, v193
    v_rcp_f32 v194, v194
    v_rcp_f32 v195, v195
    v_rcp_f32 v196, v196
    v_rcp_f32 v197, v197
    v_rcp_f32 v198, v198
    v_rcp_f32 v199, v199
    v_pk_mul_f32 v[124:125], v[124:125], v[192:193]
    v_pk_mul_f32 v[126:127], v[126:127], v[194:195]
    v_pk_mul_f32 v[128:129], v[128:129], v[196:197]
    v_pk_mul_f32 v[130:131], v[130:131], v[198:199]
    v_cvt_pk_bf16_f32 v242, v124, v125
    v_cvt_pk_bf16_f32 v243, v126, v127
    v_cvt_pk_bf16_f32 v244, v128, v129
    v_cvt_pk_bf16_f32 v245, v130, v131
    ds_write_b128 v17, v[242:245] offset:34816
    v_pk_fma_f32 v[48:49], v[164:165], v[160:161], v[48:49] op_sel_hi:[0,1,1] neg_lo:[1,0,0] neg_hi:[1,0,0]
    v_pk_fma_f32 v[50:51], v[164:165], v[162:163], v[50:51] op_sel_hi:[0,1,1] neg_lo:[1,0,0] neg_hi:[1,0,0]
    v_pk_fma_f32 v[76:77], v[166:167], v[160:161], v[76:77] op_sel_hi:[0,1,1] neg_lo:[1,0,0] neg_hi:[1,0,0]
    v_pk_fma_f32 v[78:79], v[166:167], v[162:163], v[78:79] op_sel_hi:[0,1,1] neg_lo:[1,0,0] neg_hi:[1,0,0]
    v_pk_mul_f32 v[192:193], v[48:49], v[48:49]
    v_pk_mul_f32 v[194:195], v[50:51], v[50:51]
    v_pk_mul_f32 v[196:197], v[76:77], v[76:77]
    v_pk_mul_f32 v[198:199], v[78:79], v[78:79]
    v_pk_fma_f32 v[192:193], v[192:193], v[184:185], v[184:185] op_sel:[0,1,0] op_sel_hi:[1,1,0]
    v_pk_fma_f32 v[194:195], v[194:195], v[184:185], v[184:185] op_sel:[0,1,0] op_sel_hi:[1,1,0]
    v_pk_fma_f32 v[196:197], v[196:197], v[186:187], v[186:187] op_sel:[0,1,0] op_sel_hi:[1,1,0]
    v_pk_fma_f32 v[198:199], v[198:199], v[186:187], v[186:187] op_sel:[0,1,0] op_sel_hi:[1,1,0]
    v_pk_mul_f32 v[192:193], v[192:193], v[48:49]
    v_pk_mul_f32 v[194:195], v[194:195], v[50:51]
    v_pk_mul_f32 v[196:197], v[196:197], v[76:77]
    v_pk_mul_f32 v[198:199], v[198:199], v[78:79]
    v_exp_f32 v192, v192
    v_exp_f32 v193, v193
    v_exp_f32 v194, v194
    v_exp_f32 v195, v195
    v_exp_f32 v196, v196
    v_exp_f32 v197, v197
    v_exp_f32 v198, v198
    v_exp_f32 v199, v199
    v_pk_fma_f32 v[192:193], v[192:193], v[164:165], v[164:165] op_sel:[0,1,1] op_sel_hi:[1,1,1]
    v_pk_fma_f32 v[194:195], v[194:195], v[164:165], v[164:165] op_sel:[0,1,1] op_sel_hi:[1,1,1]
    v_pk_fma_f32 v[196:197], v[196:197], v[166:167], v[166:167] op_sel:[0,1,1] op_sel_hi:[1,1,1]
    v_pk_fma_f32 v[198:199], v[198:199], v[166:167], v[166:167] op_sel:[0,1,1] op_sel_hi:[1,1,1]
    v_rcp_f32 v192, v192
    v_rcp_f32 v193, v193
    v_rcp_f32 v194, v194
    v_rcp_f32 v195, v195
    v_rcp_f32 v196, v196
    v_rcp_f32 v197, v197
    v_rcp_f32 v198, v198
    v_rcp_f32 v199, v199
    v_pk_mul_f32 v[48:49], v[48:49], v[192:193]
    v_pk_mul_f32 v[50:51], v[50:51], v[194:195]
    v_pk_mul_f32 v[76:77], v[76:77], v[196:197]
    v_pk_mul_f32 v[78:79], v[78:79], v[198:199]
    v_cvt_pk_bf16_f32 v246, v48, v49
    v_cvt_pk_bf16_f32 v247, v50, v51
    s_add_u32 s36, s45, 0
    buffer_store_dwordx4 v[32:35], v2, s[16:19], s36 offen sc1
    v_cvt_pk_bf16_f32 v248, v76, v77
    v_cvt_pk_bf16_f32 v249, v78, v79
    s_add_u32 s36, s45, 229376
    buffer_store_dwordx4 v[60:63], v2, s[16:19], s36 offen sc1
    v_pk_fma_f32 v[104:105], v[168:169], v[160:161], v[104:105] op_sel_hi:[0,1,1] neg_lo:[1,0,0] neg_hi:[1,0,0]
    v_pk_fma_f32 v[106:107], v[168:169], v[162:163], v[106:107] op_sel_hi:[0,1,1] neg_lo:[1,0,0] neg_hi:[1,0,0]
    v_pk_fma_f32 v[132:133], v[170:171], v[160:161], v[132:133] op_sel_hi:[0,1,1] neg_lo:[1,0,0] neg_hi:[1,0,0]
    v_pk_fma_f32 v[134:135], v[170:171], v[162:163], v[134:135] op_sel_hi:[0,1,1] neg_lo:[1,0,0] neg_hi:[1,0,0]
    v_pk_mul_f32 v[192:193], v[104:105], v[104:105]
    v_pk_mul_f32 v[194:195], v[106:107], v[106:107]
    v_pk_mul_f32 v[196:197], v[132:133], v[132:133]
    v_pk_mul_f32 v[198:199], v[134:135], v[134:135]
    v_pk_fma_f32 v[192:193], v[192:193], v[188:189], v[188:189] op_sel:[0,1,0] op_sel_hi:[1,1,0]
    v_pk_fma_f32 v[194:195], v[194:195], v[188:189], v[188:189] op_sel:[0,1,0] op_sel_hi:[1,1,0]
    v_pk_fma_f32 v[196:197], v[196:197], v[190:191], v[190:191] op_sel:[0,1,0] op_sel_hi:[1,1,0]
    v_pk_fma_f32 v[198:199], v[198:199], v[190:191], v[190:191] op_sel:[0,1,0] op_sel_hi:[1,1,0]
    v_pk_mul_f32 v[192:193], v[192:193], v[104:105]
    v_pk_mul_f32 v[194:195], v[194:195], v[106:107]
    v_pk_mul_f32 v[196:197], v[196:197], v[132:133]
    v_pk_mul_f32 v[198:199], v[198:199], v[134:135]
    v_exp_f32 v192, v192
    v_exp_f32 v193, v193
    v_exp_f32 v194, v194
    v_exp_f32 v195, v195
    v_exp_f32 v196, v196
    v_exp_f32 v197, v197
    v_exp_f32 v198, v198
    v_exp_f32 v199, v199
    v_pk_fma_f32 v[192:193], v[192:193], v[168:169], v[168:169] op_sel:[0,1,1] op_sel_hi:[1,1,1]
    v_pk_fma_f32 v[194:195], v[194:195], v[168:169], v[168:169] op_sel:[0,1,1] op_sel_hi:[1,1,1]
    v_pk_fma_f32 v[196:197], v[196:197], v[170:171], v[170:171] op_sel:[0,1,1] op_sel_hi:[1,1,1]
    v_pk_fma_f32 v[198:199], v[198:199], v[170:171], v[170:171] op_sel:[0,1,1] op_sel_hi:[1,1,1]
    v_rcp_f32 v192, v192
    v_rcp_f32 v193, v193
    v_rcp_f32 v194, v194
    v_rcp_f32 v195, v195
    v_rcp_f32 v196, v196
    v_rcp_f32 v197, v197
    v_rcp_f32 v198, v198
    v_rcp_f32 v199, v199
    v_pk_mul_f32 v[104:105], v[104:105], v[192:193]
    v_pk_mul_f32 v[106:107], v[106:107], v[194:195]
    v_pk_mul_f32 v[132:133], v[132:133], v[196:197]
    v_pk_mul_f32 v[134:135], v[134:135], v[198:199]
    v_cvt_pk_bf16_f32 v250, v104, v105
    v_cvt_pk_bf16_f32 v251, v106, v107
    s_add_u32 s36, s45, 458752
    buffer_store_dwordx4 v[88:91], v2, s[16:19], s36 offen sc1
    v_cvt_pk_bf16_f32 v252, v132, v133
    v_cvt_pk_bf16_f32 v253, v134, v135
    s_add_u32 s36, s45, 688128
    buffer_store_dwordx4 v[116:119], v2, s[16:19], s36 offen sc1
    s_waitcnt lgkmcnt(0)
    s_lshr_b32 s34, s30, 1
    s_and_b32 s35, s30, 1
    v_and_b32 v22, 15, v1
    v_lshrrev_b32 v23, 4, v1
    s_mul_i32 s37, s34, 4
    s_mul_i32 s38, s33, 8
    s_mul_i32 s36, s35, 4
    s_add_u32 s38, s38, s36
    s_lshr_b32 s36, s38, 1
    s_lshr_b32 s53, s36, 3
    s_lshl_b32 s53, s53, 14
    s_and_b32 s39, s36, 7
    s_lshl_b32 s39, s39, 10
    s_add_u32 s39, s39, s53
    s_lshl_b32 s36, s37, 16
    s_add_u32 s39, s39, s36
    s_mul_i32 s36, s34, 8192
    v_add_u32 v12, s36, v2
    v_lshrrev_b32 v6, 2, v1
    v_mul_u32_u24 v13, 256, v6
    v_and_b32 v7, 3, v1
    v_lshl_add_u32 v13, v7, 3, v13
    v_add_u32 v13, 49152, v13
    v_and_b32 v6, 7, v6
    s_mul_i32 s36, s35, 4
    s_add_u32 s36, s36, 3
    v_xor_b32 v7, s36, v6
    v_lshl_add_u32 v16, v7, 5, v13
    s_mul_i32 s36, s35, 4
    s_add_u32 s36, s36, 2
    v_xor_b32 v7, s36, v6
    v_lshl_add_u32 v15, v7, 5, v13
    s_mul_i32 s36, s35, 4
    s_add_u32 s36, s36, 1
    v_xor_b32 v7, s36, v6
    v_lshl_add_u32 v14, v7, 5, v13
    s_mul_i32 s36, s35, 4
    s_add_u32 s36, s36, 0
    v_xor_b32 v7, s36, v6
    v_lshl_add_u32 v13, v7, 5, v13
    s_mov_b32 s42, 0
    s_mov_b32 s43, 0
    s_mov_b32 s48, 0
    v_mov_b32 v17, v12
    v_mov_b32 v18, v13
    v_mov_b32 v19, v14
    v_mov_b32 v20, v15
    v_mov_b32 v21, v16
    s_waitcnt lgkmcnt(0)
    s_barrier
    ds_read_b128 v[24:27], v17 offset:0
    ds_read_b128 v[28:31], v17 offset:2048
    ds_read_b128 v[32:35], v17 offset:4096
    ds_read_b128 v[36:39], v17 offset:6144
    ds_read_b64_tr_b16 v[40:41], v18 offset:0
    ds_read_b64_tr_b16 v[42:43], v18 offset:4096
    ds_read_b64_tr_b16 v[44:45], v19 offset:0
    ds_read_b64_tr_b16 v[46:47], v19 offset:4096
    ds_read_b64_tr_b16 v[48:49], v20 offset:0
    ds_read_b64_tr_b16 v[50:51], v20 offset:4096
    ds_read_b64_tr_b16 v[52:53], v21 offset:0
    ds_read_b64_tr_b16 v[54:55], v21 offset:4096
    s_waitcnt lgkmcnt(0)
    v_mfma_f32_16x16x32_bf16 v[120:123], v[40:43], v[24:27], 0
    ds_read_b128 v[184:187], v17 offset:1024
    ds_read_b128 v[188:191], v17 offset:3072
    v_mfma_f32_16x16x32_bf16 v[136:139], v[40:43], v[28:31], 0
    ds_read_b128 v[192:195], v17 offset:5120
    v_mfma_f32_16x16x32_bf16 v[152:155], v[40:43], v[32:35], 0
    ds_read_b128 v[196:199], v17 offset:7168
    v_mfma_f32_16x16x32_bf16 v[168:171], v[40:43], v[36:39], 0
    s_add_u32 s36, s46, 0
    buffer_store_dwordx4 v[230:233], v2, s[16:19], s36 offen sc1
    v_mfma_f32_16x16x32_bf16 v[172:175], v[44:47], v[36:39], 0
    ds_read_b64_tr_b16 v[200:201], v18 offset:8192
    v_mfma_f32_16x16x32_bf16 v[156:159], v[44:47], v[32:35], 0
    ds_read_b64_tr_b16 v[202:203], v18 offset:12288
    v_mfma_f32_16x16x32_bf16 v[140:143], v[44:47], v[28:31], 0
    ds_read_b64_tr_b16 v[204:205], v19 offset:8192
    s_add_u32 s36, s47, 0
    buffer_store_dwordx2 v[246:247], v254, s[16:19], s36 offen sc1
    v_mfma_f32_16x16x32_bf16 v[124:127], v[44:47], v[24:27], 0
    ds_read_b64_tr_b16 v[206:207], v19 offset:12288
    v_mfma_f32_16x16x32_bf16 v[128:131], v[48:51], v[24:27], 0
    ds_read_b64_tr_b16 v[208:209], v20 offset:8192
    v_mfma_f32_16x16x32_bf16 v[144:147], v[48:51], v[28:31], 0
    ds_read_b64_tr_b16 v[210:211], v20 offset:12288
    v_mfma_f32_16x16x32_bf16 v[160:163], v[48:51], v[32:35], 0
    ds_read_b64_tr_b16 v[212:213], v21 offset:8192
    v_mfma_f32_16x16x32_bf16 v[176:179], v[48:51], v[36:39], 0
    ds_read_b64_tr_b16 v[214:215], v21 offset:12288
    s_add_u32 s42, s42, 16384
    s_cmp_eq_u32 s42, 49152
    s_cselect_b32 s42, 0, s42
    v_mfma_f32_16x16x32_bf16 v[180:183], v[52:55], v[36:39], 0
    s_add_u32 s48, s48, 16384
    s_cmp_eq_u32 s48, 98304
    s_cselect_b32 s48, 0, s48
    v_mfma_f32_16x16x32_bf16 v[164:167], v[52:55], v[32:35], 0
    v_add_u32 v17, s42, v12
    v_add_u32 v18, s48, v13
    v_add_u32 v19, s48, v14
    v_mfma_f32_16x16x32_bf16 v[148:151], v[52:55], v[28:31], 0
    v_add_u32 v20, s48, v15
    v_add_u32 v21, s48, v16
    v_mfma_f32_16x16x32_bf16 v[132:135], v[52:55], v[24:27], 0
    s_waitcnt lgkmcnt(0)
    s_barrier
    v_mfma_f32_16x16x32_bf16 v[120:123], v[200:203], v[184:187], v[120:123]
    ds_read_b128 v[24:27], v17 offset:0
    ds_read_b128 v[28:31], v17 offset:2048
    v_mfma_f32_16x16x32_bf16 v[136:139], v[200:203], v[188:191], v[136:139]
    ds_read_b128 v[32:35], v17 offset:4096
    v_mfma_f32_16x16x32_bf16 v[152:155], v[200:203], v[192:195], v[152:155]
    ds_read_b128 v[36:39], v17 offset:6144
    v_mfma_f32_16x16x32_bf16 v[168:171], v[200:203], v[196:199], v[168:171]
    s_add_u32 s36, s46, 229376
    buffer_store_dwordx4 v[234:237], v2, s[16:19], s36 offen sc1
    v_mfma_f32_16x16x32_bf16 v[172:175], v[204:207], v[196:199], v[172:175]
    ds_read_b64_tr_b16 v[40:41], v18 offset:0
    v_mfma_f32_16x16x32_bf16 v[156:159], v[204:207], v[192:195], v[156:159]
    ds_read_b64_tr_b16 v[42:43], v18 offset:4096
    v_mfma_f32_16x16x32_bf16 v[140:143], v[204:207], v[188:191], v[140:143]
    ds_read_b64_tr_b16 v[44:45], v19 offset:0
    s_add_u32 s36, s47, 229376
    buffer_store_dwordx2 v[248:249], v254, s[16:19], s36 offen sc1
    v_mfma_f32_16x16x32_bf16 v[124:127], v[204:207], v[184:187], v[124:127]
    ds_read_b64_tr_b16 v[46:47], v19 offset:4096
    v_mfma_f32_16x16x32_bf16 v[128:131], v[208:211], v[184:187], v[128:131]
    ds_read_b64_tr_b16 v[48:49], v20 offset:0
    v_mfma_f32_16x16x32_bf16 v[144:147], v[208:211], v[188:191], v[144:147]
    ds_read_b64_tr_b16 v[50:51], v20 offset:4096
    v_mfma_f32_16x16x32_bf16 v[160:163], v[208:211], v[192:195], v[160:163]
    ds_read_b64_tr_b16 v[52:53], v21 offset:0
    v_mfma_f32_16x16x32_bf16 v[176:179], v[208:211], v[196:199], v[176:179]
    ds_read_b64_tr_b16 v[54:55], v21 offset:4096
    s_add_u32 s43, s43, 1
    v_mfma_f32_16x16x32_bf16 v[180:183], v[212:215], v[196:199], v[180:183]
    s_cmp_lt_u32 s43, 27
    v_mfma_f32_16x16x32_bf16 v[164:167], v[212:215], v[192:195], v[164:167]
    v_mfma_f32_16x16x32_bf16 v[148:151], v[212:215], v[188:191], v[148:151]
    v_mfma_f32_16x16x32_bf16 v[132:135], v[212:215], v[184:187], v[132:135]
    s_waitcnt lgkmcnt(0)
    v_mfma_f32_16x16x32_bf16 v[120:123], v[40:43], v[24:27], v[120:123]
    ds_read_b128 v[184:187], v17 offset:1024
    ds_read_b128 v[188:191], v17 offset:3072
    v_mfma_f32_16x16x32_bf16 v[136:139], v[40:43], v[28:31], v[136:139]
    ds_read_b128 v[192:195], v17 offset:5120
    v_mfma_f32_16x16x32_bf16 v[152:155], v[40:43], v[32:35], v[152:155]
    ds_read_b128 v[196:199], v17 offset:7168
    v_mfma_f32_16x16x32_bf16 v[168:171], v[40:43], v[36:39], v[168:171]
    s_add_u32 s36, s46, 458752
    buffer_store_dwordx4 v[238:241], v2, s[16:19], s36 offen sc1
    v_mfma_f32_16x16x32_bf16 v[172:175], v[44:47], v[36:39], v[172:175]
    ds_read_b64_tr_b16 v[200:201], v18 offset:8192
    v_mfma_f32_16x16x32_bf16 v[156:159], v[44:47], v[32:35], v[156:159]
    ds_read_b64_tr_b16 v[202:203], v18 offset:12288
    v_mfma_f32_16x16x32_bf16 v[140:143], v[44:47], v[28:31], v[140:143]
    ds_read_b64_tr_b16 v[204:205], v19 offset:8192
    s_add_u32 s36, s47, 458752
    buffer_store_dwordx2 v[250:251], v254, s[16:19], s36 offen sc1
    v_mfma_f32_16x16x32_bf16 v[124:127], v[44:47], v[24:27], v[124:127]
    ds_read_b64_tr_b16 v[206:207], v19 offset:12288
    v_mfma_f32_16x16x32_bf16 v[128:131], v[48:51], v[24:27], v[128:131]
    ds_read_b64_tr_b16 v[208:209], v20 offset:8192
    v_mfma_f32_16x16x32_bf16 v[144:147], v[48:51], v[28:31], v[144:147]
    ds_read_b64_tr_b16 v[210:211], v20 offset:12288
    v_mfma_f32_16x16x32_bf16 v[160:163], v[48:51], v[32:35], v[160:163]
    ds_read_b64_tr_b16 v[212:213], v21 offset:8192
    v_mfma_f32_16x16x32_bf16 v[176:179], v[48:51], v[36:39], v[176:179]
    ds_read_b64_tr_b16 v[214:215], v21 offset:12288
    s_add_u32 s42, s42, 16384
    s_cmp_eq_u32 s42, 49152
    s_cselect_b32 s42, 0, s42
    v_mfma_f32_16x16x32_bf16 v[180:183], v[52:55], v[36:39], v[180:183]
    s_add_u32 s48, s48, 16384
    s_cmp_eq_u32 s48, 98304
    s_cselect_b32 s48, 0, s48
    v_mfma_f32_16x16x32_bf16 v[164:167], v[52:55], v[32:35], v[164:167]
    v_add_u32 v17, s42, v12
    v_add_u32 v18, s48, v13
    v_add_u32 v19, s48, v14
    v_mfma_f32_16x16x32_bf16 v[148:151], v[52:55], v[28:31], v[148:151]
    v_add_u32 v20, s48, v15
    v_add_u32 v21, s48, v16
    v_mfma_f32_16x16x32_bf16 v[132:135], v[52:55], v[24:27], v[132:135]
    s_waitcnt lgkmcnt(0)
    s_barrier
    v_mfma_f32_16x16x32_bf16 v[120:123], v[200:203], v[184:187], v[120:123]
    ds_read_b128 v[24:27], v17 offset:0
    ds_read_b128 v[28:31], v17 offset:2048
    v_mfma_f32_16x16x32_bf16 v[136:139], v[200:203], v[188:191], v[136:139]
    ds_read_b128 v[32:35], v17 offset:4096
    v_mfma_f32_16x16x32_bf16 v[152:155], v[200:203], v[192:195], v[152:155]
    ds_read_b128 v[36:39], v17 offset:6144
    v_mfma_f32_16x16x32_bf16 v[168:171], v[200:203], v[196:199], v[168:171]
    s_add_u32 s36, s46, 688128
    buffer_store_dwordx4 v[242:245], v2, s[16:19], s36 offen sc1
    v_mfma_f32_16x16x32_bf16 v[172:175], v[204:207], v[196:199], v[172:175]
    ds_read_b64_tr_b16 v[40:41], v18 offset:0
    v_mfma_f32_16x16x32_bf16 v[156:159], v[204:207], v[192:195], v[156:159]
    ds_read_b64_tr_b16 v[42:43], v18 offset:4096
    v_mfma_f32_16x16x32_bf16 v[140:143], v[204:207], v[188:191], v[140:143]
    ds_read_b64_tr_b16 v[44:45], v19 offset:0
    s_add_u32 s36, s47, 688128
    buffer_store_dwordx2 v[252:253], v254, s[16:19], s36 offen sc1
    v_mfma_f32_16x16x32_bf16 v[124:127], v[204:207], v[184:187], v[124:127]
    ds_read_b64_tr_b16 v[46:47], v19 offset:4096
    v_mfma_f32_16x16x32_bf16 v[128:131], v[208:211], v[184:187], v[128:131]
    ds_read_b64_tr_b16 v[48:49], v20 offset:0
    v_mfma_f32_16x16x32_bf16 v[144:147], v[208:211], v[188:191], v[144:147]
    ds_read_b64_tr_b16 v[50:51], v20 offset:4096
    v_mfma_f32_16x16x32_bf16 v[160:163], v[208:211], v[192:195], v[160:163]
    ds_read_b64_tr_b16 v[52:53], v21 offset:0
    v_mfma_f32_16x16x32_bf16 v[176:179], v[208:211], v[196:199], v[176:179]
    ds_read_b64_tr_b16 v[54:55], v21 offset:4096
    s_add_u32 s43, s43, 1
    v_mfma_f32_16x16x32_bf16 v[180:183], v[212:215], v[196:199], v[180:183]
    s_cmp_lt_u32 s43, 27
    v_mfma_f32_16x16x32_bf16 v[164:167], v[212:215], v[192:195], v[164:167]
    v_mfma_f32_16x16x32_bf16 v[148:151], v[212:215], v[188:191], v[148:151]
    v_mfma_f32_16x16x32_bf16 v[132:135], v[212:215], v[184:187], v[132:135]
    s_lshr_b32 s53, s30, 1
    s_lshl1_add_u32 s53, s31, s53
    s_lshl_b32 s53, s53, 7
    s_add_u32 s53, s53, s55
    s_add_u32 s53, s53, 0x1200
    v_mov_b32 v8, 1
    v_mov_b32 v9, 0
    s_mov_b64 exec, 1
    s_waitcnt vmcnt(8)
    buffer_atomic_add v8, v9, s[56:59], s53 offen sc1
    s_mov_b64 exec, -1
    s_waitcnt lgkmcnt(0)
    v_mfma_f32_16x16x32_bf16 v[120:123], v[40:43], v[24:27], v[120:123]
    ds_read_b128 v[184:187], v17 offset:1024
    ds_read_b128 v[188:191], v17 offset:3072
    ds_read_b128 v[192:195], v17 offset:5120
    ds_read_b128 v[196:199], v17 offset:7168
    v_mfma_f32_16x16x32_bf16 v[136:139], v[40:43], v[28:31], v[136:139]
    ds_read_b64_tr_b16 v[200:201], v18 offset:8192
    ds_read_b64_tr_b16 v[202:203], v18 offset:12288
    ds_read_b64_tr_b16 v[204:205], v19 offset:8192
    ds_read_b64_tr_b16 v[206:207], v19 offset:12288
    v_mfma_f32_16x16x32_bf16 v[152:155], v[40:43], v[32:35], v[152:155]
    ds_read_b64_tr_b16 v[208:209], v20 offset:8192
    ds_read_b64_tr_b16 v[210:211], v20 offset:12288
    ds_read_b64_tr_b16 v[212:213], v21 offset:8192
    ds_read_b64_tr_b16 v[214:215], v21 offset:12288
    v_mfma_f32_16x16x32_bf16 v[168:171], v[40:43], v[36:39], v[168:171]
    s_lshl_b32 s86, s60, 24
    s_lshl_b32 s87, s94, 13
    s_add_u32 s86, s86, s87
    s_add_u32 s86, s86, 167772160
    v_mfma_f32_16x16x32_bf16 v[172:175], v[44:47], v[36:39], v[172:175]
    s_add_u32 s84, s4, s86
    s_addc_u32 s85, s5, 0
    s_mov_b32 s86, 8380416
    s_mov_b32 s87, 0x20000
    v_mfma_f32_16x16x32_bf16 v[156:159], v[44:47], v[32:35], v[156:159]
    s_add_u32 s88, s62, 0x480000
    s_addc_u32 s89, s63, 0
    s_mov_b32 s90, 0x7e000
    s_mov_b32 s91, 0x20000
    v_mfma_f32_16x16x32_bf16 v[140:143], v[44:47], v[28:31], v[140:143]
    s_lshl_b32 s40, s31, 17
    s_add_u32 s40, s40, s39
    s_xor_b32 s41, s40, 0x20000
    v_and_b32 v66, 3, v22
    v_mfma_f32_16x16x32_bf16 v[124:127], v[44:47], v[24:27], v[124:127]
    v_lshrrev_b32 v65, 2, v22
    v_lshlrev_b32 v65, 14, v65
    v_lshl_add_u32 v65, v66, 11, v65
    v_lshl_add_u32 v65, v23, 4, v65
    v_mfma_f32_16x16x32_bf16 v[128:131], v[48:51], v[24:27], v[128:131]
    s_lshl3_add_u32 s46, s28, s37
    s_lshl1_add_u32 s46, s31, s46
    s_lshl_b32 s49, s46, 16
    s_lshl_b32 s47, s38, 5
    v_mfma_f32_16x16x32_bf16 v[144:147], v[48:51], v[28:31], v[144:147]
    s_add_u32 s49, s49, s47
    s_add_u32 s44, s40, 65536
    buffer_load_dwordx4 v[86:89], v65, s[84:87], s49 offen offset:0 sc1
    buffer_load_dwordx4 v[90:93], v2, s[88:91], s40 offen offset:0 sc1
    v_mfma_f32_16x16x32_bf16 v[160:163], v[48:51], v[32:35], v[160:163]
    buffer_load_dwordx4 v[94:97], v65, s[84:87], s49 offen offset:64 sc1
    buffer_load_dwordx4 v[98:101], v2, s[88:91], s40 offen offset:1024 sc1
    s_add_u32 s49, s49, 65536
    buffer_load_dwordx4 v[102:105], v65, s[84:87], s49 offen offset:0 sc1
    v_mfma_f32_16x16x32_bf16 v[176:179], v[48:51], v[36:39], v[176:179]
    buffer_load_dwordx4 v[106:109], v2, s[88:91], s44 offen offset:0 sc1
    buffer_load_dwordx4 v[216:219], v65, s[84:87], s49 offen offset:64 sc1
    buffer_load_dwordx4 v[220:223], v2, s[88:91], s44 offen offset:1024 sc1
    s_add_u32 s42, s42, 16384
    s_cmp_eq_u32 s42, 49152
    s_cselect_b32 s42, 0, s42
    v_mfma_f32_16x16x32_bf16 v[180:183], v[52:55], v[36:39], v[180:183]
    s_add_u32 s48, s48, 16384
    s_cmp_eq_u32 s48, 98304
    s_cselect_b32 s48, 0, s48
    v_mfma_f32_16x16x32_bf16 v[164:167], v[52:55], v[32:35], v[164:167]
    v_add_u32 v17, s42, v12
    v_add_u32 v18, s48, v13
    v_add_u32 v19, s48, v14
    v_mfma_f32_16x16x32_bf16 v[148:151], v[52:55], v[28:31], v[148:151]
    v_add_u32 v20, s48, v15
    v_add_u32 v21, s48, v16
    v_mfma_f32_16x16x32_bf16 v[132:135], v[52:55], v[24:27], v[132:135]
    s_waitcnt lgkmcnt(0)
    s_barrier
    v_mfma_f32_16x16x32_bf16 v[120:123], v[200:203], v[184:187], v[120:123]
    ds_read_b128 v[24:27], v17 offset:0
    ds_read_b128 v[28:31], v17 offset:2048
    ds_read_b128 v[32:35], v17 offset:4096
    ds_read_b128 v[36:39], v17 offset:6144
    ds_read_b64_tr_b16 v[40:41], v18 offset:0
    v_mfma_f32_16x16x32_bf16 v[136:139], v[200:203], v[188:191], v[136:139]
    ds_read_b64_tr_b16 v[42:43], v18 offset:4096
    ds_read_b64_tr_b16 v[44:45], v19 offset:0
    ds_read_b64_tr_b16 v[46:47], v19 offset:4096
    ds_read_b64_tr_b16 v[48:49], v20 offset:0
    v_mfma_f32_16x16x32_bf16 v[152:155], v[200:203], v[192:195], v[152:155]
    ds_read_b64_tr_b16 v[50:51], v20 offset:4096
    ds_read_b64_tr_b16 v[52:53], v21 offset:0
    ds_read_b64_tr_b16 v[54:55], v21 offset:4096
    v_and_b32 v81, 7, v0
    v_lshrrev_b32 v84, 6, v0
    v_mfma_f32_16x16x32_bf16 v[168:171], v[200:203], v[196:199], v[168:171]
    v_lshlrev_b32 v84, 4, v84
    v_bfe_u32 v85, v0, 3, 3
    v_add_u32 v84, v84, v85
    s_lshr_b32 s78, s29, 1
    v_mfma_f32_16x16x32_bf16 v[172:175], v[204:207], v[196:199], v[172:175]
    s_lshl_b32 s78, s78, 16
    s_and_b32 s79, s29, 1
    s_lshl_b32 s79, s79, 7
    s_add_u32 s78, s78, s79
    s_lshr_b32 s79, s30, 1
    v_mfma_f32_16x16x32_bf16 v[156:159], v[204:207], v[192:195], v[156:159]
    s_lshl_b32 s79, s79, 13
    s_add_u32 s78, s78, s79
    v_lshlrev_b32 v78, 8, v84
    v_lshl_add_u32 v78, v81, 4, v78
    v_mfma_f32_16x16x32_bf16 v[140:143], v[204:207], v[188:191], v[140:143]
    v_add_u32 v78, s78, v78
    s_lshl_b32 s78, s28, 7
    s_lshl_b32 s79, s29, 3
    s_add_u32 s78, s78, s79
    v_mfma_f32_16x16x32_bf16 v[124:127], v[204:207], v[184:187], v[124:127]
    v_add_u32 v79, s78, v81
    v_lshlrev_b32 v80, 11, v79
    v_and_b32 v85, 3, v79
    v_lshrrev_b32 v82, 2, v79
    v_lshlrev_b32 v82, 14, v82
    v_mfma_f32_16x16x32_bf16 v[128:131], v[208:211], v[184:187], v[128:131]
    v_lshl_add_u32 v82, v85, 11, v82
    v_lshl_add_u32 v82, v84, 4, v82
    v_lshrrev_b32 v85, 2, v84
    v_lshlrev_b32 v85, 3, v85
    v_mfma_f32_16x16x32_bf16 v[144:147], v[208:211], v[188:191], v[144:147]
    v_and_b32 v84, 3, v84
    v_add_u32 v84, v84, v85
    v_lshl_add_u32 v80, v84, 3, v80
    v_lshlrev_b32 v79, 3, v79
    v_lshl_add_u32 v79, v84, 14, v79
    v_mfma_f32_16x16x32_bf16 v[160:163], v[208:211], v[192:195], v[160:163]
    s_add_u32 s80, s4, 0x1800000
    s_addc_u32 s81, s5, 0
    s_mov_b32 s82, 0x400000
    s_mov_b32 s83, 0x20000
    v_mfma_f32_16x16x32_bf16 v[176:179], v[208:211], v[196:199], v[176:179]
    s_mov_b32 s78, 0
    buffer_load_dwordx2 v[110:111], v79, s[80:83], s78 offen sc1
    s_mov_b32 s78, 65536
    buffer_load_dwordx2 v[112:113], v79, s[80:83], s78 offen sc1
    s_mov_b32 s78, 262144
    buffer_load_dwordx2 v[114:115], v79, s[80:83], s78 offen sc1
    s_mov_b32 s78, 327680
    buffer_load_dwordx2 v[116:117], v79, s[80:83], s78 offen sc1
    s_add_u32 s43, s43, 1
    v_mfma_f32_16x16x32_bf16 v[180:183], v[212:215], v[196:199], v[180:183]
    s_cmp_lt_u32 s43, 27
    v_mfma_f32_16x16x32_bf16 v[164:167], v[212:215], v[192:195], v[164:167]
    v_mfma_f32_16x16x32_bf16 v[148:151], v[212:215], v[188:191], v[148:151]
    v_mfma_f32_16x16x32_bf16 v[132:135], v[212:215], v[184:187], v[132:135]
    s_waitcnt lgkmcnt(0)
    v_mfma_f32_16x16x32_bf16 v[120:123], v[40:43], v[24:27], v[120:123]
    ds_read_b128 v[184:187], v17 offset:1024
    ds_read_b128 v[188:191], v17 offset:3072
    ds_read_b128 v[192:195], v17 offset:5120
    v_mfma_f32_16x16x32_bf16 v[136:139], v[40:43], v[28:31], v[136:139]
    ds_read_b128 v[196:199], v17 offset:7168
    ds_read_b64_tr_b16 v[200:201], v18 offset:8192
    ds_read_b64_tr_b16 v[202:203], v18 offset:12288
    v_mfma_f32_16x16x32_bf16 v[152:155], v[40:43], v[32:35], v[152:155]
    ds_read_b64_tr_b16 v[204:205], v19 offset:8192
    ds_read_b64_tr_b16 v[206:207], v19 offset:12288
    v_mfma_f32_16x16x32_bf16 v[168:171], v[40:43], v[36:39], v[168:171]
    ds_read_b64_tr_b16 v[208:209], v20 offset:8192
    ds_read_b64_tr_b16 v[210:211], v20 offset:12288
    ds_read_b64_tr_b16 v[212:213], v21 offset:8192
    v_mfma_f32_16x16x32_bf16 v[172:175], v[44:47], v[36:39], v[172:175]
    ds_read_b64_tr_b16 v[214:215], v21 offset:12288
    s_load_dwordx2 s[6:7], s[0:1], 88
    v_lshrrev_b32 v6, 2, v22
    v_mfma_f32_16x16x32_bf16 v[156:159], v[44:47], v[32:35], v[156:159]
    v_cmp_eq_u32 vcc, v6, v23
    v_and_b32 v6, 1, v22
    v_mfma_f32_16x16x32_bf16 v[140:143], v[44:47], v[28:31], v[140:143]
    v_lshlrev_b32 v6, 4, v6
    v_mov_b32 v7, 0x3f80
    v_lshlrev_b32 v6, v6, v7
    v_mfma_f32_16x16x32_bf16 v[124:127], v[44:47], v[24:27], v[124:127]
    v_cndmask_b32 v6, 0, v6, vcc
    v_mov_b32 v58, 0
    v_mov_b32 v59, 0
    v_mfma_f32_16x16x32_bf16 v[128:131], v[48:51], v[24:27], v[128:131]
    v_mov_b32 v60, 0
    v_mov_b32 v61, 0
    v_mfma_f32_16x16x32_bf16 v[144:147], v[48:51], v[28:31], v[144:147]
    v_and_b32 v7, 2, v22
    v_cmp_eq_u32 vcc, 0, v7
    s_nop 1
    v_cndmask_b32 v56, 0, v6, vcc
    v_mfma_f32_16x16x32_bf16 v[160:163], v[48:51], v[32:35], v[160:163]
    v_cndmask_b32 v57, v6, v58, vcc
    v_mov_b32 v62, v56
    v_mov_b32 v63, v57
    v_mfma_f32_16x16x32_bf16 v[176:179], v[48:51], v[36:39], v[176:179]
    s_mov_b32 s45, 0xffff0000
    v_mov_b32 v64, 0x10000
    s_add_u32 s42, s42, 16384
    s_cmp_eq_u32 s42, 49152
    s_cselect_b32 s42, 0, s42
    v_mfma_f32_16x16x32_bf16 v[180:183], v[52:55], v[36:39], v[180:183]
    s_add_u32 s48, s48, 16384
    s_cmp_eq_u32 s48, 98304
    s_cselect_b32 s48, 0, s48
    v_mfma_f32_16x16x32_bf16 v[164:167], v[52:55], v[32:35], v[164:167]
    v_add_u32 v17, s42, v12
    v_add_u32 v18, s48, v13
    v_add_u32 v19, s48, v14
    v_mfma_f32_16x16x32_bf16 v[148:151], v[52:55], v[28:31], v[148:151]
    v_add_u32 v20, s48, v15
    v_add_u32 v21, s48, v16
    v_mfma_f32_16x16x32_bf16 v[132:135], v[52:55], v[24:27], v[132:135]
    s_waitcnt lgkmcnt(0)
    s_barrier
    v_mfma_f32_16x16x32_bf16 v[120:123], v[200:203], v[184:187], v[120:123]
    ds_read_b128 v[24:27], v17 offset:0
    ds_read_b128 v[28:31], v17 offset:2048
    ds_read_b128 v[32:35], v17 offset:4096
    ds_read_b128 v[36:39], v17 offset:6144
    v_mfma_f32_16x16x32_bf16 v[136:139], v[200:203], v[188:191], v[136:139]
    ds_read_b64_tr_b16 v[40:41], v18 offset:0
    ds_read_b64_tr_b16 v[42:43], v18 offset:4096
    ds_read_b64_tr_b16 v[44:45], v19 offset:0
    ds_read_b64_tr_b16 v[46:47], v19 offset:4096
    v_mfma_f32_16x16x32_bf16 v[152:155], v[200:203], v[192:195], v[152:155]
    ds_read_b64_tr_b16 v[48:49], v20 offset:0
    ds_read_b64_tr_b16 v[50:51], v20 offset:4096
    ds_read_b64_tr_b16 v[52:53], v21 offset:0
    ds_read_b64_tr_b16 v[54:55], v21 offset:4096
    v_mfma_f32_16x16x32_bf16 v[168:171], v[200:203], v[196:199], v[168:171]
    s_lshr_b32 s49, s28, 3
    s_and_b32 s36, s28, 3
    s_lshl2_add_u32 s36, s49, s36
    v_mfma_f32_16x16x32_bf16 v[172:175], v[204:207], v[196:199], v[172:175]
    s_lshl_b32 s36, s36, 19
    s_xor_b32 s49, s49, s94
    s_lshl_b32 s49, s49, 2
    s_xor_b32 s49, s49, s28
    v_mfma_f32_16x16x32_bf16 v[156:159], v[204:207], v[192:195], v[156:159]
    s_and_b32 s49, s49, 4
    s_lshl_b32 s49, s49, 11
    s_add_u32 s36, s36, s49
    s_add_u32 s36, s36, 29360128
    v_mfma_f32_16x16x32_bf16 v[140:143], v[204:207], v[188:191], v[140:143]
    s_add_u32 s49, s55, 2359296
    s_cmp_le_u32 s31, s60
    s_cselect_b32 s36, s49, s36
    s_add_u32 s24, s4, s36
    s_addc_u32 s25, s5, 0
    s_mov_b32 s26, 516096
    v_mfma_f32_16x16x32_bf16 v[124:127], v[204:207], v[184:187], v[124:127]
    s_mov_b32 s27, 0x20000
    s_mov_b32 s20, s6
    s_mov_b32 s21, s7
    v_mfma_f32_16x16x32_bf16 v[128:131], v[208:211], v[184:187], v[128:131]
    s_mov_b32 s22, 0x400000
    s_mov_b32 s23, 0x20000
    s_lshl_b32 s46, s46, 15
    s_add_u32 s46, s46, s47
    v_mfma_f32_16x16x32_bf16 v[144:147], v[208:211], v[188:191], v[144:147]
    s_add_u32 s47, s46, 32768
    v_and_b32 v67, 1, v23
    v_lshlrev_b32 v66, 11, v22
    v_lshl_add_u32 v66, v67, 5, v66
    v_mfma_f32_16x16x32_bf16 v[160:163], v[208:211], v[192:195], v[160:163]
    v_lshrrev_b32 v67, 1, v23
    v_lshl_add_u32 v66, v67, 4, v66
    v_cmp_gt_u32 s[50:51], 8, v22
    v_lshrrev_b32 v67, 3, v22
    v_mfma_f32_16x16x32_bf16 v[176:179], v[208:211], v[196:199], v[176:179]
    v_mul_u32_u24 v67, 16320, v67
    v_sub_u32 v66, v66, v67
    v_add_u32 v67, 16384, v66
    s_add_u32 s43, s43, 1
    v_mfma_f32_16x16x32_bf16 v[180:183], v[212:215], v[196:199], v[180:183]
    s_cmp_lt_u32 s43, 27
    v_mfma_f32_16x16x32_bf16 v[164:167], v[212:215], v[192:195], v[164:167]
    v_mfma_f32_16x16x32_bf16 v[148:151], v[212:215], v[188:191], v[148:151]
    v_mfma_f32_16x16x32_bf16 v[132:135], v[212:215], v[184:187], v[132:135]
    s_lshr_b32 s53, s30, 1
    s_lshl1_add_u32 s53, s31, s53
    s_lshl_b32 s53, s53, 7
    s_add_u32 s53, s53, s55
    s_add_u32 s53, s53, 0x1400
    v_mov_b32 v8, 1
    v_mov_b32 v9, 0
    s_mov_b64 exec, 1
    s_waitcnt vmcnt(0)
    buffer_atomic_add v8, v9, s[56:59], s53 offen sc1
    s_mov_b64 exec, -1
    v_mfma_f32_16x16x32_bf16 v[120:123], v[56:59], v[86:89], v[120:123]
    v_mfma_f32_16x16x32_bf16 v[124:127], v[60:63], v[86:89], v[124:127]
    v_mfma_f32_16x16x32_bf16 v[128:131], v[56:59], v[94:97], v[128:131]
    v_mfma_f32_16x16x32_bf16 v[132:135], v[60:63], v[94:97], v[132:135]
    v_mfma_f32_16x16x32_bf16 v[136:139], v[56:59], v[102:105], v[136:139]
    v_mfma_f32_16x16x32_bf16 v[140:143], v[60:63], v[102:105], v[140:143]
    v_mfma_f32_16x16x32_bf16 v[144:147], v[56:59], v[216:219], v[144:147]
    v_mfma_f32_16x16x32_bf16 v[148:151], v[60:63], v[216:219], v[148:151]
    v_mfma_f32_16x16x32_bf16 v[120:123], v[56:59], v[90:93], v[120:123]
    v_mfma_f32_16x16x32_bf16 v[124:127], v[60:63], v[90:93], v[124:127]
    v_mfma_f32_16x16x32_bf16 v[128:131], v[56:59], v[98:101], v[128:131]
    v_mfma_f32_16x16x32_bf16 v[132:135], v[60:63], v[98:101], v[132:135]
    v_mfma_f32_16x16x32_bf16 v[136:139], v[56:59], v[106:109], v[136:139]
    v_mfma_f32_16x16x32_bf16 v[140:143], v[60:63], v[106:109], v[140:143]
    v_mfma_f32_16x16x32_bf16 v[144:147], v[56:59], v[220:223], v[144:147]
    v_mfma_f32_16x16x32_bf16 v[148:151], v[60:63], v[220:223], v[148:151]
mm_22:
    s_waitcnt lgkmcnt(0)
    v_mfma_f32_16x16x32_bf16 v[120:123], v[40:43], v[24:27], v[120:123]
    ds_read_b128 v[184:187], v17 offset:1024
    v_mfma_f32_16x16x32_bf16 v[136:139], v[40:43], v[28:31], v[136:139]
    ds_read_b128 v[188:191], v17 offset:3072
    v_mfma_f32_16x16x32_bf16 v[152:155], v[40:43], v[32:35], v[152:155]
    ds_read_b128 v[192:195], v17 offset:5120
    v_mfma_f32_16x16x32_bf16 v[168:171], v[40:43], v[36:39], v[168:171]
    ds_read_b128 v[196:199], v17 offset:7168
    v_mfma_f32_16x16x32_bf16 v[172:175], v[44:47], v[36:39], v[172:175]
    ds_read_b64_tr_b16 v[200:201], v18 offset:8192
    v_mfma_f32_16x16x32_bf16 v[156:159], v[44:47], v[32:35], v[156:159]
    ds_read_b64_tr_b16 v[202:203], v18 offset:12288
    v_mfma_f32_16x16x32_bf16 v[140:143], v[44:47], v[28:31], v[140:143]
    ds_read_b64_tr_b16 v[204:205], v19 offset:8192
    v_mfma_f32_16x16x32_bf16 v[124:127], v[44:47], v[24:27], v[124:127]
    ds_read_b64_tr_b16 v[206:207], v19 offset:12288
    v_mfma_f32_16x16x32_bf16 v[128:131], v[48:51], v[24:27], v[128:131]
    ds_read_b64_tr_b16 v[208:209], v20 offset:8192
    v_mfma_f32_16x16x32_bf16 v[144:147], v[48:51], v[28:31], v[144:147]
    ds_read_b64_tr_b16 v[210:211], v20 offset:12288
    v_mfma_f32_16x16x32_bf16 v[160:163], v[48:51], v[32:35], v[160:163]
    ds_read_b64_tr_b16 v[212:213], v21 offset:8192
    v_mfma_f32_16x16x32_bf16 v[176:179], v[48:51], v[36:39], v[176:179]
    ds_read_b64_tr_b16 v[214:215], v21 offset:12288
    s_add_u32 s42, s42, 16384
    s_cmp_eq_u32 s42, 49152
    s_cselect_b32 s42, 0, s42
    v_mfma_f32_16x16x32_bf16 v[180:183], v[52:55], v[36:39], v[180:183]
    s_add_u32 s48, s48, 16384
    s_cmp_eq_u32 s48, 98304
    s_cselect_b32 s48, 0, s48
    v_mfma_f32_16x16x32_bf16 v[164:167], v[52:55], v[32:35], v[164:167]
    v_add_u32 v17, s42, v12
    v_add_u32 v18, s48, v13
    v_add_u32 v19, s48, v14
    v_mfma_f32_16x16x32_bf16 v[148:151], v[52:55], v[28:31], v[148:151]
    v_add_u32 v20, s48, v15
    v_add_u32 v21, s48, v16
    v_mfma_f32_16x16x32_bf16 v[132:135], v[52:55], v[24:27], v[132:135]
    s_waitcnt lgkmcnt(0)
    s_barrier
    v_mfma_f32_16x16x32_bf16 v[120:123], v[200:203], v[184:187], v[120:123]
    ds_read_b128 v[24:27], v17 offset:0
    v_mfma_f32_16x16x32_bf16 v[136:139], v[200:203], v[188:191], v[136:139]
    ds_read_b128 v[28:31], v17 offset:2048
    v_mfma_f32_16x16x32_bf16 v[152:155], v[200:203], v[192:195], v[152:155]
    ds_read_b128 v[32:35], v17 offset:4096
    v_mfma_f32_16x16x32_bf16 v[168:171], v[200:203], v[196:199], v[168:171]
    ds_read_b128 v[36:39], v17 offset:6144
    v_mfma_f32_16x16x32_bf16 v[172:175], v[204:207], v[196:199], v[172:175]
    ds_read_b64_tr_b16 v[40:41], v18 offset:0
    v_mfma_f32_16x16x32_bf16 v[156:159], v[204:207], v[192:195], v[156:159]
    ds_read_b64_tr_b16 v[42:43], v18 offset:4096
    v_mfma_f32_16x16x32_bf16 v[140:143], v[204:207], v[188:191], v[140:143]
    ds_read_b64_tr_b16 v[44:45], v19 offset:0
    v_mfma_f32_16x16x32_bf16 v[124:127], v[204:207], v[184:187], v[124:127]
    ds_read_b64_tr_b16 v[46:47], v19 offset:4096
    v_mfma_f32_16x16x32_bf16 v[128:131], v[208:211], v[184:187], v[128:131]
    ds_read_b64_tr_b16 v[48:49], v20 offset:0
    v_mfma_f32_16x16x32_bf16 v[144:147], v[208:211], v[188:191], v[144:147]
    ds_read_b64_tr_b16 v[50:51], v20 offset:4096
    v_mfma_f32_16x16x32_bf16 v[160:163], v[208:211], v[192:195], v[160:163]
    ds_read_b64_tr_b16 v[52:53], v21 offset:0
    v_mfma_f32_16x16x32_bf16 v[176:179], v[208:211], v[196:199], v[176:179]
    ds_read_b64_tr_b16 v[54:55], v21 offset:4096
    s_add_u32 s43, s43, 1
    v_mfma_f32_16x16x32_bf16 v[180:183], v[212:215], v[196:199], v[180:183]
    s_cmp_lt_u32 s43, 27
    v_mfma_f32_16x16x32_bf16 v[164:167], v[212:215], v[192:195], v[164:167]
    v_mfma_f32_16x16x32_bf16 v[148:151], v[212:215], v[188:191], v[148:151]
    v_mfma_f32_16x16x32_bf16 v[132:135], v[212:215], v[184:187], v[132:135]
    s_cbranch_scc1 mm_22
    s_waitcnt lgkmcnt(0)
    v_mfma_f32_16x16x32_bf16 v[152:155], v[40:43], v[32:35], v[152:155]
    ds_read_b128 v[192:195], v17 offset:5120
    ds_read_b128 v[196:199], v17 offset:7168
    v_mfma_f32_16x16x32_bf16 v[168:171], v[40:43], v[36:39], v[168:171]
    ds_read_b64_tr_b16 v[200:201], v18 offset:8192
    ds_read_b64_tr_b16 v[202:203], v18 offset:12288
    v_mfma_f32_16x16x32_bf16 v[172:175], v[44:47], v[36:39], v[172:175]
    ds_read_b64_tr_b16 v[204:205], v19 offset:8192
    ds_read_b64_tr_b16 v[206:207], v19 offset:12288
    v_mfma_f32_16x16x32_bf16 v[156:159], v[44:47], v[32:35], v[156:159]
    ds_read_b64_tr_b16 v[208:209], v20 offset:8192
    ds_read_b64_tr_b16 v[210:211], v20 offset:12288
    v_mfma_f32_16x16x32_bf16 v[160:163], v[48:51], v[32:35], v[160:163]
    ds_read_b64_tr_b16 v[212:213], v21 offset:8192
    ds_read_b64_tr_b16 v[214:215], v21 offset:12288
    v_mfma_f32_16x16x32_bf16 v[176:179], v[48:51], v[36:39], v[176:179]
    ds_read_b128 v[184:187], v17 offset:1024
    ds_read_b128 v[188:191], v17 offset:3072
    v_mfma_f32_16x16x32_bf16 v[180:183], v[52:55], v[36:39], v[180:183]
    v_mfma_f32_16x16x32_bf16 v[164:167], v[52:55], v[32:35], v[164:167]
    v_mfma_f32_16x16x32_bf16 v[120:123], v[40:43], v[24:27], v[120:123]
    v_mfma_f32_16x16x32_bf16 v[136:139], v[40:43], v[28:31], v[136:139]
    v_mfma_f32_16x16x32_bf16 v[140:143], v[44:47], v[28:31], v[140:143]
    v_mfma_f32_16x16x32_bf16 v[124:127], v[44:47], v[24:27], v[124:127]
    s_waitcnt lgkmcnt(0)
    v_mfma_f32_16x16x32_bf16 v[152:155], v[200:203], v[192:195], v[152:155]
    v_mfma_f32_16x16x32_bf16 v[168:171], v[200:203], v[196:199], v[168:171]
    v_mfma_f32_16x16x32_bf16 v[172:175], v[204:207], v[196:199], v[172:175]
    v_mfma_f32_16x16x32_bf16 v[156:159], v[204:207], v[192:195], v[156:159]
    v_mfma_f32_16x16x32_bf16 v[160:163], v[208:211], v[192:195], v[160:163]
    v_mfma_f32_16x16x32_bf16 v[176:179], v[208:211], v[196:199], v[176:179]
    v_mfma_f32_16x16x32_bf16 v[180:183], v[212:215], v[196:199], v[180:183]
    v_mfma_f32_16x16x32_bf16 v[164:167], v[212:215], v[192:195], v[164:167]
    v_mfma_f32_16x16x32_bf16 v[128:131], v[48:51], v[24:27], v[128:131]
    v_mfma_f32_16x16x32_bf16 v[144:147], v[48:51], v[28:31], v[144:147]
    v_mfma_f32_16x16x32_bf16 v[148:151], v[52:55], v[28:31], v[148:151]
    v_mfma_f32_16x16x32_bf16 v[132:135], v[52:55], v[24:27], v[132:135]
    v_and_or_b32 v152, v152, s45, v64
    v_and_or_b32 v154, v154, s45, v64
    v_and_or_b32 v156, v156, s45, v64
    v_and_or_b32 v158, v158, s45, v64
    v_cvt_pk_bf16_f32 v152, v152, v153
    v_cvt_pk_bf16_f32 v153, v154, v155
    v_cvt_pk_bf16_f32 v154, v156, v157
    v_cvt_pk_bf16_f32 v155, v158, v159
    buffer_store_dwordx4 v[152:155], v2, s[24:27], s41 offen offset:0 sc1
    v_and_or_b32 v160, v160, s45, v64
    v_and_or_b32 v162, v162, s45, v64
    v_and_or_b32 v164, v164, s45, v64
    v_and_or_b32 v166, v166, s45, v64
    v_cvt_pk_bf16_f32 v160, v160, v161
    v_cvt_pk_bf16_f32 v161, v162, v163
    v_cvt_pk_bf16_f32 v162, v164, v165
    v_cvt_pk_bf16_f32 v163, v166, v167
    buffer_store_dwordx4 v[160:163], v2, s[24:27], s41 offen offset:1024 sc1
    s_add_u32 s36, s41, 65536
    v_and_or_b32 v168, v168, s45, v64
    v_and_or_b32 v170, v170, s45, v64
    v_and_or_b32 v172, v172, s45, v64
    v_and_or_b32 v174, v174, s45, v64
    v_cvt_pk_bf16_f32 v168, v168, v169
    v_cvt_pk_bf16_f32 v169, v170, v171
    v_cvt_pk_bf16_f32 v170, v172, v173
    v_cvt_pk_bf16_f32 v171, v174, v175
    buffer_store_dwordx4 v[168:171], v2, s[24:27], s36 offen offset:0 sc1
    v_and_or_b32 v176, v176, s45, v64
    v_and_or_b32 v178, v178, s45, v64
    v_and_or_b32 v180, v180, s45, v64
    v_and_or_b32 v182, v182, s45, v64
    v_cvt_pk_bf16_f32 v176, v176, v177
    v_cvt_pk_bf16_f32 v177, v178, v179
    v_cvt_pk_bf16_f32 v178, v180, v181
    v_cvt_pk_bf16_f32 v179, v182, v183
    buffer_store_dwordx4 v[176:179], v2, s[24:27], s36 offen offset:1024 sc1
    v_mfma_f32_16x16x32_bf16 v[120:123], v[200:203], v[184:187], v[120:123]
    v_mfma_f32_16x16x32_bf16 v[136:139], v[200:203], v[188:191], v[136:139]
    v_mfma_f32_16x16x32_bf16 v[140:143], v[204:207], v[188:191], v[140:143]
    v_mfma_f32_16x16x32_bf16 v[124:127], v[204:207], v[184:187], v[124:127]
    v_mfma_f32_16x16x32_bf16 v[128:131], v[208:211], v[184:187], v[128:131]
    v_mfma_f32_16x16x32_bf16 v[144:147], v[208:211], v[188:191], v[144:147]
    v_mfma_f32_16x16x32_bf16 v[148:151], v[212:215], v[188:191], v[148:151]
    v_mfma_f32_16x16x32_bf16 v[132:135], v[212:215], v[184:187], v[132:135]
    s_cmp_eq_u32 s60, 1
    s_cbranch_scc1 G4_last
    v_and_or_b32 v120, v120, s45, v64
    v_and_or_b32 v122, v122, s45, v64
    v_and_or_b32 v124, v124, s45, v64
    v_and_or_b32 v126, v126, s45, v64
    v_cvt_pk_bf16_f32 v120, v120, v121
    v_cvt_pk_bf16_f32 v121, v122, v123
    v_cvt_pk_bf16_f32 v122, v124, v125
    v_cvt_pk_bf16_f32 v123, v126, v127
    buffer_store_dwordx4 v[120:123], v2, s[24:27], s40 offen offset:0 sc1
    v_and_or_b32 v128, v128, s45, v64
    v_and_or_b32 v130, v130, s45, v64
    v_and_or_b32 v132, v132, s45, v64
    v_and_or_b32 v134, v134, s45, v64
    v_cvt_pk_bf16_f32 v128, v128, v129
    v_cvt_pk_bf16_f32 v129, v130, v131
    v_cvt_pk_bf16_f32 v130, v132, v133
    v_cvt_pk_bf16_f32 v131, v134, v135
    buffer_store_dwordx4 v[128:131], v2, s[24:27], s40 offen offset:1024 sc1
    s_add_u32 s36, s40, 65536
    v_and_or_b32 v136, v136, s45, v64
    v_and_or_b32 v138, v138, s45, v64
    v_and_or_b32 v140, v140, s45, v64
    v_and_or_b32 v142, v142, s45, v64
    v_cvt_pk_bf16_f32 v136, v136, v137
    v_cvt_pk_bf16_f32 v137, v138, v139
    v_cvt_pk_bf16_f32 v138, v140, v141
    v_cvt_pk_bf16_f32 v139, v142, v143
    buffer_store_dwordx4 v[136:139], v2, s[24:27], s36 offen offset:0 sc1
    v_and_or_b32 v144, v144, s45, v64
    v_and_or_b32 v146, v146, s45, v64
    v_and_or_b32 v148, v148, s45, v64
    v_and_or_b32 v150, v150, s45, v64
    v_cvt_pk_bf16_f32 v144, v144, v145
    v_cvt_pk_bf16_f32 v145, v146, v147
    v_cvt_pk_bf16_f32 v146, v148, v149
    v_cvt_pk_bf16_f32 v147, v150, v151
    buffer_store_dwordx4 v[144:147], v2, s[24:27], s36 offen offset:1024 sc1
    s_barrier
    s_branch NEXT
G4_last:
    buffer_load_dwordx4 v[24:27], v2, s[24:27], s40 offen offset:0 sc1
    buffer_load_dwordx4 v[28:31], v2, s[24:27], s40 offen offset:1024 sc1
    buffer_load_dwordx4 v[32:35], v2, s[24:27], s44 offen offset:0 sc1
    buffer_load_dwordx4 v[36:39], v2, s[24:27], s44 offen offset:1024 sc1
    s_mov_b32 s53, 0
dw_23:
    s_waitcnt vmcnt(0)
    v_and_b32 v8, v24, v25
    v_and_b32 v9, v32, v33
    v_bitop3_b32 v8, v26, v27, v8 bitop3:0x80
    v_bitop3_b32 v9, v34, v35, v9 bitop3:0x80
    v_bitop3_b32 v8, v28, v29, v8 bitop3:0x80
    v_bitop3_b32 v9, v36, v37, v9 bitop3:0x80
    v_bitop3_b32 v8, v30, v31, v8 bitop3:0x80
    v_bitop3_b32 v9, v38, v39, v9 bitop3:0x80
    v_bitop3_b32 v8, v8, v9, 1 bitop3:0x80
    v_cmp_eq_u32 vcc, 0, v8
    s_nop 0
    s_cmp_eq_u64 vcc, 0
    s_cbranch_scc1 dok_24
    s_mov_b64 exec, vcc
    s_sleep 1
    buffer_load_dwordx4 v[24:27], v2, s[24:27], s40 offen offset:0 sc1
    buffer_load_dwordx4 v[28:31], v2, s[24:27], s40 offen offset:1024 sc1
    buffer_load_dwordx4 v[32:35], v2, s[24:27], s44 offen offset:0 sc1
    buffer_load_dwordx4 v[36:39], v2, s[24:27], s44 offen offset:1024 sc1
    s_add_u32 s53, s53, 1
    s_cmp_lt_u32 s53, s61
    s_cbranch_scc1 dw_23
    s_mov_b32 s61, 0
    s_waitcnt vmcnt(0)
dok_24:
    s_mov_b64 exec, -1
    v_mfma_f32_16x16x32_bf16 v[120:123], v[56:59], v[24:27], v[120:123]
    v_mfma_f32_16x16x32_bf16 v[124:127], v[60:63], v[24:27], v[124:127]
    v_mfma_f32_16x16x32_bf16 v[128:131], v[56:59], v[28:31], v[128:131]
    v_mfma_f32_16x16x32_bf16 v[132:135], v[60:63], v[28:31], v[132:135]
    v_mfma_f32_16x16x32_bf16 v[136:139], v[56:59], v[32:35], v[136:139]
    v_mfma_f32_16x16x32_bf16 v[140:143], v[60:63], v[32:35], v[140:143]
    v_mfma_f32_16x16x32_bf16 v[144:147], v[56:59], v[36:39], v[144:147]
    v_mfma_f32_16x16x32_bf16 v[148:151], v[60:63], v[36:39], v[148:151]
    s_nop 0
    v_cvt_pk_bf16_f32 v120, v120, v121
    v_cvt_pk_bf16_f32 v121, v122, v123
    v_cvt_pk_bf16_f32 v122, v124, v125
    v_cvt_pk_bf16_f32 v123, v126, v127
    s_nop 0
    v_permlane16_swap_b32 v120, v122
    v_permlane16_swap_b32 v121, v123
    v_cvt_pk_bf16_f32 v128, v128, v129
    v_cvt_pk_bf16_f32 v129, v130, v131
    v_cvt_pk_bf16_f32 v130, v132, v133
    v_cvt_pk_bf16_f32 v131, v134, v135
    s_nop 0
    v_permlane16_swap_b32 v128, v130
    v_permlane16_swap_b32 v129, v131
    v_cndmask_b32 v132, v120, v128, s[50:51]
    v_cndmask_b32 v133, v121, v129, s[50:51]
    v_cndmask_b32 v134, v122, v130, s[50:51]
    v_cndmask_b32 v135, v123, v131, s[50:51]
    v_mov_b32_dpp v124, v132 row_ror:8 row_mask:0xf bank_mask:0xf
    v_mov_b32_dpp v125, v133 row_ror:8 row_mask:0xf bank_mask:0xf
    v_mov_b32_dpp v126, v134 row_ror:8 row_mask:0xf bank_mask:0xf
    v_mov_b32_dpp v127, v135 row_ror:8 row_mask:0xf bank_mask:0xf
    v_cndmask_b32 v120, v124, v120, s[50:51]
    v_cndmask_b32 v128, v128, v124, s[50:51]
    v_cndmask_b32 v121, v125, v121, s[50:51]
    v_cndmask_b32 v129, v129, v125, s[50:51]
    v_cndmask_b32 v122, v126, v122, s[50:51]
    v_cndmask_b32 v130, v130, v126, s[50:51]
    v_cndmask_b32 v123, v127, v123, s[50:51]
    v_cndmask_b32 v131, v131, v127, s[50:51]
    buffer_store_dwordx4 v[120:123], v66, s[20:23], s46 offen sc1
    buffer_store_dwordx4 v[128:131], v67, s[20:23], s46 offen sc1
    v_cvt_pk_bf16_f32 v136, v136, v137
    v_cvt_pk_bf16_f32 v137, v138, v139
    v_cvt_pk_bf16_f32 v138, v140, v141
    v_cvt_pk_bf16_f32 v139, v142, v143
    s_nop 0
    v_permlane16_swap_b32 v136, v138
    v_permlane16_swap_b32 v137, v139
    v_cvt_pk_bf16_f32 v144, v144, v145
    v_cvt_pk_bf16_f32 v145, v146, v147
    v_cvt_pk_bf16_f32 v146, v148, v149
    v_cvt_pk_bf16_f32 v147, v150, v151
    s_nop 0
    v_permlane16_swap_b32 v144, v146
    v_permlane16_swap_b32 v145, v147
    v_cndmask_b32 v148, v136, v144, s[50:51]
    v_cndmask_b32 v149, v137, v145, s[50:51]
    v_cndmask_b32 v150, v138, v146, s[50:51]
    v_cndmask_b32 v151, v139, v147, s[50:51]
    v_mov_b32_dpp v140, v148 row_ror:8 row_mask:0xf bank_mask:0xf
    v_mov_b32_dpp v141, v149 row_ror:8 row_mask:0xf bank_mask:0xf
    v_mov_b32_dpp v142, v150 row_ror:8 row_mask:0xf bank_mask:0xf
    v_mov_b32_dpp v143, v151 row_ror:8 row_mask:0xf bank_mask:0xf
    v_cndmask_b32 v136, v140, v136, s[50:51]
    v_cndmask_b32 v144, v144, v140, s[50:51]
    v_cndmask_b32 v137, v141, v137, s[50:51]
    v_cndmask_b32 v145, v145, v141, s[50:51]
    v_cndmask_b32 v138, v142, v138, s[50:51]
    v_cndmask_b32 v146, v146, v142, s[50:51]
    v_cndmask_b32 v139, v143, v139, s[50:51]
    v_cndmask_b32 v147, v147, v143, s[50:51]
    buffer_store_dwordx4 v[136:139], v66, s[20:23], s47 offen sc1
    buffer_store_dwordx4 v[144:147], v67, s[20:23], s47 offen sc1
    s_branch K_fin
LOADERS:
    s_mov_b64 s[80:81], s[68:69]
    s_mov_b32 s82, 2097152
    s_mov_b32 s83, 0x20000
    s_cmp_lg_u32 s60, 0
    s_cbranch_scc1 WY_1
    ds_read_b64_tr_b16 v[128:129], v74 offset:0
    ds_read_b64_tr_b16 v[130:131], v74 offset:2048
    ds_read_b64_tr_b16 v[136:137], v74 offset:4096
    ds_read_b64_tr_b16 v[138:139], v74 offset:6144
    ds_read_b64_tr_b16 v[144:145], v74 offset:8192
    ds_read_b64_tr_b16 v[146:147], v74 offset:10240
    ds_read_b64_tr_b16 v[152:153], v74 offset:12288
    ds_read_b64_tr_b16 v[154:155], v74 offset:14336
    ds_read_b64_tr_b16 v[160:161], v74 offset:16384
    ds_read_b64_tr_b16 v[162:163], v74 offset:18432
    ds_read_b64_tr_b16 v[168:169], v74 offset:20480
    ds_read_b64_tr_b16 v[170:171], v74 offset:22528
    ds_read_b64_tr_b16 v[176:177], v75 offset:16384
    ds_read_b64_tr_b16 v[178:179], v75 offset:18432
    ds_read_b64_tr_b16 v[184:185], v75 offset:20480
    ds_read_b64_tr_b16 v[186:187], v75 offset:22528
    ds_read_b64_tr_b16 v[192:193], v75 offset:24576
    ds_read_b64_tr_b16 v[194:195], v75 offset:26624
    ds_read_b64_tr_b16 v[200:201], v75 offset:28672
    ds_read_b64_tr_b16 v[202:203], v75 offset:30720
    ds_read_b64_tr_b16 v[208:209], v74 offset:32768
    ds_read_b64_tr_b16 v[210:211], v74 offset:34816
    ds_read_b64_tr_b16 v[216:217], v74 offset:36864
    ds_read_b64_tr_b16 v[218:219], v74 offset:38912
    ds_read_b64_tr_b16 v[224:225], v74 offset:40960
    ds_read_b64_tr_b16 v[226:227], v74 offset:43008
    ds_read_b64_tr_b16 v[232:233], v74 offset:45056
    ds_read_b64_tr_b16 v[234:235], v74 offset:47104
    ds_read_b64_tr_b16 v[240:241], v75 offset:32768
    ds_read_b64_tr_b16 v[242:243], v75 offset:34816
    ds_read_b64_tr_b16 v[248:249], v75 offset:36864
    ds_read_b64_tr_b16 v[250:251], v75 offset:38912
    s_waitcnt vmcnt(0) lgkmcnt(0)
    s_barrier
    s_and_b32 s49, s30, 3
    s_lshl_b32 s36, s49, 14
    s_lshl_b32 s48, s29, 7
    s_add_u32 s48, s48, s36
    s_lshl_b32 s49, s49, 10
    s_xor_b32 s48, s48, 128
    s_add_u32 s36, s67, 7
    s_and_b32 s36, s36, 7
    s_lshl_b32 s36, s36, 17
    s_add_u32 s36, s36, s48
    s_add_u32 m0, s49, 81920
    s_nop 0
    buffer_load_dwordx4 v118, s[80:83], s36 offen lds
    s_add_u32 s36, s36, 65536
    s_add_u32 m0, s49, 86016
    s_nop 0
    buffer_load_dwordx4 v118, s[80:83], s36 offen lds
    s_add_u32 s36, s67, 0
    s_and_b32 s36, s36, 7
    s_lshl_b32 s36, s36, 17
    s_add_u32 s36, s36, s48
    s_add_u32 s36, s36, 1048576
    s_add_u32 m0, s49, 90112
    s_nop 0
    buffer_load_dwordx4 v118, s[80:83], s36 offen lds
    s_add_u32 s36, s36, 65536
    s_add_u32 m0, s49, 94208
    s_nop 0
    buffer_load_dwordx4 v118, s[80:83], s36 offen lds
    s_add_u32 s36, s67, 1
    s_and_b32 s36, s36, 7
    s_lshl_b32 s36, s36, 17
    s_add_u32 s36, s36, s48
    s_add_u32 m0, s49, 32768
    s_nop 0
    buffer_load_dwordx4 v118, s[80:83], s36 offen lds
    s_add_u32 s36, s36, 65536
    s_add_u32 m0, s49, 36864
    s_nop 0
    buffer_load_dwordx4 v118, s[80:83], s36 offen lds
    s_branch WY_2
WY_1:
    s_and_b32 s49, s30, 3
    s_lshl_b32 s36, s49, 14
    s_lshl_b32 s48, s29, 7
    s_add_u32 s48, s48, s36
    s_lshl_b32 s49, s49, 10
    s_xor_b32 s48, s48, 128
    s_add_u32 s36, s67, 7
    s_and_b32 s36, s36, 7
    s_lshl_b32 s36, s36, 17
    s_add_u32 s36, s36, s48
    s_add_u32 m0, s49, 81920
    s_nop 0
    buffer_load_dwordx4 v118, s[80:83], s36 offen lds
    s_add_u32 s36, s36, 65536
    s_add_u32 m0, s49, 86016
    s_nop 0
    buffer_load_dwordx4 v118, s[80:83], s36 offen lds
    s_add_u32 s36, s67, 0
    s_and_b32 s36, s36, 7
    s_lshl_b32 s36, s36, 17
    s_add_u32 s36, s36, s48
    s_add_u32 s36, s36, 1048576
    s_add_u32 m0, s49, 90112
    s_nop 0
    buffer_load_dwordx4 v118, s[80:83], s36 offen lds
    s_add_u32 s36, s36, 65536
    s_add_u32 m0, s49, 94208
    s_nop 0
    buffer_load_dwordx4 v118, s[80:83], s36 offen lds
    s_add_u32 s36, s67, 1
    s_and_b32 s36, s36, 7
    s_lshl_b32 s36, s36, 17
    s_add_u32 s36, s36, s48
    s_add_u32 m0, s49, 32768
    s_nop 0
    buffer_load_dwordx4 v118, s[80:83], s36 offen lds
    s_add_u32 s36, s36, 65536
    s_add_u32 m0, s49, 36864
    s_nop 0
    buffer_load_dwordx4 v118, s[80:83], s36 offen lds
    s_waitcnt vmcnt(6)
    s_barrier
WY_2:
    s_and_b32 s49, s30, 3
    s_lshl_b32 s36, s49, 14
    s_lshl_b32 s48, s29, 7
    s_add_u32 s48, s48, s36
    s_lshl_b32 s49, s49, 10
    s_xor_b32 s48, s48, 128
    s_add_u32 s36, s67, 2
    s_and_b32 s36, s36, 7
    s_lshl_b32 s36, s36, 17
    s_add_u32 s36, s36, s48
    s_add_u32 m0, s49, 40960
    s_nop 0
    buffer_load_dwordx4 v118, s[80:83], s36 offen lds
    s_add_u32 s36, s36, 65536
    s_add_u32 m0, s49, 45056
    s_nop 0
    buffer_load_dwordx4 v118, s[80:83], s36 offen lds
    s_add_u32 s36, s67, 1
    s_and_b32 s36, s36, 7
    s_lshl_b32 s36, s36, 17
    s_add_u32 s36, s36, s48
    s_add_u32 s36, s36, 1048576
    s_add_u32 m0, s49, 98304
    s_nop 0
    buffer_load_dwordx4 v118, s[80:83], s36 offen lds
    s_add_u32 s36, s36, 65536
    s_add_u32 m0, s49, 102400
    s_nop 0
    buffer_load_dwordx4 v118, s[80:83], s36 offen lds
    s_add_u32 s36, s67, 2
    s_and_b32 s36, s36, 7
    s_lshl_b32 s36, s36, 17
    s_add_u32 s36, s36, s48
    s_add_u32 s36, s36, 1048576
    s_add_u32 m0, s49, 106496
    s_nop 0
    buffer_load_dwordx4 v118, s[80:83], s36 offen lds
    s_add_u32 s36, s36, 65536
    s_add_u32 m0, s49, 110592
    s_nop 0
    buffer_load_dwordx4 v118, s[80:83], s36 offen lds
    v_and_b32 v8, 15, v1
    v_lshrrev_b32 v9, 4, v1
    s_and_b32 s34, s30, 1
    s_and_b32 s37, s30, 3
    s_lshr_b32 s38, s29, 3
    s_add_u32 s38, s38, 1
    s_sub_u32 s39, 0, s38
    s_bitcmp1_b32 s29, 2
    s_cselect_b32 s38, s38, s39
    s_lshl_b32 s48, s28, 7
    s_cmp_lt_u32 s37, 2
    s_cselect_b32 s36, s38, 0
    s_add_u32 s36, s36, s48
    s_lshl_b32 s45, s34, 6
    s_add_u32 s36, s36, s45
    v_add_u32 v72, s36, v1
    s_movk_i32 s45, 2048
    v_cmp_gt_u32 s[46:47], s45, v72
    v_lshlrev_b32 v72, 4, v72
    s_lshl_b32 s22, s60, 15
    s_add_u32 s22, s22, 23199744
    s_add_u32 s20, s4, s22
    s_addc_u32 s21, s5, 0
    s_mov_b32 s22, 32768
    s_mov_b32 s23, 0x20000
    s_lshl_b32 s36, s37, 2
    v_add_u32 v6, s36, v9
    v_xor_b32 v10, v6, v8
    s_add_u32 s36, s48, s38
    s_add_u32 s36, s36, 16
    v_add_u32 v6, s36, v6
    v_and_b32 v7, 3, v6
    v_lshrrev_b32 v11, 2, v6
    v_lshlrev_b32 v11, 14, v11
    v_lshl_add_u32 v11, v7, 11, v11
    v_lshl_add_u32 v11, v10, 4, v11
    v_subrev_u32 v10, 65536, v11
    s_add_u32 s40, s67, 0
    s_and_b32 s40, s40, 6
    s_lshl_b32 s40, s40, 7
    s_add_u32 s41, s67, 2
    s_and_b32 s41, s41, 6
    s_lshl_b32 s41, s41, 7
    s_add_u32 s42, s67, 4
    s_and_b32 s42, s42, 6
    s_lshl_b32 s42, s42, 7
    s_add_u32 s43, s67, 6
    s_and_b32 s43, s43, 6
    s_lshl_b32 s43, s43, 7
    s_lshl_b32 s44, s37, 10
    v_lshrrev_b32 v6, 3, v1
    v_and_b32 v17, 7, v1
    v_xor_b32 v17, v17, v6
    s_lshl_b32 s36, s37, 3
    s_add_u32 s36, s36, s48
    v_add_u32 v6, s36, v6
    v_and_b32 v7, 3, v6
    v_lshrrev_b32 v12, 2, v6
    v_lshlrev_b32 v12, 14, v12
    v_lshl_add_u32 v12, v7, 11, v12
    s_lshl_b32 s36, s29, 7
    v_lshl_add_u32 v12, v17, 4, v12
    v_add_u32 v12, s36, v12
    v_lshrrev_b32 v6, 1, v9
    s_lshl_b32 s36, s37, 1
    v_add_u32 v6, s36, v6
    v_and_b32 v7, 7, v8
    v_xor_b32 v6, v6, v7
    v_lshlrev_b32 v17, 7, v8
    v_lshl_add_u32 v17, v6, 4, v17
    v_and_b32 v6, 1, v9
    v_lshl_add_u32 v17, v6, 3, v17
    v_and_b32 v6, 1, v9
    v_lshlrev_b32 v13, 16, v6
    v_lshrrev_b32 v6, 1, v9
    v_lshl_add_u32 v13, v6, 8, v13
    v_lshl_add_u32 v13, v8, 4, v13
    s_bfe_u32 s36, s30, 0x10001
    s_lshl1_add_u32 s36, s29, s36
    s_lshr_b32 s53, s36, 3
    s_lshl_b32 s53, s53, 14
    s_and_b32 s39, s36, 7
    s_lshl_b32 s39, s39, 10
    s_add_u32 s39, s39, s53
    s_and_b32 s36, s30, 1
    s_lshl_b32 s36, s36, 9
    s_add_u32 s39, s39, s36
    v_mov_b32 v14, v2
    v_add_u32 v15, 106496, v2
    v_lshrrev_b32 v6, 5, v13
    v_and_b32 v6, 2048, v6
    v_and_b32 v16, 511, v13
    v_add_u32 v16, v16, v6
    s_lshl_b32 s36, s37, 9
    v_add_u32 v16, s36, v16
    s_lshl_b32 s14, s60, 24
    s_lshl_b32 s15, s94, 13
    s_add_u32 s14, s14, s15
    s_add_u32 s14, s14, 167772160
    s_add_u32 s12, s4, s14
    s_addc_u32 s13, s5, 0
    s_mov_b32 s14, 8380416
    s_mov_b32 s15, 0x20000
    s_add_u32 s16, s62, 0x400000
    s_addc_u32 s17, s63, 0
    s_mov_b32 s18, 0x7e000
    s_mov_b32 s19, 0x20000
    s_add_u32 s24, s62, 0x480000
    s_addc_u32 s25, s63, 0
    s_mov_b32 s26, 0x7e000
    s_mov_b32 s27, 0x20000
    s_and_b32 s82, s30, 3
    s_lshl_b32 s82, s82, 15
    s_add_u32 s53, s67, 0
    s_and_b32 s78, s53, 4
    s_and_b32 s53, s53, 2
    s_lshl_b32 s78, s78, 12
    s_lshl_b32 s53, s53, 11
    s_add_u32 s78, s78, s53
    s_add_u32 s78, s78, s82
    s_add_u32 s53, s67, 2
    s_and_b32 s79, s53, 4
    s_and_b32 s53, s53, 2
    s_lshl_b32 s79, s79, 12
    s_lshl_b32 s53, s53, 11
    s_add_u32 s79, s79, s53
    s_add_u32 s79, s79, s82
    s_add_u32 s53, s67, 4
    s_and_b32 s80, s53, 4
    s_and_b32 s53, s53, 2
    s_lshl_b32 s80, s80, 12
    s_lshl_b32 s53, s53, 11
    s_add_u32 s80, s80, s53
    s_add_u32 s80, s80, s82
    s_add_u32 s53, s67, 6
    s_and_b32 s81, s53, 4
    s_and_b32 s53, s53, 2
    s_lshl_b32 s81, s81, 12
    s_lshl_b32 s53, s53, 11
    s_add_u32 s81, s81, s53
    s_add_u32 s81, s81, s82
    s_and_b32 s53, s30, 2
    s_lshl_b32 s53, s53, 11
    s_and_b32 s82, s30, 1
    s_lshl_b32 s82, s82, 13
    s_add_u32 s82, s82, s53
    s_and_b32 s84, s30, 1
    s_lshl_b32 s84, s84, 8
    s_add_u32 s84, s84, s55
    s_add_u32 s85, s52, 16
    s_waitcnt vmcnt(0) lgkmcnt(0)
    s_barrier
    s_setprio 1
    s_add_u32 m0, s44, 16384
    s_add_u32 s49, s40, 0
    s_barrier
    buffer_load_dwordx4 v[52:55], v72, s[20:23], 0 offen sc1
    buffer_load_dwordx4 v10, s[12:15], s49 offen offset:0 sc1 lds
    s_add_u32 m0, s44, 23552
    s_nop 0
    buffer_load_dwordx4 v10, s[12:15], s49 offen offset:1024 sc1 lds
    s_add_u32 m0, s44, 20480
    s_nop 0
    buffer_load_dwordx4 v11, s[12:15], s49 offen offset:0 sc1 lds
    s_add_u32 m0, s44, 27648
    s_nop 0
    buffer_load_dwordx4 v11, s[12:15], s49 offen offset:1024 sc1 lds
    s_add_u32 m0, s44, 32768
    s_add_u32 s49, s41, 0
    buffer_load_dwordx4 v10, s[12:15], s49 offen offset:0 sc1 lds
    s_add_u32 m0, s44, 39936
    s_nop 0
    buffer_load_dwordx4 v10, s[12:15], s49 offen offset:1024 sc1 lds
    s_add_u32 m0, s44, 36864
    s_nop 0
    buffer_load_dwordx4 v11, s[12:15], s49 offen offset:0 sc1 lds
    s_add_u32 m0, s44, 44032
    s_nop 0
    buffer_load_dwordx4 v11, s[12:15], s49 offen offset:1024 sc1 lds
    s_waitcnt vmcnt(8)
    s_mov_b32 s53, 0
lns_25:
    v_cmp_eq_u32 vcc, s52, v53
    v_cmp_eq_u32 s[50:51], s52, v55
    s_nop 0
    s_and_b64 vcc, vcc, s[50:51]
    s_orn2_b64 vcc, vcc, s[46:47]
    s_cmp_eq_u64 vcc, -1
    s_cbranch_scc1 lnk_26
    buffer_load_dwordx4 v[52:55], v72, s[20:23], 0 offen sc1
    s_waitcnt vmcnt(0)
    s_add_u32 s53, s53, 1
    s_cmp_lt_u32 s53, s61
    s_cbranch_scc1 lns_25
    s_mov_b32 s61, 0
lnk_26:
    v_lshlrev_b32 v56, 16, v52
    v_and_b32 v57, 0xffff0000, v52
    v_lshlrev_b32 v58, 16, v54
    v_and_b32 v59, 0xffff0000, v54
    v_cndmask_b32 v57, 1.0, v57, s[46:47]
    v_cndmask_b32 v59, 1.0, v59, s[46:47]
    s_lshl_b32 s36, s34, 10
    s_add_u32 s36, s36, 155648
    v_add_u32 v6, s36, v2
    s_cmp_ge_u32 s37, 2
    s_cbranch_scc1 lnx_27
    v_mul_f32 v66, v57, v59
    v_fma_f32 v60, -v58, v57, -v56
    v_rcp_f32 v7, v66
    v_mov_b32 v67, v66
    v_mov_b32 v61, v60
    v_mul_f32 v62, 0xc0135761, v7
    v_mul_f32 v7, v7, v7
    v_mov_b32 v63, v62
    v_mul_f32 v7, 0x3d372713, v7
    v_mul_f32 v64, v7, v62
    v_mov_b32 v65, v64
    ds_write_b128 v6, v[60:63] offset:0
    ds_write_b128 v6, v[64:67] offset:2048
    s_branch lnd_28
lnx_27:
    v_rcp_f32 v60, v57
    s_nop 0
    v_mul_f32 v62, -v56, v60
    v_mov_b32 v61, v60
    v_mov_b32 v63, v62
    ds_write_b128 v6, v[60:63] offset:5120
lnd_28:
    v_lshlrev_b32 v7, 4, v8
    v_add_u32 v7, 160768, v7
    s_add_u32 m0, s44, 106496
    s_add_u32 s49, s42, 0
    buffer_load_dwordx4 v10, s[12:15], s49 offen offset:0 sc1 lds
    s_add_u32 m0, s44, 113664
    s_nop 0
    buffer_load_dwordx4 v10, s[12:15], s49 offen offset:1024 sc1 lds
    s_add_u32 m0, s44, 110592
    s_nop 0
    buffer_load_dwordx4 v11, s[12:15], s49 offen offset:0 sc1 lds
    s_add_u32 m0, s44, 117760
    s_nop 0
    buffer_load_dwordx4 v11, s[12:15], s49 offen offset:1024 sc1 lds
    s_add_u32 m0, s44, 122880
    s_add_u32 s49, s43, 0
    s_waitcnt vmcnt(8)
    s_barrier
    buffer_load_dwordx4 v10, s[12:15], s49 offen offset:0 sc1 lds
    s_add_u32 m0, s44, 130048
    s_nop 0
    buffer_load_dwordx4 v10, s[12:15], s49 offen offset:1024 sc1 lds
    s_add_u32 m0, s44, 126976
    s_nop 0
    buffer_load_dwordx4 v11, s[12:15], s49 offen offset:0 sc1 lds
    s_add_u32 m0, s44, 134144
    s_nop 0
    buffer_load_dwordx4 v11, s[12:15], s49 offen offset:1024 sc1 lds
    v_mov_b32 v10, v11
    v_add_u32 v11, 65536, v11
    s_add_u32 m0, s44, 139264
    s_add_u32 s49, s40, 65536
    s_waitcnt vmcnt(8)
    s_barrier
    buffer_load_dwordx4 v10, s[12:15], s49 offen offset:0 sc1 lds
    s_add_u32 m0, s44, 146432
    s_nop 0
    buffer_load_dwordx4 v10, s[12:15], s49 offen offset:1024 sc1 lds
    s_add_u32 m0, s44, 143360
    s_nop 0
    buffer_load_dwordx4 v11, s[12:15], s49 offen offset:0 sc1 lds
    s_add_u32 m0, s44, 150528
    s_nop 0
    buffer_load_dwordx4 v11, s[12:15], s49 offen offset:1024 sc1 lds
    s_add_u32 m0, s44, 16384
    s_add_u32 s49, s41, 65536
    s_waitcnt vmcnt(8)
    s_barrier
    buffer_load_dwordx4 v10, s[12:15], s49 offen offset:0 sc1 lds
    s_add_u32 m0, s44, 23552
    s_nop 0
    buffer_load_dwordx4 v10, s[12:15], s49 offen offset:1024 sc1 lds
    s_add_u32 m0, s44, 20480
    s_nop 0
    buffer_load_dwordx4 v11, s[12:15], s49 offen offset:0 sc1 lds
    s_add_u32 m0, s44, 27648
    s_nop 0
    buffer_load_dwordx4 v11, s[12:15], s49 offen offset:1024 sc1 lds
    s_add_u32 m0, s44, 32768
    s_add_u32 s49, s42, 65536
    s_waitcnt vmcnt(8)
    s_barrier
    buffer_load_dwordx4 v10, s[12:15], s49 offen offset:0 sc1 lds
    s_add_u32 m0, s44, 39936
    s_nop 0
    buffer_load_dwordx4 v10, s[12:15], s49 offen offset:1024 sc1 lds
    s_add_u32 m0, s44, 36864
    s_nop 0
    buffer_load_dwordx4 v11, s[12:15], s49 offen offset:0 sc1 lds
    s_add_u32 m0, s44, 44032
    s_nop 0
    buffer_load_dwordx4 v11, s[12:15], s49 offen offset:1024 sc1 lds
    s_waitcnt lgkmcnt(0)
    s_add_u32 m0, s44, 106496
    s_add_u32 s49, s43, 65536
    s_waitcnt vmcnt(8)
    s_barrier
    buffer_load_dwordx4 v10, s[12:15], s49 offen offset:0 sc1 lds
    s_add_u32 m0, s44, 113664
    s_nop 0
    buffer_load_dwordx4 v10, s[12:15], s49 offen offset:1024 sc1 lds
    s_add_u32 m0, s44, 110592
    s_nop 0
    buffer_load_dwordx4 v11, s[12:15], s49 offen offset:0 sc1 lds
    s_add_u32 m0, s44, 117760
    s_nop 0
    buffer_load_dwordx4 v11, s[12:15], s49 offen offset:1024 sc1 lds
    s_add_u32 m0, s44, 0
    s_mov_b32 s36, 0
    buffer_load_dwordx4 v12, s[12:15], s36 offen sc1 lds
    s_add_u32 m0, s44, 4096
    s_mov_b32 s36, 131072
    buffer_load_dwordx4 v12, s[12:15], s36 offen sc1 lds
    s_add_u32 m0, s44, 8192
    s_mov_b32 s36, 262144
    buffer_load_dwordx4 v12, s[12:15], s36 offen sc1 lds
    s_add_u32 m0, s44, 12288
    s_mov_b32 s36, 393216
    buffer_load_dwordx4 v12, s[12:15], s36 offen sc1 lds
    s_add_u32 m0, s44, 122880
    s_add_u32 s49, s40, 196608
    s_waitcnt vmcnt(12)
    s_barrier
    buffer_load_dwordx4 v10, s[12:15], s49 offen offset:0 sc1 lds
    s_add_u32 m0, s44, 130048
    s_nop 0
    buffer_load_dwordx4 v10, s[12:15], s49 offen offset:1024 sc1 lds
    s_add_u32 m0, s44, 126976
    s_nop 0
    buffer_load_dwordx4 v11, s[12:15], s49 offen offset:0 sc1 lds
    s_add_u32 m0, s44, 134144
    s_nop 0
    buffer_load_dwordx4 v11, s[12:15], s49 offen offset:1024 sc1 lds
    s_add_u32 m0, s44, 139264
    s_add_u32 s49, s41, 196608
    s_waitcnt vmcnt(12)
    s_barrier
    buffer_load_dwordx4 v10, s[12:15], s49 offen offset:0 sc1 lds
    s_add_u32 m0, s44, 146432
    s_nop 0
    buffer_load_dwordx4 v10, s[12:15], s49 offen offset:1024 sc1 lds
    s_add_u32 m0, s44, 143360
    s_nop 0
    buffer_load_dwordx4 v11, s[12:15], s49 offen offset:0 sc1 lds
    s_add_u32 m0, s44, 150528
    s_nop 0
    buffer_load_dwordx4 v11, s[12:15], s49 offen offset:1024 sc1 lds
    s_add_u32 m0, s44, 16384
    s_add_u32 s49, s42, 196608
    s_waitcnt vmcnt(8)
    s_barrier
    buffer_load_dwordx4 v10, s[12:15], s49 offen offset:0 sc1 lds
    s_add_u32 m0, s44, 23552
    s_nop 0
    buffer_load_dwordx4 v10, s[12:15], s49 offen offset:1024 sc1 lds
    s_add_u32 m0, s44, 20480
    s_nop 0
    buffer_load_dwordx4 v11, s[12:15], s49 offen offset:0 sc1 lds
    s_add_u32 m0, s44, 27648
    s_nop 0
    buffer_load_dwordx4 v11, s[12:15], s49 offen offset:1024 sc1 lds
    ds_read_b64 v[22:23], v17 offset:0
    ds_read_b128 v[60:63], v7 offset:0
    ds_read_b64 v[26:27], v17 offset:2048
    ds_read_b128 v[64:67], v7 offset:256
    s_add_u32 m0, s44, 32768
    s_add_u32 s49, s43, 196608
    s_waitcnt vmcnt(8)
    s_barrier
    buffer_load_dwordx4 v10, s[12:15], s49 offen offset:0 sc1 lds
    s_waitcnt lgkmcnt(0)
    v_lshlrev_b32 v20, 16, v22
    v_and_b32 v21, 0xffff0000, v22
    v_lshlrev_b32 v22, 16, v23
    v_and_b32 v23, 0xffff0000, v23
    s_add_u32 m0, s44, 39936
    s_nop 0
    buffer_load_dwordx4 v10, s[12:15], s49 offen offset:1024 sc1 lds
    v_pk_fma_f32 v[20:21], v[20:21], v[60:61], v[62:63]
    v_pk_fma_f32 v[22:23], v[22:23], v[60:61], v[62:63]
    v_lshlrev_b32 v24, 16, v26
    v_and_b32 v25, 0xffff0000, v26
    v_lshlrev_b32 v26, 16, v27
    s_add_u32 m0, s44, 36864
    s_nop 0
    buffer_load_dwordx4 v11, s[12:15], s49 offen offset:0 sc1 lds
    v_and_b32 v27, 0xffff0000, v27
    v_pk_fma_f32 v[24:25], v[24:25], v[64:65], v[66:67]
    v_pk_fma_f32 v[26:27], v[26:27], v[64:65], v[66:67]
    s_add_u32 m0, s44, 44032
    s_nop 0
    buffer_load_dwordx4 v11, s[12:15], s49 offen offset:1024 sc1 lds
    ds_read_b64 v[30:31], v17 offset:4096
    ds_read_b128 v[60:63], v7 offset:512
    ds_read_b64 v[34:35], v17 offset:6144
    ds_read_b128 v[64:67], v7 offset:768
    s_mov_b32 s88, 0
    s_call_b64 s[76:77], SUB_w3_sub_3
    s_add_u32 m0, s44, 106496
    s_add_u32 s49, s40, 327680
    s_waitcnt vmcnt(15)
    s_barrier
    buffer_load_dwordx4 v10, s[12:15], s49 offen offset:0 sc1 lds
    s_waitcnt lgkmcnt(0)
    v_lshlrev_b32 v28, 16, v30
    v_and_b32 v29, 0xffff0000, v30
    v_lshlrev_b32 v30, 16, v31
    v_and_b32 v31, 0xffff0000, v31
    s_add_u32 m0, s44, 113664
    s_nop 0
    buffer_load_dwordx4 v10, s[12:15], s49 offen offset:1024 sc1 lds
    v_pk_fma_f32 v[28:29], v[28:29], v[60:61], v[62:63]
    v_pk_fma_f32 v[30:31], v[30:31], v[60:61], v[62:63]
    v_lshlrev_b32 v32, 16, v34
    v_and_b32 v33, 0xffff0000, v34
    v_lshlrev_b32 v34, 16, v35
    s_add_u32 m0, s44, 110592
    s_nop 0
    buffer_load_dwordx4 v11, s[12:15], s49 offen offset:0 sc1 lds
    v_and_b32 v35, 0xffff0000, v35
    v_pk_fma_f32 v[32:33], v[32:33], v[64:65], v[66:67]
    v_pk_fma_f32 v[34:35], v[34:35], v[64:65], v[66:67]
    s_add_u32 m0, s44, 117760
    s_nop 0
    buffer_load_dwordx4 v11, s[12:15], s49 offen offset:1024 sc1 lds
    ds_read_b64 v[38:39], v17 offset:8192
    ds_read_b128 v[60:63], v7 offset:1024
    ds_read_b64 v[42:43], v17 offset:10240
    ds_read_b128 v[64:67], v7 offset:1280
    s_add_u32 m0, s44, 122880
    s_add_u32 s49, s41, 327680
    s_waitcnt vmcnt(15)
    s_barrier
    buffer_load_dwordx4 v10, s[12:15], s49 offen offset:0 sc1 lds
    s_waitcnt lgkmcnt(0)
    v_lshlrev_b32 v36, 16, v38
    v_and_b32 v37, 0xffff0000, v38
    v_lshlrev_b32 v38, 16, v39
    v_and_b32 v39, 0xffff0000, v39
    s_add_u32 m0, s44, 130048
    s_nop 0
    buffer_load_dwordx4 v10, s[12:15], s49 offen offset:1024 sc1 lds
    v_pk_fma_f32 v[36:37], v[36:37], v[60:61], v[62:63]
    v_pk_fma_f32 v[38:39], v[38:39], v[60:61], v[62:63]
    v_lshlrev_b32 v40, 16, v42
    v_and_b32 v41, 0xffff0000, v42
    v_lshlrev_b32 v42, 16, v43
    s_add_u32 m0, s44, 126976
    s_nop 0
    buffer_load_dwordx4 v11, s[12:15], s49 offen offset:0 sc1 lds
    v_and_b32 v43, 0xffff0000, v43
    v_pk_fma_f32 v[40:41], v[40:41], v[64:65], v[66:67]
    v_pk_fma_f32 v[42:43], v[42:43], v[64:65], v[66:67]
    s_add_u32 m0, s44, 134144
    s_nop 0
    buffer_load_dwordx4 v11, s[12:15], s49 offen offset:1024 sc1 lds
    ds_read_b64 v[46:47], v17 offset:12288
    ds_read_b128 v[60:63], v7 offset:1536
    ds_read_b64 v[50:51], v17 offset:14336
    ds_read_b128 v[64:67], v7 offset:1792
    s_add_u32 m0, s44, 139264
    s_add_u32 s49, s42, 327680
    s_waitcnt vmcnt(15)
    s_barrier
    buffer_load_dwordx4 v10, s[12:15], s49 offen offset:0 sc1 lds
    s_waitcnt lgkmcnt(0)
    v_lshlrev_b32 v44, 16, v46
    v_and_b32 v45, 0xffff0000, v46
    v_lshlrev_b32 v46, 16, v47
    v_and_b32 v47, 0xffff0000, v47
    s_add_u32 m0, s44, 146432
    s_nop 0
    buffer_load_dwordx4 v10, s[12:15], s49 offen offset:1024 sc1 lds
    v_pk_fma_f32 v[44:45], v[44:45], v[60:61], v[62:63]
    v_pk_fma_f32 v[46:47], v[46:47], v[60:61], v[62:63]
    v_lshlrev_b32 v48, 16, v50
    v_and_b32 v49, 0xffff0000, v50
    v_lshlrev_b32 v50, 16, v51
    s_add_u32 m0, s44, 143360
    s_nop 0
    buffer_load_dwordx4 v11, s[12:15], s49 offen offset:0 sc1 lds
    v_and_b32 v51, 0xffff0000, v51
    v_pk_fma_f32 v[48:49], v[48:49], v[64:65], v[66:67]
    v_pk_fma_f32 v[50:51], v[50:51], v[64:65], v[66:67]
    s_add_u32 m0, s44, 150528
    s_nop 0
    buffer_load_dwordx4 v11, s[12:15], s49 offen offset:1024 sc1 lds
    s_add_u32 m0, s44, 16384
    s_add_u32 s49, s43, 327680
    s_waitcnt vmcnt(8)
    s_barrier
    s_load_dword s32, s[4:5], s84 offset:2048
    s_load_dword s3, s[4:5], s84 offset:2176
    buffer_load_dwordx4 v10, s[12:15], s49 offen offset:0 sc1 lds
    s_add_u32 m0, s44, 23552
    s_nop 0
    buffer_load_dwordx4 v10, s[12:15], s49 offen offset:1024 sc1 lds
    s_add_u32 m0, s44, 20480
    s_nop 0
    buffer_load_dwordx4 v11, s[12:15], s49 offen offset:0 sc1 lds
    s_add_u32 m0, s44, 27648
    s_nop 0
    buffer_load_dwordx4 v11, s[12:15], s49 offen offset:1024 sc1 lds
    s_mov_b32 s88, 1
    s_call_b64 s[76:77], SUB_w3_sub_3
    s_add_u32 m0, s82, 32768
    s_add_u32 s49, s78, 0
    s_waitcnt vmcnt(15)
    s_barrier
    s_waitcnt lgkmcnt(0)
    s_cmp_eq_u32 s32, s85
    s_cselect_b32 s32, s3, 0
    s_cmp_eq_u32 s32, s85
    s_cbranch_scc1 hok_29
    s_add_u32 s53, s84, 2048
    v_lshlrev_b32 v109, 7, v1
    v_add_u32 v109, s53, v109
    s_mov_b32 s53, 0
    s_add_u32 s54, s52, 16
    s_bfm_b64 exec, 2, 0
poll_30:
    buffer_load_dword v108, v109, s[56:59], 0 offen sc1
    s_waitcnt vmcnt(0)
    v_cmp_eq_u32 vcc, s54, v108
    s_nop 0
    s_cmp_eq_u64 vcc, exec
    s_cbranch_scc1 pok_31
    s_sleep 8
    s_add_u32 s53, s53, 1
    s_cmp_lt_u32 s53, s61
    s_cbranch_scc1 poll_30
    s_mov_b32 s61, 0
pok_31:
    s_mov_b64 exec, -1
hok_29:
    buffer_load_dwordx4 v2, s[16:19], s49 offen offset:0 sc1 lds
    buffer_load_dwordx4 v2, s[16:19], s49 offen offset:1024 sc1 lds
    buffer_load_dwordx4 v2, s[16:19], s49 offen offset:2048 sc1 lds
    buffer_load_dwordx4 v2, s[16:19], s49 offen offset:3072 sc1 lds
    s_add_u32 m0, s82, 106496
    s_add_u32 s49, s79, 0
    s_waitcnt vmcnt(15)
    s_barrier
    buffer_load_dwordx4 v2, s[16:19], s49 offen offset:0 sc1 lds
    buffer_load_dwordx4 v2, s[16:19], s49 offen offset:1024 sc1 lds
    buffer_load_dwordx4 v2, s[16:19], s49 offen offset:2048 sc1 lds
    buffer_load_dwordx4 v2, s[16:19], s49 offen offset:3072 sc1 lds
    s_add_u32 m0, s82, 122880
    s_add_u32 s49, s80, 0
    s_waitcnt vmcnt(15)
    s_barrier
    buffer_load_dwordx4 v2, s[16:19], s49 offen offset:0 sc1 lds
    buffer_load_dwordx4 v2, s[16:19], s49 offen offset:1024 sc1 lds
    buffer_load_dwordx4 v2, s[16:19], s49 offen offset:2048 sc1 lds
    buffer_load_dwordx4 v2, s[16:19], s49 offen offset:3072 sc1 lds
    s_setprio 0
    s_waitcnt vmcnt(8)
    s_barrier
    ds_read_b128 v[52:55], v14 offset:32768
    ds_read_b128 v[56:59], v14 offset:36864
    ds_read_b128 v[60:63], v14 offset:40960
    ds_read_b128 v[64:67], v14 offset:45056
    ds_read_b128 v[68:71], v14 offset:33792
    ds_read_b128 v[72:75], v14 offset:37888
    ds_read_b128 v[76:79], v14 offset:41984
    ds_read_b128 v[80:83], v14 offset:46080
    s_waitcnt lgkmcnt(4)
    v_mfma_f32_16x16x32_bf16 v[20:23], v[128:131], v[52:55], v[20:23]
    ds_read_b128 v[84:87], v14 offset:34816
    v_mfma_f32_16x16x32_bf16 v[24:27], v[128:131], v[56:59], v[24:27]
    ds_read_b128 v[88:91], v14 offset:38912
    v_mfma_f32_16x16x32_bf16 v[24:27], v[132:135], v[64:67], v[24:27]
    ds_read_b128 v[92:95], v14 offset:43008
    v_mfma_f32_16x16x32_bf16 v[20:23], v[132:135], v[60:63], v[20:23]
    ds_read_b128 v[96:99], v14 offset:47104
    s_waitcnt lgkmcnt(4)
    v_mfma_f32_16x16x32_bf16 v[20:23], v[136:139], v[68:71], v[20:23]
    ds_read_b128 v[52:55], v14 offset:35840
    v_mfma_f32_16x16x32_bf16 v[24:27], v[136:139], v[72:75], v[24:27]
    ds_read_b128 v[56:59], v14 offset:39936
    v_mfma_f32_16x16x32_bf16 v[24:27], v[140:143], v[80:83], v[24:27]
    ds_read_b128 v[60:63], v14 offset:44032
    v_mfma_f32_16x16x32_bf16 v[20:23], v[140:143], v[76:79], v[20:23]
    ds_read_b128 v[64:67], v14 offset:48128
    s_waitcnt vmcnt(4)
    s_barrier
    s_waitcnt lgkmcnt(4)
    v_mfma_f32_16x16x32_bf16 v[20:23], v[144:147], v[84:87], v[20:23]
    ds_read_b128 v[68:71], v15 offset:0
    v_mfma_f32_16x16x32_bf16 v[24:27], v[144:147], v[88:91], v[24:27]
    ds_read_b128 v[72:75], v15 offset:4096
    v_mfma_f32_16x16x32_bf16 v[24:27], v[148:151], v[96:99], v[24:27]
    ds_read_b128 v[76:79], v15 offset:8192
    v_mfma_f32_16x16x32_bf16 v[20:23], v[148:151], v[92:95], v[20:23]
    ds_read_b128 v[80:83], v15 offset:12288
    s_waitcnt lgkmcnt(4)
    v_mfma_f32_16x16x32_bf16 v[20:23], v[152:155], v[52:55], v[20:23]
    ds_read_b128 v[84:87], v15 offset:1024
    v_mfma_f32_16x16x32_bf16 v[24:27], v[152:155], v[56:59], v[24:27]
    ds_read_b128 v[88:91], v15 offset:5120
    v_mfma_f32_16x16x32_bf16 v[24:27], v[156:159], v[64:67], v[24:27]
    ds_read_b128 v[92:95], v15 offset:9216
    v_mfma_f32_16x16x32_bf16 v[20:23], v[156:159], v[60:63], v[20:23]
    ds_read_b128 v[96:99], v15 offset:13312
    s_waitcnt lgkmcnt(4)
    v_mfma_f32_16x16x32_bf16 v[20:23], v[160:163], v[68:71], v[20:23]
    ds_read_b128 v[52:55], v15 offset:2048
    v_mfma_f32_16x16x32_bf16 v[24:27], v[160:163], v[72:75], v[24:27]
    ds_read_b128 v[56:59], v15 offset:6144
    v_mfma_f32_16x16x32_bf16 v[24:27], v[164:167], v[80:83], v[24:27]
    ds_read_b128 v[60:63], v15 offset:10240
    v_mfma_f32_16x16x32_bf16 v[20:23], v[164:167], v[76:79], v[20:23]
    ds_read_b128 v[64:67], v15 offset:14336
    s_waitcnt lgkmcnt(4)
    v_mfma_f32_16x16x32_bf16 v[20:23], v[168:171], v[84:87], v[20:23]
    ds_read_b128 v[68:71], v15 offset:3072
    v_mfma_f32_16x16x32_bf16 v[24:27], v[168:171], v[88:91], v[24:27]
    ds_read_b128 v[72:75], v15 offset:7168
    v_mfma_f32_16x16x32_bf16 v[24:27], v[172:175], v[96:99], v[24:27]
    ds_read_b128 v[76:79], v15 offset:11264
    v_mfma_f32_16x16x32_bf16 v[20:23], v[172:175], v[92:95], v[20:23]
    ds_read_b128 v[80:83], v15 offset:15360
    s_waitcnt vmcnt(0)
    s_barrier
    s_waitcnt lgkmcnt(4)
    v_mfma_f32_16x16x32_bf16 v[20:23], v[176:179], v[52:55], v[20:23]
    ds_read_b128 v[84:87], v15 offset:16384
    v_mfma_f32_16x16x32_bf16 v[24:27], v[176:179], v[56:59], v[24:27]
    ds_read_b128 v[88:91], v15 offset:20480
    v_mfma_f32_16x16x32_bf16 v[24:27], v[180:183], v[64:67], v[24:27]
    ds_read_b128 v[92:95], v15 offset:24576
    v_mfma_f32_16x16x32_bf16 v[20:23], v[180:183], v[60:63], v[20:23]
    ds_read_b128 v[96:99], v15 offset:28672
    s_waitcnt lgkmcnt(4)
    v_mfma_f32_16x16x32_bf16 v[20:23], v[184:187], v[68:71], v[20:23]
    ds_read_b128 v[52:55], v15 offset:17408
    v_mfma_f32_16x16x32_bf16 v[24:27], v[184:187], v[72:75], v[24:27]
    ds_read_b128 v[56:59], v15 offset:21504
    v_mfma_f32_16x16x32_bf16 v[24:27], v[188:191], v[80:83], v[24:27]
    ds_read_b128 v[60:63], v15 offset:25600
    v_mfma_f32_16x16x32_bf16 v[20:23], v[188:191], v[76:79], v[20:23]
    ds_read_b128 v[64:67], v15 offset:29696
    s_waitcnt lgkmcnt(4)
    v_mfma_f32_16x16x32_bf16 v[20:23], v[192:195], v[84:87], v[20:23]
    ds_read_b128 v[68:71], v15 offset:18432
    v_mfma_f32_16x16x32_bf16 v[24:27], v[192:195], v[88:91], v[24:27]
    ds_read_b128 v[72:75], v15 offset:22528
    v_mfma_f32_16x16x32_bf16 v[24:27], v[196:199], v[96:99], v[24:27]
    ds_read_b128 v[76:79], v15 offset:26624
    v_mfma_f32_16x16x32_bf16 v[20:23], v[196:199], v[92:95], v[20:23]
    ds_read_b128 v[80:83], v15 offset:30720
    s_waitcnt lgkmcnt(4)
    v_mfma_f32_16x16x32_bf16 v[20:23], v[200:203], v[52:55], v[20:23]
    ds_read_b128 v[84:87], v15 offset:19456
    v_mfma_f32_16x16x32_bf16 v[24:27], v[200:203], v[56:59], v[24:27]
    ds_read_b128 v[88:91], v15 offset:23552
    v_mfma_f32_16x16x32_bf16 v[24:27], v[204:207], v[64:67], v[24:27]
    ds_read_b128 v[92:95], v15 offset:27648
    v_mfma_f32_16x16x32_bf16 v[20:23], v[204:207], v[60:63], v[20:23]
    ds_read_b128 v[96:99], v15 offset:31744
    s_barrier
    s_waitcnt lgkmcnt(4)
    v_mfma_f32_16x16x32_bf16 v[20:23], v[208:211], v[68:71], v[20:23]
    ds_read_b128 v[52:55], v15 offset:32768
    v_mfma_f32_16x16x32_bf16 v[24:27], v[208:211], v[72:75], v[24:27]
    ds_read_b128 v[56:59], v15 offset:36864
    v_mfma_f32_16x16x32_bf16 v[24:27], v[212:215], v[80:83], v[24:27]
    ds_read_b128 v[60:63], v15 offset:40960
    v_mfma_f32_16x16x32_bf16 v[20:23], v[212:215], v[76:79], v[20:23]
    ds_read_b128 v[64:67], v15 offset:45056
    s_waitcnt lgkmcnt(4)
    v_mfma_f32_16x16x32_bf16 v[20:23], v[216:219], v[84:87], v[20:23]
    ds_read_b128 v[68:71], v15 offset:33792
    v_mfma_f32_16x16x32_bf16 v[24:27], v[216:219], v[88:91], v[24:27]
    ds_read_b128 v[72:75], v15 offset:37888
    v_mfma_f32_16x16x32_bf16 v[24:27], v[220:223], v[96:99], v[24:27]
    ds_read_b128 v[76:79], v15 offset:41984
    v_mfma_f32_16x16x32_bf16 v[20:23], v[220:223], v[92:95], v[20:23]
    ds_read_b128 v[80:83], v15 offset:46080
    s_waitcnt lgkmcnt(4)
    v_mfma_f32_16x16x32_bf16 v[20:23], v[224:227], v[52:55], v[20:23]
    ds_read_b128 v[84:87], v15 offset:34816
    v_mfma_f32_16x16x32_bf16 v[24:27], v[224:227], v[56:59], v[24:27]
    ds_read_b128 v[88:91], v15 offset:38912
    v_mfma_f32_16x16x32_bf16 v[24:27], v[228:231], v[64:67], v[24:27]
    ds_read_b128 v[92:95], v15 offset:43008
    v_mfma_f32_16x16x32_bf16 v[20:23], v[228:231], v[60:63], v[20:23]
    ds_read_b128 v[96:99], v15 offset:47104
    s_waitcnt lgkmcnt(4)
    v_mfma_f32_16x16x32_bf16 v[20:23], v[232:235], v[68:71], v[20:23]
    ds_read_b128 v[52:55], v15 offset:35840
    v_mfma_f32_16x16x32_bf16 v[24:27], v[232:235], v[72:75], v[24:27]
    ds_read_b128 v[56:59], v15 offset:39936
    v_mfma_f32_16x16x32_bf16 v[24:27], v[236:239], v[80:83], v[24:27]
    ds_read_b128 v[60:63], v15 offset:44032
    v_mfma_f32_16x16x32_bf16 v[20:23], v[236:239], v[76:79], v[20:23]
    ds_read_b128 v[64:67], v15 offset:48128
    s_barrier
    s_waitcnt lgkmcnt(4)
    v_mfma_f32_16x16x32_bf16 v[20:23], v[240:243], v[84:87], v[20:23]
    ds_read_b128 v[68:71], v14 offset:16384
    v_mfma_f32_16x16x32_bf16 v[24:27], v[240:243], v[88:91], v[24:27]
    ds_read_b128 v[72:75], v14 offset:20480
    v_mfma_f32_16x16x32_bf16 v[24:27], v[244:247], v[96:99], v[24:27]
    ds_read_b128 v[76:79], v14 offset:24576
    v_mfma_f32_16x16x32_bf16 v[20:23], v[244:247], v[92:95], v[20:23]
    ds_read_b128 v[80:83], v14 offset:28672
    s_waitcnt lgkmcnt(4)
    v_mfma_f32_16x16x32_bf16 v[20:23], v[248:251], v[52:55], v[20:23]
    ds_read_b128 v[84:87], v14 offset:17408
    v_mfma_f32_16x16x32_bf16 v[24:27], v[248:251], v[56:59], v[24:27]
    ds_read_b128 v[88:91], v14 offset:21504
    v_mfma_f32_16x16x32_bf16 v[24:27], v[252:255], v[64:67], v[24:27]
    ds_read_b128 v[92:95], v14 offset:25600
    v_mfma_f32_16x16x32_bf16 v[20:23], v[252:255], v[60:63], v[20:23]
    ds_read_b128 v[96:99], v14 offset:29696
    s_waitcnt lgkmcnt(4)
    v_mfma_f32_16x16x32_bf16 v[28:31], v[128:131], v[68:71], v[28:31]
    ds_read_b128 v[52:55], v14 offset:18432
    v_mfma_f32_16x16x32_bf16 v[32:35], v[128:131], v[72:75], v[32:35]
    ds_read_b128 v[56:59], v14 offset:22528
    v_mfma_f32_16x16x32_bf16 v[32:35], v[132:135], v[80:83], v[32:35]
    ds_read_b128 v[60:63], v14 offset:26624
    v_mfma_f32_16x16x32_bf16 v[28:31], v[132:135], v[76:79], v[28:31]
    ds_read_b128 v[64:67], v14 offset:30720
    v_cvt_pk_bf16_f32 v20, v20, v21
    v_cvt_pk_bf16_f32 v21, v22, v23
    v_cvt_pk_bf16_f32 v22, v24, v25
    v_cvt_pk_bf16_f32 v23, v26, v27
    s_add_u32 s36, s39, 0
    v_permlane16_swap_b32 v20, v22
    v_permlane16_swap_b32 v21, v23
    s_waitcnt lgkmcnt(4)
    v_mfma_f32_16x16x32_bf16 v[28:31], v[136:139], v[84:87], v[28:31]
    ds_read_b128 v[68:71], v14 offset:19456
    v_mfma_f32_16x16x32_bf16 v[32:35], v[136:139], v[88:91], v[32:35]
    ds_read_b128 v[72:75], v14 offset:23552
    v_mfma_f32_16x16x32_bf16 v[32:35], v[140:143], v[96:99], v[32:35]
    ds_read_b128 v[76:79], v14 offset:27648
    v_mfma_f32_16x16x32_bf16 v[28:31], v[140:143], v[92:95], v[28:31]
    ds_read_b128 v[80:83], v14 offset:31744
    s_barrier
    s_waitcnt lgkmcnt(4)
    v_mfma_f32_16x16x32_bf16 v[28:31], v[144:147], v[52:55], v[28:31]
    ds_read_b128 v[84:87], v14 offset:32768
    v_mfma_f32_16x16x32_bf16 v[32:35], v[144:147], v[56:59], v[32:35]
    ds_read_b128 v[88:91], v14 offset:36864
    v_mfma_f32_16x16x32_bf16 v[32:35], v[148:151], v[64:67], v[32:35]
    ds_read_b128 v[92:95], v14 offset:40960
    v_mfma_f32_16x16x32_bf16 v[28:31], v[148:151], v[60:63], v[28:31]
    ds_read_b128 v[96:99], v14 offset:45056
    s_waitcnt lgkmcnt(4)
    v_mfma_f32_16x16x32_bf16 v[28:31], v[152:155], v[68:71], v[28:31]
    ds_read_b128 v[52:55], v14 offset:33792
    v_mfma_f32_16x16x32_bf16 v[32:35], v[152:155], v[72:75], v[32:35]
    ds_read_b128 v[56:59], v14 offset:37888
    v_mfma_f32_16x16x32_bf16 v[32:35], v[156:159], v[80:83], v[32:35]
    ds_read_b128 v[60:63], v14 offset:41984
    v_mfma_f32_16x16x32_bf16 v[28:31], v[156:159], v[76:79], v[28:31]
    ds_read_b128 v[64:67], v14 offset:46080
    s_waitcnt lgkmcnt(4)
    v_mfma_f32_16x16x32_bf16 v[28:31], v[160:163], v[84:87], v[28:31]
    ds_read_b128 v[68:71], v14 offset:34816
    v_mfma_f32_16x16x32_bf16 v[32:35], v[160:163], v[88:91], v[32:35]
    ds_read_b128 v[72:75], v14 offset:38912
    v_mfma_f32_16x16x32_bf16 v[32:35], v[164:167], v[96:99], v[32:35]
    ds_read_b128 v[76:79], v14 offset:43008
    v_mfma_f32_16x16x32_bf16 v[28:31], v[164:167], v[92:95], v[28:31]
    ds_read_b128 v[80:83], v14 offset:47104
    s_waitcnt lgkmcnt(4)
    v_mfma_f32_16x16x32_bf16 v[28:31], v[168:171], v[52:55], v[28:31]
    ds_read_b128 v[84:87], v14 offset:35840
    v_mfma_f32_16x16x32_bf16 v[32:35], v[168:171], v[56:59], v[32:35]
    ds_read_b128 v[88:91], v14 offset:39936
    v_mfma_f32_16x16x32_bf16 v[32:35], v[172:175], v[64:67], v[32:35]
    ds_read_b128 v[92:95], v14 offset:44032
    v_mfma_f32_16x16x32_bf16 v[28:31], v[172:175], v[60:63], v[28:31]
    ds_read_b128 v[96:99], v14 offset:48128
    s_barrier
    s_waitcnt lgkmcnt(4)
    v_mfma_f32_16x16x32_bf16 v[28:31], v[176:179], v[68:71], v[28:31]
    ds_read_b128 v[52:55], v15 offset:0
    v_mfma_f32_16x16x32_bf16 v[32:35], v[176:179], v[72:75], v[32:35]
    ds_read_b128 v[56:59], v15 offset:4096
    v_mfma_f32_16x16x32_bf16 v[32:35], v[180:183], v[80:83], v[32:35]
    ds_read_b128 v[60:63], v15 offset:8192
    v_mfma_f32_16x16x32_bf16 v[28:31], v[180:183], v[76:79], v[28:31]
    ds_read_b128 v[64:67], v15 offset:12288
    s_waitcnt lgkmcnt(4)
    v_mfma_f32_16x16x32_bf16 v[28:31], v[184:187], v[84:87], v[28:31]
    ds_read_b128 v[68:71], v15 offset:1024
    v_mfma_f32_16x16x32_bf16 v[32:35], v[184:187], v[88:91], v[32:35]
    ds_read_b128 v[72:75], v15 offset:5120
    v_mfma_f32_16x16x32_bf16 v[32:35], v[188:191], v[96:99], v[32:35]
    ds_read_b128 v[76:79], v15 offset:9216
    v_mfma_f32_16x16x32_bf16 v[28:31], v[188:191], v[92:95], v[28:31]
    ds_read_b128 v[80:83], v15 offset:13312
    s_waitcnt lgkmcnt(4)
    v_mfma_f32_16x16x32_bf16 v[28:31], v[192:195], v[52:55], v[28:31]
    ds_read_b128 v[84:87], v15 offset:2048
    v_mfma_f32_16x16x32_bf16 v[32:35], v[192:195], v[56:59], v[32:35]
    ds_read_b128 v[88:91], v15 offset:6144
    v_mfma_f32_16x16x32_bf16 v[32:35], v[196:199], v[64:67], v[32:35]
    ds_read_b128 v[92:95], v15 offset:10240
    v_mfma_f32_16x16x32_bf16 v[28:31], v[196:199], v[60:63], v[28:31]
    ds_read_b128 v[96:99], v15 offset:14336
    s_waitcnt lgkmcnt(4)
    v_mfma_f32_16x16x32_bf16 v[28:31], v[200:203], v[68:71], v[28:31]
    ds_read_b128 v[52:55], v15 offset:3072
    v_mfma_f32_16x16x32_bf16 v[32:35], v[200:203], v[72:75], v[32:35]
    ds_read_b128 v[56:59], v15 offset:7168
    v_mfma_f32_16x16x32_bf16 v[32:35], v[204:207], v[80:83], v[32:35]
    ds_read_b128 v[60:63], v15 offset:11264
    v_mfma_f32_16x16x32_bf16 v[28:31], v[204:207], v[76:79], v[28:31]
    ds_read_b128 v[64:67], v15 offset:15360
    s_barrier
    s_waitcnt lgkmcnt(4)
    v_mfma_f32_16x16x32_bf16 v[28:31], v[208:211], v[84:87], v[28:31]
    ds_read_b128 v[68:71], v15 offset:16384
    v_mfma_f32_16x16x32_bf16 v[32:35], v[208:211], v[88:91], v[32:35]
    ds_read_b128 v[72:75], v15 offset:20480
    v_mfma_f32_16x16x32_bf16 v[32:35], v[212:215], v[96:99], v[32:35]
    ds_read_b128 v[76:79], v15 offset:24576
    v_mfma_f32_16x16x32_bf16 v[28:31], v[212:215], v[92:95], v[28:31]
    ds_read_b128 v[80:83], v15 offset:28672
    s_waitcnt lgkmcnt(4)
    v_mfma_f32_16x16x32_bf16 v[28:31], v[216:219], v[52:55], v[28:31]
    ds_read_b128 v[84:87], v15 offset:17408
    v_mfma_f32_16x16x32_bf16 v[32:35], v[216:219], v[56:59], v[32:35]
    ds_read_b128 v[88:91], v15 offset:21504
    v_mfma_f32_16x16x32_bf16 v[32:35], v[220:223], v[64:67], v[32:35]
    ds_read_b128 v[92:95], v15 offset:25600
    v_mfma_f32_16x16x32_bf16 v[28:31], v[220:223], v[60:63], v[28:31]
    ds_read_b128 v[96:99], v15 offset:29696
    s_waitcnt lgkmcnt(4)
    v_mfma_f32_16x16x32_bf16 v[28:31], v[224:227], v[68:71], v[28:31]
    ds_read_b128 v[52:55], v15 offset:18432
    v_mfma_f32_16x16x32_bf16 v[32:35], v[224:227], v[72:75], v[32:35]
    ds_read_b128 v[56:59], v15 offset:22528
    v_mfma_f32_16x16x32_bf16 v[32:35], v[228:231], v[80:83], v[32:35]
    ds_read_b128 v[60:63], v15 offset:26624
    v_mfma_f32_16x16x32_bf16 v[28:31], v[228:231], v[76:79], v[28:31]
    ds_read_b128 v[64:67], v15 offset:30720
    s_waitcnt lgkmcnt(4)
    v_mfma_f32_16x16x32_bf16 v[28:31], v[232:235], v[84:87], v[28:31]
    ds_read_b128 v[68:71], v15 offset:19456
    v_mfma_f32_16x16x32_bf16 v[32:35], v[232:235], v[88:91], v[32:35]
    ds_read_b128 v[72:75], v15 offset:23552
    v_mfma_f32_16x16x32_bf16 v[32:35], v[236:239], v[96:99], v[32:35]
    ds_read_b128 v[76:79], v15 offset:27648
    v_mfma_f32_16x16x32_bf16 v[28:31], v[236:239], v[92:95], v[28:31]
    ds_read_b128 v[80:83], v15 offset:31744
    s_barrier
    s_waitcnt lgkmcnt(4)
    v_mfma_f32_16x16x32_bf16 v[28:31], v[240:243], v[52:55], v[28:31]
    ds_read_b128 v[84:87], v15 offset:32768
    v_mfma_f32_16x16x32_bf16 v[32:35], v[240:243], v[56:59], v[32:35]
    ds_read_b128 v[88:91], v15 offset:36864
    v_mfma_f32_16x16x32_bf16 v[32:35], v[244:247], v[64:67], v[32:35]
    ds_read_b128 v[92:95], v15 offset:40960
    v_mfma_f32_16x16x32_bf16 v[28:31], v[244:247], v[60:63], v[28:31]
    ds_read_b128 v[96:99], v15 offset:45056
    s_waitcnt lgkmcnt(4)
    v_mfma_f32_16x16x32_bf16 v[28:31], v[248:251], v[68:71], v[28:31]
    ds_read_b128 v[52:55], v15 offset:33792
    v_mfma_f32_16x16x32_bf16 v[32:35], v[248:251], v[72:75], v[32:35]
    ds_read_b128 v[56:59], v15 offset:37888
    v_mfma_f32_16x16x32_bf16 v[32:35], v[252:255], v[80:83], v[32:35]
    ds_read_b128 v[60:63], v15 offset:41984
    v_mfma_f32_16x16x32_bf16 v[28:31], v[252:255], v[76:79], v[28:31]
    ds_read_b128 v[64:67], v15 offset:46080
    s_waitcnt lgkmcnt(4)
    v_mfma_f32_16x16x32_bf16 v[36:39], v[128:131], v[84:87], v[36:39]
    ds_read_b128 v[68:71], v15 offset:34816
    v_mfma_f32_16x16x32_bf16 v[40:43], v[128:131], v[88:91], v[40:43]
    ds_read_b128 v[72:75], v15 offset:38912
    v_mfma_f32_16x16x32_bf16 v[40:43], v[132:135], v[96:99], v[40:43]
    ds_read_b128 v[76:79], v15 offset:43008
    v_mfma_f32_16x16x32_bf16 v[36:39], v[132:135], v[92:95], v[36:39]
    ds_read_b128 v[80:83], v15 offset:47104
    v_cvt_pk_bf16_f32 v28, v28, v29
    v_cvt_pk_bf16_f32 v29, v30, v31
    v_cvt_pk_bf16_f32 v30, v32, v33
    v_cvt_pk_bf16_f32 v31, v34, v35
    s_add_u32 s36, s39, 131072
    v_permlane16_swap_b32 v28, v30
    v_permlane16_swap_b32 v29, v31
    s_waitcnt lgkmcnt(4)
    v_mfma_f32_16x16x32_bf16 v[36:39], v[136:139], v[52:55], v[36:39]
    ds_read_b128 v[84:87], v15 offset:35840
    v_mfma_f32_16x16x32_bf16 v[40:43], v[136:139], v[56:59], v[40:43]
    ds_read_b128 v[88:91], v15 offset:39936
    v_mfma_f32_16x16x32_bf16 v[40:43], v[140:143], v[64:67], v[40:43]
    ds_read_b128 v[92:95], v15 offset:44032
    v_mfma_f32_16x16x32_bf16 v[36:39], v[140:143], v[60:63], v[36:39]
    ds_read_b128 v[96:99], v15 offset:48128
    s_barrier
    s_waitcnt lgkmcnt(4)
    v_mfma_f32_16x16x32_bf16 v[36:39], v[144:147], v[68:71], v[36:39]
    ds_read_b128 v[52:55], v14 offset:16384
    v_mfma_f32_16x16x32_bf16 v[40:43], v[144:147], v[72:75], v[40:43]
    ds_read_b128 v[56:59], v14 offset:20480
    v_mfma_f32_16x16x32_bf16 v[40:43], v[148:151], v[80:83], v[40:43]
    ds_read_b128 v[60:63], v14 offset:24576
    v_mfma_f32_16x16x32_bf16 v[36:39], v[148:151], v[76:79], v[36:39]
    ds_read_b128 v[64:67], v14 offset:28672
    s_waitcnt lgkmcnt(4)
    v_mfma_f32_16x16x32_bf16 v[36:39], v[152:155], v[84:87], v[36:39]
    ds_read_b128 v[68:71], v14 offset:17408
    v_mfma_f32_16x16x32_bf16 v[40:43], v[152:155], v[88:91], v[40:43]
    ds_read_b128 v[72:75], v14 offset:21504
    v_mfma_f32_16x16x32_bf16 v[40:43], v[156:159], v[96:99], v[40:43]
    ds_read_b128 v[76:79], v14 offset:25600
    v_mfma_f32_16x16x32_bf16 v[36:39], v[156:159], v[92:95], v[36:39]
    ds_read_b128 v[80:83], v14 offset:29696
    s_waitcnt lgkmcnt(4)
    v_mfma_f32_16x16x32_bf16 v[36:39], v[160:163], v[52:55], v[36:39]
    ds_read_b128 v[84:87], v14 offset:18432
    v_mfma_f32_16x16x32_bf16 v[40:43], v[160:163], v[56:59], v[40:43]
    ds_read_b128 v[88:91], v14 offset:22528
    v_mfma_f32_16x16x32_bf16 v[40:43], v[164:167], v[64:67], v[40:43]
    ds_read_b128 v[92:95], v14 offset:26624
    v_mfma_f32_16x16x32_bf16 v[36:39], v[164:167], v[60:63], v[36:39]
    ds_read_b128 v[96:99], v14 offset:30720
    s_waitcnt lgkmcnt(4)
    v_mfma_f32_16x16x32_bf16 v[36:39], v[168:171], v[68:71], v[36:39]
    ds_read_b128 v[52:55], v14 offset:19456
    v_mfma_f32_16x16x32_bf16 v[40:43], v[168:171], v[72:75], v[40:43]
    ds_read_b128 v[56:59], v14 offset:23552
    v_mfma_f32_16x16x32_bf16 v[40:43], v[172:175], v[80:83], v[40:43]
    ds_read_b128 v[60:63], v14 offset:27648
    v_mfma_f32_16x16x32_bf16 v[36:39], v[172:175], v[76:79], v[36:39]
    ds_read_b128 v[64:67], v14 offset:31744
    s_barrier
    s_waitcnt lgkmcnt(4)
    v_mfma_f32_16x16x32_bf16 v[36:39], v[176:179], v[84:87], v[36:39]
    ds_read_b128 v[68:71], v14 offset:32768
    v_mfma_f32_16x16x32_bf16 v[40:43], v[176:179], v[88:91], v[40:43]
    ds_read_b128 v[72:75], v14 offset:36864
    v_mfma_f32_16x16x32_bf16 v[40:43], v[180:183], v[96:99], v[40:43]
    ds_read_b128 v[76:79], v14 offset:40960
    v_mfma_f32_16x16x32_bf16 v[36:39], v[180:183], v[92:95], v[36:39]
    ds_read_b128 v[80:83], v14 offset:45056
    s_waitcnt lgkmcnt(4)
    v_mfma_f32_16x16x32_bf16 v[36:39], v[184:187], v[52:55], v[36:39]
    ds_read_b128 v[84:87], v14 offset:33792
    v_mfma_f32_16x16x32_bf16 v[40:43], v[184:187], v[56:59], v[40:43]
    ds_read_b128 v[88:91], v14 offset:37888
    v_mfma_f32_16x16x32_bf16 v[40:43], v[188:191], v[64:67], v[40:43]
    ds_read_b128 v[92:95], v14 offset:41984
    v_mfma_f32_16x16x32_bf16 v[36:39], v[188:191], v[60:63], v[36:39]
    ds_read_b128 v[96:99], v14 offset:46080
    s_waitcnt lgkmcnt(4)
    v_mfma_f32_16x16x32_bf16 v[36:39], v[192:195], v[68:71], v[36:39]
    ds_read_b128 v[52:55], v14 offset:34816
    v_mfma_f32_16x16x32_bf16 v[40:43], v[192:195], v[72:75], v[40:43]
    ds_read_b128 v[56:59], v14 offset:38912
    v_mfma_f32_16x16x32_bf16 v[40:43], v[196:199], v[80:83], v[40:43]
    ds_read_b128 v[60:63], v14 offset:43008
    v_mfma_f32_16x16x32_bf16 v[36:39], v[196:199], v[76:79], v[36:39]
    ds_read_b128 v[64:67], v14 offset:47104
    s_waitcnt lgkmcnt(4)
    v_mfma_f32_16x16x32_bf16 v[36:39], v[200:203], v[84:87], v[36:39]
    ds_read_b128 v[68:71], v14 offset:35840
    v_mfma_f32_16x16x32_bf16 v[40:43], v[200:203], v[88:91], v[40:43]
    ds_read_b128 v[72:75], v14 offset:39936
    v_mfma_f32_16x16x32_bf16 v[40:43], v[204:207], v[96:99], v[40:43]
    ds_read_b128 v[76:79], v14 offset:44032
    v_mfma_f32_16x16x32_bf16 v[36:39], v[204:207], v[92:95], v[36:39]
    ds_read_b128 v[80:83], v14 offset:48128
    s_barrier
    s_waitcnt lgkmcnt(4)
    v_mfma_f32_16x16x32_bf16 v[36:39], v[208:211], v[52:55], v[36:39]
    ds_read_b128 v[84:87], v15 offset:0
    v_mfma_f32_16x16x32_bf16 v[40:43], v[208:211], v[56:59], v[40:43]
    ds_read_b128 v[88:91], v15 offset:4096
    v_mfma_f32_16x16x32_bf16 v[40:43], v[212:215], v[64:67], v[40:43]
    ds_read_b128 v[92:95], v15 offset:8192
    v_mfma_f32_16x16x32_bf16 v[36:39], v[212:215], v[60:63], v[36:39]
    ds_read_b128 v[96:99], v15 offset:12288
    s_waitcnt lgkmcnt(4)
    v_mfma_f32_16x16x32_bf16 v[36:39], v[216:219], v[68:71], v[36:39]
    ds_read_b128 v[52:55], v15 offset:1024
    v_mfma_f32_16x16x32_bf16 v[40:43], v[216:219], v[72:75], v[40:43]
    ds_read_b128 v[56:59], v15 offset:5120
    v_mfma_f32_16x16x32_bf16 v[40:43], v[220:223], v[80:83], v[40:43]
    ds_read_b128 v[60:63], v15 offset:9216
    v_mfma_f32_16x16x32_bf16 v[36:39], v[220:223], v[76:79], v[36:39]
    ds_read_b128 v[64:67], v15 offset:13312
    s_waitcnt lgkmcnt(4)
    v_mfma_f32_16x16x32_bf16 v[36:39], v[224:227], v[84:87], v[36:39]
    ds_read_b128 v[68:71], v15 offset:2048
    v_mfma_f32_16x16x32_bf16 v[40:43], v[224:227], v[88:91], v[40:43]
    ds_read_b128 v[72:75], v15 offset:6144
    v_mfma_f32_16x16x32_bf16 v[40:43], v[228:231], v[96:99], v[40:43]
    ds_read_b128 v[76:79], v15 offset:10240
    v_mfma_f32_16x16x32_bf16 v[36:39], v[228:231], v[92:95], v[36:39]
    ds_read_b128 v[80:83], v15 offset:14336
    s_waitcnt lgkmcnt(4)
    v_mfma_f32_16x16x32_bf16 v[36:39], v[232:235], v[52:55], v[36:39]
    ds_read_b128 v[84:87], v15 offset:3072
    v_mfma_f32_16x16x32_bf16 v[40:43], v[232:235], v[56:59], v[40:43]
    ds_read_b128 v[88:91], v15 offset:7168
    v_mfma_f32_16x16x32_bf16 v[40:43], v[236:239], v[64:67], v[40:43]
    ds_read_b128 v[92:95], v15 offset:11264
    v_mfma_f32_16x16x32_bf16 v[36:39], v[236:239], v[60:63], v[36:39]
    ds_read_b128 v[96:99], v15 offset:15360
    s_barrier
    s_waitcnt lgkmcnt(4)
    v_mfma_f32_16x16x32_bf16 v[36:39], v[240:243], v[68:71], v[36:39]
    ds_read_b128 v[52:55], v15 offset:16384
    v_mfma_f32_16x16x32_bf16 v[40:43], v[240:243], v[72:75], v[40:43]
    ds_read_b128 v[56:59], v15 offset:20480
    v_mfma_f32_16x16x32_bf16 v[40:43], v[244:247], v[80:83], v[40:43]
    ds_read_b128 v[60:63], v15 offset:24576
    v_mfma_f32_16x16x32_bf16 v[36:39], v[244:247], v[76:79], v[36:39]
    ds_read_b128 v[64:67], v15 offset:28672
    s_waitcnt lgkmcnt(4)
    v_mfma_f32_16x16x32_bf16 v[36:39], v[248:251], v[84:87], v[36:39]
    ds_read_b128 v[68:71], v15 offset:17408
    v_mfma_f32_16x16x32_bf16 v[40:43], v[248:251], v[88:91], v[40:43]
    ds_read_b128 v[72:75], v15 offset:21504
    v_mfma_f32_16x16x32_bf16 v[40:43], v[252:255], v[96:99], v[40:43]
    ds_read_b128 v[76:79], v15 offset:25600
    v_mfma_f32_16x16x32_bf16 v[36:39], v[252:255], v[92:95], v[36:39]
    ds_read_b128 v[80:83], v15 offset:29696
    s_waitcnt lgkmcnt(4)
    v_mfma_f32_16x16x32_bf16 v[44:47], v[128:131], v[52:55], v[44:47]
    ds_read_b128 v[84:87], v15 offset:18432
    v_mfma_f32_16x16x32_bf16 v[48:51], v[128:131], v[56:59], v[48:51]
    ds_read_b128 v[88:91], v15 offset:22528
    v_mfma_f32_16x16x32_bf16 v[48:51], v[132:135], v[64:67], v[48:51]
    ds_read_b128 v[92:95], v15 offset:26624
    v_mfma_f32_16x16x32_bf16 v[44:47], v[132:135], v[60:63], v[44:47]
    ds_read_b128 v[96:99], v15 offset:30720
    v_cvt_pk_bf16_f32 v36, v36, v37
    v_cvt_pk_bf16_f32 v37, v38, v39
    v_cvt_pk_bf16_f32 v38, v40, v41
    v_cvt_pk_bf16_f32 v39, v42, v43
    s_add_u32 s36, s39, 262144
    v_permlane16_swap_b32 v36, v38
    v_permlane16_swap_b32 v37, v39
    s_waitcnt lgkmcnt(4)
    v_mfma_f32_16x16x32_bf16 v[44:47], v[136:139], v[68:71], v[44:47]
    ds_read_b128 v[52:55], v15 offset:19456
    v_mfma_f32_16x16x32_bf16 v[48:51], v[136:139], v[72:75], v[48:51]
    ds_read_b128 v[56:59], v15 offset:23552
    v_mfma_f32_16x16x32_bf16 v[48:51], v[140:143], v[80:83], v[48:51]
    ds_read_b128 v[60:63], v15 offset:27648
    v_mfma_f32_16x16x32_bf16 v[44:47], v[140:143], v[76:79], v[44:47]
    ds_read_b128 v[64:67], v15 offset:31744
    s_barrier
    s_waitcnt lgkmcnt(4)
    v_mfma_f32_16x16x32_bf16 v[44:47], v[144:147], v[84:87], v[44:47]
    ds_read_b128 v[68:71], v15 offset:32768
    v_mfma_f32_16x16x32_bf16 v[48:51], v[144:147], v[88:91], v[48:51]
    ds_read_b128 v[72:75], v15 offset:36864
    v_mfma_f32_16x16x32_bf16 v[48:51], v[148:151], v[96:99], v[48:51]
    ds_read_b128 v[76:79], v15 offset:40960
    v_mfma_f32_16x16x32_bf16 v[44:47], v[148:151], v[92:95], v[44:47]
    ds_read_b128 v[80:83], v15 offset:45056
    s_add_u32 s36, s39, 0
    buffer_store_dwordx4 v[20:23], v13, s[24:27], s36 offen sc1
    s_waitcnt lgkmcnt(4)
    v_mfma_f32_16x16x32_bf16 v[44:47], v[152:155], v[52:55], v[44:47]
    ds_read_b128 v[84:87], v15 offset:33792
    v_mfma_f32_16x16x32_bf16 v[48:51], v[152:155], v[56:59], v[48:51]
    ds_read_b128 v[88:91], v15 offset:37888
    v_mfma_f32_16x16x32_bf16 v[48:51], v[156:159], v[64:67], v[48:51]
    ds_read_b128 v[92:95], v15 offset:41984
    v_mfma_f32_16x16x32_bf16 v[44:47], v[156:159], v[60:63], v[44:47]
    ds_read_b128 v[96:99], v15 offset:46080
    s_add_u32 s36, s39, 131072
    buffer_store_dwordx4 v[28:31], v13, s[24:27], s36 offen sc1
    s_waitcnt lgkmcnt(4)
    v_mfma_f32_16x16x32_bf16 v[44:47], v[160:163], v[68:71], v[44:47]
    ds_read_b128 v[52:55], v15 offset:34816
    v_mfma_f32_16x16x32_bf16 v[48:51], v[160:163], v[72:75], v[48:51]
    ds_read_b128 v[56:59], v15 offset:38912
    v_mfma_f32_16x16x32_bf16 v[48:51], v[164:167], v[80:83], v[48:51]
    ds_read_b128 v[60:63], v15 offset:43008
    v_mfma_f32_16x16x32_bf16 v[44:47], v[164:167], v[76:79], v[44:47]
    ds_read_b128 v[64:67], v15 offset:47104
    s_add_u32 s36, s39, 262144
    buffer_store_dwordx4 v[36:39], v13, s[24:27], s36 offen sc1
    s_waitcnt lgkmcnt(4)
    v_mfma_f32_16x16x32_bf16 v[44:47], v[168:171], v[84:87], v[44:47]
    ds_read_b128 v[68:71], v15 offset:35840
    v_mfma_f32_16x16x32_bf16 v[48:51], v[168:171], v[88:91], v[48:51]
    ds_read_b128 v[72:75], v15 offset:39936
    v_mfma_f32_16x16x32_bf16 v[48:51], v[172:175], v[96:99], v[48:51]
    ds_read_b128 v[76:79], v15 offset:44032
    v_mfma_f32_16x16x32_bf16 v[44:47], v[172:175], v[92:95], v[44:47]
    ds_read_b128 v[80:83], v15 offset:48128
    s_barrier
    s_waitcnt lgkmcnt(4)
    v_mfma_f32_16x16x32_bf16 v[44:47], v[176:179], v[52:55], v[44:47]
    ds_read_b128 v[84:87], v14 offset:16384
    v_mfma_f32_16x16x32_bf16 v[48:51], v[176:179], v[56:59], v[48:51]
    ds_read_b128 v[88:91], v14 offset:20480
    v_mfma_f32_16x16x32_bf16 v[48:51], v[180:183], v[64:67], v[48:51]
    ds_read_b128 v[92:95], v14 offset:24576
    v_mfma_f32_16x16x32_bf16 v[44:47], v[180:183], v[60:63], v[44:47]
    ds_read_b128 v[96:99], v14 offset:28672
    s_waitcnt lgkmcnt(4)
    v_mfma_f32_16x16x32_bf16 v[44:47], v[184:187], v[68:71], v[44:47]
    ds_read_b128 v[52:55], v14 offset:17408
    v_mfma_f32_16x16x32_bf16 v[48:51], v[184:187], v[72:75], v[48:51]
    ds_read_b128 v[56:59], v14 offset:21504
    v_mfma_f32_16x16x32_bf16 v[48:51], v[188:191], v[80:83], v[48:51]
    ds_read_b128 v[60:63], v14 offset:25600
    v_mfma_f32_16x16x32_bf16 v[44:47], v[188:191], v[76:79], v[44:47]
    ds_read_b128 v[64:67], v14 offset:29696
    s_waitcnt lgkmcnt(4)
    v_mfma_f32_16x16x32_bf16 v[44:47], v[192:195], v[84:87], v[44:47]
    ds_read_b128 v[68:71], v14 offset:18432
    v_mfma_f32_16x16x32_bf16 v[48:51], v[192:195], v[88:91], v[48:51]
    ds_read_b128 v[72:75], v14 offset:22528
    v_mfma_f32_16x16x32_bf16 v[48:51], v[196:199], v[96:99], v[48:51]
    ds_read_b128 v[76:79], v14 offset:26624
    v_mfma_f32_16x16x32_bf16 v[44:47], v[196:199], v[92:95], v[44:47]
    ds_read_b128 v[80:83], v14 offset:30720
    s_waitcnt lgkmcnt(4)
    v_mfma_f32_16x16x32_bf16 v[44:47], v[200:203], v[52:55], v[44:47]
    ds_read_b128 v[84:87], v14 offset:19456
    v_mfma_f32_16x16x32_bf16 v[48:51], v[200:203], v[56:59], v[48:51]
    ds_read_b128 v[88:91], v14 offset:23552
    v_mfma_f32_16x16x32_bf16 v[48:51], v[204:207], v[64:67], v[48:51]
    ds_read_b128 v[92:95], v14 offset:27648
    v_mfma_f32_16x16x32_bf16 v[44:47], v[204:207], v[60:63], v[44:47]
    ds_read_b128 v[96:99], v14 offset:31744
    s_barrier
    s_waitcnt lgkmcnt(4)
    v_mfma_f32_16x16x32_bf16 v[44:47], v[208:211], v[68:71], v[44:47]
    ds_read_b128 v[52:55], v14 offset:32768
    v_mfma_f32_16x16x32_bf16 v[48:51], v[208:211], v[72:75], v[48:51]
    ds_read_b128 v[56:59], v14 offset:36864
    v_mfma_f32_16x16x32_bf16 v[48:51], v[212:215], v[80:83], v[48:51]
    ds_read_b128 v[60:63], v14 offset:40960
    v_mfma_f32_16x16x32_bf16 v[44:47], v[212:215], v[76:79], v[44:47]
    ds_read_b128 v[64:67], v14 offset:45056
    s_waitcnt lgkmcnt(4)
    v_mfma_f32_16x16x32_bf16 v[44:47], v[216:219], v[84:87], v[44:47]
    ds_read_b128 v[68:71], v14 offset:33792
    v_mfma_f32_16x16x32_bf16 v[48:51], v[216:219], v[88:91], v[48:51]
    ds_read_b128 v[72:75], v14 offset:37888
    v_mfma_f32_16x16x32_bf16 v[48:51], v[220:223], v[96:99], v[48:51]
    ds_read_b128 v[76:79], v14 offset:41984
    v_mfma_f32_16x16x32_bf16 v[44:47], v[220:223], v[92:95], v[44:47]
    ds_read_b128 v[80:83], v14 offset:46080
    s_waitcnt lgkmcnt(4)
    v_mfma_f32_16x16x32_bf16 v[44:47], v[224:227], v[52:55], v[44:47]
    ds_read_b128 v[84:87], v14 offset:34816
    v_mfma_f32_16x16x32_bf16 v[48:51], v[224:227], v[56:59], v[48:51]
    ds_read_b128 v[88:91], v14 offset:38912
    v_mfma_f32_16x16x32_bf16 v[48:51], v[228:231], v[64:67], v[48:51]
    ds_read_b128 v[92:95], v14 offset:43008
    v_mfma_f32_16x16x32_bf16 v[44:47], v[228:231], v[60:63], v[44:47]
    ds_read_b128 v[96:99], v14 offset:47104
    s_waitcnt lgkmcnt(4)
    v_mfma_f32_16x16x32_bf16 v[44:47], v[232:235], v[68:71], v[44:47]
    ds_read_b128 v[52:55], v14 offset:35840
    v_mfma_f32_16x16x32_bf16 v[48:51], v[232:235], v[72:75], v[48:51]
    ds_read_b128 v[56:59], v14 offset:39936
    v_mfma_f32_16x16x32_bf16 v[48:51], v[236:239], v[80:83], v[48:51]
    ds_read_b128 v[60:63], v14 offset:44032
    v_mfma_f32_16x16x32_bf16 v[44:47], v[236:239], v[76:79], v[44:47]
    ds_read_b128 v[64:67], v14 offset:48128
    ds_write_b128 v16, v[20:23] offset:0
    ds_write_b128 v16, v[28:31] offset:4096
    ds_write_b128 v16, v[36:39] offset:8192
    s_waitcnt lgkmcnt(7)
    v_mfma_f32_16x16x32_bf16 v[44:47], v[240:243], v[84:87], v[44:47]
    v_mfma_f32_16x16x32_bf16 v[48:51], v[240:243], v[88:91], v[48:51]
    v_mfma_f32_16x16x32_bf16 v[48:51], v[244:247], v[96:99], v[48:51]
    v_mfma_f32_16x16x32_bf16 v[44:47], v[244:247], v[92:95], v[44:47]
    s_waitcnt lgkmcnt(3)
    v_mfma_f32_16x16x32_bf16 v[44:47], v[248:251], v[52:55], v[44:47]
    v_mfma_f32_16x16x32_bf16 v[48:51], v[248:251], v[56:59], v[48:51]
    v_mfma_f32_16x16x32_bf16 v[48:51], v[252:255], v[64:67], v[48:51]
    v_mfma_f32_16x16x32_bf16 v[44:47], v[252:255], v[60:63], v[44:47]
    s_setprio 0
    s_nop 6
    v_cvt_pk_bf16_f32 v44, v44, v45
    v_cvt_pk_bf16_f32 v45, v46, v47
    v_cvt_pk_bf16_f32 v46, v48, v49
    v_cvt_pk_bf16_f32 v47, v50, v51
    s_add_u32 s36, s39, 393216
    v_permlane16_swap_b32 v44, v46
    v_permlane16_swap_b32 v45, v47
    s_add_u32 s36, s39, 393216
    buffer_store_dwordx4 v[44:47], v13, s[24:27], s36 offen sc1
    ds_write_b128 v16, v[44:47] offset:12288
    s_waitcnt lgkmcnt(0)
    s_barrier
    s_cmp_ge_u32 s30, 6
    s_cbranch_scc1 WLOAD
    s_and_b32 s35, s30, 1
    s_add_u32 s12, s62, 0x480000
    s_addc_u32 s13, s63, 0
    s_mov_b32 s14, 0x7e000
    s_mov_b32 s15, 0x20000
    s_mul_i32 s38, s35, 262144
    s_lshl_b32 s41, s35, 13
    s_mov_b32 s42, 0
    s_mov_b32 s44, s29
    s_add_u32 s54, s55, 1024
    v_mov_b32 v9, s54
    v_lshl_add_u32 v9, v1, 7, v9
    s_add_u32 s44, s44, 1
    s_and_b32 s44, s44, 15
    s_add_u32 s46, s29, 1
    s_and_b32 s46, s46, 15
    s_cmp_eq_u32 s28, s29
    s_cselect_b32 s47, s46, s28
    s_mov_b32 s42, 16384
    s_and_b32 s35, s30, 1
    s_lshl_b32 s35, s35, 7
    s_add_u32 s35, s35, s55
    s_add_u32 s35, s35, 0x1600
    s_and_b32 s40, s30, 1
    s_lshl_b32 s40, s40, 13
    s_lshl_b32 s53, s29, 7
    s_add_u32 s40, s40, s53
    s_add_u32 s40, s40, 23068672
    v_lshlrev_b32 v10, 3, v1
    s_add_u32 s20, s62, 0x1c8000
    s_addc_u32 s21, s63, 0
    s_mov_b32 s22, 0x6000
    s_mov_b32 s23, 0x20000
    s_and_b32 s34, s30, 1
    s_lshl_b32 s34, s34, 9
    s_call_b64 s[76:77], PREP_a_issue_3
    s_mov_b32 m0, s19
    s_mov_b32 s39, s16
    s_and_b32 s53, s30, 3
    s_lshl_b32 s53, s53, 7
    s_add_u32 s53, s53, s55
    s_add_u32 s53, s53, 0x400
    v_mov_b32 v14, 1
    v_mov_b32 v15, 0
    s_mov_b64 exec, 1
    s_waitcnt vmcnt(0)
    buffer_atomic_add v14, v15, s[56:59], s53 offen sc1
    s_mov_b64 exec, -1
    s_call_b64 s[76:77], SUB_rest_2
    s_waitcnt lgkmcnt(0)
    s_mov_b32 s53, 0
    s_add_u32 s54, s52, 16
    s_bfm_b64 exec, 4, 0
poll_32:
    buffer_load_dword v8, v9, s[56:59], 0 offen sc1
    s_waitcnt vmcnt(0)
    v_cmp_eq_u32 vcc, s54, v8
    s_nop 0
    s_cmp_eq_u64 vcc, exec
    s_cbranch_scc1 pok_33
    s_sleep 5
    s_add_u32 s53, s53, 1
    s_cmp_lt_u32 s53, s61
    s_cbranch_scc1 poll_32
    s_mov_b32 s61, 0
pok_33:
    s_mov_b64 exec, -1
    buffer_load_dwordx4 v2, s[12:15], s39 offen sc1 lds
    buffer_load_dwordx4 v2, s[12:15], s39 offen offset:1024 sc1 lds
    s_call_b64 s[76:77], PREP_a_issue_3
    s_add_u32 m0, m0, 2048
    s_add_u32 s39, s39, 65536
    buffer_load_dwordx4 v2, s[12:15], s39 offen sc1 lds
    buffer_load_dwordx4 v2, s[12:15], s39 offen offset:1024 sc1 lds
    s_add_u32 m0, m0, 2048
    s_add_u32 s39, s39, 65536
    buffer_load_dwordx4 v2, s[12:15], s39 offen sc1 lds
    buffer_load_dwordx4 v2, s[12:15], s39 offen offset:1024 sc1 lds
    s_add_u32 m0, m0, 2048
    s_add_u32 s39, s39, 65536
    buffer_load_dwordx4 v2, s[12:15], s39 offen sc1 lds
    buffer_load_dwordx4 v2, s[12:15], s39 offen offset:1024 sc1 lds
    s_mov_b32 m0, s19
    s_mov_b32 s39, s16
    buffer_load_dwordx4 v2, s[12:15], s39 offen sc1 lds
    buffer_load_dwordx4 v2, s[12:15], s39 offen offset:1024 sc1 lds
    s_call_b64 s[76:77], PREP_a_issue_3
    s_add_u32 m0, m0, 2048
    s_add_u32 s39, s39, 65536
    buffer_load_dwordx4 v2, s[12:15], s39 offen sc1 lds
    buffer_load_dwordx4 v2, s[12:15], s39 offen offset:1024 sc1 lds
    s_add_u32 m0, m0, 2048
    s_add_u32 s39, s39, 65536
    buffer_load_dwordx4 v2, s[12:15], s39 offen sc1 lds
    buffer_load_dwordx4 v2, s[12:15], s39 offen offset:1024 sc1 lds
    s_add_u32 m0, m0, 2048
    s_add_u32 s39, s39, 65536
    buffer_load_dwordx4 v2, s[12:15], s39 offen sc1 lds
    buffer_load_dwordx4 v2, s[12:15], s39 offen offset:1024 sc1 lds
    s_mov_b32 m0, s19
    s_mov_b32 s39, s16
    s_waitcnt vmcnt(8)
    s_barrier
    buffer_load_dwordx4 v2, s[12:15], s39 offen sc1 lds
    buffer_load_dwordx4 v2, s[12:15], s39 offen offset:1024 sc1 lds
    s_call_b64 s[76:77], PREP_a_issue_3
    s_add_u32 m0, m0, 2048
    s_add_u32 s39, s39, 65536
    buffer_load_dwordx4 v2, s[12:15], s39 offen sc1 lds
    buffer_load_dwordx4 v2, s[12:15], s39 offen offset:1024 sc1 lds
    s_add_u32 m0, m0, 2048
    s_add_u32 s39, s39, 65536
    buffer_load_dwordx4 v2, s[12:15], s39 offen sc1 lds
    buffer_load_dwordx4 v2, s[12:15], s39 offen offset:1024 sc1 lds
    s_add_u32 m0, m0, 2048
    s_add_u32 s39, s39, 65536
    buffer_load_dwordx4 v2, s[12:15], s39 offen sc1 lds
    buffer_load_dwordx4 v2, s[12:15], s39 offen offset:1024 sc1 lds
    s_mov_b32 m0, s19
    s_mov_b32 s39, s16
    s_add_u32 s36, s34, 155648
    v_add_u32 v51, s36, v10
    ds_read_b64 v[18:19], v51 offset:0
    ds_read_b64 v[20:21], v51 offset:1024
    ds_read_b64 v[22:23], v51 offset:2048
    ds_read_b64 v[24:25], v51 offset:3072
    s_lshr_b32 s53, s29, 3
    s_lshl_b32 s53, s53, 14
    s_and_b32 s36, s29, 7
    s_lshl_b32 s36, s36, 10
    s_add_u32 s36, s36, s53
    s_add_u32 s36, s36, s34
    s_waitcnt lgkmcnt(0)
    v_pk_add_f32 v[18:19], v[18:19], v[20:21]
    v_pk_add_f32 v[18:19], v[18:19], v[22:23]
    v_pk_add_f32 v[18:19], v[18:19], v[24:25]
    buffer_store_dwordx2 v[18:19], v10, s[20:23], s36 offen sc1
    s_waitcnt vmcnt(9)
    s_barrier
    buffer_load_dwordx4 v2, s[12:15], s39 offen sc1 lds
    buffer_load_dwordx4 v2, s[12:15], s39 offen offset:1024 sc1 lds
    s_call_b64 s[76:77], PREP_a_issue_3
    s_add_u32 m0, m0, 2048
    s_add_u32 s39, s39, 65536
    buffer_load_dwordx4 v2, s[12:15], s39 offen sc1 lds
    buffer_load_dwordx4 v2, s[12:15], s39 offen offset:1024 sc1 lds
    s_add_u32 m0, m0, 2048
    s_add_u32 s39, s39, 65536
    buffer_load_dwordx4 v2, s[12:15], s39 offen sc1 lds
    buffer_load_dwordx4 v2, s[12:15], s39 offen offset:1024 sc1 lds
    s_add_u32 m0, m0, 2048
    s_add_u32 s39, s39, 65536
    buffer_load_dwordx4 v2, s[12:15], s39 offen sc1 lds
    buffer_load_dwordx4 v2, s[12:15], s39 offen offset:1024 sc1 lds
    s_mov_b32 m0, s19
    s_mov_b32 s39, s16
    s_waitcnt vmcnt(9)
    s_barrier
    buffer_load_dwordx4 v2, s[12:15], s39 offen sc1 lds
    buffer_load_dwordx4 v2, s[12:15], s39 offen offset:1024 sc1 lds
    s_call_b64 s[76:77], PREP_a_issue_3
    s_add_u32 m0, m0, 2048
    s_add_u32 s39, s39, 65536
    buffer_load_dwordx4 v2, s[12:15], s39 offen sc1 lds
    buffer_load_dwordx4 v2, s[12:15], s39 offen offset:1024 sc1 lds
    s_add_u32 m0, m0, 2048
    s_add_u32 s39, s39, 65536
    buffer_load_dwordx4 v2, s[12:15], s39 offen sc1 lds
    buffer_load_dwordx4 v2, s[12:15], s39 offen offset:1024 sc1 lds
    s_add_u32 m0, m0, 2048
    s_add_u32 s39, s39, 65536
    buffer_load_dwordx4 v2, s[12:15], s39 offen sc1 lds
    buffer_load_dwordx4 v2, s[12:15], s39 offen offset:1024 sc1 lds
    s_mov_b32 m0, s19
    s_mov_b32 s39, s16
    s_waitcnt vmcnt(16)
    s_and_b32 s53, s30, 1
    s_lshl_b32 s53, s53, 7
    s_add_u32 s53, s53, s55
    s_add_u32 s53, s53, 0x1600
    v_mov_b32 v14, 1
    v_mov_b32 v15, 0
    s_mov_b64 exec, 1
    buffer_atomic_add v14, v15, s[56:59], s53 offen sc1
    s_mov_b64 exec, -1
    s_waitcnt vmcnt(9)
    s_barrier
    buffer_load_dwordx4 v2, s[12:15], s39 offen sc1 lds
    buffer_load_dwordx4 v2, s[12:15], s39 offen offset:1024 sc1 lds
    s_call_b64 s[76:77], PREP_a_issue_3
    s_add_u32 m0, m0, 2048
    s_add_u32 s39, s39, 65536
    buffer_load_dwordx4 v2, s[12:15], s39 offen sc1 lds
    buffer_load_dwordx4 v2, s[12:15], s39 offen offset:1024 sc1 lds
    s_add_u32 m0, m0, 2048
    s_add_u32 s39, s39, 65536
    buffer_load_dwordx4 v2, s[12:15], s39 offen sc1 lds
    buffer_load_dwordx4 v2, s[12:15], s39 offen offset:1024 sc1 lds
    s_add_u32 m0, m0, 2048
    s_add_u32 s39, s39, 65536
    buffer_load_dwordx4 v2, s[12:15], s39 offen sc1 lds
    buffer_load_dwordx4 v2, s[12:15], s39 offen offset:1024 sc1 lds
    s_mov_b32 m0, s19
    s_mov_b32 s39, s16
    s_waitcnt vmcnt(9)
    s_barrier
    buffer_load_dwordx4 v2, s[12:15], s39 offen sc1 lds
    buffer_load_dwordx4 v2, s[12:15], s39 offen offset:1024 sc1 lds
    s_call_b64 s[76:77], PREP_a_issue_3
    s_add_u32 m0, m0, 2048
    s_add_u32 s39, s39, 65536
    buffer_load_dwordx4 v2, s[12:15], s39 offen sc1 lds
    buffer_load_dwordx4 v2, s[12:15], s39 offen offset:1024 sc1 lds
    s_add_u32 m0, m0, 2048
    s_add_u32 s39, s39, 65536
    buffer_load_dwordx4 v2, s[12:15], s39 offen sc1 lds
    buffer_load_dwordx4 v2, s[12:15], s39 offen offset:1024 sc1 lds
    s_add_u32 m0, m0, 2048
    s_add_u32 s39, s39, 65536
    buffer_load_dwordx4 v2, s[12:15], s39 offen sc1 lds
    buffer_load_dwordx4 v2, s[12:15], s39 offen offset:1024 sc1 lds
    s_mov_b32 m0, s19
    s_mov_b32 s39, s16
    s_waitcnt vmcnt(8)
    s_barrier
    buffer_load_dwordx4 v2, s[12:15], s39 offen sc1 lds
    buffer_load_dwordx4 v2, s[12:15], s39 offen offset:1024 sc1 lds
    s_call_b64 s[76:77], PREP_a_issue_3
    s_add_u32 m0, m0, 2048
    s_add_u32 s39, s39, 65536
    buffer_load_dwordx4 v2, s[12:15], s39 offen sc1 lds
    buffer_load_dwordx4 v2, s[12:15], s39 offen offset:1024 sc1 lds
    s_add_u32 m0, m0, 2048
    s_add_u32 s39, s39, 65536
    buffer_load_dwordx4 v2, s[12:15], s39 offen sc1 lds
    buffer_load_dwordx4 v2, s[12:15], s39 offen offset:1024 sc1 lds
    s_add_u32 m0, m0, 2048
    s_add_u32 s39, s39, 65536
    buffer_load_dwordx4 v2, s[12:15], s39 offen sc1 lds
    buffer_load_dwordx4 v2, s[12:15], s39 offen offset:1024 sc1 lds
    s_mov_b32 m0, s19
    s_mov_b32 s39, s16
    s_waitcnt vmcnt(8)
    s_barrier
    buffer_load_dwordx4 v2, s[12:15], s39 offen sc1 lds
    buffer_load_dwordx4 v2, s[12:15], s39 offen offset:1024 sc1 lds
    s_call_b64 s[76:77], PREP_a_issue_3
    s_add_u32 m0, m0, 2048
    s_add_u32 s39, s39, 65536
    buffer_load_dwordx4 v2, s[12:15], s39 offen sc1 lds
    buffer_load_dwordx4 v2, s[12:15], s39 offen offset:1024 sc1 lds
    s_add_u32 m0, m0, 2048
    s_add_u32 s39, s39, 65536
    buffer_load_dwordx4 v2, s[12:15], s39 offen sc1 lds
    buffer_load_dwordx4 v2, s[12:15], s39 offen offset:1024 sc1 lds
    s_add_u32 m0, m0, 2048
    s_add_u32 s39, s39, 65536
    buffer_load_dwordx4 v2, s[12:15], s39 offen sc1 lds
    buffer_load_dwordx4 v2, s[12:15], s39 offen offset:1024 sc1 lds
    s_mov_b32 m0, s19
    s_mov_b32 s39, s16
    s_load_dword s32, s[4:5], s35
    s_load_dword s3, s[4:5], s40
    s_waitcnt vmcnt(8)
    s_barrier
    buffer_load_dwordx4 v2, s[12:15], s39 offen sc1 lds
    buffer_load_dwordx4 v2, s[12:15], s39 offen offset:1024 sc1 lds
    s_call_b64 s[76:77], PREP_a_issue_3
    s_add_u32 m0, m0, 2048
    s_add_u32 s39, s39, 65536
    buffer_load_dwordx4 v2, s[12:15], s39 offen sc1 lds
    buffer_load_dwordx4 v2, s[12:15], s39 offen offset:1024 sc1 lds
    s_add_u32 m0, m0, 2048
    s_add_u32 s39, s39, 65536
    buffer_load_dwordx4 v2, s[12:15], s39 offen sc1 lds
    buffer_load_dwordx4 v2, s[12:15], s39 offen offset:1024 sc1 lds
    s_add_u32 m0, m0, 2048
    s_add_u32 s39, s39, 65536
    buffer_load_dwordx4 v2, s[12:15], s39 offen sc1 lds
    buffer_load_dwordx4 v2, s[12:15], s39 offen offset:1024 sc1 lds
    s_mov_b32 m0, s19
    s_mov_b32 s39, s16
    s_add_u32 s54, s52, 16
    s_waitcnt lgkmcnt(0)
    s_cmp_eq_u32 s32, s54
    s_cbranch_scc1 fok_34
    v_mov_b32 v15, s35
    s_mov_b32 s53, 0
    s_add_u32 s54, s52, 16
    s_bfm_b64 exec, 1, 0
poll_35:
    buffer_load_dword v14, v15, s[56:59], 0 offen sc1
    s_waitcnt vmcnt(0)
    v_cmp_eq_u32 vcc, s54, v14
    s_nop 0
    s_cmp_eq_u64 vcc, exec
    s_cbranch_scc1 pok_36
    s_sleep 5
    s_add_u32 s53, s53, 1
    s_cmp_lt_u32 s53, s61
    s_cbranch_scc1 poll_35
    s_mov_b32 s61, 0
pok_36:
    s_mov_b64 exec, -1
fok_34:
    s_add_u32 s36, s34, 0
    buffer_load_dwordx2 v[18:19], v10, s[20:23], s36 offen offset:0 sc1
    buffer_load_dwordx2 v[20:21], v10, s[20:23], s36 offen offset:1024 sc1
    buffer_load_dwordx2 v[22:23], v10, s[20:23], s36 offen offset:2048 sc1
    buffer_load_dwordx2 v[24:25], v10, s[20:23], s36 offen offset:3072 sc1
    s_add_u32 s36, s36, 4096
    buffer_load_dwordx2 v[26:27], v10, s[20:23], s36 offen offset:0 sc1
    buffer_load_dwordx2 v[28:29], v10, s[20:23], s36 offen offset:1024 sc1
    buffer_load_dwordx2 v[30:31], v10, s[20:23], s36 offen offset:2048 sc1
    buffer_load_dwordx2 v[32:33], v10, s[20:23], s36 offen offset:3072 sc1
    s_waitcnt vmcnt(16)
    s_barrier
    buffer_load_dwordx4 v2, s[12:15], s39 offen sc1 lds
    buffer_load_dwordx4 v2, s[12:15], s39 offen offset:1024 sc1 lds
    s_call_b64 s[76:77], PREP_a_issue_3
    s_add_u32 m0, m0, 2048
    s_add_u32 s39, s39, 65536
    buffer_load_dwordx4 v2, s[12:15], s39 offen sc1 lds
    buffer_load_dwordx4 v2, s[12:15], s39 offen offset:1024 sc1 lds
    s_add_u32 m0, m0, 2048
    s_add_u32 s39, s39, 65536
    buffer_load_dwordx4 v2, s[12:15], s39 offen sc1 lds
    buffer_load_dwordx4 v2, s[12:15], s39 offen offset:1024 sc1 lds
    s_add_u32 m0, m0, 2048
    s_add_u32 s39, s39, 65536
    buffer_load_dwordx4 v2, s[12:15], s39 offen sc1 lds
    buffer_load_dwordx4 v2, s[12:15], s39 offen offset:1024 sc1 lds
    s_mov_b32 m0, s19
    s_mov_b32 s39, s16
    s_add_u32 s36, s34, 16384
    buffer_load_dwordx2 v[34:35], v10, s[20:23], s36 offen offset:0 sc1
    buffer_load_dwordx2 v[36:37], v10, s[20:23], s36 offen offset:1024 sc1
    buffer_load_dwordx2 v[38:39], v10, s[20:23], s36 offen offset:2048 sc1
    buffer_load_dwordx2 v[40:41], v10, s[20:23], s36 offen offset:3072 sc1
    s_add_u32 s36, s36, 4096
    buffer_load_dwordx2 v[42:43], v10, s[20:23], s36 offen offset:0 sc1
    buffer_load_dwordx2 v[44:45], v10, s[20:23], s36 offen offset:1024 sc1
    buffer_load_dwordx2 v[46:47], v10, s[20:23], s36 offen offset:2048 sc1
    buffer_load_dwordx2 v[48:49], v10, s[20:23], s36 offen offset:3072 sc1
    s_waitcnt vmcnt(24)
    s_barrier
    buffer_load_dwordx4 v2, s[12:15], s39 offen sc1 lds
    buffer_load_dwordx4 v2, s[12:15], s39 offen offset:1024 sc1 lds
    s_call_b64 s[76:77], PREP_a_issue_3
    s_add_u32 m0, m0, 2048
    s_add_u32 s39, s39, 65536
    buffer_load_dwordx4 v2, s[12:15], s39 offen sc1 lds
    buffer_load_dwordx4 v2, s[12:15], s39 offen offset:1024 sc1 lds
    s_add_u32 m0, m0, 2048
    s_add_u32 s39, s39, 65536
    buffer_load_dwordx4 v2, s[12:15], s39 offen sc1 lds
    buffer_load_dwordx4 v2, s[12:15], s39 offen offset:1024 sc1 lds
    s_add_u32 m0, m0, 2048
    s_add_u32 s39, s39, 65536
    buffer_load_dwordx4 v2, s[12:15], s39 offen sc1 lds
    buffer_load_dwordx4 v2, s[12:15], s39 offen offset:1024 sc1 lds
    s_mov_b32 m0, s19
    s_mov_b32 s39, s16
    s_add_u32 s54, s52, 16
    s_waitcnt lgkmcnt(0)
    s_cmp_eq_u32 s3, s54
    s_cbranch_scc1 fok_37
    v_mov_b32 v15, s40
    s_mov_b32 s53, 0
    s_add_u32 s54, s52, 16
    s_bfm_b64 exec, 1, 0
poll_38:
    buffer_load_dword v14, v15, s[56:59], 0 offen sc1
    s_waitcnt vmcnt(0)
    v_cmp_eq_u32 vcc, s54, v14
    s_nop 0
    s_cmp_eq_u64 vcc, exec
    s_cbranch_scc1 pok_39
    s_sleep 5
    s_add_u32 s53, s53, 1
    s_cmp_lt_u32 s53, s61
    s_cbranch_scc1 poll_38
    s_mov_b32 s61, 0
pok_39:
    s_mov_b64 exec, -1
fok_37:
    s_add_u32 s24, s4, 0x1420000
    s_addc_u32 s25, s5, 0
    s_mov_b32 s26, 0x38000
    s_mov_b32 s27, 0x20000
    s_cmp_eq_u32 s60, 0
    s_cselect_b32 s26, s26, 0
    s_and_b32 s36, s30, 1
    s_mul_i32 s36, s36, 448
    s_mul_i32 s37, s29, 896
    s_add_u32 s37, s36, s37
    v_lshrrev_b32 v13, 5, v1
    v_mul_u32_u24 v13, 14336, v13
    v_and_b32 v6, 496, v2
    v_add_u32 v13, v13, v6
    buffer_load_dwordx4 v[54:57], v13, s[24:27], s37 offen sc1
    s_add_u32 s37, s37, 28672
    buffer_load_dwordx4 v[58:61], v13, s[24:27], s37 offen sc1
    s_add_u32 s37, s37, 28672
    buffer_load_dwordx4 v[62:65], v13, s[24:27], s37 offen sc1
    s_add_u32 s37, s37, 28672
    buffer_load_dwordx4 v[66:69], v13, s[24:27], s37 offen sc1
    s_add_u32 s37, s37, 28672
    buffer_load_dwordx4 v[70:73], v13, s[24:27], s37 offen sc1
    s_add_u32 s37, s37, 28672
    buffer_load_dwordx4 v[74:77], v13, s[24:27], s37 offen sc1
    s_add_u32 s37, s37, 28672
    buffer_load_dwordx4 v[78:81], v13, s[24:27], s37 offen sc1
    s_add_u32 s37, s37, 28672
    buffer_load_dwordx4 v[82:85], v13, s[24:27], s37 offen sc1
    s_add_u32 s37, s37, 28672
    s_waitcnt vmcnt(24)
    s_barrier
    buffer_load_dwordx4 v2, s[12:15], s39 offen sc1 lds
    buffer_load_dwordx4 v2, s[12:15], s39 offen offset:1024 sc1 lds
    s_call_b64 s[76:77], PREP_a_issue_3
    s_add_u32 m0, m0, 2048
    s_add_u32 s39, s39, 65536
    buffer_load_dwordx4 v2, s[12:15], s39 offen sc1 lds
    buffer_load_dwordx4 v2, s[12:15], s39 offen offset:1024 sc1 lds
    s_add_u32 m0, m0, 2048
    s_add_u32 s39, s39, 65536
    buffer_load_dwordx4 v2, s[12:15], s39 offen sc1 lds
    buffer_load_dwordx4 v2, s[12:15], s39 offen offset:1024 sc1 lds
    s_add_u32 m0, m0, 2048
    s_add_u32 s39, s39, 65536
    buffer_load_dwordx4 v2, s[12:15], s39 offen sc1 lds
    buffer_load_dwordx4 v2, s[12:15], s39 offen offset:1024 sc1 lds
    s_mov_b32 m0, s19
    s_mov_b32 s39, s16
    s_waitcnt vmcnt(24)
    v_pk_add_f32 v[18:19], v[18:19], v[34:35]
    v_pk_add_f32 v[20:21], v[20:21], v[36:37]
    v_pk_add_f32 v[22:23], v[22:23], v[38:39]
    v_pk_add_f32 v[24:25], v[24:25], v[40:41]
    v_pk_add_f32 v[26:27], v[26:27], v[42:43]
    v_pk_add_f32 v[28:29], v[28:29], v[44:45]
    v_pk_add_f32 v[30:31], v[30:31], v[46:47]
    v_pk_add_f32 v[32:33], v[32:33], v[48:49]
    v_pk_add_f32 v[18:19], v[18:19], v[26:27]
    v_pk_add_f32 v[20:21], v[20:21], v[28:29]
    v_pk_add_f32 v[22:23], v[22:23], v[30:31]
    v_pk_add_f32 v[24:25], v[24:25], v[32:33]
    s_waitcnt vmcnt(16)
    s_barrier
    buffer_load_dwordx4 v2, s[12:15], s39 offen sc1 lds
    buffer_load_dwordx4 v2, s[12:15], s39 offen offset:1024 sc1 lds
    s_call_b64 s[76:77], PREP_a_issue_3
    s_add_u32 m0, m0, 2048
    s_add_u32 s39, s39, 65536
    buffer_load_dwordx4 v2, s[12:15], s39 offen sc1 lds
    buffer_load_dwordx4 v2, s[12:15], s39 offen offset:1024 sc1 lds
    s_add_u32 m0, m0, 2048
    s_add_u32 s39, s39, 65536
    buffer_load_dwordx4 v2, s[12:15], s39 offen sc1 lds
    buffer_load_dwordx4 v2, s[12:15], s39 offen offset:1024 sc1 lds
    s_add_u32 m0, m0, 2048
    s_add_u32 s39, s39, 65536
    buffer_load_dwordx4 v2, s[12:15], s39 offen sc1 lds
    buffer_load_dwordx4 v2, s[12:15], s39 offen offset:1024 sc1 lds
    s_mov_b32 m0, s19
    s_mov_b32 s39, s16
    v_pk_add_f32 v[18:19], v[18:19], v[22:23]
    v_pk_add_f32 v[20:21], v[20:21], v[24:25]
    v_pk_add_f32 v[18:19], v[18:19], v[20:21]
    v_mul_f32 v52, 0x3a800000, v18
    v_mul_f32 v50, 0x3a800000, v19
    v_fma_f32 v50, -v52, v52, v50
    v_max_f32 v50, 0, v50
    v_cvt_pk_bf16_f32 v52, v52, v52
    v_lshlrev_b32 v52, 16, v52
    v_cvt_pk_bf16_f32 v50, v50, v50
    v_lshlrev_b32 v50, 16, v50
    s_waitcnt vmcnt(8)
    s_barrier
    buffer_load_dwordx4 v2, s[12:15], s39 offen sc1 lds
    buffer_load_dwordx4 v2, s[12:15], s39 offen offset:1024 sc1 lds
    s_add_u32 m0, m0, 2048
    s_add_u32 s39, s39, 65536
    buffer_load_dwordx4 v2, s[12:15], s39 offen sc1 lds
    buffer_load_dwordx4 v2, s[12:15], s39 offen offset:1024 sc1 lds
    s_add_u32 m0, m0, 2048
    s_add_u32 s39, s39, 65536
    buffer_load_dwordx4 v2, s[12:15], s39 offen sc1 lds
    buffer_load_dwordx4 v2, s[12:15], s39 offen offset:1024 sc1 lds
    s_add_u32 m0, m0, 2048
    s_add_u32 s39, s39, 65536
    buffer_load_dwordx4 v2, s[12:15], s39 offen sc1 lds
    buffer_load_dwordx4 v2, s[12:15], s39 offen offset:1024 sc1 lds
    s_waitcnt vmcnt(24)
    v_add_f32 v50, 0x3727c5ac, v50
    v_cvt_pk_bf16_f32 v50, v50, v50
    v_lshlrev_b32 v50, 16, v50
    v_sqrt_f32 v50, v50
    s_nop 0
    v_cvt_pk_bf16_f32 v50, v50, v50
    v_lshlrev_b32 v50, 16, v50
    v_rcp_f32 v53, v50
    s_add_u32 s36, s34, 160768
    v_add_u32 v51, s36, v10
    ds_write_b64 v51, v[52:53]
    s_waitcnt lgkmcnt(0)
    s_cmp_lg_u32 s60, 0
    s_cbranch_scc1 pc_43
    v_pk_add_f32 v[54:55], v[54:55], v[58:59]
    v_pk_add_f32 v[56:57], v[56:57], v[60:61]
    v_pk_add_f32 v[54:55], v[54:55], v[62:63]
    v_pk_add_f32 v[56:57], v[56:57], v[64:65]
    v_pk_add_f32 v[54:55], v[54:55], v[66:67]
    v_pk_add_f32 v[56:57], v[56:57], v[68:69]
    v_pk_add_f32 v[54:55], v[54:55], v[70:71]
    v_pk_add_f32 v[56:57], v[56:57], v[72:73]
pc_43:
    s_waitcnt vmcnt(8)
    s_barrier
    s_cmp_lg_u32 s60, 0
    s_cbranch_scc1 pc_44
    v_pk_add_f32 v[54:55], v[54:55], v[74:75]
    v_pk_add_f32 v[56:57], v[56:57], v[76:77]
    v_pk_add_f32 v[54:55], v[54:55], v[78:79]
    v_pk_add_f32 v[56:57], v[56:57], v[80:81]
    v_pk_add_f32 v[54:55], v[54:55], v[82:83]
    v_pk_add_f32 v[56:57], v[56:57], v[84:85]
    v_mov_b32 v58, v54
    v_mov_b32 v59, v55
    v_mov_b32 v60, v56
    v_mov_b32 v61, v57
    v_permlane32_swap_b32 v54, v58
    v_permlane32_swap_b32 v55, v59
    v_permlane32_swap_b32 v56, v60
    v_permlane32_swap_b32 v57, v61
    v_pk_add_f32 v[54:55], v[54:55], v[58:59]
    v_pk_add_f32 v[56:57], v[56:57], v[60:61]
    s_and_b32 s36, s30, 1
    s_mul_i32 s36, s36, 448
    s_add_u32 s36, s36, 159744
    v_add_u32 v6, s36, v2
    s_bfm_b64 exec, 28, 0
    ds_write_b128 v6, v[54:57]
    s_mov_b64 exec, -1
    s_waitcnt lgkmcnt(0)
pc_44:
    s_waitcnt vmcnt(0)
    s_barrier
    s_cmp_lg_u32 s60, 0
    s_cbranch_scc1 tw4_45
    s_mov_b64 s[48:49], s[74:75]
    s_lshl_b32 s45, s2, 1
    s_and_b32 s50, s30, 1
    s_add_u32 s45, s45, s50
    s_mul_i32 s45, s45, 14336
    s_mov_b32 s50, 7340032
    s_mov_b32 s51, 0x20000
    buffer_load_dwordx4 v[60:63], v2, s[48:51], s45 offen offset:0
    buffer_load_dwordx4 v[60:63], v2, s[48:51], s45 offen offset:1024
    buffer_load_dwordx4 v[60:63], v2, s[48:51], s45 offen offset:2048
    buffer_load_dwordx4 v[60:63], v2, s[48:51], s45 offen offset:3072
    s_add_u32 s45, s45, 4096
    buffer_load_dwordx4 v[60:63], v2, s[48:51], s45 offen offset:0
    buffer_load_dwordx4 v[60:63], v2, s[48:51], s45 offen offset:1024
    buffer_load_dwordx4 v[60:63], v2, s[48:51], s45 offen offset:2048
    buffer_load_dwordx4 v[60:63], v2, s[48:51], s45 offen offset:3072
    s_add_u32 s45, s45, 4096
    buffer_load_dwordx4 v[60:63], v2, s[48:51], s45 offen offset:0
    buffer_load_dwordx4 v[60:63], v2, s[48:51], s45 offen offset:1024
    buffer_load_dwordx4 v[60:63], v2, s[48:51], s45 offen offset:2048
    buffer_load_dwordx4 v[60:63], v2, s[48:51], s45 offen offset:3072
    s_add_u32 s45, s45, 4096
    buffer_load_dwordx4 v[60:63], v2, s[48:51], s45 offen offset:0
    buffer_load_dwordx4 v[60:63], v2, s[48:51], s45 offen offset:1024
tw4_45:
    s_barrier
    s_and_b32 s35, s30, 1
    s_mov_b32 s12, s62
    s_mov_b32 s13, s63
    s_mov_b32 s14, 0x1be000
    s_mov_b32 s15, 0x20000
    s_mul_i32 s38, s35, 917504
    s_mul_i32 s36, s31, 573440
    s_add_u32 s38, s38, s36
    s_mul_i32 s37, s31, 917504
    s_sub_u32 s37, 229376, s37
    s_lshl_b32 s41, s35, 13
    s_mov_b32 s42, 0
    s_mov_b32 s44, 0
    s_and_b32 s34, s30, 1
    s_lshl1_add_u32 s34, s31, s34
    s_lshl_b32 s34, s34, 7
    s_add_u32 s34, s34, s55
    s_add_u32 s34, s34, 0x1200
    s_and_b32 s35, s30, 1
    s_lshl1_add_u32 s35, s31, s35
    s_lshl_b32 s35, s35, 7
    s_add_u32 s35, s35, s55
    s_add_u32 s35, s35, 0x1400
    s_sub_u32 s48, s34, 512
    s_mov_b32 s44, 3
    s_call_b64 s[76:77], PREP_a_issue_4
    s_mov_b32 m0, s19
    s_mov_b32 s39, s16
    s_mov_b32 s40, s17
    s_waitcnt vmcnt(16)
    s_barrier
    s_load_dword s32, s[4:5], s48
    s_waitcnt vmcnt(8)
    s_barrier
    s_add_u32 s54, s52, 16
    s_waitcnt lgkmcnt(0)
    s_cmp_eq_u32 s32, s54
    s_cbranch_scc1 fok_46
    v_mov_b32 v9, s48
    s_mov_b32 s53, 0
    s_add_u32 s54, s52, 16
    s_bfm_b64 exec, 1, 0
poll_47:
    buffer_load_dword v8, v9, s[56:59], 0 offen sc1
    s_waitcnt vmcnt(0)
    v_cmp_eq_u32 vcc, s54, v8
    s_nop 0
    s_cmp_eq_u64 vcc, exec
    s_cbranch_scc1 pok_48
    s_sleep 5
    s_add_u32 s53, s53, 1
    s_cmp_lt_u32 s53, s61
    s_cbranch_scc1 poll_47
    s_mov_b32 s61, 0
pok_48:
    s_mov_b64 exec, -1
fok_46:
    buffer_load_dwordx4 v2, s[12:15], s39 offen sc1 lds
    s_add_u32 m0, m0, 1024
    s_nop 0
    buffer_load_dwordx4 v2, s[12:15], s40 offen sc1 lds
    s_call_b64 s[76:77], PREP_a_issue_4
    s_add_u32 m0, m0, 1024
    s_add_u32 s39, s39, 229376
    buffer_load_dwordx4 v2, s[12:15], s39 offen sc1 lds
    s_add_u32 m0, m0, 1024
    s_add_u32 s40, s40, 229376
    buffer_load_dwordx4 v2, s[12:15], s40 offen sc1 lds
    s_add_u32 m0, m0, 1024
    s_add_u32 s39, s39, s37
    buffer_load_dwordx4 v2, s[12:15], s39 offen sc1 lds
    s_add_u32 m0, m0, 1024
    s_add_u32 s40, s40, s37
    buffer_load_dwordx4 v2, s[12:15], s40 offen sc1 lds
    s_add_u32 m0, m0, 1024
    s_add_u32 s39, s39, 229376
    buffer_load_dwordx4 v2, s[12:15], s39 offen sc1 lds
    s_add_u32 m0, m0, 1024
    s_add_u32 s40, s40, 229376
    buffer_load_dwordx4 v2, s[12:15], s40 offen sc1 lds
    s_mov_b32 m0, s19
    s_mov_b32 s39, s16
    s_mov_b32 s40, s17
    s_waitcnt vmcnt(8)
    s_barrier
    buffer_load_dwordx4 v2, s[12:15], s39 offen sc1 lds
    s_add_u32 m0, m0, 1024
    s_nop 0
    buffer_load_dwordx4 v2, s[12:15], s40 offen sc1 lds
    s_mov_b32 s43, 1
ld_49:
    s_add_u32 s19, s41, s42
    s_lshl_b32 s45, s44, 1
    s_add_u32 s45, s45, 0
    s_sub_u32 s45, s45, 32
    s_mul_i32 s46, s45, 86
    s_lshr_b32 s46, s46, 8
    s_mul_i32 s47, s46, 3
    s_sub_u32 s47, s45, s47
    s_lshl_b32 s47, s47, 2
    s_lshr_b32 s47, 0x362, s47
    s_and_b32 s47, s47, 7
    s_cmp_ge_u32 s44, 10
    s_cselect_b32 s45, 9, 2
    s_cselect_b32 s51, 1, 0
    s_sub_u32 s45, s44, s45
    s_cmp_lt_u32 s44, 3
    s_cselect_b32 s45, 0, s45
    s_cselect_b32 s51, s44, s51
    s_lshl2_add_u32 s51, 0, s51
    s_cmp_lt_u32 s44, 17
    s_cselect_b32 s47, s51, s47
    s_cselect_b32 s46, s45, s46
    s_add_u32 s46, s46, s33
    s_and_b32 s46, s46, 7
    s_mul_i32 s46, s46, 7
    s_add_u32 s16, s46, s47
    s_lshr_b32 s53, s16, 3
    s_lshl_b32 s53, s53, 14
    s_and_b32 s16, s16, 7
    s_lshl_b32 s16, s16, 10
    s_add_u32 s16, s16, s53
    s_add_u32 s16, s16, s38
    s_lshl_b32 s45, s44, 1
    s_add_u32 s45, s45, 1
    s_sub_u32 s45, s45, 32
    s_mul_i32 s46, s45, 86
    s_lshr_b32 s46, s46, 8
    s_mul_i32 s47, s46, 3
    s_sub_u32 s47, s45, s47
    s_lshl_b32 s47, s47, 2
    s_lshr_b32 s47, 0x362, s47
    s_and_b32 s47, s47, 7
    s_cmp_ge_u32 s44, 10
    s_cselect_b32 s45, 9, 2
    s_cselect_b32 s51, 1, 0
    s_sub_u32 s45, s44, s45
    s_cmp_lt_u32 s44, 3
    s_cselect_b32 s45, 0, s45
    s_cselect_b32 s51, s44, s51
    s_lshl2_add_u32 s51, 1, s51
    s_cmp_lt_u32 s44, 17
    s_cselect_b32 s47, s51, s47
    s_cselect_b32 s46, s45, s46
    s_add_u32 s46, s46, s33
    s_and_b32 s46, s46, 7
    s_mul_i32 s46, s46, 7
    s_add_u32 s17, s46, s47
    s_lshr_b32 s53, s17, 3
    s_lshl_b32 s53, s53, 14
    s_and_b32 s17, s17, 7
    s_lshl_b32 s17, s17, 10
    s_add_u32 s17, s17, s53
    s_add_u32 s17, s17, s38
    s_add_u32 s44, s44, 1
    s_add_u32 s42, s42, 16384
    s_cmp_eq_u32 s42, 49152
    s_cselect_b32 s42, 0, s42
    s_add_u32 m0, m0, 1024
    s_add_u32 s39, s39, 229376
    buffer_load_dwordx4 v2, s[12:15], s39 offen sc1 lds
    s_add_u32 m0, m0, 1024
    s_add_u32 s40, s40, 229376
    buffer_load_dwordx4 v2, s[12:15], s40 offen sc1 lds
    s_add_u32 m0, m0, 1024
    s_add_u32 s39, s39, s37
    buffer_load_dwordx4 v2, s[12:15], s39 offen sc1 lds
    s_add_u32 m0, m0, 1024
    s_add_u32 s40, s40, s37
    buffer_load_dwordx4 v2, s[12:15], s40 offen sc1 lds
    s_add_u32 m0, m0, 1024
    s_add_u32 s39, s39, 229376
    buffer_load_dwordx4 v2, s[12:15], s39 offen sc1 lds
    s_add_u32 m0, m0, 1024
    s_add_u32 s40, s40, 229376
    buffer_load_dwordx4 v2, s[12:15], s40 offen sc1 lds
    s_mov_b32 m0, s19
    s_mov_b32 s39, s16
    s_mov_b32 s40, s17
    s_waitcnt vmcnt(8)
    s_barrier
    buffer_load_dwordx4 v2, s[12:15], s39 offen sc1 lds
    s_add_u32 m0, m0, 1024
    s_nop 0
    buffer_load_dwordx4 v2, s[12:15], s40 offen sc1 lds
    s_add_u32 s43, s43, 1
    s_cmp_lt_u32 s43, 4
    s_cbranch_scc1 ld_49
    s_call_b64 s[76:77], PREP_a_issue_4
    s_add_u32 m0, m0, 1024
    s_add_u32 s39, s39, 229376
    buffer_load_dwordx4 v2, s[12:15], s39 offen sc1 lds
    s_add_u32 m0, m0, 1024
    s_add_u32 s40, s40, 229376
    buffer_load_dwordx4 v2, s[12:15], s40 offen sc1 lds
    s_add_u32 m0, m0, 1024
    s_add_u32 s39, s39, s37
    buffer_load_dwordx4 v2, s[12:15], s39 offen sc1 lds
    s_add_u32 m0, m0, 1024
    s_add_u32 s40, s40, s37
    buffer_load_dwordx4 v2, s[12:15], s40 offen sc1 lds
    s_add_u32 m0, m0, 1024
    s_add_u32 s39, s39, 229376
    buffer_load_dwordx4 v2, s[12:15], s39 offen sc1 lds
    s_add_u32 m0, m0, 1024
    s_add_u32 s40, s40, 229376
    buffer_load_dwordx4 v2, s[12:15], s40 offen sc1 lds
    s_mov_b32 m0, s19
    s_mov_b32 s39, s16
    s_mov_b32 s40, s17
    s_waitcnt vmcnt(8)
    s_barrier
    buffer_load_dwordx4 v2, s[12:15], s39 offen sc1 lds
    s_add_u32 m0, m0, 1024
    s_nop 0
    buffer_load_dwordx4 v2, s[12:15], s40 offen sc1 lds
    s_load_dword s32, s[4:5], s34
    s_call_b64 s[76:77], PREP_a_issue_4
    s_add_u32 m0, m0, 1024
    s_add_u32 s39, s39, 229376
    buffer_load_dwordx4 v2, s[12:15], s39 offen sc1 lds
    s_add_u32 m0, m0, 1024
    s_add_u32 s40, s40, 229376
    buffer_load_dwordx4 v2, s[12:15], s40 offen sc1 lds
    s_add_u32 m0, m0, 1024
    s_add_u32 s39, s39, s37
    buffer_load_dwordx4 v2, s[12:15], s39 offen sc1 lds
    s_add_u32 m0, m0, 1024
    s_add_u32 s40, s40, s37
    buffer_load_dwordx4 v2, s[12:15], s40 offen sc1 lds
    s_add_u32 m0, m0, 1024
    s_add_u32 s39, s39, 229376
    buffer_load_dwordx4 v2, s[12:15], s39 offen sc1 lds
    s_add_u32 m0, m0, 1024
    s_add_u32 s40, s40, 229376
    buffer_load_dwordx4 v2, s[12:15], s40 offen sc1 lds
    s_mov_b32 m0, s19
    s_mov_b32 s39, s16
    s_mov_b32 s40, s17
    s_waitcnt vmcnt(8)
    s_barrier
    buffer_load_dwordx4 v2, s[12:15], s39 offen sc1 lds
    s_add_u32 m0, m0, 1024
    s_nop 0
    buffer_load_dwordx4 v2, s[12:15], s40 offen sc1 lds
    s_add_u32 s54, s52, 16
    s_waitcnt lgkmcnt(0)
    s_cmp_eq_u32 s32, s54
    s_cbranch_scc1 fok_50
    v_mov_b32 v9, s34
    s_mov_b32 s53, 0
    s_add_u32 s54, s52, 16
    s_bfm_b64 exec, 1, 0
poll_51:
    buffer_load_dword v8, v9, s[56:59], 0 offen sc1
    s_waitcnt vmcnt(0)
    v_cmp_eq_u32 vcc, s54, v8
    s_nop 0
    s_cmp_eq_u64 vcc, exec
    s_cbranch_scc1 pok_52
    s_sleep 5
    s_add_u32 s53, s53, 1
    s_cmp_lt_u32 s53, s61
    s_cbranch_scc1 poll_51
    s_mov_b32 s61, 0
pok_52:
    s_mov_b64 exec, -1
fok_50:
    s_call_b64 s[76:77], PREP_a_issue_4
    s_add_u32 m0, m0, 1024
    s_add_u32 s39, s39, 229376
    buffer_load_dwordx4 v2, s[12:15], s39 offen sc1 lds
    s_add_u32 m0, m0, 1024
    s_add_u32 s40, s40, 229376
    buffer_load_dwordx4 v2, s[12:15], s40 offen sc1 lds
    s_add_u32 m0, m0, 1024
    s_add_u32 s39, s39, s37
    buffer_load_dwordx4 v2, s[12:15], s39 offen sc1 lds
    s_add_u32 m0, m0, 1024
    s_add_u32 s40, s40, s37
    buffer_load_dwordx4 v2, s[12:15], s40 offen sc1 lds
    s_add_u32 m0, m0, 1024
    s_add_u32 s39, s39, 229376
    buffer_load_dwordx4 v2, s[12:15], s39 offen sc1 lds
    s_add_u32 m0, m0, 1024
    s_add_u32 s40, s40, 229376
    buffer_load_dwordx4 v2, s[12:15], s40 offen sc1 lds
    s_mov_b32 m0, s19
    s_mov_b32 s39, s16
    s_mov_b32 s40, s17
    s_waitcnt vmcnt(8)
    s_barrier
    buffer_load_dwordx4 v2, s[12:15], s39 offen sc1 lds
    s_add_u32 m0, m0, 1024
    s_nop 0
    buffer_load_dwordx4 v2, s[12:15], s40 offen sc1 lds
    s_mov_b32 s43, 1
ld_53:
    s_add_u32 s19, s41, s42
    s_lshl_b32 s45, s44, 1
    s_add_u32 s45, s45, 0
    s_sub_u32 s45, s45, 32
    s_mul_i32 s46, s45, 86
    s_lshr_b32 s46, s46, 8
    s_mul_i32 s47, s46, 3
    s_sub_u32 s47, s45, s47
    s_lshl_b32 s47, s47, 2
    s_lshr_b32 s47, 0x362, s47
    s_and_b32 s47, s47, 7
    s_cmp_ge_u32 s44, 10
    s_cselect_b32 s45, 9, 2
    s_cselect_b32 s51, 1, 0
    s_sub_u32 s45, s44, s45
    s_cmp_lt_u32 s44, 3
    s_cselect_b32 s45, 0, s45
    s_cselect_b32 s51, s44, s51
    s_lshl2_add_u32 s51, 0, s51
    s_cmp_lt_u32 s44, 17
    s_cselect_b32 s47, s51, s47
    s_cselect_b32 s46, s45, s46
    s_add_u32 s46, s46, s33
    s_and_b32 s46, s46, 7
    s_mul_i32 s46, s46, 7
    s_add_u32 s16, s46, s47
    s_lshr_b32 s53, s16, 3
    s_lshl_b32 s53, s53, 14
    s_and_b32 s16, s16, 7
    s_lshl_b32 s16, s16, 10
    s_add_u32 s16, s16, s53
    s_add_u32 s16, s16, s38
    s_lshl_b32 s45, s44, 1
    s_add_u32 s45, s45, 1
    s_sub_u32 s45, s45, 32
    s_mul_i32 s46, s45, 86
    s_lshr_b32 s46, s46, 8
    s_mul_i32 s47, s46, 3
    s_sub_u32 s47, s45, s47
    s_lshl_b32 s47, s47, 2
    s_lshr_b32 s47, 0x362, s47
    s_and_b32 s47, s47, 7
    s_cmp_ge_u32 s44, 10
    s_cselect_b32 s45, 9, 2
    s_cselect_b32 s51, 1, 0
    s_sub_u32 s45, s44, s45
    s_cmp_lt_u32 s44, 3
    s_cselect_b32 s45, 0, s45
    s_cselect_b32 s51, s44, s51
    s_lshl2_add_u32 s51, 1, s51
    s_cmp_lt_u32 s44, 17
    s_cselect_b32 s47, s51, s47
    s_cselect_b32 s46, s45, s46
    s_add_u32 s46, s46, s33
    s_and_b32 s46, s46, 7
    s_mul_i32 s46, s46, 7
    s_add_u32 s17, s46, s47
    s_lshr_b32 s53, s17, 3
    s_lshl_b32 s53, s53, 14
    s_and_b32 s17, s17, 7
    s_lshl_b32 s17, s17, 10
    s_add_u32 s17, s17, s53
    s_add_u32 s17, s17, s38
    s_add_u32 s44, s44, 1
    s_add_u32 s42, s42, 16384
    s_cmp_eq_u32 s42, 49152
    s_cselect_b32 s42, 0, s42
    s_add_u32 m0, m0, 1024
    s_add_u32 s39, s39, 229376
    buffer_load_dwordx4 v2, s[12:15], s39 offen sc1 lds
    s_add_u32 m0, m0, 1024
    s_add_u32 s40, s40, 229376
    buffer_load_dwordx4 v2, s[12:15], s40 offen sc1 lds
    s_add_u32 m0, m0, 1024
    s_add_u32 s39, s39, s37
    buffer_load_dwordx4 v2, s[12:15], s39 offen sc1 lds
    s_add_u32 m0, m0, 1024
    s_add_u32 s40, s40, s37
    buffer_load_dwordx4 v2, s[12:15], s40 offen sc1 lds
    s_add_u32 m0, m0, 1024
    s_add_u32 s39, s39, 229376
    buffer_load_dwordx4 v2, s[12:15], s39 offen sc1 lds
    s_add_u32 m0, m0, 1024
    s_add_u32 s40, s40, 229376
    buffer_load_dwordx4 v2, s[12:15], s40 offen sc1 lds
    s_mov_b32 m0, s19
    s_mov_b32 s39, s16
    s_mov_b32 s40, s17
    s_waitcnt vmcnt(8)
    s_barrier
    buffer_load_dwordx4 v2, s[12:15], s39 offen sc1 lds
    s_add_u32 m0, m0, 1024
    s_nop 0
    buffer_load_dwordx4 v2, s[12:15], s40 offen sc1 lds
    s_add_u32 s43, s43, 1
    s_cmp_lt_u32 s43, 5
    s_cbranch_scc1 ld_53
    s_call_b64 s[76:77], PREP_a_issue_4
    s_add_u32 m0, m0, 1024
    s_add_u32 s39, s39, 229376
    buffer_load_dwordx4 v2, s[12:15], s39 offen sc1 lds
    s_add_u32 m0, m0, 1024
    s_add_u32 s40, s40, 229376
    buffer_load_dwordx4 v2, s[12:15], s40 offen sc1 lds
    s_add_u32 m0, m0, 1024
    s_add_u32 s39, s39, s37
    buffer_load_dwordx4 v2, s[12:15], s39 offen sc1 lds
    s_add_u32 m0, m0, 1024
    s_add_u32 s40, s40, s37
    buffer_load_dwordx4 v2, s[12:15], s40 offen sc1 lds
    s_add_u32 m0, m0, 1024
    s_add_u32 s39, s39, 229376
    buffer_load_dwordx4 v2, s[12:15], s39 offen sc1 lds
    s_add_u32 m0, m0, 1024
    s_add_u32 s40, s40, 229376
    buffer_load_dwordx4 v2, s[12:15], s40 offen sc1 lds
    s_mov_b32 m0, s19
    s_mov_b32 s39, s16
    s_mov_b32 s40, s17
    s_waitcnt vmcnt(8)
    s_barrier
    buffer_load_dwordx4 v2, s[12:15], s39 offen sc1 lds
    s_add_u32 m0, m0, 1024
    s_nop 0
    buffer_load_dwordx4 v2, s[12:15], s40 offen sc1 lds
    s_load_dword s32, s[4:5], s35
    s_call_b64 s[76:77], PREP_a_issue_4
    s_add_u32 m0, m0, 1024
    s_add_u32 s39, s39, 229376
    buffer_load_dwordx4 v2, s[12:15], s39 offen sc1 lds
    s_add_u32 m0, m0, 1024
    s_add_u32 s40, s40, 229376
    buffer_load_dwordx4 v2, s[12:15], s40 offen sc1 lds
    s_add_u32 m0, m0, 1024
    s_add_u32 s39, s39, s37
    buffer_load_dwordx4 v2, s[12:15], s39 offen sc1 lds
    s_add_u32 m0, m0, 1024
    s_add_u32 s40, s40, s37
    buffer_load_dwordx4 v2, s[12:15], s40 offen sc1 lds
    s_add_u32 m0, m0, 1024
    s_add_u32 s39, s39, 229376
    buffer_load_dwordx4 v2, s[12:15], s39 offen sc1 lds
    s_add_u32 m0, m0, 1024
    s_add_u32 s40, s40, 229376
    buffer_load_dwordx4 v2, s[12:15], s40 offen sc1 lds
    s_mov_b32 m0, s19
    s_mov_b32 s39, s16
    s_mov_b32 s40, s17
    s_waitcnt vmcnt(8)
    s_barrier
    buffer_load_dwordx4 v2, s[12:15], s39 offen sc1 lds
    s_add_u32 m0, m0, 1024
    s_nop 0
    buffer_load_dwordx4 v2, s[12:15], s40 offen sc1 lds
    s_add_u32 s54, s52, 16
    s_waitcnt lgkmcnt(0)
    s_cmp_eq_u32 s32, s54
    s_cbranch_scc1 fok_54
    v_mov_b32 v9, s35
    s_mov_b32 s53, 0
    s_add_u32 s54, s52, 16
    s_bfm_b64 exec, 1, 0
poll_55:
    buffer_load_dword v8, v9, s[56:59], 0 offen sc1
    s_waitcnt vmcnt(0)
    v_cmp_eq_u32 vcc, s54, v8
    s_nop 0
    s_cmp_eq_u64 vcc, exec
    s_cbranch_scc1 pok_56
    s_sleep 5
    s_add_u32 s53, s53, 1
    s_cmp_lt_u32 s53, s61
    s_cbranch_scc1 poll_55
    s_mov_b32 s61, 0
pok_56:
    s_mov_b64 exec, -1
fok_54:
    s_call_b64 s[76:77], PREP_a_issue_4
    s_add_u32 m0, m0, 1024
    s_add_u32 s39, s39, 229376
    buffer_load_dwordx4 v2, s[12:15], s39 offen sc1 lds
    s_add_u32 m0, m0, 1024
    s_add_u32 s40, s40, 229376
    buffer_load_dwordx4 v2, s[12:15], s40 offen sc1 lds
    s_add_u32 m0, m0, 1024
    s_add_u32 s39, s39, s37
    buffer_load_dwordx4 v2, s[12:15], s39 offen sc1 lds
    s_add_u32 m0, m0, 1024
    s_add_u32 s40, s40, s37
    buffer_load_dwordx4 v2, s[12:15], s40 offen sc1 lds
    s_add_u32 m0, m0, 1024
    s_add_u32 s39, s39, 229376
    buffer_load_dwordx4 v2, s[12:15], s39 offen sc1 lds
    s_add_u32 m0, m0, 1024
    s_add_u32 s40, s40, 229376
    buffer_load_dwordx4 v2, s[12:15], s40 offen sc1 lds
    s_mov_b32 m0, s19
    s_mov_b32 s39, s16
    s_mov_b32 s40, s17
    s_waitcnt vmcnt(8)
    s_barrier
    buffer_load_dwordx4 v2, s[12:15], s39 offen sc1 lds
    s_add_u32 m0, m0, 1024
    s_nop 0
    buffer_load_dwordx4 v2, s[12:15], s40 offen sc1 lds
    s_mov_b32 s43, 1
ld_57:
    s_add_u32 s19, s41, s42
    s_lshl_b32 s45, s44, 1
    s_add_u32 s45, s45, 0
    s_sub_u32 s45, s45, 32
    s_mul_i32 s46, s45, 86
    s_lshr_b32 s46, s46, 8
    s_mul_i32 s47, s46, 3
    s_sub_u32 s47, s45, s47
    s_lshl_b32 s47, s47, 2
    s_lshr_b32 s47, 0x362, s47
    s_and_b32 s47, s47, 7
    s_cmp_ge_u32 s44, 10
    s_cselect_b32 s45, 9, 2
    s_cselect_b32 s51, 1, 0
    s_sub_u32 s45, s44, s45
    s_cmp_lt_u32 s44, 3
    s_cselect_b32 s45, 0, s45
    s_cselect_b32 s51, s44, s51
    s_lshl2_add_u32 s51, 0, s51
    s_cmp_lt_u32 s44, 17
    s_cselect_b32 s47, s51, s47
    s_cselect_b32 s46, s45, s46
    s_add_u32 s46, s46, s33
    s_and_b32 s46, s46, 7
    s_mul_i32 s46, s46, 7
    s_add_u32 s16, s46, s47
    s_lshr_b32 s53, s16, 3
    s_lshl_b32 s53, s53, 14
    s_and_b32 s16, s16, 7
    s_lshl_b32 s16, s16, 10
    s_add_u32 s16, s16, s53
    s_add_u32 s16, s16, s38
    s_lshl_b32 s45, s44, 1
    s_add_u32 s45, s45, 1
    s_sub_u32 s45, s45, 32
    s_mul_i32 s46, s45, 86
    s_lshr_b32 s46, s46, 8
    s_mul_i32 s47, s46, 3
    s_sub_u32 s47, s45, s47
    s_lshl_b32 s47, s47, 2
    s_lshr_b32 s47, 0x362, s47
    s_and_b32 s47, s47, 7
    s_cmp_ge_u32 s44, 10
    s_cselect_b32 s45, 9, 2
    s_cselect_b32 s51, 1, 0
    s_sub_u32 s45, s44, s45
    s_cmp_lt_u32 s44, 3
    s_cselect_b32 s45, 0, s45
    s_cselect_b32 s51, s44, s51
    s_lshl2_add_u32 s51, 1, s51
    s_cmp_lt_u32 s44, 17
    s_cselect_b32 s47, s51, s47
    s_cselect_b32 s46, s45, s46
    s_add_u32 s46, s46, s33
    s_and_b32 s46, s46, 7
    s_mul_i32 s46, s46, 7
    s_add_u32 s17, s46, s47
    s_lshr_b32 s53, s17, 3
    s_lshl_b32 s53, s53, 14
    s_and_b32 s17, s17, 7
    s_lshl_b32 s17, s17, 10
    s_add_u32 s17, s17, s53
    s_add_u32 s17, s17, s38
    s_add_u32 s44, s44, 1
    s_add_u32 s42, s42, 16384
    s_cmp_eq_u32 s42, 49152
    s_cselect_b32 s42, 0, s42
    s_add_u32 m0, m0, 1024
    s_add_u32 s39, s39, 229376
    buffer_load_dwordx4 v2, s[12:15], s39 offen sc1 lds
    s_add_u32 m0, m0, 1024
    s_add_u32 s40, s40, 229376
    buffer_load_dwordx4 v2, s[12:15], s40 offen sc1 lds
    s_add_u32 m0, m0, 1024
    s_add_u32 s39, s39, s37
    buffer_load_dwordx4 v2, s[12:15], s39 offen sc1 lds
    s_add_u32 m0, m0, 1024
    s_add_u32 s40, s40, s37
    buffer_load_dwordx4 v2, s[12:15], s40 offen sc1 lds
    s_add_u32 m0, m0, 1024
    s_add_u32 s39, s39, 229376
    buffer_load_dwordx4 v2, s[12:15], s39 offen sc1 lds
    s_add_u32 m0, m0, 1024
    s_add_u32 s40, s40, 229376
    buffer_load_dwordx4 v2, s[12:15], s40 offen sc1 lds
    s_mov_b32 m0, s19
    s_mov_b32 s39, s16
    s_mov_b32 s40, s17
    s_waitcnt vmcnt(8)
    s_barrier
    buffer_load_dwordx4 v2, s[12:15], s39 offen sc1 lds
    s_add_u32 m0, m0, 1024
    s_nop 0
    buffer_load_dwordx4 v2, s[12:15], s40 offen sc1 lds
    s_add_u32 s43, s43, 1
    s_cmp_lt_u32 s43, 10
    s_cbranch_scc1 ld_57
    s_call_b64 s[76:77], PREP_a_issue_4
    s_add_u32 m0, m0, 1024
    s_add_u32 s39, s39, 229376
    buffer_load_dwordx4 v2, s[12:15], s39 offen sc1 lds
    s_add_u32 m0, m0, 1024
    s_add_u32 s40, s40, 229376
    buffer_load_dwordx4 v2, s[12:15], s40 offen sc1 lds
    s_add_u32 m0, m0, 1024
    s_add_u32 s39, s39, s37
    buffer_load_dwordx4 v2, s[12:15], s39 offen sc1 lds
    s_add_u32 m0, m0, 1024
    s_add_u32 s40, s40, s37
    buffer_load_dwordx4 v2, s[12:15], s40 offen sc1 lds
    s_add_u32 m0, m0, 1024
    s_add_u32 s39, s39, 229376
    buffer_load_dwordx4 v2, s[12:15], s39 offen sc1 lds
    s_add_u32 m0, m0, 1024
    s_add_u32 s40, s40, 229376
    buffer_load_dwordx4 v2, s[12:15], s40 offen sc1 lds
    s_mov_b32 m0, s19
    s_mov_b32 s39, s16
    s_mov_b32 s40, s17
    s_waitcnt vmcnt(8)
    s_barrier
    buffer_load_dwordx4 v2, s[12:15], s39 offen sc1 lds
    s_add_u32 m0, m0, 1024
    s_nop 0
    buffer_load_dwordx4 v2, s[12:15], s40 offen sc1 lds
    s_add_u32 m0, m0, 1024
    s_add_u32 s39, s39, 229376
    buffer_load_dwordx4 v2, s[12:15], s39 offen sc1 lds
    s_add_u32 m0, m0, 1024
    s_add_u32 s40, s40, 229376
    buffer_load_dwordx4 v2, s[12:15], s40 offen sc1 lds
    s_add_u32 m0, m0, 1024
    s_add_u32 s39, s39, s37
    buffer_load_dwordx4 v2, s[12:15], s39 offen sc1 lds
    s_add_u32 m0, m0, 1024
    s_add_u32 s40, s40, s37
    buffer_load_dwordx4 v2, s[12:15], s40 offen sc1 lds
    s_add_u32 m0, m0, 1024
    s_add_u32 s39, s39, 229376
    buffer_load_dwordx4 v2, s[12:15], s39 offen sc1 lds
    s_add_u32 m0, m0, 1024
    s_add_u32 s40, s40, 229376
    buffer_load_dwordx4 v2, s[12:15], s40 offen sc1 lds
    s_waitcnt vmcnt(8)
    s_barrier
    s_waitcnt vmcnt(0)
    s_barrier
    s_cmp_eq_u32 s60, 1
    s_cbranch_scc1 K_fin
    v_and_b32 v81, 7, v0
    v_lshrrev_b32 v84, 6, v0
    v_lshlrev_b32 v84, 4, v84
    v_bfe_u32 v85, v0, 3, 3
    v_add_u32 v84, v84, v85
    s_lshr_b32 s78, s29, 1
    s_lshl_b32 s78, s78, 16
    s_and_b32 s79, s29, 1
    s_lshl_b32 s79, s79, 7
    s_add_u32 s78, s78, s79
    s_lshr_b32 s79, s30, 1
    s_lshl_b32 s79, s79, 13
    s_add_u32 s78, s78, s79
    v_lshlrev_b32 v78, 8, v84
    v_lshl_add_u32 v78, v81, 4, v78
    v_add_u32 v78, s78, v78
    s_lshl_b32 s78, s28, 7
    s_lshl_b32 s79, s29, 3
    s_add_u32 s78, s78, s79
    v_add_u32 v79, s78, v81
    v_lshlrev_b32 v80, 11, v79
    v_and_b32 v85, 3, v79
    v_lshrrev_b32 v82, 2, v79
    v_lshlrev_b32 v82, 14, v82
    v_lshl_add_u32 v82, v85, 11, v82
    v_lshl_add_u32 v82, v84, 4, v82
    v_lshrrev_b32 v85, 2, v84
    v_lshlrev_b32 v85, 3, v85
    v_and_b32 v84, 3, v84
    v_add_u32 v84, v84, v85
    v_lshl_add_u32 v80, v84, 3, v80
    v_lshlrev_b32 v79, 3, v79
    v_lshl_add_u32 v79, v84, 14, v79
    s_add_u32 s80, s4, 0x1800000
    s_addc_u32 s81, s5, 0
    s_mov_b32 s82, 0x400000
    s_mov_b32 s83, 0x20000
    s_mov_b32 s78, 0
    buffer_load_dwordx2 v[110:111], v79, s[80:83], s78 offen sc1
    s_mov_b32 s78, 65536
    buffer_load_dwordx2 v[112:113], v79, s[80:83], s78 offen sc1
    s_mov_b32 s78, 262144
    buffer_load_dwordx2 v[114:115], v79, s[80:83], s78 offen sc1
    s_mov_b32 s78, 327680
    buffer_load_dwordx2 v[116:117], v79, s[80:83], s78 offen sc1
    s_waitcnt vmcnt(0)
    s_barrier
    s_branch NEXT
WLOAD:
    s_mov_b64 s[12:13], s[72:73]
    s_mov_b32 s14, 7340032
    s_mov_b32 s15, 0x20000
    s_and_b32 s35, s30, 1
    s_mul_i32 s38, s29, 448
    s_mul_i32 s41, s35, 229376
    s_add_u32 s38, s38, s41
    s_mul_i32 s41, s35, 14336
    s_add_u32 s41, s41, 49152
    s_mov_b32 s42, 0
    s_mov_b32 s44, s29
    s_add_u32 s44, s44, 1
    s_and_b32 s44, s44, 15
    s_add_u32 s44, s44, 1
    s_and_b32 s44, s44, 15
    s_add_u32 s46, s29, 1
    s_and_b32 s46, s46, 15
    s_cmp_eq_u32 s28, s29
    s_cselect_b32 s47, s46, s28
    s_mov_b32 s42, 57344
    s_call_b64 s[76:77], PREP_w_issue_3
    s_mov_b32 m0, s19
    s_mov_b32 s39, s16
    s_waitcnt vmcnt(0)
    s_and_b32 s53, s30, 3
    s_lshl_b32 s53, s53, 7
    s_add_u32 s53, s53, s55
    s_add_u32 s53, s53, 0x400
    v_mov_b32 v14, 1
    v_mov_b32 v15, 0
    s_mov_b64 exec, 1
    buffer_atomic_add v14, v15, s[56:59], s53 offen sc1
    s_mov_b64 exec, -1
    s_call_b64 s[76:77], SUB_rest_2
    s_waitcnt lgkmcnt(0)
    buffer_load_dwordx4 v121, s[12:15], s39 offen lds
    s_add_u32 m0, m0, 1024
    s_nop 0
    buffer_load_dwordx4 v122, s[12:15], s39 offen lds
    s_add_u32 m0, m0, 1024
    s_nop 0
    buffer_load_dwordx4 v123, s[12:15], s39 offen lds
    s_call_b64 s[76:77], PREP_w_issue_3
    s_add_u32 m0, m0, 1024
    s_nop 0
    buffer_load_dwordx4 v124, s[12:15], s39 offen lds
    s_add_u32 m0, m0, 1024
    s_nop 0
    buffer_load_dwordx4 v125, s[12:15], s39 offen lds
    s_add_u32 m0, m0, 1024
    s_nop 0
    buffer_load_dwordx4 v126, s[12:15], s39 offen lds
    s_add_u32 m0, m0, 1024
    s_nop 0
    buffer_load_dwordx4 v127, s[12:15], s39 offen lds
    s_add_u32 m0, m0, 1024
    s_add_u32 s39, s39, 114688
    buffer_load_dwordx4 v121, s[12:15], s39 offen lds
    s_add_u32 m0, m0, 1024
    s_nop 0
    buffer_load_dwordx4 v122, s[12:15], s39 offen lds
    s_add_u32 m0, m0, 1024
    s_nop 0
    buffer_load_dwordx4 v123, s[12:15], s39 offen lds
    s_add_u32 m0, m0, 1024
    s_nop 0
    buffer_load_dwordx4 v124, s[12:15], s39 offen lds
    s_add_u32 m0, m0, 1024
    s_nop 0
    buffer_load_dwordx4 v125, s[12:15], s39 offen lds
    s_add_u32 m0, m0, 1024
    s_nop 0
    buffer_load_dwordx4 v126, s[12:15], s39 offen lds
    s_add_u32 m0, m0, 1024
    s_nop 0
    buffer_load_dwordx4 v127, s[12:15], s39 offen lds
    s_mov_b32 m0, s19
    s_mov_b32 s39, s16
    s_cmp_lg_u32 s60, 0
    s_cbranch_scc1 cs_58
    s_and_b32 s35, s30, 1
    v_lshrrev_b32 v112, 2, v1
    v_mul_u32_u24 v104, 448, v112
    v_and_b32 v113, 3, v1
    v_lshl_add_u32 v104, v113, 3, v104
    v_add_u32 v104, 49152, v104
    v_mul_u32_u24 v106, 448, v112
    v_and_b32 v113, 2, v1
    v_lshl_add_u32 v106, v113, 2, v106
    v_bfe_u32 v112, v1, 4, 1
    v_and_b32 v113, 1, v1
    v_xor_b32 v113, v113, v112
    v_lshl_add_u32 v106, v113, 5, v106
    s_lshl_b32 s36, s35, 4
    s_add_u32 s36, s36, 49344
    v_add_u32 v106, s36, v106
    s_lshl_b32 s36, s35, 8
    v_add_u32 v104, s36, v104
    v_lshlrev_b32 v112, 5, v112
    v_sub_u32 v105, v104, v112
    v_add_u32 v104, v104, v112
    s_cmp_eq_u32 s28, s29
    s_cselect_b32 s36, 0, 28672
    v_add_u32 v104, s36, v104
    v_add_u32 v105, s36, v105
    v_add_u32 v106, s36, v106
    ds_read_b64_tr_b16 v[48:49], v104 offset:0
    ds_read_b64_tr_b16 v[50:51], v104 offset:7168
    ds_read_b64_tr_b16 v[52:53], v104 offset:14336
    ds_read_b64_tr_b16 v[54:55], v104 offset:21504
    ds_read_b64_tr_b16 v[56:57], v105 offset:32
    ds_read_b64_tr_b16 v[58:59], v105 offset:7200
    ds_read_b64_tr_b16 v[60:61], v105 offset:14368
    ds_read_b64_tr_b16 v[62:63], v105 offset:21536
    ds_read_b64_tr_b16 v[64:65], v104 offset:64
    ds_read_b64_tr_b16 v[66:67], v104 offset:7232
    ds_read_b64_tr_b16 v[68:69], v104 offset:14400
    ds_read_b64_tr_b16 v[70:71], v104 offset:21568
    ds_read_b64_tr_b16 v[72:73], v105 offset:96
    ds_read_b64_tr_b16 v[74:75], v105 offset:7264
    ds_read_b64_tr_b16 v[76:77], v105 offset:14432
    ds_read_b64_tr_b16 v[78:79], v105 offset:21600
    ds_read_b64_tr_b16 v[80:81], v104 offset:128
    ds_read_b64_tr_b16 v[82:83], v104 offset:7296
    ds_read_b64_tr_b16 v[84:85], v104 offset:14464
    ds_read_b64_tr_b16 v[86:87], v104 offset:21632
    ds_read_b64_tr_b16 v[88:89], v105 offset:160
    ds_read_b64_tr_b16 v[90:91], v105 offset:7328
    ds_read_b64_tr_b16 v[92:93], v105 offset:14496
    ds_read_b64_tr_b16 v[94:95], v105 offset:21664
    ds_read_b64_tr_b16 v[96:97], v106 offset:0
    ds_read_b64_tr_b16 v[98:99], v106 offset:7168
    ds_read_b64_tr_b16 v[100:101], v106 offset:14336
    ds_read_b64_tr_b16 v[102:103], v106 offset:21504
    v_and_b32 v112, 15, v1
    v_mov_b32 v113, 0x3f803f80
    v_cmp_eq_u32 vcc, 0, v112
    s_nop 1
    v_cndmask_b32 v20, 0, v113, vcc
    v_cndmask_b32 v21, 0, v113, vcc
    v_cndmask_b32 v22, 0, v113, vcc
    v_cndmask_b32 v23, 0, v113, vcc
    v_cmp_eq_u32 vcc, 1, v112
    s_nop 1
    v_cndmask_b32 v24, 0, v113, vcc
    v_cndmask_b32 v25, 0, v113, vcc
    v_cndmask_b32 v26, 0, v113, vcc
    v_cndmask_b32 v27, 0, v113, vcc
    v_cmp_eq_u32 vcc, 2, v112
    s_nop 1
    v_cndmask_b32 v28, 0, v113, vcc
    v_cndmask_b32 v29, 0, v113, vcc
    v_cndmask_b32 v30, 0, v113, vcc
    v_cndmask_b32 v31, 0, v113, vcc
    v_cmp_eq_u32 vcc, 3, v112
    s_nop 1
    v_cndmask_b32 v32, 0, v113, vcc
    v_cndmask_b32 v33, 0, v113, vcc
    v_cndmask_b32 v34, 0, v113, vcc
    v_cndmask_b32 v35, 0, v113, vcc
    v_cmp_eq_u32 vcc, 4, v112
    s_nop 1
    v_cndmask_b32 v36, 0, v113, vcc
    v_cndmask_b32 v37, 0, v113, vcc
    v_cndmask_b32 v38, 0, v113, vcc
    v_cndmask_b32 v39, 0, v113, vcc
    v_cmp_eq_u32 vcc, 5, v112
    s_nop 1
    v_cndmask_b32 v40, 0, v113, vcc
    v_cndmask_b32 v41, 0, v113, vcc
    v_cndmask_b32 v42, 0, v113, vcc
    v_cndmask_b32 v43, 0, v113, vcc
    v_cmp_eq_u32 vcc, 6, v112
    s_nop 1
    v_cndmask_b32 v44, 0, v113, vcc
    v_cndmask_b32 v45, 0, v113, vcc
    v_cndmask_b32 v46, 0, v113, vcc
    v_cndmask_b32 v47, 0, v113, vcc
    v_and_b32 v114, 48, v1
    v_lshl_add_u32 v114, v112, 6, v114
    v_mov_b32 v113, 0x7f000000
    v_cmp_gt_u32 vcc, 7, v112
    s_nop 1
    v_cndmask_b32 v114, v113, v114, vcc
    s_add_u32 s20, s4, 0x1420000
    s_addc_u32 s21, s5, 0
    s_mov_b32 s22, 0x38000
    s_mov_b32 s23, 0x20000
    s_mul_i32 s36, s28, 14336
    s_lshl1_add_u32 s35, s29, s35
    s_mul_i32 s35, s35, 448
    s_add_u32 s35, s35, s36
    s_waitcnt lgkmcnt(0)
    v_mfma_f32_16x16x32_bf16 v[108:111], v[48:51], v[20:23], 0
    v_mfma_f32_16x16x32_bf16 v[108:111], v[52:55], v[20:23], v[108:111]
    v_mfma_f32_16x16x32_bf16 v[108:111], v[56:59], v[24:27], v[108:111]
    v_mfma_f32_16x16x32_bf16 v[108:111], v[60:63], v[24:27], v[108:111]
    v_mfma_f32_16x16x32_bf16 v[108:111], v[64:67], v[28:31], v[108:111]
    v_mfma_f32_16x16x32_bf16 v[108:111], v[68:71], v[28:31], v[108:111]
    v_mfma_f32_16x16x32_bf16 v[108:111], v[72:75], v[32:35], v[108:111]
    v_mfma_f32_16x16x32_bf16 v[108:111], v[76:79], v[32:35], v[108:111]
    v_mfma_f32_16x16x32_bf16 v[108:111], v[80:83], v[36:39], v[108:111]
    v_mfma_f32_16x16x32_bf16 v[108:111], v[84:87], v[36:39], v[108:111]
    v_mfma_f32_16x16x32_bf16 v[108:111], v[88:91], v[40:43], v[108:111]
    v_mfma_f32_16x16x32_bf16 v[108:111], v[92:95], v[40:43], v[108:111]
    v_mfma_f32_16x16x32_bf16 v[108:111], v[96:99], v[44:47], v[108:111]
    v_mfma_f32_16x16x32_bf16 v[108:111], v[100:103], v[44:47], v[108:111]
    s_nop 7
    buffer_store_dwordx4 v[108:111], v114, s[20:23], s35 offen sc1
cs_58:
    s_waitcnt vmcnt(15)
    s_barrier
    buffer_load_dwordx4 v121, s[12:15], s39 offen lds
    s_add_u32 m0, m0, 1024
    s_nop 0
    buffer_load_dwordx4 v122, s[12:15], s39 offen lds
    s_add_u32 m0, m0, 1024
    s_nop 0
    buffer_load_dwordx4 v123, s[12:15], s39 offen lds
    s_call_b64 s[76:77], PREP_w_issue_3
    s_add_u32 m0, m0, 1024
    s_nop 0
    buffer_load_dwordx4 v124, s[12:15], s39 offen lds
    s_add_u32 m0, m0, 1024
    s_nop 0
    buffer_load_dwordx4 v125, s[12:15], s39 offen lds
    s_add_u32 m0, m0, 1024
    s_nop 0
    buffer_load_dwordx4 v126, s[12:15], s39 offen lds
    s_add_u32 m0, m0, 1024
    s_nop 0
    buffer_load_dwordx4 v127, s[12:15], s39 offen lds
    s_add_u32 m0, m0, 1024
    s_add_u32 s39, s39, 114688
    buffer_load_dwordx4 v121, s[12:15], s39 offen lds
    s_add_u32 m0, m0, 1024
    s_nop 0
    buffer_load_dwordx4 v122, s[12:15], s39 offen lds
    s_add_u32 m0, m0, 1024
    s_nop 0
    buffer_load_dwordx4 v123, s[12:15], s39 offen lds
    s_add_u32 m0, m0, 1024
    s_nop 0
    buffer_load_dwordx4 v124, s[12:15], s39 offen lds
    s_add_u32 m0, m0, 1024
    s_nop 0
    buffer_load_dwordx4 v125, s[12:15], s39 offen lds
    s_add_u32 m0, m0, 1024
    s_nop 0
    buffer_load_dwordx4 v126, s[12:15], s39 offen lds
    s_add_u32 m0, m0, 1024
    s_nop 0
    buffer_load_dwordx4 v127, s[12:15], s39 offen lds
    s_mov_b32 m0, s19
    s_mov_b32 s39, s16
    s_waitcnt vmcnt(14)
    s_barrier
    buffer_load_dwordx4 v121, s[12:15], s39 offen lds
    s_add_u32 m0, m0, 1024
    s_nop 0
    buffer_load_dwordx4 v122, s[12:15], s39 offen lds
    s_add_u32 m0, m0, 1024
    s_nop 0
    buffer_load_dwordx4 v123, s[12:15], s39 offen lds
    s_call_b64 s[76:77], PREP_w_issue_3
    s_add_u32 m0, m0, 1024
    s_nop 0
    buffer_load_dwordx4 v124, s[12:15], s39 offen lds
    s_add_u32 m0, m0, 1024
    s_nop 0
    buffer_load_dwordx4 v125, s[12:15], s39 offen lds
    s_add_u32 m0, m0, 1024
    s_nop 0
    buffer_load_dwordx4 v126, s[12:15], s39 offen lds
    s_add_u32 m0, m0, 1024
    s_nop 0
    buffer_load_dwordx4 v127, s[12:15], s39 offen lds
    s_add_u32 m0, m0, 1024
    s_add_u32 s39, s39, 114688
    buffer_load_dwordx4 v121, s[12:15], s39 offen lds
    s_add_u32 m0, m0, 1024
    s_nop 0
    buffer_load_dwordx4 v122, s[12:15], s39 offen lds
    s_add_u32 m0, m0, 1024
    s_nop 0
    buffer_load_dwordx4 v123, s[12:15], s39 offen lds
    s_add_u32 m0, m0, 1024
    s_nop 0
    buffer_load_dwordx4 v124, s[12:15], s39 offen lds
    s_add_u32 m0, m0, 1024
    s_nop 0
    buffer_load_dwordx4 v125, s[12:15], s39 offen lds
    s_add_u32 m0, m0, 1024
    s_nop 0
    buffer_load_dwordx4 v126, s[12:15], s39 offen lds
    s_add_u32 m0, m0, 1024
    s_nop 0
    buffer_load_dwordx4 v127, s[12:15], s39 offen lds
    s_mov_b32 m0, s19
    s_mov_b32 s39, s16
    s_waitcnt vmcnt(14)
    s_barrier
    buffer_load_dwordx4 v121, s[12:15], s39 offen lds
    s_add_u32 m0, m0, 1024
    s_nop 0
    buffer_load_dwordx4 v122, s[12:15], s39 offen lds
    s_add_u32 m0, m0, 1024
    s_nop 0
    buffer_load_dwordx4 v123, s[12:15], s39 offen lds
    s_call_b64 s[76:77], PREP_w_issue_3
    s_add_u32 m0, m0, 1024
    s_nop 0
    buffer_load_dwordx4 v124, s[12:15], s39 offen lds
    s_add_u32 m0, m0, 1024
    s_nop 0
    buffer_load_dwordx4 v125, s[12:15], s39 offen lds
    s_add_u32 m0, m0, 1024
    s_nop 0
    buffer_load_dwordx4 v126, s[12:15], s39 offen lds
    s_add_u32 m0, m0, 1024
    s_nop 0
    buffer_load_dwordx4 v127, s[12:15], s39 offen lds
    s_add_u32 m0, m0, 1024
    s_add_u32 s39, s39, 114688
    buffer_load_dwordx4 v121, s[12:15], s39 offen lds
    s_add_u32 m0, m0, 1024
    s_nop 0
    buffer_load_dwordx4 v122, s[12:15], s39 offen lds
    s_add_u32 m0, m0, 1024
    s_nop 0
    buffer_load_dwordx4 v123, s[12:15], s39 offen lds
    s_add_u32 m0, m0, 1024
    s_nop 0
    buffer_load_dwordx4 v124, s[12:15], s39 offen lds
    s_add_u32 m0, m0, 1024
    s_nop 0
    buffer_load_dwordx4 v125, s[12:15], s39 offen lds
    s_add_u32 m0, m0, 1024
    s_nop 0
    buffer_load_dwordx4 v126, s[12:15], s39 offen lds
    s_add_u32 m0, m0, 1024
    s_nop 0
    buffer_load_dwordx4 v127, s[12:15], s39 offen lds
    s_mov_b32 m0, s19
    s_mov_b32 s39, s16
    s_waitcnt vmcnt(28)
    s_cmp_lg_u32 s60, 0
    s_cbranch_scc1 cs_59
    s_and_b32 s36, s30, 1
    s_lshl_b32 s36, s36, 13
    s_lshl_b32 s53, s29, 7
    s_add_u32 s36, s36, s53
    s_add_u32 s36, s36, 23068672
    v_mov_b32 v14, 1
    v_mov_b32 v15, 0
    s_mov_b64 exec, 1
    buffer_atomic_add v14, v15, s[56:59], s36 offen sc1
    s_mov_b64 exec, -1
cs_59:
    s_waitcnt vmcnt(14)
    s_barrier
    buffer_load_dwordx4 v121, s[12:15], s39 offen lds
    s_add_u32 m0, m0, 1024
    s_nop 0
    buffer_load_dwordx4 v122, s[12:15], s39 offen lds
    s_add_u32 m0, m0, 1024
    s_nop 0
    buffer_load_dwordx4 v123, s[12:15], s39 offen lds
    s_mov_b32 s43, 1
ld_60:
    s_add_u32 s19, s41, s42
    s_cmp_eq_u32 s44, s47
    s_cselect_b32 s16, s46, s44
    s_mul_i32 s16, s16, 458752
    s_add_u32 s16, s16, s38
    s_add_u32 s44, s44, 1
    s_and_b32 s44, s44, 15
    s_add_u32 s42, s42, 28672
    s_cmp_eq_u32 s42, 86016
    s_cselect_b32 s42, 0, s42
    s_add_u32 m0, m0, 1024
    s_nop 0
    buffer_load_dwordx4 v124, s[12:15], s39 offen lds
    s_add_u32 m0, m0, 1024
    s_nop 0
    buffer_load_dwordx4 v125, s[12:15], s39 offen lds
    s_add_u32 m0, m0, 1024
    s_nop 0
    buffer_load_dwordx4 v126, s[12:15], s39 offen lds
    s_add_u32 m0, m0, 1024
    s_nop 0
    buffer_load_dwordx4 v127, s[12:15], s39 offen lds
    s_add_u32 m0, m0, 1024
    s_add_u32 s39, s39, 114688
    buffer_load_dwordx4 v121, s[12:15], s39 offen lds
    s_add_u32 m0, m0, 1024
    s_nop 0
    buffer_load_dwordx4 v122, s[12:15], s39 offen lds
    s_add_u32 m0, m0, 1024
    s_nop 0
    buffer_load_dwordx4 v123, s[12:15], s39 offen lds
    s_add_u32 m0, m0, 1024
    s_nop 0
    buffer_load_dwordx4 v124, s[12:15], s39 offen lds
    s_add_u32 m0, m0, 1024
    s_nop 0
    buffer_load_dwordx4 v125, s[12:15], s39 offen lds
    s_add_u32 m0, m0, 1024
    s_nop 0
    buffer_load_dwordx4 v126, s[12:15], s39 offen lds
    s_add_u32 m0, m0, 1024
    s_nop 0
    buffer_load_dwordx4 v127, s[12:15], s39 offen lds
    s_mov_b32 m0, s19
    s_mov_b32 s39, s16
    s_waitcnt vmcnt(14)
    s_barrier
    buffer_load_dwordx4 v121, s[12:15], s39 offen lds
    s_add_u32 m0, m0, 1024
    s_nop 0
    buffer_load_dwordx4 v122, s[12:15], s39 offen lds
    s_add_u32 m0, m0, 1024
    s_nop 0
    buffer_load_dwordx4 v123, s[12:15], s39 offen lds
    s_add_u32 s43, s43, 1
    s_cmp_lt_u32 s43, 9
    s_cbranch_scc1 ld_60
    s_call_b64 s[76:77], PREP_w_issue_3
    s_add_u32 m0, m0, 1024
    s_nop 0
    buffer_load_dwordx4 v124, s[12:15], s39 offen lds
    s_add_u32 m0, m0, 1024
    s_nop 0
    buffer_load_dwordx4 v125, s[12:15], s39 offen lds
    s_add_u32 m0, m0, 1024
    s_nop 0
    buffer_load_dwordx4 v126, s[12:15], s39 offen lds
    s_add_u32 m0, m0, 1024
    s_nop 0
    buffer_load_dwordx4 v127, s[12:15], s39 offen lds
    s_add_u32 m0, m0, 1024
    s_add_u32 s39, s39, 114688
    buffer_load_dwordx4 v121, s[12:15], s39 offen lds
    s_add_u32 m0, m0, 1024
    s_nop 0
    buffer_load_dwordx4 v122, s[12:15], s39 offen lds
    s_add_u32 m0, m0, 1024
    s_nop 0
    buffer_load_dwordx4 v123, s[12:15], s39 offen lds
    s_add_u32 m0, m0, 1024
    s_nop 0
    buffer_load_dwordx4 v124, s[12:15], s39 offen lds
    s_add_u32 m0, m0, 1024
    s_nop 0
    buffer_load_dwordx4 v125, s[12:15], s39 offen lds
    s_add_u32 m0, m0, 1024
    s_nop 0
    buffer_load_dwordx4 v126, s[12:15], s39 offen lds
    s_add_u32 m0, m0, 1024
    s_nop 0
    buffer_load_dwordx4 v127, s[12:15], s39 offen lds
    s_mov_b32 m0, s19
    s_mov_b32 s39, s16
    s_waitcnt vmcnt(14)
    s_barrier
    buffer_load_dwordx4 v121, s[12:15], s39 offen lds
    s_add_u32 m0, m0, 1024
    s_nop 0
    buffer_load_dwordx4 v122, s[12:15], s39 offen lds
    s_add_u32 m0, m0, 1024
    s_nop 0
    buffer_load_dwordx4 v123, s[12:15], s39 offen lds
    s_add_u32 m0, m0, 1024
    s_nop 0
    buffer_load_dwordx4 v124, s[12:15], s39 offen lds
    s_add_u32 m0, m0, 1024
    s_nop 0
    buffer_load_dwordx4 v125, s[12:15], s39 offen lds
    s_add_u32 m0, m0, 1024
    s_nop 0
    buffer_load_dwordx4 v126, s[12:15], s39 offen lds
    s_add_u32 m0, m0, 1024
    s_nop 0
    buffer_load_dwordx4 v127, s[12:15], s39 offen lds
    s_add_u32 m0, m0, 1024
    s_add_u32 s39, s39, 114688
    buffer_load_dwordx4 v121, s[12:15], s39 offen lds
    s_add_u32 m0, m0, 1024
    s_nop 0
    buffer_load_dwordx4 v122, s[12:15], s39 offen lds
    s_add_u32 m0, m0, 1024
    s_nop 0
    buffer_load_dwordx4 v123, s[12:15], s39 offen lds
    s_add_u32 m0, m0, 1024
    s_nop 0
    buffer_load_dwordx4 v124, s[12:15], s39 offen lds
    s_add_u32 m0, m0, 1024
    s_nop 0
    buffer_load_dwordx4 v125, s[12:15], s39 offen lds
    s_add_u32 m0, m0, 1024
    s_nop 0
    buffer_load_dwordx4 v126, s[12:15], s39 offen lds
    s_add_u32 m0, m0, 1024
    s_nop 0
    buffer_load_dwordx4 v127, s[12:15], s39 offen lds
    s_waitcnt vmcnt(14)
    s_barrier
    s_waitcnt vmcnt(0)
    s_barrier
    s_barrier
    s_mov_b64 s[12:13], s[74:75]
    s_mov_b32 s14, 7340032
    s_mov_b32 s15, 0x20000
    s_and_b32 s35, s30, 1
    s_mul_i32 s38, s33, 256
    s_mul_i32 s41, s31, 3670016
    s_add_u32 s38, s38, s41
    s_mul_i32 s41, s35, 8192
    s_add_u32 s41, s41, 49152
    s_mov_b32 s42, 0
    s_mov_b32 s44, 0
    s_mov_b32 s49, s44
    s_and_b32 s43, s28, 0
    s_mul_i32 s43, s43, 6
    s_lshr_b32 s43, s43, 2
    s_mov_b32 s50, 0
wpre_61:
    s_mul_i32 s42, s43, 16384
    s_add_u32 s44, s49, s43
    s_add_u32 s19, s41, s42
    s_and_b32 s40, s30, 1
    s_lshl_b32 s45, s44, 1
    s_add_u32 s45, s45, s40
    s_sub_u32 s45, s45, 32
    s_mul_i32 s46, s45, 86
    s_lshr_b32 s46, s46, 8
    s_mul_i32 s47, s46, 3
    s_sub_u32 s47, s45, s47
    s_lshl_b32 s47, s47, 2
    s_lshr_b32 s47, 0x362, s47
    s_and_b32 s47, s47, 7
    s_cmp_ge_u32 s44, 10
    s_cselect_b32 s45, 9, 2
    s_cselect_b32 s51, 1, 0
    s_sub_u32 s45, s44, s45
    s_cmp_lt_u32 s44, 3
    s_cselect_b32 s45, 0, s45
    s_cselect_b32 s51, s44, s51
    s_lshl2_add_u32 s51, s40, s51
    s_cmp_lt_u32 s44, 17
    s_cselect_b32 s47, s51, s47
    s_cselect_b32 s46, s45, s46
    s_add_u32 s46, s46, s33
    s_and_b32 s46, s46, 7
    s_mul_i32 s46, s46, 7
    s_add_u32 s16, s46, s47
    s_mul_i32 s16, s16, 65536
    s_add_u32 s16, s16, s38
    s_add_u32 s44, s44, 1
    s_add_u32 s42, s42, 16384
    s_cmp_eq_u32 s42, 98304
    s_cselect_b32 s42, 0, s42
    s_mov_b32 m0, s19
    s_mov_b32 s39, s16
    buffer_load_dwordx4 v119, s[12:15], s39 offen lds
    s_add_u32 m0, m0, 1024
    s_add_u32 s39, s39, 8192
    buffer_load_dwordx4 v120, s[12:15], s39 offen lds
    s_add_u32 m0, m0, 1024
    s_add_u32 s39, s39, 8192
    buffer_load_dwordx4 v119, s[12:15], s39 offen lds
    s_add_u32 m0, m0, 1024
    s_add_u32 s39, s39, 8192
    buffer_load_dwordx4 v120, s[12:15], s39 offen lds
    s_waitcnt vmcnt(8)
    s_add_u32 m0, m0, 1024
    s_add_u32 s39, s39, 8192
    buffer_load_dwordx4 v119, s[12:15], s39 offen lds
    s_add_u32 m0, m0, 1024
    s_add_u32 s39, s39, 8192
    buffer_load_dwordx4 v120, s[12:15], s39 offen lds
    s_add_u32 m0, m0, 1024
    s_add_u32 s39, s39, 8192
    buffer_load_dwordx4 v119, s[12:15], s39 offen lds
    s_add_u32 m0, m0, 1024
    s_add_u32 s39, s39, 8192
    buffer_load_dwordx4 v120, s[12:15], s39 offen lds
    s_waitcnt vmcnt(8)
    s_add_u32 s43, s43, 1
    s_cmp_eq_u32 s43, 6
    s_cselect_b32 s43, 0, s43
    s_add_u32 s50, s50, 1
    s_cmp_lt_u32 s50, 6
    s_cbranch_scc1 wpre_61
    s_mov_b32 s42, 0
    s_add_u32 s44, s49, 6
    s_cmp_eq_u32 s60, 1
    s_cbranch_scc1 WL_t1
    s_call_b64 s[76:77], PREP_w_issue_4
    s_mov_b32 m0, s19
    s_mov_b32 s39, s16
    s_waitcnt vmcnt(40)
    s_barrier
    s_waitcnt vmcnt(32)
    s_barrier
    buffer_load_dwordx4 v119, s[12:15], s39 offen lds
    s_add_u32 m0, m0, 1024
    s_add_u32 s39, s39, 8192
    buffer_load_dwordx4 v120, s[12:15], s39 offen lds
    s_mov_b32 s43, 1
ld_62:
    s_add_u32 s19, s41, s42
    s_and_b32 s40, s30, 1
    s_lshl_b32 s45, s44, 1
    s_add_u32 s45, s45, s40
    s_sub_u32 s45, s45, 32
    s_mul_i32 s46, s45, 86
    s_lshr_b32 s46, s46, 8
    s_mul_i32 s47, s46, 3
    s_sub_u32 s47, s45, s47
    s_lshl_b32 s47, s47, 2
    s_lshr_b32 s47, 0x362, s47
    s_and_b32 s47, s47, 7
    s_cmp_ge_u32 s44, 10
    s_cselect_b32 s45, 9, 2
    s_cselect_b32 s51, 1, 0
    s_sub_u32 s45, s44, s45
    s_cmp_lt_u32 s44, 3
    s_cselect_b32 s45, 0, s45
    s_cselect_b32 s51, s44, s51
    s_lshl2_add_u32 s51, s40, s51
    s_cmp_lt_u32 s44, 17
    s_cselect_b32 s47, s51, s47
    s_cselect_b32 s46, s45, s46
    s_add_u32 s46, s46, s33
    s_and_b32 s46, s46, 7
    s_mul_i32 s46, s46, 7
    s_add_u32 s16, s46, s47
    s_mul_i32 s16, s16, 65536
    s_add_u32 s16, s16, s38
    s_add_u32 s44, s44, 1
    s_add_u32 s42, s42, 16384
    s_cmp_eq_u32 s42, 98304
    s_cselect_b32 s42, 0, s42
    s_add_u32 m0, m0, 1024
    s_add_u32 s39, s39, 8192
    buffer_load_dwordx4 v119, s[12:15], s39 offen lds
    s_add_u32 m0, m0, 1024
    s_add_u32 s39, s39, 8192
    buffer_load_dwordx4 v120, s[12:15], s39 offen lds
    s_add_u32 m0, m0, 1024
    s_add_u32 s39, s39, 8192
    buffer_load_dwordx4 v119, s[12:15], s39 offen lds
    s_add_u32 m0, m0, 1024
    s_add_u32 s39, s39, 8192
    buffer_load_dwordx4 v120, s[12:15], s39 offen lds
    s_add_u32 m0, m0, 1024
    s_add_u32 s39, s39, 8192
    buffer_load_dwordx4 v119, s[12:15], s39 offen lds
    s_add_u32 m0, m0, 1024
    s_add_u32 s39, s39, 8192
    buffer_load_dwordx4 v120, s[12:15], s39 offen lds
    s_mov_b32 m0, s19
    s_mov_b32 s39, s16
    s_waitcnt vmcnt(32)
    s_barrier
    buffer_load_dwordx4 v119, s[12:15], s39 offen lds
    s_add_u32 m0, m0, 1024
    s_add_u32 s39, s39, 8192
    buffer_load_dwordx4 v120, s[12:15], s39 offen lds
    s_add_u32 s43, s43, 1
    s_cmp_lt_u32 s43, 21
    s_cbranch_scc1 ld_62
    s_call_b64 s[76:77], PREP_w_issue_4
    s_add_u32 m0, m0, 1024
    s_add_u32 s39, s39, 8192
    buffer_load_dwordx4 v119, s[12:15], s39 offen lds
    s_add_u32 m0, m0, 1024
    s_add_u32 s39, s39, 8192
    buffer_load_dwordx4 v120, s[12:15], s39 offen lds
    s_add_u32 m0, m0, 1024
    s_add_u32 s39, s39, 8192
    buffer_load_dwordx4 v119, s[12:15], s39 offen lds
    s_add_u32 m0, m0, 1024
    s_add_u32 s39, s39, 8192
    buffer_load_dwordx4 v120, s[12:15], s39 offen lds
    s_add_u32 m0, m0, 1024
    s_add_u32 s39, s39, 8192
    buffer_load_dwordx4 v119, s[12:15], s39 offen lds
    s_add_u32 m0, m0, 1024
    s_add_u32 s39, s39, 8192
    buffer_load_dwordx4 v120, s[12:15], s39 offen lds
    s_mov_b32 m0, s19
    s_mov_b32 s39, s16
    s_waitcnt vmcnt(32)
    s_barrier
    buffer_load_dwordx4 v119, s[12:15], s39 offen lds
    s_add_u32 m0, m0, 1024
    s_add_u32 s39, s39, 8192
    buffer_load_dwordx4 v120, s[12:15], s39 offen lds
    s_add_u32 m0, m0, 1024
    s_add_u32 s39, s39, 8192
    buffer_load_dwordx4 v119, s[12:15], s39 offen lds
    s_add_u32 m0, m0, 1024
    s_add_u32 s39, s39, 8192
    buffer_load_dwordx4 v120, s[12:15], s39 offen lds
    s_add_u32 m0, m0, 1024
    s_add_u32 s39, s39, 8192
    buffer_load_dwordx4 v119, s[12:15], s39 offen lds
    s_add_u32 m0, m0, 1024
    s_add_u32 s39, s39, 8192
    buffer_load_dwordx4 v120, s[12:15], s39 offen lds
    s_add_u32 m0, m0, 1024
    s_add_u32 s39, s39, 8192
    buffer_load_dwordx4 v119, s[12:15], s39 offen lds
    s_add_u32 m0, m0, 1024
    s_add_u32 s39, s39, 8192
    buffer_load_dwordx4 v120, s[12:15], s39 offen lds
    s_waitcnt vmcnt(32)
    s_barrier
    s_mov_b64 s[12:13], s[68:69]
    s_mov_b32 s14, 2097152
    s_mov_b32 s15, 0x20000
    s_and_b32 s35, s30, 1
    s_mul_i32 s38, s29, 128
    s_xor_b32 s38, s38, 128
    s_mul_i32 s41, s35, 65536
    s_add_u32 s38, s38, s41
    s_mul_i32 s41, s35, 4096
    s_mov_b32 s42, 0
    s_mov_b32 s44, 0
    s_mov_b32 s42, 114688
    s_add_u32 s44, s67, 3
    s_and_b32 s44, s44, 7
    s_or_b32 s44, s44, 8
    s_call_b64 s[76:77], SUB_w_issue_1
    s_mov_b32 s42, 122880
    s_add_u32 s44, s67, 4
    s_and_b32 s44, s44, 7
    s_or_b32 s44, s44, 8
    s_call_b64 s[76:77], SUB_w_issue_1
    s_mov_b32 s42, 147456
    s_add_u32 s44, s67, 7
    s_and_b32 s44, s44, 7
    s_or_b32 s44, s44, 8
    s_call_b64 s[76:77], SUB_w_issue_1
    s_waitcnt vmcnt(36)
    s_barrier
    s_mov_b32 s42, 131072
    s_add_u32 s44, s67, 5
    s_and_b32 s44, s44, 7
    s_or_b32 s44, s44, 8
    s_call_b64 s[76:77], SUB_w_issue_1
    s_mov_b32 s42, 139264
    s_add_u32 s44, s67, 6
    s_and_b32 s44, s44, 7
    s_or_b32 s44, s44, 8
    s_call_b64 s[76:77], SUB_w_issue_1
    s_waitcnt vmcnt(36)
    s_barrier
    s_mov_b32 s42, 49152
    s_add_u32 s44, s67, 3
    s_and_b32 s44, s44, 7
    s_call_b64 s[76:77], SUB_w_issue_1
    s_mov_b32 s42, 57344
    s_add_u32 s44, s67, 4
    s_and_b32 s44, s44, 7
    s_call_b64 s[76:77], SUB_w_issue_1
    s_waitcnt vmcnt(36)
    s_barrier
    s_mov_b32 s42, 65536
    s_add_u32 s44, s67, 5
    s_and_b32 s44, s44, 7
    s_call_b64 s[76:77], SUB_w_issue_1
    s_mov_b32 s42, 73728
    s_add_u32 s44, s67, 6
    s_and_b32 s44, s44, 7
    s_call_b64 s[76:77], SUB_w_issue_1
    s_mov_b32 s42, 24576
    s_add_u32 s44, s67, 0
    s_and_b32 s44, s44, 7
    s_call_b64 s[76:77], SUB_w_issue_1
    s_waitcnt vmcnt(40)
    s_barrier
    v_and_b32 v81, 7, v0
    v_lshrrev_b32 v84, 6, v0
    v_lshlrev_b32 v84, 4, v84
    v_bfe_u32 v85, v0, 3, 3
    v_add_u32 v84, v84, v85
    s_lshr_b32 s78, s29, 1
    s_lshl_b32 s78, s78, 16
    s_and_b32 s79, s29, 1
    s_lshl_b32 s79, s79, 7
    s_add_u32 s78, s78, s79
    s_lshr_b32 s79, s30, 1
    s_lshl_b32 s79, s79, 13
    s_add_u32 s78, s78, s79
    v_lshlrev_b32 v78, 8, v84
    v_lshl_add_u32 v78, v81, 4, v78
    v_add_u32 v78, s78, v78
    s_lshl_b32 s78, s28, 7
    s_lshl_b32 s79, s29, 3
    s_add_u32 s78, s78, s79
    v_add_u32 v79, s78, v81
    v_lshlrev_b32 v80, 11, v79
    v_and_b32 v85, 3, v79
    v_lshrrev_b32 v82, 2, v79
    v_lshlrev_b32 v82, 14, v82
    v_lshl_add_u32 v82, v85, 11, v82
    v_lshl_add_u32 v82, v84, 4, v82
    v_lshrrev_b32 v85, 2, v84
    v_lshlrev_b32 v85, 3, v85
    v_and_b32 v84, 3, v84
    v_add_u32 v84, v84, v85
    v_lshl_add_u32 v80, v84, 3, v80
    v_lshlrev_b32 v79, 3, v79
    v_lshl_add_u32 v79, v84, 14, v79
    s_add_u32 s80, s4, 0x1800000
    s_addc_u32 s81, s5, 0
    s_mov_b32 s82, 0x400000
    s_mov_b32 s83, 0x20000
    s_mov_b32 s78, 0
    buffer_load_dwordx2 v[110:111], v79, s[80:83], s78 offen sc1
    s_mov_b32 s78, 65536
    buffer_load_dwordx2 v[112:113], v79, s[80:83], s78 offen sc1
    s_mov_b32 s78, 262144
    buffer_load_dwordx2 v[114:115], v79, s[80:83], s78 offen sc1
    s_mov_b32 s78, 327680
    buffer_load_dwordx2 v[116:117], v79, s[80:83], s78 offen sc1
    s_waitcnt vmcnt(0)
    s_barrier
    s_branch NEXT
WL_t1:
    s_call_b64 s[76:77], PREP_w_issue_4
    s_mov_b32 m0, s19
    s_mov_b32 s39, s16
    s_waitcnt vmcnt(40)
    s_barrier
    s_waitcnt vmcnt(32)
    s_barrier
    s_waitcnt vmcnt(24)
    s_barrier
    s_waitcnt vmcnt(16)
    s_barrier
    s_waitcnt vmcnt(8)
    s_barrier
    buffer_load_dwordx4 v119, s[12:15], s39 offen lds
    s_add_u32 m0, m0, 1024
    s_add_u32 s39, s39, 8192
    buffer_load_dwordx4 v120, s[12:15], s39 offen lds
    s_mov_b32 s43, 1
ld_63:
    s_add_u32 s19, s41, s42
    s_and_b32 s40, s30, 1
    s_lshl_b32 s45, s44, 1
    s_add_u32 s45, s45, s40
    s_sub_u32 s45, s45, 32
    s_mul_i32 s46, s45, 86
    s_lshr_b32 s46, s46, 8
    s_mul_i32 s47, s46, 3
    s_sub_u32 s47, s45, s47
    s_lshl_b32 s47, s47, 2
    s_lshr_b32 s47, 0x362, s47
    s_and_b32 s47, s47, 7
    s_cmp_ge_u32 s44, 10
    s_cselect_b32 s45, 9, 2
    s_cselect_b32 s51, 1, 0
    s_sub_u32 s45, s44, s45
    s_cmp_lt_u32 s44, 3
    s_cselect_b32 s45, 0, s45
    s_cselect_b32 s51, s44, s51
    s_lshl2_add_u32 s51, s40, s51
    s_cmp_lt_u32 s44, 17
    s_cselect_b32 s47, s51, s47
    s_cselect_b32 s46, s45, s46
    s_add_u32 s46, s46, s33
    s_and_b32 s46, s46, 7
    s_mul_i32 s46, s46, 7
    s_add_u32 s16, s46, s47
    s_mul_i32 s16, s16, 65536
    s_add_u32 s16, s16, s38
    s_add_u32 s44, s44, 1
    s_add_u32 s42, s42, 16384
    s_cmp_eq_u32 s42, 98304
    s_cselect_b32 s42, 0, s42
    s_add_u32 m0, m0, 1024
    s_add_u32 s39, s39, 8192
    buffer_load_dwordx4 v119, s[12:15], s39 offen lds
    s_add_u32 m0, m0, 1024
    s_add_u32 s39, s39, 8192
    buffer_load_dwordx4 v120, s[12:15], s39 offen lds
    s_add_u32 m0, m0, 1024
    s_add_u32 s39, s39, 8192
    buffer_load_dwordx4 v119, s[12:15], s39 offen lds
    s_add_u32 m0, m0, 1024
    s_add_u32 s39, s39, 8192
    buffer_load_dwordx4 v120, s[12:15], s39 offen lds
    s_add_u32 m0, m0, 1024
    s_add_u32 s39, s39, 8192
    buffer_load_dwordx4 v119, s[12:15], s39 offen lds
    s_add_u32 m0, m0, 1024
    s_add_u32 s39, s39, 8192
    buffer_load_dwordx4 v120, s[12:15], s39 offen lds
    s_mov_b32 m0, s19
    s_mov_b32 s39, s16
    s_waitcnt vmcnt(8)
    s_barrier
    buffer_load_dwordx4 v119, s[12:15], s39 offen lds
    s_add_u32 m0, m0, 1024
    s_add_u32 s39, s39, 8192
    buffer_load_dwordx4 v120, s[12:15], s39 offen lds
    s_add_u32 s43, s43, 1
    s_cmp_lt_u32 s43, 21
    s_cbranch_scc1 ld_63
    s_call_b64 s[76:77], PREP_w_issue_4
    s_add_u32 m0, m0, 1024
    s_add_u32 s39, s39, 8192
    buffer_load_dwordx4 v119, s[12:15], s39 offen lds
    s_add_u32 m0, m0, 1024
    s_add_u32 s39, s39, 8192
    buffer_load_dwordx4 v120, s[12:15], s39 offen lds
    s_add_u32 m0, m0, 1024
    s_add_u32 s39, s39, 8192
    buffer_load_dwordx4 v119, s[12:15], s39 offen lds
    s_add_u32 m0, m0, 1024
    s_add_u32 s39, s39, 8192
    buffer_load_dwordx4 v120, s[12:15], s39 offen lds
    s_add_u32 m0, m0, 1024
    s_add_u32 s39, s39, 8192
    buffer_load_dwordx4 v119, s[12:15], s39 offen lds
    s_add_u32 m0, m0, 1024
    s_add_u32 s39, s39, 8192
    buffer_load_dwordx4 v120, s[12:15], s39 offen lds
    s_mov_b32 m0, s19
    s_mov_b32 s39, s16
    s_waitcnt vmcnt(8)
    s_barrier
    buffer_load_dwordx4 v119, s[12:15], s39 offen lds
    s_add_u32 m0, m0, 1024
    s_add_u32 s39, s39, 8192
    buffer_load_dwordx4 v120, s[12:15], s39 offen lds
    s_add_u32 m0, m0, 1024
    s_add_u32 s39, s39, 8192
    buffer_load_dwordx4 v119, s[12:15], s39 offen lds
    s_add_u32 m0, m0, 1024
    s_add_u32 s39, s39, 8192
    buffer_load_dwordx4 v120, s[12:15], s39 offen lds
    s_add_u32 m0, m0, 1024
    s_add_u32 s39, s39, 8192
    buffer_load_dwordx4 v119, s[12:15], s39 offen lds
    s_add_u32 m0, m0, 1024
    s_add_u32 s39, s39, 8192
    buffer_load_dwordx4 v120, s[12:15], s39 offen lds
    s_add_u32 m0, m0, 1024
    s_add_u32 s39, s39, 8192
    buffer_load_dwordx4 v119, s[12:15], s39 offen lds
    s_add_u32 m0, m0, 1024
    s_add_u32 s39, s39, 8192
    buffer_load_dwordx4 v120, s[12:15], s39 offen lds
    s_waitcnt vmcnt(8)
    s_barrier
    s_waitcnt vmcnt(0)
    s_barrier
    s_branch K_fin
NEXT:
    s_setprio 0
    s_add_u32 s60, s60, 1
    s_add_u32 s55, s55, 67108864
    s_add_u32 s62, s62, 67108864
    s_addc_u32 s63, s63, 0
    s_branch LAYER
K_fin:
    s_endpgm
SUB_w3_sub_3:
    s_mov_b64 s[8:9], s[72:73]
    s_mov_b32 s10, 7340032
    s_mov_b32 s11, 0x20000
    s_add_u32 s36, s29, s88
    s_and_b32 s36, s36, 15
    s_cmp_lg_u32 s28, s29
    s_cselect_b32 s89, s88, 0
    s_cmp_eq_u32 s89, 1
    s_cselect_b32 s36, s28, s36
    s_and_b32 s89, s30, 3
    s_lshl2_add_u32 s36, s36, s89
    s_mul_i32 s90, s36, 114688
    s_mul_i32 s36, s29, 448
    s_add_u32 s90, s90, s36
    s_lshl2_add_u32 s89, s88, s89
    s_mul_i32 s89, s89, 7168
    s_add_u32 m0, s89, 49152
    s_nop 0
    buffer_load_dwordx4 v121, s[8:11], s90 offen lds
    s_add_u32 m0, m0, 1024
    s_nop 0
    buffer_load_dwordx4 v122, s[8:11], s90 offen lds
    s_add_u32 m0, m0, 1024
    s_nop 0
    buffer_load_dwordx4 v123, s[8:11], s90 offen lds
    s_add_u32 m0, m0, 1024
    s_nop 0
    buffer_load_dwordx4 v124, s[8:11], s90 offen lds
    s_add_u32 m0, m0, 1024
    s_nop 0
    buffer_load_dwordx4 v125, s[8:11], s90 offen lds
    s_add_u32 m0, m0, 1024
    s_nop 0
    buffer_load_dwordx4 v126, s[8:11], s90 offen lds
    s_add_u32 m0, m0, 1024
    s_nop 0
    buffer_load_dwordx4 v127, s[8:11], s90 offen lds
    s_setpc_b64 s[76:77]
PREP_a_issue_3:
    s_add_u32 s19, s41, s42
    s_cmp_eq_u32 s44, s47
    s_cselect_b32 s16, s46, s44
    s_cmp_eq_u32 s44, s46
    s_cselect_b32 s16, s47, s16
    s_lshr_b32 s45, s16, 2
    s_lshl_b32 s45, s45, 14
    s_and_b32 s16, s16, 3
    s_lshl_b32 s16, s16, 11
    s_add_u32 s16, s16, s45
    s_add_u32 s16, s16, s38
    s_add_u32 s44, s44, 1
    s_and_b32 s44, s44, 15
    s_add_u32 s42, s42, 16384
    s_cmp_eq_u32 s42, 49152
    s_cselect_b32 s42, 0, s42
    s_setpc_b64 s[76:77]
SUB_rest_2:
    v_lshlrev_b32 v108, 16, v20
    v_and_b32 v109, 0xffff0000, v20
    v_lshlrev_b32 v110, 16, v21
    v_and_b32 v111, 0xffff0000, v21
    v_lshlrev_b32 v112, 16, v22
    v_and_b32 v113, 0xffff0000, v22
    v_lshlrev_b32 v114, 16, v23
    v_and_b32 v115, 0xffff0000, v23
    v_pk_add_f32 v[24:25], v[108:109], v[110:111]
    v_pk_mul_f32 v[26:27], v[108:109], v[108:109]
    v_pk_fma_f32 v[26:27], v[110:111], v[110:111], v[26:27]
    v_pk_add_f32 v[24:25], v[24:25], v[112:113]
    v_pk_fma_f32 v[26:27], v[112:113], v[112:113], v[26:27]
    v_pk_add_f32 v[24:25], v[24:25], v[114:115]
    v_pk_fma_f32 v[26:27], v[114:115], v[114:115], v[26:27]
    v_add_f32 v100, v24, v25
    v_add_f32 v101, v26, v27
    v_lshlrev_b32 v108, 16, v28
    v_and_b32 v109, 0xffff0000, v28
    v_lshlrev_b32 v110, 16, v29
    v_and_b32 v111, 0xffff0000, v29
    v_lshlrev_b32 v112, 16, v30
    v_and_b32 v113, 0xffff0000, v30
    v_lshlrev_b32 v114, 16, v31
    v_and_b32 v115, 0xffff0000, v31
    v_pk_add_f32 v[32:33], v[108:109], v[110:111]
    v_pk_mul_f32 v[34:35], v[108:109], v[108:109]
    v_pk_fma_f32 v[34:35], v[110:111], v[110:111], v[34:35]
    v_pk_add_f32 v[32:33], v[32:33], v[112:113]
    v_pk_fma_f32 v[34:35], v[112:113], v[112:113], v[34:35]
    v_pk_add_f32 v[32:33], v[32:33], v[114:115]
    v_pk_fma_f32 v[34:35], v[114:115], v[114:115], v[34:35]
    v_add_f32 v102, v32, v33
    v_add_f32 v103, v34, v35
    v_lshlrev_b32 v108, 16, v36
    v_and_b32 v109, 0xffff0000, v36
    v_lshlrev_b32 v110, 16, v37
    v_and_b32 v111, 0xffff0000, v37
    v_lshlrev_b32 v112, 16, v38
    v_and_b32 v113, 0xffff0000, v38
    v_lshlrev_b32 v114, 16, v39
    v_and_b32 v115, 0xffff0000, v39
    v_pk_add_f32 v[40:41], v[108:109], v[110:111]
    v_pk_mul_f32 v[42:43], v[108:109], v[108:109]
    v_pk_fma_f32 v[42:43], v[110:111], v[110:111], v[42:43]
    v_pk_add_f32 v[40:41], v[40:41], v[112:113]
    v_pk_fma_f32 v[42:43], v[112:113], v[112:113], v[42:43]
    v_pk_add_f32 v[40:41], v[40:41], v[114:115]
    v_pk_fma_f32 v[42:43], v[114:115], v[114:115], v[42:43]
    v_add_f32 v104, v40, v41
    v_add_f32 v105, v42, v43
    v_lshlrev_b32 v108, 16, v44
    v_and_b32 v109, 0xffff0000, v44
    v_lshlrev_b32 v110, 16, v45
    v_and_b32 v111, 0xffff0000, v45
    v_lshlrev_b32 v112, 16, v46
    v_and_b32 v113, 0xffff0000, v46
    v_lshlrev_b32 v114, 16, v47
    v_and_b32 v115, 0xffff0000, v47
    v_pk_add_f32 v[48:49], v[108:109], v[110:111]
    v_pk_mul_f32 v[50:51], v[108:109], v[108:109]
    v_pk_fma_f32 v[50:51], v[110:111], v[110:111], v[50:51]
    v_pk_add_f32 v[48:49], v[48:49], v[112:113]
    v_pk_fma_f32 v[50:51], v[112:113], v[112:113], v[50:51]
    v_pk_add_f32 v[48:49], v[48:49], v[114:115]
    v_pk_fma_f32 v[50:51], v[114:115], v[114:115], v[50:51]
    v_add_f32 v106, v48, v49
    v_add_f32 v107, v50, v51
    s_and_b32 s36, s30, 3
    s_lshl_b32 s36, s36, 10
    s_add_u32 s36, s36, 155648
    v_lshlrev_b32 v6, 3, v1
    v_add_u32 v6, s36, v6
    v_permlane32_swap_b32 v100, v102
    v_permlane32_swap_b32 v104, v106
    v_permlane32_swap_b32 v101, v103
    v_permlane32_swap_b32 v105, v107
    v_pk_add_f32 v[100:101], v[100:101], v[102:103]
    v_pk_add_f32 v[104:105], v[104:105], v[106:107]
    ds_write_b64 v6, v[100:101] offset:0
    ds_write_b64 v6, v[104:105] offset:512
    s_setpc_b64 s[76:77]
PREP_a_issue_4:
    s_add_u32 s19, s41, s42
    s_lshl_b32 s45, s44, 1
    s_add_u32 s45, s45, 0
    s_sub_u32 s45, s45, 32
    s_mul_i32 s46, s45, 86
    s_lshr_b32 s46, s46, 8
    s_mul_i32 s47, s46, 3
    s_sub_u32 s47, s45, s47
    s_lshl_b32 s47, s47, 2
    s_lshr_b32 s47, 0x362, s47
    s_and_b32 s47, s47, 7
    s_cmp_ge_u32 s44, 10
    s_cselect_b32 s45, 9, 2
    s_cselect_b32 s51, 1, 0
    s_sub_u32 s45, s44, s45
    s_cmp_lt_u32 s44, 3
    s_cselect_b32 s45, 0, s45
    s_cselect_b32 s51, s44, s51
    s_lshl2_add_u32 s51, 0, s51
    s_cmp_lt_u32 s44, 17
    s_cselect_b32 s47, s51, s47
    s_cselect_b32 s46, s45, s46
    s_add_u32 s46, s46, s33
    s_and_b32 s46, s46, 7
    s_mul_i32 s46, s46, 7
    s_add_u32 s16, s46, s47
    s_lshr_b32 s53, s16, 3
    s_lshl_b32 s53, s53, 14
    s_and_b32 s16, s16, 7
    s_lshl_b32 s16, s16, 10
    s_add_u32 s16, s16, s53
    s_add_u32 s16, s16, s38
    s_lshl_b32 s45, s44, 1
    s_add_u32 s45, s45, 1
    s_sub_u32 s45, s45, 32
    s_mul_i32 s46, s45, 86
    s_lshr_b32 s46, s46, 8
    s_mul_i32 s47, s46, 3
    s_sub_u32 s47, s45, s47
    s_lshl_b32 s47, s47, 2
    s_lshr_b32 s47, 0x362, s47
    s_and_b32 s47, s47, 7
    s_cmp_ge_u32 s44, 10
    s_cselect_b32 s45, 9, 2
    s_cselect_b32 s51, 1, 0
    s_sub_u32 s45, s44, s45
    s_cmp_lt_u32 s44, 3
    s_cselect_b32 s45, 0, s45
    s_cselect_b32 s51, s44, s51
    s_lshl2_add_u32 s51, 1, s51
    s_cmp_lt_u32 s44, 17
    s_cselect_b32 s47, s51, s47
    s_cselect_b32 s46, s45, s46
    s_add_u32 s46, s46, s33
    s_and_b32 s46, s46, 7
    s_mul_i32 s46, s46, 7
    s_add_u32 s17, s46, s47
    s_lshr_b32 s53, s17, 3
    s_lshl_b32 s53, s53, 14
    s_and_b32 s17, s17, 7
    s_lshl_b32 s17, s17, 10
    s_add_u32 s17, s17, s53
    s_add_u32 s17, s17, s38
    s_add_u32 s44, s44, 1
    s_add_u32 s42, s42, 16384
    s_cmp_eq_u32 s42, 49152
    s_cselect_b32 s42, 0, s42
    s_setpc_b64 s[76:77]
PREP_w_issue_3:
    s_add_u32 s19, s41, s42
    s_cmp_eq_u32 s44, s47
    s_cselect_b32 s16, s46, s44
    s_mul_i32 s16, s16, 458752
    s_add_u32 s16, s16, s38
    s_add_u32 s44, s44, 1
    s_and_b32 s44, s44, 15
    s_add_u32 s42, s42, 28672
    s_cmp_eq_u32 s42, 86016
    s_cselect_b32 s42, 0, s42
    s_setpc_b64 s[76:77]
PREP_w_issue_4:
    s_add_u32 s19, s41, s42
    s_and_b32 s40, s30, 1
    s_lshl_b32 s45, s44, 1
    s_add_u32 s45, s45, s40
    s_sub_u32 s45, s45, 32
    s_mul_i32 s46, s45, 86
    s_lshr_b32 s46, s46, 8
    s_mul_i32 s47, s46, 3
    s_sub_u32 s47, s45, s47
    s_lshl_b32 s47, s47, 2
    s_lshr_b32 s47, 0x362, s47
    s_and_b32 s47, s47, 7
    s_cmp_ge_u32 s44, 10
    s_cselect_b32 s45, 9, 2
    s_cselect_b32 s51, 1, 0
    s_sub_u32 s45, s44, s45
    s_cmp_lt_u32 s44, 3
    s_cselect_b32 s45, 0, s45
    s_cselect_b32 s51, s44, s51
    s_lshl2_add_u32 s51, s40, s51
    s_cmp_lt_u32 s44, 17
    s_cselect_b32 s47, s51, s47
    s_cselect_b32 s46, s45, s46
    s_add_u32 s46, s46, s33
    s_and_b32 s46, s46, 7
    s_mul_i32 s46, s46, 7
    s_add_u32 s16, s46, s47
    s_mul_i32 s16, s16, 65536
    s_add_u32 s16, s16, s38
    s_add_u32 s44, s44, 1
    s_add_u32 s42, s42, 16384
    s_cmp_eq_u32 s42, 98304
    s_cselect_b32 s42, 0, s42
    s_setpc_b64 s[76:77]
SUB_w_issue_1:
    s_add_u32 s19, s41, s42
    s_mul_i32 s16, s44, 131072
    s_add_u32 s16, s16, s38
    s_mov_b32 m0, s19
    s_mov_b32 s39, s16
    buffer_load_dwordx4 v118, s[12:15], s39 offen lds
    s_add_u32 m0, m0, 1024
    s_add_u32 s39, s39, 16384
    buffer_load_dwordx4 v118, s[12:15], s39 offen lds
    s_add_u32 m0, m0, 1024
    s_add_u32 s39, s39, 16384
    buffer_load_dwordx4 v118, s[12:15], s39 offen lds
    s_add_u32 m0, m0, 1024
    s_add_u32 s39, s39, 16384
    buffer_load_dwordx4 v118, s[12:15], s39 offen lds
    s_setpc_b64 s[76:77]
K_end:
    s_endpgm
.section .rodata,"a"
.p2align 6
.amdhsa_kernel interleave_layers__ssm_conv_h3__mixer_s_mlp__prompt_kernel
  .amdhsa_next_free_vgpr 256
  .amdhsa_next_free_sgpr 102
  .amdhsa_accum_offset 256
  .amdhsa_group_segment_fixed_size 0
  .amdhsa_kernarg_size 112
  .amdhsa_user_sgpr_count 2
  .amdhsa_user_sgpr_kernarg_segment_ptr 1
  .amdhsa_system_sgpr_workgroup_id_x 1
  .amdhsa_float_denorm_mode_32 3
.end_amdhsa_kernel
```

```asm
; @launch grid=(256,1,1) block=(512,1,1) lds=163840
.amdgcn_target "amdgcn-amd-amdhsa--gfx950"
.text
.globl interleave_layers__ssm_conv_h3__mixer_s_mlp__prompt_kernel
.p2align 8
.type interleave_layers__ssm_conv_h3__mixer_s_mlp__prompt_kernel,@function
interleave_layers__ssm_conv_h3__mixer_s_mlp__prompt_kernel:
    s_cmp_ge_u32 s2, 256
    s_cbranch_scc1 K_end
    s_load_dwordx8 s[8:15], s[0:1], 8
    s_load_dwordx2 s[6:7], s[0:1], 0
    s_load_dwordx8 s[68:75], s[0:1], 56
    s_load_dwordx2 s[4:5], s[0:1], 104
    s_load_dwordx2 s[84:85], s[0:1], 96
    s_memrealtime s[46:47]
    s_load_dwordx2 s[76:77], s[0:1], 40
    v_lshrrev_b32 v1, 6, v0
    s_nop 0
    v_readfirstlane_b32 s30, v1
    s_getpc_b64 s[48:49]
K_pc:
    s_lshr_b32 s36, s2, 3
    s_lshl_b32 s36, s36, 12
    v_lshlrev_b32 v252, 3, v0
    v_add_u32 v252, s36, v252
    v_cmp_gt_u32 vcc, K_end-K_pc-8, v252
    s_nop 0
    s_and_saveexec_b64 s[36:37], vcc
    s_cbranch_execz K_3
    v_mov_b32 v253, s49
    v_add_co_u32 v252, vcc, s48, v252
    s_nop 1
    v_addc_co_u32 v253, vcc, 0, v253, vcc
    global_load_dword v250, v[252:253], off
K_3:
    s_mov_b64 exec, -1
    v_bfe_u32 v8, v0, 4, 2
    v_and_b32 v9, 15, v0
    v_lshlrev_b32 v6, 11, v8
    v_lshlrev_b32 v8, 1, v8
    v_xor_b32 v8, v8, v9
    v_lshl_add_u32 v8, v8, 4, v6
    s_and_b32 s34, s2, 7
    s_lshr_b32 s35, s2, 3
    s_lshl_b32 s36, s35, 17
    s_lshl_b32 s37, s34, 8
    s_add_u32 s36, s36, s37
    s_lshl_b32 s37, s30, 6
    s_and_b32 s38, s37, 128
    s_add_u32 s37, s37, 64
    s_and_b32 s37, s37, 128
    v_xor_b32 v6, s38, v8
    v_xor_b32 v7, s37, v8
    s_lshl_b32 s37, s30, 14
    s_add_u32 s37, s37, s36
    s_add_u32 s38, s37, 8192
    s_lshl_b32 s39, s30, 11
    s_mov_b32 s18, 4194304
    s_mov_b32 s19, 0x20000
    s_mov_b32 s22, s18
    s_mov_b32 s23, s19
    s_add_u32 m0, s39, 99328
    s_waitcnt lgkmcnt(0)
    s_mov_b64 s[16:17], s[8:9]
    s_mov_b64 s[20:21], s[10:11]
    buffer_load_dwordx4 v6, s[16:19], s37 offen nt lds
    s_add_u32 m0, m0, 1024
    s_nop 0
    buffer_load_dwordx4 v7, s[16:19], s38 offen nt lds
    s_add_u32 m0, s39, 115712
    s_nop 0
    buffer_load_dwordx4 v6, s[20:23], s37 offen nt lds
    s_add_u32 m0, m0, 1024
    s_nop 0
    buffer_load_dwordx4 v6, s[20:23], s38 offen nt lds
    s_mov_b32 s86, 256
    s_mov_b32 s87, 0x20000
    v_mov_b32 v10, 0
    s_cmp_lg_u32 s30, 0
    s_cbranch_scc1 KV_t0
    s_sub_u32 s36, s36, 8192
    v_add_u32 v8, s36, v8
    s_mov_b32 m0, 98304
    s_nop 0
    buffer_load_dwordx4 v8, s[16:19], 0 offen nt lds
    s_cmp_lg_u32 s2, 0
    s_cbranch_scc1 KV_t0
    s_lshl_b32 s44, s46, 6
    s_or_b32 s44, s44, 1
    v_mov_b32 v9, s44
    s_mov_b64 exec, 1
    buffer_store_dword v9, v10, s[84:87], 0 offen sc1
    s_mov_b64 exec, -1
KV_t0:
    s_lshl_b32 s37, s34, 10
    s_lshl_b32 s38, s30, 7
    s_add_u32 s37, s37, s38
    v_and_b32 v9, 15, v0
    v_lshlrev_b32 v9, 3, v9
    s_mov_b32 s24, s12
    s_mov_b32 s25, s13
    s_mov_b32 s26, 0x2000
    s_mov_b32 s27, 0x20000
    buffer_load_dwordx2 v[12:13], v9, s[24:27], s37 offen
    v_and_b32 v1, 63, v0
    v_lshlrev_b32 v2, 4, v1
    v_lshlrev_b32 v3, 2, v1
    s_and_b32 s32, s2, 7
    s_lshr_b32 s33, s2, 3
    s_and_b32 s28, s32, 2
    s_lshr_b32 s34, s32, 2
    s_or_b32 s28, s28, s34
    s_lshl_b32 s28, s28, 2
    s_and_b32 s34, s33, 3
    s_add_u32 s28, s28, s34
    s_and_b32 s31, s32, 1
    s_lshr_b32 s33, s33, 2
    s_lshl_b32 s29, s31, 3
    s_add_u32 s29, s29, s33
    s_and_b32 s67, s33, 4
    s_mov_b32 s60, 0
    s_mov_b32 s61, 40000
    s_mov_b32 s52, 0
    s_mov_b32 s55, 0
    s_mov_b32 s92, 0
    s_mov_b32 s93, 0
    s_mov_b32 s94, 0
    s_mov_b32 s56, s4
    s_mov_b32 s57, s5
    s_mov_b32 s58, 0xa000000
    s_mov_b32 s59, 0x20000
    s_add_u32 s62, s4, 33554432
    s_addc_u32 s63, s5, 0
    s_cmp_lg_u32 s30, 4
    s_cbranch_scc1 HB_1
    v_add_u32 v14, 162816, v3
    ds_write_b32 v14, v10
HB_1:
    s_mov_b64 s[88:89], s[70:71]
    s_mov_b32 s90, 2097152
    s_mov_b32 s91, 0x20000
    s_lshl3_add_u32 s36, s2, s30
    s_lshl_b32 s36, s36, 10
    s_mov_b64 s[80:81], s[68:69]
    s_mov_b32 s82, 2097152
    s_mov_b32 s83, 0x20000
    s_mov_b32 s50, s36
    v_lshrrev_b32 v14, 3, v1
    v_lshlrev_b32 v118, 11, v14
    v_and_b32 v14, 6, v14
    v_and_b32 v15, 7, v1
    v_xor_b32 v14, v14, v15
    v_lshl_add_u32 v118, v14, 4, v118
    s_lshl_b32 s48, s29, 7
    s_lshl_b32 s36, s30, 14
    s_add_u32 s48, s48, s36
    s_lshl_b32 s49, s30, 10
    s_add_u32 s48, s48, 1048576
    s_and_b32 s41, s30, 3
    s_and_b32 s38, s2, 7
    s_lshl_b32 s38, s38, 5
    s_lshr_b32 s39, s2, 3
    s_add_u32 s38, s38, s39
    s_lshl_b32 s39, s38, 2
    s_add_u32 s39, s39, s41
    s_mul_i32 s40, s41, 21504
    s_lshl_b32 s36, s39, 12
    s_add_u32 s12, s14, s36
    s_addc_u32 s13, s15, 0
    s_mov_b32 s14, 4096
    s_mov_b32 s15, 0x20000
    s_lshr_b32 s45, s30, 2
    s_lshl_b32 s45, s45, 11
    s_add_u32 s36, s45, 0xffffffc0
    v_add_u32 v22, s36, v2
    v_add_u32 v23, 16, v22
    s_add_u32 s36, s45, 0x3c0
    v_add_u32 v24, s36, v2
    v_add_u32 v25, 16, v24
    s_mov_b32 s36, 4032
    v_add_u32 v26, s36, v2
    v_add_u32 v27, 16, v26
    v_add_u32 v19, s40, v2
    v_add_u32 v20, s45, v19
    s_lshl_b32 s36, s38, 14
    s_add_u32 s36, s36, 25165824
    s_add_u32 s20, s4, s36
    s_addc_u32 s21, s5, 0
    s_mov_b32 s22, 16384
    s_mov_b32 s23, 0x20000
    s_lshl_b32 s36, s30, 6
    v_lshrrev_b32 v94, 2, v1
    v_and_b32 v97, 48, v2
    v_lshl_add_u32 v97, v94, 8, v97
    v_add_u32 v97, s36, v97
    s_lshr_b32 s36, s39, 1
    s_lshl_b32 s36, s36, 2
    s_load_dword s41, s[76:77], s36
    v_and_b32 v100, 15, v1
    v_lshrrev_b32 v101, 4, v1
    v_and_b32 v94, 3, v100
    v_mul_u32_u24 v98, 4160, v94
    v_lshl_add_u32 v98, v101, 4, v98
    v_lshrrev_b32 v94, 2, v100
    v_lshl_add_u32 v98, v94, 3, v98
    v_add_u32 v98, s40, v98
    v_sub_u32 v94, 15, v100
    v_lshlrev_b32 v99, 5, v94
    v_add_u32 v99, s40, v99
    v_lshl_add_u32 v99, v101, 4, v99
    s_lshr_b32 s36, s38, 2
    s_lshl_b32 s36, s36, 12
    s_add_u32 s36, s36, 23330816
    v_lshlrev_b32 v102, 7, v1
    v_add_u32 v102, s36, v102
    v_and_b32 v81, 7, v0
    v_lshrrev_b32 v84, 6, v0
    v_lshlrev_b32 v84, 4, v84
    v_bfe_u32 v85, v0, 3, 3
    v_add_u32 v84, v84, v85
    s_lshr_b32 s78, s29, 1
    s_lshl_b32 s78, s78, 16
    s_and_b32 s79, s29, 1
    s_lshl_b32 s79, s79, 7
    s_add_u32 s78, s78, s79
    s_lshr_b32 s79, s30, 1
    s_lshl_b32 s79, s79, 13
    s_add_u32 s78, s78, s79
    v_lshlrev_b32 v78, 8, v84
    v_lshl_add_u32 v78, v81, 4, v78
    v_add_u32 v78, s78, v78
    s_lshl_b32 s78, s28, 7
    s_lshl_b32 s79, s29, 3
    s_add_u32 s78, s78, s79
    v_add_u32 v79, s78, v81
    v_lshlrev_b32 v80, 11, v79
    v_and_b32 v85, 3, v79
    v_lshrrev_b32 v82, 2, v79
    v_lshlrev_b32 v82, 14, v82
    v_lshl_add_u32 v82, v85, 11, v82
    v_lshl_add_u32 v82, v84, 4, v82
    v_lshrrev_b32 v85, 2, v84
    v_lshlrev_b32 v85, 3, v85
    v_and_b32 v84, 3, v84
    v_add_u32 v84, v84, v85
    v_lshl_add_u32 v80, v84, 3, v80
    v_lshlrev_b32 v79, 3, v79
    v_lshl_add_u32 v79, v84, 14, v79
    s_mov_b32 s8, s6
    s_mov_b32 s9, s7
    s_mov_b32 s10, 0x400000
    s_mov_b32 s11, 0x20000
    v_mov_b32 v60, 0
    v_mov_b32 v61, 0
    v_mov_b32 v62, 0
    v_mov_b32 v63, 0
    s_bfm_b64 exec, 40, 0
    ds_write_b128 v19, v[60:63] offset:20736
    s_mov_b64 exec, -1
    s_and_b32 s34, s2, 7
    s_lshr_b32 s35, s2, 3
    v_bfe_u32 v14, v1, 2, 3
    v_xor_b32 v14, s30, v14
    v_lshlrev_b32 v16, 5, v14
    v_and_b32 v14, 3, v1
    v_lshl_add_u32 v16, v14, 3, v16
    v_bfe_u32 v14, v1, 2, 2
    v_lshl_add_u32 v16, v14, 8, v16
    v_lshrrev_b32 v14, 4, v1
    v_lshl_add_u32 v16, v14, 12, v16
    v_add_u32 v16, 98304, v16
    v_xor_b32 v17, 128, v16
    s_add_u32 s16, s4, 0x1800000
    s_addc_u32 s17, s5, 0
    s_mov_b32 s18, 0x400000
    s_mov_b32 s19, 0x20000
    v_bfe_u32 v18, v1, 2, 2
    v_lshlrev_b32 v18, 14, v18
    v_and_b32 v14, 3, v1
    v_lshl_add_u32 v18, v14, 6, v18
    v_bfe_u32 v14, v1, 4, 1
    v_lshrrev_b32 v15, 5, v1
    v_lshl_add_u32 v14, v14, 1, v15
    v_xor_b32 v14, 3, v14
    v_lshl_add_u32 v18, v14, 4, v18
    s_lshl3_add_u32 s42, s34, s30
    s_lshl_b32 s43, s42, 16
    s_sub_u32 s37, 31, s35
    s_lshl_b32 s37, s37, 9
    s_add_u32 s43, s43, s37
    s_lshl_b32 s44, s42, 5
    s_add_u32 s44, s44, s35
    s_lshl_b32 s44, s44, 7
    s_add_u32 s44, s44, 23330816
    buffer_load_dwordx4 v[28:31], v22, s[12:15], 0 offen nt
    buffer_load_dwordx2 v[32:33], v23, s[12:15], 0 offen nt
    buffer_load_dwordx4 v[34:37], v24, s[12:15], 0 offen nt
    buffer_load_dwordx2 v[38:39], v25, s[12:15], 0 offen nt
    buffer_load_dwordx4 v[40:43], v26, s[12:15], 0 offen nt
    buffer_load_dwordx2 v[44:45], v27, s[12:15], 0 offen nt
    buffer_load_dwordx4 v[240:243], v2, s[88:91], s50 offen
    s_waitcnt vmcnt(7) lgkmcnt(0)
    s_barrier
    ds_read_b64_tr_b16 v[128:129], v16 offset:0
    ds_read_b64_tr_b16 v[130:131], v16 offset:1024
    ds_read_b64_tr_b16 v[132:133], v16 offset:2048
    ds_read_b64_tr_b16 v[134:135], v16 offset:3072
    ds_read_b64_tr_b16 v[136:137], v17 offset:4096
    ds_read_b64_tr_b16 v[138:139], v16 offset:17408
    ds_read_b64_tr_b16 v[140:141], v16 offset:18432
    ds_read_b64_tr_b16 v[142:143], v16 offset:19456
    ds_read_b64_tr_b16 v[144:145], v16 offset:20480
    s_load_dword s52, s[84:85], 0
    v_lshlrev_b32 v46, 16, v12
    v_and_b32 v47, 0xffff0000, v12
    v_lshlrev_b32 v48, 16, v13
    v_and_b32 v49, 0xffff0000, v13
    s_waitcnt lgkmcnt(0)
    v_lshlrev_b32 v146, 16, v128
    v_and_b32 v147, 0xffff0000, v128
    v_lshlrev_b32 v148, 16, v129
    v_and_b32 v149, 0xffff0000, v129
    v_lshlrev_b32 v150, 16, v130
    v_and_b32 v151, 0xffff0000, v130
    v_lshlrev_b32 v152, 16, v131
    v_and_b32 v153, 0xffff0000, v131
    v_lshlrev_b32 v154, 16, v132
    v_and_b32 v155, 0xffff0000, v132
    v_lshlrev_b32 v156, 16, v133
    v_and_b32 v157, 0xffff0000, v133
    v_lshlrev_b32 v158, 16, v134
    v_and_b32 v159, 0xffff0000, v134
    v_lshlrev_b32 v160, 16, v135
    v_and_b32 v161, 0xffff0000, v135
    v_lshlrev_b32 v162, 16, v136
    v_and_b32 v163, 0xffff0000, v136
    v_lshlrev_b32 v164, 16, v137
    v_and_b32 v165, 0xffff0000, v137
    v_mul_f32 v166, v147, v49
    v_mul_f32 v167, v148, v49
    v_mul_f32 v168, v149, v49
    v_mul_f32 v169, v150, v49
    v_mul_f32 v170, v151, v49
    v_mul_f32 v171, v152, v49
    v_mul_f32 v172, v153, v49
    v_mul_f32 v173, v154, v49
    v_mul_f32 v174, v155, v49
    v_mul_f32 v175, v156, v49
    v_mul_f32 v176, v157, v49
    v_mul_f32 v177, v158, v49
    v_mul_f32 v178, v159, v49
    v_mul_f32 v179, v160, v49
    v_mul_f32 v180, v161, v49
    v_mul_f32 v181, v162, v49
    v_fmac_f32 v166, v148, v48
    v_fmac_f32 v167, v149, v48
    v_fmac_f32 v168, v150, v48
    v_fmac_f32 v169, v151, v48
    v_fmac_f32 v170, v152, v48
    v_fmac_f32 v171, v153, v48
    v_fmac_f32 v172, v154, v48
    v_fmac_f32 v173, v155, v48
    v_fmac_f32 v174, v156, v48
    v_fmac_f32 v175, v157, v48
    v_fmac_f32 v176, v158, v48
    v_fmac_f32 v177, v159, v48
    v_fmac_f32 v178, v160, v48
    v_fmac_f32 v179, v161, v48
    v_fmac_f32 v180, v162, v48
    v_fmac_f32 v181, v163, v48
    v_fmac_f32 v166, v149, v47
    v_fmac_f32 v167, v150, v47
    v_fmac_f32 v168, v151, v47
    v_fmac_f32 v169, v152, v47
    v_fmac_f32 v170, v153, v47
    v_fmac_f32 v171, v154, v47
    v_fmac_f32 v172, v155, v47
    v_fmac_f32 v173, v156, v47
    v_fmac_f32 v174, v157, v47
    v_fmac_f32 v175, v158, v47
    v_fmac_f32 v176, v159, v47
    v_fmac_f32 v177, v160, v47
    v_fmac_f32 v178, v161, v47
    v_fmac_f32 v179, v162, v47
    v_fmac_f32 v180, v163, v47
    v_fmac_f32 v181, v164, v47
    v_fmac_f32 v166, v150, v46
    v_fmac_f32 v167, v151, v46
    v_fmac_f32 v168, v152, v46
    v_fmac_f32 v169, v153, v46
    v_fmac_f32 v170, v154, v46
    v_fmac_f32 v171, v155, v46
    v_fmac_f32 v172, v156, v46
    v_fmac_f32 v173, v157, v46
    v_fmac_f32 v174, v158, v46
    v_fmac_f32 v175, v159, v46
    v_fmac_f32 v176, v160, v46
    v_fmac_f32 v177, v161, v46
    v_fmac_f32 v178, v162, v46
    v_fmac_f32 v179, v163, v46
    v_fmac_f32 v180, v164, v46
    v_fmac_f32 v181, v165, v46
    v_lshlrev_b32 v146, 16, v138
    v_and_b32 v147, 0xffff0000, v138
    v_lshlrev_b32 v148, 16, v139
    v_and_b32 v149, 0xffff0000, v139
    v_lshlrev_b32 v150, 16, v140
    v_and_b32 v151, 0xffff0000, v140
    v_lshlrev_b32 v152, 16, v141
    v_and_b32 v153, 0xffff0000, v141
    v_lshlrev_b32 v154, 16, v142
    v_and_b32 v155, 0xffff0000, v142
    v_lshlrev_b32 v156, 16, v143
    v_and_b32 v157, 0xffff0000, v143
    v_lshlrev_b32 v158, 16, v144
    v_and_b32 v159, 0xffff0000, v144
    v_lshlrev_b32 v160, 16, v145
    v_and_b32 v161, 0xffff0000, v145
    v_mul_f32 v166, v166, v146
    v_mul_f32 v167, v167, v147
    v_mul_f32 v168, v168, v148
    v_mul_f32 v169, v169, v149
    v_mul_f32 v170, v170, v150
    v_mul_f32 v171, v171, v151
    v_mul_f32 v172, v172, v152
    v_mul_f32 v173, v173, v153
    v_mul_f32 v174, v174, v154
    v_mul_f32 v175, v175, v155
    v_mul_f32 v176, v176, v156
    v_mul_f32 v177, v177, v157
    v_mul_f32 v178, v178, v158
    v_mul_f32 v179, v179, v159
    v_mul_f32 v180, v180, v160
    v_mul_f32 v181, v181, v161
    v_add_u32 v167, 0x10000, v167
    v_and_b32 v167, 0xfffe0000, v167
    v_add_u32 v169, 0x10000, v169
    v_and_b32 v169, 0xfffe0000, v169
    v_add_u32 v171, 0x10000, v171
    v_and_b32 v171, 0xfffe0000, v171
    v_add_u32 v173, 0x10000, v173
    v_and_b32 v173, 0xfffe0000, v173
    v_add_u32 v175, 0x10000, v175
    v_and_b32 v175, 0xfffe0000, v175
    v_add_u32 v177, 0x10000, v177
    v_and_b32 v177, 0xfffe0000, v177
    v_add_u32 v179, 0x10000, v179
    v_and_b32 v179, 0xfffe0000, v179
    v_add_u32 v181, 0x10000, v181
    v_and_b32 v181, 0xfffe0000, v181
    v_cvt_pk_bf16_f32 v52, v173, v172
    v_cvt_pk_bf16_f32 v53, v171, v170
    v_cvt_pk_bf16_f32 v54, v169, v168
    v_cvt_pk_bf16_f32 v55, v167, v166
    v_cvt_pk_bf16_f32 v56, v181, v180
    v_cvt_pk_bf16_f32 v57, v179, v178
    v_cvt_pk_bf16_f32 v58, v177, v176
    v_cvt_pk_bf16_f32 v59, v175, v174
    s_cmp_lg_u32 s52, 0
    s_cbranch_scc1 HB_q
    s_mov_b32 s53, 0
HB_p:
    buffer_load_dword v14, v10, s[84:87], 0 offen sc1
    s_waitcnt vmcnt(0)
    v_readfirstlane_b32 s52, v14
    s_nop 0
    s_cmp_lg_u32 s52, 0
    s_cbranch_scc1 HB_q
    s_add_u32 s53, s53, 1
    s_cmp_lt_u32 s53, s61
    s_cbranch_scc1 HB_p
    s_mov_b32 s52, 1
    s_mov_b32 s61, 0
HB_q:
    v_permlane32_swap_b32 v52, v56
    v_permlane32_swap_b32 v53, v57
    v_permlane32_swap_b32 v54, v58
    v_permlane32_swap_b32 v55, v59
    v_mov_b32 v14, s52
    buffer_store_dwordx4 v[52:55], v18, s[16:19], s43 offen offset:256 sc1
    buffer_store_dwordx4 v[56:59], v18, s[16:19], s43 offen offset:0 sc1
    s_lshl_b32 s37, s42, 7
    s_lshl_b32 s53, s35, 13
    s_add_u32 s37, s37, s53
    s_add_u32 s37, s37, 23592960
    s_cmp_ge_u32 s35, 16
    s_cbranch_scc1 KV_ni
    s_mov_b64 exec, 1
    buffer_store_dword v14, v10, s[56:59], s37 offen sc1
    s_mov_b64 exec, -1
KV_ni:
    s_waitcnt vmcnt(3)
    v_alignbit_b32 v128, v29, v28, 16
    v_mov_b32 v132, v29
    v_alignbit_b32 v136, v30, v29, 16
    v_alignbit_b32 v129, v30, v29, 16
    v_mov_b32 v133, v30
    v_alignbit_b32 v137, v31, v30, 16
    v_alignbit_b32 v130, v31, v30, 16
    v_mov_b32 v134, v31
    v_alignbit_b32 v138, v32, v31, 16
    v_alignbit_b32 v131, v32, v31, 16
    v_mov_b32 v135, v32
    v_alignbit_b32 v139, v33, v32, 16
    ds_write_b128 v20, v[128:131] offset:0
    ds_write_b128 v20, v[132:135] offset:4160
    ds_write_b128 v20, v[136:139] offset:8320
    ds_write_b128 v20, v[30:33] offset:12480
    s_waitcnt vmcnt(0)
    s_mov_b64 exec, 1
    buffer_store_dword v14, v10, s[56:59], s44 offen sc1
    s_mov_b64 exec, -1
    s_cmp_lg_u32 s30, 5
    s_cbranch_scc1 KV_n3
    s_lshl_b32 s36, s2, 14
    s_add_u32 s36, s36, 29360128
    v_lshrrev_b32 v15, 3, v1
    v_mul_u32_u24 v15, 8064, v15
    v_add_u32 v15, v15, v2
    s_mov_b64 exec, 0xffff
    buffer_store_dwordx4 v[60:63], v15, s[56:59], s36 offen sc1
    s_mov_b64 exec, -1
KV_n3:
    v_alignbit_b32 v140, v35, v34, 16
    v_mov_b32 v144, v35
    v_alignbit_b32 v148, v36, v35, 16
    v_alignbit_b32 v141, v36, v35, 16
    v_mov_b32 v145, v36
    v_alignbit_b32 v149, v37, v36, 16
    v_alignbit_b32 v142, v37, v36, 16
    v_mov_b32 v146, v37
    v_alignbit_b32 v150, v38, v37, 16
    v_alignbit_b32 v143, v38, v37, 16
    v_mov_b32 v147, v38
    v_alignbit_b32 v151, v39, v38, 16
    ds_write_b128 v20, v[140:143] offset:1024
    ds_write_b128 v20, v[144:147] offset:5184
    ds_write_b128 v20, v[148:151] offset:9344
    ds_write_b128 v20, v[36:39] offset:13504
    v_alignbit_b32 v152, v41, v40, 16
    v_mov_b32 v156, v41
    v_alignbit_b32 v160, v42, v41, 16
    v_alignbit_b32 v153, v42, v41, 16
    v_mov_b32 v157, v42
    v_alignbit_b32 v161, v43, v42, 16
    v_alignbit_b32 v154, v43, v42, 16
    v_mov_b32 v158, v43
    v_alignbit_b32 v162, v44, v43, 16
    v_alignbit_b32 v155, v44, v43, 16
    v_mov_b32 v159, v44
    v_alignbit_b32 v163, v45, v44, 16
    s_mov_b64 exec, 0xf
    ds_write_b128 v19, v[152:155] offset:4096
    ds_write_b128 v19, v[156:159] offset:8256
    ds_write_b128 v19, v[160:163] offset:12416
    ds_write_b128 v19, v[42:45] offset:16576
    s_mov_b64 exec, -1
    s_waitcnt lgkmcnt(0)
    s_barrier
    s_add_u32 s36, s67, 0
    s_and_b32 s36, s36, 7
    s_lshl_b32 s36, s36, 17
    s_add_u32 s36, s36, s48
    s_add_u32 m0, s49, 90112
    s_nop 0
    buffer_load_dwordx4 v118, s[88:91], s36 offen lds
    s_add_u32 s36, s67, 1
    s_and_b32 s36, s36, 7
    s_lshl_b32 s36, s36, 17
    s_add_u32 s36, s36, s48
    s_add_u32 m0, s49, 98304
    s_nop 0
    buffer_load_dwordx4 v118, s[88:91], s36 offen lds
    s_add_u32 s36, s67, 2
    s_and_b32 s36, s36, 7
    s_lshl_b32 s36, s36, 17
    s_add_u32 s36, s36, s48
    s_add_u32 m0, s49, 106496
    s_nop 0
    buffer_load_dwordx4 v118, s[88:91], s36 offen lds
    s_add_u32 s36, s67, 3
    s_and_b32 s36, s36, 7
    s_lshl_b32 s36, s36, 17
    s_add_u32 s36, s36, s48
    s_add_u32 m0, s49, 114688
    s_nop 0
    buffer_load_dwordx4 v118, s[88:91], s36 offen lds
    s_add_u32 s36, s67, 4
    s_and_b32 s36, s36, 7
    s_lshl_b32 s36, s36, 17
    s_add_u32 s36, s36, s48
    s_add_u32 m0, s49, 122880
    s_nop 0
    buffer_load_dwordx4 v118, s[88:91], s36 offen lds
    s_add_u32 s36, s67, 5
    s_and_b32 s36, s36, 7
    s_lshl_b32 s36, s36, 17
    s_add_u32 s36, s36, s48
    s_add_u32 m0, s49, 131072
    s_nop 0
    buffer_load_dwordx4 v118, s[88:91], s36 offen lds
    s_add_u32 s36, s67, 6
    s_and_b32 s36, s36, 7
    s_lshl_b32 s36, s36, 17
    s_add_u32 s36, s36, s48
    s_add_u32 m0, s49, 139264
    s_nop 0
    buffer_load_dwordx4 v118, s[88:91], s36 offen lds
    s_add_u32 s36, s67, 7
    s_and_b32 s36, s36, 7
    s_lshl_b32 s36, s36, 17
    s_add_u32 s36, s36, s48
    s_add_u32 m0, s49, 147456
    s_nop 0
    buffer_load_dwordx4 v118, s[88:91], s36 offen lds
    s_cmp_ge_u32 s30, 4
    s_cbranch_scc1 FR_b
    s_bitcmp1_b32 s39, 0
    s_cselect_b32 s36, 0, 16
    s_lshl_b32 s41, s41, s36
    s_and_b32 s41, s41, 0xffff0000
    s_lshr_b32 s42, s41, 16
    v_lshl_add_u32 v94, v101, 3, v100
    v_sub_u32 v94, 15, v94
    v_and_b32 v95, 1, v94
    v_cmp_eq_u32 vcc, 1, v95
    v_mov_b32 v95, s42
    v_mov_b32 v96, s41
    v_cndmask_b32 v95, v95, v96, vcc
    v_ashrrev_i32 v94, 1, v94
    v_cmp_eq_u32 vcc, 0, v94
    s_nop 1
    v_cndmask_b32 v104, 0, v95, vcc
    v_cmp_eq_u32 vcc, 1, v94
    s_nop 1
    v_cndmask_b32 v105, 0, v95, vcc
    v_cmp_eq_u32 vcc, 2, v94
    s_nop 1
    v_cndmask_b32 v106, 0, v95, vcc
    v_cmp_eq_u32 vcc, 3, v94
    s_nop 1
    v_cndmask_b32 v107, 0, v95, vcc
    v_mov_b32 v119, 0
    s_mul_i32 s36, s30, 21568
    v_lshrrev_b32 v6, 1, v100
    v_mul_u32_u24 v12, 72, v6
    v_and_b32 v6, 1, v100
    v_lshl_add_u32 v12, v6, 4, v12
    v_lshl_add_u32 v12, v101, 2, v12
    v_add_u32 v12, s36, v12
    v_add_u32 v13, 1152, v12
    v_add_u32 v14, 2304, v12
    v_add_u32 v15, 3456, v12
    v_bfe_u32 v6, v1, 2, 2
    v_mul_u32_u24 v16, 21568, v6
    v_mul_u32_u24 v6, 72, v101
    v_add_u32 v16, v16, v6
    v_and_b32 v6, 3, v1
    v_lshl_add_u32 v16, v6, 3, v16
    s_mul_i32 s36, s30, 1152
    v_add_u32 v16, s36, v16
    s_lshl_b32 s44, s30, 12
    s_mov_b32 s45, 0x07060302
    s_cmp_lg_u32 s30, 0
    s_cbranch_scc1 CV_w
    s_mov_b32 s53, 0
    s_add_u32 s54, s52, 0
    s_bfm_b64 exec, 32, 0
poll_1:
    buffer_load_dword v8, v102, s[56:59], 0 offen sc1
    s_waitcnt vmcnt(0)
    v_cmp_eq_u32 vcc, s54, v8
    s_nop 0
    s_cmp_eq_u64 vcc, exec
    s_cbranch_scc1 pok_2
    s_sleep 5
    s_add_u32 s53, s53, 1
    s_cmp_lt_u32 s53, s61
    s_cbranch_scc1 poll_1
    s_mov_b32 s61, 0
pok_2:
    s_mov_b64 exec, -1
CV_w:
    s_add_u32 m0, s40, 16640
    s_mov_b32 s36, 0
    s_waitcnt vmcnt(0)
    s_barrier
    buffer_load_dwordx4 v97, s[20:23], s36 offen offset:0 sc1 lds
    s_add_u32 s36, s36, 3072
    buffer_load_dwordx4 v97, s[20:23], s36 offen offset:1024 sc1 lds
    s_add_u32 s36, s36, 3072
    buffer_load_dwordx4 v97, s[20:23], s36 offen offset:2048 sc1 lds
    s_add_u32 s36, s36, 3072
    buffer_load_dwordx4 v97, s[20:23], s36 offen offset:3072 sc1 lds
    s_barrier
    buffer_load_dwordx2 v[86:87], v80, s[8:11], 0 offen offset:0 nt
    buffer_load_dwordx2 v[88:89], v80, s[8:11], 0 offen offset:32 nt
    buffer_load_dwordx2 v[90:91], v80, s[8:11], 0 offen offset:128 nt
    buffer_load_dwordx2 v[92:93], v80, s[8:11], 0 offen offset:160 nt
    ds_read_b64 v[120:121], v98 offset:32
    ds_read_b64 v[122:123], v98 offset:40
    ds_read_b64 v[124:125], v98 offset:544
    ds_read_b64 v[126:127], v98 offset:552
    ds_read_b64 v[128:129], v98 offset:1056
    ds_read_b64 v[130:131], v98 offset:1064
    ds_read_b64 v[132:133], v98 offset:1568
    ds_read_b64 v[134:135], v98 offset:1576
    ds_read_b64 v[136:137], v98 offset:2080
    ds_read_b64 v[138:139], v98 offset:2088
    ds_read_b64 v[140:141], v98 offset:2592
    ds_read_b64 v[142:143], v98 offset:2600
    ds_read_b64 v[144:145], v98 offset:3104
    ds_read_b64 v[146:147], v98 offset:3112
    ds_read_b64 v[148:149], v98 offset:3616
    ds_read_b64 v[150:151], v98 offset:3624
    s_waitcnt vmcnt(4)
    ds_read_b128 v[184:187], v99 offset:20224
    ds_read_b128 v[188:191], v99 offset:19712
    ds_read_b128 v[192:195], v99 offset:19200
    ds_read_b128 v[196:199], v99 offset:18688
    ds_read_b128 v[200:203], v99 offset:18176
    ds_read_b128 v[204:207], v99 offset:17664
    ds_read_b128 v[208:211], v99 offset:17152
    ds_read_b128 v[212:215], v99 offset:16640
    s_waitcnt lgkmcnt(0)
    v_mfma_f32_16x16x32_bf16 v[20:23], v[104:107], v[184:187], 0
    v_mfma_f32_16x16x32_bf16 v[24:27], v[104:107], v[188:191], 0
    v_mfma_f32_16x16x32_bf16 v[28:31], v[104:107], v[192:195], 0
    v_mfma_f32_16x16x32_bf16 v[32:35], v[104:107], v[196:199], 0
    v_mfma_f32_16x16x32_bf16 v[36:39], v[104:107], v[200:203], 0
    v_mfma_f32_16x16x32_bf16 v[40:43], v[104:107], v[204:207], 0
    v_mfma_f32_16x16x32_bf16 v[44:47], v[104:107], v[208:211], 0
    v_mfma_f32_16x16x32_bf16 v[48:51], v[104:107], v[212:215], 0
    s_mov_b32 s43, 0
CV_r:
    s_waitcnt lgkmcnt(0)
    v_mfma_f32_16x16x32_bf16 v[20:23], v[120:123], v[184:187], v[20:23]
    v_mfma_f32_16x16x32_bf16 v[24:27], v[120:123], v[188:191], v[24:27]
    v_mfma_f32_16x16x32_bf16 v[28:31], v[120:123], v[192:195], v[28:31]
    v_mfma_f32_16x16x32_bf16 v[32:35], v[120:123], v[196:199], v[32:35]
    v_mfma_f32_16x16x32_bf16 v[36:39], v[120:123], v[200:203], v[36:39]
    v_mfma_f32_16x16x32_bf16 v[40:43], v[120:123], v[204:207], v[40:43]
    v_mfma_f32_16x16x32_bf16 v[44:47], v[120:123], v[208:211], v[44:47]
    v_mfma_f32_16x16x32_bf16 v[48:51], v[120:123], v[212:215], v[48:51]
    v_mfma_f32_16x16x32_bf16 v[24:27], v[124:127], v[184:187], v[24:27]
    v_mfma_f32_16x16x32_bf16 v[28:31], v[124:127], v[188:191], v[28:31]
    v_mfma_f32_16x16x32_bf16 v[32:35], v[124:127], v[192:195], v[32:35]
    v_mfma_f32_16x16x32_bf16 v[36:39], v[124:127], v[196:199], v[36:39]
    v_mfma_f32_16x16x32_bf16 v[40:43], v[124:127], v[200:203], v[40:43]
    v_mfma_f32_16x16x32_bf16 v[44:47], v[124:127], v[204:207], v[44:47]
    v_mfma_f32_16x16x32_bf16 v[48:51], v[124:127], v[208:211], v[48:51]
    v_mfma_f32_16x16x32_bf16 v[28:31], v[128:131], v[184:187], v[28:31]
    v_mfma_f32_16x16x32_bf16 v[32:35], v[128:131], v[188:191], v[32:35]
    v_mfma_f32_16x16x32_bf16 v[36:39], v[128:131], v[192:195], v[36:39]
    v_mfma_f32_16x16x32_bf16 v[40:43], v[128:131], v[196:199], v[40:43]
    v_mfma_f32_16x16x32_bf16 v[44:47], v[128:131], v[200:203], v[44:47]
    v_mfma_f32_16x16x32_bf16 v[48:51], v[128:131], v[204:207], v[48:51]
    v_mfma_f32_16x16x32_bf16 v[32:35], v[132:135], v[184:187], v[32:35]
    v_mfma_f32_16x16x32_bf16 v[36:39], v[132:135], v[188:191], v[36:39]
    v_mfma_f32_16x16x32_bf16 v[40:43], v[132:135], v[192:195], v[40:43]
    v_mfma_f32_16x16x32_bf16 v[44:47], v[132:135], v[196:199], v[44:47]
    v_mfma_f32_16x16x32_bf16 v[48:51], v[132:135], v[200:203], v[48:51]
    v_mfma_f32_16x16x32_bf16 v[36:39], v[136:139], v[184:187], v[36:39]
    v_mfma_f32_16x16x32_bf16 v[40:43], v[136:139], v[188:191], v[40:43]
    v_mfma_f32_16x16x32_bf16 v[44:47], v[136:139], v[192:195], v[44:47]
    v_mfma_f32_16x16x32_bf16 v[48:51], v[136:139], v[196:199], v[48:51]
    v_mfma_f32_16x16x32_bf16 v[40:43], v[140:143], v[184:187], v[40:43]
    v_mfma_f32_16x16x32_bf16 v[44:47], v[140:143], v[188:191], v[44:47]
    v_mfma_f32_16x16x32_bf16 v[48:51], v[140:143], v[192:195], v[48:51]
    v_mfma_f32_16x16x32_bf16 v[44:47], v[144:147], v[184:187], v[44:47]
    v_mfma_f32_16x16x32_bf16 v[48:51], v[144:147], v[188:191], v[48:51]
    v_mfma_f32_16x16x32_bf16 v[48:51], v[148:151], v[184:187], v[48:51]
    ds_read_b128 v[216:219], v99 offset:20288
    ds_read_b128 v[220:223], v99 offset:19776
    ds_read_b128 v[224:227], v99 offset:19264
    ds_read_b128 v[228:231], v99 offset:18752
    ds_read_b128 v[232:235], v99 offset:18240
    ds_read_b128 v[236:239], v99 offset:17728
    ds_read_b128 v[240:243], v99 offset:17216
    ds_read_b128 v[244:247], v99 offset:16704
    ds_read_b64 v[152:153], v98 offset:96
    ds_read_b64 v[154:155], v98 offset:104
    ds_read_b64 v[156:157], v98 offset:608
    ds_read_b64 v[158:159], v98 offset:616
    ds_read_b64 v[160:161], v98 offset:1120
    ds_read_b64 v[162:163], v98 offset:1128
    ds_read_b64 v[164:165], v98 offset:1632
    ds_read_b64 v[166:167], v98 offset:1640
    ds_read_b64 v[168:169], v98 offset:2144
    ds_read_b64 v[170:171], v98 offset:2152
    ds_read_b64 v[172:173], v98 offset:2656
    ds_read_b64 v[174:175], v98 offset:2664
    ds_read_b64 v[176:177], v98 offset:3168
    ds_read_b64 v[178:179], v98 offset:3176
    ds_read_b64 v[180:181], v98 offset:3680
    ds_read_b64 v[182:183], v98 offset:3688
    s_waitcnt lgkmcnt(0)
    v_mfma_f32_16x16x32_bf16 v[20:23], v[152:155], v[216:219], v[20:23]
    v_mfma_f32_16x16x32_bf16 v[24:27], v[152:155], v[220:223], v[24:27]
    v_mfma_f32_16x16x32_bf16 v[28:31], v[152:155], v[224:227], v[28:31]
    v_mfma_f32_16x16x32_bf16 v[32:35], v[152:155], v[228:231], v[32:35]
    v_mfma_f32_16x16x32_bf16 v[36:39], v[152:155], v[232:235], v[36:39]
    v_mfma_f32_16x16x32_bf16 v[40:43], v[152:155], v[236:239], v[40:43]
    v_mfma_f32_16x16x32_bf16 v[44:47], v[152:155], v[240:243], v[44:47]
    v_mfma_f32_16x16x32_bf16 v[48:51], v[152:155], v[244:247], v[48:51]
    v_mfma_f32_16x16x32_bf16 v[24:27], v[156:159], v[216:219], v[24:27]
    v_mfma_f32_16x16x32_bf16 v[28:31], v[156:159], v[220:223], v[28:31]
    v_mfma_f32_16x16x32_bf16 v[32:35], v[156:159], v[224:227], v[32:35]
    v_mfma_f32_16x16x32_bf16 v[36:39], v[156:159], v[228:231], v[36:39]
    v_mfma_f32_16x16x32_bf16 v[40:43], v[156:159], v[232:235], v[40:43]
    v_mfma_f32_16x16x32_bf16 v[44:47], v[156:159], v[236:239], v[44:47]
    v_mfma_f32_16x16x32_bf16 v[48:51], v[156:159], v[240:243], v[48:51]
    v_mfma_f32_16x16x32_bf16 v[28:31], v[160:163], v[216:219], v[28:31]
    v_mfma_f32_16x16x32_bf16 v[32:35], v[160:163], v[220:223], v[32:35]
    v_mfma_f32_16x16x32_bf16 v[36:39], v[160:163], v[224:227], v[36:39]
    v_mfma_f32_16x16x32_bf16 v[40:43], v[160:163], v[228:231], v[40:43]
    v_mfma_f32_16x16x32_bf16 v[44:47], v[160:163], v[232:235], v[44:47]
    v_mfma_f32_16x16x32_bf16 v[48:51], v[160:163], v[236:239], v[48:51]
    v_mfma_f32_16x16x32_bf16 v[32:35], v[164:167], v[216:219], v[32:35]
    v_mfma_f32_16x16x32_bf16 v[36:39], v[164:167], v[220:223], v[36:39]
    v_mfma_f32_16x16x32_bf16 v[40:43], v[164:167], v[224:227], v[40:43]
    v_mfma_f32_16x16x32_bf16 v[44:47], v[164:167], v[228:231], v[44:47]
    v_mfma_f32_16x16x32_bf16 v[48:51], v[164:167], v[232:235], v[48:51]
    v_mfma_f32_16x16x32_bf16 v[36:39], v[168:171], v[216:219], v[36:39]
    v_mfma_f32_16x16x32_bf16 v[40:43], v[168:171], v[220:223], v[40:43]
    v_mfma_f32_16x16x32_bf16 v[44:47], v[168:171], v[224:227], v[44:47]
    v_mfma_f32_16x16x32_bf16 v[48:51], v[168:171], v[228:231], v[48:51]
    v_mfma_f32_16x16x32_bf16 v[40:43], v[172:175], v[216:219], v[40:43]
    v_mfma_f32_16x16x32_bf16 v[44:47], v[172:175], v[220:223], v[44:47]
    v_mfma_f32_16x16x32_bf16 v[48:51], v[172:175], v[224:227], v[48:51]
    v_mfma_f32_16x16x32_bf16 v[44:47], v[176:179], v[216:219], v[44:47]
    v_mfma_f32_16x16x32_bf16 v[48:51], v[176:179], v[220:223], v[48:51]
    v_mfma_f32_16x16x32_bf16 v[48:51], v[180:183], v[216:219], v[48:51]
    ds_read_b128 v[184:187], v99 offset:20352
    ds_read_b128 v[188:191], v99 offset:19840
    ds_read_b128 v[192:195], v99 offset:19328
    ds_read_b128 v[196:199], v99 offset:18816
    ds_read_b128 v[200:203], v99 offset:18304
    ds_read_b128 v[204:207], v99 offset:17792
    ds_read_b128 v[208:211], v99 offset:17280
    ds_read_b128 v[212:215], v99 offset:16768
    ds_read_b64 v[120:121], v98 offset:160
    ds_read_b64 v[122:123], v98 offset:168
    ds_read_b64 v[124:125], v98 offset:672
    ds_read_b64 v[126:127], v98 offset:680
    ds_read_b64 v[128:129], v98 offset:1184
    ds_read_b64 v[130:131], v98 offset:1192
    ds_read_b64 v[132:133], v98 offset:1696
    ds_read_b64 v[134:135], v98 offset:1704
    ds_read_b64 v[136:137], v98 offset:2208
    ds_read_b64 v[138:139], v98 offset:2216
    ds_read_b64 v[140:141], v98 offset:2720
    ds_read_b64 v[142:143], v98 offset:2728
    ds_read_b64 v[144:145], v98 offset:3232
    ds_read_b64 v[146:147], v98 offset:3240
    ds_read_b64 v[148:149], v98 offset:3744
    ds_read_b64 v[150:151], v98 offset:3752
    v_add_u32 v98, 128, v98
    v_add_u32 v99, 128, v99
    s_add_u32 s43, s43, 1
    s_cmp_lt_u32 s43, 2
    s_cbranch_scc1 CV_r
CV_l:
    s_waitcnt lgkmcnt(0)
    v_mfma_f32_16x16x32_bf16 v[20:23], v[120:123], v[184:187], v[20:23]
    ds_read_b128 v[216:219], v99 offset:20288
    v_mfma_f32_16x16x32_bf16 v[24:27], v[120:123], v[188:191], v[24:27]
    ds_read_b128 v[220:223], v99 offset:19776
    v_mfma_f32_16x16x32_bf16 v[28:31], v[120:123], v[192:195], v[28:31]
    ds_read_b128 v[224:227], v99 offset:19264
    v_mfma_f32_16x16x32_bf16 v[32:35], v[120:123], v[196:199], v[32:35]
    ds_read_b128 v[228:231], v99 offset:18752
    v_mfma_f32_16x16x32_bf16 v[36:39], v[120:123], v[200:203], v[36:39]
    ds_read_b128 v[232:235], v99 offset:18240
    v_mfma_f32_16x16x32_bf16 v[40:43], v[120:123], v[204:207], v[40:43]
    ds_read_b128 v[236:239], v99 offset:17728
    v_mfma_f32_16x16x32_bf16 v[44:47], v[120:123], v[208:211], v[44:47]
    ds_read_b128 v[240:243], v99 offset:17216
    v_mfma_f32_16x16x32_bf16 v[48:51], v[120:123], v[212:215], v[48:51]
    ds_read_b128 v[244:247], v99 offset:16704
    v_mfma_f32_16x16x32_bf16 v[24:27], v[124:127], v[184:187], v[24:27]
    ds_read_b64 v[152:153], v98 offset:96
    v_mfma_f32_16x16x32_bf16 v[28:31], v[124:127], v[188:191], v[28:31]
    ds_read_b64 v[154:155], v98 offset:104
    v_mfma_f32_16x16x32_bf16 v[32:35], v[124:127], v[192:195], v[32:35]
    ds_read_b64 v[156:157], v98 offset:608
    v_mfma_f32_16x16x32_bf16 v[36:39], v[124:127], v[196:199], v[36:39]
    ds_read_b64 v[158:159], v98 offset:616
    v_mfma_f32_16x16x32_bf16 v[40:43], v[124:127], v[200:203], v[40:43]
    ds_read_b64 v[160:161], v98 offset:1120
    v_mfma_f32_16x16x32_bf16 v[44:47], v[124:127], v[204:207], v[44:47]
    ds_read_b64 v[162:163], v98 offset:1128
    v_mfma_f32_16x16x32_bf16 v[48:51], v[124:127], v[208:211], v[48:51]
    ds_read_b64 v[164:165], v98 offset:1632
    v_mfma_f32_16x16x32_bf16 v[28:31], v[128:131], v[184:187], v[28:31]
    ds_read_b64 v[166:167], v98 offset:1640
    v_mfma_f32_16x16x32_bf16 v[32:35], v[128:131], v[188:191], v[32:35]
    ds_read_b64 v[168:169], v98 offset:2144
    v_mfma_f32_16x16x32_bf16 v[36:39], v[128:131], v[192:195], v[36:39]
    ds_read_b64 v[170:171], v98 offset:2152
    v_mfma_f32_16x16x32_bf16 v[40:43], v[128:131], v[196:199], v[40:43]
    ds_read_b64 v[172:173], v98 offset:2656
    v_mfma_f32_16x16x32_bf16 v[44:47], v[128:131], v[200:203], v[44:47]
    ds_read_b64 v[174:175], v98 offset:2664
    v_mfma_f32_16x16x32_bf16 v[48:51], v[128:131], v[204:207], v[48:51]
    ds_read_b64 v[176:177], v98 offset:3168
    v_mfma_f32_16x16x32_bf16 v[32:35], v[132:135], v[184:187], v[32:35]
    ds_read_b64 v[178:179], v98 offset:3176
    v_mfma_f32_16x16x32_bf16 v[36:39], v[132:135], v[188:191], v[36:39]
    ds_read_b64 v[180:181], v98 offset:3680
    v_mfma_f32_16x16x32_bf16 v[40:43], v[132:135], v[192:195], v[40:43]
    ds_read_b64 v[182:183], v98 offset:3688
    v_mfma_f32_16x16x32_bf16 v[44:47], v[132:135], v[196:199], v[44:47]
    v_mfma_f32_16x16x32_bf16 v[48:51], v[132:135], v[200:203], v[48:51]
    v_mfma_f32_16x16x32_bf16 v[36:39], v[136:139], v[184:187], v[36:39]
    v_mfma_f32_16x16x32_bf16 v[40:43], v[136:139], v[188:191], v[40:43]
    v_mfma_f32_16x16x32_bf16 v[44:47], v[136:139], v[192:195], v[44:47]
    v_mfma_f32_16x16x32_bf16 v[48:51], v[136:139], v[196:199], v[48:51]
    v_mfma_f32_16x16x32_bf16 v[40:43], v[140:143], v[184:187], v[40:43]
    v_mfma_f32_16x16x32_bf16 v[44:47], v[140:143], v[188:191], v[44:47]
    v_mfma_f32_16x16x32_bf16 v[48:51], v[140:143], v[192:195], v[48:51]
    v_mfma_f32_16x16x32_bf16 v[44:47], v[144:147], v[184:187], v[44:47]
    v_mfma_f32_16x16x32_bf16 v[48:51], v[144:147], v[188:191], v[48:51]
    v_mfma_f32_16x16x32_bf16 v[48:51], v[148:151], v[184:187], v[48:51]
    s_waitcnt lgkmcnt(0)
    v_mfma_f32_16x16x32_bf16 v[20:23], v[152:155], v[216:219], v[20:23]
    ds_read_b128 v[184:187], v99 offset:20352
    v_mfma_f32_16x16x32_bf16 v[24:27], v[152:155], v[220:223], v[24:27]
    ds_read_b128 v[188:191], v99 offset:19840
    v_mfma_f32_16x16x32_bf16 v[28:31], v[152:155], v[224:227], v[28:31]
    ds_read_b128 v[192:195], v99 offset:19328
    v_mfma_f32_16x16x32_bf16 v[32:35], v[152:155], v[228:231], v[32:35]
    ds_read_b128 v[196:199], v99 offset:18816
    v_mfma_f32_16x16x32_bf16 v[36:39], v[152:155], v[232:235], v[36:39]
    ds_read_b128 v[200:203], v99 offset:18304
    v_mfma_f32_16x16x32_bf16 v[40:43], v[152:155], v[236:239], v[40:43]
    ds_read_b128 v[204:207], v99 offset:17792
    v_mfma_f32_16x16x32_bf16 v[44:47], v[152:155], v[240:243], v[44:47]
    ds_read_b128 v[208:211], v99 offset:17280
    v_mfma_f32_16x16x32_bf16 v[48:51], v[152:155], v[244:247], v[48:51]
    ds_read_b128 v[212:215], v99 offset:16768
    v_mfma_f32_16x16x32_bf16 v[24:27], v[156:159], v[216:219], v[24:27]
    ds_read_b64 v[120:121], v98 offset:160
    v_mfma_f32_16x16x32_bf16 v[28:31], v[156:159], v[220:223], v[28:31]
    ds_read_b64 v[122:123], v98 offset:168
    v_mfma_f32_16x16x32_bf16 v[32:35], v[156:159], v[224:227], v[32:35]
    ds_read_b64 v[124:125], v98 offset:672
    v_mfma_f32_16x16x32_bf16 v[36:39], v[156:159], v[228:231], v[36:39]
    ds_read_b64 v[126:127], v98 offset:680
    v_mfma_f32_16x16x32_bf16 v[40:43], v[156:159], v[232:235], v[40:43]
    ds_read_b64 v[128:129], v98 offset:1184
    v_mfma_f32_16x16x32_bf16 v[44:47], v[156:159], v[236:239], v[44:47]
    ds_read_b64 v[130:131], v98 offset:1192
    v_mfma_f32_16x16x32_bf16 v[48:51], v[156:159], v[240:243], v[48:51]
    ds_read_b64 v[132:133], v98 offset:1696
    v_mfma_f32_16x16x32_bf16 v[28:31], v[160:163], v[216:219], v[28:31]
    ds_read_b64 v[134:135], v98 offset:1704
    v_mfma_f32_16x16x32_bf16 v[32:35], v[160:163], v[220:223], v[32:35]
    ds_read_b64 v[136:137], v98 offset:2208
    v_mfma_f32_16x16x32_bf16 v[36:39], v[160:163], v[224:227], v[36:39]
    ds_read_b64 v[138:139], v98 offset:2216
    v_mfma_f32_16x16x32_bf16 v[40:43], v[160:163], v[228:231], v[40:43]
    ds_read_b64 v[140:141], v98 offset:2720
    v_mfma_f32_16x16x32_bf16 v[44:47], v[160:163], v[232:235], v[44:47]
    ds_read_b64 v[142:143], v98 offset:2728
    v_mfma_f32_16x16x32_bf16 v[48:51], v[160:163], v[236:239], v[48:51]
    ds_read_b64 v[144:145], v98 offset:3232
    v_mfma_f32_16x16x32_bf16 v[32:35], v[164:167], v[216:219], v[32:35]
    ds_read_b64 v[146:147], v98 offset:3240
    v_mfma_f32_16x16x32_bf16 v[36:39], v[164:167], v[220:223], v[36:39]
    ds_read_b64 v[148:149], v98 offset:3744
    v_mfma_f32_16x16x32_bf16 v[40:43], v[164:167], v[224:227], v[40:43]
    ds_read_b64 v[150:151], v98 offset:3752
    v_mfma_f32_16x16x32_bf16 v[44:47], v[164:167], v[228:231], v[44:47]
    v_add_u32 v98, 128, v98
    v_mfma_f32_16x16x32_bf16 v[48:51], v[164:167], v[232:235], v[48:51]
    v_add_u32 v99, 128, v99
    v_mfma_f32_16x16x32_bf16 v[36:39], v[168:171], v[216:219], v[36:39]
    s_add_u32 s43, s43, 1
    v_mfma_f32_16x16x32_bf16 v[40:43], v[168:171], v[220:223], v[40:43]
    s_cmp_lt_u32 s43, 4
    v_mfma_f32_16x16x32_bf16 v[44:47], v[168:171], v[224:227], v[44:47]
    v_mfma_f32_16x16x32_bf16 v[48:51], v[168:171], v[228:231], v[48:51]
    v_mfma_f32_16x16x32_bf16 v[40:43], v[172:175], v[216:219], v[40:43]
    v_mfma_f32_16x16x32_bf16 v[44:47], v[172:175], v[220:223], v[44:47]
    v_mfma_f32_16x16x32_bf16 v[48:51], v[172:175], v[224:227], v[48:51]
    v_mfma_f32_16x16x32_bf16 v[44:47], v[176:179], v[216:219], v[44:47]
    v_mfma_f32_16x16x32_bf16 v[48:51], v[176:179], v[220:223], v[48:51]
    v_mfma_f32_16x16x32_bf16 v[48:51], v[180:183], v[216:219], v[48:51]
    s_cbranch_scc1 CV_l
    s_bitcmp1_b32 s30, 0
    s_waitcnt lgkmcnt(0)
    s_cbranch_scc1 CV_o
    v_perm_b32 v20, v22, v20, s45
    v_perm_b32 v21, v23, v21, s45
    v_or_b32 v20, 0x10001, v20
    v_or_b32 v21, 0x10001, v21
    ds_write2_b32 v12, v20, v21 offset0:0 offset1:8
    v_perm_b32 v24, v26, v24, s45
    v_perm_b32 v25, v27, v25, s45
    v_or_b32 v24, 0x10001, v24
    v_or_b32 v25, 0x10001, v25
    ds_write2_b32 v12, v24, v25 offset0:144 offset1:152
    v_perm_b32 v28, v30, v28, s45
    v_perm_b32 v29, v31, v29, s45
    v_or_b32 v28, 0x10001, v28
    v_or_b32 v29, 0x10001, v29
    ds_write2_b32 v13, v28, v29 offset0:0 offset1:8
    v_perm_b32 v32, v34, v32, s45
    v_perm_b32 v33, v35, v33, s45
    v_or_b32 v32, 0x10001, v32
    v_or_b32 v33, 0x10001, v33
    ds_write2_b32 v13, v32, v33 offset0:144 offset1:152
    v_perm_b32 v36, v38, v36, s45
    v_perm_b32 v37, v39, v37, s45
    v_or_b32 v36, 0x10001, v36
    v_or_b32 v37, 0x10001, v37
    ds_write2_b32 v14, v36, v37 offset0:0 offset1:8
    v_perm_b32 v40, v42, v40, s45
    v_perm_b32 v41, v43, v41, s45
    v_or_b32 v40, 0x10001, v40
    v_or_b32 v41, 0x10001, v41
    ds_write2_b32 v14, v40, v41 offset0:144 offset1:152
    v_perm_b32 v44, v46, v44, s45
    v_perm_b32 v45, v47, v45, s45
    v_or_b32 v44, 0x10001, v44
    v_or_b32 v45, 0x10001, v45
    ds_write2_b32 v15, v44, v45 offset0:0 offset1:8
    v_perm_b32 v48, v50, v48, s45
    v_perm_b32 v49, v51, v49, s45
    v_or_b32 v48, 0x10001, v48
    v_or_b32 v49, 0x10001, v49
    ds_write2_b32 v15, v48, v49 offset0:144 offset1:152
    s_branch CV_e
CV_o:
    v_cvt_pk_bf16_f32 v20, v20, v22
    v_cvt_pk_bf16_f32 v21, v21, v23
    ds_write2_b32 v12, v20, v21 offset0:0 offset1:8
    v_cvt_pk_bf16_f32 v24, v24, v26
    v_cvt_pk_bf16_f32 v25, v25, v27
    ds_write2_b32 v12, v24, v25 offset0:144 offset1:152
    v_cvt_pk_bf16_f32 v28, v28, v30
    v_cvt_pk_bf16_f32 v29, v29, v31
    ds_write2_b32 v13, v28, v29 offset0:0 offset1:8
    v_cvt_pk_bf16_f32 v32, v32, v34
    v_cvt_pk_bf16_f32 v33, v33, v35
    ds_write2_b32 v13, v32, v33 offset0:144 offset1:152
    v_cvt_pk_bf16_f32 v36, v36, v38
    v_cvt_pk_bf16_f32 v37, v37, v39
    ds_write2_b32 v14, v36, v37 offset0:0 offset1:8
    v_cvt_pk_bf16_f32 v40, v40, v42
    v_cvt_pk_bf16_f32 v41, v41, v43
    ds_write2_b32 v14, v40, v41 offset0:144 offset1:152
    v_cvt_pk_bf16_f32 v44, v44, v46
    v_cvt_pk_bf16_f32 v45, v45, v47
    ds_write2_b32 v15, v44, v45 offset0:0 offset1:8
    v_cvt_pk_bf16_f32 v48, v48, v50
    v_cvt_pk_bf16_f32 v49, v49, v51
    ds_write2_b32 v15, v48, v49 offset0:144 offset1:152
CV_e:
    v_mov_b32 v8, 162824
    v_mov_b32 v9, 1
    s_waitcnt lgkmcnt(0)
    s_mov_b64 exec, 1
    ds_add_u32 v8, v9
    s_mov_b64 exec, -1
    v_mov_b32 v8, 162824
spin_3:
    ds_read_b32 v9, v8
    s_waitcnt lgkmcnt(0)
    v_readfirstlane_b32 s53, v9
    s_nop 0
    s_cmp_ge_u32 s53, 8
    s_cbranch_scc0 spin_3
    ds_read_b64_tr_b16 v[120:121], v16 offset:0
    ds_read_b64_tr_b16 v[122:123], v16 offset:32
    ds_read_b64_tr_b16 v[124:125], v16 offset:288
    ds_read_b64_tr_b16 v[126:127], v16 offset:320
    ds_read_b64_tr_b16 v[128:129], v16 offset:576
    ds_read_b64_tr_b16 v[130:131], v16 offset:608
    ds_read_b64_tr_b16 v[132:133], v16 offset:864
    ds_read_b64_tr_b16 v[134:135], v16 offset:896
    s_waitcnt lgkmcnt(6)
    buffer_store_dwordx4 v[120:123], v2, s[20:23], s44 offen offset:0 sc1
    s_waitcnt lgkmcnt(4)
    buffer_store_dwordx4 v[124:127], v2, s[20:23], s44 offen offset:1024 sc1
    s_waitcnt lgkmcnt(2)
    buffer_store_dwordx4 v[128:131], v2, s[20:23], s44 offen offset:2048 sc1
    s_waitcnt lgkmcnt(0)
    buffer_store_dwordx4 v[132:135], v2, s[20:23], s44 offen offset:3072 sc1
    s_waitcnt vmcnt(4)
    s_branch FR_end
FR_b:
    v_lshrrev_b32 v10, 2, v1
    v_lshlrev_b32 v74, 7, v10
    v_bfe_u32 v10, v10, 1, 2
    s_and_b32 s35, s30, 2
    v_and_b32 v11, 1, v1
    v_or_b32 v11, s35, v11
    v_xor_b32 v10, v10, v11
    v_lshl_add_u32 v74, v10, 5, v74
    v_and_b32 v10, 2, v1
    v_lshl_add_u32 v74, v10, 2, v74
    s_and_b32 s35, s30, 1
    s_lshl_b32 s35, s35, 4
    v_add_u32 v74, s35, v74
    v_add_u32 v75, 65536, v74
    v_add_u32 v76, 131072, v74
    s_and_b32 s36, s30, 3
    s_lshl_b32 s36, s36, 14
    s_lshl_b32 s48, s29, 7
    s_add_u32 s48, s48, s36
    v_mov_b32 v110, 0
    v_mov_b32 v111, 0
    v_mov_b32 v112, 0
    v_mov_b32 v113, 0
    s_and_b32 s44, s30, 3
    s_lshl2_add_u32 s44, s2, s44
    s_lshl_b32 s44, s44, 12
    s_add_u32 s44, s44, 29360128
    s_cmp_lg_u32 s30, 5
    s_cbranch_scc1 FB_np
    s_lshl_b32 s42, s2, 14
    s_add_u32 s42, s42, 29360128
    s_waitcnt vmcnt(8)
    s_memtime s[34:35]
    s_waitcnt lgkmcnt(0)
    s_load_dword s32, s[4:5], s42 offset:0 glc
    s_waitcnt lgkmcnt(0)
    s_memtime s[36:37]
    s_waitcnt lgkmcnt(0)
    s_sub_u32 s46, s36, s34
    s_memtime s[34:35]
    s_waitcnt lgkmcnt(0)
    s_load_dword s32, s[4:5], s42 offset:8192 glc
    s_waitcnt lgkmcnt(0)
    s_memtime s[36:37]
    s_waitcnt lgkmcnt(0)
    s_sub_u32 s47, s36, s34
    s_cmp_lt_u32 s47, s46
    s_cselect_b32 s45, 1, 0
    s_lshr_b32 s46, s28, 2
    s_xor_b32 s45, s45, s46
    s_lshr_b32 s46, s2, 7
    s_xor_b32 s45, s45, s46
    s_and_b32 s45, s45, 1
    s_lshl_b32 s45, s45, 8
FB_np:
    s_lshr_b32 s53, s28, 3
    s_lshl_b32 s53, s53, 2
    s_and_b32 s54, s28, 3
    s_add_u32 s53, s53, s54
    s_lshl_b32 s53, s53, 23
    s_lshr_b32 s54, s28, 2
    s_xor_b32 s54, s54, s94
    s_and_b32 s54, s54, 1
    s_lshl_b32 s54, s54, 13
    s_add_u32 s37, s53, s54
    s_add_u32 s37, s37, 33554432
    s_andn2_b32 s37, s37, 0x2000
    s_lshl_b32 s43, s29, 7
    s_add_u32 s37, s37, s43
    s_add_u32 s37, s37, 1835008
    s_add_u32 s43, s43, 23068672
    v_mov_b32 v102, s52
    v_and_b32 v103, 1, v1
    v_lshlrev_b32 v103, 13, v103
    v_bfe_u32 v104, v1, 1, 1
    v_lshl_add_u32 v103, v104, 26, v103
    v_lshrrev_b32 v104, 2, v1
    v_lshl_add_u32 v103, v104, 11, v103
    s_waitcnt vmcnt(0) lgkmcnt(0)
    s_barrier
    ds_read_b64_tr_b16 v[132:133], v75 offset:24576
    ds_read_b64_tr_b16 v[134:135], v75 offset:26624
    ds_read_b64_tr_b16 v[140:141], v75 offset:28672
    ds_read_b64_tr_b16 v[142:143], v75 offset:30720
    ds_read_b64_tr_b16 v[148:149], v75 offset:32768
    ds_read_b64_tr_b16 v[150:151], v75 offset:34816
    ds_read_b64_tr_b16 v[156:157], v75 offset:36864
    ds_read_b64_tr_b16 v[158:159], v75 offset:38912
    ds_read_b64_tr_b16 v[164:165], v75 offset:40960
    ds_read_b64_tr_b16 v[166:167], v75 offset:43008
    ds_read_b64_tr_b16 v[172:173], v75 offset:45056
    ds_read_b64_tr_b16 v[174:175], v75 offset:47104
    ds_read_b64_tr_b16 v[180:181], v75 offset:49152
    ds_read_b64_tr_b16 v[182:183], v75 offset:51200
    ds_read_b64_tr_b16 v[188:189], v75 offset:53248
    ds_read_b64_tr_b16 v[190:191], v75 offset:55296
    ds_read_b64_tr_b16 v[196:197], v75 offset:57344
    ds_read_b64_tr_b16 v[198:199], v75 offset:59392
    ds_read_b64_tr_b16 v[204:205], v75 offset:61440
    ds_read_b64_tr_b16 v[206:207], v75 offset:63488
    ds_read_b64_tr_b16 v[212:213], v76 offset:0
    ds_read_b64_tr_b16 v[214:215], v76 offset:2048
    ds_read_b64_tr_b16 v[220:221], v76 offset:4096
    ds_read_b64_tr_b16 v[222:223], v76 offset:6144
    ds_read_b64_tr_b16 v[228:229], v76 offset:8192
    ds_read_b64_tr_b16 v[230:231], v76 offset:10240
    ds_read_b64_tr_b16 v[236:237], v76 offset:12288
    ds_read_b64_tr_b16 v[238:239], v76 offset:14336
    ds_read_b64_tr_b16 v[244:245], v76 offset:16384
    ds_read_b64_tr_b16 v[246:247], v76 offset:18432
    ds_read_b64_tr_b16 v[252:253], v76 offset:20480
    ds_read_b64_tr_b16 v[254:255], v76 offset:22528
    s_waitcnt lgkmcnt(0)
    s_barrier
    s_cmp_lg_u32 s30, 5
    s_cbranch_scc1 FB_na
    s_and_b32 s36, s2, 7
    s_lshr_b32 s53, s2, 5
    s_lshl3_add_u32 s36, s36, s53
    s_lshl_b32 s36, s36, 7
    s_add_u32 s36, s36, 23592960
    s_or_b32 s45, s45, 1
    v_mov_b32 v8, s45
    v_lshlrev_b32 v9, 13, v1
    s_mov_b64 exec, 0xffff
    buffer_atomic_add v8, v9, s[56:59], s36 offen sc1
    s_mov_b64 exec, -1
FB_na:
    buffer_load_dwordx4 v[12:15], v2, s[80:83], s50 offen
    s_sub_u32 s50, s50, 4096
    buffer_load_dwordx4 v[12:15], v2, s[80:83], s50 offen
    s_sub_u32 s50, s50, 4096
    buffer_load_dwordx2 v[86:87], v80, s[8:11], 0 offen offset:0 nt
    buffer_load_dwordx2 v[88:89], v80, s[8:11], 0 offen offset:32 nt
    buffer_load_dwordx2 v[90:91], v80, s[8:11], 0 offen offset:128 nt
    buffer_load_dwordx2 v[92:93], v80, s[8:11], 0 offen offset:160 nt
    s_cmp_lg_u32 s30, 4
    s_cbranch_scc1 FB_ni
    s_mov_b64 exec, 0xfff
    buffer_store_dword v102, v103, s[56:59], s37 offen sc1
    s_cmp_lg_u32 s28, 0
    s_cbranch_scc1 FB_n2
    s_mov_b64 exec, 3
    buffer_store_dword v102, v103, s[56:59], s43 offen sc1
FB_n2:
    s_mov_b64 exec, -1
FB_ni:
    buffer_store_dwordx4 v[110:113], v2, s[56:59], s44 offen offset:0 sc1
    buffer_store_dwordx4 v[110:113], v2, s[56:59], s44 offen offset:1024 sc1
    buffer_store_dwordx4 v[110:113], v2, s[56:59], s44 offen offset:2048 sc1
    buffer_store_dwordx4 v[110:113], v2, s[56:59], s44 offen offset:3072 sc1
    s_add_u32 s36, s67, 0
    s_and_b32 s36, s36, 7
    s_lshl_b32 s36, s36, 17
    s_add_u32 s36, s36, s48
    buffer_load_dwordx4 v[128:131], v118, s[88:91], s36 offen
    s_add_u32 s36, s36, 65536
    buffer_load_dwordx4 v[136:139], v118, s[88:91], s36 offen
    s_add_u32 s36, s67, 1
    s_and_b32 s36, s36, 7
    s_lshl_b32 s36, s36, 17
    s_add_u32 s36, s36, s48
    buffer_load_dwordx4 v[144:147], v118, s[88:91], s36 offen
    s_add_u32 s36, s36, 65536
    buffer_load_dwordx4 v[152:155], v118, s[88:91], s36 offen
    s_and_b32 s49, s30, 3
    s_lshl_b32 s36, s49, 14
    s_lshl_b32 s48, s29, 7
    s_add_u32 s48, s48, s36
    s_lshl_b32 s49, s49, 10
    s_xor_b32 s48, s48, 128
    s_add_u32 s36, s67, 3
    s_and_b32 s36, s36, 7
    s_lshl_b32 s36, s36, 17
    s_add_u32 s36, s36, s48
    s_add_u32 s36, s36, 1048576
    s_add_u32 m0, s49, 114688
    s_nop 0
    buffer_load_dwordx4 v118, s[80:83], s36 offen lds
    s_add_u32 s36, s36, 65536
    s_add_u32 m0, s49, 118784
    s_nop 0
    buffer_load_dwordx4 v118, s[80:83], s36 offen lds
    s_add_u32 s36, s67, 4
    s_and_b32 s36, s36, 7
    s_lshl_b32 s36, s36, 17
    s_add_u32 s36, s36, s48
    s_add_u32 s36, s36, 1048576
    s_add_u32 m0, s49, 122880
    s_nop 0
    buffer_load_dwordx4 v118, s[80:83], s36 offen lds
    s_add_u32 s36, s36, 65536
    s_add_u32 m0, s49, 126976
    s_nop 0
    buffer_load_dwordx4 v118, s[80:83], s36 offen lds
    s_add_u32 s36, s67, 7
    s_and_b32 s36, s36, 7
    s_lshl_b32 s36, s36, 17
    s_add_u32 s36, s36, s48
    s_add_u32 s36, s36, 1048576
    s_add_u32 m0, s49, 147456
    s_nop 0
    buffer_load_dwordx4 v118, s[80:83], s36 offen lds
    s_add_u32 s36, s36, 65536
    s_add_u32 m0, s49, 151552
    s_nop 0
    buffer_load_dwordx4 v118, s[80:83], s36 offen lds
    s_add_u32 s36, s67, 5
    s_and_b32 s36, s36, 7
    s_lshl_b32 s36, s36, 17
    s_add_u32 s36, s36, s48
    s_add_u32 s36, s36, 1048576
    s_add_u32 m0, s49, 131072
    s_nop 0
    buffer_load_dwordx4 v118, s[80:83], s36 offen lds
    s_add_u32 s36, s36, 65536
    s_add_u32 m0, s49, 135168
    s_nop 0
    buffer_load_dwordx4 v118, s[80:83], s36 offen lds
    s_add_u32 s36, s67, 6
    s_and_b32 s36, s36, 7
    s_lshl_b32 s36, s36, 17
    s_add_u32 s36, s36, s48
    s_add_u32 s36, s36, 1048576
    s_add_u32 m0, s49, 139264
    s_nop 0
    buffer_load_dwordx4 v118, s[80:83], s36 offen lds
    s_add_u32 s36, s36, 65536
    s_add_u32 m0, s49, 143360
    s_nop 0
    buffer_load_dwordx4 v118, s[80:83], s36 offen lds
    s_waitcnt vmcnt(14)
    v_mov_b32 v6, 162824
    v_mov_b32 v7, 1
    s_waitcnt lgkmcnt(0)
    s_mov_b64 exec, 1
    ds_add_u32 v6, v7
    s_mov_b64 exec, -1
    s_add_u32 s36, s67, 3
    s_and_b32 s36, s36, 7
    s_lshl_b32 s36, s36, 17
    s_add_u32 s36, s36, s48
    buffer_load_dwordx4 v[28:31], v118, s[80:83], s36 offen
    s_add_u32 s36, s36, 65536
    buffer_load_dwordx4 v[32:35], v118, s[80:83], s36 offen
    s_add_u32 s36, s67, 4
    s_and_b32 s36, s36, 7
    s_lshl_b32 s36, s36, 17
    s_add_u32 s36, s36, s48
    buffer_load_dwordx4 v[36:39], v118, s[80:83], s36 offen
    s_add_u32 s36, s36, 65536
    buffer_load_dwordx4 v[40:43], v118, s[80:83], s36 offen
    s_add_u32 s36, s67, 5
    s_and_b32 s36, s36, 7
    s_lshl_b32 s36, s36, 17
    s_add_u32 s36, s36, s48
    buffer_load_dwordx4 v[52:55], v118, s[80:83], s36 offen
    s_add_u32 s36, s36, 65536
    buffer_load_dwordx4 v[56:59], v118, s[80:83], s36 offen
    s_add_u32 s36, s67, 6
    s_and_b32 s36, s36, 7
    s_lshl_b32 s36, s36, 17
    s_add_u32 s36, s36, s48
    buffer_load_dwordx4 v[60:63], v118, s[80:83], s36 offen
    s_add_u32 s36, s36, 65536
    buffer_load_dwordx4 v[64:67], v118, s[80:83], s36 offen
    s_add_u32 s36, s67, 0
    s_and_b32 s36, s36, 7
    s_lshl_b32 s36, s36, 17
    s_add_u32 s36, s36, s48
    buffer_load_dwordx4 v[94:97], v118, s[80:83], s36 offen
    s_add_u32 s36, s36, 65536
    buffer_load_dwordx4 v[98:101], v118, s[80:83], s36 offen
    s_xor_b32 s48, s48, 128
    s_add_u32 s36, s67, 2
    s_and_b32 s36, s36, 7
    s_lshl_b32 s36, s36, 17
    s_add_u32 s36, s36, s48
    buffer_load_dwordx4 v[160:163], v118, s[88:91], s36 offen
    s_add_u32 s36, s36, 65536
    buffer_load_dwordx4 v[168:171], v118, s[88:91], s36 offen
    s_add_u32 s36, s67, 3
    s_and_b32 s36, s36, 7
    s_lshl_b32 s36, s36, 17
    s_add_u32 s36, s36, s48
    buffer_load_dwordx4 v[176:179], v118, s[88:91], s36 offen
    s_add_u32 s36, s36, 65536
    buffer_load_dwordx4 v[184:187], v118, s[88:91], s36 offen
    s_add_u32 s36, s67, 4
    s_and_b32 s36, s36, 7
    s_lshl_b32 s36, s36, 17
    s_add_u32 s36, s36, s48
    buffer_load_dwordx4 v[192:195], v118, s[88:91], s36 offen
    s_add_u32 s36, s36, 65536
    buffer_load_dwordx4 v[200:203], v118, s[88:91], s36 offen
    s_add_u32 s36, s67, 5
    s_and_b32 s36, s36, 7
    s_lshl_b32 s36, s36, 17
    s_add_u32 s36, s36, s48
    buffer_load_dwordx4 v[208:211], v118, s[88:91], s36 offen
    s_add_u32 s36, s36, 65536
    buffer_load_dwordx4 v[216:219], v118, s[88:91], s36 offen
    s_add_u32 s36, s67, 6
    s_and_b32 s36, s36, 7
    s_lshl_b32 s36, s36, 17
    s_add_u32 s36, s36, s48
    buffer_load_dwordx4 v[224:227], v118, s[88:91], s36 offen
    s_add_u32 s36, s36, 65536
    buffer_load_dwordx4 v[232:235], v118, s[88:91], s36 offen
    s_add_u32 s36, s67, 7
    s_and_b32 s36, s36, 7
    s_lshl_b32 s36, s36, 17
    s_add_u32 s36, s36, s48
    buffer_load_dwordx4 v[240:243], v118, s[88:91], s36 offen
    s_add_u32 s36, s36, 65536
    buffer_load_dwordx4 v[248:251], v118, s[88:91], s36 offen
    v_lshrrev_b32 v10, 4, v1
    v_lshlrev_b32 v119, 11, v10
    v_add_u32 v10, 0, v10
    v_lshlrev_b32 v10, 1, v10
    v_and_b32 v11, 15, v1
    v_xor_b32 v10, v10, v11
    v_lshl_add_u32 v119, v10, 4, v119
    v_lshrrev_b32 v10, 4, v1
    v_lshlrev_b32 v120, 11, v10
    v_add_u32 v10, 4, v10
    v_lshlrev_b32 v10, 1, v10
    v_and_b32 v11, 15, v1
    v_xor_b32 v10, v10, v11
    v_lshl_add_u32 v120, v10, 4, v120
    v_add_u32 v11, 0, v1
    v_mul_u32_u24 v10, 2341, v11
    v_lshrrev_b32 v10, 16, v10
    v_mul_u32_u24 v121, 28, v10
    v_sub_u32 v11, v11, v121
    v_mul_u32_u24 v121, 7168, v10
    v_lshrrev_b32 v10, 1, v10
    v_and_b32 v10, 2, v10
    v_xor_b32 v11, v11, v10
    v_lshl_add_u32 v121, v11, 4, v121
    v_add_u32 v11, 64, v1
    v_mul_u32_u24 v10, 2341, v11
    v_lshrrev_b32 v10, 16, v10
    v_mul_u32_u24 v122, 28, v10
    v_sub_u32 v11, v11, v122
    v_mul_u32_u24 v122, 7168, v10
    v_lshrrev_b32 v10, 1, v10
    v_and_b32 v10, 2, v10
    v_xor_b32 v11, v11, v10
    v_lshl_add_u32 v122, v11, 4, v122
    v_add_u32 v11, 128, v1
    v_mul_u32_u24 v10, 2341, v11
    v_lshrrev_b32 v10, 16, v10
    v_mul_u32_u24 v123, 28, v10
    v_sub_u32 v11, v11, v123
    v_mul_u32_u24 v123, 7168, v10
    v_lshrrev_b32 v10, 1, v10
    v_and_b32 v10, 2, v10
    v_xor_b32 v11, v11, v10
    v_lshl_add_u32 v123, v11, 4, v123
    v_add_u32 v11, 192, v1
    v_mul_u32_u24 v10, 2341, v11
    v_lshrrev_b32 v10, 16, v10
    v_mul_u32_u24 v124, 28, v10
    v_sub_u32 v11, v11, v124
    v_mul_u32_u24 v124, 7168, v10
    v_lshrrev_b32 v10, 1, v10
    v_and_b32 v10, 2, v10
    v_xor_b32 v11, v11, v10
    v_lshl_add_u32 v124, v11, 4, v124
    v_add_u32 v11, 256, v1
    v_mul_u32_u24 v10, 2341, v11
    v_lshrrev_b32 v10, 16, v10
    v_mul_u32_u24 v125, 28, v10
    v_sub_u32 v11, v11, v125
    v_mul_u32_u24 v125, 7168, v10
    v_lshrrev_b32 v10, 1, v10
    v_and_b32 v10, 2, v10
    v_xor_b32 v11, v11, v10
    v_lshl_add_u32 v125, v11, 4, v125
    v_add_u32 v11, 320, v1
    v_mul_u32_u24 v10, 2341, v11
    v_lshrrev_b32 v10, 16, v10
    v_mul_u32_u24 v126, 28, v10
    v_sub_u32 v11, v11, v126
    v_mul_u32_u24 v126, 7168, v10
    v_lshrrev_b32 v10, 1, v10
    v_and_b32 v10, 2, v10
    v_xor_b32 v11, v11, v10
    v_lshl_add_u32 v126, v11, 4, v126
    v_add_u32 v11, 384, v1
    v_mul_u32_u24 v10, 2341, v11
    v_lshrrev_b32 v10, 16, v10
    v_mul_u32_u24 v127, 28, v10
    v_sub_u32 v11, v11, v127
    v_mul_u32_u24 v127, 7168, v10
    v_lshrrev_b32 v10, 1, v10
    v_and_b32 v10, 2, v10
    v_xor_b32 v11, v11, v10
    v_lshl_add_u32 v127, v11, 4, v127
    s_cmp_lg_u32 s30, 4
    s_cbranch_scc1 R_fw
    s_lshl_b32 s36, s28, 13
    s_add_u32 s36, s36, 23592960
    v_lshlrev_b32 v8, 7, v1
    v_add_u32 v8, s36, v8
    s_mov_b32 s53, 0
R_fp:
    buffer_load_dword v6, v8, s[56:59], 0 offen sc1
    s_waitcnt vmcnt(0)
    v_subrev_u32 v6, s52, v6
    v_and_b32 v7, 0xfffff8ff, v6
    v_cmp_eq_u32 vcc, 4, v7
    s_nop 0
    s_cmp_eq_u64 vcc, exec
    s_cbranch_scc1 R_fq
    s_sleep 3
    s_add_u32 s53, s53, 1
    s_cmp_lt_u32 s53, s61
    s_cbranch_scc1 R_fp
    s_mov_b32 s61, 0
R_fq:
    v_lshrrev_b32 v6, 8, v6
    v_mov_b32 v7, 162844
    ds_add_u32 v7, v6
R_fw:
    s_waitcnt vmcnt(0)
FR_end:
    v_and_b32 v81, 7, v0
    v_lshlrev_b32 v72, 6, v81
    v_add_u32 v72, 161792, v72
    s_lshl_b32 s35, s30, 3
    v_add_u32 v71, s35, v72
    v_lshlrev_b32 v12, 16, v86
    v_and_b32 v13, 0xffff0000, v86
    v_lshlrev_b32 v14, 16, v87
    v_and_b32 v15, 0xffff0000, v87
    v_lshlrev_b32 v16, 16, v88
    v_and_b32 v17, 0xffff0000, v88
    v_lshlrev_b32 v18, 16, v89
    v_and_b32 v19, 0xffff0000, v89
    v_lshlrev_b32 v20, 16, v90
    v_and_b32 v21, 0xffff0000, v90
    v_lshlrev_b32 v22, 16, v91
    v_and_b32 v23, 0xffff0000, v91
    v_lshlrev_b32 v24, 16, v92
    v_and_b32 v25, 0xffff0000, v92
    v_lshlrev_b32 v26, 16, v93
    v_and_b32 v27, 0xffff0000, v93
    v_pk_add_f32 v[48:49], v[12:13], v[14:15]
    v_pk_mul_f32 v[50:51], v[12:13], v[12:13]
    v_pk_fma_f32 v[50:51], v[14:15], v[14:15], v[50:51]
    v_pk_add_f32 v[48:49], v[48:49], v[16:17]
    v_pk_fma_f32 v[50:51], v[16:17], v[16:17], v[50:51]
    v_pk_add_f32 v[48:49], v[48:49], v[18:19]
    v_pk_fma_f32 v[50:51], v[18:19], v[18:19], v[50:51]
    v_pk_add_f32 v[48:49], v[48:49], v[20:21]
    v_pk_fma_f32 v[50:51], v[20:21], v[20:21], v[50:51]
    v_pk_add_f32 v[48:49], v[48:49], v[22:23]
    v_pk_fma_f32 v[50:51], v[22:23], v[22:23], v[50:51]
    v_pk_add_f32 v[48:49], v[48:49], v[24:25]
    v_pk_fma_f32 v[50:51], v[24:25], v[24:25], v[50:51]
    v_pk_add_f32 v[48:49], v[48:49], v[26:27]
    v_pk_fma_f32 v[50:51], v[26:27], v[26:27], v[50:51]
    v_add_f32 v46, v48, v49
    v_add_f32 v47, v50, v51
    s_nop 0
    v_add_f32_dpp v46, v46, v46 row_ror:8 row_mask:0xf bank_mask:0xf
    v_add_f32_dpp v47, v47, v47 row_ror:8 row_mask:0xf bank_mask:0xf
    v_mov_b32 v48, v46
    v_mov_b32 v49, v47
    s_nop 0
    v_permlane16_swap_b32 v46, v48
    v_permlane16_swap_b32 v47, v49
    v_pk_add_f32 v[46:47], v[46:47], v[48:49]
    v_mov_b32 v48, v46
    v_mov_b32 v49, v47
    s_nop 0
    v_permlane32_swap_b32 v46, v48
    v_permlane32_swap_b32 v47, v49
    v_pk_add_f32 v[46:47], v[46:47], v[48:49]
    ds_write_b64 v71, v[46:47] offset:0
    s_waitcnt lgkmcnt(0)
    s_barrier
LAYER:
    v_and_b32 v81, 7, v0
    v_lshlrev_b32 v72, 6, v81
    v_add_u32 v72, 161792, v72
    s_lshl_b32 s35, s30, 3
    v_add_u32 v71, s35, v72
    v_lshrrev_b32 v6, 2, v1
    v_lshlrev_b32 v74, 7, v6
    v_bfe_u32 v6, v6, 1, 2
    s_and_b32 s35, s30, 2
    v_and_b32 v7, 1, v1
    v_or_b32 v7, s35, v7
    v_xor_b32 v6, v6, v7
    v_lshl_add_u32 v74, v6, 5, v74
    v_and_b32 v6, 2, v1
    v_lshl_add_u32 v74, v6, 2, v74
    s_and_b32 s35, s30, 1
    s_lshl_b32 s35, s35, 4
    v_add_u32 v74, s35, v74
    v_add_u32 v75, 65536, v74
    v_add_u32 v76, 131072, v74
    s_cmp_eq_u32 s60, 0
    s_cbranch_scc1 R_l0
    s_lshr_b32 s37, s28, 3
    s_and_b32 s36, s28, 3
    s_lshl2_add_u32 s36, s37, s36
    s_lshl_b32 s36, s36, 19
    s_xor_b32 s37, s37, s94
    s_lshl_b32 s37, s37, 2
    s_xor_b32 s37, s37, s28
    s_and_b32 s37, s37, 4
    s_lshl_b32 s37, s37, 11
    s_add_u32 s36, s36, s37
    s_add_u32 s36, s36, 29360128
    s_add_u32 s12, s4, s36
    s_addc_u32 s13, s5, 0
    s_mov_b32 s14, 516096
    s_mov_b32 s15, 0x20000
    buffer_load_dwordx4 v[86:89], v78, s[12:15], 0 offen offset:0 sc1
    buffer_load_dwordx4 v[90:93], v78, s[12:15], 0 offen offset:2048 sc1
    s_waitcnt vmcnt(2)
    v_lshlrev_b32 v102, 16, v110
    v_and_b32 v103, 0xffff0000, v110
    v_lshlrev_b32 v104, 16, v111
    v_and_b32 v105, 0xffff0000, v111
    v_lshlrev_b32 v106, 16, v112
    v_and_b32 v107, 0xffff0000, v112
    v_lshlrev_b32 v108, 16, v113
    v_and_b32 v109, 0xffff0000, v113
    v_lshlrev_b32 v110, 16, v114
    v_and_b32 v111, 0xffff0000, v114
    v_lshlrev_b32 v112, 16, v115
    v_and_b32 v113, 0xffff0000, v115
    v_lshlrev_b32 v114, 16, v116
    v_and_b32 v115, 0xffff0000, v116
    v_lshlrev_b32 v116, 16, v117
    v_and_b32 v117, 0xffff0000, v117
    s_mov_b32 s53, 0
dw_4:
    s_waitcnt vmcnt(0)
    v_and_b32 v6, v86, v87
    v_and_b32 v7, v90, v91
    v_bitop3_b32 v6, v88, v89, v6 bitop3:0x80
    v_bitop3_b32 v7, v92, v93, v7 bitop3:0x80
    v_bitop3_b32 v6, v6, v7, 1 bitop3:0x80
    v_cmp_eq_u32 vcc, 0, v6
    s_nop 0
    s_cmp_eq_u64 vcc, 0
    s_cbranch_scc1 dok_5
    s_mov_b64 exec, vcc
    s_sleep 2
    buffer_load_dwordx4 v[86:89], v78, s[12:15], 0 offen offset:0 sc1
    buffer_load_dwordx4 v[90:93], v78, s[12:15], 0 offen offset:2048 sc1
    s_add_u32 s53, s53, 1
    s_cmp_lt_u32 s53, s61
    s_cbranch_scc1 dw_4
    s_mov_b32 s61, 0
    s_waitcnt vmcnt(0)
dok_5:
    s_mov_b64 exec, -1
    v_lshlrev_b32 v12, 16, v86
    v_and_b32 v13, 0xffff0000, v86
    v_lshlrev_b32 v14, 16, v87
    v_and_b32 v15, 0xffff0000, v87
    v_lshlrev_b32 v16, 16, v88
    v_and_b32 v17, 0xffff0000, v88
    v_lshlrev_b32 v18, 16, v89
    v_and_b32 v19, 0xffff0000, v89
    v_lshlrev_b32 v20, 16, v90
    v_and_b32 v21, 0xffff0000, v90
    v_lshlrev_b32 v22, 16, v91
    v_and_b32 v23, 0xffff0000, v91
    v_lshlrev_b32 v24, 16, v92
    v_and_b32 v25, 0xffff0000, v92
    v_lshlrev_b32 v26, 16, v93
    v_and_b32 v27, 0xffff0000, v93
    v_pk_add_f32 v[48:49], v[12:13], v[14:15]
    v_pk_mul_f32 v[50:51], v[12:13], v[12:13]
    v_pk_fma_f32 v[50:51], v[14:15], v[14:15], v[50:51]
    v_pk_add_f32 v[48:49], v[48:49], v[16:17]
    v_pk_fma_f32 v[50:51], v[16:17], v[16:17], v[50:51]
    v_pk_add_f32 v[48:49], v[48:49], v[18:19]
    v_pk_fma_f32 v[50:51], v[18:19], v[18:19], v[50:51]
    v_pk_add_f32 v[48:49], v[48:49], v[20:21]
    v_pk_fma_f32 v[50:51], v[20:21], v[20:21], v[50:51]
    v_pk_add_f32 v[48:49], v[48:49], v[22:23]
    v_pk_fma_f32 v[50:51], v[22:23], v[22:23], v[50:51]
    v_pk_add_f32 v[48:49], v[48:49], v[24:25]
    v_pk_fma_f32 v[50:51], v[24:25], v[24:25], v[50:51]
    v_pk_add_f32 v[48:49], v[48:49], v[26:27]
    v_pk_fma_f32 v[50:51], v[26:27], v[26:27], v[50:51]
    v_add_f32 v46, v48, v49
    v_add_f32 v47, v50, v51
    s_nop 0
    v_add_f32_dpp v46, v46, v46 row_ror:8 row_mask:0xf bank_mask:0xf
    v_add_f32_dpp v47, v47, v47 row_ror:8 row_mask:0xf bank_mask:0xf
    v_mov_b32 v48, v46
    v_mov_b32 v49, v47
    s_nop 0
    v_permlane16_swap_b32 v46, v48
    v_permlane16_swap_b32 v47, v49
    v_pk_add_f32 v[46:47], v[46:47], v[48:49]
    v_mov_b32 v48, v46
    v_mov_b32 v49, v47
    s_nop 0
    v_permlane32_swap_b32 v46, v48
    v_permlane32_swap_b32 v47, v49
    v_pk_add_f32 v[46:47], v[46:47], v[48:49]
    ds_write_b64 v71, v[46:47] offset:0
    s_lshl_b32 s22, s60, 24
    s_lshl_b32 s23, s94, 13
    s_add_u32 s22, s22, s23
    s_add_u32 s22, s22, 167772160
    s_add_u32 s20, s4, s22
    s_addc_u32 s21, s5, 0
    s_mov_b32 s22, 8380416
    s_mov_b32 s23, 0x20000
    s_waitcnt lgkmcnt(0)
    s_barrier
    ds_read_b128 v[52:55], v72 offset:0
    ds_read_b128 v[56:59], v72 offset:16
    ds_read_b128 v[60:63], v72 offset:32
    ds_read_b128 v[64:67], v72 offset:48
    s_waitcnt lgkmcnt(0)
    v_pk_add_f32 v[52:53], v[52:53], v[54:55]
    v_pk_add_f32 v[56:57], v[56:57], v[58:59]
    v_pk_add_f32 v[60:61], v[60:61], v[62:63]
    v_pk_add_f32 v[64:65], v[64:65], v[66:67]
    v_pk_add_f32 v[52:53], v[52:53], v[56:57]
    v_pk_add_f32 v[60:61], v[60:61], v[64:65]
    v_pk_add_f32 v[52:53], v[52:53], v[60:61]
    v_mul_f32 v68, 0x3a800000, v52
    v_mul_f32 v70, 0x3a800000, v53
    v_fma_f32 v70, -v68, v68, v70
    v_max_f32 v70, 0, v70
    v_cvt_pk_bf16_f32 v68, v68, v68
    v_lshlrev_b32 v68, 16, v68
    v_cvt_pk_bf16_f32 v70, v70, v70
    v_lshlrev_b32 v70, 16, v70
    v_add_f32 v70, 0x3727c5ac, v70
    v_cvt_pk_bf16_f32 v70, v70, v70
    v_lshlrev_b32 v70, 16, v70
    v_sqrt_f32 v70, v70
    s_nop 0
    v_cvt_pk_bf16_f32 v70, v70, v70
    v_lshlrev_b32 v70, 16, v70
    v_rcp_f32 v69, v70
    s_nop 0
    v_mul_f32 v68, -v68, v69
    v_pk_fma_f32 v[28:29], v[12:13], v[68:69], v[68:69] op_sel:[0,1,0] op_sel_hi:[1,1,0]
    v_pk_fma_f32 v[30:31], v[14:15], v[68:69], v[68:69] op_sel:[0,1,0] op_sel_hi:[1,1,0]
    v_pk_fma_f32 v[32:33], v[16:17], v[68:69], v[68:69] op_sel:[0,1,0] op_sel_hi:[1,1,0]
    v_pk_fma_f32 v[34:35], v[18:19], v[68:69], v[68:69] op_sel:[0,1,0] op_sel_hi:[1,1,0]
    v_pk_fma_f32 v[36:37], v[20:21], v[68:69], v[68:69] op_sel:[0,1,0] op_sel_hi:[1,1,0]
    v_pk_fma_f32 v[38:39], v[22:23], v[68:69], v[68:69] op_sel:[0,1,0] op_sel_hi:[1,1,0]
    v_pk_fma_f32 v[40:41], v[24:25], v[68:69], v[68:69] op_sel:[0,1,0] op_sel_hi:[1,1,0]
    v_pk_fma_f32 v[42:43], v[26:27], v[68:69], v[68:69] op_sel:[0,1,0] op_sel_hi:[1,1,0]
    s_branch R_s2
R_l0:
    s_cmp_lt_u32 s30, 4
    s_cbranch_scc1 R_f2
    s_and_b32 s36, s30, 3
    s_lshl_b32 s36, s36, 10
    v_add_u32 v8, s36, v2
    v_add_u32 v9, 65536, v8
    ds_write_b128 v8, v[28:31] offset:49152
    ds_write_b128 v8, v[32:35] offset:53248
    ds_write_b128 v8, v[36:39] offset:57344
    ds_write_b128 v8, v[40:43] offset:61440
    ds_write_b128 v9, v[52:55] offset:0
    ds_write_b128 v9, v[56:59] offset:4096
    ds_write_b128 v9, v[60:63] offset:8192
    ds_write_b128 v9, v[64:67] offset:12288
    ds_write_b128 v8, v[94:97] offset:24576
    ds_write_b128 v8, v[98:101] offset:28672
R_f2:
    v_mov_b32 v6, 162844
    ds_read_b32 v7, v6
    ds_read_b128 v[52:55], v72 offset:0
    ds_read_b128 v[56:59], v72 offset:16
    ds_read_b128 v[60:63], v72 offset:32
    ds_read_b128 v[64:67], v72 offset:48
    s_waitcnt lgkmcnt(0)
    v_pk_add_f32 v[52:53], v[52:53], v[54:55]
    v_pk_add_f32 v[56:57], v[56:57], v[58:59]
    v_pk_add_f32 v[60:61], v[60:61], v[62:63]
    v_pk_add_f32 v[64:65], v[64:65], v[66:67]
    v_pk_add_f32 v[52:53], v[52:53], v[56:57]
    v_pk_add_f32 v[60:61], v[60:61], v[64:65]
    v_pk_add_f32 v[52:53], v[52:53], v[60:61]
    v_mul_f32 v68, 0x3a800000, v52
    v_mul_f32 v70, 0x3a800000, v53
    v_fma_f32 v70, -v68, v68, v70
    v_max_f32 v70, 0, v70
    v_cvt_pk_bf16_f32 v68, v68, v68
    v_lshlrev_b32 v68, 16, v68
    v_cvt_pk_bf16_f32 v70, v70, v70
    v_lshlrev_b32 v70, 16, v70
    v_add_f32 v70, 0x3727c5ac, v70
    v_cvt_pk_bf16_f32 v70, v70, v70
    v_lshlrev_b32 v70, 16, v70
    v_sqrt_f32 v70, v70
    s_nop 0
    v_cvt_pk_bf16_f32 v70, v70, v70
    v_lshlrev_b32 v70, 16, v70
    v_rcp_f32 v69, v70
    s_nop 0
    v_mul_f32 v68, -v68, v69
    v_pk_fma_f32 v[28:29], v[12:13], v[68:69], v[68:69] op_sel:[0,1,0] op_sel_hi:[1,1,0]
    v_pk_fma_f32 v[30:31], v[14:15], v[68:69], v[68:69] op_sel:[0,1,0] op_sel_hi:[1,1,0]
    v_pk_fma_f32 v[32:33], v[16:17], v[68:69], v[68:69] op_sel:[0,1,0] op_sel_hi:[1,1,0]
    v_pk_fma_f32 v[34:35], v[18:19], v[68:69], v[68:69] op_sel:[0,1,0] op_sel_hi:[1,1,0]
    v_pk_fma_f32 v[36:37], v[20:21], v[68:69], v[68:69] op_sel:[0,1,0] op_sel_hi:[1,1,0]
    v_pk_fma_f32 v[38:39], v[22:23], v[68:69], v[68:69] op_sel:[0,1,0] op_sel_hi:[1,1,0]
    v_pk_fma_f32 v[40:41], v[24:25], v[68:69], v[68:69] op_sel:[0,1,0] op_sel_hi:[1,1,0]
    v_pk_fma_f32 v[42:43], v[26:27], v[68:69], v[68:69] op_sel:[0,1,0] op_sel_hi:[1,1,0]
    v_readfirstlane_b32 s94, v7
    s_nop 0
    s_cmp_gt_u32 s94, 127
    s_cselect_b32 s94, 1, 0
    s_lshr_b32 s53, s28, 3
    s_lshl_b32 s53, s53, 2
    s_and_b32 s54, s28, 3
    s_add_u32 s53, s53, s54
    s_lshl_b32 s53, s53, 23
    s_lshr_b32 s54, s28, 2
    s_xor_b32 s54, s54, s94
    s_and_b32 s54, s54, 1
    s_lshl_b32 s54, s54, 13
    s_add_u32 s55, s53, s54
    s_add_u32 s55, s55, 33554432
    s_add_u32 s62, s4, s55
    s_addc_u32 s63, s5, 0
    s_sub_u32 s36, s28, 1
    s_max_i32 s36, s36, 0
    s_lshr_b32 s53, s36, 3
    s_lshl_b32 s53, s53, 2
    s_and_b32 s54, s36, 3
    s_add_u32 s53, s53, s54
    s_lshl_b32 s53, s53, 23
    s_lshr_b32 s54, s36, 2
    s_xor_b32 s54, s54, s94
    s_and_b32 s54, s54, 1
    s_lshl_b32 s54, s54, 13
    s_add_u32 s92, s53, s54
    s_add_u32 s92, s92, 33554432
    s_sub_u32 s92, s92, s55
    s_add_u32 s36, s28, 1
    s_min_u32 s36, s36, 15
    s_lshr_b32 s53, s36, 3
    s_lshl_b32 s53, s53, 2
    s_and_b32 s54, s36, 3
    s_add_u32 s53, s53, s54
    s_lshl_b32 s53, s53, 23
    s_lshr_b32 s54, s36, 2
    s_xor_b32 s54, s54, s94
    s_and_b32 s54, s54, 1
    s_lshl_b32 s54, s54, 13
    s_add_u32 s93, s53, s54
    s_add_u32 s93, s93, 33554432
    s_sub_u32 s93, s93, s55
    s_add_u32 s55, s55, 1835008
    s_lshl_b32 s22, s60, 24
    s_lshl_b32 s23, s94, 13
    s_add_u32 s22, s22, s23
    s_add_u32 s22, s22, 167772160
    s_add_u32 s20, s4, s22
    s_addc_u32 s21, s5, 0
    s_mov_b32 s22, 8380416
    s_mov_b32 s23, 0x20000
    s_add_u32 s80, s4, 0x1800000
    s_addc_u32 s81, s5, 0
    s_mov_b32 s82, 0x400000
    s_mov_b32 s83, 0x20000
    s_mov_b32 s78, 0
    buffer_load_dwordx2 v[110:111], v79, s[80:83], s78 offen sc1
    s_mov_b32 s78, 65536
    buffer_load_dwordx2 v[112:113], v79, s[80:83], s78 offen sc1
    s_mov_b32 s78, 262144
    buffer_load_dwordx2 v[114:115], v79, s[80:83], s78 offen sc1
    s_mov_b32 s78, 327680
    buffer_load_dwordx2 v[116:117], v79, s[80:83], s78 offen sc1
    s_cmp_lt_u32 s30, 4
    s_cbranch_scc1 R_f3
    s_and_b32 s36, s30, 3
    s_lshl_b32 s36, s36, 10
    v_add_u32 v8, s36, v2
    v_add_u32 v9, 65536, v8
    ds_write_b128 v8, v[128:131] offset:0
    ds_write_b128 v8, v[136:139] offset:4096
    ds_write_b128 v8, v[144:147] offset:8192
    ds_write_b128 v8, v[152:155] offset:12288
    ds_write_b128 v8, v[160:163] offset:16384
    ds_write_b128 v8, v[168:171] offset:20480
    ds_write_b128 v9, v[176:179] offset:16384
    ds_write_b128 v9, v[184:187] offset:20480
    ds_write_b128 v9, v[192:195] offset:24576
    ds_write_b128 v9, v[200:203] offset:28672
    ds_write_b128 v8, v[208:211] offset:32768
    ds_write_b128 v8, v[216:219] offset:36864
    ds_write_b128 v8, v[224:227] offset:40960
    ds_write_b128 v8, v[232:235] offset:45056
    ds_write_b128 v9, v[240:243] offset:32768
    ds_write_b128 v9, v[248:251] offset:36864
R_f3:
    s_mov_b32 s53, 0
dw_6:
    s_waitcnt vmcnt(0)
    v_and_b32 v6, v110, v111
    v_and_b32 v7, v114, v115
    v_bitop3_b32 v6, v112, v113, v6 bitop3:0x80
    v_bitop3_b32 v7, v116, v117, v7 bitop3:0x80
    v_bitop3_b32 v6, v6, v7, 1 bitop3:0x80
    v_cmp_eq_u32 vcc, 0, v6
    s_nop 0
    s_cmp_eq_u64 vcc, 0
    s_cbranch_scc1 dok_7
    s_mov_b64 exec, vcc
    s_sleep 4
    s_mov_b32 s78, 0
    buffer_load_dwordx2 v[110:111], v79, s[80:83], s78 offen sc1
    s_mov_b32 s78, 65536
    buffer_load_dwordx2 v[112:113], v79, s[80:83], s78 offen sc1
    s_mov_b32 s78, 262144
    buffer_load_dwordx2 v[114:115], v79, s[80:83], s78 offen sc1
    s_mov_b32 s78, 327680
    buffer_load_dwordx2 v[116:117], v79, s[80:83], s78 offen sc1
    s_add_u32 s53, s53, 1
    s_cmp_lt_u32 s53, s61
    s_cbranch_scc1 dw_6
    s_mov_b32 s61, 0
    s_waitcnt vmcnt(0)
dok_7:
    s_mov_b64 exec, -1
    v_lshlrev_b32 v102, 16, v110
    v_and_b32 v103, 0xffff0000, v110
    v_lshlrev_b32 v104, 16, v111
    v_and_b32 v105, 0xffff0000, v111
    v_lshlrev_b32 v106, 16, v112
    v_and_b32 v107, 0xffff0000, v112
    v_lshlrev_b32 v108, 16, v113
    v_and_b32 v109, 0xffff0000, v113
    v_lshlrev_b32 v110, 16, v114
    v_and_b32 v111, 0xffff0000, v114
    v_lshlrev_b32 v112, 16, v115
    v_and_b32 v113, 0xffff0000, v115
    v_lshlrev_b32 v114, 16, v116
    v_and_b32 v115, 0xffff0000, v116
    v_lshlrev_b32 v116, 16, v117
    v_and_b32 v117, 0xffff0000, v117
R_s2:
    v_pk_fma_f32 v[12:13], v[28:29], v[102:103], v[12:13]
    v_pk_fma_f32 v[14:15], v[30:31], v[104:105], v[14:15]
    v_pk_fma_f32 v[16:17], v[32:33], v[106:107], v[16:17]
    v_pk_fma_f32 v[18:19], v[34:35], v[108:109], v[18:19]
    v_cvt_pk_bf16_f32 v86, v12, v13
    v_cvt_pk_bf16_f32 v87, v14, v15
    v_cvt_pk_bf16_f32 v88, v16, v17
    v_cvt_pk_bf16_f32 v89, v18, v19
    buffer_store_dwordx4 v[86:89], v82, s[20:23], 0 offen offset:0 sc1
    v_pk_fma_f32 v[20:21], v[36:37], v[110:111], v[20:21]
    v_pk_fma_f32 v[22:23], v[38:39], v[112:113], v[22:23]
    v_pk_fma_f32 v[24:25], v[40:41], v[114:115], v[24:25]
    v_pk_fma_f32 v[26:27], v[42:43], v[116:117], v[26:27]
    v_cvt_pk_bf16_f32 v90, v20, v21
    v_cvt_pk_bf16_f32 v91, v22, v23
    v_cvt_pk_bf16_f32 v92, v24, v25
    v_cvt_pk_bf16_f32 v93, v26, v27
    buffer_store_dwordx4 v[90:93], v82, s[20:23], 0 offen offset:128 sc1
    v_pk_add_f32 v[48:49], v[12:13], v[14:15]
    v_pk_mul_f32 v[50:51], v[12:13], v[12:13]
    v_pk_fma_f32 v[50:51], v[14:15], v[14:15], v[50:51]
    v_pk_add_f32 v[48:49], v[48:49], v[16:17]
    v_pk_fma_f32 v[50:51], v[16:17], v[16:17], v[50:51]
    v_pk_add_f32 v[48:49], v[48:49], v[18:19]
    v_pk_fma_f32 v[50:51], v[18:19], v[18:19], v[50:51]
    v_pk_add_f32 v[48:49], v[48:49], v[20:21]
    v_pk_fma_f32 v[50:51], v[20:21], v[20:21], v[50:51]
    v_pk_add_f32 v[48:49], v[48:49], v[22:23]
    v_pk_fma_f32 v[50:51], v[22:23], v[22:23], v[50:51]
    v_pk_add_f32 v[48:49], v[48:49], v[24:25]
    v_pk_fma_f32 v[50:51], v[24:25], v[24:25], v[50:51]
    v_pk_add_f32 v[48:49], v[48:49], v[26:27]
    v_pk_fma_f32 v[50:51], v[26:27], v[26:27], v[50:51]
    v_add_f32 v46, v48, v49
    v_add_f32 v47, v50, v51
    s_nop 0
    v_add_f32_dpp v46, v46, v46 row_ror:8 row_mask:0xf bank_mask:0xf
    v_add_f32_dpp v47, v47, v47 row_ror:8 row_mask:0xf bank_mask:0xf
    v_mov_b32 v48, v46
    v_mov_b32 v49, v47
    s_nop 0
    v_permlane16_swap_b32 v46, v48
    v_permlane16_swap_b32 v47, v49
    v_pk_add_f32 v[46:47], v[46:47], v[48:49]
    v_mov_b32 v48, v46
    v_mov_b32 v49, v47
    s_nop 0
    v_permlane32_swap_b32 v46, v48
    v_permlane32_swap_b32 v47, v49
    v_pk_add_f32 v[46:47], v[46:47], v[48:49]
    ds_write_b64 v71, v[46:47] offset:1536
    s_waitcnt lgkmcnt(0)
    s_barrier
    s_cmp_ge_u32 s30, 4
    s_cbranch_scc1 LOADERS
    s_cmp_lg_u32 s30, 3
    s_cbranch_scc1 R_nl
    ds_read_b128 v[52:55], v72 offset:1536
    ds_read_b128 v[56:59], v72 offset:1552
    ds_read_b128 v[60:63], v72 offset:1568
    ds_read_b128 v[64:67], v72 offset:1584
    s_waitcnt lgkmcnt(0)
    v_pk_add_f32 v[52:53], v[52:53], v[54:55]
    v_pk_add_f32 v[56:57], v[56:57], v[58:59]
    v_pk_add_f32 v[60:61], v[60:61], v[62:63]
    v_pk_add_f32 v[64:65], v[64:65], v[66:67]
    v_pk_add_f32 v[52:53], v[52:53], v[56:57]
    v_pk_add_f32 v[60:61], v[60:61], v[64:65]
    v_pk_add_f32 v[52:53], v[52:53], v[60:61]
    v_mul_f32 v68, 0x3a800000, v52
    v_mul_f32 v70, 0x3a800000, v53
    v_fma_f32 v70, -v68, v68, v70
    v_max_f32 v70, 0, v70
    v_mov_b32 v32, v68
    v_mov_b32 v33, v70
    v_cvt_pk_bf16_f32 v68, v68, v68
    v_lshlrev_b32 v68, 16, v68
    v_cvt_pk_bf16_f32 v70, v70, v70
    v_lshlrev_b32 v70, 16, v70
    v_add_f32 v70, 0x3727c5ac, v70
    v_cvt_pk_bf16_f32 v70, v70, v70
    v_lshlrev_b32 v70, 16, v70
    v_sqrt_f32 v70, v70
    s_nop 0
    v_cvt_pk_bf16_f32 v70, v70, v70
    v_lshlrev_b32 v70, 16, v70
    v_rcp_f32 v69, v70
    v_sub_f32 v32, v32, v68
    v_mul_f32 v32, v32, v69
    v_mul_f32 v33, v33, v69
    v_mul_f32 v33, v33, v69
    v_cvt_pk_bf16_f32 v32, v32, v32
    v_lshlrev_b32 v32, 16, v32
    v_cvt_pk_bf16_f32 v33, v33, v33
    v_lshlrev_b32 v33, 16, v33
    v_add_f32 v33, 0x3727c5ac, v33
    v_cvt_pk_bf16_f32 v33, v33, v33
    v_lshlrev_b32 v33, 16, v33
    v_sqrt_f32 v33, v33
    s_nop 0
    v_cvt_pk_bf16_f32 v33, v33, v33
    v_lshlrev_b32 v33, 16, v33
    v_cvt_pk_bf16_f32 v28, v68, v70
    v_cvt_pk_bf16_f32 v30, v32, v33
    v_mov_b32 v29, s52
    v_mov_b32 v31, s52
    s_lshl_b32 s26, s60, 15
    s_add_u32 s26, s26, 23199744
    s_add_u32 s24, s4, s26
    s_addc_u32 s25, s5, 0
    s_mov_b32 s26, 32768
    s_mov_b32 s27, 0x20000
    s_lshl_b32 s36, s28, 4
    s_add_u32 s36, s36, s29
    s_lshl_b32 s36, s36, 7
    s_mov_b64 exec, 0xff
    buffer_store_dwordx4 v[28:31], v2, s[24:27], s36 offen sc1
    s_mov_b64 exec, -1
R_nl:
    v_mov_b32 v6, 1
    v_mov_b32 v7, 0
    s_cmp_eq_u32 s30, 3
    s_waitcnt vmcnt(1)
    s_cbranch_scc1 R_n2
    s_waitcnt vmcnt(0)
R_n2:
    s_barrier
    s_cmp_lg_u32 s30, 0
    s_cbranch_scc1 R_n3
    s_mov_b64 exec, 1
    buffer_atomic_add v6, v7, s[56:59], s55 offen sc1
    s_mov_b64 exec, -1
R_n3:
    ds_read_b64_tr_b16 v[180:181], v75 offset:49152
    ds_read_b64_tr_b16 v[182:183], v75 offset:51200
    ds_read_b64_tr_b16 v[188:189], v75 offset:53248
    ds_read_b64_tr_b16 v[190:191], v75 offset:55296
    ds_read_b64_tr_b16 v[196:197], v75 offset:57344
    ds_read_b64_tr_b16 v[198:199], v75 offset:59392
    ds_read_b64_tr_b16 v[204:205], v75 offset:61440
    ds_read_b64_tr_b16 v[206:207], v75 offset:63488
    ds_read_b64_tr_b16 v[244:245], v76 offset:16384
    ds_read_b64_tr_b16 v[246:247], v76 offset:18432
    ds_read_b64_tr_b16 v[252:253], v76 offset:20480
    ds_read_b64_tr_b16 v[254:255], v76 offset:22528
    ds_read_b64_tr_b16 v[212:213], v76 offset:0
    ds_read_b64_tr_b16 v[214:215], v76 offset:2048
    ds_read_b64_tr_b16 v[220:221], v76 offset:4096
    ds_read_b64_tr_b16 v[222:223], v76 offset:6144
    ds_read_b64_tr_b16 v[228:229], v76 offset:8192
    ds_read_b64_tr_b16 v[230:231], v76 offset:10240
    ds_read_b64_tr_b16 v[236:237], v76 offset:12288
    ds_read_b64_tr_b16 v[238:239], v76 offset:14336
    ds_read_b64_tr_b16 v[176:177], v74 offset:49152
    ds_read_b64_tr_b16 v[178:179], v74 offset:51200
    ds_read_b64_tr_b16 v[184:185], v74 offset:53248
    ds_read_b64_tr_b16 v[186:187], v74 offset:55296
    ds_read_b64_tr_b16 v[192:193], v74 offset:57344
    ds_read_b64_tr_b16 v[194:195], v74 offset:59392
    ds_read_b64_tr_b16 v[200:201], v74 offset:61440
    ds_read_b64_tr_b16 v[202:203], v74 offset:63488
    ds_read_b64_tr_b16 v[208:209], v75 offset:0
    ds_read_b64_tr_b16 v[210:211], v75 offset:2048
    ds_read_b64_tr_b16 v[216:217], v75 offset:4096
    ds_read_b64_tr_b16 v[218:219], v75 offset:6144
    ds_read_b64_tr_b16 v[224:225], v75 offset:8192
    ds_read_b64_tr_b16 v[226:227], v75 offset:10240
    ds_read_b64_tr_b16 v[232:233], v75 offset:12288
    ds_read_b64_tr_b16 v[234:235], v75 offset:14336
    ds_read_b64_tr_b16 v[128:129], v74 offset:24576
    ds_read_b64_tr_b16 v[130:131], v74 offset:26624
    ds_read_b64_tr_b16 v[136:137], v74 offset:28672
    ds_read_b64_tr_b16 v[138:139], v74 offset:30720
    v_and_b32 v8, 15, v1
    v_lshrrev_b32 v9, 4, v1
    v_xor_b32 v6, v9, v8
    v_lshlrev_b32 v7, 8, v8
    v_xor_b32 v10, 0, v6
    v_lshl_add_u32 v10, v10, 4, v7
    v_add_u32 v14, 106496, v10
    v_xor_b32 v11, 4, v6
    v_lshl_add_u32 v11, v11, 4, v7
    v_add_u32 v15, 106496, v11
    v_xor_b32 v12, 8, v6
    v_lshl_add_u32 v12, v12, 4, v7
    v_add_u32 v16, 106496, v12
    v_xor_b32 v13, 12, v6
    v_lshl_add_u32 v13, v13, 4, v7
    v_add_u32 v17, 106496, v13
    v_lshlrev_b32 v18, 4, v8
    v_add_u32 v18, 155648, v18
    s_add_u32 s16, s62, 0x400000
    s_addc_u32 s17, s63, 0
    s_mov_b32 s18, 0x7e000
    s_mov_b32 s19, 0x20000
    v_and_b32 v6, 1, v9
    v_lshlrev_b32 v114, 16, v6
    v_lshrrev_b32 v6, 1, v9
    v_lshl_add_u32 v114, v6, 8, v114
    v_lshl_add_u32 v114, v8, 4, v114
    s_bfe_u32 s36, s30, 0x10001
    s_lshl1_add_u32 s36, s29, s36
    s_xor_b32 s36, s36, 2
    s_lshr_b32 s53, s36, 3
    s_lshl_b32 s53, s53, 14
    s_and_b32 s39, s36, 7
    s_lshl_b32 s39, s39, 10
    s_add_u32 s39, s39, s53
    s_and_b32 s36, s30, 1
    s_lshl_b32 s36, s36, 9
    s_add_u32 s39, s39, s36
    s_and_b32 s12, s30, 3
    s_lshl_b32 s12, s12, 15
    s_add_u32 s53, s67, 0
    s_and_b32 s8, s53, 4
    s_and_b32 s53, s53, 2
    s_lshl_b32 s8, s8, 12
    s_lshl_b32 s53, s53, 11
    s_add_u32 s8, s8, s53
    s_add_u32 s8, s8, s12
    s_add_u32 s53, s67, 2
    s_and_b32 s9, s53, 4
    s_and_b32 s53, s53, 2
    s_lshl_b32 s9, s9, 12
    s_lshl_b32 s53, s53, 11
    s_add_u32 s9, s9, s53
    s_add_u32 s9, s9, s12
    s_add_u32 s53, s67, 4
    s_and_b32 s10, s53, 4
    s_and_b32 s53, s53, 2
    s_lshl_b32 s10, s10, 12
    s_lshl_b32 s53, s53, 11
    s_add_u32 s10, s10, s53
    s_add_u32 s10, s10, s12
    s_add_u32 s53, s67, 6
    s_and_b32 s11, s53, 4
    s_and_b32 s53, s53, 2
    s_lshl_b32 s11, s11, 12
    s_lshl_b32 s53, s53, 11
    s_add_u32 s11, s11, s53
    s_add_u32 s11, s11, s12
    s_and_b32 s53, s30, 2
    s_lshl_b32 s53, s53, 11
    s_and_b32 s12, s30, 1
    s_lshl_b32 s12, s12, 13
    s_add_u32 s12, s12, s53
    s_and_b32 s20, s30, 1
    s_lshl_b32 s20, s20, 8
    s_add_u32 s20, s20, s55
    s_add_u32 s21, s52, 16
    v_mov_b32 v112, 0x7f000000
    v_writelane_b32 v112, 0, 0
    v_mov_b32 v113, 1
    s_and_b32 s40, s30, 1
    s_lshl1_add_u32 s40, s31, s40
    s_lshl_b32 s40, s40, 7
    s_add_u32 s40, s40, s55
    s_barrier
    ds_read_b64_tr_b16 v[240:241], v75 offset:16384
    ds_read_b64_tr_b16 v[242:243], v75 offset:18432
    ds_read_b64_tr_b16 v[248:249], v75 offset:20480
    ds_read_b64_tr_b16 v[250:251], v75 offset:22528
    ds_read_b64_tr_b16 v[132:133], v75 offset:24576
    ds_read_b64_tr_b16 v[134:135], v75 offset:26624
    ds_read_b64_tr_b16 v[140:141], v75 offset:28672
    ds_read_b64_tr_b16 v[142:143], v75 offset:30720
    ds_read_b64_tr_b16 v[144:145], v74 offset:32768
    ds_read_b64_tr_b16 v[146:147], v74 offset:34816
    ds_read_b64_tr_b16 v[152:153], v74 offset:36864
    ds_read_b64_tr_b16 v[154:155], v74 offset:38912
    ds_read_b64_tr_b16 v[160:161], v74 offset:40960
    ds_read_b64_tr_b16 v[162:163], v74 offset:43008
    ds_read_b64_tr_b16 v[168:169], v74 offset:45056
    ds_read_b64_tr_b16 v[170:171], v74 offset:47104
    ds_read_b64_tr_b16 v[148:149], v75 offset:32768
    ds_read_b64_tr_b16 v[150:151], v75 offset:34816
    ds_read_b64_tr_b16 v[156:157], v75 offset:36864
    ds_read_b64_tr_b16 v[158:159], v75 offset:38912
    ds_read_b64_tr_b16 v[164:165], v75 offset:40960
    ds_read_b64_tr_b16 v[166:167], v75 offset:43008
    ds_read_b64_tr_b16 v[172:173], v75 offset:45056
    ds_read_b64_tr_b16 v[174:175], v75 offset:47104
    v_mov_b32 v88, 0x3f803f80
    v_mov_b32 v89, 0x3f803f80
    v_mov_b32 v90, 0x3f803f80
    v_mov_b32 v91, 0x3f803f80
    s_cmp_lg_u32 s30, 0
    s_cbranch_scc1 pdone_8
    s_add_u32 s54, s55, 0
    s_bitcmp1_b32 s29, 2
    s_cselect_b32 s53, s93, s92
    s_add_u32 s53, s53, s54
    v_mov_b32 v105, s54
    v_writelane_b32 v105, s53, 1
    s_mov_b32 s53, 0
    s_add_u32 s54, s52, 16
    s_bfm_b64 exec, 2, 0
poll_9:
    buffer_load_dword v104, v105, s[56:59], 0 offen sc1
    s_waitcnt vmcnt(0)
    v_cmp_eq_u32 vcc, s54, v104
    s_nop 0
    s_cmp_eq_u64 vcc, exec
    s_cbranch_scc1 pok_10
    s_sleep 3
    s_add_u32 s53, s53, 1
    s_cmp_lt_u32 s53, s61
    s_cbranch_scc1 poll_9
    s_mov_b32 s61, 0
pok_10:
    s_mov_b64 exec, -1
pdone_8:
    s_waitcnt lgkmcnt(0)
    s_barrier
    v_mfma_f32_16x16x32_bf16 v[84:87], v[128:131], v[88:91], 0
    v_mfma_f32_16x16x32_bf16 v[84:87], v[132:135], v[88:91], v[84:87]
    v_mfma_f32_16x16x32_bf16 v[84:87], v[136:139], v[88:91], v[84:87]
    v_mfma_f32_16x16x32_bf16 v[84:87], v[140:143], v[88:91], v[84:87]
    v_mfma_f32_16x16x32_bf16 v[84:87], v[144:147], v[88:91], v[84:87]
    v_mfma_f32_16x16x32_bf16 v[84:87], v[148:151], v[88:91], v[84:87]
    v_mfma_f32_16x16x32_bf16 v[84:87], v[152:155], v[88:91], v[84:87]
    v_mfma_f32_16x16x32_bf16 v[84:87], v[156:159], v[88:91], v[84:87]
    v_mfma_f32_16x16x32_bf16 v[84:87], v[160:163], v[88:91], v[84:87]
    v_mfma_f32_16x16x32_bf16 v[84:87], v[164:167], v[88:91], v[84:87]
    v_mfma_f32_16x16x32_bf16 v[84:87], v[168:171], v[88:91], v[84:87]
    v_mfma_f32_16x16x32_bf16 v[84:87], v[172:175], v[88:91], v[84:87]
    v_mfma_f32_16x16x32_bf16 v[84:87], v[176:179], v[88:91], v[84:87]
    v_mfma_f32_16x16x32_bf16 v[84:87], v[180:183], v[88:91], v[84:87]
    v_mfma_f32_16x16x32_bf16 v[84:87], v[184:187], v[88:91], v[84:87]
    v_mfma_f32_16x16x32_bf16 v[84:87], v[188:191], v[88:91], v[84:87]
    v_mfma_f32_16x16x32_bf16 v[84:87], v[192:195], v[88:91], v[84:87]
    v_mfma_f32_16x16x32_bf16 v[84:87], v[196:199], v[88:91], v[84:87]
    v_mfma_f32_16x16x32_bf16 v[84:87], v[200:203], v[88:91], v[84:87]
    v_mfma_f32_16x16x32_bf16 v[84:87], v[204:207], v[88:91], v[84:87]
    v_mfma_f32_16x16x32_bf16 v[84:87], v[208:211], v[88:91], v[84:87]
    v_mfma_f32_16x16x32_bf16 v[84:87], v[212:215], v[88:91], v[84:87]
    v_mfma_f32_16x16x32_bf16 v[84:87], v[216:219], v[88:91], v[84:87]
    v_mfma_f32_16x16x32_bf16 v[84:87], v[220:223], v[88:91], v[84:87]
    v_mfma_f32_16x16x32_bf16 v[84:87], v[224:227], v[88:91], v[84:87]
    v_mfma_f32_16x16x32_bf16 v[84:87], v[228:231], v[88:91], v[84:87]
    v_mfma_f32_16x16x32_bf16 v[84:87], v[232:235], v[88:91], v[84:87]
    v_mfma_f32_16x16x32_bf16 v[84:87], v[236:239], v[88:91], v[84:87]
    v_mfma_f32_16x16x32_bf16 v[84:87], v[240:243], v[88:91], v[84:87]
    v_mfma_f32_16x16x32_bf16 v[84:87], v[244:247], v[88:91], v[84:87]
    v_mfma_f32_16x16x32_bf16 v[84:87], v[248:251], v[88:91], v[84:87]
    v_mfma_f32_16x16x32_bf16 v[84:87], v[252:255], v[88:91], v[84:87]
    s_barrier
    ds_read_b128 v[36:39], v10 offset:16384
    ds_read_b128 v[40:43], v10 offset:20480
    ds_read_b128 v[44:47], v10 offset:24576
    ds_read_b128 v[48:51], v10 offset:28672
    ds_read_b128 v[52:55], v11 offset:16384
    ds_read_b128 v[56:59], v11 offset:20480
    ds_read_b128 v[60:63], v11 offset:24576
    ds_read_b128 v[64:67], v11 offset:28672
    s_waitcnt lgkmcnt(4)
    v_mfma_f32_16x16x32_bf16 v[20:23], v[128:131], v[36:39], 0
    ds_read_b128 v[68:71], v12 offset:16384
    v_mfma_f32_16x16x32_bf16 v[24:27], v[128:131], v[40:43], 0
    ds_read_b128 v[72:75], v12 offset:20480
    v_mfma_f32_16x16x32_bf16 v[24:27], v[132:135], v[48:51], v[24:27]
    ds_read_b128 v[76:79], v12 offset:24576
    v_mfma_f32_16x16x32_bf16 v[20:23], v[132:135], v[44:47], v[20:23]
    ds_read_b128 v[80:83], v12 offset:28672
    s_waitcnt lgkmcnt(4)
    v_mfma_f32_16x16x32_bf16 v[20:23], v[136:139], v[52:55], v[20:23]
    ds_read_b128 v[36:39], v13 offset:16384
    v_mfma_f32_16x16x32_bf16 v[24:27], v[136:139], v[56:59], v[24:27]
    ds_read_b128 v[40:43], v13 offset:20480
    v_mfma_f32_16x16x32_bf16 v[24:27], v[140:143], v[64:67], v[24:27]
    ds_read_b128 v[44:47], v13 offset:24576
    v_mfma_f32_16x16x32_bf16 v[20:23], v[140:143], v[60:63], v[20:23]
    ds_read_b128 v[48:51], v13 offset:28672
    s_barrier
    s_waitcnt lgkmcnt(4)
    v_mfma_f32_16x16x32_bf16 v[20:23], v[144:147], v[68:71], v[20:23]
    ds_read_b128 v[52:55], v10 offset:32768
    v_mfma_f32_16x16x32_bf16 v[24:27], v[144:147], v[72:75], v[24:27]
    ds_read_b128 v[56:59], v10 offset:36864
    v_mfma_f32_16x16x32_bf16 v[24:27], v[148:151], v[80:83], v[24:27]
    ds_read_b128 v[60:63], v10 offset:40960
    v_mfma_f32_16x16x32_bf16 v[20:23], v[148:151], v[76:79], v[20:23]
    ds_read_b128 v[64:67], v10 offset:45056
    s_waitcnt lgkmcnt(4)
    v_mfma_f32_16x16x32_bf16 v[20:23], v[152:155], v[36:39], v[20:23]
    ds_read_b128 v[68:71], v11 offset:32768
    v_mfma_f32_16x16x32_bf16 v[24:27], v[152:155], v[40:43], v[24:27]
    ds_read_b128 v[72:75], v11 offset:36864
    v_mfma_f32_16x16x32_bf16 v[24:27], v[156:159], v[48:51], v[24:27]
    ds_read_b128 v[76:79], v11 offset:40960
    v_mfma_f32_16x16x32_bf16 v[20:23], v[156:159], v[44:47], v[20:23]
    ds_read_b128 v[80:83], v11 offset:45056
    s_waitcnt lgkmcnt(4)
    v_mfma_f32_16x16x32_bf16 v[20:23], v[160:163], v[52:55], v[20:23]
    ds_read_b128 v[36:39], v12 offset:32768
    v_mfma_f32_16x16x32_bf16 v[24:27], v[160:163], v[56:59], v[24:27]
    ds_read_b128 v[40:43], v12 offset:36864
    v_mfma_f32_16x16x32_bf16 v[24:27], v[164:167], v[64:67], v[24:27]
    ds_read_b128 v[44:47], v12 offset:40960
    v_mfma_f32_16x16x32_bf16 v[20:23], v[164:167], v[60:63], v[20:23]
    ds_read_b128 v[48:51], v12 offset:45056
    s_waitcnt lgkmcnt(4)
    v_mfma_f32_16x16x32_bf16 v[20:23], v[168:171], v[68:71], v[20:23]
    ds_read_b128 v[52:55], v13 offset:32768
    v_mfma_f32_16x16x32_bf16 v[24:27], v[168:171], v[72:75], v[24:27]
    ds_read_b128 v[56:59], v13 offset:36864
    v_mfma_f32_16x16x32_bf16 v[24:27], v[172:175], v[80:83], v[24:27]
    ds_read_b128 v[60:63], v13 offset:40960
    v_mfma_f32_16x16x32_bf16 v[20:23], v[172:175], v[76:79], v[20:23]
    ds_read_b128 v[64:67], v13 offset:45056
    s_barrier
    s_waitcnt lgkmcnt(4)
    v_mfma_f32_16x16x32_bf16 v[20:23], v[176:179], v[36:39], v[20:23]
    ds_read_b128 v[68:71], v14 offset:0
    v_mfma_f32_16x16x32_bf16 v[24:27], v[176:179], v[40:43], v[24:27]
    ds_read_b128 v[72:75], v14 offset:4096
    v_mfma_f32_16x16x32_bf16 v[24:27], v[180:183], v[48:51], v[24:27]
    ds_read_b128 v[76:79], v14 offset:8192
    v_mfma_f32_16x16x32_bf16 v[20:23], v[180:183], v[44:47], v[20:23]
    ds_read_b128 v[80:83], v14 offset:12288
    s_waitcnt lgkmcnt(4)
    v_mfma_f32_16x16x32_bf16 v[20:23], v[184:187], v[52:55], v[20:23]
    ds_read_b128 v[36:39], v15 offset:0
    v_mfma_f32_16x16x32_bf16 v[24:27], v[184:187], v[56:59], v[24:27]
    ds_read_b128 v[40:43], v15 offset:4096
    v_mfma_f32_16x16x32_bf16 v[24:27], v[188:191], v[64:67], v[24:27]
    ds_read_b128 v[44:47], v15 offset:8192
    v_mfma_f32_16x16x32_bf16 v[20:23], v[188:191], v[60:63], v[20:23]
    ds_read_b128 v[48:51], v15 offset:12288
    s_waitcnt lgkmcnt(4)
    v_mfma_f32_16x16x32_bf16 v[20:23], v[192:195], v[68:71], v[20:23]
    ds_read_b128 v[52:55], v16 offset:0
    v_mfma_f32_16x16x32_bf16 v[24:27], v[192:195], v[72:75], v[24:27]
    ds_read_b128 v[56:59], v16 offset:4096
    v_mfma_f32_16x16x32_bf16 v[24:27], v[196:199], v[80:83], v[24:27]
    ds_read_b128 v[60:63], v16 offset:8192
    v_mfma_f32_16x16x32_bf16 v[20:23], v[196:199], v[76:79], v[20:23]
    ds_read_b128 v[64:67], v16 offset:12288
    s_waitcnt lgkmcnt(4)
    v_mfma_f32_16x16x32_bf16 v[20:23], v[200:203], v[36:39], v[20:23]
    ds_read_b128 v[68:71], v17 offset:0
    v_mfma_f32_16x16x32_bf16 v[24:27], v[200:203], v[40:43], v[24:27]
    ds_read_b128 v[72:75], v17 offset:4096
    v_mfma_f32_16x16x32_bf16 v[24:27], v[204:207], v[48:51], v[24:27]
    ds_read_b128 v[76:79], v17 offset:8192
    v_mfma_f32_16x16x32_bf16 v[20:23], v[204:207], v[44:47], v[20:23]
    ds_read_b128 v[80:83], v17 offset:12288
    s_barrier
    s_waitcnt lgkmcnt(4)
    v_mfma_f32_16x16x32_bf16 v[20:23], v[208:211], v[52:55], v[20:23]
    ds_read_b128 v[36:39], v14 offset:16384
    v_mfma_f32_16x16x32_bf16 v[24:27], v[208:211], v[56:59], v[24:27]
    ds_read_b128 v[40:43], v14 offset:20480
    v_mfma_f32_16x16x32_bf16 v[24:27], v[212:215], v[64:67], v[24:27]
    ds_read_b128 v[44:47], v14 offset:24576
    v_mfma_f32_16x16x32_bf16 v[20:23], v[212:215], v[60:63], v[20:23]
    ds_read_b128 v[48:51], v14 offset:28672
    s_waitcnt lgkmcnt(4)
    v_mfma_f32_16x16x32_bf16 v[20:23], v[216:219], v[68:71], v[20:23]
    ds_read_b128 v[52:55], v15 offset:16384
    v_mfma_f32_16x16x32_bf16 v[24:27], v[216:219], v[72:75], v[24:27]
    ds_read_b128 v[56:59], v15 offset:20480
    v_mfma_f32_16x16x32_bf16 v[24:27], v[220:223], v[80:83], v[24:27]
    ds_read_b128 v[60:63], v15 offset:24576
    v_mfma_f32_16x16x32_bf16 v[20:23], v[220:223], v[76:79], v[20:23]
    ds_read_b128 v[64:67], v15 offset:28672
    s_waitcnt lgkmcnt(4)
    v_mfma_f32_16x16x32_bf16 v[20:23], v[224:227], v[36:39], v[20:23]
    ds_read_b128 v[68:71], v16 offset:16384
    v_mfma_f32_16x16x32_bf16 v[24:27], v[224:227], v[40:43], v[24:27]
    ds_read_b128 v[72:75], v16 offset:20480
    v_mfma_f32_16x16x32_bf16 v[24:27], v[228:231], v[48:51], v[24:27]
    ds_read_b128 v[76:79], v16 offset:24576
    v_mfma_f32_16x16x32_bf16 v[20:23], v[228:231], v[44:47], v[20:23]
    ds_read_b128 v[80:83], v16 offset:28672
    s_waitcnt lgkmcnt(4)
    v_mfma_f32_16x16x32_bf16 v[20:23], v[232:235], v[52:55], v[20:23]
    ds_read_b128 v[36:39], v17 offset:16384
    v_mfma_f32_16x16x32_bf16 v[24:27], v[232:235], v[56:59], v[24:27]
    ds_read_b128 v[40:43], v17 offset:20480
    v_mfma_f32_16x16x32_bf16 v[24:27], v[236:239], v[64:67], v[24:27]
    ds_read_b128 v[44:47], v17 offset:24576
    v_mfma_f32_16x16x32_bf16 v[20:23], v[236:239], v[60:63], v[20:23]
    ds_read_b128 v[48:51], v17 offset:28672
    s_barrier
    ds_read_b128 v[88:91], v18 offset:0
    ds_read_b128 v[92:95], v18 offset:2048
    ds_read_b128 v[96:99], v18 offset:256
    ds_read_b128 v[100:103], v18 offset:2304
    s_waitcnt lgkmcnt(8)
    v_mfma_f32_16x16x32_bf16 v[20:23], v[240:243], v[68:71], v[20:23]
    ds_read_b128 v[52:55], v14 offset:32768
    v_mfma_f32_16x16x32_bf16 v[24:27], v[240:243], v[72:75], v[24:27]
    ds_read_b128 v[56:59], v14 offset:36864
    v_mfma_f32_16x16x32_bf16 v[24:27], v[244:247], v[80:83], v[24:27]
    ds_read_b128 v[60:63], v14 offset:40960
    v_mfma_f32_16x16x32_bf16 v[20:23], v[244:247], v[76:79], v[20:23]
    ds_read_b128 v[64:67], v14 offset:45056
    s_waitcnt lgkmcnt(8)
    v_mfma_f32_16x16x32_bf16 v[20:23], v[248:251], v[36:39], v[20:23]
    ds_read_b128 v[68:71], v15 offset:32768
    v_mfma_f32_16x16x32_bf16 v[24:27], v[248:251], v[40:43], v[24:27]
    ds_read_b128 v[72:75], v15 offset:36864
    v_mfma_f32_16x16x32_bf16 v[24:27], v[252:255], v[48:51], v[24:27]
    ds_read_b128 v[76:79], v15 offset:40960
    v_mfma_f32_16x16x32_bf16 v[20:23], v[252:255], v[44:47], v[20:23]
    ds_read_b128 v[80:83], v15 offset:45056
    s_waitcnt lgkmcnt(4)
    v_mfma_f32_16x16x32_bf16 v[28:31], v[128:131], v[52:55], 0
    ds_read_b128 v[36:39], v16 offset:32768
    v_mfma_f32_16x16x32_bf16 v[32:35], v[128:131], v[56:59], 0
    ds_read_b128 v[40:43], v16 offset:36864
    v_mfma_f32_16x16x32_bf16 v[32:35], v[132:135], v[64:67], v[32:35]
    ds_read_b128 v[44:47], v16 offset:40960
    v_mfma_f32_16x16x32_bf16 v[28:31], v[132:135], v[60:63], v[28:31]
    ds_read_b128 v[48:51], v16 offset:45056
    v_pk_fma_f32 v[20:21], v[88:89], v[84:85], v[20:21]
    v_pk_fma_f32 v[22:23], v[88:89], v[86:87], v[22:23]
    v_pk_fma_f32 v[24:25], v[96:97], v[84:85], v[24:25]
    v_pk_fma_f32 v[26:27], v[96:97], v[86:87], v[26:27]
    v_pk_mul_f32 v[104:105], v[20:21], v[20:21]
    v_pk_mul_f32 v[106:107], v[22:23], v[22:23]
    v_pk_mul_f32 v[108:109], v[24:25], v[24:25]
    v_pk_mul_f32 v[110:111], v[26:27], v[26:27]
    v_pk_fma_f32 v[104:105], v[104:105], v[92:93], v[90:91]
    v_pk_fma_f32 v[106:107], v[106:107], v[92:93], v[90:91]
    v_pk_fma_f32 v[108:109], v[108:109], v[100:101], v[98:99]
    v_pk_fma_f32 v[110:111], v[110:111], v[100:101], v[98:99]
    v_pk_mul_f32 v[104:105], v[104:105], v[20:21]
    v_pk_mul_f32 v[106:107], v[106:107], v[22:23]
    v_pk_mul_f32 v[108:109], v[108:109], v[24:25]
    v_pk_mul_f32 v[110:111], v[110:111], v[26:27]
    v_exp_f32 v104, v104
    v_exp_f32 v105, v105
    v_exp_f32 v106, v106
    v_exp_f32 v107, v107
    v_exp_f32 v108, v108
    v_exp_f32 v109, v109
    v_exp_f32 v110, v110
    v_exp_f32 v111, v111
    v_pk_fma_f32 v[104:105], v[104:105], v[94:95], v[94:95]
    v_pk_fma_f32 v[106:107], v[106:107], v[94:95], v[94:95]
    v_pk_fma_f32 v[108:109], v[108:109], v[102:103], v[102:103]
    v_pk_fma_f32 v[110:111], v[110:111], v[102:103], v[102:103]
    v_rcp_f32 v104, v104
    v_rcp_f32 v105, v105
    v_rcp_f32 v106, v106
    v_rcp_f32 v107, v107
    v_rcp_f32 v108, v108
    v_rcp_f32 v109, v109
    v_rcp_f32 v110, v110
    v_rcp_f32 v111, v111
    v_pk_mul_f32 v[20:21], v[20:21], v[104:105]
    v_pk_mul_f32 v[22:23], v[22:23], v[106:107]
    v_pk_mul_f32 v[24:25], v[24:25], v[108:109]
    v_pk_mul_f32 v[26:27], v[26:27], v[110:111]
    v_add_u32 v20, 0x10000, v20
    v_add_u32 v22, 0x10000, v22
    v_add_u32 v24, 0x10000, v24
    v_add_u32 v26, 0x10000, v26
    v_and_b32 v20, 0xfffe0000, v20
    v_and_b32 v22, 0xfffe0000, v22
    v_and_b32 v24, 0xfffe0000, v24
    v_and_b32 v26, 0xfffe0000, v26
    v_cvt_pk_bf16_f32 v104, v20, v21
    v_cvt_pk_bf16_f32 v105, v22, v23
    v_cvt_pk_bf16_f32 v106, v24, v25
    v_cvt_pk_bf16_f32 v107, v26, v27
    s_add_u32 s36, s39, 0
    v_permlane16_swap_b32 v104, v106
    v_permlane16_swap_b32 v105, v107
    buffer_store_dwordx4 v[104:107], v114, s[16:19], s36 offen sc1
    s_waitcnt lgkmcnt(4)
    v_mfma_f32_16x16x32_bf16 v[28:31], v[136:139], v[68:71], v[28:31]
    ds_read_b128 v[52:55], v17 offset:32768
    v_mfma_f32_16x16x32_bf16 v[32:35], v[136:139], v[72:75], v[32:35]
    ds_read_b128 v[56:59], v17 offset:36864
    v_mfma_f32_16x16x32_bf16 v[32:35], v[140:143], v[80:83], v[32:35]
    ds_read_b128 v[60:63], v17 offset:40960
    v_mfma_f32_16x16x32_bf16 v[28:31], v[140:143], v[76:79], v[28:31]
    ds_read_b128 v[64:67], v17 offset:45056
    s_barrier
    s_waitcnt lgkmcnt(4)
    v_mfma_f32_16x16x32_bf16 v[28:31], v[144:147], v[36:39], v[28:31]
    ds_read_b128 v[68:71], v10 offset:16384
    v_mfma_f32_16x16x32_bf16 v[32:35], v[144:147], v[40:43], v[32:35]
    ds_read_b128 v[72:75], v10 offset:20480
    v_mfma_f32_16x16x32_bf16 v[32:35], v[148:151], v[48:51], v[32:35]
    ds_read_b128 v[76:79], v10 offset:24576
    v_mfma_f32_16x16x32_bf16 v[28:31], v[148:151], v[44:47], v[28:31]
    ds_read_b128 v[80:83], v10 offset:28672
    s_waitcnt lgkmcnt(4)
    v_mfma_f32_16x16x32_bf16 v[28:31], v[152:155], v[52:55], v[28:31]
    ds_read_b128 v[36:39], v11 offset:16384
    v_mfma_f32_16x16x32_bf16 v[32:35], v[152:155], v[56:59], v[32:35]
    ds_read_b128 v[40:43], v11 offset:20480
    v_mfma_f32_16x16x32_bf16 v[32:35], v[156:159], v[64:67], v[32:35]
    ds_read_b128 v[44:47], v11 offset:24576
    v_mfma_f32_16x16x32_bf16 v[28:31], v[156:159], v[60:63], v[28:31]
    ds_read_b128 v[48:51], v11 offset:28672
    s_waitcnt lgkmcnt(4)
    v_mfma_f32_16x16x32_bf16 v[28:31], v[160:163], v[68:71], v[28:31]
    ds_read_b128 v[52:55], v12 offset:16384
    v_mfma_f32_16x16x32_bf16 v[32:35], v[160:163], v[72:75], v[32:35]
    ds_read_b128 v[56:59], v12 offset:20480
    v_mfma_f32_16x16x32_bf16 v[32:35], v[164:167], v[80:83], v[32:35]
    ds_read_b128 v[60:63], v12 offset:24576
    v_mfma_f32_16x16x32_bf16 v[28:31], v[164:167], v[76:79], v[28:31]
    ds_read_b128 v[64:67], v12 offset:28672
    s_waitcnt lgkmcnt(4)
    v_mfma_f32_16x16x32_bf16 v[28:31], v[168:171], v[36:39], v[28:31]
    ds_read_b128 v[68:71], v13 offset:16384
    v_mfma_f32_16x16x32_bf16 v[32:35], v[168:171], v[40:43], v[32:35]
    ds_read_b128 v[72:75], v13 offset:20480
    v_mfma_f32_16x16x32_bf16 v[32:35], v[172:175], v[48:51], v[32:35]
    ds_read_b128 v[76:79], v13 offset:24576
    v_mfma_f32_16x16x32_bf16 v[28:31], v[172:175], v[44:47], v[28:31]
    ds_read_b128 v[80:83], v13 offset:28672
    s_barrier
    s_waitcnt lgkmcnt(4)
    v_mfma_f32_16x16x32_bf16 v[28:31], v[176:179], v[52:55], v[28:31]
    ds_read_b128 v[36:39], v10 offset:32768
    v_mfma_f32_16x16x32_bf16 v[32:35], v[176:179], v[56:59], v[32:35]
    ds_read_b128 v[40:43], v10 offset:36864
    v_mfma_f32_16x16x32_bf16 v[32:35], v[180:183], v[64:67], v[32:35]
    ds_read_b128 v[44:47], v10 offset:40960
    v_mfma_f32_16x16x32_bf16 v[28:31], v[180:183], v[60:63], v[28:31]
    ds_read_b128 v[48:51], v10 offset:45056
    s_waitcnt lgkmcnt(4)
    v_mfma_f32_16x16x32_bf16 v[28:31], v[184:187], v[68:71], v[28:31]
    ds_read_b128 v[52:55], v11 offset:32768
    v_mfma_f32_16x16x32_bf16 v[32:35], v[184:187], v[72:75], v[32:35]
    ds_read_b128 v[56:59], v11 offset:36864
    v_mfma_f32_16x16x32_bf16 v[32:35], v[188:191], v[80:83], v[32:35]
    ds_read_b128 v[60:63], v11 offset:40960
    v_mfma_f32_16x16x32_bf16 v[28:31], v[188:191], v[76:79], v[28:31]
    ds_read_b128 v[64:67], v11 offset:45056
    s_waitcnt lgkmcnt(4)
    v_mfma_f32_16x16x32_bf16 v[28:31], v[192:195], v[36:39], v[28:31]
    ds_read_b128 v[68:71], v12 offset:32768
    v_mfma_f32_16x16x32_bf16 v[32:35], v[192:195], v[40:43], v[32:35]
    ds_read_b128 v[72:75], v12 offset:36864
    v_mfma_f32_16x16x32_bf16 v[32:35], v[196:199], v[48:51], v[32:35]
    ds_read_b128 v[76:79], v12 offset:40960
    v_mfma_f32_16x16x32_bf16 v[28:31], v[196:199], v[44:47], v[28:31]
    ds_read_b128 v[80:83], v12 offset:45056
    s_waitcnt lgkmcnt(4)
    v_mfma_f32_16x16x32_bf16 v[28:31], v[200:203], v[52:55], v[28:31]
    ds_read_b128 v[36:39], v13 offset:32768
    v_mfma_f32_16x16x32_bf16 v[32:35], v[200:203], v[56:59], v[32:35]
    ds_read_b128 v[40:43], v13 offset:36864
    v_mfma_f32_16x16x32_bf16 v[32:35], v[204:207], v[64:67], v[32:35]
    ds_read_b128 v[44:47], v13 offset:40960
    v_mfma_f32_16x16x32_bf16 v[28:31], v[204:207], v[60:63], v[28:31]
    ds_read_b128 v[48:51], v13 offset:45056
    s_barrier
    s_waitcnt lgkmcnt(4)
    v_mfma_f32_16x16x32_bf16 v[28:31], v[208:211], v[68:71], v[28:31]
    ds_read_b128 v[52:55], v14 offset:0
    v_mfma_f32_16x16x32_bf16 v[32:35], v[208:211], v[72:75], v[32:35]
    ds_read_b128 v[56:59], v14 offset:4096
    v_mfma_f32_16x16x32_bf16 v[32:35], v[212:215], v[80:83], v[32:35]
    ds_read_b128 v[60:63], v14 offset:8192
    v_mfma_f32_16x16x32_bf16 v[28:31], v[212:215], v[76:79], v[28:31]
    ds_read_b128 v[64:67], v14 offset:12288
    s_waitcnt lgkmcnt(4)
    v_mfma_f32_16x16x32_bf16 v[28:31], v[216:219], v[36:39], v[28:31]
    ds_read_b128 v[68:71], v15 offset:0
    v_mfma_f32_16x16x32_bf16 v[32:35], v[216:219], v[40:43], v[32:35]
    ds_read_b128 v[72:75], v15 offset:4096
    v_mfma_f32_16x16x32_bf16 v[32:35], v[220:223], v[48:51], v[32:35]
    ds_read_b128 v[76:79], v15 offset:8192
    v_mfma_f32_16x16x32_bf16 v[28:31], v[220:223], v[44:47], v[28:31]
    ds_read_b128 v[80:83], v15 offset:12288
    s_waitcnt lgkmcnt(4)
    v_mfma_f32_16x16x32_bf16 v[28:31], v[224:227], v[52:55], v[28:31]
    ds_read_b128 v[36:39], v16 offset:0
    v_mfma_f32_16x16x32_bf16 v[32:35], v[224:227], v[56:59], v[32:35]
    ds_read_b128 v[40:43], v16 offset:4096
    v_mfma_f32_16x16x32_bf16 v[32:35], v[228:231], v[64:67], v[32:35]
    ds_read_b128 v[44:47], v16 offset:8192
    v_mfma_f32_16x16x32_bf16 v[28:31], v[228:231], v[60:63], v[28:31]
    ds_read_b128 v[48:51], v16 offset:12288
    s_waitcnt lgkmcnt(4)
    v_mfma_f32_16x16x32_bf16 v[28:31], v[232:235], v[68:71], v[28:31]
    ds_read_b128 v[52:55], v17 offset:0
    v_mfma_f32_16x16x32_bf16 v[32:35], v[232:235], v[72:75], v[32:35]
    ds_read_b128 v[56:59], v17 offset:4096
    v_mfma_f32_16x16x32_bf16 v[32:35], v[236:239], v[80:83], v[32:35]
    ds_read_b128 v[60:63], v17 offset:8192
    v_mfma_f32_16x16x32_bf16 v[28:31], v[236:239], v[76:79], v[28:31]
    ds_read_b128 v[64:67], v17 offset:12288
    s_barrier
    ds_read_b128 v[88:91], v18 offset:512
    ds_read_b128 v[92:95], v18 offset:2560
    ds_read_b128 v[96:99], v18 offset:768
    ds_read_b128 v[100:103], v18 offset:2816
    s_waitcnt vmcnt(0)
    buffer_atomic_add v113, v112, s[56:59], s40 offen offset:2048 sc1
    s_waitcnt lgkmcnt(8)
    v_mfma_f32_16x16x32_bf16 v[28:31], v[240:243], v[36:39], v[28:31]
    ds_read_b128 v[68:71], v14 offset:16384
    v_mfma_f32_16x16x32_bf16 v[32:35], v[240:243], v[40:43], v[32:35]
    ds_read_b128 v[72:75], v14 offset:20480
    v_mfma_f32_16x16x32_bf16 v[32:35], v[244:247], v[48:51], v[32:35]
    ds_read_b128 v[76:79], v14 offset:24576
    v_mfma_f32_16x16x32_bf16 v[28:31], v[244:247], v[44:47], v[28:31]
    ds_read_b128 v[80:83], v14 offset:28672
    s_waitcnt lgkmcnt(8)
    v_mfma_f32_16x16x32_bf16 v[28:31], v[248:251], v[52:55], v[28:31]
    ds_read_b128 v[36:39], v15 offset:16384
    v_mfma_f32_16x16x32_bf16 v[32:35], v[248:251], v[56:59], v[32:35]
    ds_read_b128 v[40:43], v15 offset:20480
    v_mfma_f32_16x16x32_bf16 v[32:35], v[252:255], v[64:67], v[32:35]
    ds_read_b128 v[44:47], v15 offset:24576
    v_mfma_f32_16x16x32_bf16 v[28:31], v[252:255], v[60:63], v[28:31]
    ds_read_b128 v[48:51], v15 offset:28672
    s_waitcnt lgkmcnt(4)
    v_mfma_f32_16x16x32_bf16 v[20:23], v[128:131], v[68:71], 0
    ds_read_b128 v[52:55], v16 offset:16384
    v_mfma_f32_16x16x32_bf16 v[24:27], v[128:131], v[72:75], 0
    ds_read_b128 v[56:59], v16 offset:20480
    v_mfma_f32_16x16x32_bf16 v[24:27], v[132:135], v[80:83], v[24:27]
    ds_read_b128 v[60:63], v16 offset:24576
    v_mfma_f32_16x16x32_bf16 v[20:23], v[132:135], v[76:79], v[20:23]
    ds_read_b128 v[64:67], v16 offset:28672
    v_pk_fma_f32 v[28:29], v[88:89], v[84:85], v[28:29]
    v_pk_fma_f32 v[30:31], v[88:89], v[86:87], v[30:31]
    v_pk_fma_f32 v[32:33], v[96:97], v[84:85], v[32:33]
    v_pk_fma_f32 v[34:35], v[96:97], v[86:87], v[34:35]
    v_pk_mul_f32 v[104:105], v[28:29], v[28:29]
    v_pk_mul_f32 v[106:107], v[30:31], v[30:31]
    v_pk_mul_f32 v[108:109], v[32:33], v[32:33]
    v_pk_mul_f32 v[110:111], v[34:35], v[34:35]
    v_pk_fma_f32 v[104:105], v[104:105], v[92:93], v[90:91]
    v_pk_fma_f32 v[106:107], v[106:107], v[92:93], v[90:91]
    v_pk_fma_f32 v[108:109], v[108:109], v[100:101], v[98:99]
    v_pk_fma_f32 v[110:111], v[110:111], v[100:101], v[98:99]
    v_pk_mul_f32 v[104:105], v[104:105], v[28:29]
    v_pk_mul_f32 v[106:107], v[106:107], v[30:31]
    v_pk_mul_f32 v[108:109], v[108:109], v[32:33]
    v_pk_mul_f32 v[110:111], v[110:111], v[34:35]
    v_exp_f32 v104, v104
    v_exp_f32 v105, v105
    v_exp_f32 v106, v106
    v_exp_f32 v107, v107
    v_exp_f32 v108, v108
    v_exp_f32 v109, v109
    v_exp_f32 v110, v110
    v_exp_f32 v111, v111
    v_pk_fma_f32 v[104:105], v[104:105], v[94:95], v[94:95]
    v_pk_fma_f32 v[106:107], v[106:107], v[94:95], v[94:95]
    v_pk_fma_f32 v[108:109], v[108:109], v[102:103], v[102:103]
    v_pk_fma_f32 v[110:111], v[110:111], v[102:103], v[102:103]
    v_rcp_f32 v104, v104
    v_rcp_f32 v105, v105
    v_rcp_f32 v106, v106
    v_rcp_f32 v107, v107
    v_rcp_f32 v108, v108
    v_rcp_f32 v109, v109
    v_rcp_f32 v110, v110
    v_rcp_f32 v111, v111
    v_pk_mul_f32 v[28:29], v[28:29], v[104:105]
    v_pk_mul_f32 v[30:31], v[30:31], v[106:107]
    v_pk_mul_f32 v[32:33], v[32:33], v[108:109]
    v_pk_mul_f32 v[34:35], v[34:35], v[110:111]
    v_add_u32 v28, 0x10000, v28
    v_add_u32 v30, 0x10000, v30
    v_add_u32 v32, 0x10000, v32
    v_add_u32 v34, 0x10000, v34
    v_and_b32 v28, 0xfffe0000, v28
    v_and_b32 v30, 0xfffe0000, v30
    v_and_b32 v32, 0xfffe0000, v32
    v_and_b32 v34, 0xfffe0000, v34
    v_cvt_pk_bf16_f32 v104, v28, v29
    v_cvt_pk_bf16_f32 v105, v30, v31
    v_cvt_pk_bf16_f32 v106, v32, v33
    v_cvt_pk_bf16_f32 v107, v34, v35
    s_add_u32 s36, s39, 131072
    v_permlane16_swap_b32 v104, v106
    v_permlane16_swap_b32 v105, v107
    buffer_store_dwordx4 v[104:107], v114, s[16:19], s36 offen sc1
    s_waitcnt lgkmcnt(4)
    v_mfma_f32_16x16x32_bf16 v[20:23], v[136:139], v[36:39], v[20:23]
    ds_read_b128 v[68:71], v17 offset:16384
    v_mfma_f32_16x16x32_bf16 v[24:27], v[136:139], v[40:43], v[24:27]
    ds_read_b128 v[72:75], v17 offset:20480
    v_mfma_f32_16x16x32_bf16 v[24:27], v[140:143], v[48:51], v[24:27]
    ds_read_b128 v[76:79], v17 offset:24576
    v_mfma_f32_16x16x32_bf16 v[20:23], v[140:143], v[44:47], v[20:23]
    ds_read_b128 v[80:83], v17 offset:28672
    s_barrier
    s_waitcnt lgkmcnt(4)
    v_mfma_f32_16x16x32_bf16 v[20:23], v[144:147], v[52:55], v[20:23]
    ds_read_b128 v[36:39], v14 offset:32768
    v_mfma_f32_16x16x32_bf16 v[24:27], v[144:147], v[56:59], v[24:27]
    ds_read_b128 v[40:43], v14 offset:36864
    v_mfma_f32_16x16x32_bf16 v[24:27], v[148:151], v[64:67], v[24:27]
    ds_read_b128 v[44:47], v14 offset:40960
    v_mfma_f32_16x16x32_bf16 v[20:23], v[148:151], v[60:63], v[20:23]
    ds_read_b128 v[48:51], v14 offset:45056
    s_waitcnt lgkmcnt(4)
    v_mfma_f32_16x16x32_bf16 v[20:23], v[152:155], v[68:71], v[20:23]
    ds_read_b128 v[52:55], v15 offset:32768
    v_mfma_f32_16x16x32_bf16 v[24:27], v[152:155], v[72:75], v[24:27]
    ds_read_b128 v[56:59], v15 offset:36864
    v_mfma_f32_16x16x32_bf16 v[24:27], v[156:159], v[80:83], v[24:27]
    ds_read_b128 v[60:63], v15 offset:40960
    v_mfma_f32_16x16x32_bf16 v[20:23], v[156:159], v[76:79], v[20:23]
    ds_read_b128 v[64:67], v15 offset:45056
    s_waitcnt lgkmcnt(4)
    v_mfma_f32_16x16x32_bf16 v[20:23], v[160:163], v[36:39], v[20:23]
    ds_read_b128 v[68:71], v16 offset:32768
    v_mfma_f32_16x16x32_bf16 v[24:27], v[160:163], v[40:43], v[24:27]
    ds_read_b128 v[72:75], v16 offset:36864
    v_mfma_f32_16x16x32_bf16 v[24:27], v[164:167], v[48:51], v[24:27]
    ds_read_b128 v[76:79], v16 offset:40960
    v_mfma_f32_16x16x32_bf16 v[20:23], v[164:167], v[44:47], v[20:23]
    ds_read_b128 v[80:83], v16 offset:45056
    s_waitcnt lgkmcnt(4)
    v_mfma_f32_16x16x32_bf16 v[20:23], v[168:171], v[52:55], v[20:23]
    ds_read_b128 v[36:39], v17 offset:32768
    v_mfma_f32_16x16x32_bf16 v[24:27], v[168:171], v[56:59], v[24:27]
    ds_read_b128 v[40:43], v17 offset:36864
    v_mfma_f32_16x16x32_bf16 v[24:27], v[172:175], v[64:67], v[24:27]
    ds_read_b128 v[44:47], v17 offset:40960
    v_mfma_f32_16x16x32_bf16 v[20:23], v[172:175], v[60:63], v[20:23]
    ds_read_b128 v[48:51], v17 offset:45056
    s_barrier
    s_waitcnt lgkmcnt(4)
    v_mfma_f32_16x16x32_bf16 v[20:23], v[176:179], v[68:71], v[20:23]
    ds_read_b128 v[52:55], v10 offset:16384
    v_mfma_f32_16x16x32_bf16 v[24:27], v[176:179], v[72:75], v[24:27]
    ds_read_b128 v[56:59], v10 offset:20480
    v_mfma_f32_16x16x32_bf16 v[24:27], v[180:183], v[80:83], v[24:27]
    ds_read_b128 v[60:63], v10 offset:24576
    v_mfma_f32_16x16x32_bf16 v[20:23], v[180:183], v[76:79], v[20:23]
    ds_read_b128 v[64:67], v10 offset:28672
    s_waitcnt lgkmcnt(4)
    v_mfma_f32_16x16x32_bf16 v[20:23], v[184:187], v[36:39], v[20:23]
    ds_read_b128 v[68:71], v11 offset:16384
    v_mfma_f32_16x16x32_bf16 v[24:27], v[184:187], v[40:43], v[24:27]
    ds_read_b128 v[72:75], v11 offset:20480
    v_mfma_f32_16x16x32_bf16 v[24:27], v[188:191], v[48:51], v[24:27]
    ds_read_b128 v[76:79], v11 offset:24576
    v_mfma_f32_16x16x32_bf16 v[20:23], v[188:191], v[44:47], v[20:23]
    ds_read_b128 v[80:83], v11 offset:28672
    s_waitcnt lgkmcnt(4)
    v_mfma_f32_16x16x32_bf16 v[20:23], v[192:195], v[52:55], v[20:23]
    ds_read_b128 v[36:39], v12 offset:16384
    v_mfma_f32_16x16x32_bf16 v[24:27], v[192:195], v[56:59], v[24:27]
    ds_read_b128 v[40:43], v12 offset:20480
    v_mfma_f32_16x16x32_bf16 v[24:27], v[196:199], v[64:67], v[24:27]
    ds_read_b128 v[44:47], v12 offset:24576
    v_mfma_f32_16x16x32_bf16 v[20:23], v[196:199], v[60:63], v[20:23]
    ds_read_b128 v[48:51], v12 offset:28672
    s_waitcnt lgkmcnt(4)
    v_mfma_f32_16x16x32_bf16 v[20:23], v[200:203], v[68:71], v[20:23]
    ds_read_b128 v[52:55], v13 offset:16384
    v_mfma_f32_16x16x32_bf16 v[24:27], v[200:203], v[72:75], v[24:27]
    ds_read_b128 v[56:59], v13 offset:20480
    v_mfma_f32_16x16x32_bf16 v[24:27], v[204:207], v[80:83], v[24:27]
    ds_read_b128 v[60:63], v13 offset:24576
    v_mfma_f32_16x16x32_bf16 v[20:23], v[204:207], v[76:79], v[20:23]
    ds_read_b128 v[64:67], v13 offset:28672
    s_barrier
    s_waitcnt lgkmcnt(4)
    v_mfma_f32_16x16x32_bf16 v[20:23], v[208:211], v[36:39], v[20:23]
    ds_read_b128 v[68:71], v10 offset:32768
    v_mfma_f32_16x16x32_bf16 v[24:27], v[208:211], v[40:43], v[24:27]
    ds_read_b128 v[72:75], v10 offset:36864
    v_mfma_f32_16x16x32_bf16 v[24:27], v[212:215], v[48:51], v[24:27]
    ds_read_b128 v[76:79], v10 offset:40960
    v_mfma_f32_16x16x32_bf16 v[20:23], v[212:215], v[44:47], v[20:23]
    ds_read_b128 v[80:83], v10 offset:45056
    s_waitcnt lgkmcnt(4)
    v_mfma_f32_16x16x32_bf16 v[20:23], v[216:219], v[52:55], v[20:23]
    ds_read_b128 v[36:39], v11 offset:32768
    v_mfma_f32_16x16x32_bf16 v[24:27], v[216:219], v[56:59], v[24:27]
    ds_read_b128 v[40:43], v11 offset:36864
    v_mfma_f32_16x16x32_bf16 v[24:27], v[220:223], v[64:67], v[24:27]
    ds_read_b128 v[44:47], v11 offset:40960
    v_mfma_f32_16x16x32_bf16 v[20:23], v[220:223], v[60:63], v[20:23]
    ds_read_b128 v[48:51], v11 offset:45056
    s_waitcnt lgkmcnt(4)
    v_mfma_f32_16x16x32_bf16 v[20:23], v[224:227], v[68:71], v[20:23]
    ds_read_b128 v[52:55], v12 offset:32768
    v_mfma_f32_16x16x32_bf16 v[24:27], v[224:227], v[72:75], v[24:27]
    ds_read_b128 v[56:59], v12 offset:36864
    v_mfma_f32_16x16x32_bf16 v[24:27], v[228:231], v[80:83], v[24:27]
    ds_read_b128 v[60:63], v12 offset:40960
    v_mfma_f32_16x16x32_bf16 v[20:23], v[228:231], v[76:79], v[20:23]
    ds_read_b128 v[64:67], v12 offset:45056
    s_waitcnt lgkmcnt(4)
    v_mfma_f32_16x16x32_bf16 v[20:23], v[232:235], v[36:39], v[20:23]
    ds_read_b128 v[68:71], v13 offset:32768
    v_mfma_f32_16x16x32_bf16 v[24:27], v[232:235], v[40:43], v[24:27]
    ds_read_b128 v[72:75], v13 offset:36864
    v_mfma_f32_16x16x32_bf16 v[24:27], v[236:239], v[48:51], v[24:27]
    ds_read_b128 v[76:79], v13 offset:40960
    v_mfma_f32_16x16x32_bf16 v[20:23], v[236:239], v[44:47], v[20:23]
    ds_read_b128 v[80:83], v13 offset:45056
    s_barrier
    ds_read_b128 v[88:91], v18 offset:1024
    ds_read_b128 v[92:95], v18 offset:3072
    ds_read_b128 v[96:99], v18 offset:1280
    ds_read_b128 v[100:103], v18 offset:3328
    s_waitcnt vmcnt(0)
    buffer_atomic_add v113, v112, s[56:59], s40 offen offset:2560 sc1
    s_waitcnt lgkmcnt(8)
    v_mfma_f32_16x16x32_bf16 v[20:23], v[240:243], v[52:55], v[20:23]
    ds_read_b128 v[36:39], v14 offset:0
    v_mfma_f32_16x16x32_bf16 v[24:27], v[240:243], v[56:59], v[24:27]
    ds_read_b128 v[40:43], v14 offset:4096
    v_mfma_f32_16x16x32_bf16 v[24:27], v[244:247], v[64:67], v[24:27]
    ds_read_b128 v[44:47], v14 offset:8192
    v_mfma_f32_16x16x32_bf16 v[20:23], v[244:247], v[60:63], v[20:23]
    ds_read_b128 v[48:51], v14 offset:12288
    s_waitcnt lgkmcnt(8)
    v_mfma_f32_16x16x32_bf16 v[20:23], v[248:251], v[68:71], v[20:23]
    ds_read_b128 v[52:55], v15 offset:0
    v_mfma_f32_16x16x32_bf16 v[24:27], v[248:251], v[72:75], v[24:27]
    ds_read_b128 v[56:59], v15 offset:4096
    v_mfma_f32_16x16x32_bf16 v[24:27], v[252:255], v[80:83], v[24:27]
    ds_read_b128 v[60:63], v15 offset:8192
    v_mfma_f32_16x16x32_bf16 v[20:23], v[252:255], v[76:79], v[20:23]
    ds_read_b128 v[64:67], v15 offset:12288
    s_waitcnt lgkmcnt(4)
    v_mfma_f32_16x16x32_bf16 v[28:31], v[128:131], v[36:39], 0
    ds_read_b128 v[68:71], v16 offset:0
    v_mfma_f32_16x16x32_bf16 v[32:35], v[128:131], v[40:43], 0
    ds_read_b128 v[72:75], v16 offset:4096
    v_mfma_f32_16x16x32_bf16 v[32:35], v[132:135], v[48:51], v[32:35]
    ds_read_b128 v[76:79], v16 offset:8192
    v_mfma_f32_16x16x32_bf16 v[28:31], v[132:135], v[44:47], v[28:31]
    ds_read_b128 v[80:83], v16 offset:12288
    v_pk_fma_f32 v[20:21], v[88:89], v[84:85], v[20:21]
    v_pk_fma_f32 v[22:23], v[88:89], v[86:87], v[22:23]
    v_pk_fma_f32 v[24:25], v[96:97], v[84:85], v[24:25]
    v_pk_fma_f32 v[26:27], v[96:97], v[86:87], v[26:27]
    v_pk_mul_f32 v[104:105], v[20:21], v[20:21]
    v_pk_mul_f32 v[106:107], v[22:23], v[22:23]
    v_pk_mul_f32 v[108:109], v[24:25], v[24:25]
    v_pk_mul_f32 v[110:111], v[26:27], v[26:27]
    v_pk_fma_f32 v[104:105], v[104:105], v[92:93], v[90:91]
    v_pk_fma_f32 v[106:107], v[106:107], v[92:93], v[90:91]
    v_pk_fma_f32 v[108:109], v[108:109], v[100:101], v[98:99]
    v_pk_fma_f32 v[110:111], v[110:111], v[100:101], v[98:99]
    v_pk_mul_f32 v[104:105], v[104:105], v[20:21]
    v_pk_mul_f32 v[106:107], v[106:107], v[22:23]
    v_pk_mul_f32 v[108:109], v[108:109], v[24:25]
    v_pk_mul_f32 v[110:111], v[110:111], v[26:27]
    v_exp_f32 v104, v104
    v_exp_f32 v105, v105
    v_exp_f32 v106, v106
    v_exp_f32 v107, v107
    v_exp_f32 v108, v108
    v_exp_f32 v109, v109
    v_exp_f32 v110, v110
    v_exp_f32 v111, v111
    v_pk_fma_f32 v[104:105], v[104:105], v[94:95], v[94:95]
    v_pk_fma_f32 v[106:107], v[106:107], v[94:95], v[94:95]
    v_pk_fma_f32 v[108:109], v[108:109], v[102:103], v[102:103]
    v_pk_fma_f32 v[110:111], v[110:111], v[102:103], v[102:103]
    v_rcp_f32 v104, v104
    v_rcp_f32 v105, v105
    v_rcp_f32 v106, v106
    v_rcp_f32 v107, v107
    v_rcp_f32 v108, v108
    v_rcp_f32 v109, v109
    v_rcp_f32 v110, v110
    v_rcp_f32 v111, v111
    v_pk_mul_f32 v[20:21], v[20:21], v[104:105]
    v_pk_mul_f32 v[22:23], v[22:23], v[106:107]
    v_pk_mul_f32 v[24:25], v[24:25], v[108:109]
    v_pk_mul_f32 v[26:27], v[26:27], v[110:111]
    v_add_u32 v20, 0x10000, v20
    v_add_u32 v22, 0x10000, v22
    v_add_u32 v24, 0x10000, v24
    v_add_u32 v26, 0x10000, v26
    v_and_b32 v20, 0xfffe0000, v20
    v_and_b32 v22, 0xfffe0000, v22
    v_and_b32 v24, 0xfffe0000, v24
    v_and_b32 v26, 0xfffe0000, v26
    v_cvt_pk_bf16_f32 v104, v20, v21
    v_cvt_pk_bf16_f32 v105, v22, v23
    v_cvt_pk_bf16_f32 v106, v24, v25
    v_cvt_pk_bf16_f32 v107, v26, v27
    s_add_u32 s36, s39, 262144
    v_permlane16_swap_b32 v104, v106
    v_permlane16_swap_b32 v105, v107
    buffer_store_dwordx4 v[104:107], v114, s[16:19], s36 offen sc1
    s_waitcnt lgkmcnt(4)
    v_mfma_f32_16x16x32_bf16 v[28:31], v[136:139], v[52:55], v[28:31]
    ds_read_b128 v[36:39], v17 offset:0
    v_mfma_f32_16x16x32_bf16 v[32:35], v[136:139], v[56:59], v[32:35]
    ds_read_b128 v[40:43], v17 offset:4096
    v_mfma_f32_16x16x32_bf16 v[32:35], v[140:143], v[64:67], v[32:35]
    ds_read_b128 v[44:47], v17 offset:8192
    v_mfma_f32_16x16x32_bf16 v[28:31], v[140:143], v[60:63], v[28:31]
    ds_read_b128 v[48:51], v17 offset:12288
    s_barrier
    s_waitcnt lgkmcnt(4)
    v_mfma_f32_16x16x32_bf16 v[28:31], v[144:147], v[68:71], v[28:31]
    ds_read_b128 v[52:55], v14 offset:16384
    v_mfma_f32_16x16x32_bf16 v[32:35], v[144:147], v[72:75], v[32:35]
    ds_read_b128 v[56:59], v14 offset:20480
    v_mfma_f32_16x16x32_bf16 v[32:35], v[148:151], v[80:83], v[32:35]
    ds_read_b128 v[60:63], v14 offset:24576
    v_mfma_f32_16x16x32_bf16 v[28:31], v[148:151], v[76:79], v[28:31]
    ds_read_b128 v[64:67], v14 offset:28672
    s_waitcnt lgkmcnt(4)
    v_mfma_f32_16x16x32_bf16 v[28:31], v[152:155], v[36:39], v[28:31]
    ds_read_b128 v[68:71], v15 offset:16384
    v_mfma_f32_16x16x32_bf16 v[32:35], v[152:155], v[40:43], v[32:35]
    ds_read_b128 v[72:75], v15 offset:20480
    v_mfma_f32_16x16x32_bf16 v[32:35], v[156:159], v[48:51], v[32:35]
    ds_read_b128 v[76:79], v15 offset:24576
    v_mfma_f32_16x16x32_bf16 v[28:31], v[156:159], v[44:47], v[28:31]
    ds_read_b128 v[80:83], v15 offset:28672
    s_waitcnt lgkmcnt(4)
    v_mfma_f32_16x16x32_bf16 v[28:31], v[160:163], v[52:55], v[28:31]
    ds_read_b128 v[36:39], v16 offset:16384
    v_mfma_f32_16x16x32_bf16 v[32:35], v[160:163], v[56:59], v[32:35]
    ds_read_b128 v[40:43], v16 offset:20480
    v_mfma_f32_16x16x32_bf16 v[32:35], v[164:167], v[64:67], v[32:35]
    ds_read_b128 v[44:47], v16 offset:24576
    v_mfma_f32_16x16x32_bf16 v[28:31], v[164:167], v[60:63], v[28:31]
    ds_read_b128 v[48:51], v16 offset:28672
    s_waitcnt lgkmcnt(4)
    v_mfma_f32_16x16x32_bf16 v[28:31], v[168:171], v[68:71], v[28:31]
    ds_read_b128 v[52:55], v17 offset:16384
    v_mfma_f32_16x16x32_bf16 v[32:35], v[168:171], v[72:75], v[32:35]
    ds_read_b128 v[56:59], v17 offset:20480
    v_mfma_f32_16x16x32_bf16 v[32:35], v[172:175], v[80:83], v[32:35]
    ds_read_b128 v[60:63], v17 offset:24576
    v_mfma_f32_16x16x32_bf16 v[28:31], v[172:175], v[76:79], v[28:31]
    ds_read_b128 v[64:67], v17 offset:28672
    s_barrier
    s_waitcnt lgkmcnt(4)
    v_mfma_f32_16x16x32_bf16 v[28:31], v[176:179], v[36:39], v[28:31]
    ds_read_b128 v[68:71], v14 offset:32768
    v_mfma_f32_16x16x32_bf16 v[32:35], v[176:179], v[40:43], v[32:35]
    ds_read_b128 v[72:75], v14 offset:36864
    v_mfma_f32_16x16x32_bf16 v[32:35], v[180:183], v[48:51], v[32:35]
    ds_read_b128 v[76:79], v14 offset:40960
    v_mfma_f32_16x16x32_bf16 v[28:31], v[180:183], v[44:47], v[28:31]
    ds_read_b128 v[80:83], v14 offset:45056
    s_waitcnt lgkmcnt(4)
    v_mfma_f32_16x16x32_bf16 v[28:31], v[184:187], v[52:55], v[28:31]
    ds_read_b128 v[36:39], v15 offset:32768
    v_mfma_f32_16x16x32_bf16 v[32:35], v[184:187], v[56:59], v[32:35]
    ds_read_b128 v[40:43], v15 offset:36864
    v_mfma_f32_16x16x32_bf16 v[32:35], v[188:191], v[64:67], v[32:35]
    ds_read_b128 v[44:47], v15 offset:40960
    v_mfma_f32_16x16x32_bf16 v[28:31], v[188:191], v[60:63], v[28:31]
    ds_read_b128 v[48:51], v15 offset:45056
    s_waitcnt lgkmcnt(4)
    v_mfma_f32_16x16x32_bf16 v[28:31], v[192:195], v[68:71], v[28:31]
    ds_read_b128 v[52:55], v16 offset:32768
    v_mfma_f32_16x16x32_bf16 v[32:35], v[192:195], v[72:75], v[32:35]
    ds_read_b128 v[56:59], v16 offset:36864
    v_mfma_f32_16x16x32_bf16 v[32:35], v[196:199], v[80:83], v[32:35]
    ds_read_b128 v[60:63], v16 offset:40960
    v_mfma_f32_16x16x32_bf16 v[28:31], v[196:199], v[76:79], v[28:31]
    ds_read_b128 v[64:67], v16 offset:45056
    s_waitcnt lgkmcnt(4)
    v_mfma_f32_16x16x32_bf16 v[28:31], v[200:203], v[36:39], v[28:31]
    ds_read_b128 v[68:71], v17 offset:32768
    v_mfma_f32_16x16x32_bf16 v[32:35], v[200:203], v[40:43], v[32:35]
    ds_read_b128 v[72:75], v17 offset:36864
    v_mfma_f32_16x16x32_bf16 v[32:35], v[204:207], v[48:51], v[32:35]
    ds_read_b128 v[76:79], v17 offset:40960
    v_mfma_f32_16x16x32_bf16 v[28:31], v[204:207], v[44:47], v[28:31]
    ds_read_b128 v[80:83], v17 offset:45056
    s_barrier
    s_waitcnt lgkmcnt(4)
    v_mfma_f32_16x16x32_bf16 v[28:31], v[208:211], v[52:55], v[28:31]
    ds_read_b128 v[36:39], v10 offset:16384
    v_mfma_f32_16x16x32_bf16 v[32:35], v[208:211], v[56:59], v[32:35]
    ds_read_b128 v[40:43], v10 offset:20480
    v_mfma_f32_16x16x32_bf16 v[32:35], v[212:215], v[64:67], v[32:35]
    ds_read_b128 v[44:47], v10 offset:24576
    v_mfma_f32_16x16x32_bf16 v[28:31], v[212:215], v[60:63], v[28:31]
    ds_read_b128 v[48:51], v10 offset:28672
    s_waitcnt lgkmcnt(4)
    v_mfma_f32_16x16x32_bf16 v[28:31], v[216:219], v[68:71], v[28:31]
    ds_read_b128 v[52:55], v11 offset:16384
    v_mfma_f32_16x16x32_bf16 v[32:35], v[216:219], v[72:75], v[32:35]
    ds_read_b128 v[56:59], v11 offset:20480
    v_mfma_f32_16x16x32_bf16 v[32:35], v[220:223], v[80:83], v[32:35]
    ds_read_b128 v[60:63], v11 offset:24576
    v_mfma_f32_16x16x32_bf16 v[28:31], v[220:223], v[76:79], v[28:31]
    ds_read_b128 v[64:67], v11 offset:28672
    s_waitcnt vmcnt(0)
    buffer_atomic_add v113, v112, s[56:59], s40 offen offset:3072 sc1
    s_waitcnt lgkmcnt(4)
    v_mfma_f32_16x16x32_bf16 v[28:31], v[224:227], v[36:39], v[28:31]
    ds_read_b128 v[68:71], v12 offset:16384
    v_mfma_f32_16x16x32_bf16 v[32:35], v[224:227], v[40:43], v[32:35]
    ds_read_b128 v[72:75], v12 offset:20480
    v_mfma_f32_16x16x32_bf16 v[32:35], v[228:231], v[48:51], v[32:35]
    ds_read_b128 v[76:79], v12 offset:24576
    v_mfma_f32_16x16x32_bf16 v[28:31], v[228:231], v[44:47], v[28:31]
    ds_read_b128 v[80:83], v12 offset:28672
    s_waitcnt lgkmcnt(4)
    v_mfma_f32_16x16x32_bf16 v[28:31], v[232:235], v[52:55], v[28:31]
    ds_read_b128 v[36:39], v13 offset:16384
    v_mfma_f32_16x16x32_bf16 v[32:35], v[232:235], v[56:59], v[32:35]
    ds_read_b128 v[40:43], v13 offset:20480
    v_mfma_f32_16x16x32_bf16 v[32:35], v[236:239], v[64:67], v[32:35]
    ds_read_b128 v[44:47], v13 offset:24576
    v_mfma_f32_16x16x32_bf16 v[28:31], v[236:239], v[60:63], v[28:31]
    ds_read_b128 v[48:51], v13 offset:28672
    s_barrier
    ds_read_b128 v[88:91], v18 offset:1536
    ds_read_b128 v[92:95], v18 offset:3584
    ds_read_b128 v[96:99], v18 offset:1792
    ds_read_b128 v[100:103], v18 offset:3840
    s_waitcnt lgkmcnt(8)
    v_mfma_f32_16x16x32_bf16 v[28:31], v[240:243], v[68:71], v[28:31]
    v_mfma_f32_16x16x32_bf16 v[32:35], v[240:243], v[72:75], v[32:35]
    v_mfma_f32_16x16x32_bf16 v[32:35], v[244:247], v[80:83], v[32:35]
    v_mfma_f32_16x16x32_bf16 v[28:31], v[244:247], v[76:79], v[28:31]
    s_waitcnt lgkmcnt(4)
    v_mfma_f32_16x16x32_bf16 v[28:31], v[248:251], v[36:39], v[28:31]
    v_mfma_f32_16x16x32_bf16 v[32:35], v[248:251], v[40:43], v[32:35]
    v_mfma_f32_16x16x32_bf16 v[32:35], v[252:255], v[48:51], v[32:35]
    v_mfma_f32_16x16x32_bf16 v[28:31], v[252:255], v[44:47], v[28:31]
    s_setprio 1
    s_waitcnt lgkmcnt(0)
    s_load_dword s32, s[4:5], s20 offset:2560
    s_load_dword s3, s[4:5], s20 offset:2688
    s_add_u32 m0, s12, 139264
    s_add_u32 s49, s11, 0
    buffer_load_dwordx4 v2, s[16:19], s49 offen offset:0 sc1 lds
    buffer_load_dwordx4 v2, s[16:19], s49 offen offset:1024 sc1 lds
    buffer_load_dwordx4 v2, s[16:19], s49 offen offset:2048 sc1 lds
    buffer_load_dwordx4 v2, s[16:19], s49 offen offset:3072 sc1 lds
    v_pk_fma_f32 v[28:29], v[88:89], v[84:85], v[28:29]
    v_pk_fma_f32 v[30:31], v[88:89], v[86:87], v[30:31]
    v_pk_fma_f32 v[32:33], v[96:97], v[84:85], v[32:33]
    v_pk_fma_f32 v[34:35], v[96:97], v[86:87], v[34:35]
    v_pk_mul_f32 v[104:105], v[28:29], v[28:29]
    v_pk_mul_f32 v[106:107], v[30:31], v[30:31]
    v_pk_mul_f32 v[108:109], v[32:33], v[32:33]
    v_pk_mul_f32 v[110:111], v[34:35], v[34:35]
    v_pk_fma_f32 v[104:105], v[104:105], v[92:93], v[90:91]
    v_pk_fma_f32 v[106:107], v[106:107], v[92:93], v[90:91]
    v_pk_fma_f32 v[108:109], v[108:109], v[100:101], v[98:99]
    v_pk_fma_f32 v[110:111], v[110:111], v[100:101], v[98:99]
    v_pk_mul_f32 v[104:105], v[104:105], v[28:29]
    v_pk_mul_f32 v[106:107], v[106:107], v[30:31]
    v_pk_mul_f32 v[108:109], v[108:109], v[32:33]
    v_pk_mul_f32 v[110:111], v[110:111], v[34:35]
    v_exp_f32 v104, v104
    v_exp_f32 v105, v105
    v_exp_f32 v106, v106
    v_exp_f32 v107, v107
    v_exp_f32 v108, v108
    v_exp_f32 v109, v109
    v_exp_f32 v110, v110
    v_exp_f32 v111, v111
    v_pk_fma_f32 v[104:105], v[104:105], v[94:95], v[94:95]
    v_pk_fma_f32 v[106:107], v[106:107], v[94:95], v[94:95]
    v_pk_fma_f32 v[108:109], v[108:109], v[102:103], v[102:103]
    v_pk_fma_f32 v[110:111], v[110:111], v[102:103], v[102:103]
    v_rcp_f32 v104, v104
    v_rcp_f32 v105, v105
    v_rcp_f32 v106, v106
    v_rcp_f32 v107, v107
    v_rcp_f32 v108, v108
    v_rcp_f32 v109, v109
    v_rcp_f32 v110, v110
    v_rcp_f32 v111, v111
    v_pk_mul_f32 v[28:29], v[28:29], v[104:105]
    v_pk_mul_f32 v[30:31], v[30:31], v[106:107]
    v_pk_mul_f32 v[32:33], v[32:33], v[108:109]
    v_pk_mul_f32 v[34:35], v[34:35], v[110:111]
    v_add_u32 v28, 0x10000, v28
    v_add_u32 v30, 0x10000, v30
    v_add_u32 v32, 0x10000, v32
    v_add_u32 v34, 0x10000, v34
    v_and_b32 v28, 0xfffe0000, v28
    v_and_b32 v30, 0xfffe0000, v30
    v_and_b32 v32, 0xfffe0000, v32
    v_and_b32 v34, 0xfffe0000, v34
    v_cvt_pk_bf16_f32 v104, v28, v29
    v_cvt_pk_bf16_f32 v105, v30, v31
    v_cvt_pk_bf16_f32 v106, v32, v33
    v_cvt_pk_bf16_f32 v107, v34, v35
    s_add_u32 s36, s39, 393216
    v_permlane16_swap_b32 v104, v106
    v_permlane16_swap_b32 v105, v107
    buffer_store_dwordx4 v[104:107], v114, s[16:19], s36 offen sc1
    s_add_u32 m0, s12, 16384
    s_add_u32 s49, s8, 131072
    s_barrier
    s_waitcnt lgkmcnt(0)
    s_cmp_eq_u32 s32, s21
    s_cselect_b32 s32, s3, 0
    s_cmp_eq_u32 s32, s21
    s_cbranch_scc1 hok_11
    s_add_u32 s53, s20, 2560
    v_lshlrev_b32 v85, 7, v1
    v_add_u32 v85, s53, v85
    s_mov_b32 s53, 0
    s_add_u32 s54, s52, 16
    s_bfm_b64 exec, 2, 0
poll_12:
    buffer_load_dword v84, v85, s[56:59], 0 offen sc1
    s_waitcnt vmcnt(0)
    v_cmp_eq_u32 vcc, s54, v84
    s_nop 0
    s_cmp_eq_u64 vcc, exec
    s_cbranch_scc1 pok_13
    s_sleep 8
    s_add_u32 s53, s53, 1
    s_cmp_lt_u32 s53, s61
    s_cbranch_scc1 poll_12
    s_mov_b32 s61, 0
pok_13:
    s_mov_b64 exec, -1
hok_11:
    buffer_load_dwordx4 v2, s[16:19], s49 offen offset:0 sc1 lds
    buffer_load_dwordx4 v2, s[16:19], s49 offen offset:1024 sc1 lds
    buffer_load_dwordx4 v2, s[16:19], s49 offen offset:2048 sc1 lds
    buffer_load_dwordx4 v2, s[16:19], s49 offen offset:3072 sc1 lds
    s_add_u32 m0, s12, 32768
    s_add_u32 s49, s9, 131072
    s_barrier
    buffer_load_dwordx4 v2, s[16:19], s49 offen offset:0 sc1 lds
    buffer_load_dwordx4 v2, s[16:19], s49 offen offset:1024 sc1 lds
    buffer_load_dwordx4 v2, s[16:19], s49 offen offset:2048 sc1 lds
    buffer_load_dwordx4 v2, s[16:19], s49 offen offset:3072 sc1 lds
    s_add_u32 m0, s12, 106496
    s_add_u32 s49, s10, 131072
    s_waitcnt vmcnt(9)
    s_barrier
    s_waitcnt vmcnt(8)
    buffer_atomic_add v113, v112, s[56:59], s40 offen offset:3584 sc1
    buffer_load_dwordx4 v2, s[16:19], s49 offen offset:0 sc1 lds
    buffer_load_dwordx4 v2, s[16:19], s49 offen offset:1024 sc1 lds
    buffer_load_dwordx4 v2, s[16:19], s49 offen offset:2048 sc1 lds
    buffer_load_dwordx4 v2, s[16:19], s49 offen offset:3072 sc1 lds
    s_add_u32 m0, s12, 122880
    s_add_u32 s49, s11, 131072
    s_waitcnt vmcnt(9)
    s_barrier
    s_load_dword s32, s[4:5], s20 offset:3072
    s_load_dword s3, s[4:5], s20 offset:3200
    buffer_load_dwordx4 v2, s[16:19], s49 offen offset:0 sc1 lds
    buffer_load_dwordx4 v2, s[16:19], s49 offen offset:1024 sc1 lds
    buffer_load_dwordx4 v2, s[16:19], s49 offen offset:2048 sc1 lds
    buffer_load_dwordx4 v2, s[16:19], s49 offen offset:3072 sc1 lds
    s_add_u32 m0, s12, 139264
    s_add_u32 s49, s8, 262144
    s_waitcnt vmcnt(9)
    s_barrier
    s_waitcnt lgkmcnt(0)
    s_cmp_eq_u32 s32, s21
    s_cselect_b32 s32, s3, 0
    s_cmp_eq_u32 s32, s21
    s_cbranch_scc1 hok_14
    s_add_u32 s53, s20, 3072
    v_lshlrev_b32 v85, 7, v1
    v_add_u32 v85, s53, v85
    s_mov_b32 s53, 0
    s_add_u32 s54, s52, 16
    s_bfm_b64 exec, 2, 0
poll_15:
    buffer_load_dword v84, v85, s[56:59], 0 offen sc1
    s_waitcnt vmcnt(0)
    v_cmp_eq_u32 vcc, s54, v84
    s_nop 0
    s_cmp_eq_u64 vcc, exec
    s_cbranch_scc1 pok_16
    s_sleep 8
    s_add_u32 s53, s53, 1
    s_cmp_lt_u32 s53, s61
    s_cbranch_scc1 poll_15
    s_mov_b32 s61, 0
pok_16:
    s_mov_b64 exec, -1
hok_14:
    buffer_load_dwordx4 v2, s[16:19], s49 offen offset:0 sc1 lds
    buffer_load_dwordx4 v2, s[16:19], s49 offen offset:1024 sc1 lds
    buffer_load_dwordx4 v2, s[16:19], s49 offen offset:2048 sc1 lds
    buffer_load_dwordx4 v2, s[16:19], s49 offen offset:3072 sc1 lds
    s_add_u32 m0, s12, 16384
    s_add_u32 s49, s9, 262144
    s_waitcnt vmcnt(8)
    s_barrier
    buffer_load_dwordx4 v2, s[16:19], s49 offen offset:0 sc1 lds
    buffer_load_dwordx4 v2, s[16:19], s49 offen offset:1024 sc1 lds
    buffer_load_dwordx4 v2, s[16:19], s49 offen offset:2048 sc1 lds
    buffer_load_dwordx4 v2, s[16:19], s49 offen offset:3072 sc1 lds
    s_add_u32 m0, s12, 32768
    s_add_u32 s49, s10, 262144
    s_waitcnt vmcnt(8)
    s_barrier
    buffer_load_dwordx4 v2, s[16:19], s49 offen offset:0 sc1 lds
    buffer_load_dwordx4 v2, s[16:19], s49 offen offset:1024 sc1 lds
    buffer_load_dwordx4 v2, s[16:19], s49 offen offset:2048 sc1 lds
    buffer_load_dwordx4 v2, s[16:19], s49 offen offset:3072 sc1 lds
    s_add_u32 m0, s12, 106496
    s_add_u32 s49, s11, 262144
    s_waitcnt vmcnt(8)
    s_barrier
    s_load_dword s32, s[4:5], s20 offset:3584
    s_load_dword s3, s[4:5], s20 offset:3712
    buffer_load_dwordx4 v2, s[16:19], s49 offen offset:0 sc1 lds
    buffer_load_dwordx4 v2, s[16:19], s49 offen offset:1024 sc1 lds
    buffer_load_dwordx4 v2, s[16:19], s49 offen offset:2048 sc1 lds
    buffer_load_dwordx4 v2, s[16:19], s49 offen offset:3072 sc1 lds
    s_add_u32 m0, s12, 122880
    s_add_u32 s49, s8, 393216
    s_waitcnt vmcnt(8)
    s_barrier
    s_waitcnt lgkmcnt(0)
    s_cmp_eq_u32 s32, s21
    s_cselect_b32 s32, s3, 0
    s_cmp_eq_u32 s32, s21
    s_cbranch_scc1 hok_17
    s_add_u32 s53, s20, 3584
    v_lshlrev_b32 v85, 7, v1
    v_add_u32 v85, s53, v85
    s_mov_b32 s53, 0
    s_add_u32 s54, s52, 16
    s_bfm_b64 exec, 2, 0
poll_18:
    buffer_load_dword v84, v85, s[56:59], 0 offen sc1
    s_waitcnt vmcnt(0)
    v_cmp_eq_u32 vcc, s54, v84
    s_nop 0
    s_cmp_eq_u64 vcc, exec
    s_cbranch_scc1 pok_19
    s_sleep 8
    s_add_u32 s53, s53, 1
    s_cmp_lt_u32 s53, s61
    s_cbranch_scc1 poll_18
    s_mov_b32 s61, 0
pok_19:
    s_mov_b64 exec, -1
hok_17:
    buffer_load_dwordx4 v2, s[16:19], s49 offen offset:0 sc1 lds
    buffer_load_dwordx4 v2, s[16:19], s49 offen offset:1024 sc1 lds
    buffer_load_dwordx4 v2, s[16:19], s49 offen offset:2048 sc1 lds
    buffer_load_dwordx4 v2, s[16:19], s49 offen offset:3072 sc1 lds
    s_add_u32 m0, s12, 139264
    s_add_u32 s49, s9, 393216
    s_waitcnt vmcnt(8)
    s_barrier
    buffer_load_dwordx4 v2, s[16:19], s49 offen offset:0 sc1 lds
    buffer_load_dwordx4 v2, s[16:19], s49 offen offset:1024 sc1 lds
    buffer_load_dwordx4 v2, s[16:19], s49 offen offset:2048 sc1 lds
    buffer_load_dwordx4 v2, s[16:19], s49 offen offset:3072 sc1 lds
    s_add_u32 m0, s12, 16384
    s_add_u32 s49, s10, 393216
    s_waitcnt vmcnt(8)
    s_barrier
    buffer_load_dwordx4 v2, s[16:19], s49 offen offset:0 sc1 lds
    buffer_load_dwordx4 v2, s[16:19], s49 offen offset:1024 sc1 lds
    buffer_load_dwordx4 v2, s[16:19], s49 offen offset:2048 sc1 lds
    buffer_load_dwordx4 v2, s[16:19], s49 offen offset:3072 sc1 lds
    s_add_u32 m0, s12, 32768
    s_add_u32 s49, s11, 393216
    s_waitcnt vmcnt(8)
    s_barrier
    buffer_load_dwordx4 v2, s[16:19], s49 offen offset:0 sc1 lds
    buffer_load_dwordx4 v2, s[16:19], s49 offen offset:1024 sc1 lds
    buffer_load_dwordx4 v2, s[16:19], s49 offen offset:2048 sc1 lds
    buffer_load_dwordx4 v2, s[16:19], s49 offen offset:3072 sc1 lds
    s_waitcnt vmcnt(8)
    s_barrier
    s_lshr_b32 s34, s30, 1
    s_and_b32 s35, s30, 1
    v_and_b32 v22, 15, v1
    v_lshrrev_b32 v23, 4, v1
    s_mul_i32 s37, s34, 4
    s_mul_i32 s38, s29, 14
    s_mul_i32 s36, s35, 7
    s_add_u32 s38, s38, s36
    s_mul_i32 s36, s34, 8192
    v_add_u32 v12, s36, v2
    v_lshrrev_b32 v6, 2, v1
    v_mul_u32_u24 v13, 448, v6
    v_and_b32 v7, 3, v1
    v_lshl_add_u32 v13, v7, 3, v13
    v_add_u32 v13, 49152, v13
    v_mul_u32_u24 v15, 448, v6
    v_and_b32 v7, 2, v1
    v_lshl_add_u32 v15, v7, 2, v15
    v_bfe_u32 v6, v1, 4, 1
    v_and_b32 v7, 1, v1
    v_xor_b32 v7, v7, v6
    v_lshl_add_u32 v15, v7, 5, v15
    s_lshl_b32 s36, s35, 4
    s_add_u32 s36, s36, 49344
    v_add_u32 v15, s36, v15
    s_lshl_b32 s36, s35, 8
    v_add_u32 v13, s36, v13
    v_lshlrev_b32 v6, 5, v6
    v_sub_u32 v14, v13, v6
    v_add_u32 v13, v13, v6
    s_mov_b32 s42, 0
    s_mov_b32 s43, 0
    s_mov_b32 s48, 0
    v_mov_b32 v17, v12
    v_mov_b32 v18, v13
    v_mov_b32 v19, v14
    v_mov_b32 v20, v15
    s_waitcnt vmcnt(4)
    s_barrier
    s_waitcnt vmcnt(0)
    s_barrier
    s_setprio 0
    s_waitcnt lgkmcnt(0)
    s_barrier
    ds_read_b128 v[136:139], v17 offset:0
    ds_read_b128 v[140:143], v17 offset:2048
    ds_read_b128 v[144:147], v17 offset:4096
    ds_read_b128 v[148:151], v17 offset:6144
    ds_read_b64_tr_b16 v[152:153], v18 offset:0
    ds_read_b64_tr_b16 v[154:155], v18 offset:7168
    ds_read_b64_tr_b16 v[156:157], v19 offset:32
    ds_read_b64_tr_b16 v[158:159], v19 offset:7200
    ds_read_b64_tr_b16 v[160:161], v18 offset:64
    ds_read_b64_tr_b16 v[162:163], v18 offset:7232
    ds_read_b64_tr_b16 v[164:165], v19 offset:96
    ds_read_b64_tr_b16 v[166:167], v19 offset:7264
    ds_read_b64_tr_b16 v[168:169], v18 offset:128
    ds_read_b64_tr_b16 v[170:171], v18 offset:7296
    ds_read_b64_tr_b16 v[172:173], v19 offset:160
    ds_read_b64_tr_b16 v[174:175], v19 offset:7328
    ds_read_b64_tr_b16 v[176:177], v20 offset:0
    ds_read_b64_tr_b16 v[178:179], v20 offset:7168
    s_waitcnt lgkmcnt(0)
    v_mfma_f32_16x16x32_bf16 v[24:27], v[152:155], v[136:139], 0
    ds_read_b128 v[180:183], v17 offset:1024
    v_mfma_f32_16x16x32_bf16 v[52:55], v[152:155], v[140:143], 0
    ds_read_b128 v[184:187], v17 offset:3072
    v_mfma_f32_16x16x32_bf16 v[80:83], v[152:155], v[144:147], 0
    ds_read_b128 v[188:191], v17 offset:5120
    v_mfma_f32_16x16x32_bf16 v[108:111], v[152:155], v[148:151], 0
    ds_read_b128 v[192:195], v17 offset:7168
    v_mfma_f32_16x16x32_bf16 v[112:115], v[156:159], v[148:151], 0
    ds_read_b64_tr_b16 v[196:197], v18 offset:14336
    v_mfma_f32_16x16x32_bf16 v[84:87], v[156:159], v[144:147], 0
    ds_read_b64_tr_b16 v[198:199], v18 offset:21504
    v_mfma_f32_16x16x32_bf16 v[56:59], v[156:159], v[140:143], 0
    v_mfma_f32_16x16x32_bf16 v[28:31], v[156:159], v[136:139], 0
    ds_read_b64_tr_b16 v[200:201], v19 offset:14368
    v_mfma_f32_16x16x32_bf16 v[32:35], v[160:163], v[136:139], 0
    ds_read_b64_tr_b16 v[202:203], v19 offset:21536
    v_mfma_f32_16x16x32_bf16 v[60:63], v[160:163], v[140:143], 0
    ds_read_b64_tr_b16 v[204:205], v18 offset:14400
    v_mfma_f32_16x16x32_bf16 v[88:91], v[160:163], v[144:147], 0
    ds_read_b64_tr_b16 v[206:207], v18 offset:21568
    v_mfma_f32_16x16x32_bf16 v[116:119], v[160:163], v[148:151], 0
    ds_read_b64_tr_b16 v[208:209], v19 offset:14432
    v_mfma_f32_16x16x32_bf16 v[120:123], v[164:167], v[148:151], 0
    ds_read_b64_tr_b16 v[210:211], v19 offset:21600
    v_mfma_f32_16x16x32_bf16 v[92:95], v[164:167], v[144:147], 0
    v_mfma_f32_16x16x32_bf16 v[64:67], v[164:167], v[140:143], 0
    ds_read_b64_tr_b16 v[212:213], v18 offset:14464
    v_mfma_f32_16x16x32_bf16 v[36:39], v[164:167], v[136:139], 0
    ds_read_b64_tr_b16 v[214:215], v18 offset:21632
    v_mfma_f32_16x16x32_bf16 v[40:43], v[168:171], v[136:139], 0
    ds_read_b64_tr_b16 v[216:217], v19 offset:14496
    v_mfma_f32_16x16x32_bf16 v[68:71], v[168:171], v[140:143], 0
    ds_read_b64_tr_b16 v[218:219], v19 offset:21664
    v_mfma_f32_16x16x32_bf16 v[96:99], v[168:171], v[144:147], 0
    ds_read_b64_tr_b16 v[220:221], v20 offset:14336
    v_mfma_f32_16x16x32_bf16 v[124:127], v[168:171], v[148:151], 0
    ds_read_b64_tr_b16 v[222:223], v20 offset:21504
    v_mfma_f32_16x16x32_bf16 v[128:131], v[172:175], v[148:151], 0
    s_add_u32 s42, s42, 16384
    s_cmp_eq_u32 s42, 49152
    v_mfma_f32_16x16x32_bf16 v[100:103], v[172:175], v[144:147], 0
    s_cselect_b32 s42, 0, s42
    s_add_u32 s48, s48, 28672
    v_mfma_f32_16x16x32_bf16 v[72:75], v[172:175], v[140:143], 0
    s_cmp_eq_u32 s48, 86016
    s_cselect_b32 s48, 0, s48
    v_mfma_f32_16x16x32_bf16 v[44:47], v[172:175], v[136:139], 0
    v_add_u32 v17, s42, v12
    v_add_u32 v18, s48, v13
    v_mfma_f32_16x16x32_bf16 v[48:51], v[176:179], v[136:139], 0
    v_add_u32 v19, s48, v14
    v_add_u32 v20, s48, v15
    v_mfma_f32_16x16x32_bf16 v[76:79], v[176:179], v[140:143], 0
    v_mfma_f32_16x16x32_bf16 v[104:107], v[176:179], v[144:147], 0
    v_mfma_f32_16x16x32_bf16 v[132:135], v[176:179], v[148:151], 0
    s_waitcnt lgkmcnt(0)
    v_mfma_f32_16x16x32_bf16 v[24:27], v[196:199], v[180:183], v[24:27]
    v_mfma_f32_16x16x32_bf16 v[52:55], v[196:199], v[184:187], v[52:55]
    v_mfma_f32_16x16x32_bf16 v[80:83], v[196:199], v[188:191], v[80:83]
    v_mfma_f32_16x16x32_bf16 v[108:111], v[196:199], v[192:195], v[108:111]
    v_mfma_f32_16x16x32_bf16 v[112:115], v[200:203], v[192:195], v[112:115]
    v_mfma_f32_16x16x32_bf16 v[84:87], v[200:203], v[188:191], v[84:87]
    v_mfma_f32_16x16x32_bf16 v[56:59], v[200:203], v[184:187], v[56:59]
    v_mfma_f32_16x16x32_bf16 v[28:31], v[200:203], v[180:183], v[28:31]
    v_mfma_f32_16x16x32_bf16 v[32:35], v[204:207], v[180:183], v[32:35]
    v_mfma_f32_16x16x32_bf16 v[60:63], v[204:207], v[184:187], v[60:63]
    v_mfma_f32_16x16x32_bf16 v[88:91], v[204:207], v[188:191], v[88:91]
    v_mfma_f32_16x16x32_bf16 v[116:119], v[204:207], v[192:195], v[116:119]
    v_mfma_f32_16x16x32_bf16 v[120:123], v[208:211], v[192:195], v[120:123]
    v_mfma_f32_16x16x32_bf16 v[92:95], v[208:211], v[188:191], v[92:95]
    v_mfma_f32_16x16x32_bf16 v[64:67], v[208:211], v[184:187], v[64:67]
    v_mfma_f32_16x16x32_bf16 v[36:39], v[208:211], v[180:183], v[36:39]
    v_mfma_f32_16x16x32_bf16 v[40:43], v[212:215], v[180:183], v[40:43]
    v_mfma_f32_16x16x32_bf16 v[68:71], v[212:215], v[184:187], v[68:71]
    v_mfma_f32_16x16x32_bf16 v[96:99], v[212:215], v[188:191], v[96:99]
    v_mfma_f32_16x16x32_bf16 v[124:127], v[212:215], v[192:195], v[124:127]
    v_mfma_f32_16x16x32_bf16 v[128:131], v[216:219], v[192:195], v[128:131]
    s_add_u32 s43, s43, 1
    v_mfma_f32_16x16x32_bf16 v[100:103], v[216:219], v[188:191], v[100:103]
    v_mfma_f32_16x16x32_bf16 v[72:75], v[216:219], v[184:187], v[72:75]
    v_mfma_f32_16x16x32_bf16 v[44:47], v[216:219], v[180:183], v[44:47]
    v_mfma_f32_16x16x32_bf16 v[48:51], v[220:223], v[180:183], v[48:51]
    v_mfma_f32_16x16x32_bf16 v[76:79], v[220:223], v[184:187], v[76:79]
    v_mfma_f32_16x16x32_bf16 v[104:107], v[220:223], v[188:191], v[104:107]
    v_mfma_f32_16x16x32_bf16 v[132:135], v[220:223], v[192:195], v[132:135]
    s_barrier
    ds_read_b128 v[136:139], v17 offset:0
    ds_read_b128 v[140:143], v17 offset:2048
    ds_read_b128 v[144:147], v17 offset:4096
    ds_read_b128 v[148:151], v17 offset:6144
    ds_read_b64_tr_b16 v[152:153], v18 offset:0
    ds_read_b64_tr_b16 v[154:155], v18 offset:7168
    ds_read_b64_tr_b16 v[156:157], v19 offset:32
    ds_read_b64_tr_b16 v[158:159], v19 offset:7200
    ds_read_b64_tr_b16 v[160:161], v18 offset:64
    ds_read_b64_tr_b16 v[162:163], v18 offset:7232
    ds_read_b64_tr_b16 v[164:165], v19 offset:96
    ds_read_b64_tr_b16 v[166:167], v19 offset:7264
    ds_read_b64_tr_b16 v[168:169], v18 offset:128
    ds_read_b64_tr_b16 v[170:171], v18 offset:7296
    ds_read_b64_tr_b16 v[172:173], v19 offset:160
    ds_read_b64_tr_b16 v[174:175], v19 offset:7328
    ds_read_b64_tr_b16 v[176:177], v20 offset:0
    ds_read_b64_tr_b16 v[178:179], v20 offset:7168
mm_20:
    s_waitcnt lgkmcnt(0)
    v_mfma_f32_16x16x32_bf16 v[24:27], v[152:155], v[136:139], v[24:27]
    ds_read_b128 v[180:183], v17 offset:1024
    v_mfma_f32_16x16x32_bf16 v[52:55], v[152:155], v[140:143], v[52:55]
    ds_read_b128 v[184:187], v17 offset:3072
    v_mfma_f32_16x16x32_bf16 v[80:83], v[152:155], v[144:147], v[80:83]
    ds_read_b128 v[188:191], v17 offset:5120
    v_mfma_f32_16x16x32_bf16 v[108:111], v[152:155], v[148:151], v[108:111]
    ds_read_b128 v[192:195], v17 offset:7168
    v_mfma_f32_16x16x32_bf16 v[112:115], v[156:159], v[148:151], v[112:115]
    ds_read_b64_tr_b16 v[196:197], v18 offset:14336
    v_mfma_f32_16x16x32_bf16 v[84:87], v[156:159], v[144:147], v[84:87]
    ds_read_b64_tr_b16 v[198:199], v18 offset:21504
    v_mfma_f32_16x16x32_bf16 v[56:59], v[156:159], v[140:143], v[56:59]
    v_mfma_f32_16x16x32_bf16 v[28:31], v[156:159], v[136:139], v[28:31]
    ds_read_b64_tr_b16 v[200:201], v19 offset:14368
    v_mfma_f32_16x16x32_bf16 v[32:35], v[160:163], v[136:139], v[32:35]
    ds_read_b64_tr_b16 v[202:203], v19 offset:21536
    v_mfma_f32_16x16x32_bf16 v[60:63], v[160:163], v[140:143], v[60:63]
    ds_read_b64_tr_b16 v[204:205], v18 offset:14400
    v_mfma_f32_16x16x32_bf16 v[88:91], v[160:163], v[144:147], v[88:91]
    ds_read_b64_tr_b16 v[206:207], v18 offset:21568
    v_mfma_f32_16x16x32_bf16 v[116:119], v[160:163], v[148:151], v[116:119]
    ds_read_b64_tr_b16 v[208:209], v19 offset:14432
    v_mfma_f32_16x16x32_bf16 v[120:123], v[164:167], v[148:151], v[120:123]
    ds_read_b64_tr_b16 v[210:211], v19 offset:21600
    v_mfma_f32_16x16x32_bf16 v[92:95], v[164:167], v[144:147], v[92:95]
    v_mfma_f32_16x16x32_bf16 v[64:67], v[164:167], v[140:143], v[64:67]
    ds_read_b64_tr_b16 v[212:213], v18 offset:14464
    v_mfma_f32_16x16x32_bf16 v[36:39], v[164:167], v[136:139], v[36:39]
    ds_read_b64_tr_b16 v[214:215], v18 offset:21632
    v_mfma_f32_16x16x32_bf16 v[40:43], v[168:171], v[136:139], v[40:43]
    ds_read_b64_tr_b16 v[216:217], v19 offset:14496
    v_mfma_f32_16x16x32_bf16 v[68:71], v[168:171], v[140:143], v[68:71]
    ds_read_b64_tr_b16 v[218:219], v19 offset:21664
    v_mfma_f32_16x16x32_bf16 v[96:99], v[168:171], v[144:147], v[96:99]
    ds_read_b64_tr_b16 v[220:221], v20 offset:14336
    v_mfma_f32_16x16x32_bf16 v[124:127], v[168:171], v[148:151], v[124:127]
    ds_read_b64_tr_b16 v[222:223], v20 offset:21504
    v_mfma_f32_16x16x32_bf16 v[128:131], v[172:175], v[148:151], v[128:131]
    s_add_u32 s42, s42, 16384
    s_cmp_eq_u32 s42, 49152
    v_mfma_f32_16x16x32_bf16 v[100:103], v[172:175], v[144:147], v[100:103]
    s_cselect_b32 s42, 0, s42
    s_add_u32 s48, s48, 28672
    v_mfma_f32_16x16x32_bf16 v[72:75], v[172:175], v[140:143], v[72:75]
    s_cmp_eq_u32 s48, 86016
    s_cselect_b32 s48, 0, s48
    v_mfma_f32_16x16x32_bf16 v[44:47], v[172:175], v[136:139], v[44:47]
    v_add_u32 v17, s42, v12
    v_add_u32 v18, s48, v13
    v_mfma_f32_16x16x32_bf16 v[48:51], v[176:179], v[136:139], v[48:51]
    v_add_u32 v19, s48, v14
    v_add_u32 v20, s48, v15
    v_mfma_f32_16x16x32_bf16 v[76:79], v[176:179], v[140:143], v[76:79]
    v_mfma_f32_16x16x32_bf16 v[104:107], v[176:179], v[144:147], v[104:107]
    v_mfma_f32_16x16x32_bf16 v[132:135], v[176:179], v[148:151], v[132:135]
    s_waitcnt lgkmcnt(0)
    s_barrier
    v_mfma_f32_16x16x32_bf16 v[24:27], v[196:199], v[180:183], v[24:27]
    ds_read_b128 v[136:139], v17 offset:0
    v_mfma_f32_16x16x32_bf16 v[52:55], v[196:199], v[184:187], v[52:55]
    ds_read_b128 v[140:143], v17 offset:2048
    v_mfma_f32_16x16x32_bf16 v[80:83], v[196:199], v[188:191], v[80:83]
    ds_read_b128 v[144:147], v17 offset:4096
    v_mfma_f32_16x16x32_bf16 v[108:111], v[196:199], v[192:195], v[108:111]
    ds_read_b128 v[148:151], v17 offset:6144
    v_mfma_f32_16x16x32_bf16 v[112:115], v[200:203], v[192:195], v[112:115]
    ds_read_b64_tr_b16 v[152:153], v18 offset:0
    v_mfma_f32_16x16x32_bf16 v[84:87], v[200:203], v[188:191], v[84:87]
    ds_read_b64_tr_b16 v[154:155], v18 offset:7168
    v_mfma_f32_16x16x32_bf16 v[56:59], v[200:203], v[184:187], v[56:59]
    v_mfma_f32_16x16x32_bf16 v[28:31], v[200:203], v[180:183], v[28:31]
    ds_read_b64_tr_b16 v[156:157], v19 offset:32
    v_mfma_f32_16x16x32_bf16 v[32:35], v[204:207], v[180:183], v[32:35]
    ds_read_b64_tr_b16 v[158:159], v19 offset:7200
    v_mfma_f32_16x16x32_bf16 v[60:63], v[204:207], v[184:187], v[60:63]
    ds_read_b64_tr_b16 v[160:161], v18 offset:64
    v_mfma_f32_16x16x32_bf16 v[88:91], v[204:207], v[188:191], v[88:91]
    ds_read_b64_tr_b16 v[162:163], v18 offset:7232
    v_mfma_f32_16x16x32_bf16 v[116:119], v[204:207], v[192:195], v[116:119]
    ds_read_b64_tr_b16 v[164:165], v19 offset:96
    v_mfma_f32_16x16x32_bf16 v[120:123], v[208:211], v[192:195], v[120:123]
    ds_read_b64_tr_b16 v[166:167], v19 offset:7264
    v_mfma_f32_16x16x32_bf16 v[92:95], v[208:211], v[188:191], v[92:95]
    v_mfma_f32_16x16x32_bf16 v[64:67], v[208:211], v[184:187], v[64:67]
    ds_read_b64_tr_b16 v[168:169], v18 offset:128
    v_mfma_f32_16x16x32_bf16 v[36:39], v[208:211], v[180:183], v[36:39]
    ds_read_b64_tr_b16 v[170:171], v18 offset:7296
    v_mfma_f32_16x16x32_bf16 v[40:43], v[212:215], v[180:183], v[40:43]
    ds_read_b64_tr_b16 v[172:173], v19 offset:160
    v_mfma_f32_16x16x32_bf16 v[68:71], v[212:215], v[184:187], v[68:71]
    ds_read_b64_tr_b16 v[174:175], v19 offset:7328
    v_mfma_f32_16x16x32_bf16 v[96:99], v[212:215], v[188:191], v[96:99]
    ds_read_b64_tr_b16 v[176:177], v20 offset:0
    v_mfma_f32_16x16x32_bf16 v[124:127], v[212:215], v[192:195], v[124:127]
    ds_read_b64_tr_b16 v[178:179], v20 offset:7168
    v_mfma_f32_16x16x32_bf16 v[128:131], v[216:219], v[192:195], v[128:131]
    s_add_u32 s43, s43, 1
    v_mfma_f32_16x16x32_bf16 v[100:103], v[216:219], v[188:191], v[100:103]
    s_cmp_lt_u32 s43, 15
    v_mfma_f32_16x16x32_bf16 v[72:75], v[216:219], v[184:187], v[72:75]
    v_mfma_f32_16x16x32_bf16 v[44:47], v[216:219], v[180:183], v[44:47]
    v_mfma_f32_16x16x32_bf16 v[48:51], v[220:223], v[180:183], v[48:51]
    v_mfma_f32_16x16x32_bf16 v[76:79], v[220:223], v[184:187], v[76:79]
    v_mfma_f32_16x16x32_bf16 v[104:107], v[220:223], v[188:191], v[104:107]
    v_mfma_f32_16x16x32_bf16 v[132:135], v[220:223], v[192:195], v[132:135]
    s_cbranch_scc1 mm_20
    s_waitcnt lgkmcnt(0)
    v_mfma_f32_16x16x32_bf16 v[24:27], v[152:155], v[136:139], v[24:27]
    ds_read_b128 v[180:183], v17 offset:1024
    v_mfma_f32_16x16x32_bf16 v[52:55], v[152:155], v[140:143], v[52:55]
    ds_read_b128 v[184:187], v17 offset:3072
    v_mfma_f32_16x16x32_bf16 v[80:83], v[152:155], v[144:147], v[80:83]
    ds_read_b128 v[188:191], v17 offset:5120
    v_mfma_f32_16x16x32_bf16 v[108:111], v[152:155], v[148:151], v[108:111]
    ds_read_b128 v[192:195], v17 offset:7168
    v_mfma_f32_16x16x32_bf16 v[112:115], v[156:159], v[148:151], v[112:115]
    ds_read_b64_tr_b16 v[196:197], v18 offset:14336
    v_mfma_f32_16x16x32_bf16 v[84:87], v[156:159], v[144:147], v[84:87]
    ds_read_b64_tr_b16 v[198:199], v18 offset:21504
    v_mfma_f32_16x16x32_bf16 v[56:59], v[156:159], v[140:143], v[56:59]
    v_mfma_f32_16x16x32_bf16 v[28:31], v[156:159], v[136:139], v[28:31]
    ds_read_b64_tr_b16 v[200:201], v19 offset:14368
    v_mfma_f32_16x16x32_bf16 v[32:35], v[160:163], v[136:139], v[32:35]
    ds_read_b64_tr_b16 v[202:203], v19 offset:21536
    v_mfma_f32_16x16x32_bf16 v[60:63], v[160:163], v[140:143], v[60:63]
    ds_read_b64_tr_b16 v[204:205], v18 offset:14400
    v_mfma_f32_16x16x32_bf16 v[88:91], v[160:163], v[144:147], v[88:91]
    ds_read_b64_tr_b16 v[206:207], v18 offset:21568
    v_mfma_f32_16x16x32_bf16 v[116:119], v[160:163], v[148:151], v[116:119]
    ds_read_b64_tr_b16 v[208:209], v19 offset:14432
    v_mfma_f32_16x16x32_bf16 v[120:123], v[164:167], v[148:151], v[120:123]
    ds_read_b64_tr_b16 v[210:211], v19 offset:21600
    v_mfma_f32_16x16x32_bf16 v[92:95], v[164:167], v[144:147], v[92:95]
    v_mfma_f32_16x16x32_bf16 v[64:67], v[164:167], v[140:143], v[64:67]
    ds_read_b64_tr_b16 v[212:213], v18 offset:14464
    v_mfma_f32_16x16x32_bf16 v[36:39], v[164:167], v[136:139], v[36:39]
    ds_read_b64_tr_b16 v[214:215], v18 offset:21632
    v_mfma_f32_16x16x32_bf16 v[40:43], v[168:171], v[136:139], v[40:43]
    ds_read_b64_tr_b16 v[216:217], v19 offset:14496
    v_mfma_f32_16x16x32_bf16 v[68:71], v[168:171], v[140:143], v[68:71]
    ds_read_b64_tr_b16 v[218:219], v19 offset:21664
    v_mfma_f32_16x16x32_bf16 v[96:99], v[168:171], v[144:147], v[96:99]
    ds_read_b64_tr_b16 v[220:221], v20 offset:14336
    v_mfma_f32_16x16x32_bf16 v[124:127], v[168:171], v[148:151], v[124:127]
    ds_read_b64_tr_b16 v[222:223], v20 offset:21504
    v_mfma_f32_16x16x32_bf16 v[128:131], v[172:175], v[148:151], v[128:131]
    v_mfma_f32_16x16x32_bf16 v[100:103], v[172:175], v[144:147], v[100:103]
    v_mfma_f32_16x16x32_bf16 v[72:75], v[172:175], v[140:143], v[72:75]
    v_mfma_f32_16x16x32_bf16 v[44:47], v[172:175], v[136:139], v[44:47]
    v_mfma_f32_16x16x32_bf16 v[48:51], v[176:179], v[136:139], v[48:51]
    v_mfma_f32_16x16x32_bf16 v[76:79], v[176:179], v[140:143], v[76:79]
    v_mfma_f32_16x16x32_bf16 v[104:107], v[176:179], v[144:147], v[104:107]
    v_mfma_f32_16x16x32_bf16 v[132:135], v[176:179], v[148:151], v[132:135]
    s_waitcnt lgkmcnt(0)
    s_barrier
    v_mfma_f32_16x16x32_bf16 v[24:27], v[196:199], v[180:183], v[24:27]
    s_mul_i32 s36, s35, 448
    s_add_u32 s36, s36, 159744
    v_lshlrev_b32 v6, 4, v23
    v_add_u32 v6, s36, v6
    v_mfma_f32_16x16x32_bf16 v[52:55], v[196:199], v[184:187], v[52:55]
    ds_read_b128 v[136:139], v6 offset:0
    ds_read_b128 v[140:143], v6 offset:64
    ds_read_b128 v[144:147], v6 offset:128
    ds_read_b128 v[148:151], v6 offset:192
    v_mfma_f32_16x16x32_bf16 v[80:83], v[196:199], v[188:191], v[80:83]
    ds_read_b128 v[152:155], v6 offset:256
    ds_read_b128 v[156:159], v6 offset:320
    ds_read_b128 v[160:163], v6 offset:384
    s_lshl_b32 s36, s34, 9
    v_mfma_f32_16x16x32_bf16 v[108:111], v[196:199], v[192:195], v[108:111]
    s_add_u32 s36, s36, 160768
    v_lshlrev_b32 v7, 3, v22
    v_add_u32 v7, s36, v7
    ds_read_b64 v[164:165], v7 offset:0
    v_mfma_f32_16x16x32_bf16 v[112:115], v[200:203], v[192:195], v[112:115]
    ds_read_b64 v[166:167], v7 offset:128
    ds_read_b64 v[168:169], v7 offset:256
    ds_read_b64 v[170:171], v7 offset:384
    s_mov_b32 s16, s62
    v_mfma_f32_16x16x32_bf16 v[84:87], v[200:203], v[188:191], v[84:87]
    s_mov_b32 s17, s63
    s_mov_b32 s18, 0x1be000
    s_mov_b32 s19, 0x20000
    s_mul_i32 s39, s37, 229376
    v_mfma_f32_16x16x32_bf16 v[56:59], v[200:203], v[184:187], v[56:59]
    s_mul_i32 s40, s29, 7
    s_lshl2_add_u32 s41, s35, s40
    s_add_u32 s36, s41, 0
    s_lshr_b32 s53, s36, 3
    v_mfma_f32_16x16x32_bf16 v[28:31], v[200:203], v[180:183], v[28:31]
    s_lshl_b32 s53, s53, 14
    s_and_b32 s44, s36, 7
    s_lshl_b32 s44, s44, 10
    s_add_u32 s44, s44, s53
    v_mfma_f32_16x16x32_bf16 v[32:35], v[204:207], v[180:183], v[32:35]
    s_add_u32 s44, s44, s39
    s_add_u32 s36, s41, 1
    s_lshr_b32 s53, s36, 3
    s_lshl_b32 s53, s53, 14
    v_mfma_f32_16x16x32_bf16 v[60:63], v[204:207], v[184:187], v[60:63]
    s_and_b32 s45, s36, 7
    s_lshl_b32 s45, s45, 10
    s_add_u32 s45, s45, s53
    s_add_u32 s45, s45, s39
    v_mfma_f32_16x16x32_bf16 v[88:91], v[204:207], v[188:191], v[88:91]
    s_add_u32 s36, s41, 2
    s_lshr_b32 s53, s36, 3
    s_lshl_b32 s53, s53, 14
    v_mfma_f32_16x16x32_bf16 v[116:119], v[204:207], v[192:195], v[116:119]
    s_and_b32 s46, s36, 7
    s_lshl_b32 s46, s46, 10
    s_add_u32 s46, s46, s53
    s_add_u32 s46, s46, s39
    v_mfma_f32_16x16x32_bf16 v[120:123], v[208:211], v[192:195], v[120:123]
    s_add_u32 s36, s40, 3
    s_lshr_b32 s53, s36, 3
    s_lshl_b32 s53, s53, 14
    s_and_b32 s47, s36, 7
    v_mfma_f32_16x16x32_bf16 v[92:95], v[208:211], v[188:191], v[92:95]
    s_lshl_b32 s47, s47, 10
    s_add_u32 s47, s47, s53
    s_add_u32 s47, s47, s39
    s_lshl_b32 s36, s35, 9
    v_mfma_f32_16x16x32_bf16 v[64:67], v[208:211], v[184:187], v[64:67]
    s_add_u32 s47, s47, s36
    s_lshl_b32 s36, s37, 1
    s_add_u32 s36, s36, s35
    s_lshl2_add_u32 s36, s31, s36
    v_mfma_f32_16x16x32_bf16 v[36:39], v[208:211], v[180:183], v[36:39]
    s_lshl_b32 s36, s36, 10
    v_add_u32 v12, s36, v2
    v_xor_b32 v17, 4096, v12
    v_lshrrev_b32 v254, 1, v23
    v_mfma_f32_16x16x32_bf16 v[40:43], v[212:215], v[180:183], v[40:43]
    v_lshlrev_b32 v254, 8, v254
    v_lshl_add_u32 v254, v22, 4, v254
    v_and_b32 v255, 1, v23
    v_lshl_add_u32 v254, v255, 3, v254
    v_mfma_f32_16x16x32_bf16 v[68:71], v[212:215], v[184:187], v[68:71]
    v_lshrrev_b32 v255, 2, v22
    v_cmp_eq_u32 vcc, v255, v23
    v_and_b32 v255, 1, v22
    v_lshlrev_b32 v255, 4, v255
    v_mfma_f32_16x16x32_bf16 v[96:99], v[212:215], v[188:191], v[96:99]
    v_mov_b32 v224, 0x3f80
    v_lshlrev_b32 v255, v255, v224
    v_cndmask_b32 v255, 0, v255, vcc
    v_and_b32 v224, 2, v22
    v_mfma_f32_16x16x32_bf16 v[124:127], v[212:215], v[192:195], v[124:127]
    v_cmp_eq_u32 vcc, 0, v224
    v_mov_b32 v224, 0
    v_mov_b32 v225, 0
    v_mov_b32 v228, 0
    v_mfma_f32_16x16x32_bf16 v[128:131], v[216:219], v[192:195], v[128:131]
    v_mov_b32 v229, 0
    v_cndmask_b32 v226, 0, v255, vcc
    v_cndmask_b32 v227, v255, v224, vcc
    v_mfma_f32_16x16x32_bf16 v[100:103], v[216:219], v[188:191], v[100:103]
    v_mfma_f32_16x16x32_bf16 v[72:75], v[216:219], v[184:187], v[72:75]
    v_mfma_f32_16x16x32_bf16 v[44:47], v[216:219], v[180:183], v[44:47]
    v_mfma_f32_16x16x32_bf16 v[48:51], v[220:223], v[180:183], v[48:51]
    v_mfma_f32_16x16x32_bf16 v[76:79], v[220:223], v[184:187], v[76:79]
    v_mfma_f32_16x16x32_bf16 v[104:107], v[220:223], v[188:191], v[104:107]
    v_mfma_f32_16x16x32_bf16 v[132:135], v[220:223], v[192:195], v[132:135]
    s_lshl_b32 s86, s60, 24
    s_lshl_b32 s87, s94, 13
    s_add_u32 s86, s86, s87
    s_add_u32 s86, s86, 167772160
    s_add_u32 s84, s4, s86
    s_addc_u32 s85, s5, 0
    s_mov_b32 s86, 8380416
    s_mov_b32 s87, 0x20000
    s_add_u32 s88, s62, 0x480000
    s_addc_u32 s89, s63, 0
    s_mov_b32 s90, 0x7e000
    s_mov_b32 s91, 0x20000
    s_lshl1_add_u32 s8, s33, s35
    s_lshl_b32 s36, s8, 1
    s_lshr_b32 s53, s36, 3
    s_lshl_b32 s53, s53, 14
    s_and_b32 s9, s36, 7
    s_lshl_b32 s9, s9, 10
    s_add_u32 s9, s9, s53
    s_lshl1_add_u32 s11, s31, s37
    s_lshl_b32 s36, s11, 16
    s_add_u32 s9, s9, s36
    s_add_u32 s10, s9, 65536
    s_lshl3_add_u32 s11, s28, s11
    v_and_b32 v7, 3, v22
    v_lshrrev_b32 v6, 2, v22
    v_lshlrev_b32 v6, 14, v6
    v_lshl_add_u32 v6, v7, 11, v6
    v_lshl_add_u32 v6, v23, 4, v6
    s_lshl_b32 s36, s11, 16
    s_lshl_b32 s40, s8, 7
    s_add_u32 s36, s36, s40
    s_waitcnt lgkmcnt(0)
    buffer_load_dwordx4 v[172:175], v6, s[84:87], s36 offen offset:0 sc1
    buffer_load_dwordx4 v[176:179], v2, s[88:91], s9 offen offset:0 sc1
    buffer_load_dwordx4 v[200:203], v6, s[84:87], s36 offen offset:64 sc1
    buffer_load_dwordx4 v[204:207], v2, s[88:91], s9 offen offset:1024 sc1
    s_add_u32 s36, s36, 65536
    buffer_load_dwordx4 v[208:211], v6, s[84:87], s36 offen offset:0 sc1
    buffer_load_dwordx4 v[212:215], v2, s[88:91], s10 offen offset:0 sc1
    buffer_load_dwordx4 v[216:219], v6, s[84:87], s36 offen offset:64 sc1
    buffer_load_dwordx4 v[220:223], v2, s[88:91], s10 offen offset:1024 sc1
    v_mul_f32 v184, 0xc0135761, v165
    v_mul_f32 v185, v165, v165
    v_mul_f32 v185, v185, v184
    v_mul_f32 v185, 0x3d372713, v185
    v_rcp_f32 v165, v165
    v_mul_f32 v186, 0xc0135761, v167
    v_mul_f32 v187, v167, v167
    v_mul_f32 v187, v187, v186
    v_mul_f32 v187, 0x3d372713, v187
    v_rcp_f32 v167, v167
    v_mul_f32 v188, 0xc0135761, v169
    v_mul_f32 v189, v169, v169
    v_mul_f32 v189, v189, v188
    v_mul_f32 v189, 0x3d372713, v189
    v_rcp_f32 v169, v169
    v_mul_f32 v190, 0xc0135761, v171
    v_mul_f32 v191, v171, v171
    v_mul_f32 v191, v191, v190
    v_mul_f32 v191, 0x3d372713, v191
    v_rcp_f32 v171, v171
    v_pk_fma_f32 v[24:25], v[164:165], v[136:137], v[24:25] op_sel_hi:[0,1,1] neg_lo:[1,0,0] neg_hi:[1,0,0]
    v_pk_fma_f32 v[26:27], v[164:165], v[138:139], v[26:27] op_sel_hi:[0,1,1] neg_lo:[1,0,0] neg_hi:[1,0,0]
    v_pk_fma_f32 v[28:29], v[164:165], v[140:141], v[28:29] op_sel_hi:[0,1,1] neg_lo:[1,0,0] neg_hi:[1,0,0]
    v_pk_fma_f32 v[30:31], v[164:165], v[142:143], v[30:31] op_sel_hi:[0,1,1] neg_lo:[1,0,0] neg_hi:[1,0,0]
    v_pk_mul_f32 v[192:193], v[24:25], v[24:25]
    v_pk_mul_f32 v[194:195], v[26:27], v[26:27]
    v_pk_mul_f32 v[196:197], v[28:29], v[28:29]
    v_pk_mul_f32 v[198:199], v[30:31], v[30:31]
    v_pk_fma_f32 v[192:193], v[192:193], v[184:185], v[184:185] op_sel:[0,1,0] op_sel_hi:[1,1,0]
    v_pk_fma_f32 v[194:195], v[194:195], v[184:185], v[184:185] op_sel:[0,1,0] op_sel_hi:[1,1,0]
    v_pk_fma_f32 v[196:197], v[196:197], v[184:185], v[184:185] op_sel:[0,1,0] op_sel_hi:[1,1,0]
    v_pk_fma_f32 v[198:199], v[198:199], v[184:185], v[184:185] op_sel:[0,1,0] op_sel_hi:[1,1,0]
    v_pk_mul_f32 v[192:193], v[192:193], v[24:25]
    v_pk_mul_f32 v[194:195], v[194:195], v[26:27]
    v_pk_mul_f32 v[196:197], v[196:197], v[28:29]
    v_pk_mul_f32 v[198:199], v[198:199], v[30:31]
    v_exp_f32 v192, v192
    v_exp_f32 v193, v193
    v_exp_f32 v194, v194
    v_exp_f32 v195, v195
    v_exp_f32 v196, v196
    v_exp_f32 v197, v197
    v_exp_f32 v198, v198
    v_exp_f32 v199, v199
    v_pk_fma_f32 v[192:193], v[192:193], v[164:165], v[164:165] op_sel:[0,1,1] op_sel_hi:[1,1,1]
    v_pk_fma_f32 v[194:195], v[194:195], v[164:165], v[164:165] op_sel:[0,1,1] op_sel_hi:[1,1,1]
    v_pk_fma_f32 v[196:197], v[196:197], v[164:165], v[164:165] op_sel:[0,1,1] op_sel_hi:[1,1,1]
    v_pk_fma_f32 v[198:199], v[198:199], v[164:165], v[164:165] op_sel:[0,1,1] op_sel_hi:[1,1,1]
    v_rcp_f32 v192, v192
    v_rcp_f32 v193, v193
    v_rcp_f32 v194, v194
    v_rcp_f32 v195, v195
    v_rcp_f32 v196, v196
    v_rcp_f32 v197, v197
    v_rcp_f32 v198, v198
    v_rcp_f32 v199, v199
    v_pk_mul_f32 v[24:25], v[24:25], v[192:193]
    v_pk_mul_f32 v[26:27], v[26:27], v[194:195]
    v_pk_mul_f32 v[28:29], v[28:29], v[196:197]
    v_pk_mul_f32 v[30:31], v[30:31], v[198:199]
    v_cvt_pk_bf16_f32 v24, v24, v25
    v_cvt_pk_bf16_f32 v25, v26, v27
    v_cvt_pk_bf16_f32 v26, v28, v29
    v_cvt_pk_bf16_f32 v27, v30, v31
    ds_write_b128 v12, v[24:27] offset:0
    s_add_u32 s36, s44, 0
    buffer_store_dwordx4 v[24:27], v2, s[16:19], s36 offen sc1
    v_pk_fma_f32 v[52:53], v[166:167], v[136:137], v[52:53] op_sel_hi:[0,1,1] neg_lo:[1,0,0] neg_hi:[1,0,0]
    v_pk_fma_f32 v[54:55], v[166:167], v[138:139], v[54:55] op_sel_hi:[0,1,1] neg_lo:[1,0,0] neg_hi:[1,0,0]
    v_pk_fma_f32 v[56:57], v[166:167], v[140:141], v[56:57] op_sel_hi:[0,1,1] neg_lo:[1,0,0] neg_hi:[1,0,0]
    v_pk_fma_f32 v[58:59], v[166:167], v[142:143], v[58:59] op_sel_hi:[0,1,1] neg_lo:[1,0,0] neg_hi:[1,0,0]
    v_pk_mul_f32 v[192:193], v[52:53], v[52:53]
    v_pk_mul_f32 v[194:195], v[54:55], v[54:55]
    v_pk_mul_f32 v[196:197], v[56:57], v[56:57]
    v_pk_mul_f32 v[198:199], v[58:59], v[58:59]
    v_pk_fma_f32 v[192:193], v[192:193], v[186:187], v[186:187] op_sel:[0,1,0] op_sel_hi:[1,1,0]
    v_pk_fma_f32 v[194:195], v[194:195], v[186:187], v[186:187] op_sel:[0,1,0] op_sel_hi:[1,1,0]
    v_pk_fma_f32 v[196:197], v[196:197], v[186:187], v[186:187] op_sel:[0,1,0] op_sel_hi:[1,1,0]
    v_pk_fma_f32 v[198:199], v[198:199], v[186:187], v[186:187] op_sel:[0,1,0] op_sel_hi:[1,1,0]
    v_pk_mul_f32 v[192:193], v[192:193], v[52:53]
    v_pk_mul_f32 v[194:195], v[194:195], v[54:55]
    v_pk_mul_f32 v[196:197], v[196:197], v[56:57]
    v_pk_mul_f32 v[198:199], v[198:199], v[58:59]
    v_exp_f32 v192, v192
    v_exp_f32 v193, v193
    v_exp_f32 v194, v194
    v_exp_f32 v195, v195
    v_exp_f32 v196, v196
    v_exp_f32 v197, v197
    v_exp_f32 v198, v198
    v_exp_f32 v199, v199
    v_pk_fma_f32 v[192:193], v[192:193], v[166:167], v[166:167] op_sel:[0,1,1] op_sel_hi:[1,1,1]
    v_pk_fma_f32 v[194:195], v[194:195], v[166:167], v[166:167] op_sel:[0,1,1] op_sel_hi:[1,1,1]
    v_pk_fma_f32 v[196:197], v[196:197], v[166:167], v[166:167] op_sel:[0,1,1] op_sel_hi:[1,1,1]
    v_pk_fma_f32 v[198:199], v[198:199], v[166:167], v[166:167] op_sel:[0,1,1] op_sel_hi:[1,1,1]
    v_rcp_f32 v192, v192
    v_rcp_f32 v193, v193
    v_rcp_f32 v194, v194
    v_rcp_f32 v195, v195
    v_rcp_f32 v196, v196
    v_rcp_f32 v197, v197
    v_rcp_f32 v198, v198
    v_rcp_f32 v199, v199
    v_pk_mul_f32 v[52:53], v[52:53], v[192:193]
    v_pk_mul_f32 v[54:55], v[54:55], v[194:195]
    v_pk_mul_f32 v[56:57], v[56:57], v[196:197]
    v_pk_mul_f32 v[58:59], v[58:59], v[198:199]
    v_cvt_pk_bf16_f32 v52, v52, v53
    v_cvt_pk_bf16_f32 v53, v54, v55
    v_cvt_pk_bf16_f32 v54, v56, v57
    v_cvt_pk_bf16_f32 v55, v58, v59
    ds_write_b128 v12, v[52:55] offset:2048
    s_add_u32 s36, s44, 229376
    buffer_store_dwordx4 v[52:55], v2, s[16:19], s36 offen sc1
    v_pk_fma_f32 v[80:81], v[168:169], v[136:137], v[80:81] op_sel_hi:[0,1,1] neg_lo:[1,0,0] neg_hi:[1,0,0]
    v_pk_fma_f32 v[82:83], v[168:169], v[138:139], v[82:83] op_sel_hi:[0,1,1] neg_lo:[1,0,0] neg_hi:[1,0,0]
    v_pk_fma_f32 v[84:85], v[168:169], v[140:141], v[84:85] op_sel_hi:[0,1,1] neg_lo:[1,0,0] neg_hi:[1,0,0]
    v_pk_fma_f32 v[86:87], v[168:169], v[142:143], v[86:87] op_sel_hi:[0,1,1] neg_lo:[1,0,0] neg_hi:[1,0,0]
    v_pk_mul_f32 v[192:193], v[80:81], v[80:81]
    v_pk_mul_f32 v[194:195], v[82:83], v[82:83]
    v_pk_mul_f32 v[196:197], v[84:85], v[84:85]
    v_pk_mul_f32 v[198:199], v[86:87], v[86:87]
    v_pk_fma_f32 v[192:193], v[192:193], v[188:189], v[188:189] op_sel:[0,1,0] op_sel_hi:[1,1,0]
    v_pk_fma_f32 v[194:195], v[194:195], v[188:189], v[188:189] op_sel:[0,1,0] op_sel_hi:[1,1,0]
    v_pk_fma_f32 v[196:197], v[196:197], v[188:189], v[188:189] op_sel:[0,1,0] op_sel_hi:[1,1,0]
    v_pk_fma_f32 v[198:199], v[198:199], v[188:189], v[188:189] op_sel:[0,1,0] op_sel_hi:[1,1,0]
    v_pk_mul_f32 v[192:193], v[192:193], v[80:81]
    v_pk_mul_f32 v[194:195], v[194:195], v[82:83]
    v_pk_mul_f32 v[196:197], v[196:197], v[84:85]
    v_pk_mul_f32 v[198:199], v[198:199], v[86:87]
    v_exp_f32 v192, v192
    v_exp_f32 v193, v193
    v_exp_f32 v194, v194
    v_exp_f32 v195, v195
    v_exp_f32 v196, v196
    v_exp_f32 v197, v197
    v_exp_f32 v198, v198
    v_exp_f32 v199, v199
    v_pk_fma_f32 v[192:193], v[192:193], v[168:169], v[168:169] op_sel:[0,1,1] op_sel_hi:[1,1,1]
    v_pk_fma_f32 v[194:195], v[194:195], v[168:169], v[168:169] op_sel:[0,1,1] op_sel_hi:[1,1,1]
    v_pk_fma_f32 v[196:197], v[196:197], v[168:169], v[168:169] op_sel:[0,1,1] op_sel_hi:[1,1,1]
    v_pk_fma_f32 v[198:199], v[198:199], v[168:169], v[168:169] op_sel:[0,1,1] op_sel_hi:[1,1,1]
    v_rcp_f32 v192, v192
    v_rcp_f32 v193, v193
    v_rcp_f32 v194, v194
    v_rcp_f32 v195, v195
    v_rcp_f32 v196, v196
    v_rcp_f32 v197, v197
    v_rcp_f32 v198, v198
    v_rcp_f32 v199, v199
    v_pk_mul_f32 v[80:81], v[80:81], v[192:193]
    v_pk_mul_f32 v[82:83], v[82:83], v[194:195]
    v_pk_mul_f32 v[84:85], v[84:85], v[196:197]
    v_pk_mul_f32 v[86:87], v[86:87], v[198:199]
    v_cvt_pk_bf16_f32 v80, v80, v81
    v_cvt_pk_bf16_f32 v81, v82, v83
    v_cvt_pk_bf16_f32 v82, v84, v85
    v_cvt_pk_bf16_f32 v83, v86, v87
    ds_write_b128 v17, v[80:83] offset:0
    s_add_u32 s36, s44, 458752
    buffer_store_dwordx4 v[80:83], v2, s[16:19], s36 offen sc1
    v_pk_fma_f32 v[108:109], v[170:171], v[136:137], v[108:109] op_sel_hi:[0,1,1] neg_lo:[1,0,0] neg_hi:[1,0,0]
    v_pk_fma_f32 v[110:111], v[170:171], v[138:139], v[110:111] op_sel_hi:[0,1,1] neg_lo:[1,0,0] neg_hi:[1,0,0]
    v_pk_fma_f32 v[112:113], v[170:171], v[140:141], v[112:113] op_sel_hi:[0,1,1] neg_lo:[1,0,0] neg_hi:[1,0,0]
    v_pk_fma_f32 v[114:115], v[170:171], v[142:143], v[114:115] op_sel_hi:[0,1,1] neg_lo:[1,0,0] neg_hi:[1,0,0]
    v_pk_mul_f32 v[192:193], v[108:109], v[108:109]
    v_pk_mul_f32 v[194:195], v[110:111], v[110:111]
    v_pk_mul_f32 v[196:197], v[112:113], v[112:113]
    v_pk_mul_f32 v[198:199], v[114:115], v[114:115]
    v_pk_fma_f32 v[192:193], v[192:193], v[190:191], v[190:191] op_sel:[0,1,0] op_sel_hi:[1,1,0]
    v_pk_fma_f32 v[194:195], v[194:195], v[190:191], v[190:191] op_sel:[0,1,0] op_sel_hi:[1,1,0]
    v_pk_fma_f32 v[196:197], v[196:197], v[190:191], v[190:191] op_sel:[0,1,0] op_sel_hi:[1,1,0]
    v_pk_fma_f32 v[198:199], v[198:199], v[190:191], v[190:191] op_sel:[0,1,0] op_sel_hi:[1,1,0]
    v_pk_mul_f32 v[192:193], v[192:193], v[108:109]
    v_pk_mul_f32 v[194:195], v[194:195], v[110:111]
    v_pk_mul_f32 v[196:197], v[196:197], v[112:113]
    v_pk_mul_f32 v[198:199], v[198:199], v[114:115]
    v_exp_f32 v192, v192
    v_exp_f32 v193, v193
    v_exp_f32 v194, v194
    v_exp_f32 v195, v195
    v_exp_f32 v196, v196
    v_exp_f32 v197, v197
    v_exp_f32 v198, v198
    v_exp_f32 v199, v199
    v_pk_fma_f32 v[192:193], v[192:193], v[170:171], v[170:171] op_sel:[0,1,1] op_sel_hi:[1,1,1]
    v_pk_fma_f32 v[194:195], v[194:195], v[170:171], v[170:171] op_sel:[0,1,1] op_sel_hi:[1,1,1]
    v_pk_fma_f32 v[196:197], v[196:197], v[170:171], v[170:171] op_sel:[0,1,1] op_sel_hi:[1,1,1]
    v_pk_fma_f32 v[198:199], v[198:199], v[170:171], v[170:171] op_sel:[0,1,1] op_sel_hi:[1,1,1]
    v_rcp_f32 v192, v192
    v_rcp_f32 v193, v193
    v_rcp_f32 v194, v194
    v_rcp_f32 v195, v195
    v_rcp_f32 v196, v196
    v_rcp_f32 v197, v197
    v_rcp_f32 v198, v198
    v_rcp_f32 v199, v199
    v_pk_mul_f32 v[108:109], v[108:109], v[192:193]
    v_pk_mul_f32 v[110:111], v[110:111], v[194:195]
    v_pk_mul_f32 v[112:113], v[112:113], v[196:197]
    v_pk_mul_f32 v[114:115], v[114:115], v[198:199]
    v_cvt_pk_bf16_f32 v108, v108, v109
    v_cvt_pk_bf16_f32 v109, v110, v111
    v_cvt_pk_bf16_f32 v110, v112, v113
    v_cvt_pk_bf16_f32 v111, v114, v115
    ds_write_b128 v17, v[108:111] offset:2048
    s_add_u32 s36, s44, 688128
    buffer_store_dwordx4 v[108:111], v2, s[16:19], s36 offen sc1
    v_pk_fma_f32 v[32:33], v[164:165], v[144:145], v[32:33] op_sel_hi:[0,1,1] neg_lo:[1,0,0] neg_hi:[1,0,0]
    v_pk_fma_f32 v[34:35], v[164:165], v[146:147], v[34:35] op_sel_hi:[0,1,1] neg_lo:[1,0,0] neg_hi:[1,0,0]
    v_pk_fma_f32 v[36:37], v[164:165], v[148:149], v[36:37] op_sel_hi:[0,1,1] neg_lo:[1,0,0] neg_hi:[1,0,0]
    v_pk_fma_f32 v[38:39], v[164:165], v[150:151], v[38:39] op_sel_hi:[0,1,1] neg_lo:[1,0,0] neg_hi:[1,0,0]
    v_pk_mul_f32 v[192:193], v[32:33], v[32:33]
    v_pk_mul_f32 v[194:195], v[34:35], v[34:35]
    v_pk_mul_f32 v[196:197], v[36:37], v[36:37]
    v_pk_mul_f32 v[198:199], v[38:39], v[38:39]
    v_pk_fma_f32 v[192:193], v[192:193], v[184:185], v[184:185] op_sel:[0,1,0] op_sel_hi:[1,1,0]
    v_pk_fma_f32 v[194:195], v[194:195], v[184:185], v[184:185] op_sel:[0,1,0] op_sel_hi:[1,1,0]
    v_pk_fma_f32 v[196:197], v[196:197], v[184:185], v[184:185] op_sel:[0,1,0] op_sel_hi:[1,1,0]
    v_pk_fma_f32 v[198:199], v[198:199], v[184:185], v[184:185] op_sel:[0,1,0] op_sel_hi:[1,1,0]
    v_pk_mul_f32 v[192:193], v[192:193], v[32:33]
    v_pk_mul_f32 v[194:195], v[194:195], v[34:35]
    v_pk_mul_f32 v[196:197], v[196:197], v[36:37]
    v_pk_mul_f32 v[198:199], v[198:199], v[38:39]
    v_exp_f32 v192, v192
    v_exp_f32 v193, v193
    v_exp_f32 v194, v194
    v_exp_f32 v195, v195
    v_exp_f32 v196, v196
    v_exp_f32 v197, v197
    v_exp_f32 v198, v198
    v_exp_f32 v199, v199
    v_pk_fma_f32 v[192:193], v[192:193], v[164:165], v[164:165] op_sel:[0,1,1] op_sel_hi:[1,1,1]
    v_pk_fma_f32 v[194:195], v[194:195], v[164:165], v[164:165] op_sel:[0,1,1] op_sel_hi:[1,1,1]
    v_pk_fma_f32 v[196:197], v[196:197], v[164:165], v[164:165] op_sel:[0,1,1] op_sel_hi:[1,1,1]
    v_pk_fma_f32 v[198:199], v[198:199], v[164:165], v[164:165] op_sel:[0,1,1] op_sel_hi:[1,1,1]
    v_rcp_f32 v192, v192
    v_rcp_f32 v193, v193
    v_rcp_f32 v194, v194
    v_rcp_f32 v195, v195
    v_rcp_f32 v196, v196
    v_rcp_f32 v197, v197
    v_rcp_f32 v198, v198
    v_rcp_f32 v199, v199
    v_pk_mul_f32 v[32:33], v[32:33], v[192:193]
    v_pk_mul_f32 v[34:35], v[34:35], v[194:195]
    v_pk_mul_f32 v[36:37], v[36:37], v[196:197]
    v_pk_mul_f32 v[38:39], v[38:39], v[198:199]
    v_cvt_pk_bf16_f32 v32, v32, v33
    v_cvt_pk_bf16_f32 v33, v34, v35
    v_cvt_pk_bf16_f32 v34, v36, v37
    v_cvt_pk_bf16_f32 v35, v38, v39
    ds_write_b128 v12, v[32:35] offset:16384
    v_pk_fma_f32 v[60:61], v[166:167], v[144:145], v[60:61] op_sel_hi:[0,1,1] neg_lo:[1,0,0] neg_hi:[1,0,0]
    v_pk_fma_f32 v[62:63], v[166:167], v[146:147], v[62:63] op_sel_hi:[0,1,1] neg_lo:[1,0,0] neg_hi:[1,0,0]
    v_pk_fma_f32 v[64:65], v[166:167], v[148:149], v[64:65] op_sel_hi:[0,1,1] neg_lo:[1,0,0] neg_hi:[1,0,0]
    v_pk_fma_f32 v[66:67], v[166:167], v[150:151], v[66:67] op_sel_hi:[0,1,1] neg_lo:[1,0,0] neg_hi:[1,0,0]
    v_pk_mul_f32 v[192:193], v[60:61], v[60:61]
    v_pk_mul_f32 v[194:195], v[62:63], v[62:63]
    v_pk_mul_f32 v[196:197], v[64:65], v[64:65]
    v_pk_mul_f32 v[198:199], v[66:67], v[66:67]
    v_pk_fma_f32 v[192:193], v[192:193], v[186:187], v[186:187] op_sel:[0,1,0] op_sel_hi:[1,1,0]
    v_pk_fma_f32 v[194:195], v[194:195], v[186:187], v[186:187] op_sel:[0,1,0] op_sel_hi:[1,1,0]
    v_pk_fma_f32 v[196:197], v[196:197], v[186:187], v[186:187] op_sel:[0,1,0] op_sel_hi:[1,1,0]
    v_pk_fma_f32 v[198:199], v[198:199], v[186:187], v[186:187] op_sel:[0,1,0] op_sel_hi:[1,1,0]
    v_pk_mul_f32 v[192:193], v[192:193], v[60:61]
    v_pk_mul_f32 v[194:195], v[194:195], v[62:63]
    v_pk_mul_f32 v[196:197], v[196:197], v[64:65]
    v_pk_mul_f32 v[198:199], v[198:199], v[66:67]
    v_exp_f32 v192, v192
    v_exp_f32 v193, v193
    v_exp_f32 v194, v194
    v_exp_f32 v195, v195
    v_exp_f32 v196, v196
    v_exp_f32 v197, v197
    v_exp_f32 v198, v198
    v_exp_f32 v199, v199
    v_pk_fma_f32 v[192:193], v[192:193], v[166:167], v[166:167] op_sel:[0,1,1] op_sel_hi:[1,1,1]
    v_pk_fma_f32 v[194:195], v[194:195], v[166:167], v[166:167] op_sel:[0,1,1] op_sel_hi:[1,1,1]
    v_pk_fma_f32 v[196:197], v[196:197], v[166:167], v[166:167] op_sel:[0,1,1] op_sel_hi:[1,1,1]
    v_pk_fma_f32 v[198:199], v[198:199], v[166:167], v[166:167] op_sel:[0,1,1] op_sel_hi:[1,1,1]
    v_rcp_f32 v192, v192
    v_rcp_f32 v193, v193
    v_rcp_f32 v194, v194
    v_rcp_f32 v195, v195
    v_rcp_f32 v196, v196
    v_rcp_f32 v197, v197
    v_rcp_f32 v198, v198
    v_rcp_f32 v199, v199
    v_pk_mul_f32 v[60:61], v[60:61], v[192:193]
    v_pk_mul_f32 v[62:63], v[62:63], v[194:195]
    v_pk_mul_f32 v[64:65], v[64:65], v[196:197]
    v_pk_mul_f32 v[66:67], v[66:67], v[198:199]
    v_cvt_pk_bf16_f32 v60, v60, v61
    v_cvt_pk_bf16_f32 v61, v62, v63
    v_cvt_pk_bf16_f32 v62, v64, v65
    v_cvt_pk_bf16_f32 v63, v66, v67
    ds_write_b128 v12, v[60:63] offset:18432
    v_pk_fma_f32 v[88:89], v[168:169], v[144:145], v[88:89] op_sel_hi:[0,1,1] neg_lo:[1,0,0] neg_hi:[1,0,0]
    v_pk_fma_f32 v[90:91], v[168:169], v[146:147], v[90:91] op_sel_hi:[0,1,1] neg_lo:[1,0,0] neg_hi:[1,0,0]
    v_pk_fma_f32 v[92:93], v[168:169], v[148:149], v[92:93] op_sel_hi:[0,1,1] neg_lo:[1,0,0] neg_hi:[1,0,0]
    v_pk_fma_f32 v[94:95], v[168:169], v[150:151], v[94:95] op_sel_hi:[0,1,1] neg_lo:[1,0,0] neg_hi:[1,0,0]
    v_pk_mul_f32 v[192:193], v[88:89], v[88:89]
    v_pk_mul_f32 v[194:195], v[90:91], v[90:91]
    v_pk_mul_f32 v[196:197], v[92:93], v[92:93]
    v_pk_mul_f32 v[198:199], v[94:95], v[94:95]
    v_pk_fma_f32 v[192:193], v[192:193], v[188:189], v[188:189] op_sel:[0,1,0] op_sel_hi:[1,1,0]
    v_pk_fma_f32 v[194:195], v[194:195], v[188:189], v[188:189] op_sel:[0,1,0] op_sel_hi:[1,1,0]
    v_pk_fma_f32 v[196:197], v[196:197], v[188:189], v[188:189] op_sel:[0,1,0] op_sel_hi:[1,1,0]
    v_pk_fma_f32 v[198:199], v[198:199], v[188:189], v[188:189] op_sel:[0,1,0] op_sel_hi:[1,1,0]
    v_pk_mul_f32 v[192:193], v[192:193], v[88:89]
    v_pk_mul_f32 v[194:195], v[194:195], v[90:91]
    v_pk_mul_f32 v[196:197], v[196:197], v[92:93]
    v_pk_mul_f32 v[198:199], v[198:199], v[94:95]
    v_exp_f32 v192, v192
    v_exp_f32 v193, v193
    v_exp_f32 v194, v194
    v_exp_f32 v195, v195
    v_exp_f32 v196, v196
    v_exp_f32 v197, v197
    v_exp_f32 v198, v198
    v_exp_f32 v199, v199
    v_pk_fma_f32 v[192:193], v[192:193], v[168:169], v[168:169] op_sel:[0,1,1] op_sel_hi:[1,1,1]
    v_pk_fma_f32 v[194:195], v[194:195], v[168:169], v[168:169] op_sel:[0,1,1] op_sel_hi:[1,1,1]
    v_pk_fma_f32 v[196:197], v[196:197], v[168:169], v[168:169] op_sel:[0,1,1] op_sel_hi:[1,1,1]
    v_pk_fma_f32 v[198:199], v[198:199], v[168:169], v[168:169] op_sel:[0,1,1] op_sel_hi:[1,1,1]
    v_rcp_f32 v192, v192
    v_rcp_f32 v193, v193
    v_rcp_f32 v194, v194
    v_rcp_f32 v195, v195
    v_rcp_f32 v196, v196
    v_rcp_f32 v197, v197
    v_rcp_f32 v198, v198
    v_rcp_f32 v199, v199
    v_pk_mul_f32 v[88:89], v[88:89], v[192:193]
    v_pk_mul_f32 v[90:91], v[90:91], v[194:195]
    v_pk_mul_f32 v[92:93], v[92:93], v[196:197]
    v_pk_mul_f32 v[94:95], v[94:95], v[198:199]
    v_cvt_pk_bf16_f32 v88, v88, v89
    v_cvt_pk_bf16_f32 v89, v90, v91
    v_cvt_pk_bf16_f32 v90, v92, v93
    v_cvt_pk_bf16_f32 v91, v94, v95
    ds_write_b128 v17, v[88:91] offset:16384
    s_lshr_b32 s53, s30, 1
    s_lshl1_add_u32 s53, s31, s53
    s_lshl_b32 s53, s53, 7
    s_add_u32 s53, s53, s55
    s_add_u32 s53, s53, 0x1000
    v_mov_b32 v8, 1
    v_mov_b32 v9, 0
    s_mov_b64 exec, 1
    s_waitcnt vmcnt(0)
    buffer_atomic_add v8, v9, s[56:59], s53 offen sc1
    s_mov_b64 exec, -1
    v_pk_fma_f32 v[116:117], v[170:171], v[144:145], v[116:117] op_sel_hi:[0,1,1] neg_lo:[1,0,0] neg_hi:[1,0,0]
    v_pk_fma_f32 v[118:119], v[170:171], v[146:147], v[118:119] op_sel_hi:[0,1,1] neg_lo:[1,0,0] neg_hi:[1,0,0]
    v_pk_fma_f32 v[120:121], v[170:171], v[148:149], v[120:121] op_sel_hi:[0,1,1] neg_lo:[1,0,0] neg_hi:[1,0,0]
    v_pk_fma_f32 v[122:123], v[170:171], v[150:151], v[122:123] op_sel_hi:[0,1,1] neg_lo:[1,0,0] neg_hi:[1,0,0]
    v_pk_mul_f32 v[192:193], v[116:117], v[116:117]
    v_pk_mul_f32 v[194:195], v[118:119], v[118:119]
    v_pk_mul_f32 v[196:197], v[120:121], v[120:121]
    v_pk_mul_f32 v[198:199], v[122:123], v[122:123]
    v_pk_fma_f32 v[192:193], v[192:193], v[190:191], v[190:191] op_sel:[0,1,0] op_sel_hi:[1,1,0]
    v_pk_fma_f32 v[194:195], v[194:195], v[190:191], v[190:191] op_sel:[0,1,0] op_sel_hi:[1,1,0]
    v_pk_fma_f32 v[196:197], v[196:197], v[190:191], v[190:191] op_sel:[0,1,0] op_sel_hi:[1,1,0]
    v_pk_fma_f32 v[198:199], v[198:199], v[190:191], v[190:191] op_sel:[0,1,0] op_sel_hi:[1,1,0]
    v_pk_mul_f32 v[192:193], v[192:193], v[116:117]
    v_pk_mul_f32 v[194:195], v[194:195], v[118:119]
    v_pk_mul_f32 v[196:197], v[196:197], v[120:121]
    v_pk_mul_f32 v[198:199], v[198:199], v[122:123]
    v_exp_f32 v192, v192
    v_exp_f32 v193, v193
    v_exp_f32 v194, v194
    v_exp_f32 v195, v195
    v_exp_f32 v196, v196
    v_exp_f32 v197, v197
    v_exp_f32 v198, v198
    v_exp_f32 v199, v199
    v_pk_fma_f32 v[192:193], v[192:193], v[170:171], v[170:171] op_sel:[0,1,1] op_sel_hi:[1,1,1]
    v_pk_fma_f32 v[194:195], v[194:195], v[170:171], v[170:171] op_sel:[0,1,1] op_sel_hi:[1,1,1]
    v_pk_fma_f32 v[196:197], v[196:197], v[170:171], v[170:171] op_sel:[0,1,1] op_sel_hi:[1,1,1]
    v_pk_fma_f32 v[198:199], v[198:199], v[170:171], v[170:171] op_sel:[0,1,1] op_sel_hi:[1,1,1]
    v_rcp_f32 v192, v192
    v_rcp_f32 v193, v193
    v_rcp_f32 v194, v194
    v_rcp_f32 v195, v195
    v_rcp_f32 v196, v196
    v_rcp_f32 v197, v197
    v_rcp_f32 v198, v198
    v_rcp_f32 v199, v199
    v_pk_mul_f32 v[116:117], v[116:117], v[192:193]
    v_pk_mul_f32 v[118:119], v[118:119], v[194:195]
    v_pk_mul_f32 v[120:121], v[120:121], v[196:197]
    v_pk_mul_f32 v[122:123], v[122:123], v[198:199]
    v_cvt_pk_bf16_f32 v116, v116, v117
    v_cvt_pk_bf16_f32 v117, v118, v119
    v_cvt_pk_bf16_f32 v118, v120, v121
    v_cvt_pk_bf16_f32 v119, v122, v123
    ds_write_b128 v17, v[116:119] offset:18432
    v_pk_fma_f32 v[40:41], v[164:165], v[152:153], v[40:41] op_sel_hi:[0,1,1] neg_lo:[1,0,0] neg_hi:[1,0,0]
    v_pk_fma_f32 v[42:43], v[164:165], v[154:155], v[42:43] op_sel_hi:[0,1,1] neg_lo:[1,0,0] neg_hi:[1,0,0]
    v_pk_fma_f32 v[44:45], v[164:165], v[156:157], v[44:45] op_sel_hi:[0,1,1] neg_lo:[1,0,0] neg_hi:[1,0,0]
    v_pk_fma_f32 v[46:47], v[164:165], v[158:159], v[46:47] op_sel_hi:[0,1,1] neg_lo:[1,0,0] neg_hi:[1,0,0]
    v_pk_mul_f32 v[192:193], v[40:41], v[40:41]
    v_pk_mul_f32 v[194:195], v[42:43], v[42:43]
    v_pk_mul_f32 v[196:197], v[44:45], v[44:45]
    v_pk_mul_f32 v[198:199], v[46:47], v[46:47]
    v_pk_fma_f32 v[192:193], v[192:193], v[184:185], v[184:185] op_sel:[0,1,0] op_sel_hi:[1,1,0]
    v_pk_fma_f32 v[194:195], v[194:195], v[184:185], v[184:185] op_sel:[0,1,0] op_sel_hi:[1,1,0]
    v_pk_fma_f32 v[196:197], v[196:197], v[184:185], v[184:185] op_sel:[0,1,0] op_sel_hi:[1,1,0]
    v_pk_fma_f32 v[198:199], v[198:199], v[184:185], v[184:185] op_sel:[0,1,0] op_sel_hi:[1,1,0]
    v_pk_mul_f32 v[192:193], v[192:193], v[40:41]
    v_pk_mul_f32 v[194:195], v[194:195], v[42:43]
    v_pk_mul_f32 v[196:197], v[196:197], v[44:45]
    v_pk_mul_f32 v[198:199], v[198:199], v[46:47]
    v_exp_f32 v192, v192
    v_exp_f32 v193, v193
    v_exp_f32 v194, v194
    v_exp_f32 v195, v195
    v_exp_f32 v196, v196
    v_exp_f32 v197, v197
    v_exp_f32 v198, v198
    v_exp_f32 v199, v199
    v_pk_fma_f32 v[192:193], v[192:193], v[164:165], v[164:165] op_sel:[0,1,1] op_sel_hi:[1,1,1]
    v_pk_fma_f32 v[194:195], v[194:195], v[164:165], v[164:165] op_sel:[0,1,1] op_sel_hi:[1,1,1]
    v_pk_fma_f32 v[196:197], v[196:197], v[164:165], v[164:165] op_sel:[0,1,1] op_sel_hi:[1,1,1]
    v_pk_fma_f32 v[198:199], v[198:199], v[164:165], v[164:165] op_sel:[0,1,1] op_sel_hi:[1,1,1]
    v_rcp_f32 v192, v192
    v_rcp_f32 v193, v193
    v_rcp_f32 v194, v194
    v_rcp_f32 v195, v195
    v_rcp_f32 v196, v196
    v_rcp_f32 v197, v197
    v_rcp_f32 v198, v198
    v_rcp_f32 v199, v199
    v_pk_mul_f32 v[40:41], v[40:41], v[192:193]
    v_pk_mul_f32 v[42:43], v[42:43], v[194:195]
    v_pk_mul_f32 v[44:45], v[44:45], v[196:197]
    v_pk_mul_f32 v[46:47], v[46:47], v[198:199]
    v_cvt_pk_bf16_f32 v230, v40, v41
    v_cvt_pk_bf16_f32 v231, v42, v43
    v_cvt_pk_bf16_f32 v232, v44, v45
    v_cvt_pk_bf16_f32 v233, v46, v47
    ds_write_b128 v12, v[230:233] offset:32768
    v_pk_fma_f32 v[68:69], v[166:167], v[152:153], v[68:69] op_sel_hi:[0,1,1] neg_lo:[1,0,0] neg_hi:[1,0,0]
    v_pk_fma_f32 v[70:71], v[166:167], v[154:155], v[70:71] op_sel_hi:[0,1,1] neg_lo:[1,0,0] neg_hi:[1,0,0]
    v_pk_fma_f32 v[72:73], v[166:167], v[156:157], v[72:73] op_sel_hi:[0,1,1] neg_lo:[1,0,0] neg_hi:[1,0,0]
    v_pk_fma_f32 v[74:75], v[166:167], v[158:159], v[74:75] op_sel_hi:[0,1,1] neg_lo:[1,0,0] neg_hi:[1,0,0]
    v_pk_mul_f32 v[192:193], v[68:69], v[68:69]
    v_pk_mul_f32 v[194:195], v[70:71], v[70:71]
    v_pk_mul_f32 v[196:197], v[72:73], v[72:73]
    v_pk_mul_f32 v[198:199], v[74:75], v[74:75]
    v_pk_fma_f32 v[192:193], v[192:193], v[186:187], v[186:187] op_sel:[0,1,0] op_sel_hi:[1,1,0]
    v_pk_fma_f32 v[194:195], v[194:195], v[186:187], v[186:187] op_sel:[0,1,0] op_sel_hi:[1,1,0]
    v_pk_fma_f32 v[196:197], v[196:197], v[186:187], v[186:187] op_sel:[0,1,0] op_sel_hi:[1,1,0]
    v_pk_fma_f32 v[198:199], v[198:199], v[186:187], v[186:187] op_sel:[0,1,0] op_sel_hi:[1,1,0]
    v_pk_mul_f32 v[192:193], v[192:193], v[68:69]
    v_pk_mul_f32 v[194:195], v[194:195], v[70:71]
    v_pk_mul_f32 v[196:197], v[196:197], v[72:73]
    v_pk_mul_f32 v[198:199], v[198:199], v[74:75]
    v_exp_f32 v192, v192
    v_exp_f32 v193, v193
    v_exp_f32 v194, v194
    v_exp_f32 v195, v195
    v_exp_f32 v196, v196
    v_exp_f32 v197, v197
    v_exp_f32 v198, v198
    v_exp_f32 v199, v199
    v_pk_fma_f32 v[192:193], v[192:193], v[166:167], v[166:167] op_sel:[0,1,1] op_sel_hi:[1,1,1]
    v_pk_fma_f32 v[194:195], v[194:195], v[166:167], v[166:167] op_sel:[0,1,1] op_sel_hi:[1,1,1]
    v_pk_fma_f32 v[196:197], v[196:197], v[166:167], v[166:167] op_sel:[0,1,1] op_sel_hi:[1,1,1]
    v_pk_fma_f32 v[198:199], v[198:199], v[166:167], v[166:167] op_sel:[0,1,1] op_sel_hi:[1,1,1]
    v_rcp_f32 v192, v192
    v_rcp_f32 v193, v193
    v_rcp_f32 v194, v194
    v_rcp_f32 v195, v195
    v_rcp_f32 v196, v196
    v_rcp_f32 v197, v197
    v_rcp_f32 v198, v198
    v_rcp_f32 v199, v199
    v_pk_mul_f32 v[68:69], v[68:69], v[192:193]
    v_pk_mul_f32 v[70:71], v[70:71], v[194:195]
    v_pk_mul_f32 v[72:73], v[72:73], v[196:197]
    v_pk_mul_f32 v[74:75], v[74:75], v[198:199]
    v_cvt_pk_bf16_f32 v234, v68, v69
    v_cvt_pk_bf16_f32 v235, v70, v71
    v_cvt_pk_bf16_f32 v236, v72, v73
    v_cvt_pk_bf16_f32 v237, v74, v75
    ds_write_b128 v12, v[234:237] offset:34816
    v_pk_fma_f32 v[96:97], v[168:169], v[152:153], v[96:97] op_sel_hi:[0,1,1] neg_lo:[1,0,0] neg_hi:[1,0,0]
    v_pk_fma_f32 v[98:99], v[168:169], v[154:155], v[98:99] op_sel_hi:[0,1,1] neg_lo:[1,0,0] neg_hi:[1,0,0]
    v_pk_fma_f32 v[100:101], v[168:169], v[156:157], v[100:101] op_sel_hi:[0,1,1] neg_lo:[1,0,0] neg_hi:[1,0,0]
    v_pk_fma_f32 v[102:103], v[168:169], v[158:159], v[102:103] op_sel_hi:[0,1,1] neg_lo:[1,0,0] neg_hi:[1,0,0]
    v_pk_mul_f32 v[192:193], v[96:97], v[96:97]
    v_pk_mul_f32 v[194:195], v[98:99], v[98:99]
    v_pk_mul_f32 v[196:197], v[100:101], v[100:101]
    v_pk_mul_f32 v[198:199], v[102:103], v[102:103]
    v_pk_fma_f32 v[192:193], v[192:193], v[188:189], v[188:189] op_sel:[0,1,0] op_sel_hi:[1,1,0]
    v_pk_fma_f32 v[194:195], v[194:195], v[188:189], v[188:189] op_sel:[0,1,0] op_sel_hi:[1,1,0]
    v_pk_fma_f32 v[196:197], v[196:197], v[188:189], v[188:189] op_sel:[0,1,0] op_sel_hi:[1,1,0]
    v_pk_fma_f32 v[198:199], v[198:199], v[188:189], v[188:189] op_sel:[0,1,0] op_sel_hi:[1,1,0]
    v_pk_mul_f32 v[192:193], v[192:193], v[96:97]
    v_pk_mul_f32 v[194:195], v[194:195], v[98:99]
    v_pk_mul_f32 v[196:197], v[196:197], v[100:101]
    v_pk_mul_f32 v[198:199], v[198:199], v[102:103]
    v_exp_f32 v192, v192
    v_exp_f32 v193, v193
    v_exp_f32 v194, v194
    v_exp_f32 v195, v195
    v_exp_f32 v196, v196
    v_exp_f32 v197, v197
    v_exp_f32 v198, v198
    v_exp_f32 v199, v199
    v_pk_fma_f32 v[192:193], v[192:193], v[168:169], v[168:169] op_sel:[0,1,1] op_sel_hi:[1,1,1]
    v_pk_fma_f32 v[194:195], v[194:195], v[168:169], v[168:169] op_sel:[0,1,1] op_sel_hi:[1,1,1]
    v_pk_fma_f32 v[196:197], v[196:197], v[168:169], v[168:169] op_sel:[0,1,1] op_sel_hi:[1,1,1]
    v_pk_fma_f32 v[198:199], v[198:199], v[168:169], v[168:169] op_sel:[0,1,1] op_sel_hi:[1,1,1]
    v_rcp_f32 v192, v192
    v_rcp_f32 v193, v193
    v_rcp_f32 v194, v194
    v_rcp_f32 v195, v195
    v_rcp_f32 v196, v196
    v_rcp_f32 v197, v197
    v_rcp_f32 v198, v198
    v_rcp_f32 v199, v199
    v_pk_mul_f32 v[96:97], v[96:97], v[192:193]
    v_pk_mul_f32 v[98:99], v[98:99], v[194:195]
    v_pk_mul_f32 v[100:101], v[100:101], v[196:197]
    v_pk_mul_f32 v[102:103], v[102:103], v[198:199]
    v_cvt_pk_bf16_f32 v238, v96, v97
    v_cvt_pk_bf16_f32 v239, v98, v99
    v_cvt_pk_bf16_f32 v240, v100, v101
    v_cvt_pk_bf16_f32 v241, v102, v103
    ds_write_b128 v17, v[238:241] offset:32768
    v_pk_fma_f32 v[124:125], v[170:171], v[152:153], v[124:125] op_sel_hi:[0,1,1] neg_lo:[1,0,0] neg_hi:[1,0,0]
    v_pk_fma_f32 v[126:127], v[170:171], v[154:155], v[126:127] op_sel_hi:[0,1,1] neg_lo:[1,0,0] neg_hi:[1,0,0]
    v_pk_fma_f32 v[128:129], v[170:171], v[156:157], v[128:129] op_sel_hi:[0,1,1] neg_lo:[1,0,0] neg_hi:[1,0,0]
    v_pk_fma_f32 v[130:131], v[170:171], v[158:159], v[130:131] op_sel_hi:[0,1,1] neg_lo:[1,0,0] neg_hi:[1,0,0]
    v_pk_mul_f32 v[192:193], v[124:125], v[124:125]
    v_pk_mul_f32 v[194:195], v[126:127], v[126:127]
    v_pk_mul_f32 v[196:197], v[128:129], v[128:129]
    v_pk_mul_f32 v[198:199], v[130:131], v[130:131]
    v_pk_fma_f32 v[192:193], v[192:193], v[190:191], v[190:191] op_sel:[0,1,0] op_sel_hi:[1,1,0]
    v_pk_fma_f32 v[194:195], v[194:195], v[190:191], v[190:191] op_sel:[0,1,0] op_sel_hi:[1,1,0]
    v_pk_fma_f32 v[196:197], v[196:197], v[190:191], v[190:191] op_sel:[0,1,0] op_sel_hi:[1,1,0]
    v_pk_fma_f32 v[198:199], v[198:199], v[190:191], v[190:191] op_sel:[0,1,0] op_sel_hi:[1,1,0]
    v_pk_mul_f32 v[192:193], v[192:193], v[124:125]
    v_pk_mul_f32 v[194:195], v[194:195], v[126:127]
    v_pk_mul_f32 v[196:197], v[196:197], v[128:129]
    v_pk_mul_f32 v[198:199], v[198:199], v[130:131]
    v_exp_f32 v192, v192
    v_exp_f32 v193, v193
    v_exp_f32 v194, v194
    v_exp_f32 v195, v195
    v_exp_f32 v196, v196
    v_exp_f32 v197, v197
    v_exp_f32 v198, v198
    v_exp_f32 v199, v199
    v_pk_fma_f32 v[192:193], v[192:193], v[170:171], v[170:171] op_sel:[0,1,1] op_sel_hi:[1,1,1]
    v_pk_fma_f32 v[194:195], v[194:195], v[170:171], v[170:171] op_sel:[0,1,1] op_sel_hi:[1,1,1]
    v_pk_fma_f32 v[196:197], v[196:197], v[170:171], v[170:171] op_sel:[0,1,1] op_sel_hi:[1,1,1]
    v_pk_fma_f32 v[198:199], v[198:199], v[170:171], v[170:171] op_sel:[0,1,1] op_sel_hi:[1,1,1]
    v_rcp_f32 v192, v192
    v_rcp_f32 v193, v193
    v_rcp_f32 v194, v194
    v_rcp_f32 v195, v195
    v_rcp_f32 v196, v196
    v_rcp_f32 v197, v197
    v_rcp_f32 v198, v198
    v_rcp_f32 v199, v199
    v_pk_mul_f32 v[124:125], v[124:125], v[192:193]
    v_pk_mul_f32 v[126:127], v[126:127], v[194:195]
    v_pk_mul_f32 v[128:129], v[128:129], v[196:197]
    v_pk_mul_f32 v[130:131], v[130:131], v[198:199]
    v_cvt_pk_bf16_f32 v242, v124, v125
    v_cvt_pk_bf16_f32 v243, v126, v127
    v_cvt_pk_bf16_f32 v244, v128, v129
    v_cvt_pk_bf16_f32 v245, v130, v131
    ds_write_b128 v17, v[242:245] offset:34816
    v_pk_fma_f32 v[48:49], v[164:165], v[160:161], v[48:49] op_sel_hi:[0,1,1] neg_lo:[1,0,0] neg_hi:[1,0,0]
    v_pk_fma_f32 v[50:51], v[164:165], v[162:163], v[50:51] op_sel_hi:[0,1,1] neg_lo:[1,0,0] neg_hi:[1,0,0]
    v_pk_fma_f32 v[76:77], v[166:167], v[160:161], v[76:77] op_sel_hi:[0,1,1] neg_lo:[1,0,0] neg_hi:[1,0,0]
    v_pk_fma_f32 v[78:79], v[166:167], v[162:163], v[78:79] op_sel_hi:[0,1,1] neg_lo:[1,0,0] neg_hi:[1,0,0]
    v_pk_mul_f32 v[192:193], v[48:49], v[48:49]
    v_pk_mul_f32 v[194:195], v[50:51], v[50:51]
    v_pk_mul_f32 v[196:197], v[76:77], v[76:77]
    v_pk_mul_f32 v[198:199], v[78:79], v[78:79]
    v_pk_fma_f32 v[192:193], v[192:193], v[184:185], v[184:185] op_sel:[0,1,0] op_sel_hi:[1,1,0]
    v_pk_fma_f32 v[194:195], v[194:195], v[184:185], v[184:185] op_sel:[0,1,0] op_sel_hi:[1,1,0]
    v_pk_fma_f32 v[196:197], v[196:197], v[186:187], v[186:187] op_sel:[0,1,0] op_sel_hi:[1,1,0]
    v_pk_fma_f32 v[198:199], v[198:199], v[186:187], v[186:187] op_sel:[0,1,0] op_sel_hi:[1,1,0]
    v_pk_mul_f32 v[192:193], v[192:193], v[48:49]
    v_pk_mul_f32 v[194:195], v[194:195], v[50:51]
    v_pk_mul_f32 v[196:197], v[196:197], v[76:77]
    v_pk_mul_f32 v[198:199], v[198:199], v[78:79]
    v_exp_f32 v192, v192
    v_exp_f32 v193, v193
    v_exp_f32 v194, v194
    v_exp_f32 v195, v195
    v_exp_f32 v196, v196
    v_exp_f32 v197, v197
    v_exp_f32 v198, v198
    v_exp_f32 v199, v199
    v_pk_fma_f32 v[192:193], v[192:193], v[164:165], v[164:165] op_sel:[0,1,1] op_sel_hi:[1,1,1]
    v_pk_fma_f32 v[194:195], v[194:195], v[164:165], v[164:165] op_sel:[0,1,1] op_sel_hi:[1,1,1]
    v_pk_fma_f32 v[196:197], v[196:197], v[166:167], v[166:167] op_sel:[0,1,1] op_sel_hi:[1,1,1]
    v_pk_fma_f32 v[198:199], v[198:199], v[166:167], v[166:167] op_sel:[0,1,1] op_sel_hi:[1,1,1]
    v_rcp_f32 v192, v192
    v_rcp_f32 v193, v193
    v_rcp_f32 v194, v194
    v_rcp_f32 v195, v195
    v_rcp_f32 v196, v196
    v_rcp_f32 v197, v197
    v_rcp_f32 v198, v198
    v_rcp_f32 v199, v199
    v_pk_mul_f32 v[48:49], v[48:49], v[192:193]
    v_pk_mul_f32 v[50:51], v[50:51], v[194:195]
    v_pk_mul_f32 v[76:77], v[76:77], v[196:197]
    v_pk_mul_f32 v[78:79], v[78:79], v[198:199]
    v_cvt_pk_bf16_f32 v246, v48, v49
    v_cvt_pk_bf16_f32 v247, v50, v51
    s_add_u32 s36, s45, 0
    buffer_store_dwordx4 v[32:35], v2, s[16:19], s36 offen sc1
    v_cvt_pk_bf16_f32 v248, v76, v77
    v_cvt_pk_bf16_f32 v249, v78, v79
    s_add_u32 s36, s45, 229376
    buffer_store_dwordx4 v[60:63], v2, s[16:19], s36 offen sc1
    v_pk_fma_f32 v[104:105], v[168:169], v[160:161], v[104:105] op_sel_hi:[0,1,1] neg_lo:[1,0,0] neg_hi:[1,0,0]
    v_pk_fma_f32 v[106:107], v[168:169], v[162:163], v[106:107] op_sel_hi:[0,1,1] neg_lo:[1,0,0] neg_hi:[1,0,0]
    v_pk_fma_f32 v[132:133], v[170:171], v[160:161], v[132:133] op_sel_hi:[0,1,1] neg_lo:[1,0,0] neg_hi:[1,0,0]
    v_pk_fma_f32 v[134:135], v[170:171], v[162:163], v[134:135] op_sel_hi:[0,1,1] neg_lo:[1,0,0] neg_hi:[1,0,0]
    v_pk_mul_f32 v[192:193], v[104:105], v[104:105]
    v_pk_mul_f32 v[194:195], v[106:107], v[106:107]
    v_pk_mul_f32 v[196:197], v[132:133], v[132:133]
    v_pk_mul_f32 v[198:199], v[134:135], v[134:135]
    v_pk_fma_f32 v[192:193], v[192:193], v[188:189], v[188:189] op_sel:[0,1,0] op_sel_hi:[1,1,0]
    v_pk_fma_f32 v[194:195], v[194:195], v[188:189], v[188:189] op_sel:[0,1,0] op_sel_hi:[1,1,0]
    v_pk_fma_f32 v[196:197], v[196:197], v[190:191], v[190:191] op_sel:[0,1,0] op_sel_hi:[1,1,0]
    v_pk_fma_f32 v[198:199], v[198:199], v[190:191], v[190:191] op_sel:[0,1,0] op_sel_hi:[1,1,0]
    v_pk_mul_f32 v[192:193], v[192:193], v[104:105]
    v_pk_mul_f32 v[194:195], v[194:195], v[106:107]
    v_pk_mul_f32 v[196:197], v[196:197], v[132:133]
    v_pk_mul_f32 v[198:199], v[198:199], v[134:135]
    v_exp_f32 v192, v192
    v_exp_f32 v193, v193
    v_exp_f32 v194, v194
    v_exp_f32 v195, v195
    v_exp_f32 v196, v196
    v_exp_f32 v197, v197
    v_exp_f32 v198, v198
    v_exp_f32 v199, v199
    v_pk_fma_f32 v[192:193], v[192:193], v[168:169], v[168:169] op_sel:[0,1,1] op_sel_hi:[1,1,1]
    v_pk_fma_f32 v[194:195], v[194:195], v[168:169], v[168:169] op_sel:[0,1,1] op_sel_hi:[1,1,1]
    v_pk_fma_f32 v[196:197], v[196:197], v[170:171], v[170:171] op_sel:[0,1,1] op_sel_hi:[1,1,1]
    v_pk_fma_f32 v[198:199], v[198:199], v[170:171], v[170:171] op_sel:[0,1,1] op_sel_hi:[1,1,1]
    v_rcp_f32 v192, v192
    v_rcp_f32 v193, v193
    v_rcp_f32 v194, v194
    v_rcp_f32 v195, v195
    v_rcp_f32 v196, v196
    v_rcp_f32 v197, v197
    v_rcp_f32 v198, v198
    v_rcp_f32 v199, v199
    v_pk_mul_f32 v[104:105], v[104:105], v[192:193]
    v_pk_mul_f32 v[106:107], v[106:107], v[194:195]
    v_pk_mul_f32 v[132:133], v[132:133], v[196:197]
    v_pk_mul_f32 v[134:135], v[134:135], v[198:199]
    v_cvt_pk_bf16_f32 v250, v104, v105
    v_cvt_pk_bf16_f32 v251, v106, v107
    s_add_u32 s36, s45, 458752
    buffer_store_dwordx4 v[88:91], v2, s[16:19], s36 offen sc1
    v_cvt_pk_bf16_f32 v252, v132, v133
    v_cvt_pk_bf16_f32 v253, v134, v135
    s_add_u32 s36, s45, 688128
    buffer_store_dwordx4 v[116:119], v2, s[16:19], s36 offen sc1
    s_waitcnt lgkmcnt(0)
    s_lshr_b32 s34, s30, 1
    s_and_b32 s35, s30, 1
    v_and_b32 v22, 15, v1
    v_lshrrev_b32 v23, 4, v1
    s_mul_i32 s37, s34, 4
    s_mul_i32 s38, s33, 8
    s_mul_i32 s36, s35, 4
    s_add_u32 s38, s38, s36
    s_mul_i32 s36, s34, 8192
    v_add_u32 v12, s36, v2
    v_lshrrev_b32 v6, 2, v1
    v_mul_u32_u24 v13, 256, v6
    v_and_b32 v7, 3, v1
    v_lshl_add_u32 v13, v7, 3, v13
    v_add_u32 v13, 49152, v13
    v_and_b32 v6, 7, v6
    s_mul_i32 s36, s35, 4
    s_add_u32 s36, s36, 3
    v_xor_b32 v7, s36, v6
    v_lshl_add_u32 v16, v7, 5, v13
    s_mul_i32 s36, s35, 4
    s_add_u32 s36, s36, 2
    v_xor_b32 v7, s36, v6
    v_lshl_add_u32 v15, v7, 5, v13
    s_mul_i32 s36, s35, 4
    s_add_u32 s36, s36, 1
    v_xor_b32 v7, s36, v6
    v_lshl_add_u32 v14, v7, 5, v13
    s_mul_i32 s36, s35, 4
    s_add_u32 s36, s36, 0
    v_xor_b32 v7, s36, v6
    v_lshl_add_u32 v13, v7, 5, v13
    s_mov_b32 s42, 0
    s_mov_b32 s43, 0
    s_mov_b32 s48, 0
    v_mov_b32 v17, v12
    v_mov_b32 v18, v13
    v_mov_b32 v19, v14
    v_mov_b32 v20, v15
    v_mov_b32 v21, v16
    s_waitcnt lgkmcnt(0)
    s_barrier
    ds_read_b128 v[24:27], v17 offset:0
    ds_read_b128 v[28:31], v17 offset:2048
    ds_read_b128 v[32:35], v17 offset:4096
    ds_read_b128 v[36:39], v17 offset:6144
    ds_read_b64_tr_b16 v[40:41], v18 offset:0
    ds_read_b64_tr_b16 v[42:43], v18 offset:4096
    ds_read_b64_tr_b16 v[44:45], v19 offset:0
    ds_read_b64_tr_b16 v[46:47], v19 offset:4096
    ds_read_b64_tr_b16 v[48:49], v20 offset:0
    ds_read_b64_tr_b16 v[50:51], v20 offset:4096
    ds_read_b64_tr_b16 v[52:53], v21 offset:0
    ds_read_b64_tr_b16 v[54:55], v21 offset:4096
    v_mfma_f32_16x16x32_bf16 v[120:123], v[226:229], v[172:175], 0
    v_mfma_f32_16x16x32_bf16 v[124:127], v[224:227], v[172:175], 0
    v_mfma_f32_16x16x32_bf16 v[128:131], v[226:229], v[200:203], 0
    v_mfma_f32_16x16x32_bf16 v[132:135], v[224:227], v[200:203], 0
    v_mfma_f32_16x16x32_bf16 v[136:139], v[226:229], v[208:211], 0
    v_mfma_f32_16x16x32_bf16 v[140:143], v[224:227], v[208:211], 0
    v_mfma_f32_16x16x32_bf16 v[144:147], v[226:229], v[216:219], 0
    v_mfma_f32_16x16x32_bf16 v[148:151], v[224:227], v[216:219], 0
    v_mfma_f32_16x16x32_bf16 v[120:123], v[226:229], v[176:179], v[120:123]
    v_mfma_f32_16x16x32_bf16 v[124:127], v[224:227], v[176:179], v[124:127]
    v_mfma_f32_16x16x32_bf16 v[128:131], v[226:229], v[204:207], v[128:131]
    v_mfma_f32_16x16x32_bf16 v[132:135], v[224:227], v[204:207], v[132:135]
    v_mfma_f32_16x16x32_bf16 v[136:139], v[226:229], v[212:215], v[136:139]
    v_mfma_f32_16x16x32_bf16 v[140:143], v[224:227], v[212:215], v[140:143]
    v_mfma_f32_16x16x32_bf16 v[144:147], v[226:229], v[220:223], v[144:147]
    v_mfma_f32_16x16x32_bf16 v[148:151], v[224:227], v[220:223], v[148:151]
    s_waitcnt lgkmcnt(0)
    v_mfma_f32_16x16x32_bf16 v[120:123], v[40:43], v[24:27], v[120:123]
    ds_read_b128 v[184:187], v17 offset:1024
    ds_read_b128 v[188:191], v17 offset:3072
    v_mfma_f32_16x16x32_bf16 v[136:139], v[40:43], v[28:31], v[136:139]
    ds_read_b128 v[192:195], v17 offset:5120
    v_mfma_f32_16x16x32_bf16 v[152:155], v[40:43], v[32:35], 0
    ds_read_b128 v[196:199], v17 offset:7168
    v_mfma_f32_16x16x32_bf16 v[168:171], v[40:43], v[36:39], 0
    s_add_u32 s36, s46, 0
    buffer_store_dwordx4 v[230:233], v2, s[16:19], s36 offen sc1
    v_mfma_f32_16x16x32_bf16 v[172:175], v[44:47], v[36:39], 0
    ds_read_b64_tr_b16 v[200:201], v18 offset:8192
    v_mfma_f32_16x16x32_bf16 v[156:159], v[44:47], v[32:35], 0
    ds_read_b64_tr_b16 v[202:203], v18 offset:12288
    v_mfma_f32_16x16x32_bf16 v[140:143], v[44:47], v[28:31], v[140:143]
    ds_read_b64_tr_b16 v[204:205], v19 offset:8192
    s_add_u32 s36, s47, 0
    buffer_store_dwordx2 v[246:247], v254, s[16:19], s36 offen sc1
    v_mfma_f32_16x16x32_bf16 v[124:127], v[44:47], v[24:27], v[124:127]
    ds_read_b64_tr_b16 v[206:207], v19 offset:12288
    v_mfma_f32_16x16x32_bf16 v[128:131], v[48:51], v[24:27], v[128:131]
    ds_read_b64_tr_b16 v[208:209], v20 offset:8192
    v_mfma_f32_16x16x32_bf16 v[144:147], v[48:51], v[28:31], v[144:147]
    ds_read_b64_tr_b16 v[210:211], v20 offset:12288
    v_mfma_f32_16x16x32_bf16 v[160:163], v[48:51], v[32:35], 0
    ds_read_b64_tr_b16 v[212:213], v21 offset:8192
    v_mfma_f32_16x16x32_bf16 v[176:179], v[48:51], v[36:39], 0
    ds_read_b64_tr_b16 v[214:215], v21 offset:12288
    s_add_u32 s42, s42, 16384
    s_cmp_eq_u32 s42, 49152
    s_cselect_b32 s42, 0, s42
    v_mfma_f32_16x16x32_bf16 v[180:183], v[52:55], v[36:39], 0
    s_add_u32 s48, s48, 16384
    s_cmp_eq_u32 s48, 98304
    s_cselect_b32 s48, 0, s48
    v_mfma_f32_16x16x32_bf16 v[164:167], v[52:55], v[32:35], 0
    v_add_u32 v17, s42, v12
    v_add_u32 v18, s48, v13
    v_add_u32 v19, s48, v14
    v_mfma_f32_16x16x32_bf16 v[148:151], v[52:55], v[28:31], v[148:151]
    v_add_u32 v20, s48, v15
    v_add_u32 v21, s48, v16
    v_mfma_f32_16x16x32_bf16 v[132:135], v[52:55], v[24:27], v[132:135]
    s_waitcnt lgkmcnt(0)
    s_barrier
    v_mfma_f32_16x16x32_bf16 v[120:123], v[200:203], v[184:187], v[120:123]
    ds_read_b128 v[24:27], v17 offset:0
    ds_read_b128 v[28:31], v17 offset:2048
    v_mfma_f32_16x16x32_bf16 v[136:139], v[200:203], v[188:191], v[136:139]
    ds_read_b128 v[32:35], v17 offset:4096
    v_mfma_f32_16x16x32_bf16 v[152:155], v[200:203], v[192:195], v[152:155]
    ds_read_b128 v[36:39], v17 offset:6144
    v_mfma_f32_16x16x32_bf16 v[168:171], v[200:203], v[196:199], v[168:171]
    s_add_u32 s36, s46, 229376
    buffer_store_dwordx4 v[234:237], v2, s[16:19], s36 offen sc1
    v_mfma_f32_16x16x32_bf16 v[172:175], v[204:207], v[196:199], v[172:175]
    ds_read_b64_tr_b16 v[40:41], v18 offset:0
    v_mfma_f32_16x16x32_bf16 v[156:159], v[204:207], v[192:195], v[156:159]
    ds_read_b64_tr_b16 v[42:43], v18 offset:4096
    v_mfma_f32_16x16x32_bf16 v[140:143], v[204:207], v[188:191], v[140:143]
    ds_read_b64_tr_b16 v[44:45], v19 offset:0
    s_add_u32 s36, s47, 229376
    buffer_store_dwordx2 v[248:249], v254, s[16:19], s36 offen sc1
    v_mfma_f32_16x16x32_bf16 v[124:127], v[204:207], v[184:187], v[124:127]
    ds_read_b64_tr_b16 v[46:47], v19 offset:4096
    v_mfma_f32_16x16x32_bf16 v[128:131], v[208:211], v[184:187], v[128:131]
    ds_read_b64_tr_b16 v[48:49], v20 offset:0
    v_mfma_f32_16x16x32_bf16 v[144:147], v[208:211], v[188:191], v[144:147]
    ds_read_b64_tr_b16 v[50:51], v20 offset:4096
    v_mfma_f32_16x16x32_bf16 v[160:163], v[208:211], v[192:195], v[160:163]
    ds_read_b64_tr_b16 v[52:53], v21 offset:0
    v_mfma_f32_16x16x32_bf16 v[176:179], v[208:211], v[196:199], v[176:179]
    ds_read_b64_tr_b16 v[54:55], v21 offset:4096
    s_add_u32 s43, s43, 1
    v_mfma_f32_16x16x32_bf16 v[180:183], v[212:215], v[196:199], v[180:183]
    s_cmp_lt_u32 s43, 27
    v_mfma_f32_16x16x32_bf16 v[164:167], v[212:215], v[192:195], v[164:167]
    v_mfma_f32_16x16x32_bf16 v[148:151], v[212:215], v[188:191], v[148:151]
    v_mfma_f32_16x16x32_bf16 v[132:135], v[212:215], v[184:187], v[132:135]
    s_waitcnt lgkmcnt(0)
    v_mfma_f32_16x16x32_bf16 v[120:123], v[40:43], v[24:27], v[120:123]
    ds_read_b128 v[184:187], v17 offset:1024
    ds_read_b128 v[188:191], v17 offset:3072
    v_mfma_f32_16x16x32_bf16 v[136:139], v[40:43], v[28:31], v[136:139]
    ds_read_b128 v[192:195], v17 offset:5120
    v_mfma_f32_16x16x32_bf16 v[152:155], v[40:43], v[32:35], v[152:155]
    ds_read_b128 v[196:199], v17 offset:7168
    v_mfma_f32_16x16x32_bf16 v[168:171], v[40:43], v[36:39], v[168:171]
    s_add_u32 s36, s46, 458752
    buffer_store_dwordx4 v[238:241], v2, s[16:19], s36 offen sc1
    v_mfma_f32_16x16x32_bf16 v[172:175], v[44:47], v[36:39], v[172:175]
    ds_read_b64_tr_b16 v[200:201], v18 offset:8192
    v_mfma_f32_16x16x32_bf16 v[156:159], v[44:47], v[32:35], v[156:159]
    ds_read_b64_tr_b16 v[202:203], v18 offset:12288
    v_mfma_f32_16x16x32_bf16 v[140:143], v[44:47], v[28:31], v[140:143]
    ds_read_b64_tr_b16 v[204:205], v19 offset:8192
    s_add_u32 s36, s47, 458752
    buffer_store_dwordx2 v[250:251], v254, s[16:19], s36 offen sc1
    v_mfma_f32_16x16x32_bf16 v[124:127], v[44:47], v[24:27], v[124:127]
    ds_read_b64_tr_b16 v[206:207], v19 offset:12288
    v_mfma_f32_16x16x32_bf16 v[128:131], v[48:51], v[24:27], v[128:131]
    ds_read_b64_tr_b16 v[208:209], v20 offset:8192
    v_mfma_f32_16x16x32_bf16 v[144:147], v[48:51], v[28:31], v[144:147]
    ds_read_b64_tr_b16 v[210:211], v20 offset:12288
    v_mfma_f32_16x16x32_bf16 v[160:163], v[48:51], v[32:35], v[160:163]
    ds_read_b64_tr_b16 v[212:213], v21 offset:8192
    v_mfma_f32_16x16x32_bf16 v[176:179], v[48:51], v[36:39], v[176:179]
    ds_read_b64_tr_b16 v[214:215], v21 offset:12288
    s_add_u32 s42, s42, 16384
    s_cmp_eq_u32 s42, 49152
    s_cselect_b32 s42, 0, s42
    v_mfma_f32_16x16x32_bf16 v[180:183], v[52:55], v[36:39], v[180:183]
    s_add_u32 s48, s48, 16384
    s_cmp_eq_u32 s48, 98304
    s_cselect_b32 s48, 0, s48
    v_mfma_f32_16x16x32_bf16 v[164:167], v[52:55], v[32:35], v[164:167]
    v_add_u32 v17, s42, v12
    v_add_u32 v18, s48, v13
    v_add_u32 v19, s48, v14
    v_mfma_f32_16x16x32_bf16 v[148:151], v[52:55], v[28:31], v[148:151]
    v_add_u32 v20, s48, v15
    v_add_u32 v21, s48, v16
    v_mfma_f32_16x16x32_bf16 v[132:135], v[52:55], v[24:27], v[132:135]
    s_waitcnt lgkmcnt(0)
    s_barrier
    v_mfma_f32_16x16x32_bf16 v[120:123], v[200:203], v[184:187], v[120:123]
    ds_read_b128 v[24:27], v17 offset:0
    ds_read_b128 v[28:31], v17 offset:2048
    v_mfma_f32_16x16x32_bf16 v[136:139], v[200:203], v[188:191], v[136:139]
    ds_read_b128 v[32:35], v17 offset:4096
    v_mfma_f32_16x16x32_bf16 v[152:155], v[200:203], v[192:195], v[152:155]
    ds_read_b128 v[36:39], v17 offset:6144
    v_mfma_f32_16x16x32_bf16 v[168:171], v[200:203], v[196:199], v[168:171]
    s_add_u32 s36, s46, 688128
    buffer_store_dwordx4 v[242:245], v2, s[16:19], s36 offen sc1
    v_mfma_f32_16x16x32_bf16 v[172:175], v[204:207], v[196:199], v[172:175]
    ds_read_b64_tr_b16 v[40:41], v18 offset:0
    v_mfma_f32_16x16x32_bf16 v[156:159], v[204:207], v[192:195], v[156:159]
    ds_read_b64_tr_b16 v[42:43], v18 offset:4096
    v_mfma_f32_16x16x32_bf16 v[140:143], v[204:207], v[188:191], v[140:143]
    ds_read_b64_tr_b16 v[44:45], v19 offset:0
    s_add_u32 s36, s47, 688128
    buffer_store_dwordx2 v[252:253], v254, s[16:19], s36 offen sc1
    v_mfma_f32_16x16x32_bf16 v[124:127], v[204:207], v[184:187], v[124:127]
    ds_read_b64_tr_b16 v[46:47], v19 offset:4096
    v_mfma_f32_16x16x32_bf16 v[128:131], v[208:211], v[184:187], v[128:131]
    ds_read_b64_tr_b16 v[48:49], v20 offset:0
    v_mfma_f32_16x16x32_bf16 v[144:147], v[208:211], v[188:191], v[144:147]
    ds_read_b64_tr_b16 v[50:51], v20 offset:4096
    v_mfma_f32_16x16x32_bf16 v[160:163], v[208:211], v[192:195], v[160:163]
    ds_read_b64_tr_b16 v[52:53], v21 offset:0
    v_mfma_f32_16x16x32_bf16 v[176:179], v[208:211], v[196:199], v[176:179]
    ds_read_b64_tr_b16 v[54:55], v21 offset:4096
    s_add_u32 s43, s43, 1
    v_mfma_f32_16x16x32_bf16 v[180:183], v[212:215], v[196:199], v[180:183]
    s_cmp_lt_u32 s43, 27
    v_mfma_f32_16x16x32_bf16 v[164:167], v[212:215], v[192:195], v[164:167]
    v_mfma_f32_16x16x32_bf16 v[148:151], v[212:215], v[188:191], v[148:151]
    v_mfma_f32_16x16x32_bf16 v[132:135], v[212:215], v[184:187], v[132:135]
    s_lshr_b32 s53, s30, 1
    s_lshl1_add_u32 s53, s31, s53
    s_lshl_b32 s53, s53, 7
    s_add_u32 s53, s53, s55
    s_add_u32 s53, s53, 0x1200
    v_mov_b32 v8, 1
    v_mov_b32 v9, 0
    s_mov_b64 exec, 1
    s_waitcnt vmcnt(8)
    buffer_atomic_add v8, v9, s[56:59], s53 offen sc1
    s_mov_b64 exec, -1
    s_waitcnt lgkmcnt(0)
    v_mfma_f32_16x16x32_bf16 v[120:123], v[40:43], v[24:27], v[120:123]
    ds_read_b128 v[184:187], v17 offset:1024
    ds_read_b128 v[188:191], v17 offset:3072
    v_mfma_f32_16x16x32_bf16 v[136:139], v[40:43], v[28:31], v[136:139]
    ds_read_b128 v[192:195], v17 offset:5120
    ds_read_b128 v[196:199], v17 offset:7168
    v_mfma_f32_16x16x32_bf16 v[152:155], v[40:43], v[32:35], v[152:155]
    ds_read_b64_tr_b16 v[200:201], v18 offset:8192
    v_mfma_f32_16x16x32_bf16 v[168:171], v[40:43], v[36:39], v[168:171]
    ds_read_b64_tr_b16 v[202:203], v18 offset:12288
    ds_read_b64_tr_b16 v[204:205], v19 offset:8192
    v_mfma_f32_16x16x32_bf16 v[172:175], v[44:47], v[36:39], v[172:175]
    ds_read_b64_tr_b16 v[206:207], v19 offset:12288
    ds_read_b64_tr_b16 v[208:209], v20 offset:8192
    v_mfma_f32_16x16x32_bf16 v[156:159], v[44:47], v[32:35], v[156:159]
    ds_read_b64_tr_b16 v[210:211], v20 offset:12288
    v_mfma_f32_16x16x32_bf16 v[140:143], v[44:47], v[28:31], v[140:143]
    ds_read_b64_tr_b16 v[212:213], v21 offset:8192
    ds_read_b64_tr_b16 v[214:215], v21 offset:12288
    v_mfma_f32_16x16x32_bf16 v[124:127], v[44:47], v[24:27], v[124:127]
    s_load_dwordx2 s[6:7], s[0:1], 88
    s_mov_b32 s40, s9
    v_mfma_f32_16x16x32_bf16 v[128:131], v[48:51], v[24:27], v[128:131]
    s_mov_b32 s44, s10
    v_mfma_f32_16x16x32_bf16 v[144:147], v[48:51], v[28:31], v[144:147]
    s_xor_b32 s41, s9, 0x20000
    s_mov_b32 s46, s11
    v_mfma_f32_16x16x32_bf16 v[160:163], v[48:51], v[32:35], v[160:163]
    s_lshl_b32 s47, s8, 7
    s_mov_b32 s45, 0xffff0000
    v_mfma_f32_16x16x32_bf16 v[176:179], v[48:51], v[36:39], v[176:179]
    v_mov_b32 v56, 0x10000
    s_add_u32 s42, s42, 16384
    s_cmp_eq_u32 s42, 49152
    s_cselect_b32 s42, 0, s42
    v_mfma_f32_16x16x32_bf16 v[180:183], v[52:55], v[36:39], v[180:183]
    s_add_u32 s48, s48, 16384
    s_cmp_eq_u32 s48, 98304
    s_cselect_b32 s48, 0, s48
    v_mfma_f32_16x16x32_bf16 v[164:167], v[52:55], v[32:35], v[164:167]
    v_add_u32 v17, s42, v12
    v_add_u32 v18, s48, v13
    v_add_u32 v19, s48, v14
    v_mfma_f32_16x16x32_bf16 v[148:151], v[52:55], v[28:31], v[148:151]
    v_add_u32 v20, s48, v15
    v_add_u32 v21, s48, v16
    v_mfma_f32_16x16x32_bf16 v[132:135], v[52:55], v[24:27], v[132:135]
    s_waitcnt lgkmcnt(0)
    s_barrier
    v_mfma_f32_16x16x32_bf16 v[120:123], v[200:203], v[184:187], v[120:123]
    ds_read_b128 v[24:27], v17 offset:0
    ds_read_b128 v[28:31], v17 offset:2048
    ds_read_b128 v[32:35], v17 offset:4096
    v_mfma_f32_16x16x32_bf16 v[136:139], v[200:203], v[188:191], v[136:139]
    ds_read_b128 v[36:39], v17 offset:6144
    ds_read_b64_tr_b16 v[40:41], v18 offset:0
    v_mfma_f32_16x16x32_bf16 v[152:155], v[200:203], v[192:195], v[152:155]
    ds_read_b64_tr_b16 v[42:43], v18 offset:4096
    ds_read_b64_tr_b16 v[44:45], v19 offset:0
    ds_read_b64_tr_b16 v[46:47], v19 offset:4096
    v_mfma_f32_16x16x32_bf16 v[168:171], v[200:203], v[196:199], v[168:171]
    ds_read_b64_tr_b16 v[48:49], v20 offset:0
    ds_read_b64_tr_b16 v[50:51], v20 offset:4096
    v_mfma_f32_16x16x32_bf16 v[172:175], v[204:207], v[196:199], v[172:175]
    ds_read_b64_tr_b16 v[52:53], v21 offset:0
    ds_read_b64_tr_b16 v[54:55], v21 offset:4096
    s_add_u32 s24, s62, 0x400000
    v_mfma_f32_16x16x32_bf16 v[156:159], v[204:207], v[192:195], v[156:159]
    s_addc_u32 s25, s63, 0
    s_mov_b32 s26, 0x7e000
    v_mfma_f32_16x16x32_bf16 v[140:143], v[204:207], v[188:191], v[140:143]
    s_mov_b32 s27, 0x20000
    s_lshr_b32 s49, s28, 3
    s_and_b32 s36, s28, 3
    v_mfma_f32_16x16x32_bf16 v[124:127], v[204:207], v[184:187], v[124:127]
    s_lshl2_add_u32 s36, s49, s36
    s_lshl_b32 s36, s36, 19
    v_mfma_f32_16x16x32_bf16 v[128:131], v[208:211], v[184:187], v[128:131]
    s_xor_b32 s49, s49, s94
    s_lshl_b32 s49, s49, 2
    s_xor_b32 s49, s49, s28
    v_mfma_f32_16x16x32_bf16 v[144:147], v[208:211], v[188:191], v[144:147]
    s_and_b32 s49, s49, 4
    s_lshl_b32 s49, s49, 11
    v_mfma_f32_16x16x32_bf16 v[160:163], v[208:211], v[192:195], v[160:163]
    s_add_u32 s36, s36, s49
    s_add_u32 s36, s36, 29360128
    s_add_u32 s8, s4, s36
    s_addc_u32 s9, s5, 0
    v_mfma_f32_16x16x32_bf16 v[176:179], v[208:211], v[196:199], v[176:179]
    s_mov_b32 s10, 516096
    s_mov_b32 s11, 0x20000
    s_add_u32 s43, s43, 1
    v_mfma_f32_16x16x32_bf16 v[180:183], v[212:215], v[196:199], v[180:183]
    s_cmp_lt_u32 s43, 27
    v_mfma_f32_16x16x32_bf16 v[164:167], v[212:215], v[192:195], v[164:167]
    v_mfma_f32_16x16x32_bf16 v[148:151], v[212:215], v[188:191], v[148:151]
    v_mfma_f32_16x16x32_bf16 v[132:135], v[212:215], v[184:187], v[132:135]
    s_waitcnt lgkmcnt(0)
    v_mfma_f32_16x16x32_bf16 v[120:123], v[40:43], v[24:27], v[120:123]
    ds_read_b128 v[184:187], v17 offset:1024
    ds_read_b128 v[188:191], v17 offset:3072
    v_mfma_f32_16x16x32_bf16 v[136:139], v[40:43], v[28:31], v[136:139]
    ds_read_b128 v[192:195], v17 offset:5120
    ds_read_b128 v[196:199], v17 offset:7168
    v_mfma_f32_16x16x32_bf16 v[152:155], v[40:43], v[32:35], v[152:155]
    ds_read_b64_tr_b16 v[200:201], v18 offset:8192
    v_mfma_f32_16x16x32_bf16 v[168:171], v[40:43], v[36:39], v[168:171]
    ds_read_b64_tr_b16 v[202:203], v18 offset:12288
    ds_read_b64_tr_b16 v[204:205], v19 offset:8192
    v_mfma_f32_16x16x32_bf16 v[172:175], v[44:47], v[36:39], v[172:175]
    ds_read_b64_tr_b16 v[206:207], v19 offset:12288
    ds_read_b64_tr_b16 v[208:209], v20 offset:8192
    v_mfma_f32_16x16x32_bf16 v[156:159], v[44:47], v[32:35], v[156:159]
    ds_read_b64_tr_b16 v[210:211], v20 offset:12288
    v_mfma_f32_16x16x32_bf16 v[140:143], v[44:47], v[28:31], v[140:143]
    ds_read_b64_tr_b16 v[212:213], v21 offset:8192
    ds_read_b64_tr_b16 v[214:215], v21 offset:12288
    v_mfma_f32_16x16x32_bf16 v[124:127], v[44:47], v[24:27], v[124:127]
    s_mov_b32 s20, s6
    s_mov_b32 s21, s7
    v_mfma_f32_16x16x32_bf16 v[128:131], v[48:51], v[24:27], v[128:131]
    s_mov_b32 s22, 0x400000
    v_mfma_f32_16x16x32_bf16 v[144:147], v[48:51], v[28:31], v[144:147]
    s_mov_b32 s23, 0x20000
    s_lshl_b32 s46, s46, 15
    v_mfma_f32_16x16x32_bf16 v[160:163], v[48:51], v[32:35], v[160:163]
    s_add_u32 s46, s46, s47
    s_add_u32 s47, s46, 32768
    v_mfma_f32_16x16x32_bf16 v[176:179], v[48:51], v[36:39], v[176:179]
    v_and_b32 v59, 1, v23
    s_add_u32 s42, s42, 16384
    s_cmp_eq_u32 s42, 49152
    s_cselect_b32 s42, 0, s42
    v_mfma_f32_16x16x32_bf16 v[180:183], v[52:55], v[36:39], v[180:183]
    s_add_u32 s48, s48, 16384
    s_cmp_eq_u32 s48, 98304
    s_cselect_b32 s48, 0, s48
    v_mfma_f32_16x16x32_bf16 v[164:167], v[52:55], v[32:35], v[164:167]
    v_add_u32 v17, s42, v12
    v_add_u32 v18, s48, v13
    v_add_u32 v19, s48, v14
    v_mfma_f32_16x16x32_bf16 v[148:151], v[52:55], v[28:31], v[148:151]
    v_add_u32 v20, s48, v15
    v_add_u32 v21, s48, v16
    v_mfma_f32_16x16x32_bf16 v[132:135], v[52:55], v[24:27], v[132:135]
    s_waitcnt lgkmcnt(0)
    s_barrier
    v_mfma_f32_16x16x32_bf16 v[120:123], v[200:203], v[184:187], v[120:123]
    ds_read_b128 v[24:27], v17 offset:0
    ds_read_b128 v[28:31], v17 offset:2048
    v_mfma_f32_16x16x32_bf16 v[136:139], v[200:203], v[188:191], v[136:139]
    ds_read_b128 v[32:35], v17 offset:4096
    ds_read_b128 v[36:39], v17 offset:6144
    v_mfma_f32_16x16x32_bf16 v[152:155], v[200:203], v[192:195], v[152:155]
    ds_read_b64_tr_b16 v[40:41], v18 offset:0
    ds_read_b64_tr_b16 v[42:43], v18 offset:4096
    v_mfma_f32_16x16x32_bf16 v[168:171], v[200:203], v[196:199], v[168:171]
    ds_read_b64_tr_b16 v[44:45], v19 offset:0
    v_mfma_f32_16x16x32_bf16 v[172:175], v[204:207], v[196:199], v[172:175]
    ds_read_b64_tr_b16 v[46:47], v19 offset:4096
    ds_read_b64_tr_b16 v[48:49], v20 offset:0
    v_mfma_f32_16x16x32_bf16 v[156:159], v[204:207], v[192:195], v[156:159]
    ds_read_b64_tr_b16 v[50:51], v20 offset:4096
    ds_read_b64_tr_b16 v[52:53], v21 offset:0
    v_mfma_f32_16x16x32_bf16 v[140:143], v[204:207], v[188:191], v[140:143]
    ds_read_b64_tr_b16 v[54:55], v21 offset:4096
    v_lshlrev_b32 v58, 11, v22
    v_mfma_f32_16x16x32_bf16 v[124:127], v[204:207], v[184:187], v[124:127]
    v_lshl_add_u32 v58, v59, 5, v58
    v_mfma_f32_16x16x32_bf16 v[128:131], v[208:211], v[184:187], v[128:131]
    v_lshrrev_b32 v59, 1, v23
    v_lshl_add_u32 v58, v59, 4, v58
    v_mfma_f32_16x16x32_bf16 v[144:147], v[208:211], v[188:191], v[144:147]
    v_cmp_gt_u32 s[50:51], 8, v22
    v_lshrrev_b32 v59, 3, v22
    v_mfma_f32_16x16x32_bf16 v[160:163], v[208:211], v[192:195], v[160:163]
    v_mul_u32_u24 v59, 16320, v59
    v_sub_u32 v58, v58, v59
    v_mfma_f32_16x16x32_bf16 v[176:179], v[208:211], v[196:199], v[176:179]
    v_add_u32 v59, 16384, v58
    s_add_u32 s43, s43, 1
    v_mfma_f32_16x16x32_bf16 v[180:183], v[212:215], v[196:199], v[180:183]
    s_cmp_lt_u32 s43, 27
    v_mfma_f32_16x16x32_bf16 v[164:167], v[212:215], v[192:195], v[164:167]
    v_mfma_f32_16x16x32_bf16 v[148:151], v[212:215], v[188:191], v[148:151]
    v_mfma_f32_16x16x32_bf16 v[132:135], v[212:215], v[184:187], v[132:135]
    s_lshr_b32 s53, s30, 1
    s_lshl1_add_u32 s53, s31, s53
    s_lshl_b32 s53, s53, 7
    s_add_u32 s53, s53, s55
    s_add_u32 s53, s53, 0x1400
    v_mov_b32 v8, 1
    v_mov_b32 v9, 0
    s_mov_b64 exec, 1
    s_waitcnt vmcnt(0)
    buffer_atomic_add v8, v9, s[56:59], s53 offen sc1
    s_mov_b64 exec, -1
mm_21:
    s_waitcnt lgkmcnt(0)
    v_mfma_f32_16x16x32_bf16 v[120:123], v[40:43], v[24:27], v[120:123]
    ds_read_b128 v[184:187], v17 offset:1024
    v_mfma_f32_16x16x32_bf16 v[136:139], v[40:43], v[28:31], v[136:139]
    ds_read_b128 v[188:191], v17 offset:3072
    v_mfma_f32_16x16x32_bf16 v[152:155], v[40:43], v[32:35], v[152:155]
    ds_read_b128 v[192:195], v17 offset:5120
    v_mfma_f32_16x16x32_bf16 v[168:171], v[40:43], v[36:39], v[168:171]
    ds_read_b128 v[196:199], v17 offset:7168
    v_mfma_f32_16x16x32_bf16 v[172:175], v[44:47], v[36:39], v[172:175]
    ds_read_b64_tr_b16 v[200:201], v18 offset:8192
    v_mfma_f32_16x16x32_bf16 v[156:159], v[44:47], v[32:35], v[156:159]
    ds_read_b64_tr_b16 v[202:203], v18 offset:12288
    v_mfma_f32_16x16x32_bf16 v[140:143], v[44:47], v[28:31], v[140:143]
    ds_read_b64_tr_b16 v[204:205], v19 offset:8192
    v_mfma_f32_16x16x32_bf16 v[124:127], v[44:47], v[24:27], v[124:127]
    ds_read_b64_tr_b16 v[206:207], v19 offset:12288
    v_mfma_f32_16x16x32_bf16 v[128:131], v[48:51], v[24:27], v[128:131]
    ds_read_b64_tr_b16 v[208:209], v20 offset:8192
    v_mfma_f32_16x16x32_bf16 v[144:147], v[48:51], v[28:31], v[144:147]
    ds_read_b64_tr_b16 v[210:211], v20 offset:12288
    v_mfma_f32_16x16x32_bf16 v[160:163], v[48:51], v[32:35], v[160:163]
    ds_read_b64_tr_b16 v[212:213], v21 offset:8192
    v_mfma_f32_16x16x32_bf16 v[176:179], v[48:51], v[36:39], v[176:179]
    ds_read_b64_tr_b16 v[214:215], v21 offset:12288
    s_add_u32 s42, s42, 16384
    s_cmp_eq_u32 s42, 49152
    s_cselect_b32 s42, 0, s42
    v_mfma_f32_16x16x32_bf16 v[180:183], v[52:55], v[36:39], v[180:183]
    s_add_u32 s48, s48, 16384
    s_cmp_eq_u32 s48, 98304
    s_cselect_b32 s48, 0, s48
    v_mfma_f32_16x16x32_bf16 v[164:167], v[52:55], v[32:35], v[164:167]
    v_add_u32 v17, s42, v12
    v_add_u32 v18, s48, v13
    v_add_u32 v19, s48, v14
    v_mfma_f32_16x16x32_bf16 v[148:151], v[52:55], v[28:31], v[148:151]
    v_add_u32 v20, s48, v15
    v_add_u32 v21, s48, v16
    v_mfma_f32_16x16x32_bf16 v[132:135], v[52:55], v[24:27], v[132:135]
    s_waitcnt lgkmcnt(0)
    s_barrier
    v_mfma_f32_16x16x32_bf16 v[120:123], v[200:203], v[184:187], v[120:123]
    ds_read_b128 v[24:27], v17 offset:0
    v_mfma_f32_16x16x32_bf16 v[136:139], v[200:203], v[188:191], v[136:139]
    ds_read_b128 v[28:31], v17 offset:2048
    v_mfma_f32_16x16x32_bf16 v[152:155], v[200:203], v[192:195], v[152:155]
    ds_read_b128 v[32:35], v17 offset:4096
    v_mfma_f32_16x16x32_bf16 v[168:171], v[200:203], v[196:199], v[168:171]
    ds_read_b128 v[36:39], v17 offset:6144
    v_mfma_f32_16x16x32_bf16 v[172:175], v[204:207], v[196:199], v[172:175]
    ds_read_b64_tr_b16 v[40:41], v18 offset:0
    v_mfma_f32_16x16x32_bf16 v[156:159], v[204:207], v[192:195], v[156:159]
    ds_read_b64_tr_b16 v[42:43], v18 offset:4096
    v_mfma_f32_16x16x32_bf16 v[140:143], v[204:207], v[188:191], v[140:143]
    ds_read_b64_tr_b16 v[44:45], v19 offset:0
    v_mfma_f32_16x16x32_bf16 v[124:127], v[204:207], v[184:187], v[124:127]
    ds_read_b64_tr_b16 v[46:47], v19 offset:4096
    v_mfma_f32_16x16x32_bf16 v[128:131], v[208:211], v[184:187], v[128:131]
    ds_read_b64_tr_b16 v[48:49], v20 offset:0
    v_mfma_f32_16x16x32_bf16 v[144:147], v[208:211], v[188:191], v[144:147]
    ds_read_b64_tr_b16 v[50:51], v20 offset:4096
    v_mfma_f32_16x16x32_bf16 v[160:163], v[208:211], v[192:195], v[160:163]
    ds_read_b64_tr_b16 v[52:53], v21 offset:0
    v_mfma_f32_16x16x32_bf16 v[176:179], v[208:211], v[196:199], v[176:179]
    ds_read_b64_tr_b16 v[54:55], v21 offset:4096
    s_add_u32 s43, s43, 1
    v_mfma_f32_16x16x32_bf16 v[180:183], v[212:215], v[196:199], v[180:183]
    s_cmp_lt_u32 s43, 21
    v_mfma_f32_16x16x32_bf16 v[164:167], v[212:215], v[192:195], v[164:167]
    v_mfma_f32_16x16x32_bf16 v[148:151], v[212:215], v[188:191], v[148:151]
    v_mfma_f32_16x16x32_bf16 v[132:135], v[212:215], v[184:187], v[132:135]
    s_cbranch_scc1 mm_21
    s_waitcnt lgkmcnt(0)
    v_mfma_f32_16x16x32_bf16 v[120:123], v[40:43], v[24:27], v[120:123]
    ds_read_b128 v[184:187], v17 offset:1024
    v_mfma_f32_16x16x32_bf16 v[136:139], v[40:43], v[28:31], v[136:139]
    ds_read_b128 v[188:191], v17 offset:3072
    v_mfma_f32_16x16x32_bf16 v[152:155], v[40:43], v[32:35], v[152:155]
    ds_read_b128 v[192:195], v17 offset:5120
    v_mfma_f32_16x16x32_bf16 v[168:171], v[40:43], v[36:39], v[168:171]
    ds_read_b128 v[196:199], v17 offset:7168
    v_mfma_f32_16x16x32_bf16 v[172:175], v[44:47], v[36:39], v[172:175]
    ds_read_b64_tr_b16 v[200:201], v18 offset:8192
    v_mfma_f32_16x16x32_bf16 v[156:159], v[44:47], v[32:35], v[156:159]
    ds_read_b64_tr_b16 v[202:203], v18 offset:12288
    v_mfma_f32_16x16x32_bf16 v[140:143], v[44:47], v[28:31], v[140:143]
    ds_read_b64_tr_b16 v[204:205], v19 offset:8192
    v_mfma_f32_16x16x32_bf16 v[124:127], v[44:47], v[24:27], v[124:127]
    ds_read_b64_tr_b16 v[206:207], v19 offset:12288
    v_mfma_f32_16x16x32_bf16 v[128:131], v[48:51], v[24:27], v[128:131]
    ds_read_b64_tr_b16 v[208:209], v20 offset:8192
    v_mfma_f32_16x16x32_bf16 v[144:147], v[48:51], v[28:31], v[144:147]
    ds_read_b64_tr_b16 v[210:211], v20 offset:12288
    v_mfma_f32_16x16x32_bf16 v[160:163], v[48:51], v[32:35], v[160:163]
    ds_read_b64_tr_b16 v[212:213], v21 offset:8192
    v_mfma_f32_16x16x32_bf16 v[176:179], v[48:51], v[36:39], v[176:179]
    ds_read_b64_tr_b16 v[214:215], v21 offset:12288
    v_add_u32 v18, 49152, v13
    v_mfma_f32_16x16x32_bf16 v[180:183], v[52:55], v[36:39], v[180:183]
    v_add_u32 v19, 49152, v14
    v_mfma_f32_16x16x32_bf16 v[164:167], v[52:55], v[32:35], v[164:167]
    v_add_u32 v20, 49152, v15
    v_mfma_f32_16x16x32_bf16 v[148:151], v[52:55], v[28:31], v[148:151]
    v_add_u32 v21, 49152, v16
    v_mfma_f32_16x16x32_bf16 v[132:135], v[52:55], v[24:27], v[132:135]
    s_waitcnt lgkmcnt(0)
    s_barrier
    v_mfma_f32_16x16x32_bf16 v[120:123], v[200:203], v[184:187], v[120:123]
    ds_read_b128 v[232:235], v12 offset:16384
    ds_read_b128 v[236:239], v12 offset:18432
    v_mfma_f32_16x16x32_bf16 v[136:139], v[200:203], v[188:191], v[136:139]
    ds_read_b128 v[240:243], v12 offset:17408
    ds_read_b128 v[244:247], v12 offset:19456
    v_mfma_f32_16x16x32_bf16 v[152:155], v[200:203], v[192:195], v[152:155]
    ds_read_b64_tr_b16 v[24:25], v18 offset:16384
    v_mfma_f32_16x16x32_bf16 v[168:171], v[200:203], v[196:199], v[168:171]
    ds_read_b64_tr_b16 v[26:27], v18 offset:20480
    ds_read_b64_tr_b16 v[28:29], v19 offset:16384
    v_mfma_f32_16x16x32_bf16 v[172:175], v[204:207], v[196:199], v[172:175]
    ds_read_b64_tr_b16 v[30:31], v19 offset:20480
    ds_read_b64_tr_b16 v[32:33], v20 offset:16384
    v_mfma_f32_16x16x32_bf16 v[156:159], v[204:207], v[192:195], v[156:159]
    ds_read_b64_tr_b16 v[34:35], v20 offset:20480
    v_mfma_f32_16x16x32_bf16 v[140:143], v[204:207], v[188:191], v[140:143]
    ds_read_b64_tr_b16 v[36:37], v21 offset:16384
    ds_read_b64_tr_b16 v[38:39], v21 offset:20480
    v_mfma_f32_16x16x32_bf16 v[124:127], v[204:207], v[184:187], v[124:127]
    ds_read_b64_tr_b16 v[40:41], v18 offset:24576
    ds_read_b64_tr_b16 v[42:43], v18 offset:28672
    v_mfma_f32_16x16x32_bf16 v[128:131], v[208:211], v[184:187], v[128:131]
    ds_read_b64_tr_b16 v[44:45], v19 offset:24576
    v_mfma_f32_16x16x32_bf16 v[144:147], v[208:211], v[188:191], v[144:147]
    ds_read_b64_tr_b16 v[46:47], v19 offset:28672
    ds_read_b64_tr_b16 v[48:49], v20 offset:24576
    v_mfma_f32_16x16x32_bf16 v[160:163], v[208:211], v[192:195], v[160:163]
    ds_read_b64_tr_b16 v[50:51], v20 offset:28672
    ds_read_b64_tr_b16 v[52:53], v21 offset:24576
    v_mfma_f32_16x16x32_bf16 v[176:179], v[208:211], v[196:199], v[176:179]
    ds_read_b64_tr_b16 v[54:55], v21 offset:28672
    v_mfma_f32_16x16x32_bf16 v[180:183], v[212:215], v[196:199], v[180:183]
    v_mfma_f32_16x16x32_bf16 v[164:167], v[212:215], v[192:195], v[164:167]
    v_mfma_f32_16x16x32_bf16 v[148:151], v[212:215], v[188:191], v[148:151]
    v_mfma_f32_16x16x32_bf16 v[132:135], v[212:215], v[184:187], v[132:135]
    s_waitcnt lgkmcnt(8)
    v_mfma_f32_16x16x32_bf16 v[152:155], v[24:27], v[232:235], v[152:155]
    ds_read_b128 v[88:91], v12 offset:20480
    ds_read_b128 v[92:95], v12 offset:22528
    v_mfma_f32_16x16x32_bf16 v[168:171], v[24:27], v[236:239], v[168:171]
    ds_read_b128 v[96:99], v12 offset:21504
    v_mfma_f32_16x16x32_bf16 v[172:175], v[28:31], v[236:239], v[172:175]
    ds_read_b128 v[100:103], v12 offset:23552
    v_mfma_f32_16x16x32_bf16 v[156:159], v[28:31], v[232:235], v[156:159]
    ds_read_b64_tr_b16 v[184:185], v18 offset:32768
    v_mfma_f32_16x16x32_bf16 v[160:163], v[32:35], v[232:235], v[160:163]
    ds_read_b64_tr_b16 v[186:187], v18 offset:36864
    ds_read_b64_tr_b16 v[188:189], v19 offset:32768
    v_mfma_f32_16x16x32_bf16 v[176:179], v[32:35], v[236:239], v[176:179]
    ds_read_b64_tr_b16 v[190:191], v19 offset:36864
    v_mfma_f32_16x16x32_bf16 v[180:183], v[36:39], v[236:239], v[180:183]
    ds_read_b64_tr_b16 v[192:193], v20 offset:32768
    v_mfma_f32_16x16x32_bf16 v[164:167], v[36:39], v[232:235], v[164:167]
    ds_read_b64_tr_b16 v[194:195], v20 offset:36864
    s_waitcnt lgkmcnt(10)
    v_mfma_f32_16x16x32_bf16 v[152:155], v[40:43], v[240:243], v[152:155]
    ds_read_b64_tr_b16 v[196:197], v21 offset:32768
    ds_read_b64_tr_b16 v[198:199], v21 offset:36864
    v_mfma_f32_16x16x32_bf16 v[168:171], v[40:43], v[244:247], v[168:171]
    ds_read_b64_tr_b16 v[200:201], v18 offset:40960
    v_mfma_f32_16x16x32_bf16 v[172:175], v[44:47], v[244:247], v[172:175]
    ds_read_b64_tr_b16 v[202:203], v18 offset:45056
    v_mfma_f32_16x16x32_bf16 v[156:159], v[44:47], v[240:243], v[156:159]
    ds_read_b64_tr_b16 v[204:205], v19 offset:40960
    v_mfma_f32_16x16x32_bf16 v[160:163], v[48:51], v[240:243], v[160:163]
    ds_read_b64_tr_b16 v[206:207], v19 offset:45056
    ds_read_b64_tr_b16 v[208:209], v20 offset:40960
    v_mfma_f32_16x16x32_bf16 v[176:179], v[48:51], v[244:247], v[176:179]
    ds_read_b64_tr_b16 v[210:211], v20 offset:45056
    v_mfma_f32_16x16x32_bf16 v[180:183], v[52:55], v[244:247], v[180:183]
    ds_read_b64_tr_b16 v[212:213], v21 offset:40960
    v_mfma_f32_16x16x32_bf16 v[164:167], v[52:55], v[240:243], v[164:167]
    ds_read_b64_tr_b16 v[214:215], v21 offset:45056
    s_waitcnt lgkmcnt(8)
    s_barrier
    v_mfma_f32_16x16x32_bf16 v[152:155], v[184:187], v[88:91], v[152:155]
    ds_read_b128 v[232:235], v12 offset:32768
    ds_read_b128 v[236:239], v12 offset:34816
    v_mfma_f32_16x16x32_bf16 v[168:171], v[184:187], v[92:95], v[168:171]
    ds_read_b128 v[240:243], v12 offset:33792
    v_mfma_f32_16x16x32_bf16 v[172:175], v[188:191], v[92:95], v[172:175]
    ds_read_b128 v[244:247], v12 offset:35840
    v_mfma_f32_16x16x32_bf16 v[156:159], v[188:191], v[88:91], v[156:159]
    ds_read_b64_tr_b16 v[24:25], v13 offset:0
    v_mfma_f32_16x16x32_bf16 v[160:163], v[192:195], v[88:91], v[160:163]
    ds_read_b64_tr_b16 v[26:27], v13 offset:4096
    ds_read_b64_tr_b16 v[28:29], v14 offset:0
    v_mfma_f32_16x16x32_bf16 v[176:179], v[192:195], v[92:95], v[176:179]
    ds_read_b64_tr_b16 v[30:31], v14 offset:4096
    v_mfma_f32_16x16x32_bf16 v[180:183], v[196:199], v[92:95], v[180:183]
    ds_read_b64_tr_b16 v[32:33], v15 offset:0
    v_mfma_f32_16x16x32_bf16 v[164:167], v[196:199], v[88:91], v[164:167]
    ds_read_b64_tr_b16 v[34:35], v15 offset:4096
    s_waitcnt lgkmcnt(10)
    v_mfma_f32_16x16x32_bf16 v[152:155], v[200:203], v[96:99], v[152:155]
    ds_read_b64_tr_b16 v[36:37], v16 offset:0
    ds_read_b64_tr_b16 v[38:39], v16 offset:4096
    v_mfma_f32_16x16x32_bf16 v[168:171], v[200:203], v[100:103], v[168:171]
    ds_read_b64_tr_b16 v[40:41], v13 offset:8192
    v_mfma_f32_16x16x32_bf16 v[172:175], v[204:207], v[100:103], v[172:175]
    ds_read_b64_tr_b16 v[42:43], v13 offset:12288
    v_mfma_f32_16x16x32_bf16 v[156:159], v[204:207], v[96:99], v[156:159]
    ds_read_b64_tr_b16 v[44:45], v14 offset:8192
    v_mfma_f32_16x16x32_bf16 v[160:163], v[208:211], v[96:99], v[160:163]
    ds_read_b64_tr_b16 v[46:47], v14 offset:12288
    ds_read_b64_tr_b16 v[48:49], v15 offset:8192
    v_mfma_f32_16x16x32_bf16 v[176:179], v[208:211], v[100:103], v[176:179]
    ds_read_b64_tr_b16 v[50:51], v15 offset:12288
    v_mfma_f32_16x16x32_bf16 v[180:183], v[212:215], v[100:103], v[180:183]
    ds_read_b64_tr_b16 v[52:53], v16 offset:8192
    v_mfma_f32_16x16x32_bf16 v[164:167], v[212:215], v[96:99], v[164:167]
    ds_read_b64_tr_b16 v[54:55], v16 offset:12288
    s_waitcnt lgkmcnt(8)
    v_mfma_f32_16x16x32_bf16 v[152:155], v[24:27], v[232:235], v[152:155]
    ds_read_b128 v[88:91], v12 offset:36864
    ds_read_b128 v[92:95], v12 offset:38912
    v_mfma_f32_16x16x32_bf16 v[168:171], v[24:27], v[236:239], v[168:171]
    ds_read_b128 v[96:99], v12 offset:37888
    v_mfma_f32_16x16x32_bf16 v[172:175], v[28:31], v[236:239], v[172:175]
    ds_read_b128 v[100:103], v12 offset:39936
    v_mfma_f32_16x16x32_bf16 v[156:159], v[28:31], v[232:235], v[156:159]
    ds_read_b64_tr_b16 v[184:185], v13 offset:16384
    v_mfma_f32_16x16x32_bf16 v[160:163], v[32:35], v[232:235], v[160:163]
    ds_read_b64_tr_b16 v[186:187], v13 offset:20480
    ds_read_b64_tr_b16 v[188:189], v14 offset:16384
    v_mfma_f32_16x16x32_bf16 v[176:179], v[32:35], v[236:239], v[176:179]
    ds_read_b64_tr_b16 v[190:191], v14 offset:20480
    v_mfma_f32_16x16x32_bf16 v[180:183], v[36:39], v[236:239], v[180:183]
    ds_read_b64_tr_b16 v[192:193], v15 offset:16384
    v_mfma_f32_16x16x32_bf16 v[164:167], v[36:39], v[232:235], v[164:167]
    ds_read_b64_tr_b16 v[194:195], v15 offset:20480
    s_waitcnt lgkmcnt(10)
    v_mfma_f32_16x16x32_bf16 v[152:155], v[40:43], v[240:243], v[152:155]
    ds_read_b64_tr_b16 v[196:197], v16 offset:16384
    ds_read_b64_tr_b16 v[198:199], v16 offset:20480
    v_mfma_f32_16x16x32_bf16 v[168:171], v[40:43], v[244:247], v[168:171]
    ds_read_b64_tr_b16 v[200:201], v13 offset:24576
    v_mfma_f32_16x16x32_bf16 v[172:175], v[44:47], v[244:247], v[172:175]
    ds_read_b64_tr_b16 v[202:203], v13 offset:28672
    v_mfma_f32_16x16x32_bf16 v[156:159], v[44:47], v[240:243], v[156:159]
    ds_read_b64_tr_b16 v[204:205], v14 offset:24576
    v_mfma_f32_16x16x32_bf16 v[160:163], v[48:51], v[240:243], v[160:163]
    ds_read_b64_tr_b16 v[206:207], v14 offset:28672
    ds_read_b64_tr_b16 v[208:209], v15 offset:24576
    v_mfma_f32_16x16x32_bf16 v[176:179], v[48:51], v[244:247], v[176:179]
    ds_read_b64_tr_b16 v[210:211], v15 offset:28672
    v_mfma_f32_16x16x32_bf16 v[180:183], v[52:55], v[244:247], v[180:183]
    ds_read_b64_tr_b16 v[212:213], v16 offset:24576
    v_mfma_f32_16x16x32_bf16 v[164:167], v[52:55], v[240:243], v[164:167]
    ds_read_b64_tr_b16 v[214:215], v16 offset:28672
    s_waitcnt lgkmcnt(8)
    s_barrier
    v_mfma_f32_16x16x32_bf16 v[152:155], v[184:187], v[88:91], v[152:155]
    ds_read_b128 v[232:235], v12 offset:0
    ds_read_b128 v[236:239], v12 offset:2048
    v_mfma_f32_16x16x32_bf16 v[168:171], v[184:187], v[92:95], v[168:171]
    ds_read_b128 v[240:243], v12 offset:1024
    v_mfma_f32_16x16x32_bf16 v[172:175], v[188:191], v[92:95], v[172:175]
    ds_read_b128 v[244:247], v12 offset:3072
    v_mfma_f32_16x16x32_bf16 v[156:159], v[188:191], v[88:91], v[156:159]
    ds_read_b64_tr_b16 v[24:25], v13 offset:32768
    v_mfma_f32_16x16x32_bf16 v[160:163], v[192:195], v[88:91], v[160:163]
    ds_read_b64_tr_b16 v[26:27], v13 offset:36864
    ds_read_b64_tr_b16 v[28:29], v14 offset:32768
    v_mfma_f32_16x16x32_bf16 v[176:179], v[192:195], v[92:95], v[176:179]
    ds_read_b64_tr_b16 v[30:31], v14 offset:36864
    v_mfma_f32_16x16x32_bf16 v[180:183], v[196:199], v[92:95], v[180:183]
    ds_read_b64_tr_b16 v[32:33], v15 offset:32768
    v_mfma_f32_16x16x32_bf16 v[164:167], v[196:199], v[88:91], v[164:167]
    ds_read_b64_tr_b16 v[34:35], v15 offset:36864
    s_waitcnt lgkmcnt(10)
    v_mfma_f32_16x16x32_bf16 v[152:155], v[200:203], v[96:99], v[152:155]
    ds_read_b64_tr_b16 v[36:37], v16 offset:32768
    ds_read_b64_tr_b16 v[38:39], v16 offset:36864
    v_mfma_f32_16x16x32_bf16 v[168:171], v[200:203], v[100:103], v[168:171]
    ds_read_b64_tr_b16 v[40:41], v13 offset:40960
    v_mfma_f32_16x16x32_bf16 v[172:175], v[204:207], v[100:103], v[172:175]
    ds_read_b64_tr_b16 v[42:43], v13 offset:45056
    v_mfma_f32_16x16x32_bf16 v[156:159], v[204:207], v[96:99], v[156:159]
    ds_read_b64_tr_b16 v[44:45], v14 offset:40960
    v_mfma_f32_16x16x32_bf16 v[160:163], v[208:211], v[96:99], v[160:163]
    ds_read_b64_tr_b16 v[46:47], v14 offset:45056
    ds_read_b64_tr_b16 v[48:49], v15 offset:40960
    v_mfma_f32_16x16x32_bf16 v[176:179], v[208:211], v[100:103], v[176:179]
    ds_read_b64_tr_b16 v[50:51], v15 offset:45056
    v_mfma_f32_16x16x32_bf16 v[180:183], v[212:215], v[100:103], v[180:183]
    ds_read_b64_tr_b16 v[52:53], v16 offset:40960
    v_mfma_f32_16x16x32_bf16 v[164:167], v[212:215], v[96:99], v[164:167]
    ds_read_b64_tr_b16 v[54:55], v16 offset:45056
    s_waitcnt lgkmcnt(8)
    v_mfma_f32_16x16x32_bf16 v[152:155], v[24:27], v[232:235], v[152:155]
    ds_read_b128 v[88:91], v12 offset:4096
    ds_read_b128 v[92:95], v12 offset:6144
    v_mfma_f32_16x16x32_bf16 v[168:171], v[24:27], v[236:239], v[168:171]
    ds_read_b128 v[96:99], v12 offset:5120
    v_mfma_f32_16x16x32_bf16 v[172:175], v[28:31], v[236:239], v[172:175]
    ds_read_b128 v[100:103], v12 offset:7168
    v_mfma_f32_16x16x32_bf16 v[156:159], v[28:31], v[232:235], v[156:159]
    ds_read_b64_tr_b16 v[184:185], v18 offset:0
    v_mfma_f32_16x16x32_bf16 v[160:163], v[32:35], v[232:235], v[160:163]
    ds_read_b64_tr_b16 v[186:187], v18 offset:4096
    ds_read_b64_tr_b16 v[188:189], v19 offset:0
    v_mfma_f32_16x16x32_bf16 v[176:179], v[32:35], v[236:239], v[176:179]
    ds_read_b64_tr_b16 v[190:191], v19 offset:4096
    v_mfma_f32_16x16x32_bf16 v[180:183], v[36:39], v[236:239], v[180:183]
    ds_read_b64_tr_b16 v[192:193], v20 offset:0
    v_mfma_f32_16x16x32_bf16 v[164:167], v[36:39], v[232:235], v[164:167]
    ds_read_b64_tr_b16 v[194:195], v20 offset:4096
    s_waitcnt lgkmcnt(10)
    v_mfma_f32_16x16x32_bf16 v[152:155], v[40:43], v[240:243], v[152:155]
    ds_read_b64_tr_b16 v[196:197], v21 offset:0
    ds_read_b64_tr_b16 v[198:199], v21 offset:4096
    v_mfma_f32_16x16x32_bf16 v[168:171], v[40:43], v[244:247], v[168:171]
    ds_read_b64_tr_b16 v[200:201], v18 offset:8192
    v_mfma_f32_16x16x32_bf16 v[172:175], v[44:47], v[244:247], v[172:175]
    ds_read_b64_tr_b16 v[202:203], v18 offset:12288
    v_mfma_f32_16x16x32_bf16 v[156:159], v[44:47], v[240:243], v[156:159]
    ds_read_b64_tr_b16 v[204:205], v19 offset:8192
    v_mfma_f32_16x16x32_bf16 v[160:163], v[48:51], v[240:243], v[160:163]
    ds_read_b64_tr_b16 v[206:207], v19 offset:12288
    ds_read_b64_tr_b16 v[208:209], v20 offset:8192
    v_mfma_f32_16x16x32_bf16 v[176:179], v[48:51], v[244:247], v[176:179]
    ds_read_b64_tr_b16 v[210:211], v20 offset:12288
    v_mfma_f32_16x16x32_bf16 v[180:183], v[52:55], v[244:247], v[180:183]
    ds_read_b64_tr_b16 v[212:213], v21 offset:8192
    v_mfma_f32_16x16x32_bf16 v[164:167], v[52:55], v[240:243], v[164:167]
    ds_read_b64_tr_b16 v[214:215], v21 offset:12288
    s_waitcnt lgkmcnt(8)
    s_barrier
    v_mfma_f32_16x16x32_bf16 v[152:155], v[184:187], v[88:91], v[152:155]
    ds_read_b128 v[232:235], v12 offset:16384
    ds_read_b128 v[236:239], v12 offset:18432
    v_mfma_f32_16x16x32_bf16 v[168:171], v[184:187], v[92:95], v[168:171]
    ds_read_b128 v[240:243], v12 offset:17408
    v_mfma_f32_16x16x32_bf16 v[172:175], v[188:191], v[92:95], v[172:175]
    ds_read_b128 v[244:247], v12 offset:19456
    v_mfma_f32_16x16x32_bf16 v[156:159], v[188:191], v[88:91], v[156:159]
    ds_read_b64_tr_b16 v[24:25], v18 offset:16384
    v_mfma_f32_16x16x32_bf16 v[160:163], v[192:195], v[88:91], v[160:163]
    ds_read_b64_tr_b16 v[26:27], v18 offset:20480
    ds_read_b64_tr_b16 v[28:29], v19 offset:16384
    v_mfma_f32_16x16x32_bf16 v[176:179], v[192:195], v[92:95], v[176:179]
    ds_read_b64_tr_b16 v[30:31], v19 offset:20480
    v_mfma_f32_16x16x32_bf16 v[180:183], v[196:199], v[92:95], v[180:183]
    ds_read_b64_tr_b16 v[32:33], v20 offset:16384
    v_mfma_f32_16x16x32_bf16 v[164:167], v[196:199], v[88:91], v[164:167]
    ds_read_b64_tr_b16 v[34:35], v20 offset:20480
    s_waitcnt lgkmcnt(10)
    v_mfma_f32_16x16x32_bf16 v[152:155], v[200:203], v[96:99], v[152:155]
    ds_read_b64_tr_b16 v[36:37], v21 offset:16384
    ds_read_b64_tr_b16 v[38:39], v21 offset:20480
    v_mfma_f32_16x16x32_bf16 v[168:171], v[200:203], v[100:103], v[168:171]
    ds_read_b64_tr_b16 v[40:41], v18 offset:24576
    v_mfma_f32_16x16x32_bf16 v[172:175], v[204:207], v[100:103], v[172:175]
    ds_read_b64_tr_b16 v[42:43], v18 offset:28672
    v_mfma_f32_16x16x32_bf16 v[156:159], v[204:207], v[96:99], v[156:159]
    ds_read_b64_tr_b16 v[44:45], v19 offset:24576
    v_mfma_f32_16x16x32_bf16 v[160:163], v[208:211], v[96:99], v[160:163]
    ds_read_b64_tr_b16 v[46:47], v19 offset:28672
    ds_read_b64_tr_b16 v[48:49], v20 offset:24576
    v_mfma_f32_16x16x32_bf16 v[176:179], v[208:211], v[100:103], v[176:179]
    ds_read_b64_tr_b16 v[50:51], v20 offset:28672
    v_mfma_f32_16x16x32_bf16 v[180:183], v[212:215], v[100:103], v[180:183]
    ds_read_b64_tr_b16 v[52:53], v21 offset:24576
    v_mfma_f32_16x16x32_bf16 v[164:167], v[212:215], v[96:99], v[164:167]
    ds_read_b64_tr_b16 v[54:55], v21 offset:28672
    s_waitcnt lgkmcnt(8)
    v_mfma_f32_16x16x32_bf16 v[120:123], v[24:27], v[232:235], v[120:123]
    ds_read_b128 v[88:91], v12 offset:20480
    ds_read_b128 v[92:95], v12 offset:22528
    v_mfma_f32_16x16x32_bf16 v[136:139], v[24:27], v[236:239], v[136:139]
    ds_read_b128 v[96:99], v12 offset:21504
    v_mfma_f32_16x16x32_bf16 v[140:143], v[28:31], v[236:239], v[140:143]
    ds_read_b128 v[100:103], v12 offset:23552
    v_mfma_f32_16x16x32_bf16 v[124:127], v[28:31], v[232:235], v[124:127]
    ds_read_b64_tr_b16 v[184:185], v18 offset:32768
    v_and_or_b32 v152, v152, s45, v56
    v_and_or_b32 v154, v154, s45, v56
    v_and_or_b32 v156, v156, s45, v56
    v_and_or_b32 v158, v158, s45, v56
    v_cvt_pk_bf16_f32 v152, v152, v153
    v_cvt_pk_bf16_f32 v153, v154, v155
    v_cvt_pk_bf16_f32 v154, v156, v157
    v_cvt_pk_bf16_f32 v155, v158, v159
    buffer_store_dwordx4 v[152:155], v2, s[24:27], s41 offen offset:0 sc1
    v_and_or_b32 v160, v160, s45, v56
    v_and_or_b32 v162, v162, s45, v56
    v_and_or_b32 v164, v164, s45, v56
    v_and_or_b32 v166, v166, s45, v56
    v_cvt_pk_bf16_f32 v160, v160, v161
    v_cvt_pk_bf16_f32 v161, v162, v163
    v_cvt_pk_bf16_f32 v162, v164, v165
    v_cvt_pk_bf16_f32 v163, v166, v167
    buffer_store_dwordx4 v[160:163], v2, s[24:27], s41 offen offset:1024 sc1
    s_add_u32 s36, s41, 65536
    v_and_or_b32 v168, v168, s45, v56
    v_and_or_b32 v170, v170, s45, v56
    v_and_or_b32 v172, v172, s45, v56
    v_and_or_b32 v174, v174, s45, v56
    v_cvt_pk_bf16_f32 v168, v168, v169
    v_cvt_pk_bf16_f32 v169, v170, v171
    v_cvt_pk_bf16_f32 v170, v172, v173
    v_cvt_pk_bf16_f32 v171, v174, v175
    buffer_store_dwordx4 v[168:171], v2, s[24:27], s36 offen offset:0 sc1
    v_and_or_b32 v176, v176, s45, v56
    v_and_or_b32 v178, v178, s45, v56
    v_and_or_b32 v180, v180, s45, v56
    v_and_or_b32 v182, v182, s45, v56
    v_cvt_pk_bf16_f32 v176, v176, v177
    v_cvt_pk_bf16_f32 v177, v178, v179
    v_cvt_pk_bf16_f32 v178, v180, v181
    v_cvt_pk_bf16_f32 v179, v182, v183
    buffer_store_dwordx4 v[176:179], v2, s[24:27], s36 offen offset:1024 sc1
    v_mfma_f32_16x16x32_bf16 v[128:131], v[32:35], v[232:235], v[128:131]
    ds_read_b64_tr_b16 v[186:187], v18 offset:36864
    ds_read_b64_tr_b16 v[188:189], v19 offset:32768
    v_mfma_f32_16x16x32_bf16 v[144:147], v[32:35], v[236:239], v[144:147]
    ds_read_b64_tr_b16 v[190:191], v19 offset:36864
    v_mfma_f32_16x16x32_bf16 v[148:151], v[36:39], v[236:239], v[148:151]
    ds_read_b64_tr_b16 v[192:193], v20 offset:32768
    v_mfma_f32_16x16x32_bf16 v[132:135], v[36:39], v[232:235], v[132:135]
    ds_read_b64_tr_b16 v[194:195], v20 offset:36864
    s_waitcnt lgkmcnt(10)
    v_mfma_f32_16x16x32_bf16 v[120:123], v[40:43], v[240:243], v[120:123]
    ds_read_b64_tr_b16 v[196:197], v21 offset:32768
    ds_read_b64_tr_b16 v[198:199], v21 offset:36864
    v_mfma_f32_16x16x32_bf16 v[136:139], v[40:43], v[244:247], v[136:139]
    ds_read_b64_tr_b16 v[200:201], v18 offset:40960
    v_mfma_f32_16x16x32_bf16 v[140:143], v[44:47], v[244:247], v[140:143]
    ds_read_b64_tr_b16 v[202:203], v18 offset:45056
    v_mfma_f32_16x16x32_bf16 v[124:127], v[44:47], v[240:243], v[124:127]
    ds_read_b64_tr_b16 v[204:205], v19 offset:40960
    v_mfma_f32_16x16x32_bf16 v[128:131], v[48:51], v[240:243], v[128:131]
    ds_read_b64_tr_b16 v[206:207], v19 offset:45056
    ds_read_b64_tr_b16 v[208:209], v20 offset:40960
    v_mfma_f32_16x16x32_bf16 v[144:147], v[48:51], v[244:247], v[144:147]
    ds_read_b64_tr_b16 v[210:211], v20 offset:45056
    v_mfma_f32_16x16x32_bf16 v[148:151], v[52:55], v[244:247], v[148:151]
    ds_read_b64_tr_b16 v[212:213], v21 offset:40960
    v_mfma_f32_16x16x32_bf16 v[132:135], v[52:55], v[240:243], v[132:135]
    ds_read_b64_tr_b16 v[214:215], v21 offset:45056
    s_waitcnt lgkmcnt(8)
    s_barrier
    v_mfma_f32_16x16x32_bf16 v[120:123], v[184:187], v[88:91], v[120:123]
    ds_read_b128 v[232:235], v12 offset:32768
    ds_read_b128 v[236:239], v12 offset:34816
    v_mfma_f32_16x16x32_bf16 v[136:139], v[184:187], v[92:95], v[136:139]
    ds_read_b128 v[240:243], v12 offset:33792
    v_mfma_f32_16x16x32_bf16 v[140:143], v[188:191], v[92:95], v[140:143]
    ds_read_b128 v[244:247], v12 offset:35840
    v_mfma_f32_16x16x32_bf16 v[124:127], v[188:191], v[88:91], v[124:127]
    ds_read_b64_tr_b16 v[24:25], v13 offset:0
    v_mfma_f32_16x16x32_bf16 v[128:131], v[192:195], v[88:91], v[128:131]
    ds_read_b64_tr_b16 v[26:27], v13 offset:4096
    ds_read_b64_tr_b16 v[28:29], v14 offset:0
    v_mfma_f32_16x16x32_bf16 v[144:147], v[192:195], v[92:95], v[144:147]
    ds_read_b64_tr_b16 v[30:31], v14 offset:4096
    v_mfma_f32_16x16x32_bf16 v[148:151], v[196:199], v[92:95], v[148:151]
    ds_read_b64_tr_b16 v[32:33], v15 offset:0
    v_mfma_f32_16x16x32_bf16 v[132:135], v[196:199], v[88:91], v[132:135]
    ds_read_b64_tr_b16 v[34:35], v15 offset:4096
    s_waitcnt lgkmcnt(10)
    v_mfma_f32_16x16x32_bf16 v[120:123], v[200:203], v[96:99], v[120:123]
    ds_read_b64_tr_b16 v[36:37], v16 offset:0
    ds_read_b64_tr_b16 v[38:39], v16 offset:4096
    v_mfma_f32_16x16x32_bf16 v[136:139], v[200:203], v[100:103], v[136:139]
    ds_read_b64_tr_b16 v[40:41], v13 offset:8192
    v_mfma_f32_16x16x32_bf16 v[140:143], v[204:207], v[100:103], v[140:143]
    ds_read_b64_tr_b16 v[42:43], v13 offset:12288
    v_mfma_f32_16x16x32_bf16 v[124:127], v[204:207], v[96:99], v[124:127]
    ds_read_b64_tr_b16 v[44:45], v14 offset:8192
    v_mfma_f32_16x16x32_bf16 v[128:131], v[208:211], v[96:99], v[128:131]
    ds_read_b64_tr_b16 v[46:47], v14 offset:12288
    ds_read_b64_tr_b16 v[48:49], v15 offset:8192
    v_mfma_f32_16x16x32_bf16 v[144:147], v[208:211], v[100:103], v[144:147]
    ds_read_b64_tr_b16 v[50:51], v15 offset:12288
    v_mfma_f32_16x16x32_bf16 v[148:151], v[212:215], v[100:103], v[148:151]
    ds_read_b64_tr_b16 v[52:53], v16 offset:8192
    v_mfma_f32_16x16x32_bf16 v[132:135], v[212:215], v[96:99], v[132:135]
    ds_read_b64_tr_b16 v[54:55], v16 offset:12288
    s_waitcnt lgkmcnt(8)
    v_mfma_f32_16x16x32_bf16 v[120:123], v[24:27], v[232:235], v[120:123]
    ds_read_b128 v[88:91], v12 offset:36864
    ds_read_b128 v[92:95], v12 offset:38912
    v_mfma_f32_16x16x32_bf16 v[136:139], v[24:27], v[236:239], v[136:139]
    ds_read_b128 v[96:99], v12 offset:37888
    v_mfma_f32_16x16x32_bf16 v[140:143], v[28:31], v[236:239], v[140:143]
    ds_read_b128 v[100:103], v12 offset:39936
    v_mfma_f32_16x16x32_bf16 v[124:127], v[28:31], v[232:235], v[124:127]
    ds_read_b64_tr_b16 v[184:185], v13 offset:16384
    v_mfma_f32_16x16x32_bf16 v[128:131], v[32:35], v[232:235], v[128:131]
    ds_read_b64_tr_b16 v[186:187], v13 offset:20480
    ds_read_b64_tr_b16 v[188:189], v14 offset:16384
    v_mfma_f32_16x16x32_bf16 v[144:147], v[32:35], v[236:239], v[144:147]
    ds_read_b64_tr_b16 v[190:191], v14 offset:20480
    v_mfma_f32_16x16x32_bf16 v[148:151], v[36:39], v[236:239], v[148:151]
    ds_read_b64_tr_b16 v[192:193], v15 offset:16384
    v_mfma_f32_16x16x32_bf16 v[132:135], v[36:39], v[232:235], v[132:135]
    ds_read_b64_tr_b16 v[194:195], v15 offset:20480
    s_waitcnt lgkmcnt(10)
    v_mfma_f32_16x16x32_bf16 v[120:123], v[40:43], v[240:243], v[120:123]
    ds_read_b64_tr_b16 v[196:197], v16 offset:16384
    ds_read_b64_tr_b16 v[198:199], v16 offset:20480
    v_mfma_f32_16x16x32_bf16 v[136:139], v[40:43], v[244:247], v[136:139]
    ds_read_b64_tr_b16 v[200:201], v13 offset:24576
    v_mfma_f32_16x16x32_bf16 v[140:143], v[44:47], v[244:247], v[140:143]
    ds_read_b64_tr_b16 v[202:203], v13 offset:28672
    v_mfma_f32_16x16x32_bf16 v[124:127], v[44:47], v[240:243], v[124:127]
    ds_read_b64_tr_b16 v[204:205], v14 offset:24576
    v_mfma_f32_16x16x32_bf16 v[128:131], v[48:51], v[240:243], v[128:131]
    ds_read_b64_tr_b16 v[206:207], v14 offset:28672
    ds_read_b64_tr_b16 v[208:209], v15 offset:24576
    v_mfma_f32_16x16x32_bf16 v[144:147], v[48:51], v[244:247], v[144:147]
    ds_read_b64_tr_b16 v[210:211], v15 offset:28672
    v_mfma_f32_16x16x32_bf16 v[148:151], v[52:55], v[244:247], v[148:151]
    ds_read_b64_tr_b16 v[212:213], v16 offset:24576
    v_mfma_f32_16x16x32_bf16 v[132:135], v[52:55], v[240:243], v[132:135]
    ds_read_b64_tr_b16 v[214:215], v16 offset:28672
    s_waitcnt lgkmcnt(8)
    s_barrier
    v_mfma_f32_16x16x32_bf16 v[120:123], v[184:187], v[88:91], v[120:123]
    ds_read_b128 v[232:235], v12 offset:0
    ds_read_b128 v[236:239], v12 offset:2048
    v_mfma_f32_16x16x32_bf16 v[136:139], v[184:187], v[92:95], v[136:139]
    ds_read_b128 v[240:243], v12 offset:1024
    v_mfma_f32_16x16x32_bf16 v[140:143], v[188:191], v[92:95], v[140:143]
    ds_read_b128 v[244:247], v12 offset:3072
    v_mfma_f32_16x16x32_bf16 v[124:127], v[188:191], v[88:91], v[124:127]
    ds_read_b64_tr_b16 v[24:25], v13 offset:32768
    v_mfma_f32_16x16x32_bf16 v[128:131], v[192:195], v[88:91], v[128:131]
    ds_read_b64_tr_b16 v[26:27], v13 offset:36864
    ds_read_b64_tr_b16 v[28:29], v14 offset:32768
    v_mfma_f32_16x16x32_bf16 v[144:147], v[192:195], v[92:95], v[144:147]
    ds_read_b64_tr_b16 v[30:31], v14 offset:36864
    v_mfma_f32_16x16x32_bf16 v[148:151], v[196:199], v[92:95], v[148:151]
    ds_read_b64_tr_b16 v[32:33], v15 offset:32768
    v_mfma_f32_16x16x32_bf16 v[132:135], v[196:199], v[88:91], v[132:135]
    ds_read_b64_tr_b16 v[34:35], v15 offset:36864
    s_waitcnt lgkmcnt(10)
    v_mfma_f32_16x16x32_bf16 v[120:123], v[200:203], v[96:99], v[120:123]
    ds_read_b64_tr_b16 v[36:37], v16 offset:32768
    ds_read_b64_tr_b16 v[38:39], v16 offset:36864
    v_mfma_f32_16x16x32_bf16 v[136:139], v[200:203], v[100:103], v[136:139]
    ds_read_b64_tr_b16 v[40:41], v13 offset:40960
    v_mfma_f32_16x16x32_bf16 v[140:143], v[204:207], v[100:103], v[140:143]
    ds_read_b64_tr_b16 v[42:43], v13 offset:45056
    v_mfma_f32_16x16x32_bf16 v[124:127], v[204:207], v[96:99], v[124:127]
    ds_read_b64_tr_b16 v[44:45], v14 offset:40960
    v_mfma_f32_16x16x32_bf16 v[128:131], v[208:211], v[96:99], v[128:131]
    ds_read_b64_tr_b16 v[46:47], v14 offset:45056
    ds_read_b64_tr_b16 v[48:49], v15 offset:40960
    v_mfma_f32_16x16x32_bf16 v[144:147], v[208:211], v[100:103], v[144:147]
    ds_read_b64_tr_b16 v[50:51], v15 offset:45056
    v_mfma_f32_16x16x32_bf16 v[148:151], v[212:215], v[100:103], v[148:151]
    ds_read_b64_tr_b16 v[52:53], v16 offset:40960
    v_mfma_f32_16x16x32_bf16 v[132:135], v[212:215], v[96:99], v[132:135]
    ds_read_b64_tr_b16 v[54:55], v16 offset:45056
    s_waitcnt lgkmcnt(8)
    v_mfma_f32_16x16x32_bf16 v[120:123], v[24:27], v[232:235], v[120:123]
    ds_read_b128 v[88:91], v12 offset:4096
    ds_read_b128 v[92:95], v12 offset:6144
    v_mfma_f32_16x16x32_bf16 v[136:139], v[24:27], v[236:239], v[136:139]
    ds_read_b128 v[96:99], v12 offset:5120
    v_mfma_f32_16x16x32_bf16 v[140:143], v[28:31], v[236:239], v[140:143]
    ds_read_b128 v[100:103], v12 offset:7168
    v_mfma_f32_16x16x32_bf16 v[124:127], v[28:31], v[232:235], v[124:127]
    ds_read_b64_tr_b16 v[184:185], v18 offset:0
    buffer_load_dwordx4 v[152:155], v2, s[24:27], s40 offen offset:0 sc1
    buffer_load_dwordx4 v[156:159], v2, s[24:27], s40 offen offset:1024 sc1
    buffer_load_dwordx4 v[160:163], v2, s[24:27], s44 offen offset:0 sc1
    buffer_load_dwordx4 v[164:167], v2, s[24:27], s44 offen offset:1024 sc1
    v_mfma_f32_16x16x32_bf16 v[128:131], v[32:35], v[232:235], v[128:131]
    ds_read_b64_tr_b16 v[186:187], v18 offset:4096
    ds_read_b64_tr_b16 v[188:189], v19 offset:0
    v_mfma_f32_16x16x32_bf16 v[144:147], v[32:35], v[236:239], v[144:147]
    ds_read_b64_tr_b16 v[190:191], v19 offset:4096
    v_mfma_f32_16x16x32_bf16 v[148:151], v[36:39], v[236:239], v[148:151]
    ds_read_b64_tr_b16 v[192:193], v20 offset:0
    v_mfma_f32_16x16x32_bf16 v[132:135], v[36:39], v[232:235], v[132:135]
    ds_read_b64_tr_b16 v[194:195], v20 offset:4096
    s_waitcnt lgkmcnt(10)
    v_mfma_f32_16x16x32_bf16 v[120:123], v[40:43], v[240:243], v[120:123]
    ds_read_b64_tr_b16 v[196:197], v21 offset:0
    ds_read_b64_tr_b16 v[198:199], v21 offset:4096
    v_mfma_f32_16x16x32_bf16 v[136:139], v[40:43], v[244:247], v[136:139]
    ds_read_b64_tr_b16 v[200:201], v18 offset:8192
    v_mfma_f32_16x16x32_bf16 v[140:143], v[44:47], v[244:247], v[140:143]
    ds_read_b64_tr_b16 v[202:203], v18 offset:12288
    v_mfma_f32_16x16x32_bf16 v[124:127], v[44:47], v[240:243], v[124:127]
    ds_read_b64_tr_b16 v[204:205], v19 offset:8192
    v_mfma_f32_16x16x32_bf16 v[128:131], v[48:51], v[240:243], v[128:131]
    ds_read_b64_tr_b16 v[206:207], v19 offset:12288
    ds_read_b64_tr_b16 v[208:209], v20 offset:8192
    v_mfma_f32_16x16x32_bf16 v[144:147], v[48:51], v[244:247], v[144:147]
    ds_read_b64_tr_b16 v[210:211], v20 offset:12288
    v_mfma_f32_16x16x32_bf16 v[148:151], v[52:55], v[244:247], v[148:151]
    ds_read_b64_tr_b16 v[212:213], v21 offset:8192
    v_mfma_f32_16x16x32_bf16 v[132:135], v[52:55], v[240:243], v[132:135]
    ds_read_b64_tr_b16 v[214:215], v21 offset:12288
    s_waitcnt lgkmcnt(8)
    v_mfma_f32_16x16x32_bf16 v[120:123], v[184:187], v[88:91], v[120:123]
    v_mfma_f32_16x16x32_bf16 v[136:139], v[184:187], v[92:95], v[136:139]
    v_mfma_f32_16x16x32_bf16 v[140:143], v[188:191], v[92:95], v[140:143]
    v_mfma_f32_16x16x32_bf16 v[124:127], v[188:191], v[88:91], v[124:127]
    v_mfma_f32_16x16x32_bf16 v[128:131], v[192:195], v[88:91], v[128:131]
    v_mfma_f32_16x16x32_bf16 v[144:147], v[192:195], v[92:95], v[144:147]
    v_mfma_f32_16x16x32_bf16 v[148:151], v[196:199], v[92:95], v[148:151]
    v_mfma_f32_16x16x32_bf16 v[132:135], v[196:199], v[88:91], v[132:135]
    s_waitcnt lgkmcnt(0)
    s_barrier
    v_mfma_f32_16x16x32_bf16 v[120:123], v[200:203], v[96:99], v[120:123]
    v_mfma_f32_16x16x32_bf16 v[136:139], v[200:203], v[100:103], v[136:139]
    v_mfma_f32_16x16x32_bf16 v[140:143], v[204:207], v[100:103], v[140:143]
    v_mfma_f32_16x16x32_bf16 v[124:127], v[204:207], v[96:99], v[124:127]
    v_mfma_f32_16x16x32_bf16 v[128:131], v[208:211], v[96:99], v[128:131]
    v_mfma_f32_16x16x32_bf16 v[144:147], v[208:211], v[100:103], v[144:147]
    v_mfma_f32_16x16x32_bf16 v[148:151], v[212:215], v[100:103], v[148:151]
    v_mfma_f32_16x16x32_bf16 v[132:135], v[212:215], v[96:99], v[132:135]
    s_mov_b32 s53, 0
dw_22:
    s_waitcnt vmcnt(0)
    v_and_b32 v8, v152, v153
    v_and_b32 v9, v160, v161
    v_bitop3_b32 v8, v154, v155, v8 bitop3:0x80
    v_bitop3_b32 v9, v162, v163, v9 bitop3:0x80
    v_bitop3_b32 v8, v156, v157, v8 bitop3:0x80
    v_bitop3_b32 v9, v164, v165, v9 bitop3:0x80
    v_bitop3_b32 v8, v158, v159, v8 bitop3:0x80
    v_bitop3_b32 v9, v166, v167, v9 bitop3:0x80
    v_bitop3_b32 v8, v8, v9, 1 bitop3:0x80
    v_cmp_eq_u32 vcc, 0, v8
    s_nop 0
    s_cmp_eq_u64 vcc, 0
    s_cbranch_scc1 dok_23
    s_mov_b64 exec, vcc
    s_sleep 1
    buffer_load_dwordx4 v[152:155], v2, s[24:27], s40 offen offset:0 sc1
    buffer_load_dwordx4 v[156:159], v2, s[24:27], s40 offen offset:1024 sc1
    buffer_load_dwordx4 v[160:163], v2, s[24:27], s44 offen offset:0 sc1
    buffer_load_dwordx4 v[164:167], v2, s[24:27], s44 offen offset:1024 sc1
    s_add_u32 s53, s53, 1
    s_cmp_lt_u32 s53, s61
    s_cbranch_scc1 dw_22
    s_mov_b32 s61, 0
    s_waitcnt vmcnt(0)
dok_23:
    s_mov_b64 exec, -1
    v_mfma_f32_16x16x32_bf16 v[120:123], v[226:229], v[152:155], v[120:123]
    v_mfma_f32_16x16x32_bf16 v[124:127], v[224:227], v[152:155], v[124:127]
    v_mfma_f32_16x16x32_bf16 v[128:131], v[226:229], v[156:159], v[128:131]
    v_mfma_f32_16x16x32_bf16 v[132:135], v[224:227], v[156:159], v[132:135]
    v_mfma_f32_16x16x32_bf16 v[136:139], v[226:229], v[160:163], v[136:139]
    v_mfma_f32_16x16x32_bf16 v[140:143], v[224:227], v[160:163], v[140:143]
    v_mfma_f32_16x16x32_bf16 v[144:147], v[226:229], v[164:167], v[144:147]
    v_mfma_f32_16x16x32_bf16 v[148:151], v[224:227], v[164:167], v[148:151]
    s_cmp_eq_u32 s60, 1
    s_cbranch_scc1 G4_last
    v_and_or_b32 v120, v120, s45, v56
    v_and_or_b32 v122, v122, s45, v56
    v_and_or_b32 v124, v124, s45, v56
    v_and_or_b32 v126, v126, s45, v56
    v_cvt_pk_bf16_f32 v120, v120, v121
    v_cvt_pk_bf16_f32 v121, v122, v123
    v_cvt_pk_bf16_f32 v122, v124, v125
    v_cvt_pk_bf16_f32 v123, v126, v127
    buffer_store_dwordx4 v[120:123], v2, s[8:11], s40 offen offset:0 sc1
    v_and_or_b32 v128, v128, s45, v56
    v_and_or_b32 v130, v130, s45, v56
    v_and_or_b32 v132, v132, s45, v56
    v_and_or_b32 v134, v134, s45, v56
    v_cvt_pk_bf16_f32 v128, v128, v129
    v_cvt_pk_bf16_f32 v129, v130, v131
    v_cvt_pk_bf16_f32 v130, v132, v133
    v_cvt_pk_bf16_f32 v131, v134, v135
    buffer_store_dwordx4 v[128:131], v2, s[8:11], s40 offen offset:1024 sc1
    s_add_u32 s36, s40, 65536
    v_and_or_b32 v136, v136, s45, v56
    v_and_or_b32 v138, v138, s45, v56
    v_and_or_b32 v140, v140, s45, v56
    v_and_or_b32 v142, v142, s45, v56
    v_cvt_pk_bf16_f32 v136, v136, v137
    v_cvt_pk_bf16_f32 v137, v138, v139
    v_cvt_pk_bf16_f32 v138, v140, v141
    v_cvt_pk_bf16_f32 v139, v142, v143
    buffer_store_dwordx4 v[136:139], v2, s[8:11], s36 offen offset:0 sc1
    v_and_or_b32 v144, v144, s45, v56
    v_and_or_b32 v146, v146, s45, v56
    v_and_or_b32 v148, v148, s45, v56
    v_and_or_b32 v150, v150, s45, v56
    v_cvt_pk_bf16_f32 v144, v144, v145
    v_cvt_pk_bf16_f32 v145, v146, v147
    v_cvt_pk_bf16_f32 v146, v148, v149
    v_cvt_pk_bf16_f32 v147, v150, v151
    buffer_store_dwordx4 v[144:147], v2, s[8:11], s36 offen offset:1024 sc1
    v_and_b32 v81, 7, v0
    v_lshrrev_b32 v84, 6, v0
    v_lshlrev_b32 v84, 4, v84
    v_bfe_u32 v85, v0, 3, 3
    v_add_u32 v84, v84, v85
    s_lshr_b32 s78, s29, 1
    s_lshl_b32 s78, s78, 16
    s_and_b32 s79, s29, 1
    s_lshl_b32 s79, s79, 7
    s_add_u32 s78, s78, s79
    s_lshr_b32 s79, s30, 1
    s_lshl_b32 s79, s79, 13
    s_add_u32 s78, s78, s79
    v_lshlrev_b32 v78, 8, v84
    v_lshl_add_u32 v78, v81, 4, v78
    v_add_u32 v78, s78, v78
    s_lshl_b32 s78, s28, 7
    s_lshl_b32 s79, s29, 3
    s_add_u32 s78, s78, s79
    v_add_u32 v79, s78, v81
    v_lshlrev_b32 v80, 11, v79
    v_and_b32 v85, 3, v79
    v_lshrrev_b32 v82, 2, v79
    v_lshlrev_b32 v82, 14, v82
    v_lshl_add_u32 v82, v85, 11, v82
    v_lshl_add_u32 v82, v84, 4, v82
    v_lshrrev_b32 v85, 2, v84
    v_lshlrev_b32 v85, 3, v85
    v_and_b32 v84, 3, v84
    v_add_u32 v84, v84, v85
    v_lshl_add_u32 v80, v84, 3, v80
    v_lshlrev_b32 v79, 3, v79
    v_lshl_add_u32 v79, v84, 14, v79
    s_add_u32 s80, s4, 0x1800000
    s_addc_u32 s81, s5, 0
    s_mov_b32 s82, 0x400000
    s_mov_b32 s83, 0x20000
    s_mov_b32 s78, 0
    buffer_load_dwordx2 v[110:111], v79, s[80:83], s78 offen sc1
    s_mov_b32 s78, 65536
    buffer_load_dwordx2 v[112:113], v79, s[80:83], s78 offen sc1
    s_mov_b32 s78, 262144
    buffer_load_dwordx2 v[114:115], v79, s[80:83], s78 offen sc1
    s_mov_b32 s78, 327680
    buffer_load_dwordx2 v[116:117], v79, s[80:83], s78 offen sc1
    s_branch NEXT
G4_last:
    v_cvt_pk_bf16_f32 v120, v120, v121
    v_cvt_pk_bf16_f32 v121, v122, v123
    v_cvt_pk_bf16_f32 v122, v124, v125
    v_cvt_pk_bf16_f32 v123, v126, v127
    s_nop 0
    v_permlane16_swap_b32 v120, v122
    v_permlane16_swap_b32 v121, v123
    v_cvt_pk_bf16_f32 v128, v128, v129
    v_cvt_pk_bf16_f32 v129, v130, v131
    v_cvt_pk_bf16_f32 v130, v132, v133
    v_cvt_pk_bf16_f32 v131, v134, v135
    s_nop 0
    v_permlane16_swap_b32 v128, v130
    v_permlane16_swap_b32 v129, v131
    v_cndmask_b32 v132, v120, v128, s[50:51]
    v_cndmask_b32 v133, v121, v129, s[50:51]
    v_cndmask_b32 v134, v122, v130, s[50:51]
    v_cndmask_b32 v135, v123, v131, s[50:51]
    v_mov_b32_dpp v124, v132 row_ror:8 row_mask:0xf bank_mask:0xf
    v_mov_b32_dpp v125, v133 row_ror:8 row_mask:0xf bank_mask:0xf
    v_mov_b32_dpp v126, v134 row_ror:8 row_mask:0xf bank_mask:0xf
    v_mov_b32_dpp v127, v135 row_ror:8 row_mask:0xf bank_mask:0xf
    v_cndmask_b32 v120, v124, v120, s[50:51]
    v_cndmask_b32 v128, v128, v124, s[50:51]
    v_cndmask_b32 v121, v125, v121, s[50:51]
    v_cndmask_b32 v129, v129, v125, s[50:51]
    v_cndmask_b32 v122, v126, v122, s[50:51]
    v_cndmask_b32 v130, v130, v126, s[50:51]
    v_cndmask_b32 v123, v127, v123, s[50:51]
    v_cndmask_b32 v131, v131, v127, s[50:51]
    buffer_store_dwordx4 v[120:123], v58, s[20:23], s46 offen sc1
    buffer_store_dwordx4 v[128:131], v59, s[20:23], s46 offen sc1
    v_cvt_pk_bf16_f32 v136, v136, v137
    v_cvt_pk_bf16_f32 v137, v138, v139
    v_cvt_pk_bf16_f32 v138, v140, v141
    v_cvt_pk_bf16_f32 v139, v142, v143
    s_nop 0
    v_permlane16_swap_b32 v136, v138
    v_permlane16_swap_b32 v137, v139
    v_cvt_pk_bf16_f32 v144, v144, v145
    v_cvt_pk_bf16_f32 v145, v146, v147
    v_cvt_pk_bf16_f32 v146, v148, v149
    v_cvt_pk_bf16_f32 v147, v150, v151
    s_nop 0
    v_permlane16_swap_b32 v144, v146
    v_permlane16_swap_b32 v145, v147
    v_cndmask_b32 v148, v136, v144, s[50:51]
    v_cndmask_b32 v149, v137, v145, s[50:51]
    v_cndmask_b32 v150, v138, v146, s[50:51]
    v_cndmask_b32 v151, v139, v147, s[50:51]
    v_mov_b32_dpp v140, v148 row_ror:8 row_mask:0xf bank_mask:0xf
    v_mov_b32_dpp v141, v149 row_ror:8 row_mask:0xf bank_mask:0xf
    v_mov_b32_dpp v142, v150 row_ror:8 row_mask:0xf bank_mask:0xf
    v_mov_b32_dpp v143, v151 row_ror:8 row_mask:0xf bank_mask:0xf
    v_cndmask_b32 v136, v140, v136, s[50:51]
    v_cndmask_b32 v144, v144, v140, s[50:51]
    v_cndmask_b32 v137, v141, v137, s[50:51]
    v_cndmask_b32 v145, v145, v141, s[50:51]
    v_cndmask_b32 v138, v142, v138, s[50:51]
    v_cndmask_b32 v146, v146, v142, s[50:51]
    v_cndmask_b32 v139, v143, v139, s[50:51]
    v_cndmask_b32 v147, v147, v143, s[50:51]
    buffer_store_dwordx4 v[136:139], v58, s[20:23], s47 offen sc1
    buffer_store_dwordx4 v[144:147], v59, s[20:23], s47 offen sc1
    s_branch K_fin
LOADERS:
    s_cmp_lg_u32 s60, 0
    s_cbranch_scc1 WY_1
    ds_read_b64_tr_b16 v[128:129], v74 offset:0
    ds_read_b64_tr_b16 v[130:131], v74 offset:2048
    ds_read_b64_tr_b16 v[136:137], v74 offset:4096
    ds_read_b64_tr_b16 v[138:139], v74 offset:6144
    ds_read_b64_tr_b16 v[144:145], v74 offset:8192
    ds_read_b64_tr_b16 v[146:147], v74 offset:10240
    ds_read_b64_tr_b16 v[152:153], v74 offset:12288
    ds_read_b64_tr_b16 v[154:155], v74 offset:14336
    ds_read_b64_tr_b16 v[160:161], v74 offset:16384
    ds_read_b64_tr_b16 v[162:163], v74 offset:18432
    ds_read_b64_tr_b16 v[168:169], v74 offset:20480
    ds_read_b64_tr_b16 v[170:171], v74 offset:22528
    ds_read_b64_tr_b16 v[176:177], v75 offset:16384
    ds_read_b64_tr_b16 v[178:179], v75 offset:18432
    ds_read_b64_tr_b16 v[184:185], v75 offset:20480
    ds_read_b64_tr_b16 v[186:187], v75 offset:22528
    ds_read_b64_tr_b16 v[192:193], v75 offset:24576
    ds_read_b64_tr_b16 v[194:195], v75 offset:26624
    ds_read_b64_tr_b16 v[200:201], v75 offset:28672
    ds_read_b64_tr_b16 v[202:203], v75 offset:30720
    ds_read_b64_tr_b16 v[208:209], v74 offset:32768
    ds_read_b64_tr_b16 v[210:211], v74 offset:34816
    ds_read_b64_tr_b16 v[216:217], v74 offset:36864
    ds_read_b64_tr_b16 v[218:219], v74 offset:38912
    ds_read_b64_tr_b16 v[224:225], v74 offset:40960
    ds_read_b64_tr_b16 v[226:227], v74 offset:43008
    ds_read_b64_tr_b16 v[232:233], v74 offset:45056
    ds_read_b64_tr_b16 v[234:235], v74 offset:47104
    ds_read_b64_tr_b16 v[240:241], v75 offset:32768
    ds_read_b64_tr_b16 v[242:243], v75 offset:34816
    ds_read_b64_tr_b16 v[248:249], v75 offset:36864
    ds_read_b64_tr_b16 v[250:251], v75 offset:38912
    s_mov_b64 s[80:81], s[68:69]
    s_mov_b32 s82, 2097152
    s_mov_b32 s83, 0x20000
    s_waitcnt vmcnt(0) lgkmcnt(0)
    s_barrier
    s_and_b32 s49, s30, 3
    s_lshl_b32 s36, s49, 14
    s_lshl_b32 s48, s29, 7
    s_add_u32 s48, s48, s36
    s_lshl_b32 s49, s49, 10
    s_xor_b32 s48, s48, 128
    s_add_u32 s36, s67, 7
    s_and_b32 s36, s36, 7
    s_lshl_b32 s36, s36, 17
    s_add_u32 s36, s36, s48
    s_add_u32 m0, s49, 81920
    s_nop 0
    buffer_load_dwordx4 v118, s[80:83], s36 offen lds
    s_add_u32 s36, s36, 65536
    s_add_u32 m0, s49, 86016
    s_nop 0
    buffer_load_dwordx4 v118, s[80:83], s36 offen lds
    s_add_u32 s36, s67, 0
    s_and_b32 s36, s36, 7
    s_lshl_b32 s36, s36, 17
    s_add_u32 s36, s36, s48
    s_add_u32 s36, s36, 1048576
    s_add_u32 m0, s49, 90112
    s_nop 0
    buffer_load_dwordx4 v118, s[80:83], s36 offen lds
    s_add_u32 s36, s36, 65536
    s_add_u32 m0, s49, 94208
    s_nop 0
    buffer_load_dwordx4 v118, s[80:83], s36 offen lds
    s_add_u32 s36, s67, 1
    s_and_b32 s36, s36, 7
    s_lshl_b32 s36, s36, 17
    s_add_u32 s36, s36, s48
    s_add_u32 m0, s49, 32768
    s_nop 0
    buffer_load_dwordx4 v118, s[80:83], s36 offen lds
    s_add_u32 s36, s36, 65536
    s_add_u32 m0, s49, 36864
    s_nop 0
    buffer_load_dwordx4 v118, s[80:83], s36 offen lds
    s_add_u32 s36, s67, 2
    s_and_b32 s36, s36, 7
    s_lshl_b32 s36, s36, 17
    s_add_u32 s36, s36, s48
    s_add_u32 m0, s49, 40960
    s_nop 0
    buffer_load_dwordx4 v118, s[80:83], s36 offen lds
    s_add_u32 s36, s36, 65536
    s_add_u32 m0, s49, 45056
    s_nop 0
    buffer_load_dwordx4 v118, s[80:83], s36 offen lds
    s_add_u32 s36, s67, 1
    s_and_b32 s36, s36, 7
    s_lshl_b32 s36, s36, 17
    s_add_u32 s36, s36, s48
    s_add_u32 s36, s36, 1048576
    s_add_u32 m0, s49, 98304
    s_nop 0
    buffer_load_dwordx4 v118, s[80:83], s36 offen lds
    s_add_u32 s36, s36, 65536
    s_add_u32 m0, s49, 102400
    s_nop 0
    buffer_load_dwordx4 v118, s[80:83], s36 offen lds
    s_add_u32 s36, s67, 2
    s_and_b32 s36, s36, 7
    s_lshl_b32 s36, s36, 17
    s_add_u32 s36, s36, s48
    s_add_u32 s36, s36, 1048576
    s_add_u32 m0, s49, 106496
    s_nop 0
    buffer_load_dwordx4 v118, s[80:83], s36 offen lds
    s_add_u32 s36, s36, 65536
    s_add_u32 m0, s49, 110592
    s_nop 0
    buffer_load_dwordx4 v118, s[80:83], s36 offen lds
    s_branch WY_2
WY_1:
    s_mov_b64 s[80:81], s[68:69]
    s_mov_b32 s82, 2097152
    s_mov_b32 s83, 0x20000
    s_and_b32 s49, s30, 3
    s_lshl_b32 s36, s49, 14
    s_lshl_b32 s48, s29, 7
    s_add_u32 s48, s48, s36
    s_lshl_b32 s49, s49, 10
    s_xor_b32 s48, s48, 128
    s_add_u32 s36, s67, 7
    s_and_b32 s36, s36, 7
    s_lshl_b32 s36, s36, 17
    s_add_u32 s36, s36, s48
    s_add_u32 m0, s49, 81920
    s_nop 0
    buffer_load_dwordx4 v118, s[80:83], s36 offen lds
    s_add_u32 s36, s36, 65536
    s_add_u32 m0, s49, 86016
    s_nop 0
    buffer_load_dwordx4 v118, s[80:83], s36 offen lds
    s_add_u32 s36, s67, 0
    s_and_b32 s36, s36, 7
    s_lshl_b32 s36, s36, 17
    s_add_u32 s36, s36, s48
    s_add_u32 s36, s36, 1048576
    s_add_u32 m0, s49, 90112
    s_nop 0
    buffer_load_dwordx4 v118, s[80:83], s36 offen lds
    s_add_u32 s36, s36, 65536
    s_add_u32 m0, s49, 94208
    s_nop 0
    buffer_load_dwordx4 v118, s[80:83], s36 offen lds
    s_add_u32 s36, s67, 1
    s_and_b32 s36, s36, 7
    s_lshl_b32 s36, s36, 17
    s_add_u32 s36, s36, s48
    s_add_u32 m0, s49, 32768
    s_nop 0
    buffer_load_dwordx4 v118, s[80:83], s36 offen lds
    s_add_u32 s36, s36, 65536
    s_add_u32 m0, s49, 36864
    s_nop 0
    buffer_load_dwordx4 v118, s[80:83], s36 offen lds
    s_waitcnt vmcnt(6)
    s_barrier
    s_and_b32 s49, s30, 3
    s_lshl_b32 s36, s49, 14
    s_lshl_b32 s48, s29, 7
    s_add_u32 s48, s48, s36
    s_lshl_b32 s49, s49, 10
    s_xor_b32 s48, s48, 128
    s_add_u32 s36, s67, 2
    s_and_b32 s36, s36, 7
    s_lshl_b32 s36, s36, 17
    s_add_u32 s36, s36, s48
    s_add_u32 m0, s49, 40960
    s_nop 0
    buffer_load_dwordx4 v118, s[80:83], s36 offen lds
    s_add_u32 s36, s36, 65536
    s_add_u32 m0, s49, 45056
    s_nop 0
    buffer_load_dwordx4 v118, s[80:83], s36 offen lds
    s_add_u32 s36, s67, 1
    s_and_b32 s36, s36, 7
    s_lshl_b32 s36, s36, 17
    s_add_u32 s36, s36, s48
    s_add_u32 s36, s36, 1048576
    s_add_u32 m0, s49, 98304
    s_nop 0
    buffer_load_dwordx4 v118, s[80:83], s36 offen lds
    s_add_u32 s36, s36, 65536
    s_add_u32 m0, s49, 102400
    s_nop 0
    buffer_load_dwordx4 v118, s[80:83], s36 offen lds
    s_add_u32 s36, s67, 2
    s_and_b32 s36, s36, 7
    s_lshl_b32 s36, s36, 17
    s_add_u32 s36, s36, s48
    s_add_u32 s36, s36, 1048576
    s_add_u32 m0, s49, 106496
    s_nop 0
    buffer_load_dwordx4 v118, s[80:83], s36 offen lds
    s_add_u32 s36, s36, 65536
    s_add_u32 m0, s49, 110592
    s_nop 0
    buffer_load_dwordx4 v118, s[80:83], s36 offen lds
WY_2:
    v_and_b32 v8, 15, v1
    v_lshrrev_b32 v9, 4, v1
    s_and_b32 s34, s30, 1
    s_and_b32 s37, s30, 3
    s_lshr_b32 s38, s29, 3
    s_add_u32 s38, s38, 1
    s_sub_u32 s39, 0, s38
    s_bitcmp1_b32 s29, 2
    s_cselect_b32 s38, s38, s39
    s_lshl_b32 s48, s28, 7
    s_cmp_lt_u32 s37, 2
    s_cselect_b32 s36, s38, 0
    s_add_u32 s36, s36, s48
    s_lshl_b32 s45, s34, 6
    s_add_u32 s36, s36, s45
    v_add_u32 v72, s36, v1
    s_movk_i32 s45, 2048
    v_cmp_gt_u32 s[46:47], s45, v72
    v_lshlrev_b32 v72, 4, v72
    s_lshl_b32 s22, s60, 15
    s_add_u32 s22, s22, 23199744
    s_add_u32 s20, s4, s22
    s_addc_u32 s21, s5, 0
    s_mov_b32 s22, 32768
    s_mov_b32 s23, 0x20000
    s_lshl_b32 s36, s37, 2
    v_add_u32 v6, s36, v9
    v_xor_b32 v10, v6, v8
    s_add_u32 s36, s48, s38
    s_add_u32 s36, s36, 16
    v_add_u32 v6, s36, v6
    v_and_b32 v7, 3, v6
    v_lshrrev_b32 v11, 2, v6
    v_lshlrev_b32 v11, 14, v11
    v_lshl_add_u32 v11, v7, 11, v11
    v_lshl_add_u32 v11, v10, 4, v11
    v_subrev_u32 v10, 65536, v11
    s_add_u32 s40, s67, 0
    s_and_b32 s40, s40, 6
    s_lshl_b32 s40, s40, 7
    s_add_u32 s41, s67, 2
    s_and_b32 s41, s41, 6
    s_lshl_b32 s41, s41, 7
    s_add_u32 s42, s67, 4
    s_and_b32 s42, s42, 6
    s_lshl_b32 s42, s42, 7
    s_add_u32 s43, s67, 6
    s_and_b32 s43, s43, 6
    s_lshl_b32 s43, s43, 7
    s_lshl_b32 s44, s37, 10
    v_lshrrev_b32 v6, 3, v1
    v_and_b32 v17, 7, v1
    v_xor_b32 v17, v17, v6
    s_lshl_b32 s36, s37, 3
    s_add_u32 s36, s36, s48
    v_add_u32 v6, s36, v6
    v_and_b32 v7, 3, v6
    v_lshrrev_b32 v12, 2, v6
    v_lshlrev_b32 v12, 14, v12
    v_lshl_add_u32 v12, v7, 11, v12
    s_lshl_b32 s36, s29, 7
    v_lshl_add_u32 v12, v17, 4, v12
    v_add_u32 v12, s36, v12
    v_lshrrev_b32 v6, 1, v9
    s_lshl_b32 s36, s37, 1
    v_add_u32 v6, s36, v6
    v_and_b32 v7, 7, v8
    v_xor_b32 v6, v6, v7
    v_lshlrev_b32 v17, 7, v8
    v_lshl_add_u32 v17, v6, 4, v17
    v_and_b32 v6, 1, v9
    v_lshl_add_u32 v17, v6, 3, v17
    v_and_b32 v6, 1, v9
    v_lshlrev_b32 v13, 16, v6
    v_lshrrev_b32 v6, 1, v9
    v_lshl_add_u32 v13, v6, 8, v13
    v_lshl_add_u32 v13, v8, 4, v13
    s_bfe_u32 s36, s30, 0x10001
    s_lshl1_add_u32 s36, s29, s36
    s_lshr_b32 s53, s36, 3
    s_lshl_b32 s53, s53, 14
    s_and_b32 s39, s36, 7
    s_lshl_b32 s39, s39, 10
    s_add_u32 s39, s39, s53
    s_and_b32 s36, s30, 1
    s_lshl_b32 s36, s36, 9
    s_add_u32 s39, s39, s36
    v_mov_b32 v14, v2
    v_add_u32 v15, 106496, v2
    v_lshrrev_b32 v6, 5, v13
    v_and_b32 v6, 2048, v6
    v_and_b32 v16, 511, v13
    v_add_u32 v16, v16, v6
    s_lshl_b32 s36, s37, 9
    v_add_u32 v16, s36, v16
    s_lshl_b32 s14, s60, 24
    s_lshl_b32 s15, s94, 13
    s_add_u32 s14, s14, s15
    s_add_u32 s14, s14, 167772160
    s_add_u32 s12, s4, s14
    s_addc_u32 s13, s5, 0
    s_mov_b32 s14, 8380416
    s_mov_b32 s15, 0x20000
    s_add_u32 s16, s62, 0x400000
    s_addc_u32 s17, s63, 0
    s_mov_b32 s18, 0x7e000
    s_mov_b32 s19, 0x20000
    s_add_u32 s24, s62, 0x480000
    s_addc_u32 s25, s63, 0
    s_mov_b32 s26, 0x7e000
    s_mov_b32 s27, 0x20000
    s_and_b32 s82, s30, 3
    s_lshl_b32 s82, s82, 15
    s_add_u32 s53, s67, 0
    s_and_b32 s78, s53, 4
    s_and_b32 s53, s53, 2
    s_lshl_b32 s78, s78, 12
    s_lshl_b32 s53, s53, 11
    s_add_u32 s78, s78, s53
    s_add_u32 s78, s78, s82
    s_add_u32 s53, s67, 2
    s_and_b32 s79, s53, 4
    s_and_b32 s53, s53, 2
    s_lshl_b32 s79, s79, 12
    s_lshl_b32 s53, s53, 11
    s_add_u32 s79, s79, s53
    s_add_u32 s79, s79, s82
    s_add_u32 s53, s67, 4
    s_and_b32 s80, s53, 4
    s_and_b32 s53, s53, 2
    s_lshl_b32 s80, s80, 12
    s_lshl_b32 s53, s53, 11
    s_add_u32 s80, s80, s53
    s_add_u32 s80, s80, s82
    s_add_u32 s53, s67, 6
    s_and_b32 s81, s53, 4
    s_and_b32 s53, s53, 2
    s_lshl_b32 s81, s81, 12
    s_lshl_b32 s53, s53, 11
    s_add_u32 s81, s81, s53
    s_add_u32 s81, s81, s82
    s_and_b32 s53, s30, 2
    s_lshl_b32 s53, s53, 11
    s_and_b32 s82, s30, 1
    s_lshl_b32 s82, s82, 13
    s_add_u32 s82, s82, s53
    s_and_b32 s84, s30, 1
    s_lshl_b32 s84, s84, 8
    s_add_u32 s84, s84, s55
    s_add_u32 s85, s52, 16
    s_mov_b64 s[8:9], s[72:73]
    s_mov_b32 s10, 7340032
    s_mov_b32 s11, 0x20000
    s_add_u32 s89, s29, 1
    s_and_b32 s89, s89, 15
    s_cmp_lg_u32 s28, s29
    s_cselect_b32 s89, s28, s89
    s_and_b32 s90, s30, 3
    s_mul_i32 s36, s29, 448
    s_lshl2_add_u32 s88, s29, s90
    s_mul_i32 s88, s88, 114688
    s_add_u32 s88, s88, s36
    s_lshl2_add_u32 s89, s89, s90
    s_mul_i32 s89, s89, 114688
    s_add_u32 s89, s89, s36
    s_mul_i32 s90, s90, 7168
    s_waitcnt vmcnt(0) lgkmcnt(0)
    s_barrier
    s_setprio 1
    s_add_u32 m0, s44, 16384
    s_add_u32 s49, s40, 0
    s_barrier
    buffer_load_dwordx4 v[52:55], v72, s[20:23], 0 offen sc1
    buffer_load_dwordx4 v10, s[12:15], s49 offen offset:0 sc1 lds
    s_add_u32 m0, s44, 23552
    s_nop 0
    buffer_load_dwordx4 v10, s[12:15], s49 offen offset:1024 sc1 lds
    s_add_u32 m0, s44, 20480
    s_nop 0
    buffer_load_dwordx4 v11, s[12:15], s49 offen offset:0 sc1 lds
    s_add_u32 m0, s44, 27648
    s_nop 0
    buffer_load_dwordx4 v11, s[12:15], s49 offen offset:1024 sc1 lds
    s_add_u32 m0, s44, 32768
    s_add_u32 s49, s41, 0
    buffer_load_dwordx4 v10, s[12:15], s49 offen offset:0 sc1 lds
    s_add_u32 m0, s44, 39936
    s_nop 0
    buffer_load_dwordx4 v10, s[12:15], s49 offen offset:1024 sc1 lds
    s_add_u32 m0, s44, 36864
    s_nop 0
    buffer_load_dwordx4 v11, s[12:15], s49 offen offset:0 sc1 lds
    s_add_u32 m0, s44, 44032
    s_nop 0
    buffer_load_dwordx4 v11, s[12:15], s49 offen offset:1024 sc1 lds
    s_waitcnt vmcnt(8)
    s_mov_b32 s53, 0
lns_24:
    v_cmp_eq_u32 vcc, s52, v53
    v_cmp_eq_u32 s[50:51], s52, v55
    s_nop 0
    s_and_b64 vcc, vcc, s[50:51]
    s_orn2_b64 vcc, vcc, s[46:47]
    s_cmp_eq_u64 vcc, -1
    s_cbranch_scc1 lnk_25
    buffer_load_dwordx4 v[52:55], v72, s[20:23], 0 offen sc1
    s_waitcnt vmcnt(0)
    s_add_u32 s53, s53, 1
    s_cmp_lt_u32 s53, s61
    s_cbranch_scc1 lns_24
    s_mov_b32 s61, 0
lnk_25:
    v_lshlrev_b32 v56, 16, v52
    v_and_b32 v57, 0xffff0000, v52
    v_lshlrev_b32 v58, 16, v54
    v_and_b32 v59, 0xffff0000, v54
    v_cndmask_b32 v57, 1.0, v57, s[46:47]
    v_cndmask_b32 v59, 1.0, v59, s[46:47]
    s_lshl_b32 s36, s34, 10
    s_add_u32 s36, s36, 155648
    v_add_u32 v6, s36, v2
    s_cmp_ge_u32 s37, 2
    s_cbranch_scc1 lnx_26
    v_mul_f32 v66, v57, v59
    v_fma_f32 v60, -v58, v57, -v56
    v_rcp_f32 v7, v66
    v_mov_b32 v67, v66
    v_mov_b32 v61, v60
    v_mul_f32 v62, 0xc0135761, v7
    v_mul_f32 v7, v7, v7
    v_mov_b32 v63, v62
    v_mul_f32 v7, 0x3d372713, v7
    v_mul_f32 v64, v7, v62
    v_mov_b32 v65, v64
    ds_write_b128 v6, v[60:63] offset:0
    ds_write_b128 v6, v[64:67] offset:2048
    s_branch lnd_27
lnx_26:
    v_rcp_f32 v60, v57
    s_nop 0
    v_mul_f32 v62, -v56, v60
    v_mov_b32 v61, v60
    v_mov_b32 v63, v62
    ds_write_b128 v6, v[60:63] offset:5120
lnd_27:
    v_lshlrev_b32 v7, 4, v8
    v_add_u32 v7, 160768, v7
    s_add_u32 m0, s44, 106496
    s_add_u32 s49, s42, 0
    buffer_load_dwordx4 v10, s[12:15], s49 offen offset:0 sc1 lds
    s_add_u32 m0, s44, 113664
    s_nop 0
    buffer_load_dwordx4 v10, s[12:15], s49 offen offset:1024 sc1 lds
    s_add_u32 m0, s44, 110592
    s_nop 0
    buffer_load_dwordx4 v11, s[12:15], s49 offen offset:0 sc1 lds
    s_add_u32 m0, s44, 117760
    s_nop 0
    buffer_load_dwordx4 v11, s[12:15], s49 offen offset:1024 sc1 lds
    s_add_u32 m0, s44, 122880
    s_add_u32 s49, s43, 0
    s_waitcnt vmcnt(8)
    s_barrier
    buffer_load_dwordx4 v10, s[12:15], s49 offen offset:0 sc1 lds
    s_add_u32 m0, s44, 130048
    s_nop 0
    buffer_load_dwordx4 v10, s[12:15], s49 offen offset:1024 sc1 lds
    s_add_u32 m0, s44, 126976
    s_nop 0
    buffer_load_dwordx4 v11, s[12:15], s49 offen offset:0 sc1 lds
    s_add_u32 m0, s44, 134144
    s_nop 0
    buffer_load_dwordx4 v11, s[12:15], s49 offen offset:1024 sc1 lds
    v_mov_b32 v10, v11
    v_add_u32 v11, 65536, v11
    s_add_u32 m0, s44, 139264
    s_add_u32 s49, s40, 65536
    s_waitcnt vmcnt(8)
    s_barrier
    buffer_load_dwordx4 v10, s[12:15], s49 offen offset:0 sc1 lds
    s_add_u32 m0, s44, 146432
    s_nop 0
    buffer_load_dwordx4 v10, s[12:15], s49 offen offset:1024 sc1 lds
    s_add_u32 m0, s44, 143360
    s_nop 0
    buffer_load_dwordx4 v11, s[12:15], s49 offen offset:0 sc1 lds
    s_add_u32 m0, s44, 150528
    s_nop 0
    buffer_load_dwordx4 v11, s[12:15], s49 offen offset:1024 sc1 lds
    s_add_u32 m0, s44, 16384
    s_add_u32 s49, s41, 65536
    s_waitcnt vmcnt(8)
    s_barrier
    buffer_load_dwordx4 v10, s[12:15], s49 offen offset:0 sc1 lds
    s_add_u32 m0, s44, 23552
    s_nop 0
    buffer_load_dwordx4 v10, s[12:15], s49 offen offset:1024 sc1 lds
    s_add_u32 m0, s44, 20480
    s_nop 0
    buffer_load_dwordx4 v11, s[12:15], s49 offen offset:0 sc1 lds
    s_add_u32 m0, s44, 27648
    s_nop 0
    buffer_load_dwordx4 v11, s[12:15], s49 offen offset:1024 sc1 lds
    s_add_u32 m0, s44, 32768
    s_add_u32 s49, s42, 65536
    s_waitcnt vmcnt(8)
    s_barrier
    buffer_load_dwordx4 v10, s[12:15], s49 offen offset:0 sc1 lds
    s_add_u32 m0, s44, 39936
    s_nop 0
    buffer_load_dwordx4 v10, s[12:15], s49 offen offset:1024 sc1 lds
    s_add_u32 m0, s44, 36864
    s_nop 0
    buffer_load_dwordx4 v11, s[12:15], s49 offen offset:0 sc1 lds
    s_add_u32 m0, s44, 44032
    s_nop 0
    buffer_load_dwordx4 v11, s[12:15], s49 offen offset:1024 sc1 lds
    s_waitcnt lgkmcnt(0)
    s_add_u32 m0, s44, 106496
    s_add_u32 s49, s43, 65536
    s_waitcnt vmcnt(8)
    s_barrier
    buffer_load_dwordx4 v10, s[12:15], s49 offen offset:0 sc1 lds
    s_add_u32 m0, s44, 113664
    s_nop 0
    buffer_load_dwordx4 v10, s[12:15], s49 offen offset:1024 sc1 lds
    s_add_u32 m0, s44, 110592
    s_nop 0
    buffer_load_dwordx4 v11, s[12:15], s49 offen offset:0 sc1 lds
    s_add_u32 m0, s44, 117760
    s_nop 0
    buffer_load_dwordx4 v11, s[12:15], s49 offen offset:1024 sc1 lds
    s_add_u32 m0, s44, 0
    s_mov_b32 s36, 0
    buffer_load_dwordx4 v12, s[12:15], s36 offen sc1 lds
    s_add_u32 m0, s44, 4096
    s_mov_b32 s36, 131072
    buffer_load_dwordx4 v12, s[12:15], s36 offen sc1 lds
    s_add_u32 m0, s44, 8192
    s_mov_b32 s36, 262144
    buffer_load_dwordx4 v12, s[12:15], s36 offen sc1 lds
    s_add_u32 m0, s44, 12288
    s_mov_b32 s36, 393216
    buffer_load_dwordx4 v12, s[12:15], s36 offen sc1 lds
    s_add_u32 m0, s90, 77824
    s_nop 0
    buffer_load_dwordx4 v121, s[8:11], s89 offen lds
    s_add_u32 m0, s90, 78848
    s_nop 0
    buffer_load_dwordx4 v122, s[8:11], s89 offen lds
    s_add_u32 m0, s44, 122880
    s_add_u32 s49, s40, 196608
    s_waitcnt vmcnt(14)
    s_barrier
    buffer_load_dwordx4 v10, s[12:15], s49 offen offset:0 sc1 lds
    s_add_u32 m0, s44, 130048
    s_nop 0
    buffer_load_dwordx4 v10, s[12:15], s49 offen offset:1024 sc1 lds
    s_add_u32 m0, s44, 126976
    s_nop 0
    buffer_load_dwordx4 v11, s[12:15], s49 offen offset:0 sc1 lds
    s_add_u32 m0, s44, 134144
    s_nop 0
    buffer_load_dwordx4 v11, s[12:15], s49 offen offset:1024 sc1 lds
    s_add_u32 m0, s44, 139264
    s_add_u32 s49, s41, 196608
    s_waitcnt vmcnt(14)
    s_barrier
    buffer_load_dwordx4 v10, s[12:15], s49 offen offset:0 sc1 lds
    s_add_u32 m0, s44, 146432
    s_nop 0
    buffer_load_dwordx4 v10, s[12:15], s49 offen offset:1024 sc1 lds
    s_add_u32 m0, s44, 143360
    s_nop 0
    buffer_load_dwordx4 v11, s[12:15], s49 offen offset:0 sc1 lds
    s_add_u32 m0, s44, 150528
    s_nop 0
    buffer_load_dwordx4 v11, s[12:15], s49 offen offset:1024 sc1 lds
    s_add_u32 m0, s44, 16384
    s_add_u32 s49, s42, 196608
    s_waitcnt vmcnt(10)
    s_barrier
    buffer_load_dwordx4 v10, s[12:15], s49 offen offset:0 sc1 lds
    s_add_u32 m0, s44, 23552
    s_nop 0
    buffer_load_dwordx4 v10, s[12:15], s49 offen offset:1024 sc1 lds
    s_add_u32 m0, s44, 20480
    s_nop 0
    buffer_load_dwordx4 v11, s[12:15], s49 offen offset:0 sc1 lds
    s_add_u32 m0, s44, 27648
    s_nop 0
    buffer_load_dwordx4 v11, s[12:15], s49 offen offset:1024 sc1 lds
    ds_read_b64 v[22:23], v17 offset:0
    ds_read_b128 v[60:63], v7 offset:0
    ds_read_b64 v[26:27], v17 offset:2048
    ds_read_b128 v[64:67], v7 offset:256
    s_add_u32 m0, s44, 32768
    s_add_u32 s49, s43, 196608
    s_waitcnt vmcnt(8)
    s_barrier
    buffer_load_dwordx4 v10, s[12:15], s49 offen offset:0 sc1 lds
    s_waitcnt lgkmcnt(0)
    v_lshlrev_b32 v20, 16, v22
    v_and_b32 v21, 0xffff0000, v22
    v_lshlrev_b32 v22, 16, v23
    v_and_b32 v23, 0xffff0000, v23
    s_add_u32 m0, s44, 39936
    s_nop 0
    buffer_load_dwordx4 v10, s[12:15], s49 offen offset:1024 sc1 lds
    v_pk_fma_f32 v[20:21], v[20:21], v[60:61], v[62:63]
    v_pk_fma_f32 v[22:23], v[22:23], v[60:61], v[62:63]
    v_lshlrev_b32 v24, 16, v26
    v_and_b32 v25, 0xffff0000, v26
    v_lshlrev_b32 v26, 16, v27
    s_add_u32 m0, s44, 36864
    s_nop 0
    buffer_load_dwordx4 v11, s[12:15], s49 offen offset:0 sc1 lds
    v_and_b32 v27, 0xffff0000, v27
    v_pk_fma_f32 v[24:25], v[24:25], v[64:65], v[66:67]
    v_pk_fma_f32 v[26:27], v[26:27], v[64:65], v[66:67]
    s_add_u32 m0, s44, 44032
    s_nop 0
    buffer_load_dwordx4 v11, s[12:15], s49 offen offset:1024 sc1 lds
    ds_read_b64 v[30:31], v17 offset:4096
    ds_read_b128 v[60:63], v7 offset:512
    ds_read_b64 v[34:35], v17 offset:6144
    ds_read_b128 v[64:67], v7 offset:768
    s_add_u32 m0, s90, 79872
    s_nop 0
    buffer_load_dwordx4 v123, s[8:11], s89 offen lds
    s_add_u32 m0, s90, 80896
    s_nop 0
    buffer_load_dwordx4 v124, s[8:11], s89 offen lds
    s_add_u32 m0, s90, 81920
    s_nop 0
    buffer_load_dwordx4 v125, s[8:11], s89 offen lds
    s_add_u32 m0, s90, 82944
    s_nop 0
    buffer_load_dwordx4 v126, s[8:11], s89 offen lds
    s_add_u32 m0, s90, 83968
    s_nop 0
    buffer_load_dwordx4 v127, s[8:11], s89 offen lds
    s_add_u32 m0, s90, 49152
    s_nop 0
    buffer_load_dwordx4 v121, s[8:11], s88 offen lds
    s_add_u32 m0, s44, 106496
    s_add_u32 s49, s40, 327680
    s_waitcnt vmcnt(14)
    s_barrier
    buffer_load_dwordx4 v10, s[12:15], s49 offen offset:0 sc1 lds
    s_waitcnt lgkmcnt(0)
    v_lshlrev_b32 v28, 16, v30
    v_and_b32 v29, 0xffff0000, v30
    v_lshlrev_b32 v30, 16, v31
    v_and_b32 v31, 0xffff0000, v31
    s_add_u32 m0, s44, 113664
    s_nop 0
    buffer_load_dwordx4 v10, s[12:15], s49 offen offset:1024 sc1 lds
    v_pk_fma_f32 v[28:29], v[28:29], v[60:61], v[62:63]
    v_pk_fma_f32 v[30:31], v[30:31], v[60:61], v[62:63]
    v_lshlrev_b32 v32, 16, v34
    v_and_b32 v33, 0xffff0000, v34
    v_lshlrev_b32 v34, 16, v35
    s_add_u32 m0, s44, 110592
    s_nop 0
    buffer_load_dwordx4 v11, s[12:15], s49 offen offset:0 sc1 lds
    v_and_b32 v35, 0xffff0000, v35
    v_pk_fma_f32 v[32:33], v[32:33], v[64:65], v[66:67]
    v_pk_fma_f32 v[34:35], v[34:35], v[64:65], v[66:67]
    s_add_u32 m0, s44, 117760
    s_nop 0
    buffer_load_dwordx4 v11, s[12:15], s49 offen offset:1024 sc1 lds
    ds_read_b64 v[38:39], v17 offset:8192
    ds_read_b128 v[60:63], v7 offset:1024
    ds_read_b64 v[42:43], v17 offset:10240
    ds_read_b128 v[64:67], v7 offset:1280
    s_add_u32 m0, s44, 122880
    s_add_u32 s49, s41, 327680
    s_waitcnt vmcnt(14)
    s_barrier
    buffer_load_dwordx4 v10, s[12:15], s49 offen offset:0 sc1 lds
    s_waitcnt lgkmcnt(0)
    v_lshlrev_b32 v36, 16, v38
    v_and_b32 v37, 0xffff0000, v38
    v_lshlrev_b32 v38, 16, v39
    v_and_b32 v39, 0xffff0000, v39
    s_add_u32 m0, s44, 130048
    s_nop 0
    buffer_load_dwordx4 v10, s[12:15], s49 offen offset:1024 sc1 lds
    v_pk_fma_f32 v[36:37], v[36:37], v[60:61], v[62:63]
    v_pk_fma_f32 v[38:39], v[38:39], v[60:61], v[62:63]
    v_lshlrev_b32 v40, 16, v42
    v_and_b32 v41, 0xffff0000, v42
    v_lshlrev_b32 v42, 16, v43
    s_add_u32 m0, s44, 126976
    s_nop 0
    buffer_load_dwordx4 v11, s[12:15], s49 offen offset:0 sc1 lds
    v_and_b32 v43, 0xffff0000, v43
    v_pk_fma_f32 v[40:41], v[40:41], v[64:65], v[66:67]
    v_pk_fma_f32 v[42:43], v[42:43], v[64:65], v[66:67]
    s_add_u32 m0, s44, 134144
    s_nop 0
    buffer_load_dwordx4 v11, s[12:15], s49 offen offset:1024 sc1 lds
    ds_read_b64 v[46:47], v17 offset:12288
    ds_read_b128 v[60:63], v7 offset:1536
    ds_read_b64 v[50:51], v17 offset:14336
    ds_read_b128 v[64:67], v7 offset:1792
    s_add_u32 m0, s44, 139264
    s_add_u32 s49, s42, 327680
    s_waitcnt vmcnt(14)
    s_barrier
    buffer_load_dwordx4 v10, s[12:15], s49 offen offset:0 sc1 lds
    s_waitcnt lgkmcnt(0)
    v_lshlrev_b32 v44, 16, v46
    v_and_b32 v45, 0xffff0000, v46
    v_lshlrev_b32 v46, 16, v47
    v_and_b32 v47, 0xffff0000, v47
    s_add_u32 m0, s44, 146432
    s_nop 0
    buffer_load_dwordx4 v10, s[12:15], s49 offen offset:1024 sc1 lds
    v_pk_fma_f32 v[44:45], v[44:45], v[60:61], v[62:63]
    v_pk_fma_f32 v[46:47], v[46:47], v[60:61], v[62:63]
    v_lshlrev_b32 v48, 16, v50
    v_and_b32 v49, 0xffff0000, v50
    v_lshlrev_b32 v50, 16, v51
    s_add_u32 m0, s44, 143360
    s_nop 0
    buffer_load_dwordx4 v11, s[12:15], s49 offen offset:0 sc1 lds
    v_and_b32 v51, 0xffff0000, v51
    v_pk_fma_f32 v[48:49], v[48:49], v[64:65], v[66:67]
    v_pk_fma_f32 v[50:51], v[50:51], v[64:65], v[66:67]
    s_add_u32 m0, s44, 150528
    s_nop 0
    buffer_load_dwordx4 v11, s[12:15], s49 offen offset:1024 sc1 lds
    s_add_u32 m0, s44, 16384
    s_add_u32 s49, s43, 327680
    s_waitcnt vmcnt(8)
    s_barrier
    s_load_dword s32, s[4:5], s84 offset:2048
    s_load_dword s3, s[4:5], s84 offset:2176
    buffer_load_dwordx4 v10, s[12:15], s49 offen offset:0 sc1 lds
    s_add_u32 m0, s44, 23552
    s_nop 0
    buffer_load_dwordx4 v10, s[12:15], s49 offen offset:1024 sc1 lds
    s_add_u32 m0, s44, 20480
    s_nop 0
    buffer_load_dwordx4 v11, s[12:15], s49 offen offset:0 sc1 lds
    s_add_u32 m0, s44, 27648
    s_nop 0
    buffer_load_dwordx4 v11, s[12:15], s49 offen offset:1024 sc1 lds
    s_add_u32 m0, s90, 50176
    s_nop 0
    buffer_load_dwordx4 v122, s[8:11], s88 offen lds
    s_add_u32 m0, s90, 51200
    s_nop 0
    buffer_load_dwordx4 v123, s[8:11], s88 offen lds
    s_add_u32 m0, s90, 52224
    s_nop 0
    buffer_load_dwordx4 v124, s[8:11], s88 offen lds
    s_add_u32 m0, s90, 53248
    s_nop 0
    buffer_load_dwordx4 v125, s[8:11], s88 offen lds
    s_add_u32 m0, s90, 54272
    s_nop 0
    buffer_load_dwordx4 v126, s[8:11], s88 offen lds
    s_add_u32 m0, s90, 55296
    s_nop 0
    buffer_load_dwordx4 v127, s[8:11], s88 offen lds
    s_add_u32 m0, s82, 32768
    s_add_u32 s49, s78, 0
    s_waitcnt vmcnt(14)
    s_barrier
    s_waitcnt lgkmcnt(0)
    s_cmp_eq_u32 s32, s85
    s_cselect_b32 s32, s3, 0
    s_cmp_eq_u32 s32, s85
    s_cbranch_scc1 hok_28
    s_add_u32 s53, s84, 2048
    v_lshlrev_b32 v109, 7, v1
    v_add_u32 v109, s53, v109
    s_mov_b32 s53, 0
    s_add_u32 s54, s52, 16
    s_bfm_b64 exec, 2, 0
poll_29:
    buffer_load_dword v108, v109, s[56:59], 0 offen sc1
    s_waitcnt vmcnt(0)
    v_cmp_eq_u32 vcc, s54, v108
    s_nop 0
    s_cmp_eq_u64 vcc, exec
    s_cbranch_scc1 pok_30
    s_sleep 8
    s_add_u32 s53, s53, 1
    s_cmp_lt_u32 s53, s61
    s_cbranch_scc1 poll_29
    s_mov_b32 s61, 0
pok_30:
    s_mov_b64 exec, -1
hok_28:
    buffer_load_dwordx4 v2, s[16:19], s49 offen offset:0 sc1 lds
    buffer_load_dwordx4 v2, s[16:19], s49 offen offset:1024 sc1 lds
    buffer_load_dwordx4 v2, s[16:19], s49 offen offset:2048 sc1 lds
    buffer_load_dwordx4 v2, s[16:19], s49 offen offset:3072 sc1 lds
    s_add_u32 m0, s82, 106496
    s_add_u32 s49, s79, 0
    s_waitcnt vmcnt(14)
    s_barrier
    buffer_load_dwordx4 v2, s[16:19], s49 offen offset:0 sc1 lds
    buffer_load_dwordx4 v2, s[16:19], s49 offen offset:1024 sc1 lds
    buffer_load_dwordx4 v2, s[16:19], s49 offen offset:2048 sc1 lds
    buffer_load_dwordx4 v2, s[16:19], s49 offen offset:3072 sc1 lds
    s_add_u32 m0, s82, 122880
    s_add_u32 s49, s80, 0
    s_waitcnt vmcnt(14)
    s_barrier
    buffer_load_dwordx4 v2, s[16:19], s49 offen offset:0 sc1 lds
    buffer_load_dwordx4 v2, s[16:19], s49 offen offset:1024 sc1 lds
    buffer_load_dwordx4 v2, s[16:19], s49 offen offset:2048 sc1 lds
    buffer_load_dwordx4 v2, s[16:19], s49 offen offset:3072 sc1 lds
    s_setprio 0
    s_waitcnt vmcnt(8)
    s_barrier
    ds_read_b128 v[52:55], v14 offset:32768
    ds_read_b128 v[56:59], v14 offset:36864
    ds_read_b128 v[60:63], v14 offset:40960
    ds_read_b128 v[64:67], v14 offset:45056
    ds_read_b128 v[68:71], v14 offset:33792
    ds_read_b128 v[72:75], v14 offset:37888
    ds_read_b128 v[76:79], v14 offset:41984
    ds_read_b128 v[80:83], v14 offset:46080
    s_waitcnt lgkmcnt(4)
    v_mfma_f32_16x16x32_bf16 v[20:23], v[128:131], v[52:55], v[20:23]
    ds_read_b128 v[84:87], v14 offset:34816
    v_mfma_f32_16x16x32_bf16 v[24:27], v[128:131], v[56:59], v[24:27]
    ds_read_b128 v[88:91], v14 offset:38912
    v_mfma_f32_16x16x32_bf16 v[24:27], v[132:135], v[64:67], v[24:27]
    ds_read_b128 v[92:95], v14 offset:43008
    v_mfma_f32_16x16x32_bf16 v[20:23], v[132:135], v[60:63], v[20:23]
    ds_read_b128 v[96:99], v14 offset:47104
    s_waitcnt lgkmcnt(4)
    v_mfma_f32_16x16x32_bf16 v[20:23], v[136:139], v[68:71], v[20:23]
    ds_read_b128 v[52:55], v14 offset:35840
    v_mfma_f32_16x16x32_bf16 v[24:27], v[136:139], v[72:75], v[24:27]
    ds_read_b128 v[56:59], v14 offset:39936
    v_mfma_f32_16x16x32_bf16 v[24:27], v[140:143], v[80:83], v[24:27]
    ds_read_b128 v[60:63], v14 offset:44032
    v_mfma_f32_16x16x32_bf16 v[20:23], v[140:143], v[76:79], v[20:23]
    ds_read_b128 v[64:67], v14 offset:48128
    s_waitcnt vmcnt(4)
    s_barrier
    s_waitcnt lgkmcnt(4)
    v_mfma_f32_16x16x32_bf16 v[20:23], v[144:147], v[84:87], v[20:23]
    ds_read_b128 v[68:71], v15 offset:0
    v_mfma_f32_16x16x32_bf16 v[24:27], v[144:147], v[88:91], v[24:27]
    ds_read_b128 v[72:75], v15 offset:4096
    v_mfma_f32_16x16x32_bf16 v[24:27], v[148:151], v[96:99], v[24:27]
    ds_read_b128 v[76:79], v15 offset:8192
    v_mfma_f32_16x16x32_bf16 v[20:23], v[148:151], v[92:95], v[20:23]
    ds_read_b128 v[80:83], v15 offset:12288
    s_waitcnt lgkmcnt(4)
    v_mfma_f32_16x16x32_bf16 v[20:23], v[152:155], v[52:55], v[20:23]
    ds_read_b128 v[84:87], v15 offset:1024
    v_mfma_f32_16x16x32_bf16 v[24:27], v[152:155], v[56:59], v[24:27]
    ds_read_b128 v[88:91], v15 offset:5120
    v_mfma_f32_16x16x32_bf16 v[24:27], v[156:159], v[64:67], v[24:27]
    ds_read_b128 v[92:95], v15 offset:9216
    v_mfma_f32_16x16x32_bf16 v[20:23], v[156:159], v[60:63], v[20:23]
    ds_read_b128 v[96:99], v15 offset:13312
    s_waitcnt lgkmcnt(4)
    v_mfma_f32_16x16x32_bf16 v[20:23], v[160:163], v[68:71], v[20:23]
    ds_read_b128 v[52:55], v15 offset:2048
    v_mfma_f32_16x16x32_bf16 v[24:27], v[160:163], v[72:75], v[24:27]
    ds_read_b128 v[56:59], v15 offset:6144
    v_mfma_f32_16x16x32_bf16 v[24:27], v[164:167], v[80:83], v[24:27]
    ds_read_b128 v[60:63], v15 offset:10240
    v_mfma_f32_16x16x32_bf16 v[20:23], v[164:167], v[76:79], v[20:23]
    ds_read_b128 v[64:67], v15 offset:14336
    s_waitcnt lgkmcnt(4)
    v_mfma_f32_16x16x32_bf16 v[20:23], v[168:171], v[84:87], v[20:23]
    ds_read_b128 v[68:71], v15 offset:3072
    v_mfma_f32_16x16x32_bf16 v[24:27], v[168:171], v[88:91], v[24:27]
    ds_read_b128 v[72:75], v15 offset:7168
    v_mfma_f32_16x16x32_bf16 v[24:27], v[172:175], v[96:99], v[24:27]
    ds_read_b128 v[76:79], v15 offset:11264
    v_mfma_f32_16x16x32_bf16 v[20:23], v[172:175], v[92:95], v[20:23]
    ds_read_b128 v[80:83], v15 offset:15360
    s_waitcnt vmcnt(0)
    s_barrier
    s_waitcnt lgkmcnt(4)
    v_mfma_f32_16x16x32_bf16 v[20:23], v[176:179], v[52:55], v[20:23]
    ds_read_b128 v[84:87], v15 offset:16384
    v_mfma_f32_16x16x32_bf16 v[24:27], v[176:179], v[56:59], v[24:27]
    ds_read_b128 v[88:91], v15 offset:20480
    v_mfma_f32_16x16x32_bf16 v[24:27], v[180:183], v[64:67], v[24:27]
    ds_read_b128 v[92:95], v15 offset:24576
    v_mfma_f32_16x16x32_bf16 v[20:23], v[180:183], v[60:63], v[20:23]
    ds_read_b128 v[96:99], v15 offset:28672
    s_waitcnt lgkmcnt(4)
    v_mfma_f32_16x16x32_bf16 v[20:23], v[184:187], v[68:71], v[20:23]
    ds_read_b128 v[52:55], v15 offset:17408
    v_mfma_f32_16x16x32_bf16 v[24:27], v[184:187], v[72:75], v[24:27]
    ds_read_b128 v[56:59], v15 offset:21504
    v_mfma_f32_16x16x32_bf16 v[24:27], v[188:191], v[80:83], v[24:27]
    ds_read_b128 v[60:63], v15 offset:25600
    v_mfma_f32_16x16x32_bf16 v[20:23], v[188:191], v[76:79], v[20:23]
    ds_read_b128 v[64:67], v15 offset:29696
    s_waitcnt lgkmcnt(4)
    v_mfma_f32_16x16x32_bf16 v[20:23], v[192:195], v[84:87], v[20:23]
    ds_read_b128 v[68:71], v15 offset:18432
    v_mfma_f32_16x16x32_bf16 v[24:27], v[192:195], v[88:91], v[24:27]
    ds_read_b128 v[72:75], v15 offset:22528
    v_mfma_f32_16x16x32_bf16 v[24:27], v[196:199], v[96:99], v[24:27]
    ds_read_b128 v[76:79], v15 offset:26624
    v_mfma_f32_16x16x32_bf16 v[20:23], v[196:199], v[92:95], v[20:23]
    ds_read_b128 v[80:83], v15 offset:30720
    s_waitcnt lgkmcnt(4)
    v_mfma_f32_16x16x32_bf16 v[20:23], v[200:203], v[52:55], v[20:23]
    ds_read_b128 v[84:87], v15 offset:19456
    v_mfma_f32_16x16x32_bf16 v[24:27], v[200:203], v[56:59], v[24:27]
    ds_read_b128 v[88:91], v15 offset:23552
    v_mfma_f32_16x16x32_bf16 v[24:27], v[204:207], v[64:67], v[24:27]
    ds_read_b128 v[92:95], v15 offset:27648
    v_mfma_f32_16x16x32_bf16 v[20:23], v[204:207], v[60:63], v[20:23]
    ds_read_b128 v[96:99], v15 offset:31744
    s_barrier
    s_waitcnt lgkmcnt(4)
    v_mfma_f32_16x16x32_bf16 v[20:23], v[208:211], v[68:71], v[20:23]
    ds_read_b128 v[52:55], v15 offset:32768
    v_mfma_f32_16x16x32_bf16 v[24:27], v[208:211], v[72:75], v[24:27]
    ds_read_b128 v[56:59], v15 offset:36864
    v_mfma_f32_16x16x32_bf16 v[24:27], v[212:215], v[80:83], v[24:27]
    ds_read_b128 v[60:63], v15 offset:40960
    v_mfma_f32_16x16x32_bf16 v[20:23], v[212:215], v[76:79], v[20:23]
    ds_read_b128 v[64:67], v15 offset:45056
    s_waitcnt lgkmcnt(4)
    v_mfma_f32_16x16x32_bf16 v[20:23], v[216:219], v[84:87], v[20:23]
    ds_read_b128 v[68:71], v15 offset:33792
    v_mfma_f32_16x16x32_bf16 v[24:27], v[216:219], v[88:91], v[24:27]
    ds_read_b128 v[72:75], v15 offset:37888
    v_mfma_f32_16x16x32_bf16 v[24:27], v[220:223], v[96:99], v[24:27]
    ds_read_b128 v[76:79], v15 offset:41984
    v_mfma_f32_16x16x32_bf16 v[20:23], v[220:223], v[92:95], v[20:23]
    ds_read_b128 v[80:83], v15 offset:46080
    s_waitcnt lgkmcnt(4)
    v_mfma_f32_16x16x32_bf16 v[20:23], v[224:227], v[52:55], v[20:23]
    ds_read_b128 v[84:87], v15 offset:34816
    v_mfma_f32_16x16x32_bf16 v[24:27], v[224:227], v[56:59], v[24:27]
    ds_read_b128 v[88:91], v15 offset:38912
    v_mfma_f32_16x16x32_bf16 v[24:27], v[228:231], v[64:67], v[24:27]
    ds_read_b128 v[92:95], v15 offset:43008
    v_mfma_f32_16x16x32_bf16 v[20:23], v[228:231], v[60:63], v[20:23]
    ds_read_b128 v[96:99], v15 offset:47104
    s_waitcnt lgkmcnt(4)
    v_mfma_f32_16x16x32_bf16 v[20:23], v[232:235], v[68:71], v[20:23]
    ds_read_b128 v[52:55], v15 offset:35840
    v_mfma_f32_16x16x32_bf16 v[24:27], v[232:235], v[72:75], v[24:27]
    ds_read_b128 v[56:59], v15 offset:39936
    v_mfma_f32_16x16x32_bf16 v[24:27], v[236:239], v[80:83], v[24:27]
    ds_read_b128 v[60:63], v15 offset:44032
    v_mfma_f32_16x16x32_bf16 v[20:23], v[236:239], v[76:79], v[20:23]
    ds_read_b128 v[64:67], v15 offset:48128
    s_barrier
    s_waitcnt lgkmcnt(4)
    v_mfma_f32_16x16x32_bf16 v[20:23], v[240:243], v[84:87], v[20:23]
    ds_read_b128 v[68:71], v14 offset:16384
    v_mfma_f32_16x16x32_bf16 v[24:27], v[240:243], v[88:91], v[24:27]
    ds_read_b128 v[72:75], v14 offset:20480
    v_mfma_f32_16x16x32_bf16 v[24:27], v[244:247], v[96:99], v[24:27]
    ds_read_b128 v[76:79], v14 offset:24576
    v_mfma_f32_16x16x32_bf16 v[20:23], v[244:247], v[92:95], v[20:23]
    ds_read_b128 v[80:83], v14 offset:28672
    s_waitcnt lgkmcnt(4)
    v_mfma_f32_16x16x32_bf16 v[20:23], v[248:251], v[52:55], v[20:23]
    ds_read_b128 v[84:87], v14 offset:17408
    v_mfma_f32_16x16x32_bf16 v[24:27], v[248:251], v[56:59], v[24:27]
    ds_read_b128 v[88:91], v14 offset:21504
    v_mfma_f32_16x16x32_bf16 v[24:27], v[252:255], v[64:67], v[24:27]
    ds_read_b128 v[92:95], v14 offset:25600
    v_mfma_f32_16x16x32_bf16 v[20:23], v[252:255], v[60:63], v[20:23]
    ds_read_b128 v[96:99], v14 offset:29696
    s_waitcnt lgkmcnt(4)
    v_mfma_f32_16x16x32_bf16 v[28:31], v[128:131], v[68:71], v[28:31]
    ds_read_b128 v[52:55], v14 offset:18432
    v_mfma_f32_16x16x32_bf16 v[32:35], v[128:131], v[72:75], v[32:35]
    ds_read_b128 v[56:59], v14 offset:22528
    v_mfma_f32_16x16x32_bf16 v[32:35], v[132:135], v[80:83], v[32:35]
    ds_read_b128 v[60:63], v14 offset:26624
    v_mfma_f32_16x16x32_bf16 v[28:31], v[132:135], v[76:79], v[28:31]
    ds_read_b128 v[64:67], v14 offset:30720
    v_cvt_pk_bf16_f32 v20, v20, v21
    v_cvt_pk_bf16_f32 v21, v22, v23
    v_cvt_pk_bf16_f32 v22, v24, v25
    v_cvt_pk_bf16_f32 v23, v26, v27
    s_add_u32 s36, s39, 0
    v_permlane16_swap_b32 v20, v22
    v_permlane16_swap_b32 v21, v23
    s_waitcnt lgkmcnt(4)
    v_mfma_f32_16x16x32_bf16 v[28:31], v[136:139], v[84:87], v[28:31]
    ds_read_b128 v[68:71], v14 offset:19456
    v_mfma_f32_16x16x32_bf16 v[32:35], v[136:139], v[88:91], v[32:35]
    ds_read_b128 v[72:75], v14 offset:23552
    v_mfma_f32_16x16x32_bf16 v[32:35], v[140:143], v[96:99], v[32:35]
    ds_read_b128 v[76:79], v14 offset:27648
    v_mfma_f32_16x16x32_bf16 v[28:31], v[140:143], v[92:95], v[28:31]
    ds_read_b128 v[80:83], v14 offset:31744
    s_barrier
    s_waitcnt lgkmcnt(4)
    v_mfma_f32_16x16x32_bf16 v[28:31], v[144:147], v[52:55], v[28:31]
    ds_read_b128 v[84:87], v14 offset:32768
    v_mfma_f32_16x16x32_bf16 v[32:35], v[144:147], v[56:59], v[32:35]
    ds_read_b128 v[88:91], v14 offset:36864
    v_mfma_f32_16x16x32_bf16 v[32:35], v[148:151], v[64:67], v[32:35]
    ds_read_b128 v[92:95], v14 offset:40960
    v_mfma_f32_16x16x32_bf16 v[28:31], v[148:151], v[60:63], v[28:31]
    ds_read_b128 v[96:99], v14 offset:45056
    s_waitcnt lgkmcnt(4)
    v_mfma_f32_16x16x32_bf16 v[28:31], v[152:155], v[68:71], v[28:31]
    ds_read_b128 v[52:55], v14 offset:33792
    v_mfma_f32_16x16x32_bf16 v[32:35], v[152:155], v[72:75], v[32:35]
    ds_read_b128 v[56:59], v14 offset:37888
    v_mfma_f32_16x16x32_bf16 v[32:35], v[156:159], v[80:83], v[32:35]
    ds_read_b128 v[60:63], v14 offset:41984
    v_mfma_f32_16x16x32_bf16 v[28:31], v[156:159], v[76:79], v[28:31]
    ds_read_b128 v[64:67], v14 offset:46080
    s_waitcnt lgkmcnt(4)
    v_mfma_f32_16x16x32_bf16 v[28:31], v[160:163], v[84:87], v[28:31]
    ds_read_b128 v[68:71], v14 offset:34816
    v_mfma_f32_16x16x32_bf16 v[32:35], v[160:163], v[88:91], v[32:35]
    ds_read_b128 v[72:75], v14 offset:38912
    v_mfma_f32_16x16x32_bf16 v[32:35], v[164:167], v[96:99], v[32:35]
    ds_read_b128 v[76:79], v14 offset:43008
    v_mfma_f32_16x16x32_bf16 v[28:31], v[164:167], v[92:95], v[28:31]
    ds_read_b128 v[80:83], v14 offset:47104
    s_waitcnt lgkmcnt(4)
    v_mfma_f32_16x16x32_bf16 v[28:31], v[168:171], v[52:55], v[28:31]
    ds_read_b128 v[84:87], v14 offset:35840
    v_mfma_f32_16x16x32_bf16 v[32:35], v[168:171], v[56:59], v[32:35]
    ds_read_b128 v[88:91], v14 offset:39936
    v_mfma_f32_16x16x32_bf16 v[32:35], v[172:175], v[64:67], v[32:35]
    ds_read_b128 v[92:95], v14 offset:44032
    v_mfma_f32_16x16x32_bf16 v[28:31], v[172:175], v[60:63], v[28:31]
    ds_read_b128 v[96:99], v14 offset:48128
    s_barrier
    s_waitcnt lgkmcnt(4)
    v_mfma_f32_16x16x32_bf16 v[28:31], v[176:179], v[68:71], v[28:31]
    ds_read_b128 v[52:55], v15 offset:0
    v_mfma_f32_16x16x32_bf16 v[32:35], v[176:179], v[72:75], v[32:35]
    ds_read_b128 v[56:59], v15 offset:4096
    v_mfma_f32_16x16x32_bf16 v[32:35], v[180:183], v[80:83], v[32:35]
    ds_read_b128 v[60:63], v15 offset:8192
    v_mfma_f32_16x16x32_bf16 v[28:31], v[180:183], v[76:79], v[28:31]
    ds_read_b128 v[64:67], v15 offset:12288
    s_waitcnt lgkmcnt(4)
    v_mfma_f32_16x16x32_bf16 v[28:31], v[184:187], v[84:87], v[28:31]
    ds_read_b128 v[68:71], v15 offset:1024
    v_mfma_f32_16x16x32_bf16 v[32:35], v[184:187], v[88:91], v[32:35]
    ds_read_b128 v[72:75], v15 offset:5120
    v_mfma_f32_16x16x32_bf16 v[32:35], v[188:191], v[96:99], v[32:35]
    ds_read_b128 v[76:79], v15 offset:9216
    v_mfma_f32_16x16x32_bf16 v[28:31], v[188:191], v[92:95], v[28:31]
    ds_read_b128 v[80:83], v15 offset:13312
    s_waitcnt lgkmcnt(4)
    v_mfma_f32_16x16x32_bf16 v[28:31], v[192:195], v[52:55], v[28:31]
    ds_read_b128 v[84:87], v15 offset:2048
    v_mfma_f32_16x16x32_bf16 v[32:35], v[192:195], v[56:59], v[32:35]
    ds_read_b128 v[88:91], v15 offset:6144
    v_mfma_f32_16x16x32_bf16 v[32:35], v[196:199], v[64:67], v[32:35]
    ds_read_b128 v[92:95], v15 offset:10240
    v_mfma_f32_16x16x32_bf16 v[28:31], v[196:199], v[60:63], v[28:31]
    ds_read_b128 v[96:99], v15 offset:14336
    s_waitcnt lgkmcnt(4)
    v_mfma_f32_16x16x32_bf16 v[28:31], v[200:203], v[68:71], v[28:31]
    ds_read_b128 v[52:55], v15 offset:3072
    v_mfma_f32_16x16x32_bf16 v[32:35], v[200:203], v[72:75], v[32:35]
    ds_read_b128 v[56:59], v15 offset:7168
    v_mfma_f32_16x16x32_bf16 v[32:35], v[204:207], v[80:83], v[32:35]
    ds_read_b128 v[60:63], v15 offset:11264
    v_mfma_f32_16x16x32_bf16 v[28:31], v[204:207], v[76:79], v[28:31]
    ds_read_b128 v[64:67], v15 offset:15360
    s_barrier
    s_waitcnt lgkmcnt(4)
    v_mfma_f32_16x16x32_bf16 v[28:31], v[208:211], v[84:87], v[28:31]
    ds_read_b128 v[68:71], v15 offset:16384
    v_mfma_f32_16x16x32_bf16 v[32:35], v[208:211], v[88:91], v[32:35]
    ds_read_b128 v[72:75], v15 offset:20480
    v_mfma_f32_16x16x32_bf16 v[32:35], v[212:215], v[96:99], v[32:35]
    ds_read_b128 v[76:79], v15 offset:24576
    v_mfma_f32_16x16x32_bf16 v[28:31], v[212:215], v[92:95], v[28:31]
    ds_read_b128 v[80:83], v15 offset:28672
    s_waitcnt lgkmcnt(4)
    v_mfma_f32_16x16x32_bf16 v[28:31], v[216:219], v[52:55], v[28:31]
    ds_read_b128 v[84:87], v15 offset:17408
    v_mfma_f32_16x16x32_bf16 v[32:35], v[216:219], v[56:59], v[32:35]
    ds_read_b128 v[88:91], v15 offset:21504
    v_mfma_f32_16x16x32_bf16 v[32:35], v[220:223], v[64:67], v[32:35]
    ds_read_b128 v[92:95], v15 offset:25600
    v_mfma_f32_16x16x32_bf16 v[28:31], v[220:223], v[60:63], v[28:31]
    ds_read_b128 v[96:99], v15 offset:29696
    s_waitcnt lgkmcnt(4)
    v_mfma_f32_16x16x32_bf16 v[28:31], v[224:227], v[68:71], v[28:31]
    ds_read_b128 v[52:55], v15 offset:18432
    v_mfma_f32_16x16x32_bf16 v[32:35], v[224:227], v[72:75], v[32:35]
    ds_read_b128 v[56:59], v15 offset:22528
    v_mfma_f32_16x16x32_bf16 v[32:35], v[228:231], v[80:83], v[32:35]
    ds_read_b128 v[60:63], v15 offset:26624
    v_mfma_f32_16x16x32_bf16 v[28:31], v[228:231], v[76:79], v[28:31]
    ds_read_b128 v[64:67], v15 offset:30720
    s_waitcnt lgkmcnt(4)
    v_mfma_f32_16x16x32_bf16 v[28:31], v[232:235], v[84:87], v[28:31]
    ds_read_b128 v[68:71], v15 offset:19456
    v_mfma_f32_16x16x32_bf16 v[32:35], v[232:235], v[88:91], v[32:35]
    ds_read_b128 v[72:75], v15 offset:23552
    v_mfma_f32_16x16x32_bf16 v[32:35], v[236:239], v[96:99], v[32:35]
    ds_read_b128 v[76:79], v15 offset:27648
    v_mfma_f32_16x16x32_bf16 v[28:31], v[236:239], v[92:95], v[28:31]
    ds_read_b128 v[80:83], v15 offset:31744
    s_barrier
    s_waitcnt lgkmcnt(4)
    v_mfma_f32_16x16x32_bf16 v[28:31], v[240:243], v[52:55], v[28:31]
    ds_read_b128 v[84:87], v15 offset:32768
    v_mfma_f32_16x16x32_bf16 v[32:35], v[240:243], v[56:59], v[32:35]
    ds_read_b128 v[88:91], v15 offset:36864
    v_mfma_f32_16x16x32_bf16 v[32:35], v[244:247], v[64:67], v[32:35]
    ds_read_b128 v[92:95], v15 offset:40960
    v_mfma_f32_16x16x32_bf16 v[28:31], v[244:247], v[60:63], v[28:31]
    ds_read_b128 v[96:99], v15 offset:45056
    s_waitcnt lgkmcnt(4)
    v_mfma_f32_16x16x32_bf16 v[28:31], v[248:251], v[68:71], v[28:31]
    ds_read_b128 v[52:55], v15 offset:33792
    v_mfma_f32_16x16x32_bf16 v[32:35], v[248:251], v[72:75], v[32:35]
    ds_read_b128 v[56:59], v15 offset:37888
    v_mfma_f32_16x16x32_bf16 v[32:35], v[252:255], v[80:83], v[32:35]
    ds_read_b128 v[60:63], v15 offset:41984
    v_mfma_f32_16x16x32_bf16 v[28:31], v[252:255], v[76:79], v[28:31]
    ds_read_b128 v[64:67], v15 offset:46080
    s_waitcnt lgkmcnt(4)
    v_mfma_f32_16x16x32_bf16 v[36:39], v[128:131], v[84:87], v[36:39]
    ds_read_b128 v[68:71], v15 offset:34816
    v_mfma_f32_16x16x32_bf16 v[40:43], v[128:131], v[88:91], v[40:43]
    ds_read_b128 v[72:75], v15 offset:38912
    v_mfma_f32_16x16x32_bf16 v[40:43], v[132:135], v[96:99], v[40:43]
    ds_read_b128 v[76:79], v15 offset:43008
    v_mfma_f32_16x16x32_bf16 v[36:39], v[132:135], v[92:95], v[36:39]
    ds_read_b128 v[80:83], v15 offset:47104
    v_cvt_pk_bf16_f32 v28, v28, v29
    v_cvt_pk_bf16_f32 v29, v30, v31
    v_cvt_pk_bf16_f32 v30, v32, v33
    v_cvt_pk_bf16_f32 v31, v34, v35
    s_add_u32 s36, s39, 131072
    v_permlane16_swap_b32 v28, v30
    v_permlane16_swap_b32 v29, v31
    s_waitcnt lgkmcnt(4)
    v_mfma_f32_16x16x32_bf16 v[36:39], v[136:139], v[52:55], v[36:39]
    ds_read_b128 v[84:87], v15 offset:35840
    v_mfma_f32_16x16x32_bf16 v[40:43], v[136:139], v[56:59], v[40:43]
    ds_read_b128 v[88:91], v15 offset:39936
    v_mfma_f32_16x16x32_bf16 v[40:43], v[140:143], v[64:67], v[40:43]
    ds_read_b128 v[92:95], v15 offset:44032
    v_mfma_f32_16x16x32_bf16 v[36:39], v[140:143], v[60:63], v[36:39]
    ds_read_b128 v[96:99], v15 offset:48128
    s_barrier
    s_waitcnt lgkmcnt(4)
    v_mfma_f32_16x16x32_bf16 v[36:39], v[144:147], v[68:71], v[36:39]
    ds_read_b128 v[52:55], v14 offset:16384
    v_mfma_f32_16x16x32_bf16 v[40:43], v[144:147], v[72:75], v[40:43]
    ds_read_b128 v[56:59], v14 offset:20480
    v_mfma_f32_16x16x32_bf16 v[40:43], v[148:151], v[80:83], v[40:43]
    ds_read_b128 v[60:63], v14 offset:24576
    v_mfma_f32_16x16x32_bf16 v[36:39], v[148:151], v[76:79], v[36:39]
    ds_read_b128 v[64:67], v14 offset:28672
    s_waitcnt lgkmcnt(4)
    v_mfma_f32_16x16x32_bf16 v[36:39], v[152:155], v[84:87], v[36:39]
    ds_read_b128 v[68:71], v14 offset:17408
    v_mfma_f32_16x16x32_bf16 v[40:43], v[152:155], v[88:91], v[40:43]
    ds_read_b128 v[72:75], v14 offset:21504
    v_mfma_f32_16x16x32_bf16 v[40:43], v[156:159], v[96:99], v[40:43]
    ds_read_b128 v[76:79], v14 offset:25600
    v_mfma_f32_16x16x32_bf16 v[36:39], v[156:159], v[92:95], v[36:39]
    ds_read_b128 v[80:83], v14 offset:29696
    s_waitcnt lgkmcnt(4)
    v_mfma_f32_16x16x32_bf16 v[36:39], v[160:163], v[52:55], v[36:39]
    ds_read_b128 v[84:87], v14 offset:18432
    v_mfma_f32_16x16x32_bf16 v[40:43], v[160:163], v[56:59], v[40:43]
    ds_read_b128 v[88:91], v14 offset:22528
    v_mfma_f32_16x16x32_bf16 v[40:43], v[164:167], v[64:67], v[40:43]
    ds_read_b128 v[92:95], v14 offset:26624
    v_mfma_f32_16x16x32_bf16 v[36:39], v[164:167], v[60:63], v[36:39]
    ds_read_b128 v[96:99], v14 offset:30720
    s_waitcnt lgkmcnt(4)
    v_mfma_f32_16x16x32_bf16 v[36:39], v[168:171], v[68:71], v[36:39]
    ds_read_b128 v[52:55], v14 offset:19456
    v_mfma_f32_16x16x32_bf16 v[40:43], v[168:171], v[72:75], v[40:43]
    ds_read_b128 v[56:59], v14 offset:23552
    v_mfma_f32_16x16x32_bf16 v[40:43], v[172:175], v[80:83], v[40:43]
    ds_read_b128 v[60:63], v14 offset:27648
    v_mfma_f32_16x16x32_bf16 v[36:39], v[172:175], v[76:79], v[36:39]
    ds_read_b128 v[64:67], v14 offset:31744
    s_barrier
    s_waitcnt lgkmcnt(4)
    v_mfma_f32_16x16x32_bf16 v[36:39], v[176:179], v[84:87], v[36:39]
    ds_read_b128 v[68:71], v14 offset:32768
    v_mfma_f32_16x16x32_bf16 v[40:43], v[176:179], v[88:91], v[40:43]
    ds_read_b128 v[72:75], v14 offset:36864
    v_mfma_f32_16x16x32_bf16 v[40:43], v[180:183], v[96:99], v[40:43]
    ds_read_b128 v[76:79], v14 offset:40960
    v_mfma_f32_16x16x32_bf16 v[36:39], v[180:183], v[92:95], v[36:39]
    ds_read_b128 v[80:83], v14 offset:45056
    s_waitcnt lgkmcnt(4)
    v_mfma_f32_16x16x32_bf16 v[36:39], v[184:187], v[52:55], v[36:39]
    ds_read_b128 v[84:87], v14 offset:33792
    v_mfma_f32_16x16x32_bf16 v[40:43], v[184:187], v[56:59], v[40:43]
    ds_read_b128 v[88:91], v14 offset:37888
    v_mfma_f32_16x16x32_bf16 v[40:43], v[188:191], v[64:67], v[40:43]
    ds_read_b128 v[92:95], v14 offset:41984
    v_mfma_f32_16x16x32_bf16 v[36:39], v[188:191], v[60:63], v[36:39]
    ds_read_b128 v[96:99], v14 offset:46080
    s_waitcnt lgkmcnt(4)
    v_mfma_f32_16x16x32_bf16 v[36:39], v[192:195], v[68:71], v[36:39]
    ds_read_b128 v[52:55], v14 offset:34816
    v_mfma_f32_16x16x32_bf16 v[40:43], v[192:195], v[72:75], v[40:43]
    ds_read_b128 v[56:59], v14 offset:38912
    v_mfma_f32_16x16x32_bf16 v[40:43], v[196:199], v[80:83], v[40:43]
    ds_read_b128 v[60:63], v14 offset:43008
    v_mfma_f32_16x16x32_bf16 v[36:39], v[196:199], v[76:79], v[36:39]
    ds_read_b128 v[64:67], v14 offset:47104
    s_waitcnt lgkmcnt(4)
    v_mfma_f32_16x16x32_bf16 v[36:39], v[200:203], v[84:87], v[36:39]
    ds_read_b128 v[68:71], v14 offset:35840
    v_mfma_f32_16x16x32_bf16 v[40:43], v[200:203], v[88:91], v[40:43]
    ds_read_b128 v[72:75], v14 offset:39936
    v_mfma_f32_16x16x32_bf16 v[40:43], v[204:207], v[96:99], v[40:43]
    ds_read_b128 v[76:79], v14 offset:44032
    v_mfma_f32_16x16x32_bf16 v[36:39], v[204:207], v[92:95], v[36:39]
    ds_read_b128 v[80:83], v14 offset:48128
    s_barrier
    s_waitcnt lgkmcnt(4)
    v_mfma_f32_16x16x32_bf16 v[36:39], v[208:211], v[52:55], v[36:39]
    ds_read_b128 v[84:87], v15 offset:0
    v_mfma_f32_16x16x32_bf16 v[40:43], v[208:211], v[56:59], v[40:43]
    ds_read_b128 v[88:91], v15 offset:4096
    v_mfma_f32_16x16x32_bf16 v[40:43], v[212:215], v[64:67], v[40:43]
    ds_read_b128 v[92:95], v15 offset:8192
    v_mfma_f32_16x16x32_bf16 v[36:39], v[212:215], v[60:63], v[36:39]
    ds_read_b128 v[96:99], v15 offset:12288
    s_waitcnt lgkmcnt(4)
    v_mfma_f32_16x16x32_bf16 v[36:39], v[216:219], v[68:71], v[36:39]
    ds_read_b128 v[52:55], v15 offset:1024
    v_mfma_f32_16x16x32_bf16 v[40:43], v[216:219], v[72:75], v[40:43]
    ds_read_b128 v[56:59], v15 offset:5120
    v_mfma_f32_16x16x32_bf16 v[40:43], v[220:223], v[80:83], v[40:43]
    ds_read_b128 v[60:63], v15 offset:9216
    v_mfma_f32_16x16x32_bf16 v[36:39], v[220:223], v[76:79], v[36:39]
    ds_read_b128 v[64:67], v15 offset:13312
    s_waitcnt lgkmcnt(4)
    v_mfma_f32_16x16x32_bf16 v[36:39], v[224:227], v[84:87], v[36:39]
    ds_read_b128 v[68:71], v15 offset:2048
    v_mfma_f32_16x16x32_bf16 v[40:43], v[224:227], v[88:91], v[40:43]
    ds_read_b128 v[72:75], v15 offset:6144
    v_mfma_f32_16x16x32_bf16 v[40:43], v[228:231], v[96:99], v[40:43]
    ds_read_b128 v[76:79], v15 offset:10240
    v_mfma_f32_16x16x32_bf16 v[36:39], v[228:231], v[92:95], v[36:39]
    ds_read_b128 v[80:83], v15 offset:14336
    s_waitcnt lgkmcnt(4)
    v_mfma_f32_16x16x32_bf16 v[36:39], v[232:235], v[52:55], v[36:39]
    ds_read_b128 v[84:87], v15 offset:3072
    v_mfma_f32_16x16x32_bf16 v[40:43], v[232:235], v[56:59], v[40:43]
    ds_read_b128 v[88:91], v15 offset:7168
    v_mfma_f32_16x16x32_bf16 v[40:43], v[236:239], v[64:67], v[40:43]
    ds_read_b128 v[92:95], v15 offset:11264
    v_mfma_f32_16x16x32_bf16 v[36:39], v[236:239], v[60:63], v[36:39]
    ds_read_b128 v[96:99], v15 offset:15360
    s_barrier
    s_waitcnt lgkmcnt(4)
    v_mfma_f32_16x16x32_bf16 v[36:39], v[240:243], v[68:71], v[36:39]
    ds_read_b128 v[52:55], v15 offset:16384
    v_mfma_f32_16x16x32_bf16 v[40:43], v[240:243], v[72:75], v[40:43]
    ds_read_b128 v[56:59], v15 offset:20480
    v_mfma_f32_16x16x32_bf16 v[40:43], v[244:247], v[80:83], v[40:43]
    ds_read_b128 v[60:63], v15 offset:24576
    v_mfma_f32_16x16x32_bf16 v[36:39], v[244:247], v[76:79], v[36:39]
    ds_read_b128 v[64:67], v15 offset:28672
    s_waitcnt lgkmcnt(4)
    v_mfma_f32_16x16x32_bf16 v[36:39], v[248:251], v[84:87], v[36:39]
    ds_read_b128 v[68:71], v15 offset:17408
    v_mfma_f32_16x16x32_bf16 v[40:43], v[248:251], v[88:91], v[40:43]
    ds_read_b128 v[72:75], v15 offset:21504
    v_mfma_f32_16x16x32_bf16 v[40:43], v[252:255], v[96:99], v[40:43]
    ds_read_b128 v[76:79], v15 offset:25600
    v_mfma_f32_16x16x32_bf16 v[36:39], v[252:255], v[92:95], v[36:39]
    ds_read_b128 v[80:83], v15 offset:29696
    s_waitcnt lgkmcnt(4)
    v_mfma_f32_16x16x32_bf16 v[44:47], v[128:131], v[52:55], v[44:47]
    ds_read_b128 v[84:87], v15 offset:18432
    v_mfma_f32_16x16x32_bf16 v[48:51], v[128:131], v[56:59], v[48:51]
    ds_read_b128 v[88:91], v15 offset:22528
    v_mfma_f32_16x16x32_bf16 v[48:51], v[132:135], v[64:67], v[48:51]
    ds_read_b128 v[92:95], v15 offset:26624
    v_mfma_f32_16x16x32_bf16 v[44:47], v[132:135], v[60:63], v[44:47]
    ds_read_b128 v[96:99], v15 offset:30720
    v_cvt_pk_bf16_f32 v36, v36, v37
    v_cvt_pk_bf16_f32 v37, v38, v39
    v_cvt_pk_bf16_f32 v38, v40, v41
    v_cvt_pk_bf16_f32 v39, v42, v43
    s_add_u32 s36, s39, 262144
    v_permlane16_swap_b32 v36, v38
    v_permlane16_swap_b32 v37, v39
    s_waitcnt lgkmcnt(4)
    v_mfma_f32_16x16x32_bf16 v[44:47], v[136:139], v[68:71], v[44:47]
    ds_read_b128 v[52:55], v15 offset:19456
    v_mfma_f32_16x16x32_bf16 v[48:51], v[136:139], v[72:75], v[48:51]
    ds_read_b128 v[56:59], v15 offset:23552
    v_mfma_f32_16x16x32_bf16 v[48:51], v[140:143], v[80:83], v[48:51]
    ds_read_b128 v[60:63], v15 offset:27648
    v_mfma_f32_16x16x32_bf16 v[44:47], v[140:143], v[76:79], v[44:47]
    ds_read_b128 v[64:67], v15 offset:31744
    s_barrier
    s_waitcnt lgkmcnt(4)
    v_mfma_f32_16x16x32_bf16 v[44:47], v[144:147], v[84:87], v[44:47]
    ds_read_b128 v[68:71], v15 offset:32768
    v_mfma_f32_16x16x32_bf16 v[48:51], v[144:147], v[88:91], v[48:51]
    ds_read_b128 v[72:75], v15 offset:36864
    v_mfma_f32_16x16x32_bf16 v[48:51], v[148:151], v[96:99], v[48:51]
    ds_read_b128 v[76:79], v15 offset:40960
    v_mfma_f32_16x16x32_bf16 v[44:47], v[148:151], v[92:95], v[44:47]
    ds_read_b128 v[80:83], v15 offset:45056
    s_add_u32 s36, s39, 0
    buffer_store_dwordx4 v[20:23], v13, s[24:27], s36 offen sc1
    s_waitcnt lgkmcnt(4)
    v_mfma_f32_16x16x32_bf16 v[44:47], v[152:155], v[52:55], v[44:47]
    ds_read_b128 v[84:87], v15 offset:33792
    v_mfma_f32_16x16x32_bf16 v[48:51], v[152:155], v[56:59], v[48:51]
    ds_read_b128 v[88:91], v15 offset:37888
    v_mfma_f32_16x16x32_bf16 v[48:51], v[156:159], v[64:67], v[48:51]
    ds_read_b128 v[92:95], v15 offset:41984
    v_mfma_f32_16x16x32_bf16 v[44:47], v[156:159], v[60:63], v[44:47]
    ds_read_b128 v[96:99], v15 offset:46080
    s_add_u32 s36, s39, 131072
    buffer_store_dwordx4 v[28:31], v13, s[24:27], s36 offen sc1
    s_waitcnt lgkmcnt(4)
    v_mfma_f32_16x16x32_bf16 v[44:47], v[160:163], v[68:71], v[44:47]
    ds_read_b128 v[52:55], v15 offset:34816
    v_mfma_f32_16x16x32_bf16 v[48:51], v[160:163], v[72:75], v[48:51]
    ds_read_b128 v[56:59], v15 offset:38912
    v_mfma_f32_16x16x32_bf16 v[48:51], v[164:167], v[80:83], v[48:51]
    ds_read_b128 v[60:63], v15 offset:43008
    v_mfma_f32_16x16x32_bf16 v[44:47], v[164:167], v[76:79], v[44:47]
    ds_read_b128 v[64:67], v15 offset:47104
    s_add_u32 s36, s39, 262144
    buffer_store_dwordx4 v[36:39], v13, s[24:27], s36 offen sc1
    s_waitcnt lgkmcnt(4)
    v_mfma_f32_16x16x32_bf16 v[44:47], v[168:171], v[84:87], v[44:47]
    ds_read_b128 v[68:71], v15 offset:35840
    v_mfma_f32_16x16x32_bf16 v[48:51], v[168:171], v[88:91], v[48:51]
    ds_read_b128 v[72:75], v15 offset:39936
    v_mfma_f32_16x16x32_bf16 v[48:51], v[172:175], v[96:99], v[48:51]
    ds_read_b128 v[76:79], v15 offset:44032
    v_mfma_f32_16x16x32_bf16 v[44:47], v[172:175], v[92:95], v[44:47]
    ds_read_b128 v[80:83], v15 offset:48128
    s_barrier
    s_waitcnt lgkmcnt(4)
    v_mfma_f32_16x16x32_bf16 v[44:47], v[176:179], v[52:55], v[44:47]
    ds_read_b128 v[84:87], v14 offset:16384
    v_mfma_f32_16x16x32_bf16 v[48:51], v[176:179], v[56:59], v[48:51]
    ds_read_b128 v[88:91], v14 offset:20480
    v_mfma_f32_16x16x32_bf16 v[48:51], v[180:183], v[64:67], v[48:51]
    ds_read_b128 v[92:95], v14 offset:24576
    v_mfma_f32_16x16x32_bf16 v[44:47], v[180:183], v[60:63], v[44:47]
    ds_read_b128 v[96:99], v14 offset:28672
    s_waitcnt lgkmcnt(4)
    v_mfma_f32_16x16x32_bf16 v[44:47], v[184:187], v[68:71], v[44:47]
    ds_read_b128 v[52:55], v14 offset:17408
    v_mfma_f32_16x16x32_bf16 v[48:51], v[184:187], v[72:75], v[48:51]
    ds_read_b128 v[56:59], v14 offset:21504
    v_mfma_f32_16x16x32_bf16 v[48:51], v[188:191], v[80:83], v[48:51]
    ds_read_b128 v[60:63], v14 offset:25600
    v_mfma_f32_16x16x32_bf16 v[44:47], v[188:191], v[76:79], v[44:47]
    ds_read_b128 v[64:67], v14 offset:29696
    s_waitcnt lgkmcnt(4)
    v_mfma_f32_16x16x32_bf16 v[44:47], v[192:195], v[84:87], v[44:47]
    ds_read_b128 v[68:71], v14 offset:18432
    v_mfma_f32_16x16x32_bf16 v[48:51], v[192:195], v[88:91], v[48:51]
    ds_read_b128 v[72:75], v14 offset:22528
    v_mfma_f32_16x16x32_bf16 v[48:51], v[196:199], v[96:99], v[48:51]
    ds_read_b128 v[76:79], v14 offset:26624
    v_mfma_f32_16x16x32_bf16 v[44:47], v[196:199], v[92:95], v[44:47]
    ds_read_b128 v[80:83], v14 offset:30720
    s_waitcnt lgkmcnt(4)
    v_mfma_f32_16x16x32_bf16 v[44:47], v[200:203], v[52:55], v[44:47]
    ds_read_b128 v[84:87], v14 offset:19456
    v_mfma_f32_16x16x32_bf16 v[48:51], v[200:203], v[56:59], v[48:51]
    ds_read_b128 v[88:91], v14 offset:23552
    v_mfma_f32_16x16x32_bf16 v[48:51], v[204:207], v[64:67], v[48:51]
    ds_read_b128 v[92:95], v14 offset:27648
    v_mfma_f32_16x16x32_bf16 v[44:47], v[204:207], v[60:63], v[44:47]
    ds_read_b128 v[96:99], v14 offset:31744
    s_barrier
    s_waitcnt lgkmcnt(4)
    v_mfma_f32_16x16x32_bf16 v[44:47], v[208:211], v[68:71], v[44:47]
    ds_read_b128 v[52:55], v14 offset:32768
    v_mfma_f32_16x16x32_bf16 v[48:51], v[208:211], v[72:75], v[48:51]
    ds_read_b128 v[56:59], v14 offset:36864
    v_mfma_f32_16x16x32_bf16 v[48:51], v[212:215], v[80:83], v[48:51]
    ds_read_b128 v[60:63], v14 offset:40960
    v_mfma_f32_16x16x32_bf16 v[44:47], v[212:215], v[76:79], v[44:47]
    ds_read_b128 v[64:67], v14 offset:45056
    s_waitcnt lgkmcnt(4)
    v_mfma_f32_16x16x32_bf16 v[44:47], v[216:219], v[84:87], v[44:47]
    ds_read_b128 v[68:71], v14 offset:33792
    v_mfma_f32_16x16x32_bf16 v[48:51], v[216:219], v[88:91], v[48:51]
    ds_read_b128 v[72:75], v14 offset:37888
    v_mfma_f32_16x16x32_bf16 v[48:51], v[220:223], v[96:99], v[48:51]
    ds_read_b128 v[76:79], v14 offset:41984
    v_mfma_f32_16x16x32_bf16 v[44:47], v[220:223], v[92:95], v[44:47]
    ds_read_b128 v[80:83], v14 offset:46080
    s_waitcnt lgkmcnt(4)
    v_mfma_f32_16x16x32_bf16 v[44:47], v[224:227], v[52:55], v[44:47]
    ds_read_b128 v[84:87], v14 offset:34816
    v_mfma_f32_16x16x32_bf16 v[48:51], v[224:227], v[56:59], v[48:51]
    ds_read_b128 v[88:91], v14 offset:38912
    v_mfma_f32_16x16x32_bf16 v[48:51], v[228:231], v[64:67], v[48:51]
    ds_read_b128 v[92:95], v14 offset:43008
    v_mfma_f32_16x16x32_bf16 v[44:47], v[228:231], v[60:63], v[44:47]
    ds_read_b128 v[96:99], v14 offset:47104
    s_waitcnt lgkmcnt(4)
    v_mfma_f32_16x16x32_bf16 v[44:47], v[232:235], v[68:71], v[44:47]
    ds_read_b128 v[52:55], v14 offset:35840
    v_mfma_f32_16x16x32_bf16 v[48:51], v[232:235], v[72:75], v[48:51]
    ds_read_b128 v[56:59], v14 offset:39936
    v_mfma_f32_16x16x32_bf16 v[48:51], v[236:239], v[80:83], v[48:51]
    ds_read_b128 v[60:63], v14 offset:44032
    v_mfma_f32_16x16x32_bf16 v[44:47], v[236:239], v[76:79], v[44:47]
    ds_read_b128 v[64:67], v14 offset:48128
    ds_write_b128 v16, v[20:23] offset:0
    ds_write_b128 v16, v[28:31] offset:4096
    ds_write_b128 v16, v[36:39] offset:8192
    s_waitcnt lgkmcnt(7)
    v_mfma_f32_16x16x32_bf16 v[44:47], v[240:243], v[84:87], v[44:47]
    v_mfma_f32_16x16x32_bf16 v[48:51], v[240:243], v[88:91], v[48:51]
    v_mfma_f32_16x16x32_bf16 v[48:51], v[244:247], v[96:99], v[48:51]
    v_mfma_f32_16x16x32_bf16 v[44:47], v[244:247], v[92:95], v[44:47]
    s_waitcnt lgkmcnt(3)
    v_mfma_f32_16x16x32_bf16 v[44:47], v[248:251], v[52:55], v[44:47]
    v_mfma_f32_16x16x32_bf16 v[48:51], v[248:251], v[56:59], v[48:51]
    v_mfma_f32_16x16x32_bf16 v[48:51], v[252:255], v[64:67], v[48:51]
    v_mfma_f32_16x16x32_bf16 v[44:47], v[252:255], v[60:63], v[44:47]
    s_setprio 0
    s_nop 6
    v_cvt_pk_bf16_f32 v44, v44, v45
    v_cvt_pk_bf16_f32 v45, v46, v47
    v_cvt_pk_bf16_f32 v46, v48, v49
    v_cvt_pk_bf16_f32 v47, v50, v51
    s_add_u32 s36, s39, 393216
    v_permlane16_swap_b32 v44, v46
    v_permlane16_swap_b32 v45, v47
    s_add_u32 s36, s39, 393216
    buffer_store_dwordx4 v[44:47], v13, s[24:27], s36 offen sc1
    ds_write_b128 v16, v[44:47] offset:12288
    s_waitcnt lgkmcnt(0)
    s_barrier
    s_cmp_ge_u32 s30, 6
    s_cbranch_scc1 WLOAD
    s_and_b32 s35, s30, 1
    s_add_u32 s12, s62, 0x480000
    s_addc_u32 s13, s63, 0
    s_mov_b32 s14, 0x7e000
    s_mov_b32 s15, 0x20000
    s_mul_i32 s38, s35, 262144
    s_lshl_b32 s41, s35, 13
    s_mov_b32 s42, 0
    s_mov_b32 s44, s29
    s_add_u32 s54, s55, 1024
    v_mov_b32 v9, s54
    v_lshl_add_u32 v9, v1, 7, v9
    s_add_u32 s44, s44, 1
    s_and_b32 s44, s44, 15
    s_add_u32 s46, s29, 1
    s_and_b32 s46, s46, 15
    s_cmp_eq_u32 s28, s29
    s_cselect_b32 s47, s46, s28
    s_mov_b32 s42, 16384
    s_and_b32 s35, s30, 1
    s_lshl_b32 s35, s35, 7
    s_add_u32 s35, s35, s55
    s_add_u32 s35, s35, 0x1600
    s_and_b32 s40, s30, 1
    s_lshl_b32 s40, s40, 13
    s_lshl_b32 s53, s29, 7
    s_add_u32 s40, s40, s53
    s_add_u32 s40, s40, 23068672
    v_lshlrev_b32 v10, 3, v1
    s_add_u32 s20, s62, 0x1c8000
    s_addc_u32 s21, s63, 0
    s_mov_b32 s22, 0x6000
    s_mov_b32 s23, 0x20000
    s_and_b32 s34, s30, 1
    s_lshl_b32 s34, s34, 9
    s_call_b64 s[76:77], PREP_a_issue_3
    s_mov_b32 m0, s19
    s_mov_b32 s39, s16
    s_and_b32 s53, s30, 3
    s_lshl_b32 s53, s53, 7
    s_add_u32 s53, s53, s55
    s_add_u32 s53, s53, 0x400
    v_mov_b32 v14, 1
    v_mov_b32 v15, 0
    s_mov_b64 exec, 1
    s_waitcnt vmcnt(0)
    buffer_atomic_add v14, v15, s[56:59], s53 offen sc1
    s_mov_b64 exec, -1
    s_call_b64 s[76:77], SUB_rest_2
    s_waitcnt lgkmcnt(0)
    s_mov_b32 s53, 0
    s_add_u32 s54, s52, 16
    s_bfm_b64 exec, 4, 0
poll_31:
    buffer_load_dword v8, v9, s[56:59], 0 offen sc1
    s_waitcnt vmcnt(0)
    v_cmp_eq_u32 vcc, s54, v8
    s_nop 0
    s_cmp_eq_u64 vcc, exec
    s_cbranch_scc1 pok_32
    s_sleep 5
    s_add_u32 s53, s53, 1
    s_cmp_lt_u32 s53, s61
    s_cbranch_scc1 poll_31
    s_mov_b32 s61, 0
pok_32:
    s_mov_b64 exec, -1
    buffer_load_dwordx4 v2, s[12:15], s39 offen sc1 lds
    buffer_load_dwordx4 v2, s[12:15], s39 offen offset:1024 sc1 lds
    s_call_b64 s[76:77], PREP_a_issue_3
    s_add_u32 m0, m0, 2048
    s_add_u32 s39, s39, 65536
    buffer_load_dwordx4 v2, s[12:15], s39 offen sc1 lds
    buffer_load_dwordx4 v2, s[12:15], s39 offen offset:1024 sc1 lds
    s_add_u32 m0, m0, 2048
    s_add_u32 s39, s39, 65536
    buffer_load_dwordx4 v2, s[12:15], s39 offen sc1 lds
    buffer_load_dwordx4 v2, s[12:15], s39 offen offset:1024 sc1 lds
    s_add_u32 m0, m0, 2048
    s_add_u32 s39, s39, 65536
    buffer_load_dwordx4 v2, s[12:15], s39 offen sc1 lds
    buffer_load_dwordx4 v2, s[12:15], s39 offen offset:1024 sc1 lds
    s_mov_b32 m0, s19
    s_mov_b32 s39, s16
    buffer_load_dwordx4 v2, s[12:15], s39 offen sc1 lds
    buffer_load_dwordx4 v2, s[12:15], s39 offen offset:1024 sc1 lds
    s_call_b64 s[76:77], PREP_a_issue_3
    s_add_u32 m0, m0, 2048
    s_add_u32 s39, s39, 65536
    buffer_load_dwordx4 v2, s[12:15], s39 offen sc1 lds
    buffer_load_dwordx4 v2, s[12:15], s39 offen offset:1024 sc1 lds
    s_add_u32 m0, m0, 2048
    s_add_u32 s39, s39, 65536
    buffer_load_dwordx4 v2, s[12:15], s39 offen sc1 lds
    buffer_load_dwordx4 v2, s[12:15], s39 offen offset:1024 sc1 lds
    s_add_u32 m0, m0, 2048
    s_add_u32 s39, s39, 65536
    buffer_load_dwordx4 v2, s[12:15], s39 offen sc1 lds
    buffer_load_dwordx4 v2, s[12:15], s39 offen offset:1024 sc1 lds
    s_mov_b32 m0, s19
    s_mov_b32 s39, s16
    s_waitcnt vmcnt(8)
    s_barrier
    buffer_load_dwordx4 v2, s[12:15], s39 offen sc1 lds
    buffer_load_dwordx4 v2, s[12:15], s39 offen offset:1024 sc1 lds
    s_call_b64 s[76:77], PREP_a_issue_3
    s_add_u32 m0, m0, 2048
    s_add_u32 s39, s39, 65536
    buffer_load_dwordx4 v2, s[12:15], s39 offen sc1 lds
    buffer_load_dwordx4 v2, s[12:15], s39 offen offset:1024 sc1 lds
    s_add_u32 m0, m0, 2048
    s_add_u32 s39, s39, 65536
    buffer_load_dwordx4 v2, s[12:15], s39 offen sc1 lds
    buffer_load_dwordx4 v2, s[12:15], s39 offen offset:1024 sc1 lds
    s_add_u32 m0, m0, 2048
    s_add_u32 s39, s39, 65536
    buffer_load_dwordx4 v2, s[12:15], s39 offen sc1 lds
    buffer_load_dwordx4 v2, s[12:15], s39 offen offset:1024 sc1 lds
    s_mov_b32 m0, s19
    s_mov_b32 s39, s16
    s_add_u32 s36, s34, 155648
    v_add_u32 v51, s36, v10
    ds_read_b64 v[18:19], v51 offset:0
    ds_read_b64 v[20:21], v51 offset:1024
    ds_read_b64 v[22:23], v51 offset:2048
    ds_read_b64 v[24:25], v51 offset:3072
    s_lshr_b32 s53, s29, 3
    s_lshl_b32 s53, s53, 14
    s_and_b32 s36, s29, 7
    s_lshl_b32 s36, s36, 10
    s_add_u32 s36, s36, s53
    s_add_u32 s36, s36, s34
    s_waitcnt lgkmcnt(0)
    v_pk_add_f32 v[18:19], v[18:19], v[20:21]
    v_pk_add_f32 v[18:19], v[18:19], v[22:23]
    v_pk_add_f32 v[18:19], v[18:19], v[24:25]
    buffer_store_dwordx2 v[18:19], v10, s[20:23], s36 offen sc1
    s_waitcnt vmcnt(9)
    s_barrier
    buffer_load_dwordx4 v2, s[12:15], s39 offen sc1 lds
    buffer_load_dwordx4 v2, s[12:15], s39 offen offset:1024 sc1 lds
    s_call_b64 s[76:77], PREP_a_issue_3
    s_add_u32 m0, m0, 2048
    s_add_u32 s39, s39, 65536
    buffer_load_dwordx4 v2, s[12:15], s39 offen sc1 lds
    buffer_load_dwordx4 v2, s[12:15], s39 offen offset:1024 sc1 lds
    s_add_u32 m0, m0, 2048
    s_add_u32 s39, s39, 65536
    buffer_load_dwordx4 v2, s[12:15], s39 offen sc1 lds
    buffer_load_dwordx4 v2, s[12:15], s39 offen offset:1024 sc1 lds
    s_add_u32 m0, m0, 2048
    s_add_u32 s39, s39, 65536
    buffer_load_dwordx4 v2, s[12:15], s39 offen sc1 lds
    buffer_load_dwordx4 v2, s[12:15], s39 offen offset:1024 sc1 lds
    s_mov_b32 m0, s19
    s_mov_b32 s39, s16
    s_waitcnt vmcnt(9)
    s_barrier
    buffer_load_dwordx4 v2, s[12:15], s39 offen sc1 lds
    buffer_load_dwordx4 v2, s[12:15], s39 offen offset:1024 sc1 lds
    s_call_b64 s[76:77], PREP_a_issue_3
    s_add_u32 m0, m0, 2048
    s_add_u32 s39, s39, 65536
    buffer_load_dwordx4 v2, s[12:15], s39 offen sc1 lds
    buffer_load_dwordx4 v2, s[12:15], s39 offen offset:1024 sc1 lds
    s_add_u32 m0, m0, 2048
    s_add_u32 s39, s39, 65536
    buffer_load_dwordx4 v2, s[12:15], s39 offen sc1 lds
    buffer_load_dwordx4 v2, s[12:15], s39 offen offset:1024 sc1 lds
    s_add_u32 m0, m0, 2048
    s_add_u32 s39, s39, 65536
    buffer_load_dwordx4 v2, s[12:15], s39 offen sc1 lds
    buffer_load_dwordx4 v2, s[12:15], s39 offen offset:1024 sc1 lds
    s_mov_b32 m0, s19
    s_mov_b32 s39, s16
    s_waitcnt vmcnt(16)
    s_and_b32 s53, s30, 1
    s_lshl_b32 s53, s53, 7
    s_add_u32 s53, s53, s55
    s_add_u32 s53, s53, 0x1600
    v_mov_b32 v14, 1
    v_mov_b32 v15, 0
    s_mov_b64 exec, 1
    buffer_atomic_add v14, v15, s[56:59], s53 offen sc1
    s_mov_b64 exec, -1
    s_waitcnt vmcnt(9)
    s_barrier
    buffer_load_dwordx4 v2, s[12:15], s39 offen sc1 lds
    buffer_load_dwordx4 v2, s[12:15], s39 offen offset:1024 sc1 lds
    s_call_b64 s[76:77], PREP_a_issue_3
    s_add_u32 m0, m0, 2048
    s_add_u32 s39, s39, 65536
    buffer_load_dwordx4 v2, s[12:15], s39 offen sc1 lds
    buffer_load_dwordx4 v2, s[12:15], s39 offen offset:1024 sc1 lds
    s_add_u32 m0, m0, 2048
    s_add_u32 s39, s39, 65536
    buffer_load_dwordx4 v2, s[12:15], s39 offen sc1 lds
    buffer_load_dwordx4 v2, s[12:15], s39 offen offset:1024 sc1 lds
    s_add_u32 m0, m0, 2048
    s_add_u32 s39, s39, 65536
    buffer_load_dwordx4 v2, s[12:15], s39 offen sc1 lds
    buffer_load_dwordx4 v2, s[12:15], s39 offen offset:1024 sc1 lds
    s_mov_b32 m0, s19
    s_mov_b32 s39, s16
    s_waitcnt vmcnt(9)
    s_barrier
    buffer_load_dwordx4 v2, s[12:15], s39 offen sc1 lds
    buffer_load_dwordx4 v2, s[12:15], s39 offen offset:1024 sc1 lds
    s_call_b64 s[76:77], PREP_a_issue_3
    s_add_u32 m0, m0, 2048
    s_add_u32 s39, s39, 65536
    buffer_load_dwordx4 v2, s[12:15], s39 offen sc1 lds
    buffer_load_dwordx4 v2, s[12:15], s39 offen offset:1024 sc1 lds
    s_add_u32 m0, m0, 2048
    s_add_u32 s39, s39, 65536
    buffer_load_dwordx4 v2, s[12:15], s39 offen sc1 lds
    buffer_load_dwordx4 v2, s[12:15], s39 offen offset:1024 sc1 lds
    s_add_u32 m0, m0, 2048
    s_add_u32 s39, s39, 65536
    buffer_load_dwordx4 v2, s[12:15], s39 offen sc1 lds
    buffer_load_dwordx4 v2, s[12:15], s39 offen offset:1024 sc1 lds
    s_mov_b32 m0, s19
    s_mov_b32 s39, s16
    s_waitcnt vmcnt(8)
    s_barrier
    buffer_load_dwordx4 v2, s[12:15], s39 offen sc1 lds
    buffer_load_dwordx4 v2, s[12:15], s39 offen offset:1024 sc1 lds
    s_call_b64 s[76:77], PREP_a_issue_3
    s_add_u32 m0, m0, 2048
    s_add_u32 s39, s39, 65536
    buffer_load_dwordx4 v2, s[12:15], s39 offen sc1 lds
    buffer_load_dwordx4 v2, s[12:15], s39 offen offset:1024 sc1 lds
    s_add_u32 m0, m0, 2048
    s_add_u32 s39, s39, 65536
    buffer_load_dwordx4 v2, s[12:15], s39 offen sc1 lds
    buffer_load_dwordx4 v2, s[12:15], s39 offen offset:1024 sc1 lds
    s_add_u32 m0, m0, 2048
    s_add_u32 s39, s39, 65536
    buffer_load_dwordx4 v2, s[12:15], s39 offen sc1 lds
    buffer_load_dwordx4 v2, s[12:15], s39 offen offset:1024 sc1 lds
    s_mov_b32 m0, s19
    s_mov_b32 s39, s16
    s_waitcnt vmcnt(8)
    s_barrier
    buffer_load_dwordx4 v2, s[12:15], s39 offen sc1 lds
    buffer_load_dwordx4 v2, s[12:15], s39 offen offset:1024 sc1 lds
    s_call_b64 s[76:77], PREP_a_issue_3
    s_add_u32 m0, m0, 2048
    s_add_u32 s39, s39, 65536
    buffer_load_dwordx4 v2, s[12:15], s39 offen sc1 lds
    buffer_load_dwordx4 v2, s[12:15], s39 offen offset:1024 sc1 lds
    s_add_u32 m0, m0, 2048
    s_add_u32 s39, s39, 65536
    buffer_load_dwordx4 v2, s[12:15], s39 offen sc1 lds
    buffer_load_dwordx4 v2, s[12:15], s39 offen offset:1024 sc1 lds
    s_add_u32 m0, m0, 2048
    s_add_u32 s39, s39, 65536
    buffer_load_dwordx4 v2, s[12:15], s39 offen sc1 lds
    buffer_load_dwordx4 v2, s[12:15], s39 offen offset:1024 sc1 lds
    s_mov_b32 m0, s19
    s_mov_b32 s39, s16
    s_load_dword s32, s[4:5], s35
    s_load_dword s3, s[4:5], s40
    s_waitcnt vmcnt(8)
    s_barrier
    buffer_load_dwordx4 v2, s[12:15], s39 offen sc1 lds
    buffer_load_dwordx4 v2, s[12:15], s39 offen offset:1024 sc1 lds
    s_call_b64 s[76:77], PREP_a_issue_3
    s_add_u32 m0, m0, 2048
    s_add_u32 s39, s39, 65536
    buffer_load_dwordx4 v2, s[12:15], s39 offen sc1 lds
    buffer_load_dwordx4 v2, s[12:15], s39 offen offset:1024 sc1 lds
    s_add_u32 m0, m0, 2048
    s_add_u32 s39, s39, 65536
    buffer_load_dwordx4 v2, s[12:15], s39 offen sc1 lds
    buffer_load_dwordx4 v2, s[12:15], s39 offen offset:1024 sc1 lds
    s_add_u32 m0, m0, 2048
    s_add_u32 s39, s39, 65536
    buffer_load_dwordx4 v2, s[12:15], s39 offen sc1 lds
    buffer_load_dwordx4 v2, s[12:15], s39 offen offset:1024 sc1 lds
    s_mov_b32 m0, s19
    s_mov_b32 s39, s16
    s_add_u32 s54, s52, 16
    s_waitcnt lgkmcnt(0)
    s_cmp_eq_u32 s32, s54
    s_cbranch_scc1 fok_33
    v_mov_b32 v15, s35
    s_mov_b32 s53, 0
    s_add_u32 s54, s52, 16
    s_bfm_b64 exec, 1, 0
poll_34:
    buffer_load_dword v14, v15, s[56:59], 0 offen sc1
    s_waitcnt vmcnt(0)
    v_cmp_eq_u32 vcc, s54, v14
    s_nop 0
    s_cmp_eq_u64 vcc, exec
    s_cbranch_scc1 pok_35
    s_sleep 5
    s_add_u32 s53, s53, 1
    s_cmp_lt_u32 s53, s61
    s_cbranch_scc1 poll_34
    s_mov_b32 s61, 0
pok_35:
    s_mov_b64 exec, -1
fok_33:
    s_add_u32 s36, s34, 0
    buffer_load_dwordx2 v[18:19], v10, s[20:23], s36 offen offset:0 sc1
    buffer_load_dwordx2 v[20:21], v10, s[20:23], s36 offen offset:1024 sc1
    buffer_load_dwordx2 v[22:23], v10, s[20:23], s36 offen offset:2048 sc1
    buffer_load_dwordx2 v[24:25], v10, s[20:23], s36 offen offset:3072 sc1
    s_add_u32 s36, s36, 4096
    buffer_load_dwordx2 v[26:27], v10, s[20:23], s36 offen offset:0 sc1
    buffer_load_dwordx2 v[28:29], v10, s[20:23], s36 offen offset:1024 sc1
    buffer_load_dwordx2 v[30:31], v10, s[20:23], s36 offen offset:2048 sc1
    buffer_load_dwordx2 v[32:33], v10, s[20:23], s36 offen offset:3072 sc1
    s_waitcnt vmcnt(16)
    s_barrier
    buffer_load_dwordx4 v2, s[12:15], s39 offen sc1 lds
    buffer_load_dwordx4 v2, s[12:15], s39 offen offset:1024 sc1 lds
    s_call_b64 s[76:77], PREP_a_issue_3
    s_add_u32 m0, m0, 2048
    s_add_u32 s39, s39, 65536
    buffer_load_dwordx4 v2, s[12:15], s39 offen sc1 lds
    buffer_load_dwordx4 v2, s[12:15], s39 offen offset:1024 sc1 lds
    s_add_u32 m0, m0, 2048
    s_add_u32 s39, s39, 65536
    buffer_load_dwordx4 v2, s[12:15], s39 offen sc1 lds
    buffer_load_dwordx4 v2, s[12:15], s39 offen offset:1024 sc1 lds
    s_add_u32 m0, m0, 2048
    s_add_u32 s39, s39, 65536
    buffer_load_dwordx4 v2, s[12:15], s39 offen sc1 lds
    buffer_load_dwordx4 v2, s[12:15], s39 offen offset:1024 sc1 lds
    s_mov_b32 m0, s19
    s_mov_b32 s39, s16
    s_add_u32 s36, s34, 16384
    buffer_load_dwordx2 v[34:35], v10, s[20:23], s36 offen offset:0 sc1
    buffer_load_dwordx2 v[36:37], v10, s[20:23], s36 offen offset:1024 sc1
    buffer_load_dwordx2 v[38:39], v10, s[20:23], s36 offen offset:2048 sc1
    buffer_load_dwordx2 v[40:41], v10, s[20:23], s36 offen offset:3072 sc1
    s_add_u32 s36, s36, 4096
    buffer_load_dwordx2 v[42:43], v10, s[20:23], s36 offen offset:0 sc1
    buffer_load_dwordx2 v[44:45], v10, s[20:23], s36 offen offset:1024 sc1
    buffer_load_dwordx2 v[46:47], v10, s[20:23], s36 offen offset:2048 sc1
    buffer_load_dwordx2 v[48:49], v10, s[20:23], s36 offen offset:3072 sc1
    s_waitcnt vmcnt(24)
    s_barrier
    buffer_load_dwordx4 v2, s[12:15], s39 offen sc1 lds
    buffer_load_dwordx4 v2, s[12:15], s39 offen offset:1024 sc1 lds
    s_call_b64 s[76:77], PREP_a_issue_3
    s_add_u32 m0, m0, 2048
    s_add_u32 s39, s39, 65536
    buffer_load_dwordx4 v2, s[12:15], s39 offen sc1 lds
    buffer_load_dwordx4 v2, s[12:15], s39 offen offset:1024 sc1 lds
    s_add_u32 m0, m0, 2048
    s_add_u32 s39, s39, 65536
    buffer_load_dwordx4 v2, s[12:15], s39 offen sc1 lds
    buffer_load_dwordx4 v2, s[12:15], s39 offen offset:1024 sc1 lds
    s_add_u32 m0, m0, 2048
    s_add_u32 s39, s39, 65536
    buffer_load_dwordx4 v2, s[12:15], s39 offen sc1 lds
    buffer_load_dwordx4 v2, s[12:15], s39 offen offset:1024 sc1 lds
    s_mov_b32 m0, s19
    s_mov_b32 s39, s16
    s_add_u32 s54, s52, 16
    s_waitcnt lgkmcnt(0)
    s_cmp_eq_u32 s3, s54
    s_cbranch_scc1 fok_36
    v_mov_b32 v15, s40
    s_mov_b32 s53, 0
    s_add_u32 s54, s52, 16
    s_bfm_b64 exec, 1, 0
poll_37:
    buffer_load_dword v14, v15, s[56:59], 0 offen sc1
    s_waitcnt vmcnt(0)
    v_cmp_eq_u32 vcc, s54, v14
    s_nop 0
    s_cmp_eq_u64 vcc, exec
    s_cbranch_scc1 pok_38
    s_sleep 5
    s_add_u32 s53, s53, 1
    s_cmp_lt_u32 s53, s61
    s_cbranch_scc1 poll_37
    s_mov_b32 s61, 0
pok_38:
    s_mov_b64 exec, -1
fok_36:
    s_add_u32 s24, s4, 0x1420000
    s_addc_u32 s25, s5, 0
    s_mov_b32 s26, 0x38000
    s_mov_b32 s27, 0x20000
    s_cmp_eq_u32 s60, 0
    s_cselect_b32 s26, s26, 0
    s_and_b32 s36, s30, 1
    s_mul_i32 s36, s36, 448
    s_mul_i32 s37, s29, 896
    s_add_u32 s37, s36, s37
    v_lshrrev_b32 v13, 5, v1
    v_mul_u32_u24 v13, 14336, v13
    v_and_b32 v6, 496, v2
    v_add_u32 v13, v13, v6
    buffer_load_dwordx4 v[54:57], v13, s[24:27], s37 offen sc1
    s_add_u32 s37, s37, 28672
    buffer_load_dwordx4 v[58:61], v13, s[24:27], s37 offen sc1
    s_add_u32 s37, s37, 28672
    buffer_load_dwordx4 v[62:65], v13, s[24:27], s37 offen sc1
    s_add_u32 s37, s37, 28672
    buffer_load_dwordx4 v[66:69], v13, s[24:27], s37 offen sc1
    s_add_u32 s37, s37, 28672
    buffer_load_dwordx4 v[70:73], v13, s[24:27], s37 offen sc1
    s_add_u32 s37, s37, 28672
    buffer_load_dwordx4 v[74:77], v13, s[24:27], s37 offen sc1
    s_add_u32 s37, s37, 28672
    buffer_load_dwordx4 v[78:81], v13, s[24:27], s37 offen sc1
    s_add_u32 s37, s37, 28672
    buffer_load_dwordx4 v[82:85], v13, s[24:27], s37 offen sc1
    s_add_u32 s37, s37, 28672
    s_waitcnt vmcnt(24)
    s_barrier
    buffer_load_dwordx4 v2, s[12:15], s39 offen sc1 lds
    buffer_load_dwordx4 v2, s[12:15], s39 offen offset:1024 sc1 lds
    s_call_b64 s[76:77], PREP_a_issue_3
    s_add_u32 m0, m0, 2048
    s_add_u32 s39, s39, 65536
    buffer_load_dwordx4 v2, s[12:15], s39 offen sc1 lds
    buffer_load_dwordx4 v2, s[12:15], s39 offen offset:1024 sc1 lds
    s_add_u32 m0, m0, 2048
    s_add_u32 s39, s39, 65536
    buffer_load_dwordx4 v2, s[12:15], s39 offen sc1 lds
    buffer_load_dwordx4 v2, s[12:15], s39 offen offset:1024 sc1 lds
    s_add_u32 m0, m0, 2048
    s_add_u32 s39, s39, 65536
    buffer_load_dwordx4 v2, s[12:15], s39 offen sc1 lds
    buffer_load_dwordx4 v2, s[12:15], s39 offen offset:1024 sc1 lds
    s_mov_b32 m0, s19
    s_mov_b32 s39, s16
    s_waitcnt vmcnt(24)
    v_pk_add_f32 v[18:19], v[18:19], v[34:35]
    v_pk_add_f32 v[20:21], v[20:21], v[36:37]
    v_pk_add_f32 v[22:23], v[22:23], v[38:39]
    v_pk_add_f32 v[24:25], v[24:25], v[40:41]
    v_pk_add_f32 v[26:27], v[26:27], v[42:43]
    v_pk_add_f32 v[28:29], v[28:29], v[44:45]
    v_pk_add_f32 v[30:31], v[30:31], v[46:47]
    v_pk_add_f32 v[32:33], v[32:33], v[48:49]
    v_pk_add_f32 v[18:19], v[18:19], v[26:27]
    v_pk_add_f32 v[20:21], v[20:21], v[28:29]
    v_pk_add_f32 v[22:23], v[22:23], v[30:31]
    v_pk_add_f32 v[24:25], v[24:25], v[32:33]
    s_waitcnt vmcnt(16)
    s_barrier
    buffer_load_dwordx4 v2, s[12:15], s39 offen sc1 lds
    buffer_load_dwordx4 v2, s[12:15], s39 offen offset:1024 sc1 lds
    s_call_b64 s[76:77], PREP_a_issue_3
    s_add_u32 m0, m0, 2048
    s_add_u32 s39, s39, 65536
    buffer_load_dwordx4 v2, s[12:15], s39 offen sc1 lds
    buffer_load_dwordx4 v2, s[12:15], s39 offen offset:1024 sc1 lds
    s_add_u32 m0, m0, 2048
    s_add_u32 s39, s39, 65536
    buffer_load_dwordx4 v2, s[12:15], s39 offen sc1 lds
    buffer_load_dwordx4 v2, s[12:15], s39 offen offset:1024 sc1 lds
    s_add_u32 m0, m0, 2048
    s_add_u32 s39, s39, 65536
    buffer_load_dwordx4 v2, s[12:15], s39 offen sc1 lds
    buffer_load_dwordx4 v2, s[12:15], s39 offen offset:1024 sc1 lds
    s_mov_b32 m0, s19
    s_mov_b32 s39, s16
    v_pk_add_f32 v[18:19], v[18:19], v[22:23]
    v_pk_add_f32 v[20:21], v[20:21], v[24:25]
    v_pk_add_f32 v[18:19], v[18:19], v[20:21]
    v_mul_f32 v52, 0x3a800000, v18
    v_mul_f32 v50, 0x3a800000, v19
    v_fma_f32 v50, -v52, v52, v50
    v_max_f32 v50, 0, v50
    v_cvt_pk_bf16_f32 v52, v52, v52
    v_lshlrev_b32 v52, 16, v52
    v_cvt_pk_bf16_f32 v50, v50, v50
    v_lshlrev_b32 v50, 16, v50
    s_waitcnt vmcnt(8)
    s_barrier
    buffer_load_dwordx4 v2, s[12:15], s39 offen sc1 lds
    buffer_load_dwordx4 v2, s[12:15], s39 offen offset:1024 sc1 lds
    s_add_u32 m0, m0, 2048
    s_add_u32 s39, s39, 65536
    buffer_load_dwordx4 v2, s[12:15], s39 offen sc1 lds
    buffer_load_dwordx4 v2, s[12:15], s39 offen offset:1024 sc1 lds
    s_add_u32 m0, m0, 2048
    s_add_u32 s39, s39, 65536
    buffer_load_dwordx4 v2, s[12:15], s39 offen sc1 lds
    buffer_load_dwordx4 v2, s[12:15], s39 offen offset:1024 sc1 lds
    s_add_u32 m0, m0, 2048
    s_add_u32 s39, s39, 65536
    buffer_load_dwordx4 v2, s[12:15], s39 offen sc1 lds
    buffer_load_dwordx4 v2, s[12:15], s39 offen offset:1024 sc1 lds
    s_waitcnt vmcnt(24)
    v_add_f32 v50, 0x3727c5ac, v50
    v_cvt_pk_bf16_f32 v50, v50, v50
    v_lshlrev_b32 v50, 16, v50
    v_sqrt_f32 v50, v50
    s_nop 0
    v_cvt_pk_bf16_f32 v50, v50, v50
    v_lshlrev_b32 v50, 16, v50
    v_rcp_f32 v53, v50
    s_add_u32 s36, s34, 160768
    v_add_u32 v51, s36, v10
    ds_write_b64 v51, v[52:53]
    s_waitcnt lgkmcnt(0)
    s_cmp_lg_u32 s60, 0
    s_cbranch_scc1 pc_42
    v_pk_add_f32 v[54:55], v[54:55], v[58:59]
    v_pk_add_f32 v[56:57], v[56:57], v[60:61]
    v_pk_add_f32 v[54:55], v[54:55], v[62:63]
    v_pk_add_f32 v[56:57], v[56:57], v[64:65]
    v_pk_add_f32 v[54:55], v[54:55], v[66:67]
    v_pk_add_f32 v[56:57], v[56:57], v[68:69]
    v_pk_add_f32 v[54:55], v[54:55], v[70:71]
    v_pk_add_f32 v[56:57], v[56:57], v[72:73]
pc_42:
    s_waitcnt vmcnt(8)
    s_barrier
    s_cmp_lg_u32 s60, 0
    s_cbranch_scc1 pc_43
    v_pk_add_f32 v[54:55], v[54:55], v[74:75]
    v_pk_add_f32 v[56:57], v[56:57], v[76:77]
    v_pk_add_f32 v[54:55], v[54:55], v[78:79]
    v_pk_add_f32 v[56:57], v[56:57], v[80:81]
    v_pk_add_f32 v[54:55], v[54:55], v[82:83]
    v_pk_add_f32 v[56:57], v[56:57], v[84:85]
    v_mov_b32 v58, v54
    v_mov_b32 v59, v55
    v_mov_b32 v60, v56
    v_mov_b32 v61, v57
    v_permlane32_swap_b32 v54, v58
    v_permlane32_swap_b32 v55, v59
    v_permlane32_swap_b32 v56, v60
    v_permlane32_swap_b32 v57, v61
    v_pk_add_f32 v[54:55], v[54:55], v[58:59]
    v_pk_add_f32 v[56:57], v[56:57], v[60:61]
    s_and_b32 s36, s30, 1
    s_mul_i32 s36, s36, 448
    s_add_u32 s36, s36, 159744
    v_add_u32 v6, s36, v2
    s_bfm_b64 exec, 28, 0
    ds_write_b128 v6, v[54:57]
    s_mov_b64 exec, -1
    s_waitcnt lgkmcnt(0)
pc_43:
    s_waitcnt vmcnt(0)
    s_barrier
    s_cmp_lg_u32 s60, 0
    s_cbranch_scc1 tw4_44
    s_mov_b64 s[48:49], s[74:75]
    s_lshl_b32 s45, s2, 1
    s_and_b32 s50, s30, 1
    s_add_u32 s45, s45, s50
    s_mul_i32 s45, s45, 14336
    s_mov_b32 s50, 7340032
    s_mov_b32 s51, 0x20000
    buffer_load_dwordx4 v[60:63], v2, s[48:51], s45 offen offset:0
    buffer_load_dwordx4 v[60:63], v2, s[48:51], s45 offen offset:1024
    buffer_load_dwordx4 v[60:63], v2, s[48:51], s45 offen offset:2048
    buffer_load_dwordx4 v[60:63], v2, s[48:51], s45 offen offset:3072
    s_add_u32 s45, s45, 4096
    buffer_load_dwordx4 v[60:63], v2, s[48:51], s45 offen offset:0
    buffer_load_dwordx4 v[60:63], v2, s[48:51], s45 offen offset:1024
    buffer_load_dwordx4 v[60:63], v2, s[48:51], s45 offen offset:2048
    buffer_load_dwordx4 v[60:63], v2, s[48:51], s45 offen offset:3072
    s_add_u32 s45, s45, 4096
    buffer_load_dwordx4 v[60:63], v2, s[48:51], s45 offen offset:0
    buffer_load_dwordx4 v[60:63], v2, s[48:51], s45 offen offset:1024
    buffer_load_dwordx4 v[60:63], v2, s[48:51], s45 offen offset:2048
    buffer_load_dwordx4 v[60:63], v2, s[48:51], s45 offen offset:3072
    s_add_u32 s45, s45, 4096
    buffer_load_dwordx4 v[60:63], v2, s[48:51], s45 offen offset:0
    buffer_load_dwordx4 v[60:63], v2, s[48:51], s45 offen offset:1024
tw4_44:
    s_barrier
    s_and_b32 s35, s30, 1
    s_mov_b32 s12, s62
    s_mov_b32 s13, s63
    s_mov_b32 s14, 0x1be000
    s_mov_b32 s15, 0x20000
    s_mul_i32 s38, s35, 917504
    s_mul_i32 s36, s31, 573440
    s_add_u32 s38, s38, s36
    s_mul_i32 s37, s31, 917504
    s_sub_u32 s37, 229376, s37
    s_lshl_b32 s41, s35, 13
    s_mov_b32 s42, 0
    s_mov_b32 s44, 0
    s_and_b32 s34, s30, 1
    s_lshl1_add_u32 s34, s31, s34
    s_lshl_b32 s34, s34, 7
    s_add_u32 s34, s34, s55
    s_add_u32 s34, s34, 0x1200
    s_and_b32 s35, s30, 1
    s_lshl1_add_u32 s35, s31, s35
    s_lshl_b32 s35, s35, 7
    s_add_u32 s35, s35, s55
    s_add_u32 s35, s35, 0x1400
    s_sub_u32 s48, s34, 512
    s_mov_b32 s44, 3
    s_add_u32 s36, s33, 4
    s_and_b32 s36, s36, 7
    s_mul_i32 s36, s36, 7
    s_add_u32 s36, s36, 2
    s_lshr_b32 s53, s36, 3
    s_lshl_b32 s53, s53, 14
    s_and_b32 s78, s36, 7
    s_lshl_b32 s78, s78, 10
    s_add_u32 s78, s78, s53
    s_add_u32 s36, s33, 4
    s_and_b32 s36, s36, 7
    s_mul_i32 s36, s36, 7
    s_add_u32 s36, s36, 6
    s_lshr_b32 s53, s36, 3
    s_lshl_b32 s53, s53, 14
    s_and_b32 s79, s36, 7
    s_lshl_b32 s79, s79, 10
    s_add_u32 s79, s79, s53
    s_add_u32 s36, s33, 4
    s_and_b32 s36, s36, 7
    s_mul_i32 s36, s36, 7
    s_add_u32 s36, s36, 3
    s_lshr_b32 s53, s36, 3
    s_lshl_b32 s53, s53, 14
    s_and_b32 s80, s36, 7
    s_lshl_b32 s80, s80, 10
    s_add_u32 s80, s80, s53
    s_add_u32 s36, s33, 5
    s_and_b32 s36, s36, 7
    s_mul_i32 s36, s36, 7
    s_add_u32 s36, s36, 2
    s_lshr_b32 s53, s36, 3
    s_lshl_b32 s53, s53, 14
    s_and_b32 s81, s36, 7
    s_lshl_b32 s81, s81, 10
    s_add_u32 s81, s81, s53
    s_add_u32 s36, s33, 5
    s_and_b32 s36, s36, 7
    s_mul_i32 s36, s36, 7
    s_add_u32 s36, s36, 6
    s_lshr_b32 s53, s36, 3
    s_lshl_b32 s53, s53, 14
    s_and_b32 s82, s36, 7
    s_lshl_b32 s82, s82, 10
    s_add_u32 s82, s82, s53
    s_add_u32 s36, s33, 5
    s_and_b32 s36, s36, 7
    s_mul_i32 s36, s36, 7
    s_add_u32 s36, s36, 3
    s_lshr_b32 s53, s36, 3
    s_lshl_b32 s53, s53, 14
    s_and_b32 s83, s36, 7
    s_lshl_b32 s83, s83, 10
    s_add_u32 s83, s83, s53
    s_add_u32 s36, s33, 6
    s_and_b32 s36, s36, 7
    s_mul_i32 s36, s36, 7
    s_add_u32 s36, s36, 2
    s_lshr_b32 s53, s36, 3
    s_lshl_b32 s53, s53, 14
    s_and_b32 s84, s36, 7
    s_lshl_b32 s84, s84, 10
    s_add_u32 s84, s84, s53
    s_add_u32 s36, s33, 6
    s_and_b32 s36, s36, 7
    s_mul_i32 s36, s36, 7
    s_add_u32 s36, s36, 6
    s_lshr_b32 s53, s36, 3
    s_lshl_b32 s53, s53, 14
    s_and_b32 s85, s36, 7
    s_lshl_b32 s85, s85, 10
    s_add_u32 s85, s85, s53
    s_add_u32 s36, s33, 6
    s_and_b32 s36, s36, 7
    s_mul_i32 s36, s36, 7
    s_add_u32 s36, s36, 3
    s_lshr_b32 s53, s36, 3
    s_lshl_b32 s53, s53, 14
    s_and_b32 s86, s36, 7
    s_lshl_b32 s86, s86, 10
    s_add_u32 s86, s86, s53
    s_add_u32 s36, s33, 7
    s_and_b32 s36, s36, 7
    s_mul_i32 s36, s36, 7
    s_add_u32 s36, s36, 2
    s_lshr_b32 s53, s36, 3
    s_lshl_b32 s53, s53, 14
    s_and_b32 s87, s36, 7
    s_lshl_b32 s87, s87, 10
    s_add_u32 s87, s87, s53
    s_add_u32 s36, s33, 7
    s_and_b32 s36, s36, 7
    s_mul_i32 s36, s36, 7
    s_add_u32 s36, s36, 6
    s_lshr_b32 s53, s36, 3
    s_lshl_b32 s53, s53, 14
    s_and_b32 s88, s36, 7
    s_lshl_b32 s88, s88, 10
    s_add_u32 s88, s88, s53
    s_add_u32 s36, s33, 7
    s_and_b32 s36, s36, 7
    s_mul_i32 s36, s36, 7
    s_add_u32 s36, s36, 3
    s_lshr_b32 s53, s36, 3
    s_lshl_b32 s53, s53, 14
    s_and_b32 s89, s36, 7
    s_lshl_b32 s89, s89, 10
    s_add_u32 s89, s89, s53
    s_mov_b64 s[8:9], s[68:69]
    s_mov_b32 s10, 2097152
    s_mov_b32 s11, 0x20000
    s_and_b32 s3, s30, 3
    s_lshl_b32 s36, s3, 14
    s_lshl_b32 s90, s29, 7
    s_add_u32 s90, s90, s36
    s_xor_b32 s90, s90, 128
    s_lshl_b32 s3, s3, 10
    s_call_b64 s[76:77], PREP_a_issue_4
    s_mov_b32 m0, s19
    s_mov_b32 s39, s16
    s_mov_b32 s40, s17
    s_waitcnt vmcnt(16)
    s_barrier
    s_load_dword s32, s[4:5], s48
    s_waitcnt vmcnt(8)
    s_barrier
    s_add_u32 s54, s52, 16
    s_waitcnt lgkmcnt(0)
    s_cmp_eq_u32 s32, s54
    s_cbranch_scc1 fok_45
    v_mov_b32 v9, s48
    s_mov_b32 s53, 0
    s_add_u32 s54, s52, 16
    s_bfm_b64 exec, 1, 0
poll_46:
    buffer_load_dword v8, v9, s[56:59], 0 offen sc1
    s_waitcnt vmcnt(0)
    v_cmp_eq_u32 vcc, s54, v8
    s_nop 0
    s_cmp_eq_u64 vcc, exec
    s_cbranch_scc1 pok_47
    s_sleep 5
    s_add_u32 s53, s53, 1
    s_cmp_lt_u32 s53, s61
    s_cbranch_scc1 poll_46
    s_mov_b32 s61, 0
pok_47:
    s_mov_b64 exec, -1
fok_45:
    buffer_load_dwordx4 v2, s[12:15], s39 offen sc1 lds
    s_add_u32 m0, m0, 1024
    s_nop 0
    buffer_load_dwordx4 v2, s[12:15], s40 offen sc1 lds
    s_call_b64 s[76:77], PREP_a_issue_4
    s_add_u32 m0, m0, 1024
    s_add_u32 s39, s39, 229376
    buffer_load_dwordx4 v2, s[12:15], s39 offen sc1 lds
    s_add_u32 m0, m0, 1024
    s_add_u32 s40, s40, 229376
    buffer_load_dwordx4 v2, s[12:15], s40 offen sc1 lds
    s_add_u32 m0, m0, 1024
    s_add_u32 s39, s39, s37
    buffer_load_dwordx4 v2, s[12:15], s39 offen sc1 lds
    s_add_u32 m0, m0, 1024
    s_add_u32 s40, s40, s37
    buffer_load_dwordx4 v2, s[12:15], s40 offen sc1 lds
    s_add_u32 m0, m0, 1024
    s_add_u32 s39, s39, 229376
    buffer_load_dwordx4 v2, s[12:15], s39 offen sc1 lds
    s_add_u32 m0, m0, 1024
    s_add_u32 s40, s40, 229376
    buffer_load_dwordx4 v2, s[12:15], s40 offen sc1 lds
    s_mov_b32 m0, s19
    s_mov_b32 s39, s16
    s_mov_b32 s40, s17
    s_waitcnt vmcnt(8)
    s_barrier
    buffer_load_dwordx4 v2, s[12:15], s39 offen sc1 lds
    s_add_u32 m0, m0, 1024
    s_nop 0
    buffer_load_dwordx4 v2, s[12:15], s40 offen sc1 lds
    s_mov_b32 s43, 1
ld_48:
    s_add_u32 s19, s41, s42
    s_lshl_b32 s45, s44, 1
    s_add_u32 s45, s45, 0
    s_sub_u32 s45, s45, 32
    s_mul_i32 s46, s45, 86
    s_lshr_b32 s46, s46, 8
    s_mul_i32 s47, s46, 3
    s_sub_u32 s47, s45, s47
    s_lshl_b32 s47, s47, 2
    s_lshr_b32 s47, 0x362, s47
    s_and_b32 s47, s47, 7
    s_cmp_ge_u32 s44, 10
    s_cselect_b32 s45, 9, 2
    s_cselect_b32 s51, 1, 0
    s_sub_u32 s45, s44, s45
    s_cmp_lt_u32 s44, 3
    s_cselect_b32 s45, 0, s45
    s_cselect_b32 s51, s44, s51
    s_lshl2_add_u32 s51, 0, s51
    s_cmp_lt_u32 s44, 17
    s_cselect_b32 s47, s51, s47
    s_cselect_b32 s46, s45, s46
    s_add_u32 s46, s46, s33
    s_and_b32 s46, s46, 7
    s_mul_i32 s46, s46, 7
    s_add_u32 s16, s46, s47
    s_lshr_b32 s53, s16, 3
    s_lshl_b32 s53, s53, 14
    s_and_b32 s16, s16, 7
    s_lshl_b32 s16, s16, 10
    s_add_u32 s16, s16, s53
    s_add_u32 s16, s16, s38
    s_lshl_b32 s45, s44, 1
    s_add_u32 s45, s45, 1
    s_sub_u32 s45, s45, 32
    s_mul_i32 s46, s45, 86
    s_lshr_b32 s46, s46, 8
    s_mul_i32 s47, s46, 3
    s_sub_u32 s47, s45, s47
    s_lshl_b32 s47, s47, 2
    s_lshr_b32 s47, 0x362, s47
    s_and_b32 s47, s47, 7
    s_cmp_ge_u32 s44, 10
    s_cselect_b32 s45, 9, 2
    s_cselect_b32 s51, 1, 0
    s_sub_u32 s45, s44, s45
    s_cmp_lt_u32 s44, 3
    s_cselect_b32 s45, 0, s45
    s_cselect_b32 s51, s44, s51
    s_lshl2_add_u32 s51, 1, s51
    s_cmp_lt_u32 s44, 17
    s_cselect_b32 s47, s51, s47
    s_cselect_b32 s46, s45, s46
    s_add_u32 s46, s46, s33
    s_and_b32 s46, s46, 7
    s_mul_i32 s46, s46, 7
    s_add_u32 s17, s46, s47
    s_lshr_b32 s53, s17, 3
    s_lshl_b32 s53, s53, 14
    s_and_b32 s17, s17, 7
    s_lshl_b32 s17, s17, 10
    s_add_u32 s17, s17, s53
    s_add_u32 s17, s17, s38
    s_add_u32 s44, s44, 1
    s_add_u32 s42, s42, 16384
    s_cmp_eq_u32 s42, 49152
    s_cselect_b32 s42, 0, s42
    s_add_u32 m0, m0, 1024
    s_add_u32 s39, s39, 229376
    buffer_load_dwordx4 v2, s[12:15], s39 offen sc1 lds
    s_add_u32 m0, m0, 1024
    s_add_u32 s40, s40, 229376
    buffer_load_dwordx4 v2, s[12:15], s40 offen sc1 lds
    s_add_u32 m0, m0, 1024
    s_add_u32 s39, s39, s37
    buffer_load_dwordx4 v2, s[12:15], s39 offen sc1 lds
    s_add_u32 m0, m0, 1024
    s_add_u32 s40, s40, s37
    buffer_load_dwordx4 v2, s[12:15], s40 offen sc1 lds
    s_add_u32 m0, m0, 1024
    s_add_u32 s39, s39, 229376
    buffer_load_dwordx4 v2, s[12:15], s39 offen sc1 lds
    s_add_u32 m0, m0, 1024
    s_add_u32 s40, s40, 229376
    buffer_load_dwordx4 v2, s[12:15], s40 offen sc1 lds
    s_mov_b32 m0, s19
    s_mov_b32 s39, s16
    s_mov_b32 s40, s17
    s_waitcnt vmcnt(8)
    s_barrier
    buffer_load_dwordx4 v2, s[12:15], s39 offen sc1 lds
    s_add_u32 m0, m0, 1024
    s_nop 0
    buffer_load_dwordx4 v2, s[12:15], s40 offen sc1 lds
    s_add_u32 s43, s43, 1
    s_cmp_lt_u32 s43, 4
    s_cbranch_scc1 ld_48
    s_call_b64 s[76:77], PREP_a_issue_4
    s_add_u32 m0, m0, 1024
    s_add_u32 s39, s39, 229376
    buffer_load_dwordx4 v2, s[12:15], s39 offen sc1 lds
    s_add_u32 m0, m0, 1024
    s_add_u32 s40, s40, 229376
    buffer_load_dwordx4 v2, s[12:15], s40 offen sc1 lds
    s_add_u32 m0, m0, 1024
    s_add_u32 s39, s39, s37
    buffer_load_dwordx4 v2, s[12:15], s39 offen sc1 lds
    s_add_u32 m0, m0, 1024
    s_add_u32 s40, s40, s37
    buffer_load_dwordx4 v2, s[12:15], s40 offen sc1 lds
    s_add_u32 m0, m0, 1024
    s_add_u32 s39, s39, 229376
    buffer_load_dwordx4 v2, s[12:15], s39 offen sc1 lds
    s_add_u32 m0, m0, 1024
    s_add_u32 s40, s40, 229376
    buffer_load_dwordx4 v2, s[12:15], s40 offen sc1 lds
    s_mov_b32 m0, s19
    s_mov_b32 s39, s16
    s_mov_b32 s40, s17
    s_waitcnt vmcnt(8)
    s_barrier
    buffer_load_dwordx4 v2, s[12:15], s39 offen sc1 lds
    s_add_u32 m0, m0, 1024
    s_nop 0
    buffer_load_dwordx4 v2, s[12:15], s40 offen sc1 lds
    s_load_dword s32, s[4:5], s34
    s_call_b64 s[76:77], PREP_a_issue_4
    s_add_u32 m0, m0, 1024
    s_add_u32 s39, s39, 229376
    buffer_load_dwordx4 v2, s[12:15], s39 offen sc1 lds
    s_add_u32 m0, m0, 1024
    s_add_u32 s40, s40, 229376
    buffer_load_dwordx4 v2, s[12:15], s40 offen sc1 lds
    s_add_u32 m0, m0, 1024
    s_add_u32 s39, s39, s37
    buffer_load_dwordx4 v2, s[12:15], s39 offen sc1 lds
    s_add_u32 m0, m0, 1024
    s_add_u32 s40, s40, s37
    buffer_load_dwordx4 v2, s[12:15], s40 offen sc1 lds
    s_add_u32 m0, m0, 1024
    s_add_u32 s39, s39, 229376
    buffer_load_dwordx4 v2, s[12:15], s39 offen sc1 lds
    s_add_u32 m0, m0, 1024
    s_add_u32 s40, s40, 229376
    buffer_load_dwordx4 v2, s[12:15], s40 offen sc1 lds
    s_mov_b32 m0, s19
    s_mov_b32 s39, s16
    s_mov_b32 s40, s17
    s_waitcnt vmcnt(8)
    s_barrier
    buffer_load_dwordx4 v2, s[12:15], s39 offen sc1 lds
    s_add_u32 m0, m0, 1024
    s_nop 0
    buffer_load_dwordx4 v2, s[12:15], s40 offen sc1 lds
    s_add_u32 s54, s52, 16
    s_waitcnt lgkmcnt(0)
    s_cmp_eq_u32 s32, s54
    s_cbranch_scc1 fok_49
    v_mov_b32 v9, s34
    s_mov_b32 s53, 0
    s_add_u32 s54, s52, 16
    s_bfm_b64 exec, 1, 0
poll_50:
    buffer_load_dword v8, v9, s[56:59], 0 offen sc1
    s_waitcnt vmcnt(0)
    v_cmp_eq_u32 vcc, s54, v8
    s_nop 0
    s_cmp_eq_u64 vcc, exec
    s_cbranch_scc1 pok_51
    s_sleep 5
    s_add_u32 s53, s53, 1
    s_cmp_lt_u32 s53, s61
    s_cbranch_scc1 poll_50
    s_mov_b32 s61, 0
pok_51:
    s_mov_b64 exec, -1
fok_49:
    s_call_b64 s[76:77], PREP_a_issue_4
    s_add_u32 m0, m0, 1024
    s_add_u32 s39, s39, 229376
    buffer_load_dwordx4 v2, s[12:15], s39 offen sc1 lds
    s_add_u32 m0, m0, 1024
    s_add_u32 s40, s40, 229376
    buffer_load_dwordx4 v2, s[12:15], s40 offen sc1 lds
    s_add_u32 m0, m0, 1024
    s_add_u32 s39, s39, s37
    buffer_load_dwordx4 v2, s[12:15], s39 offen sc1 lds
    s_add_u32 m0, m0, 1024
    s_add_u32 s40, s40, s37
    buffer_load_dwordx4 v2, s[12:15], s40 offen sc1 lds
    s_add_u32 m0, m0, 1024
    s_add_u32 s39, s39, 229376
    buffer_load_dwordx4 v2, s[12:15], s39 offen sc1 lds
    s_add_u32 m0, m0, 1024
    s_add_u32 s40, s40, 229376
    buffer_load_dwordx4 v2, s[12:15], s40 offen sc1 lds
    s_mov_b32 m0, s19
    s_mov_b32 s39, s16
    s_mov_b32 s40, s17
    s_waitcnt vmcnt(8)
    s_barrier
    buffer_load_dwordx4 v2, s[12:15], s39 offen sc1 lds
    s_add_u32 m0, m0, 1024
    s_nop 0
    buffer_load_dwordx4 v2, s[12:15], s40 offen sc1 lds
    s_mov_b32 s43, 1
ld_52:
    s_add_u32 s19, s41, s42
    s_lshl_b32 s45, s44, 1
    s_add_u32 s45, s45, 0
    s_sub_u32 s45, s45, 32
    s_mul_i32 s46, s45, 86
    s_lshr_b32 s46, s46, 8
    s_mul_i32 s47, s46, 3
    s_sub_u32 s47, s45, s47
    s_lshl_b32 s47, s47, 2
    s_lshr_b32 s47, 0x362, s47
    s_and_b32 s47, s47, 7
    s_cmp_ge_u32 s44, 10
    s_cselect_b32 s45, 9, 2
    s_cselect_b32 s51, 1, 0
    s_sub_u32 s45, s44, s45
    s_cmp_lt_u32 s44, 3
    s_cselect_b32 s45, 0, s45
    s_cselect_b32 s51, s44, s51
    s_lshl2_add_u32 s51, 0, s51
    s_cmp_lt_u32 s44, 17
    s_cselect_b32 s47, s51, s47
    s_cselect_b32 s46, s45, s46
    s_add_u32 s46, s46, s33
    s_and_b32 s46, s46, 7
    s_mul_i32 s46, s46, 7
    s_add_u32 s16, s46, s47
    s_lshr_b32 s53, s16, 3
    s_lshl_b32 s53, s53, 14
    s_and_b32 s16, s16, 7
    s_lshl_b32 s16, s16, 10
    s_add_u32 s16, s16, s53
    s_add_u32 s16, s16, s38
    s_lshl_b32 s45, s44, 1
    s_add_u32 s45, s45, 1
    s_sub_u32 s45, s45, 32
    s_mul_i32 s46, s45, 86
    s_lshr_b32 s46, s46, 8
    s_mul_i32 s47, s46, 3
    s_sub_u32 s47, s45, s47
    s_lshl_b32 s47, s47, 2
    s_lshr_b32 s47, 0x362, s47
    s_and_b32 s47, s47, 7
    s_cmp_ge_u32 s44, 10
    s_cselect_b32 s45, 9, 2
    s_cselect_b32 s51, 1, 0
    s_sub_u32 s45, s44, s45
    s_cmp_lt_u32 s44, 3
    s_cselect_b32 s45, 0, s45
    s_cselect_b32 s51, s44, s51
    s_lshl2_add_u32 s51, 1, s51
    s_cmp_lt_u32 s44, 17
    s_cselect_b32 s47, s51, s47
    s_cselect_b32 s46, s45, s46
    s_add_u32 s46, s46, s33
    s_and_b32 s46, s46, 7
    s_mul_i32 s46, s46, 7
    s_add_u32 s17, s46, s47
    s_lshr_b32 s53, s17, 3
    s_lshl_b32 s53, s53, 14
    s_and_b32 s17, s17, 7
    s_lshl_b32 s17, s17, 10
    s_add_u32 s17, s17, s53
    s_add_u32 s17, s17, s38
    s_add_u32 s44, s44, 1
    s_add_u32 s42, s42, 16384
    s_cmp_eq_u32 s42, 49152
    s_cselect_b32 s42, 0, s42
    s_add_u32 m0, m0, 1024
    s_add_u32 s39, s39, 229376
    buffer_load_dwordx4 v2, s[12:15], s39 offen sc1 lds
    s_add_u32 m0, m0, 1024
    s_add_u32 s40, s40, 229376
    buffer_load_dwordx4 v2, s[12:15], s40 offen sc1 lds
    s_add_u32 m0, m0, 1024
    s_add_u32 s39, s39, s37
    buffer_load_dwordx4 v2, s[12:15], s39 offen sc1 lds
    s_add_u32 m0, m0, 1024
    s_add_u32 s40, s40, s37
    buffer_load_dwordx4 v2, s[12:15], s40 offen sc1 lds
    s_add_u32 m0, m0, 1024
    s_add_u32 s39, s39, 229376
    buffer_load_dwordx4 v2, s[12:15], s39 offen sc1 lds
    s_add_u32 m0, m0, 1024
    s_add_u32 s40, s40, 229376
    buffer_load_dwordx4 v2, s[12:15], s40 offen sc1 lds
    s_mov_b32 m0, s19
    s_mov_b32 s39, s16
    s_mov_b32 s40, s17
    s_waitcnt vmcnt(8)
    s_barrier
    buffer_load_dwordx4 v2, s[12:15], s39 offen sc1 lds
    s_add_u32 m0, m0, 1024
    s_nop 0
    buffer_load_dwordx4 v2, s[12:15], s40 offen sc1 lds
    s_add_u32 s43, s43, 1
    s_cmp_lt_u32 s43, 5
    s_cbranch_scc1 ld_52
    s_call_b64 s[76:77], PREP_a_issue_4
    s_add_u32 m0, m0, 1024
    s_add_u32 s39, s39, 229376
    buffer_load_dwordx4 v2, s[12:15], s39 offen sc1 lds
    s_add_u32 m0, m0, 1024
    s_add_u32 s40, s40, 229376
    buffer_load_dwordx4 v2, s[12:15], s40 offen sc1 lds
    s_add_u32 m0, m0, 1024
    s_add_u32 s39, s39, s37
    buffer_load_dwordx4 v2, s[12:15], s39 offen sc1 lds
    s_add_u32 m0, m0, 1024
    s_add_u32 s40, s40, s37
    buffer_load_dwordx4 v2, s[12:15], s40 offen sc1 lds
    s_add_u32 m0, m0, 1024
    s_add_u32 s39, s39, 229376
    buffer_load_dwordx4 v2, s[12:15], s39 offen sc1 lds
    s_add_u32 m0, m0, 1024
    s_add_u32 s40, s40, 229376
    buffer_load_dwordx4 v2, s[12:15], s40 offen sc1 lds
    s_mov_b32 m0, s19
    s_mov_b32 s39, s16
    s_mov_b32 s40, s17
    s_waitcnt vmcnt(8)
    s_barrier
    buffer_load_dwordx4 v2, s[12:15], s39 offen sc1 lds
    s_add_u32 m0, m0, 1024
    s_nop 0
    buffer_load_dwordx4 v2, s[12:15], s40 offen sc1 lds
    s_load_dword s32, s[4:5], s35
    s_call_b64 s[76:77], PREP_a_issue_4
    s_add_u32 m0, m0, 1024
    s_add_u32 s39, s39, 229376
    buffer_load_dwordx4 v2, s[12:15], s39 offen sc1 lds
    s_add_u32 m0, m0, 1024
    s_add_u32 s40, s40, 229376
    buffer_load_dwordx4 v2, s[12:15], s40 offen sc1 lds
    s_add_u32 m0, m0, 1024
    s_add_u32 s39, s39, s37
    buffer_load_dwordx4 v2, s[12:15], s39 offen sc1 lds
    s_add_u32 m0, m0, 1024
    s_add_u32 s40, s40, s37
    buffer_load_dwordx4 v2, s[12:15], s40 offen sc1 lds
    s_add_u32 m0, m0, 1024
    s_add_u32 s39, s39, 229376
    buffer_load_dwordx4 v2, s[12:15], s39 offen sc1 lds
    s_add_u32 m0, m0, 1024
    s_add_u32 s40, s40, 229376
    buffer_load_dwordx4 v2, s[12:15], s40 offen sc1 lds
    s_mov_b32 m0, s19
    s_mov_b32 s39, s16
    s_mov_b32 s40, s17
    s_waitcnt vmcnt(8)
    s_barrier
    buffer_load_dwordx4 v2, s[12:15], s39 offen sc1 lds
    s_add_u32 m0, m0, 1024
    s_nop 0
    buffer_load_dwordx4 v2, s[12:15], s40 offen sc1 lds
    s_add_u32 s54, s52, 16
    s_waitcnt lgkmcnt(0)
    s_cmp_eq_u32 s32, s54
    s_cbranch_scc1 fok_53
    v_mov_b32 v9, s35
    s_mov_b32 s53, 0
    s_add_u32 s54, s52, 16
    s_bfm_b64 exec, 1, 0
poll_54:
    buffer_load_dword v8, v9, s[56:59], 0 offen sc1
    s_waitcnt vmcnt(0)
    v_cmp_eq_u32 vcc, s54, v8
    s_nop 0
    s_cmp_eq_u64 vcc, exec
    s_cbranch_scc1 pok_55
    s_sleep 5
    s_add_u32 s53, s53, 1
    s_cmp_lt_u32 s53, s61
    s_cbranch_scc1 poll_54
    s_mov_b32 s61, 0
pok_55:
    s_mov_b64 exec, -1
fok_53:
    s_call_b64 s[76:77], PREP_a_issue_4
    s_add_u32 m0, m0, 1024
    s_add_u32 s39, s39, 229376
    buffer_load_dwordx4 v2, s[12:15], s39 offen sc1 lds
    s_add_u32 m0, m0, 1024
    s_add_u32 s40, s40, 229376
    buffer_load_dwordx4 v2, s[12:15], s40 offen sc1 lds
    s_add_u32 m0, m0, 1024
    s_add_u32 s39, s39, s37
    buffer_load_dwordx4 v2, s[12:15], s39 offen sc1 lds
    s_add_u32 m0, m0, 1024
    s_add_u32 s40, s40, s37
    buffer_load_dwordx4 v2, s[12:15], s40 offen sc1 lds
    s_add_u32 m0, m0, 1024
    s_add_u32 s39, s39, 229376
    buffer_load_dwordx4 v2, s[12:15], s39 offen sc1 lds
    s_add_u32 m0, m0, 1024
    s_add_u32 s40, s40, 229376
    buffer_load_dwordx4 v2, s[12:15], s40 offen sc1 lds
    s_mov_b32 m0, s19
    s_mov_b32 s39, s16
    s_mov_b32 s40, s17
    s_waitcnt vmcnt(8)
    s_barrier
    buffer_load_dwordx4 v2, s[12:15], s39 offen sc1 lds
    s_add_u32 m0, m0, 1024
    s_nop 0
    buffer_load_dwordx4 v2, s[12:15], s40 offen sc1 lds
    s_mov_b32 s43, 1
ld_56:
    s_add_u32 s19, s41, s42
    s_lshl_b32 s45, s44, 1
    s_add_u32 s45, s45, 0
    s_sub_u32 s45, s45, 32
    s_mul_i32 s46, s45, 86
    s_lshr_b32 s46, s46, 8
    s_mul_i32 s47, s46, 3
    s_sub_u32 s47, s45, s47
    s_lshl_b32 s47, s47, 2
    s_lshr_b32 s47, 0x362, s47
    s_and_b32 s47, s47, 7
    s_cmp_ge_u32 s44, 10
    s_cselect_b32 s45, 9, 2
    s_cselect_b32 s51, 1, 0
    s_sub_u32 s45, s44, s45
    s_cmp_lt_u32 s44, 3
    s_cselect_b32 s45, 0, s45
    s_cselect_b32 s51, s44, s51
    s_lshl2_add_u32 s51, 0, s51
    s_cmp_lt_u32 s44, 17
    s_cselect_b32 s47, s51, s47
    s_cselect_b32 s46, s45, s46
    s_add_u32 s46, s46, s33
    s_and_b32 s46, s46, 7
    s_mul_i32 s46, s46, 7
    s_add_u32 s16, s46, s47
    s_lshr_b32 s53, s16, 3
    s_lshl_b32 s53, s53, 14
    s_and_b32 s16, s16, 7
    s_lshl_b32 s16, s16, 10
    s_add_u32 s16, s16, s53
    s_add_u32 s16, s16, s38
    s_lshl_b32 s45, s44, 1
    s_add_u32 s45, s45, 1
    s_sub_u32 s45, s45, 32
    s_mul_i32 s46, s45, 86
    s_lshr_b32 s46, s46, 8
    s_mul_i32 s47, s46, 3
    s_sub_u32 s47, s45, s47
    s_lshl_b32 s47, s47, 2
    s_lshr_b32 s47, 0x362, s47
    s_and_b32 s47, s47, 7
    s_cmp_ge_u32 s44, 10
    s_cselect_b32 s45, 9, 2
    s_cselect_b32 s51, 1, 0
    s_sub_u32 s45, s44, s45
    s_cmp_lt_u32 s44, 3
    s_cselect_b32 s45, 0, s45
    s_cselect_b32 s51, s44, s51
    s_lshl2_add_u32 s51, 1, s51
    s_cmp_lt_u32 s44, 17
    s_cselect_b32 s47, s51, s47
    s_cselect_b32 s46, s45, s46
    s_add_u32 s46, s46, s33
    s_and_b32 s46, s46, 7
    s_mul_i32 s46, s46, 7
    s_add_u32 s17, s46, s47
    s_lshr_b32 s53, s17, 3
    s_lshl_b32 s53, s53, 14
    s_and_b32 s17, s17, 7
    s_lshl_b32 s17, s17, 10
    s_add_u32 s17, s17, s53
    s_add_u32 s17, s17, s38
    s_add_u32 s44, s44, 1
    s_add_u32 s42, s42, 16384
    s_cmp_eq_u32 s42, 49152
    s_cselect_b32 s42, 0, s42
    s_add_u32 m0, m0, 1024
    s_add_u32 s39, s39, 229376
    buffer_load_dwordx4 v2, s[12:15], s39 offen sc1 lds
    s_add_u32 m0, m0, 1024
    s_add_u32 s40, s40, 229376
    buffer_load_dwordx4 v2, s[12:15], s40 offen sc1 lds
    s_add_u32 m0, m0, 1024
    s_add_u32 s39, s39, s37
    buffer_load_dwordx4 v2, s[12:15], s39 offen sc1 lds
    s_add_u32 m0, m0, 1024
    s_add_u32 s40, s40, s37
    buffer_load_dwordx4 v2, s[12:15], s40 offen sc1 lds
    s_add_u32 m0, m0, 1024
    s_add_u32 s39, s39, 229376
    buffer_load_dwordx4 v2, s[12:15], s39 offen sc1 lds
    s_add_u32 m0, m0, 1024
    s_add_u32 s40, s40, 229376
    buffer_load_dwordx4 v2, s[12:15], s40 offen sc1 lds
    s_mov_b32 m0, s19
    s_mov_b32 s39, s16
    s_mov_b32 s40, s17
    s_waitcnt vmcnt(8)
    s_barrier
    buffer_load_dwordx4 v2, s[12:15], s39 offen sc1 lds
    s_add_u32 m0, m0, 1024
    s_nop 0
    buffer_load_dwordx4 v2, s[12:15], s40 offen sc1 lds
    s_add_u32 s43, s43, 1
    s_cmp_lt_u32 s43, 5
    s_cbranch_scc1 ld_56
    s_call_b64 s[76:77], PREP_a_issue_4
    s_add_u32 m0, m0, 1024
    s_add_u32 s39, s39, 229376
    buffer_load_dwordx4 v2, s[12:15], s39 offen sc1 lds
    s_add_u32 m0, m0, 1024
    s_add_u32 s40, s40, 229376
    buffer_load_dwordx4 v2, s[12:15], s40 offen sc1 lds
    s_add_u32 m0, m0, 1024
    s_add_u32 s39, s39, s37
    buffer_load_dwordx4 v2, s[12:15], s39 offen sc1 lds
    s_add_u32 m0, m0, 1024
    s_add_u32 s40, s40, s37
    buffer_load_dwordx4 v2, s[12:15], s40 offen sc1 lds
    s_add_u32 m0, m0, 1024
    s_add_u32 s39, s39, 229376
    buffer_load_dwordx4 v2, s[12:15], s39 offen sc1 lds
    s_add_u32 m0, m0, 1024
    s_add_u32 s40, s40, 229376
    buffer_load_dwordx4 v2, s[12:15], s40 offen sc1 lds
    s_mov_b32 m0, s19
    s_mov_b32 s39, s16
    s_mov_b32 s40, s17
    s_waitcnt vmcnt(8)
    s_barrier
    s_add_u32 s39, s38, s37
    s_add_u32 s39, s39, 229376
    s_add_u32 m0, s41, 16384
    s_add_u32 s16, s39, s78
    s_add_u32 s17, s39, s79
    buffer_load_dwordx4 v2, s[12:15], s16 offen sc1 lds
    s_add_u32 m0, m0, 1024
    s_nop 0
    buffer_load_dwordx4 v2, s[12:15], s17 offen sc1 lds
    s_add_u32 m0, m0, 1024
    s_add_u32 s16, s16, 229376
    buffer_load_dwordx4 v2, s[12:15], s16 offen sc1 lds
    s_add_u32 m0, m0, 1024
    s_add_u32 s17, s17, 229376
    buffer_load_dwordx4 v2, s[12:15], s17 offen sc1 lds
    s_add_u32 m0, m0, 1024
    s_add_u32 s16, s39, s80
    s_add_u32 s17, s39, s81
    buffer_load_dwordx4 v2, s[12:15], s16 offen sc1 lds
    s_add_u32 m0, m0, 1024
    s_nop 0
    buffer_load_dwordx4 v2, s[12:15], s17 offen sc1 lds
    s_add_u32 m0, m0, 1024
    s_add_u32 s16, s16, 229376
    buffer_load_dwordx4 v2, s[12:15], s16 offen sc1 lds
    s_add_u32 m0, m0, 1024
    s_add_u32 s17, s17, 229376
    buffer_load_dwordx4 v2, s[12:15], s17 offen sc1 lds
    s_waitcnt vmcnt(8)
    s_barrier
    s_add_u32 m0, s41, 32768
    s_add_u32 s16, s39, s82
    s_add_u32 s17, s39, s83
    buffer_load_dwordx4 v2, s[12:15], s16 offen sc1 lds
    s_add_u32 m0, m0, 1024
    s_nop 0
    buffer_load_dwordx4 v2, s[12:15], s17 offen sc1 lds
    s_add_u32 m0, m0, 1024
    s_add_u32 s16, s16, 229376
    buffer_load_dwordx4 v2, s[12:15], s16 offen sc1 lds
    s_add_u32 m0, m0, 1024
    s_add_u32 s17, s17, 229376
    buffer_load_dwordx4 v2, s[12:15], s17 offen sc1 lds
    s_add_u32 m0, m0, 1024
    s_add_u32 s16, s39, s84
    s_add_u32 s17, s39, s85
    buffer_load_dwordx4 v2, s[12:15], s16 offen sc1 lds
    s_add_u32 m0, m0, 1024
    s_nop 0
    buffer_load_dwordx4 v2, s[12:15], s17 offen sc1 lds
    s_add_u32 m0, m0, 1024
    s_add_u32 s16, s16, 229376
    buffer_load_dwordx4 v2, s[12:15], s16 offen sc1 lds
    s_add_u32 m0, m0, 1024
    s_add_u32 s17, s17, 229376
    buffer_load_dwordx4 v2, s[12:15], s17 offen sc1 lds
    s_waitcnt vmcnt(8)
    s_barrier
    s_add_u32 m0, s41, 0
    s_add_u32 s16, s39, s86
    s_add_u32 s17, s39, s87
    buffer_load_dwordx4 v2, s[12:15], s16 offen sc1 lds
    s_add_u32 m0, m0, 1024
    s_nop 0
    buffer_load_dwordx4 v2, s[12:15], s17 offen sc1 lds
    s_add_u32 m0, m0, 1024
    s_add_u32 s16, s16, 229376
    buffer_load_dwordx4 v2, s[12:15], s16 offen sc1 lds
    s_add_u32 m0, m0, 1024
    s_add_u32 s17, s17, 229376
    buffer_load_dwordx4 v2, s[12:15], s17 offen sc1 lds
    s_add_u32 m0, m0, 1024
    s_add_u32 s16, s39, s88
    s_add_u32 s17, s39, s89
    buffer_load_dwordx4 v2, s[12:15], s16 offen sc1 lds
    s_add_u32 m0, m0, 1024
    s_nop 0
    buffer_load_dwordx4 v2, s[12:15], s17 offen sc1 lds
    s_add_u32 m0, m0, 1024
    s_add_u32 s16, s16, 229376
    buffer_load_dwordx4 v2, s[12:15], s16 offen sc1 lds
    s_add_u32 m0, m0, 1024
    s_add_u32 s17, s17, 229376
    buffer_load_dwordx4 v2, s[12:15], s17 offen sc1 lds
    s_cmp_lg_u32 s60, 0
    s_cbranch_scc1 tl_57
    s_call_b64 s[76:77], SUB_w1_piece_23
    s_waitcnt vmcnt(10)
    s_branch tz_58
tl_57:
    s_waitcnt vmcnt(8)
tz_58:
    s_barrier
    s_mov_b32 s39, s38
    s_add_u32 m0, s41, 16384
    s_add_u32 s16, s39, s78
    s_add_u32 s17, s39, s79
    buffer_load_dwordx4 v2, s[12:15], s16 offen sc1 lds
    s_add_u32 m0, m0, 1024
    s_nop 0
    buffer_load_dwordx4 v2, s[12:15], s17 offen sc1 lds
    s_add_u32 m0, m0, 1024
    s_add_u32 s16, s16, 229376
    buffer_load_dwordx4 v2, s[12:15], s16 offen sc1 lds
    s_add_u32 m0, m0, 1024
    s_add_u32 s17, s17, 229376
    buffer_load_dwordx4 v2, s[12:15], s17 offen sc1 lds
    s_add_u32 m0, m0, 1024
    s_add_u32 s16, s39, s80
    s_add_u32 s17, s39, s81
    buffer_load_dwordx4 v2, s[12:15], s16 offen sc1 lds
    s_add_u32 m0, m0, 1024
    s_nop 0
    buffer_load_dwordx4 v2, s[12:15], s17 offen sc1 lds
    s_add_u32 m0, m0, 1024
    s_add_u32 s16, s16, 229376
    buffer_load_dwordx4 v2, s[12:15], s16 offen sc1 lds
    s_add_u32 m0, m0, 1024
    s_add_u32 s17, s17, 229376
    buffer_load_dwordx4 v2, s[12:15], s17 offen sc1 lds
    s_cmp_lg_u32 s60, 0
    s_cbranch_scc1 tl_59
    s_call_b64 s[76:77], SUB_w1_piece_24
    s_waitcnt vmcnt(14)
    s_branch tz_60
tl_59:
    s_waitcnt vmcnt(8)
tz_60:
    s_barrier
    s_add_u32 m0, s41, 32768
    s_add_u32 s16, s39, s82
    s_add_u32 s17, s39, s83
    buffer_load_dwordx4 v2, s[12:15], s16 offen sc1 lds
    s_add_u32 m0, m0, 1024
    s_nop 0
    buffer_load_dwordx4 v2, s[12:15], s17 offen sc1 lds
    s_add_u32 m0, m0, 1024
    s_add_u32 s16, s16, 229376
    buffer_load_dwordx4 v2, s[12:15], s16 offen sc1 lds
    s_add_u32 m0, m0, 1024
    s_add_u32 s17, s17, 229376
    buffer_load_dwordx4 v2, s[12:15], s17 offen sc1 lds
    s_add_u32 m0, m0, 1024
    s_add_u32 s16, s39, s84
    s_add_u32 s17, s39, s85
    buffer_load_dwordx4 v2, s[12:15], s16 offen sc1 lds
    s_add_u32 m0, m0, 1024
    s_nop 0
    buffer_load_dwordx4 v2, s[12:15], s17 offen sc1 lds
    s_add_u32 m0, m0, 1024
    s_add_u32 s16, s16, 229376
    buffer_load_dwordx4 v2, s[12:15], s16 offen sc1 lds
    s_add_u32 m0, m0, 1024
    s_add_u32 s17, s17, 229376
    buffer_load_dwordx4 v2, s[12:15], s17 offen sc1 lds
    s_cmp_lg_u32 s60, 0
    s_cbranch_scc1 tl_61
    s_call_b64 s[76:77], SUB_w1_piece_25
    s_waitcnt vmcnt(16)
    s_branch tz_62
tl_61:
    s_waitcnt vmcnt(8)
tz_62:
    s_barrier
    s_add_u32 m0, s41, 0
    s_add_u32 s16, s39, s86
    s_add_u32 s17, s39, s87
    buffer_load_dwordx4 v2, s[12:15], s16 offen sc1 lds
    s_add_u32 m0, m0, 1024
    s_nop 0
    buffer_load_dwordx4 v2, s[12:15], s17 offen sc1 lds
    s_add_u32 m0, m0, 1024
    s_add_u32 s16, s16, 229376
    buffer_load_dwordx4 v2, s[12:15], s16 offen sc1 lds
    s_add_u32 m0, m0, 1024
    s_add_u32 s17, s17, 229376
    buffer_load_dwordx4 v2, s[12:15], s17 offen sc1 lds
    s_add_u32 m0, m0, 1024
    s_add_u32 s16, s39, s88
    s_add_u32 s17, s39, s89
    buffer_load_dwordx4 v2, s[12:15], s16 offen sc1 lds
    s_add_u32 m0, m0, 1024
    s_nop 0
    buffer_load_dwordx4 v2, s[12:15], s17 offen sc1 lds
    s_add_u32 m0, m0, 1024
    s_add_u32 s16, s16, 229376
    buffer_load_dwordx4 v2, s[12:15], s16 offen sc1 lds
    s_add_u32 m0, m0, 1024
    s_add_u32 s17, s17, 229376
    buffer_load_dwordx4 v2, s[12:15], s17 offen sc1 lds
    s_cmp_lg_u32 s60, 0
    s_cbranch_scc1 tl_63
    s_call_b64 s[76:77], SUB_w1_piece_26
    s_waitcnt vmcnt(18)
    s_branch tz_64
tl_63:
    s_waitcnt vmcnt(8)
tz_64:
    s_barrier
    s_cmp_lg_u32 s60, 0
    s_cbranch_scc1 tl_65
    s_call_b64 s[76:77], SUB_w1_piece_27
    s_waitcnt vmcnt(10)
    s_branch tz_66
tl_65:
    s_waitcnt vmcnt(0)
tz_66:
    s_barrier
    s_cmp_eq_u32 s60, 1
    s_cbranch_scc1 K_fin
    s_branch Y_END
WLOAD:
    s_mov_b64 s[12:13], s[72:73]
    s_mov_b32 s14, 7340032
    s_mov_b32 s15, 0x20000
    s_and_b32 s35, s30, 1
    s_mul_i32 s38, s29, 448
    s_mul_i32 s41, s35, 229376
    s_add_u32 s38, s38, s41
    s_mul_i32 s41, s35, 14336
    s_add_u32 s41, s41, 49152
    s_mov_b32 s42, 0
    s_mov_b32 s44, s29
    s_add_u32 s44, s44, 1
    s_and_b32 s44, s44, 15
    s_add_u32 s44, s44, 1
    s_and_b32 s44, s44, 15
    s_add_u32 s46, s29, 1
    s_and_b32 s46, s46, 15
    s_cmp_eq_u32 s28, s29
    s_cselect_b32 s47, s46, s28
    s_mov_b32 s42, 57344
    s_call_b64 s[76:77], PREP_w_issue_3
    s_mov_b32 m0, s19
    s_mov_b32 s39, s16
    s_waitcnt vmcnt(0)
    s_and_b32 s53, s30, 3
    s_lshl_b32 s53, s53, 7
    s_add_u32 s53, s53, s55
    s_add_u32 s53, s53, 0x400
    v_mov_b32 v14, 1
    v_mov_b32 v15, 0
    s_mov_b64 exec, 1
    buffer_atomic_add v14, v15, s[56:59], s53 offen sc1
    s_mov_b64 exec, -1
    s_call_b64 s[76:77], SUB_rest_2
    s_waitcnt lgkmcnt(0)
    buffer_load_dwordx4 v121, s[12:15], s39 offen lds
    s_add_u32 m0, m0, 1024
    s_nop 0
    buffer_load_dwordx4 v122, s[12:15], s39 offen lds
    s_add_u32 m0, m0, 1024
    s_nop 0
    buffer_load_dwordx4 v123, s[12:15], s39 offen lds
    s_call_b64 s[76:77], PREP_w_issue_3
    s_add_u32 m0, m0, 1024
    s_nop 0
    buffer_load_dwordx4 v124, s[12:15], s39 offen lds
    s_add_u32 m0, m0, 1024
    s_nop 0
    buffer_load_dwordx4 v125, s[12:15], s39 offen lds
    s_add_u32 m0, m0, 1024
    s_nop 0
    buffer_load_dwordx4 v126, s[12:15], s39 offen lds
    s_add_u32 m0, m0, 1024
    s_nop 0
    buffer_load_dwordx4 v127, s[12:15], s39 offen lds
    s_add_u32 m0, m0, 1024
    s_add_u32 s39, s39, 114688
    buffer_load_dwordx4 v121, s[12:15], s39 offen lds
    s_add_u32 m0, m0, 1024
    s_nop 0
    buffer_load_dwordx4 v122, s[12:15], s39 offen lds
    s_add_u32 m0, m0, 1024
    s_nop 0
    buffer_load_dwordx4 v123, s[12:15], s39 offen lds
    s_add_u32 m0, m0, 1024
    s_nop 0
    buffer_load_dwordx4 v124, s[12:15], s39 offen lds
    s_add_u32 m0, m0, 1024
    s_nop 0
    buffer_load_dwordx4 v125, s[12:15], s39 offen lds
    s_add_u32 m0, m0, 1024
    s_nop 0
    buffer_load_dwordx4 v126, s[12:15], s39 offen lds
    s_add_u32 m0, m0, 1024
    s_nop 0
    buffer_load_dwordx4 v127, s[12:15], s39 offen lds
    s_mov_b32 m0, s19
    s_mov_b32 s39, s16
    s_cmp_lg_u32 s60, 0
    s_cbranch_scc1 cs_67
    s_and_b32 s35, s30, 1
    v_lshrrev_b32 v112, 2, v1
    v_mul_u32_u24 v104, 448, v112
    v_and_b32 v113, 3, v1
    v_lshl_add_u32 v104, v113, 3, v104
    v_add_u32 v104, 49152, v104
    v_mul_u32_u24 v106, 448, v112
    v_and_b32 v113, 2, v1
    v_lshl_add_u32 v106, v113, 2, v106
    v_bfe_u32 v112, v1, 4, 1
    v_and_b32 v113, 1, v1
    v_xor_b32 v113, v113, v112
    v_lshl_add_u32 v106, v113, 5, v106
    s_lshl_b32 s36, s35, 4
    s_add_u32 s36, s36, 49344
    v_add_u32 v106, s36, v106
    s_lshl_b32 s36, s35, 8
    v_add_u32 v104, s36, v104
    v_lshlrev_b32 v112, 5, v112
    v_sub_u32 v105, v104, v112
    v_add_u32 v104, v104, v112
    s_cmp_eq_u32 s28, s29
    s_cselect_b32 s36, 0, 28672
    v_add_u32 v104, s36, v104
    v_add_u32 v105, s36, v105
    v_add_u32 v106, s36, v106
    ds_read_b64_tr_b16 v[48:49], v104 offset:0
    ds_read_b64_tr_b16 v[50:51], v104 offset:7168
    ds_read_b64_tr_b16 v[52:53], v104 offset:14336
    ds_read_b64_tr_b16 v[54:55], v104 offset:21504
    ds_read_b64_tr_b16 v[56:57], v105 offset:32
    ds_read_b64_tr_b16 v[58:59], v105 offset:7200
    ds_read_b64_tr_b16 v[60:61], v105 offset:14368
    ds_read_b64_tr_b16 v[62:63], v105 offset:21536
    ds_read_b64_tr_b16 v[64:65], v104 offset:64
    ds_read_b64_tr_b16 v[66:67], v104 offset:7232
    ds_read_b64_tr_b16 v[68:69], v104 offset:14400
    ds_read_b64_tr_b16 v[70:71], v104 offset:21568
    ds_read_b64_tr_b16 v[72:73], v105 offset:96
    ds_read_b64_tr_b16 v[74:75], v105 offset:7264
    ds_read_b64_tr_b16 v[76:77], v105 offset:14432
    ds_read_b64_tr_b16 v[78:79], v105 offset:21600
    ds_read_b64_tr_b16 v[80:81], v104 offset:128
    ds_read_b64_tr_b16 v[82:83], v104 offset:7296
    ds_read_b64_tr_b16 v[84:85], v104 offset:14464
    ds_read_b64_tr_b16 v[86:87], v104 offset:21632
    ds_read_b64_tr_b16 v[88:89], v105 offset:160
    ds_read_b64_tr_b16 v[90:91], v105 offset:7328
    ds_read_b64_tr_b16 v[92:93], v105 offset:14496
    ds_read_b64_tr_b16 v[94:95], v105 offset:21664
    ds_read_b64_tr_b16 v[96:97], v106 offset:0
    ds_read_b64_tr_b16 v[98:99], v106 offset:7168
    ds_read_b64_tr_b16 v[100:101], v106 offset:14336
    ds_read_b64_tr_b16 v[102:103], v106 offset:21504
    v_and_b32 v112, 15, v1
    v_mov_b32 v113, 0x3f803f80
    v_cmp_eq_u32 vcc, 0, v112
    s_nop 1
    v_cndmask_b32 v20, 0, v113, vcc
    v_cndmask_b32 v21, 0, v113, vcc
    v_cndmask_b32 v22, 0, v113, vcc
    v_cndmask_b32 v23, 0, v113, vcc
    v_cmp_eq_u32 vcc, 1, v112
    s_nop 1
    v_cndmask_b32 v24, 0, v113, vcc
    v_cndmask_b32 v25, 0, v113, vcc
    v_cndmask_b32 v26, 0, v113, vcc
    v_cndmask_b32 v27, 0, v113, vcc
    v_cmp_eq_u32 vcc, 2, v112
    s_nop 1
    v_cndmask_b32 v28, 0, v113, vcc
    v_cndmask_b32 v29, 0, v113, vcc
    v_cndmask_b32 v30, 0, v113, vcc
    v_cndmask_b32 v31, 0, v113, vcc
    v_cmp_eq_u32 vcc, 3, v112
    s_nop 1
    v_cndmask_b32 v32, 0, v113, vcc
    v_cndmask_b32 v33, 0, v113, vcc
    v_cndmask_b32 v34, 0, v113, vcc
    v_cndmask_b32 v35, 0, v113, vcc
    v_cmp_eq_u32 vcc, 4, v112
    s_nop 1
    v_cndmask_b32 v36, 0, v113, vcc
    v_cndmask_b32 v37, 0, v113, vcc
    v_cndmask_b32 v38, 0, v113, vcc
    v_cndmask_b32 v39, 0, v113, vcc
    v_cmp_eq_u32 vcc, 5, v112
    s_nop 1
    v_cndmask_b32 v40, 0, v113, vcc
    v_cndmask_b32 v41, 0, v113, vcc
    v_cndmask_b32 v42, 0, v113, vcc
    v_cndmask_b32 v43, 0, v113, vcc
    v_cmp_eq_u32 vcc, 6, v112
    s_nop 1
    v_cndmask_b32 v44, 0, v113, vcc
    v_cndmask_b32 v45, 0, v113, vcc
    v_cndmask_b32 v46, 0, v113, vcc
    v_cndmask_b32 v47, 0, v113, vcc
    v_and_b32 v114, 48, v1
    v_lshl_add_u32 v114, v112, 6, v114
    v_mov_b32 v113, 0x7f000000
    v_cmp_gt_u32 vcc, 7, v112
    s_nop 1
    v_cndmask_b32 v114, v113, v114, vcc
    s_add_u32 s20, s4, 0x1420000
    s_addc_u32 s21, s5, 0
    s_mov_b32 s22, 0x38000
    s_mov_b32 s23, 0x20000
    s_mul_i32 s36, s28, 14336
    s_lshl1_add_u32 s35, s29, s35
    s_mul_i32 s35, s35, 448
    s_add_u32 s35, s35, s36
    s_waitcnt lgkmcnt(0)
    v_mfma_f32_16x16x32_bf16 v[108:111], v[48:51], v[20:23], 0
    v_mfma_f32_16x16x32_bf16 v[108:111], v[52:55], v[20:23], v[108:111]
    v_mfma_f32_16x16x32_bf16 v[108:111], v[56:59], v[24:27], v[108:111]
    v_mfma_f32_16x16x32_bf16 v[108:111], v[60:63], v[24:27], v[108:111]
    v_mfma_f32_16x16x32_bf16 v[108:111], v[64:67], v[28:31], v[108:111]
    v_mfma_f32_16x16x32_bf16 v[108:111], v[68:71], v[28:31], v[108:111]
    v_mfma_f32_16x16x32_bf16 v[108:111], v[72:75], v[32:35], v[108:111]
    v_mfma_f32_16x16x32_bf16 v[108:111], v[76:79], v[32:35], v[108:111]
    v_mfma_f32_16x16x32_bf16 v[108:111], v[80:83], v[36:39], v[108:111]
    v_mfma_f32_16x16x32_bf16 v[108:111], v[84:87], v[36:39], v[108:111]
    v_mfma_f32_16x16x32_bf16 v[108:111], v[88:91], v[40:43], v[108:111]
    v_mfma_f32_16x16x32_bf16 v[108:111], v[92:95], v[40:43], v[108:111]
    v_mfma_f32_16x16x32_bf16 v[108:111], v[96:99], v[44:47], v[108:111]
    v_mfma_f32_16x16x32_bf16 v[108:111], v[100:103], v[44:47], v[108:111]
    s_nop 7
    buffer_store_dwordx4 v[108:111], v114, s[20:23], s35 offen sc1
cs_67:
    s_waitcnt vmcnt(15)
    s_barrier
    buffer_load_dwordx4 v121, s[12:15], s39 offen lds
    s_add_u32 m0, m0, 1024
    s_nop 0
    buffer_load_dwordx4 v122, s[12:15], s39 offen lds
    s_add_u32 m0, m0, 1024
    s_nop 0
    buffer_load_dwordx4 v123, s[12:15], s39 offen lds
    s_call_b64 s[76:77], PREP_w_issue_3
    s_add_u32 m0, m0, 1024
    s_nop 0
    buffer_load_dwordx4 v124, s[12:15], s39 offen lds
    s_add_u32 m0, m0, 1024
    s_nop 0
    buffer_load_dwordx4 v125, s[12:15], s39 offen lds
    s_add_u32 m0, m0, 1024
    s_nop 0
    buffer_load_dwordx4 v126, s[12:15], s39 offen lds
    s_add_u32 m0, m0, 1024
    s_nop 0
    buffer_load_dwordx4 v127, s[12:15], s39 offen lds
    s_add_u32 m0, m0, 1024
    s_add_u32 s39, s39, 114688
    buffer_load_dwordx4 v121, s[12:15], s39 offen lds
    s_add_u32 m0, m0, 1024
    s_nop 0
    buffer_load_dwordx4 v122, s[12:15], s39 offen lds
    s_add_u32 m0, m0, 1024
    s_nop 0
    buffer_load_dwordx4 v123, s[12:15], s39 offen lds
    s_add_u32 m0, m0, 1024
    s_nop 0
    buffer_load_dwordx4 v124, s[12:15], s39 offen lds
    s_add_u32 m0, m0, 1024
    s_nop 0
    buffer_load_dwordx4 v125, s[12:15], s39 offen lds
    s_add_u32 m0, m0, 1024
    s_nop 0
    buffer_load_dwordx4 v126, s[12:15], s39 offen lds
    s_add_u32 m0, m0, 1024
    s_nop 0
    buffer_load_dwordx4 v127, s[12:15], s39 offen lds
    s_mov_b32 m0, s19
    s_mov_b32 s39, s16
    s_waitcnt vmcnt(14)
    s_barrier
    buffer_load_dwordx4 v121, s[12:15], s39 offen lds
    s_add_u32 m0, m0, 1024
    s_nop 0
    buffer_load_dwordx4 v122, s[12:15], s39 offen lds
    s_add_u32 m0, m0, 1024
    s_nop 0
    buffer_load_dwordx4 v123, s[12:15], s39 offen lds
    s_call_b64 s[76:77], PREP_w_issue_3
    s_add_u32 m0, m0, 1024
    s_nop 0
    buffer_load_dwordx4 v124, s[12:15], s39 offen lds
    s_add_u32 m0, m0, 1024
    s_nop 0
    buffer_load_dwordx4 v125, s[12:15], s39 offen lds
    s_add_u32 m0, m0, 1024
    s_nop 0
    buffer_load_dwordx4 v126, s[12:15], s39 offen lds
    s_add_u32 m0, m0, 1024
    s_nop 0
    buffer_load_dwordx4 v127, s[12:15], s39 offen lds
    s_add_u32 m0, m0, 1024
    s_add_u32 s39, s39, 114688
    buffer_load_dwordx4 v121, s[12:15], s39 offen lds
    s_add_u32 m0, m0, 1024
    s_nop 0
    buffer_load_dwordx4 v122, s[12:15], s39 offen lds
    s_add_u32 m0, m0, 1024
    s_nop 0
    buffer_load_dwordx4 v123, s[12:15], s39 offen lds
    s_add_u32 m0, m0, 1024
    s_nop 0
    buffer_load_dwordx4 v124, s[12:15], s39 offen lds
    s_add_u32 m0, m0, 1024
    s_nop 0
    buffer_load_dwordx4 v125, s[12:15], s39 offen lds
    s_add_u32 m0, m0, 1024
    s_nop 0
    buffer_load_dwordx4 v126, s[12:15], s39 offen lds
    s_add_u32 m0, m0, 1024
    s_nop 0
    buffer_load_dwordx4 v127, s[12:15], s39 offen lds
    s_mov_b32 m0, s19
    s_mov_b32 s39, s16
    s_waitcnt vmcnt(14)
    s_barrier
    buffer_load_dwordx4 v121, s[12:15], s39 offen lds
    s_add_u32 m0, m0, 1024
    s_nop 0
    buffer_load_dwordx4 v122, s[12:15], s39 offen lds
    s_add_u32 m0, m0, 1024
    s_nop 0
    buffer_load_dwordx4 v123, s[12:15], s39 offen lds
    s_call_b64 s[76:77], PREP_w_issue_3
    s_add_u32 m0, m0, 1024
    s_nop 0
    buffer_load_dwordx4 v124, s[12:15], s39 offen lds
    s_add_u32 m0, m0, 1024
    s_nop 0
    buffer_load_dwordx4 v125, s[12:15], s39 offen lds
    s_add_u32 m0, m0, 1024
    s_nop 0
    buffer_load_dwordx4 v126, s[12:15], s39 offen lds
    s_add_u32 m0, m0, 1024
    s_nop 0
    buffer_load_dwordx4 v127, s[12:15], s39 offen lds
    s_add_u32 m0, m0, 1024
    s_add_u32 s39, s39, 114688
    buffer_load_dwordx4 v121, s[12:15], s39 offen lds
    s_add_u32 m0, m0, 1024
    s_nop 0
    buffer_load_dwordx4 v122, s[12:15], s39 offen lds
    s_add_u32 m0, m0, 1024
    s_nop 0
    buffer_load_dwordx4 v123, s[12:15], s39 offen lds
    s_add_u32 m0, m0, 1024
    s_nop 0
    buffer_load_dwordx4 v124, s[12:15], s39 offen lds
    s_add_u32 m0, m0, 1024
    s_nop 0
    buffer_load_dwordx4 v125, s[12:15], s39 offen lds
    s_add_u32 m0, m0, 1024
    s_nop 0
    buffer_load_dwordx4 v126, s[12:15], s39 offen lds
    s_add_u32 m0, m0, 1024
    s_nop 0
    buffer_load_dwordx4 v127, s[12:15], s39 offen lds
    s_mov_b32 m0, s19
    s_mov_b32 s39, s16
    s_waitcnt vmcnt(28)
    s_cmp_lg_u32 s60, 0
    s_cbranch_scc1 cs_68
    s_and_b32 s36, s30, 1
    s_lshl_b32 s36, s36, 13
    s_lshl_b32 s53, s29, 7
    s_add_u32 s36, s36, s53
    s_add_u32 s36, s36, 23068672
    v_mov_b32 v14, 1
    v_mov_b32 v15, 0
    s_mov_b64 exec, 1
    buffer_atomic_add v14, v15, s[56:59], s36 offen sc1
    s_mov_b64 exec, -1
cs_68:
    s_waitcnt vmcnt(14)
    s_barrier
    buffer_load_dwordx4 v121, s[12:15], s39 offen lds
    s_add_u32 m0, m0, 1024
    s_nop 0
    buffer_load_dwordx4 v122, s[12:15], s39 offen lds
    s_add_u32 m0, m0, 1024
    s_nop 0
    buffer_load_dwordx4 v123, s[12:15], s39 offen lds
    s_mov_b32 s43, 1
ld_69:
    s_add_u32 s19, s41, s42
    s_cmp_eq_u32 s44, s47
    s_cselect_b32 s16, s46, s44
    s_mul_i32 s16, s16, 458752
    s_add_u32 s16, s16, s38
    s_add_u32 s44, s44, 1
    s_and_b32 s44, s44, 15
    s_add_u32 s42, s42, 28672
    s_cmp_eq_u32 s42, 86016
    s_cselect_b32 s42, 0, s42
    s_add_u32 m0, m0, 1024
    s_nop 0
    buffer_load_dwordx4 v124, s[12:15], s39 offen lds
    s_add_u32 m0, m0, 1024
    s_nop 0
    buffer_load_dwordx4 v125, s[12:15], s39 offen lds
    s_add_u32 m0, m0, 1024
    s_nop 0
    buffer_load_dwordx4 v126, s[12:15], s39 offen lds
    s_add_u32 m0, m0, 1024
    s_nop 0
    buffer_load_dwordx4 v127, s[12:15], s39 offen lds
    s_add_u32 m0, m0, 1024
    s_add_u32 s39, s39, 114688
    buffer_load_dwordx4 v121, s[12:15], s39 offen lds
    s_add_u32 m0, m0, 1024
    s_nop 0
    buffer_load_dwordx4 v122, s[12:15], s39 offen lds
    s_add_u32 m0, m0, 1024
    s_nop 0
    buffer_load_dwordx4 v123, s[12:15], s39 offen lds
    s_add_u32 m0, m0, 1024
    s_nop 0
    buffer_load_dwordx4 v124, s[12:15], s39 offen lds
    s_add_u32 m0, m0, 1024
    s_nop 0
    buffer_load_dwordx4 v125, s[12:15], s39 offen lds
    s_add_u32 m0, m0, 1024
    s_nop 0
    buffer_load_dwordx4 v126, s[12:15], s39 offen lds
    s_add_u32 m0, m0, 1024
    s_nop 0
    buffer_load_dwordx4 v127, s[12:15], s39 offen lds
    s_mov_b32 m0, s19
    s_mov_b32 s39, s16
    s_waitcnt vmcnt(14)
    s_barrier
    buffer_load_dwordx4 v121, s[12:15], s39 offen lds
    s_add_u32 m0, m0, 1024
    s_nop 0
    buffer_load_dwordx4 v122, s[12:15], s39 offen lds
    s_add_u32 m0, m0, 1024
    s_nop 0
    buffer_load_dwordx4 v123, s[12:15], s39 offen lds
    s_add_u32 s43, s43, 1
    s_cmp_lt_u32 s43, 9
    s_cbranch_scc1 ld_69
    s_call_b64 s[76:77], PREP_w_issue_3
    s_add_u32 m0, m0, 1024
    s_nop 0
    buffer_load_dwordx4 v124, s[12:15], s39 offen lds
    s_add_u32 m0, m0, 1024
    s_nop 0
    buffer_load_dwordx4 v125, s[12:15], s39 offen lds
    s_add_u32 m0, m0, 1024
    s_nop 0
    buffer_load_dwordx4 v126, s[12:15], s39 offen lds
    s_add_u32 m0, m0, 1024
    s_nop 0
    buffer_load_dwordx4 v127, s[12:15], s39 offen lds
    s_add_u32 m0, m0, 1024
    s_add_u32 s39, s39, 114688
    buffer_load_dwordx4 v121, s[12:15], s39 offen lds
    s_add_u32 m0, m0, 1024
    s_nop 0
    buffer_load_dwordx4 v122, s[12:15], s39 offen lds
    s_add_u32 m0, m0, 1024
    s_nop 0
    buffer_load_dwordx4 v123, s[12:15], s39 offen lds
    s_add_u32 m0, m0, 1024
    s_nop 0
    buffer_load_dwordx4 v124, s[12:15], s39 offen lds
    s_add_u32 m0, m0, 1024
    s_nop 0
    buffer_load_dwordx4 v125, s[12:15], s39 offen lds
    s_add_u32 m0, m0, 1024
    s_nop 0
    buffer_load_dwordx4 v126, s[12:15], s39 offen lds
    s_add_u32 m0, m0, 1024
    s_nop 0
    buffer_load_dwordx4 v127, s[12:15], s39 offen lds
    s_mov_b32 m0, s19
    s_mov_b32 s39, s16
    s_waitcnt vmcnt(14)
    s_barrier
    buffer_load_dwordx4 v121, s[12:15], s39 offen lds
    s_add_u32 m0, m0, 1024
    s_nop 0
    buffer_load_dwordx4 v122, s[12:15], s39 offen lds
    s_add_u32 m0, m0, 1024
    s_nop 0
    buffer_load_dwordx4 v123, s[12:15], s39 offen lds
    s_add_u32 m0, m0, 1024
    s_nop 0
    buffer_load_dwordx4 v124, s[12:15], s39 offen lds
    s_add_u32 m0, m0, 1024
    s_nop 0
    buffer_load_dwordx4 v125, s[12:15], s39 offen lds
    s_add_u32 m0, m0, 1024
    s_nop 0
    buffer_load_dwordx4 v126, s[12:15], s39 offen lds
    s_add_u32 m0, m0, 1024
    s_nop 0
    buffer_load_dwordx4 v127, s[12:15], s39 offen lds
    s_add_u32 m0, m0, 1024
    s_add_u32 s39, s39, 114688
    buffer_load_dwordx4 v121, s[12:15], s39 offen lds
    s_add_u32 m0, m0, 1024
    s_nop 0
    buffer_load_dwordx4 v122, s[12:15], s39 offen lds
    s_add_u32 m0, m0, 1024
    s_nop 0
    buffer_load_dwordx4 v123, s[12:15], s39 offen lds
    s_add_u32 m0, m0, 1024
    s_nop 0
    buffer_load_dwordx4 v124, s[12:15], s39 offen lds
    s_add_u32 m0, m0, 1024
    s_nop 0
    buffer_load_dwordx4 v125, s[12:15], s39 offen lds
    s_add_u32 m0, m0, 1024
    s_nop 0
    buffer_load_dwordx4 v126, s[12:15], s39 offen lds
    s_add_u32 m0, m0, 1024
    s_nop 0
    buffer_load_dwordx4 v127, s[12:15], s39 offen lds
    s_waitcnt vmcnt(14)
    s_barrier
    s_waitcnt vmcnt(0)
    s_barrier
    s_barrier
    s_mov_b64 s[12:13], s[74:75]
    s_mov_b32 s14, 7340032
    s_mov_b32 s15, 0x20000
    s_and_b32 s35, s30, 1
    s_mul_i32 s38, s33, 256
    s_mul_i32 s41, s31, 3670016
    s_add_u32 s38, s38, s41
    s_mul_i32 s41, s35, 8192
    s_add_u32 s41, s41, 49152
    s_mov_b32 s42, 0
    s_mov_b32 s44, 0
    s_mov_b32 s49, s44
    s_and_b32 s43, s28, 0
    s_mul_i32 s43, s43, 6
    s_lshr_b32 s43, s43, 2
    s_mov_b32 s50, 0
wpre_70:
    s_mul_i32 s42, s43, 16384
    s_add_u32 s44, s49, s43
    s_add_u32 s19, s41, s42
    s_and_b32 s40, s30, 1
    s_lshl_b32 s45, s44, 1
    s_add_u32 s45, s45, s40
    s_sub_u32 s45, s45, 32
    s_mul_i32 s46, s45, 86
    s_lshr_b32 s46, s46, 8
    s_mul_i32 s47, s46, 3
    s_sub_u32 s47, s45, s47
    s_lshl_b32 s47, s47, 2
    s_lshr_b32 s47, 0x362, s47
    s_and_b32 s47, s47, 7
    s_cmp_ge_u32 s44, 10
    s_cselect_b32 s45, 9, 2
    s_cselect_b32 s51, 1, 0
    s_sub_u32 s45, s44, s45
    s_cmp_lt_u32 s44, 3
    s_cselect_b32 s45, 0, s45
    s_cselect_b32 s51, s44, s51
    s_lshl2_add_u32 s51, s40, s51
    s_cmp_lt_u32 s44, 17
    s_cselect_b32 s47, s51, s47
    s_cselect_b32 s46, s45, s46
    s_add_u32 s46, s46, s33
    s_and_b32 s46, s46, 7
    s_mul_i32 s46, s46, 7
    s_add_u32 s16, s46, s47
    s_mul_i32 s16, s16, 65536
    s_add_u32 s16, s16, s38
    s_add_u32 s44, s44, 1
    s_add_u32 s42, s42, 16384
    s_cmp_eq_u32 s42, 98304
    s_cselect_b32 s42, 0, s42
    s_mov_b32 m0, s19
    s_mov_b32 s39, s16
    buffer_load_dwordx4 v119, s[12:15], s39 offen lds
    s_add_u32 m0, m0, 1024
    s_add_u32 s39, s39, 8192
    buffer_load_dwordx4 v120, s[12:15], s39 offen lds
    s_add_u32 m0, m0, 1024
    s_add_u32 s39, s39, 8192
    buffer_load_dwordx4 v119, s[12:15], s39 offen lds
    s_add_u32 m0, m0, 1024
    s_add_u32 s39, s39, 8192
    buffer_load_dwordx4 v120, s[12:15], s39 offen lds
    s_waitcnt vmcnt(8)
    s_add_u32 m0, m0, 1024
    s_add_u32 s39, s39, 8192
    buffer_load_dwordx4 v119, s[12:15], s39 offen lds
    s_add_u32 m0, m0, 1024
    s_add_u32 s39, s39, 8192
    buffer_load_dwordx4 v120, s[12:15], s39 offen lds
    s_add_u32 m0, m0, 1024
    s_add_u32 s39, s39, 8192
    buffer_load_dwordx4 v119, s[12:15], s39 offen lds
    s_add_u32 m0, m0, 1024
    s_add_u32 s39, s39, 8192
    buffer_load_dwordx4 v120, s[12:15], s39 offen lds
    s_waitcnt vmcnt(8)
    s_add_u32 s43, s43, 1
    s_cmp_eq_u32 s43, 6
    s_cselect_b32 s43, 0, s43
    s_add_u32 s50, s50, 1
    s_cmp_lt_u32 s50, 6
    s_cbranch_scc1 wpre_70
    s_mov_b32 s42, 0
    s_add_u32 s44, s49, 6
    s_mov_b64 s[8:9], s[68:69]
    s_mov_b32 s10, 2097152
    s_mov_b32 s11, 0x20000
    s_and_b32 s3, s30, 3
    s_lshl_b32 s36, s3, 14
    s_lshl_b32 s90, s29, 7
    s_add_u32 s90, s90, s36
    s_xor_b32 s90, s90, 128
    s_lshl_b32 s3, s3, 10
    s_call_b64 s[76:77], PREP_w_issue_4
    s_mov_b32 m0, s19
    s_mov_b32 s39, s16
    s_waitcnt vmcnt(40)
    s_barrier
    s_waitcnt vmcnt(32)
    s_barrier
    buffer_load_dwordx4 v119, s[12:15], s39 offen lds
    s_add_u32 m0, m0, 1024
    s_add_u32 s39, s39, 8192
    buffer_load_dwordx4 v120, s[12:15], s39 offen lds
    s_mov_b32 s43, 1
ld_71:
    s_add_u32 s19, s41, s42
    s_and_b32 s40, s30, 1
    s_lshl_b32 s45, s44, 1
    s_add_u32 s45, s45, s40
    s_sub_u32 s45, s45, 32
    s_mul_i32 s46, s45, 86
    s_lshr_b32 s46, s46, 8
    s_mul_i32 s47, s46, 3
    s_sub_u32 s47, s45, s47
    s_lshl_b32 s47, s47, 2
    s_lshr_b32 s47, 0x362, s47
    s_and_b32 s47, s47, 7
    s_cmp_ge_u32 s44, 10
    s_cselect_b32 s45, 9, 2
    s_cselect_b32 s51, 1, 0
    s_sub_u32 s45, s44, s45
    s_cmp_lt_u32 s44, 3
    s_cselect_b32 s45, 0, s45
    s_cselect_b32 s51, s44, s51
    s_lshl2_add_u32 s51, s40, s51
    s_cmp_lt_u32 s44, 17
    s_cselect_b32 s47, s51, s47
    s_cselect_b32 s46, s45, s46
    s_add_u32 s46, s46, s33
    s_and_b32 s46, s46, 7
    s_mul_i32 s46, s46, 7
    s_add_u32 s16, s46, s47
    s_mul_i32 s16, s16, 65536
    s_add_u32 s16, s16, s38
    s_add_u32 s44, s44, 1
    s_add_u32 s42, s42, 16384
    s_cmp_eq_u32 s42, 98304
    s_cselect_b32 s42, 0, s42
    s_add_u32 m0, m0, 1024
    s_add_u32 s39, s39, 8192
    buffer_load_dwordx4 v119, s[12:15], s39 offen lds
    s_add_u32 m0, m0, 1024
    s_add_u32 s39, s39, 8192
    buffer_load_dwordx4 v120, s[12:15], s39 offen lds
    s_add_u32 m0, m0, 1024
    s_add_u32 s39, s39, 8192
    buffer_load_dwordx4 v119, s[12:15], s39 offen lds
    s_add_u32 m0, m0, 1024
    s_add_u32 s39, s39, 8192
    buffer_load_dwordx4 v120, s[12:15], s39 offen lds
    s_add_u32 m0, m0, 1024
    s_add_u32 s39, s39, 8192
    buffer_load_dwordx4 v119, s[12:15], s39 offen lds
    s_add_u32 m0, m0, 1024
    s_add_u32 s39, s39, 8192
    buffer_load_dwordx4 v120, s[12:15], s39 offen lds
    s_mov_b32 m0, s19
    s_mov_b32 s39, s16
    s_waitcnt vmcnt(32)
    s_barrier
    buffer_load_dwordx4 v119, s[12:15], s39 offen lds
    s_add_u32 m0, m0, 1024
    s_add_u32 s39, s39, 8192
    buffer_load_dwordx4 v120, s[12:15], s39 offen lds
    s_add_u32 s43, s43, 1
    s_cmp_lt_u32 s43, 20
    s_cbranch_scc1 ld_71
    s_call_b64 s[76:77], PREP_w_issue_4
    s_add_u32 m0, m0, 1024
    s_add_u32 s39, s39, 8192
    buffer_load_dwordx4 v119, s[12:15], s39 offen lds
    s_add_u32 m0, m0, 1024
    s_add_u32 s39, s39, 8192
    buffer_load_dwordx4 v120, s[12:15], s39 offen lds
    s_add_u32 m0, m0, 1024
    s_add_u32 s39, s39, 8192
    buffer_load_dwordx4 v119, s[12:15], s39 offen lds
    s_add_u32 m0, m0, 1024
    s_add_u32 s39, s39, 8192
    buffer_load_dwordx4 v120, s[12:15], s39 offen lds
    s_add_u32 m0, m0, 1024
    s_add_u32 s39, s39, 8192
    buffer_load_dwordx4 v119, s[12:15], s39 offen lds
    s_add_u32 m0, m0, 1024
    s_add_u32 s39, s39, 8192
    buffer_load_dwordx4 v120, s[12:15], s39 offen lds
    s_mov_b32 m0, s19
    s_mov_b32 s39, s16
    s_waitcnt vmcnt(32)
    s_barrier
    buffer_load_dwordx4 v119, s[12:15], s39 offen lds
    s_add_u32 m0, m0, 1024
    s_add_u32 s39, s39, 8192
    buffer_load_dwordx4 v120, s[12:15], s39 offen lds
    s_add_u32 m0, m0, 1024
    s_add_u32 s39, s39, 8192
    buffer_load_dwordx4 v119, s[12:15], s39 offen lds
    s_add_u32 m0, m0, 1024
    s_add_u32 s39, s39, 8192
    buffer_load_dwordx4 v120, s[12:15], s39 offen lds
    s_add_u32 m0, m0, 1024
    s_add_u32 s39, s39, 8192
    buffer_load_dwordx4 v119, s[12:15], s39 offen lds
    s_add_u32 m0, m0, 1024
    s_add_u32 s39, s39, 8192
    buffer_load_dwordx4 v120, s[12:15], s39 offen lds
    s_add_u32 m0, m0, 1024
    s_add_u32 s39, s39, 8192
    buffer_load_dwordx4 v119, s[12:15], s39 offen lds
    s_add_u32 m0, m0, 1024
    s_add_u32 s39, s39, 8192
    buffer_load_dwordx4 v120, s[12:15], s39 offen lds
    s_call_b64 s[76:77], PREP_w_issue_4
    s_mov_b32 m0, s19
    s_mov_b32 s39, s16
    s_waitcnt vmcnt(24)
    s_barrier
    buffer_load_dwordx4 v119, s[12:15], s39 offen lds
    s_add_u32 m0, m0, 1024
    s_add_u32 s39, s39, 8192
    buffer_load_dwordx4 v120, s[12:15], s39 offen lds
    s_add_u32 m0, m0, 1024
    s_add_u32 s39, s39, 8192
    buffer_load_dwordx4 v119, s[12:15], s39 offen lds
    s_add_u32 m0, m0, 1024
    s_add_u32 s39, s39, 8192
    buffer_load_dwordx4 v120, s[12:15], s39 offen lds
    s_add_u32 m0, m0, 1024
    s_add_u32 s39, s39, 8192
    buffer_load_dwordx4 v119, s[12:15], s39 offen lds
    s_add_u32 m0, m0, 1024
    s_add_u32 s39, s39, 8192
    buffer_load_dwordx4 v120, s[12:15], s39 offen lds
    s_add_u32 m0, m0, 1024
    s_add_u32 s39, s39, 8192
    buffer_load_dwordx4 v119, s[12:15], s39 offen lds
    s_add_u32 m0, m0, 1024
    s_add_u32 s39, s39, 8192
    buffer_load_dwordx4 v120, s[12:15], s39 offen lds
    s_cmp_lg_u32 s60, 0
    s_cbranch_scc1 tl_72
    s_call_b64 s[76:77], SUB_w1_piece_23
    s_waitcnt vmcnt(18)
    s_branch tz_73
tl_72:
    s_waitcnt vmcnt(16)
tz_73:
    s_barrier
    s_cmp_lg_u32 s60, 0
    s_cbranch_scc1 tl_74
    s_call_b64 s[76:77], SUB_w1_piece_24
    s_waitcnt vmcnt(6)
    s_branch tz_75
tl_74:
    s_waitcnt vmcnt(0)
tz_75:
    s_barrier
    s_cmp_lg_u32 s60, 0
    s_cbranch_scc1 tl_76
    s_call_b64 s[76:77], SUB_w1_piece_25
tl_76:
tz_77:
    s_barrier
    s_cmp_lg_u32 s60, 0
    s_cbranch_scc1 tl_78
    s_call_b64 s[76:77], SUB_w1_piece_26
tl_78:
tz_79:
    s_barrier
    s_cmp_lg_u32 s60, 0
    s_cbranch_scc1 tl_80
    s_call_b64 s[76:77], SUB_w1_piece_27
tl_80:
tz_81:
    s_barrier
    s_cmp_eq_u32 s60, 1
    s_cbranch_scc1 K_fin
    s_branch Y_END
Y_END:
    v_and_b32 v81, 7, v0
    v_lshrrev_b32 v84, 6, v0
    v_lshlrev_b32 v84, 4, v84
    v_bfe_u32 v85, v0, 3, 3
    v_add_u32 v84, v84, v85
    s_lshr_b32 s78, s29, 1
    s_lshl_b32 s78, s78, 16
    s_and_b32 s79, s29, 1
    s_lshl_b32 s79, s79, 7
    s_add_u32 s78, s78, s79
    s_lshr_b32 s79, s30, 1
    s_lshl_b32 s79, s79, 13
    s_add_u32 s78, s78, s79
    v_lshlrev_b32 v78, 8, v84
    v_lshl_add_u32 v78, v81, 4, v78
    v_add_u32 v78, s78, v78
    s_lshl_b32 s78, s28, 7
    s_lshl_b32 s79, s29, 3
    s_add_u32 s78, s78, s79
    v_add_u32 v79, s78, v81
    v_lshlrev_b32 v80, 11, v79
    v_and_b32 v85, 3, v79
    v_lshrrev_b32 v82, 2, v79
    v_lshlrev_b32 v82, 14, v82
    v_lshl_add_u32 v82, v85, 11, v82
    v_lshl_add_u32 v82, v84, 4, v82
    v_lshrrev_b32 v85, 2, v84
    v_lshlrev_b32 v85, 3, v85
    v_and_b32 v84, 3, v84
    v_add_u32 v84, v84, v85
    v_lshl_add_u32 v80, v84, 3, v80
    v_lshlrev_b32 v79, 3, v79
    v_lshl_add_u32 v79, v84, 14, v79
    s_add_u32 s80, s4, 0x1800000
    s_addc_u32 s81, s5, 0
    s_mov_b32 s82, 0x400000
    s_mov_b32 s83, 0x20000
    s_mov_b32 s78, 0
    buffer_load_dwordx2 v[110:111], v79, s[80:83], s78 offen sc1
    s_mov_b32 s78, 65536
    buffer_load_dwordx2 v[112:113], v79, s[80:83], s78 offen sc1
    s_mov_b32 s78, 262144
    buffer_load_dwordx2 v[114:115], v79, s[80:83], s78 offen sc1
    s_mov_b32 s78, 327680
    buffer_load_dwordx2 v[116:117], v79, s[80:83], s78 offen sc1
    s_waitcnt vmcnt(10)
    s_barrier
    s_and_b32 s36, s30, 3
    s_lshl_b32 s36, s36, 10
    v_add_u32 v8, s36, v2
    v_add_u32 v9, 65536, v8
    v_add_u32 v10, 131072, v8
    ds_write_b128 v8, v[12:15] offset:49152
    ds_write_b128 v8, v[16:19] offset:53248
    ds_write_b128 v8, v[20:23] offset:57344
    ds_write_b128 v8, v[24:27] offset:61440
    ds_write_b128 v9, v[28:31] offset:0
    ds_write_b128 v9, v[32:35] offset:4096
    ds_write_b128 v9, v[36:39] offset:8192
    ds_write_b128 v9, v[40:43] offset:12288
    ds_write_b128 v10, v[44:47] offset:0
    ds_write_b128 v10, v[48:51] offset:4096
    ds_write_b128 v10, v[52:55] offset:8192
    ds_write_b128 v10, v[56:59] offset:12288
    ds_write_b128 v8, v[60:63] offset:24576
    ds_write_b128 v8, v[64:67] offset:28672
    s_waitcnt lgkmcnt(0)
NEXT:
    s_setprio 0
    s_add_u32 s60, s60, 1
    s_add_u32 s55, s55, 67108864
    s_add_u32 s62, s62, 67108864
    s_addc_u32 s63, s63, 0
    s_branch LAYER
K_fin:
    s_endpgm
PREP_a_issue_3:
    s_add_u32 s19, s41, s42
    s_cmp_eq_u32 s44, s47
    s_cselect_b32 s16, s46, s44
    s_cmp_eq_u32 s44, s46
    s_cselect_b32 s16, s47, s16
    s_lshr_b32 s45, s16, 2
    s_lshl_b32 s45, s45, 14
    s_and_b32 s16, s16, 3
    s_lshl_b32 s16, s16, 11
    s_add_u32 s16, s16, s45
    s_add_u32 s16, s16, s38
    s_add_u32 s44, s44, 1
    s_and_b32 s44, s44, 15
    s_add_u32 s42, s42, 16384
    s_cmp_eq_u32 s42, 49152
    s_cselect_b32 s42, 0, s42
    s_setpc_b64 s[76:77]
SUB_rest_2:
    v_lshlrev_b32 v108, 16, v20
    v_and_b32 v109, 0xffff0000, v20
    v_lshlrev_b32 v110, 16, v21
    v_and_b32 v111, 0xffff0000, v21
    v_lshlrev_b32 v112, 16, v22
    v_and_b32 v113, 0xffff0000, v22
    v_lshlrev_b32 v114, 16, v23
    v_and_b32 v115, 0xffff0000, v23
    v_pk_add_f32 v[24:25], v[108:109], v[110:111]
    v_pk_mul_f32 v[26:27], v[108:109], v[108:109]
    v_pk_fma_f32 v[26:27], v[110:111], v[110:111], v[26:27]
    v_pk_add_f32 v[24:25], v[24:25], v[112:113]
    v_pk_fma_f32 v[26:27], v[112:113], v[112:113], v[26:27]
    v_pk_add_f32 v[24:25], v[24:25], v[114:115]
    v_pk_fma_f32 v[26:27], v[114:115], v[114:115], v[26:27]
    v_add_f32 v100, v24, v25
    v_add_f32 v101, v26, v27
    v_lshlrev_b32 v108, 16, v28
    v_and_b32 v109, 0xffff0000, v28
    v_lshlrev_b32 v110, 16, v29
    v_and_b32 v111, 0xffff0000, v29
    v_lshlrev_b32 v112, 16, v30
    v_and_b32 v113, 0xffff0000, v30
    v_lshlrev_b32 v114, 16, v31
    v_and_b32 v115, 0xffff0000, v31
    v_pk_add_f32 v[32:33], v[108:109], v[110:111]
    v_pk_mul_f32 v[34:35], v[108:109], v[108:109]
    v_pk_fma_f32 v[34:35], v[110:111], v[110:111], v[34:35]
    v_pk_add_f32 v[32:33], v[32:33], v[112:113]
    v_pk_fma_f32 v[34:35], v[112:113], v[112:113], v[34:35]
    v_pk_add_f32 v[32:33], v[32:33], v[114:115]
    v_pk_fma_f32 v[34:35], v[114:115], v[114:115], v[34:35]
    v_add_f32 v102, v32, v33
    v_add_f32 v103, v34, v35
    v_lshlrev_b32 v108, 16, v36
    v_and_b32 v109, 0xffff0000, v36
    v_lshlrev_b32 v110, 16, v37
    v_and_b32 v111, 0xffff0000, v37
    v_lshlrev_b32 v112, 16, v38
    v_and_b32 v113, 0xffff0000, v38
    v_lshlrev_b32 v114, 16, v39
    v_and_b32 v115, 0xffff0000, v39
    v_pk_add_f32 v[40:41], v[108:109], v[110:111]
    v_pk_mul_f32 v[42:43], v[108:109], v[108:109]
    v_pk_fma_f32 v[42:43], v[110:111], v[110:111], v[42:43]
    v_pk_add_f32 v[40:41], v[40:41], v[112:113]
    v_pk_fma_f32 v[42:43], v[112:113], v[112:113], v[42:43]
    v_pk_add_f32 v[40:41], v[40:41], v[114:115]
    v_pk_fma_f32 v[42:43], v[114:115], v[114:115], v[42:43]
    v_add_f32 v104, v40, v41
    v_add_f32 v105, v42, v43
    v_lshlrev_b32 v108, 16, v44
    v_and_b32 v109, 0xffff0000, v44
    v_lshlrev_b32 v110, 16, v45
    v_and_b32 v111, 0xffff0000, v45
    v_lshlrev_b32 v112, 16, v46
    v_and_b32 v113, 0xffff0000, v46
    v_lshlrev_b32 v114, 16, v47
    v_and_b32 v115, 0xffff0000, v47
    v_pk_add_f32 v[48:49], v[108:109], v[110:111]
    v_pk_mul_f32 v[50:51], v[108:109], v[108:109]
    v_pk_fma_f32 v[50:51], v[110:111], v[110:111], v[50:51]
    v_pk_add_f32 v[48:49], v[48:49], v[112:113]
    v_pk_fma_f32 v[50:51], v[112:113], v[112:113], v[50:51]
    v_pk_add_f32 v[48:49], v[48:49], v[114:115]
    v_pk_fma_f32 v[50:51], v[114:115], v[114:115], v[50:51]
    v_add_f32 v106, v48, v49
    v_add_f32 v107, v50, v51
    s_and_b32 s36, s30, 3
    s_lshl_b32 s36, s36, 10
    s_add_u32 s36, s36, 155648
    v_lshlrev_b32 v6, 3, v1
    v_add_u32 v6, s36, v6
    v_permlane32_swap_b32 v100, v102
    v_permlane32_swap_b32 v104, v106
    v_permlane32_swap_b32 v101, v103
    v_permlane32_swap_b32 v105, v107
    v_pk_add_f32 v[100:101], v[100:101], v[102:103]
    v_pk_add_f32 v[104:105], v[104:105], v[106:107]
    ds_write_b64 v6, v[100:101] offset:0
    ds_write_b64 v6, v[104:105] offset:512
    s_setpc_b64 s[76:77]
PREP_a_issue_4:
    s_add_u32 s19, s41, s42
    s_lshl_b32 s45, s44, 1
    s_add_u32 s45, s45, 0
    s_sub_u32 s45, s45, 32
    s_mul_i32 s46, s45, 86
    s_lshr_b32 s46, s46, 8
    s_mul_i32 s47, s46, 3
    s_sub_u32 s47, s45, s47
    s_lshl_b32 s47, s47, 2
    s_lshr_b32 s47, 0x362, s47
    s_and_b32 s47, s47, 7
    s_cmp_ge_u32 s44, 10
    s_cselect_b32 s45, 9, 2
    s_cselect_b32 s51, 1, 0
    s_sub_u32 s45, s44, s45
    s_cmp_lt_u32 s44, 3
    s_cselect_b32 s45, 0, s45
    s_cselect_b32 s51, s44, s51
    s_lshl2_add_u32 s51, 0, s51
    s_cmp_lt_u32 s44, 17
    s_cselect_b32 s47, s51, s47
    s_cselect_b32 s46, s45, s46
    s_add_u32 s46, s46, s33
    s_and_b32 s46, s46, 7
    s_mul_i32 s46, s46, 7
    s_add_u32 s16, s46, s47
    s_lshr_b32 s53, s16, 3
    s_lshl_b32 s53, s53, 14
    s_and_b32 s16, s16, 7
    s_lshl_b32 s16, s16, 10
    s_add_u32 s16, s16, s53
    s_add_u32 s16, s16, s38
    s_lshl_b32 s45, s44, 1
    s_add_u32 s45, s45, 1
    s_sub_u32 s45, s45, 32
    s_mul_i32 s46, s45, 86
    s_lshr_b32 s46, s46, 8
    s_mul_i32 s47, s46, 3
    s_sub_u32 s47, s45, s47
    s_lshl_b32 s47, s47, 2
    s_lshr_b32 s47, 0x362, s47
    s_and_b32 s47, s47, 7
    s_cmp_ge_u32 s44, 10
    s_cselect_b32 s45, 9, 2
    s_cselect_b32 s51, 1, 0
    s_sub_u32 s45, s44, s45
    s_cmp_lt_u32 s44, 3
    s_cselect_b32 s45, 0, s45
    s_cselect_b32 s51, s44, s51
    s_lshl2_add_u32 s51, 1, s51
    s_cmp_lt_u32 s44, 17
    s_cselect_b32 s47, s51, s47
    s_cselect_b32 s46, s45, s46
    s_add_u32 s46, s46, s33
    s_and_b32 s46, s46, 7
    s_mul_i32 s46, s46, 7
    s_add_u32 s17, s46, s47
    s_lshr_b32 s53, s17, 3
    s_lshl_b32 s53, s53, 14
    s_and_b32 s17, s17, 7
    s_lshl_b32 s17, s17, 10
    s_add_u32 s17, s17, s53
    s_add_u32 s17, s17, s38
    s_add_u32 s44, s44, 1
    s_add_u32 s42, s42, 16384
    s_cmp_eq_u32 s42, 49152
    s_cselect_b32 s42, 0, s42
    s_setpc_b64 s[76:77]
SUB_w1_piece_23:
    s_add_u32 s36, s67, 3
    s_and_b32 s36, s36, 7
    s_lshl_b32 s36, s36, 17
    s_add_u32 s36, s36, s90
    buffer_load_dwordx4 v[12:15], v118, s[8:11], s36 offen
    s_add_u32 s36, s36, 65536
    buffer_load_dwordx4 v[16:19], v118, s[8:11], s36 offen
    s_setpc_b64 s[76:77]
SUB_w1_piece_24:
    s_add_u32 s36, s67, 4
    s_and_b32 s36, s36, 7
    s_lshl_b32 s36, s36, 17
    s_add_u32 s36, s36, s90
    buffer_load_dwordx4 v[20:23], v118, s[8:11], s36 offen
    s_add_u32 s36, s36, 65536
    buffer_load_dwordx4 v[24:27], v118, s[8:11], s36 offen
    s_add_u32 s36, s67, 5
    s_and_b32 s36, s36, 7
    s_lshl_b32 s36, s36, 17
    s_add_u32 s36, s36, s90
    buffer_load_dwordx4 v[28:31], v118, s[8:11], s36 offen
    s_add_u32 s36, s36, 65536
    buffer_load_dwordx4 v[32:35], v118, s[8:11], s36 offen
    s_setpc_b64 s[76:77]
SUB_w1_piece_25:
    s_add_u32 s36, s67, 6
    s_and_b32 s36, s36, 7
    s_lshl_b32 s36, s36, 17
    s_add_u32 s36, s36, s90
    buffer_load_dwordx4 v[36:39], v118, s[8:11], s36 offen
    s_add_u32 s36, s36, 65536
    buffer_load_dwordx4 v[40:43], v118, s[8:11], s36 offen
    s_add_u32 s36, s67, 5
    s_and_b32 s36, s36, 7
    s_lshl_b32 s36, s36, 17
    s_add_u32 s36, s36, s90
    s_add_u32 s36, s36, 1048576
    buffer_load_dwordx4 v[44:47], v118, s[8:11], s36 offen
    s_add_u32 s36, s36, 65536
    buffer_load_dwordx4 v[48:51], v118, s[8:11], s36 offen
    s_setpc_b64 s[76:77]
SUB_w1_piece_26:
    s_add_u32 s36, s67, 6
    s_and_b32 s36, s36, 7
    s_lshl_b32 s36, s36, 17
    s_add_u32 s36, s36, s90
    s_add_u32 s36, s36, 1048576
    buffer_load_dwordx4 v[52:55], v118, s[8:11], s36 offen
    s_add_u32 s36, s36, 65536
    buffer_load_dwordx4 v[56:59], v118, s[8:11], s36 offen
    s_add_u32 s36, s67, 0
    s_and_b32 s36, s36, 7
    s_lshl_b32 s36, s36, 17
    s_add_u32 s36, s36, s90
    buffer_load_dwordx4 v[60:63], v118, s[8:11], s36 offen
    s_add_u32 s36, s36, 65536
    buffer_load_dwordx4 v[64:67], v118, s[8:11], s36 offen
    s_add_u32 s36, s67, 7
    s_and_b32 s36, s36, 7
    s_lshl_b32 s36, s36, 17
    s_add_u32 s36, s36, s90
    s_add_u32 s36, s36, 1048576
    s_add_u32 m0, s3, 147456
    s_nop 0
    buffer_load_dwordx4 v118, s[8:11], s36 offen lds
    s_add_u32 s36, s36, 65536
    s_add_u32 m0, s3, 151552
    s_nop 0
    buffer_load_dwordx4 v118, s[8:11], s36 offen lds
    s_setpc_b64 s[76:77]
SUB_w1_piece_27:
    s_add_u32 s36, s67, 3
    s_and_b32 s36, s36, 7
    s_lshl_b32 s36, s36, 17
    s_add_u32 s36, s36, s90
    s_add_u32 s36, s36, 1048576
    s_add_u32 m0, s3, 114688
    s_nop 0
    buffer_load_dwordx4 v118, s[8:11], s36 offen lds
    s_add_u32 s36, s36, 65536
    s_add_u32 m0, s3, 118784
    s_nop 0
    buffer_load_dwordx4 v118, s[8:11], s36 offen lds
    s_add_u32 s36, s67, 4
    s_and_b32 s36, s36, 7
    s_lshl_b32 s36, s36, 17
    s_add_u32 s36, s36, s90
    s_add_u32 s36, s36, 1048576
    s_add_u32 m0, s3, 122880
    s_nop 0
    buffer_load_dwordx4 v118, s[8:11], s36 offen lds
    s_add_u32 s36, s36, 65536
    s_add_u32 m0, s3, 126976
    s_nop 0
    buffer_load_dwordx4 v118, s[8:11], s36 offen lds
    s_setpc_b64 s[76:77]
PREP_w_issue_3:
    s_add_u32 s19, s41, s42
    s_cmp_eq_u32 s44, s47
    s_cselect_b32 s16, s46, s44
    s_mul_i32 s16, s16, 458752
    s_add_u32 s16, s16, s38
    s_add_u32 s44, s44, 1
    s_and_b32 s44, s44, 15
    s_add_u32 s42, s42, 28672
    s_cmp_eq_u32 s42, 86016
    s_cselect_b32 s42, 0, s42
    s_setpc_b64 s[76:77]
PREP_w_issue_4:
    s_add_u32 s19, s41, s42
    s_and_b32 s40, s30, 1
    s_lshl_b32 s45, s44, 1
    s_add_u32 s45, s45, s40
    s_sub_u32 s45, s45, 32
    s_mul_i32 s46, s45, 86
    s_lshr_b32 s46, s46, 8
    s_mul_i32 s47, s46, 3
    s_sub_u32 s47, s45, s47
    s_lshl_b32 s47, s47, 2
    s_lshr_b32 s47, 0x362, s47
    s_and_b32 s47, s47, 7
    s_cmp_ge_u32 s44, 10
    s_cselect_b32 s45, 9, 2
    s_cselect_b32 s51, 1, 0
    s_sub_u32 s45, s44, s45
    s_cmp_lt_u32 s44, 3
    s_cselect_b32 s45, 0, s45
    s_cselect_b32 s51, s44, s51
    s_lshl2_add_u32 s51, s40, s51
    s_cmp_lt_u32 s44, 17
    s_cselect_b32 s47, s51, s47
    s_cselect_b32 s46, s45, s46
    s_add_u32 s46, s46, s33
    s_and_b32 s46, s46, 7
    s_mul_i32 s46, s46, 7
    s_add_u32 s16, s46, s47
    s_mul_i32 s16, s16, 65536
    s_add_u32 s16, s16, s38
    s_add_u32 s44, s44, 1
    s_add_u32 s42, s42, 16384
    s_cmp_eq_u32 s42, 98304
    s_cselect_b32 s42, 0, s42
    s_setpc_b64 s[76:77]
K_end:
    s_endpgm
.section .rodata,"a"
.p2align 6
.amdhsa_kernel interleave_layers__ssm_conv_h3__mixer_s_mlp__prompt_kernel
  .amdhsa_next_free_vgpr 256
  .amdhsa_next_free_sgpr 102
  .amdhsa_accum_offset 256
  .amdhsa_group_segment_fixed_size 0
  .amdhsa_kernarg_size 112
  .amdhsa_user_sgpr_count 2
  .amdhsa_user_sgpr_kernarg_segment_ptr 1
  .amdhsa_system_sgpr_workgroup_id_x 1
  .amdhsa_float_denorm_mode_32 3
.end_amdhsa_kernel
```

```asm
; @launch grid=(256,1,1) block=(512,1,1) lds=163840
.amdgcn_target "amdgcn-amd-amdhsa--gfx950"
.text
.globl interleave_layers__ssm_conv_h3__mixer_s_mlp__prompt_kernel
.p2align 8
.type interleave_layers__ssm_conv_h3__mixer_s_mlp__prompt_kernel,@function
interleave_layers__ssm_conv_h3__mixer_s_mlp__prompt_kernel:
    s_cmp_ge_u32 s2, 256
    s_cbranch_scc1 K_end
    s_load_dwordx8 s[8:15], s[0:1], 8
    s_load_dwordx2 s[6:7], s[0:1], 0
    s_load_dwordx8 s[68:75], s[0:1], 56
    s_load_dwordx2 s[4:5], s[0:1], 104
    s_load_dwordx2 s[84:85], s[0:1], 96
    s_memrealtime s[46:47]
    s_load_dwordx2 s[76:77], s[0:1], 40
    v_lshrrev_b32 v1, 6, v0
    s_nop 0
    v_readfirstlane_b32 s30, v1
    s_getpc_b64 s[48:49]
K_pc:
    s_lshr_b32 s36, s2, 3
    s_lshl_b32 s36, s36, 12
    v_lshlrev_b32 v252, 3, v0
    v_add_u32 v252, s36, v252
    v_cmp_gt_u32 vcc, K_end-K_pc-8, v252
    s_nop 0
    s_and_saveexec_b64 s[36:37], vcc
    s_cbranch_execz K_3
    v_mov_b32 v253, s49
    v_add_co_u32 v252, vcc, s48, v252
    s_nop 1
    v_addc_co_u32 v253, vcc, 0, v253, vcc
    global_load_dword v250, v[252:253], off
K_3:
    s_mov_b64 exec, -1
    v_bfe_u32 v8, v0, 4, 2
    v_and_b32 v9, 15, v0
    v_lshlrev_b32 v6, 11, v8
    v_lshlrev_b32 v8, 1, v8
    v_xor_b32 v8, v8, v9
    v_lshl_add_u32 v8, v8, 4, v6
    s_and_b32 s34, s2, 7
    s_lshr_b32 s35, s2, 3
    s_lshl_b32 s36, s35, 17
    s_lshl_b32 s37, s34, 8
    s_add_u32 s36, s36, s37
    s_lshl_b32 s37, s30, 6
    s_and_b32 s38, s37, 128
    s_add_u32 s37, s37, 64
    s_and_b32 s37, s37, 128
    v_xor_b32 v6, s38, v8
    v_xor_b32 v7, s37, v8
    s_lshl_b32 s37, s30, 14
    s_add_u32 s37, s37, s36
    s_add_u32 s38, s37, 8192
    s_lshl_b32 s39, s30, 11
    s_mov_b32 s18, 4194304
    s_mov_b32 s19, 0x20000
    s_mov_b32 s22, s18
    s_mov_b32 s23, s19
    s_add_u32 m0, s39, 99328
    s_waitcnt lgkmcnt(0)
    s_mov_b64 s[16:17], s[8:9]
    s_mov_b64 s[20:21], s[10:11]
    buffer_load_dwordx4 v6, s[16:19], s37 offen nt lds
    s_add_u32 m0, m0, 1024
    s_nop 0
    buffer_load_dwordx4 v7, s[16:19], s38 offen nt lds
    s_add_u32 m0, s39, 115712
    s_nop 0
    buffer_load_dwordx4 v6, s[20:23], s37 offen nt lds
    s_add_u32 m0, m0, 1024
    s_nop 0
    buffer_load_dwordx4 v6, s[20:23], s38 offen nt lds
    s_mov_b32 s86, 256
    s_mov_b32 s87, 0x20000
    v_mov_b32 v10, 0
    s_cmp_lg_u32 s30, 0
    s_cbranch_scc1 KV_t0
    s_sub_u32 s36, s36, 8192
    v_add_u32 v8, s36, v8
    s_mov_b32 m0, 98304
    s_nop 0
    buffer_load_dwordx4 v8, s[16:19], 0 offen nt lds
    s_cmp_lg_u32 s2, 0
    s_cbranch_scc1 KV_t0
    s_lshl_b32 s44, s46, 6
    s_or_b32 s44, s44, 1
    v_mov_b32 v9, s44
    s_mov_b64 exec, 1
    buffer_store_dword v9, v10, s[84:87], 0 offen sc1
    s_mov_b64 exec, -1
KV_t0:
    s_lshl_b32 s37, s34, 10
    s_lshl_b32 s38, s30, 7
    s_add_u32 s37, s37, s38
    v_and_b32 v9, 15, v0
    v_lshlrev_b32 v9, 3, v9
    s_mov_b32 s24, s12
    s_mov_b32 s25, s13
    s_mov_b32 s26, 0x2000
    s_mov_b32 s27, 0x20000
    buffer_load_dwordx2 v[12:13], v9, s[24:27], s37 offen
    v_and_b32 v1, 63, v0
    v_lshlrev_b32 v2, 4, v1
    v_lshlrev_b32 v3, 2, v1
    s_and_b32 s32, s2, 7
    s_lshr_b32 s33, s2, 3
    s_and_b32 s28, s32, 2
    s_lshr_b32 s34, s32, 2
    s_or_b32 s28, s28, s34
    s_lshl_b32 s28, s28, 2
    s_and_b32 s34, s33, 3
    s_add_u32 s28, s28, s34
    s_and_b32 s31, s32, 1
    s_lshr_b32 s33, s33, 2
    s_lshl_b32 s29, s31, 3
    s_add_u32 s29, s29, s33
    s_and_b32 s67, s33, 4
    s_mov_b32 s60, 0
    s_mov_b32 s61, 40000
    s_mov_b32 s52, 0
    s_mov_b32 s55, 0
    s_mov_b32 s92, 0
    s_mov_b32 s93, 0
    s_mov_b32 s94, 0
    s_mov_b32 s56, s4
    s_mov_b32 s57, s5
    s_mov_b32 s58, 0xa000000
    s_mov_b32 s59, 0x20000
    s_add_u32 s62, s4, 33554432
    s_addc_u32 s63, s5, 0
    s_cmp_lg_u32 s30, 4
    s_cbranch_scc1 HB_1
    v_add_u32 v14, 162816, v3
    ds_write_b32 v14, v10
HB_1:
    s_mov_b64 s[88:89], s[70:71]
    s_mov_b32 s90, 2097152
    s_mov_b32 s91, 0x20000
    s_lshl3_add_u32 s36, s2, s30
    s_lshl_b32 s36, s36, 10
    s_mov_b64 s[80:81], s[68:69]
    s_mov_b32 s82, 2097152
    s_mov_b32 s83, 0x20000
    s_mov_b32 s50, s36
    v_lshrrev_b32 v14, 3, v1
    v_lshlrev_b32 v118, 11, v14
    v_and_b32 v14, 6, v14
    v_and_b32 v15, 7, v1
    v_xor_b32 v14, v14, v15
    v_lshl_add_u32 v118, v14, 4, v118
    v_mov_b32 v119, 0
    v_mov_b32 v120, 0
    v_mov_b32 v121, 0
    v_mov_b32 v122, 0
    v_mov_b32 v123, 0
    v_mov_b32 v124, 0
    v_mov_b32 v125, 0
    v_mov_b32 v126, 0
    v_mov_b32 v127, 0
    s_lshl_b32 s48, s29, 7
    s_lshl_b32 s36, s30, 14
    s_add_u32 s48, s48, s36
    s_lshl_b32 s49, s30, 10
    s_add_u32 s48, s48, 1048576
    s_and_b32 s41, s30, 3
    s_and_b32 s38, s2, 7
    s_lshl_b32 s38, s38, 5
    s_lshr_b32 s39, s2, 3
    s_add_u32 s38, s38, s39
    s_lshl_b32 s39, s38, 2
    s_add_u32 s39, s39, s41
    s_mul_i32 s40, s41, 21504
    s_lshl_b32 s36, s39, 12
    s_add_u32 s12, s14, s36
    s_addc_u32 s13, s15, 0
    s_mov_b32 s14, 4096
    s_mov_b32 s15, 0x20000
    s_lshr_b32 s45, s30, 2
    s_lshl_b32 s45, s45, 11
    s_add_u32 s36, s45, 0xffffffc0
    v_add_u32 v22, s36, v2
    v_add_u32 v23, 16, v22
    s_add_u32 s36, s45, 0x3c0
    v_add_u32 v24, s36, v2
    v_add_u32 v25, 16, v24
    s_mov_b32 s36, 4032
    v_add_u32 v26, s36, v2
    v_add_u32 v27, 16, v26
    v_add_u32 v19, s40, v2
    v_add_u32 v20, s45, v19
    s_lshl_b32 s36, s38, 14
    s_add_u32 s36, s36, 25165824
    s_add_u32 s20, s4, s36
    s_addc_u32 s21, s5, 0
    s_mov_b32 s22, 16384
    s_mov_b32 s23, 0x20000
    s_lshl_b32 s36, s30, 6
    v_lshrrev_b32 v94, 2, v1
    v_and_b32 v97, 48, v2
    v_lshl_add_u32 v97, v94, 8, v97
    v_add_u32 v97, s36, v97
    s_lshr_b32 s36, s39, 1
    s_lshl_b32 s36, s36, 2
    s_load_dword s41, s[76:77], s36
    v_and_b32 v100, 15, v1
    v_lshrrev_b32 v101, 4, v1
    v_and_b32 v94, 3, v100
    v_mul_u32_u24 v98, 4160, v94
    v_lshl_add_u32 v98, v101, 4, v98
    v_lshrrev_b32 v94, 2, v100
    v_lshl_add_u32 v98, v94, 3, v98
    v_add_u32 v98, s40, v98
    v_sub_u32 v94, 15, v100
    v_lshlrev_b32 v99, 5, v94
    v_add_u32 v99, s40, v99
    v_lshl_add_u32 v99, v101, 4, v99
    s_lshr_b32 s36, s38, 2
    s_lshl_b32 s36, s36, 12
    s_add_u32 s36, s36, 23330816
    v_lshlrev_b32 v102, 7, v1
    v_add_u32 v102, s36, v102
    v_and_b32 v81, 7, v0
    v_lshrrev_b32 v84, 6, v0
    v_lshlrev_b32 v84, 4, v84
    v_bfe_u32 v85, v0, 3, 3
    v_add_u32 v84, v84, v85
    s_lshr_b32 s78, s29, 1
    s_lshl_b32 s78, s78, 16
    s_and_b32 s79, s29, 1
    s_lshl_b32 s79, s79, 7
    s_add_u32 s78, s78, s79
    s_lshr_b32 s79, s30, 1
    s_lshl_b32 s79, s79, 13
    s_add_u32 s78, s78, s79
    v_lshlrev_b32 v78, 8, v84
    v_lshl_add_u32 v78, v81, 4, v78
    v_add_u32 v78, s78, v78
    s_lshl_b32 s78, s28, 7
    s_lshl_b32 s79, s29, 3
    s_add_u32 s78, s78, s79
    v_add_u32 v79, s78, v81
    v_lshlrev_b32 v80, 11, v79
    v_and_b32 v85, 3, v79
    v_lshrrev_b32 v82, 2, v79
    v_lshlrev_b32 v82, 14, v82
    v_lshl_add_u32 v82, v85, 11, v82
    v_lshl_add_u32 v82, v84, 4, v82
    v_lshrrev_b32 v85, 2, v84
    v_lshlrev_b32 v85, 3, v85
    v_and_b32 v84, 3, v84
    v_add_u32 v84, v84, v85
    v_lshl_add_u32 v80, v84, 3, v80
    v_lshlrev_b32 v79, 3, v79
    v_lshl_add_u32 v79, v84, 14, v79
    s_mov_b32 s8, s6
    s_mov_b32 s9, s7
    s_mov_b32 s10, 0x400000
    s_mov_b32 s11, 0x20000
    v_mov_b32 v60, 0
    v_mov_b32 v61, 0
    v_mov_b32 v62, 0
    v_mov_b32 v63, 0
    s_bfm_b64 exec, 40, 0
    ds_write_b128 v19, v[60:63] offset:20736
    s_mov_b64 exec, -1
    s_and_b32 s34, s2, 7
    s_lshr_b32 s35, s2, 3
    v_bfe_u32 v14, v1, 2, 3
    v_xor_b32 v14, s30, v14
    v_lshlrev_b32 v16, 5, v14
    v_and_b32 v14, 3, v1
    v_lshl_add_u32 v16, v14, 3, v16
    v_bfe_u32 v14, v1, 2, 2
    v_lshl_add_u32 v16, v14, 8, v16
    v_lshrrev_b32 v14, 4, v1
    v_lshl_add_u32 v16, v14, 12, v16
    v_add_u32 v16, 98304, v16
    v_xor_b32 v17, 128, v16
    s_add_u32 s16, s4, 0x1800000
    s_addc_u32 s17, s5, 0
    s_mov_b32 s18, 0x400000
    s_mov_b32 s19, 0x20000
    v_bfe_u32 v18, v1, 2, 2
    v_lshlrev_b32 v18, 14, v18
    v_and_b32 v14, 3, v1
    v_lshl_add_u32 v18, v14, 6, v18
    v_bfe_u32 v14, v1, 4, 1
    v_lshrrev_b32 v15, 5, v1
    v_lshl_add_u32 v14, v14, 1, v15
    v_xor_b32 v14, 3, v14
    v_lshl_add_u32 v18, v14, 4, v18
    s_lshl3_add_u32 s42, s34, s30
    s_lshl_b32 s43, s42, 16
    s_sub_u32 s37, 31, s35
    s_lshl_b32 s37, s37, 9
    s_add_u32 s43, s43, s37
    s_lshl_b32 s44, s42, 5
    s_add_u32 s44, s44, s35
    s_lshl_b32 s44, s44, 7
    s_add_u32 s44, s44, 23330816
    s_cmp_lt_u32 s30, 4
    s_cbranch_scc1 HB_4
    v_lshrrev_b32 v14, 4, v1
    v_lshlrev_b32 v119, 11, v14
    v_add_u32 v14, 0, v14
    v_lshlrev_b32 v14, 1, v14
    v_and_b32 v15, 15, v1
    v_xor_b32 v14, v14, v15
    v_lshl_add_u32 v119, v14, 4, v119
    v_lshrrev_b32 v14, 4, v1
    v_lshlrev_b32 v120, 11, v14
    v_add_u32 v14, 4, v14
    v_lshlrev_b32 v14, 1, v14
    v_and_b32 v15, 15, v1
    v_xor_b32 v14, v14, v15
    v_lshl_add_u32 v120, v14, 4, v120
    v_add_u32 v15, 0, v1
    v_mul_u32_u24 v14, 2341, v15
    v_lshrrev_b32 v14, 16, v14
    v_mul_u32_u24 v121, 28, v14
    v_sub_u32 v15, v15, v121
    v_mul_u32_u24 v121, 7168, v14
    v_lshrrev_b32 v14, 1, v14
    v_and_b32 v14, 2, v14
    v_xor_b32 v15, v15, v14
    v_lshl_add_u32 v121, v15, 4, v121
    v_add_u32 v15, 64, v1
    v_mul_u32_u24 v14, 2341, v15
    v_lshrrev_b32 v14, 16, v14
    v_mul_u32_u24 v122, 28, v14
    v_sub_u32 v15, v15, v122
    v_mul_u32_u24 v122, 7168, v14
    v_lshrrev_b32 v14, 1, v14
    v_and_b32 v14, 2, v14
    v_xor_b32 v15, v15, v14
    v_lshl_add_u32 v122, v15, 4, v122
    v_add_u32 v15, 128, v1
    v_mul_u32_u24 v14, 2341, v15
    v_lshrrev_b32 v14, 16, v14
    v_mul_u32_u24 v123, 28, v14
    v_sub_u32 v15, v15, v123
    v_mul_u32_u24 v123, 7168, v14
    v_lshrrev_b32 v14, 1, v14
    v_and_b32 v14, 2, v14
    v_xor_b32 v15, v15, v14
    v_lshl_add_u32 v123, v15, 4, v123
    v_add_u32 v15, 192, v1
    v_mul_u32_u24 v14, 2341, v15
    v_lshrrev_b32 v14, 16, v14
    v_mul_u32_u24 v124, 28, v14
    v_sub_u32 v15, v15, v124
    v_mul_u32_u24 v124, 7168, v14
    v_lshrrev_b32 v14, 1, v14
    v_and_b32 v14, 2, v14
    v_xor_b32 v15, v15, v14
    v_lshl_add_u32 v124, v15, 4, v124
    v_add_u32 v15, 256, v1
    v_mul_u32_u24 v14, 2341, v15
    v_lshrrev_b32 v14, 16, v14
    v_mul_u32_u24 v125, 28, v14
    v_sub_u32 v15, v15, v125
    v_mul_u32_u24 v125, 7168, v14
    v_lshrrev_b32 v14, 1, v14
    v_and_b32 v14, 2, v14
    v_xor_b32 v15, v15, v14
    v_lshl_add_u32 v125, v15, 4, v125
    v_add_u32 v15, 320, v1
    v_mul_u32_u24 v14, 2341, v15
    v_lshrrev_b32 v14, 16, v14
    v_mul_u32_u24 v126, 28, v14
    v_sub_u32 v15, v15, v126
    v_mul_u32_u24 v126, 7168, v14
    v_lshrrev_b32 v14, 1, v14
    v_and_b32 v14, 2, v14
    v_xor_b32 v15, v15, v14
    v_lshl_add_u32 v126, v15, 4, v126
    v_add_u32 v15, 384, v1
    v_mul_u32_u24 v14, 2341, v15
    v_lshrrev_b32 v14, 16, v14
    v_mul_u32_u24 v127, 28, v14
    v_sub_u32 v15, v15, v127
    v_mul_u32_u24 v127, 7168, v14
    v_lshrrev_b32 v14, 1, v14
    v_and_b32 v14, 2, v14
    v_xor_b32 v15, v15, v14
    v_lshl_add_u32 v127, v15, 4, v127
HB_4:
    buffer_load_dwordx4 v[28:31], v22, s[12:15], 0 offen nt
    buffer_load_dwordx2 v[32:33], v23, s[12:15], 0 offen nt
    buffer_load_dwordx4 v[34:37], v24, s[12:15], 0 offen nt
    buffer_load_dwordx2 v[38:39], v25, s[12:15], 0 offen nt
    buffer_load_dwordx4 v[40:43], v26, s[12:15], 0 offen nt
    buffer_load_dwordx2 v[44:45], v27, s[12:15], 0 offen nt
    buffer_load_dwordx4 v[240:243], v2, s[88:91], s50 offen
    s_cmp_ge_u32 s30, 4
    s_cbranch_scc1 HB_3
    s_mul_i32 s36, s30, 21568
    v_lshrrev_b32 v94, 1, v100
    v_mul_u32_u24 v108, 72, v94
    v_and_b32 v94, 1, v100
    v_lshl_add_u32 v108, v94, 4, v108
    v_lshl_add_u32 v108, v101, 2, v108
    v_add_u32 v108, s36, v108
    v_add_u32 v109, 1152, v108
    v_add_u32 v110, 2304, v108
    v_add_u32 v111, 3456, v108
    v_bfe_u32 v94, v1, 2, 2
    v_mul_u32_u24 v103, 21568, v94
    v_mul_u32_u24 v94, 72, v101
    v_add_u32 v103, v103, v94
    v_and_b32 v94, 3, v1
    v_lshl_add_u32 v103, v94, 3, v103
    s_mul_i32 s36, s30, 1152
    v_add_u32 v103, s36, v103
    s_waitcnt lgkmcnt(0)
    s_bitcmp1_b32 s39, 0
    s_cselect_b32 s36, 0, 16
    s_lshl_b32 s41, s41, s36
    s_and_b32 s41, s41, 0xffff0000
    s_lshr_b32 s36, s41, 16
    v_lshl_add_u32 v94, v101, 3, v100
    v_sub_u32 v94, 15, v94
    v_and_b32 v95, 1, v94
    v_cmp_eq_u32 vcc, 1, v95
    v_mov_b32 v95, s36
    v_mov_b32 v96, s41
    v_cndmask_b32 v95, v95, v96, vcc
    v_ashrrev_i32 v94, 1, v94
    v_cmp_eq_u32 vcc, 0, v94
    s_nop 1
    v_cndmask_b32 v104, 0, v95, vcc
    v_cmp_eq_u32 vcc, 1, v94
    s_nop 1
    v_cndmask_b32 v105, 0, v95, vcc
    v_cmp_eq_u32 vcc, 2, v94
    s_nop 1
    v_cndmask_b32 v106, 0, v95, vcc
    v_cmp_eq_u32 vcc, 3, v94
    s_nop 1
    v_cndmask_b32 v107, 0, v95, vcc
HB_3:
    s_waitcnt vmcnt(7) lgkmcnt(0)
    s_barrier
    ds_read_b64_tr_b16 v[128:129], v16 offset:0
    ds_read_b64_tr_b16 v[130:131], v16 offset:1024
    ds_read_b64_tr_b16 v[132:133], v16 offset:2048
    ds_read_b64_tr_b16 v[134:135], v16 offset:3072
    ds_read_b64_tr_b16 v[136:137], v17 offset:4096
    ds_read_b64_tr_b16 v[138:139], v16 offset:17408
    ds_read_b64_tr_b16 v[140:141], v16 offset:18432
    ds_read_b64_tr_b16 v[142:143], v16 offset:19456
    ds_read_b64_tr_b16 v[144:145], v16 offset:20480
    s_load_dword s52, s[84:85], 0
    v_lshlrev_b32 v46, 16, v12
    v_and_b32 v47, 0xffff0000, v12
    v_lshlrev_b32 v48, 16, v13
    v_and_b32 v49, 0xffff0000, v13
    s_waitcnt lgkmcnt(0)
    v_lshlrev_b32 v146, 16, v128
    v_and_b32 v147, 0xffff0000, v128
    v_lshlrev_b32 v148, 16, v129
    v_and_b32 v149, 0xffff0000, v129
    v_lshlrev_b32 v150, 16, v130
    v_and_b32 v151, 0xffff0000, v130
    v_lshlrev_b32 v152, 16, v131
    v_and_b32 v153, 0xffff0000, v131
    v_lshlrev_b32 v154, 16, v132
    v_and_b32 v155, 0xffff0000, v132
    v_lshlrev_b32 v156, 16, v133
    v_and_b32 v157, 0xffff0000, v133
    v_lshlrev_b32 v158, 16, v134
    v_and_b32 v159, 0xffff0000, v134
    v_lshlrev_b32 v160, 16, v135
    v_and_b32 v161, 0xffff0000, v135
    v_lshlrev_b32 v162, 16, v136
    v_and_b32 v163, 0xffff0000, v136
    v_lshlrev_b32 v164, 16, v137
    v_and_b32 v165, 0xffff0000, v137
    v_mul_f32 v166, v147, v49
    v_mul_f32 v167, v148, v49
    v_mul_f32 v168, v149, v49
    v_mul_f32 v169, v150, v49
    v_mul_f32 v170, v151, v49
    v_mul_f32 v171, v152, v49
    v_mul_f32 v172, v153, v49
    v_mul_f32 v173, v154, v49
    v_mul_f32 v174, v155, v49
    v_mul_f32 v175, v156, v49
    v_mul_f32 v176, v157, v49
    v_mul_f32 v177, v158, v49
    v_mul_f32 v178, v159, v49
    v_mul_f32 v179, v160, v49
    v_mul_f32 v180, v161, v49
    v_mul_f32 v181, v162, v49
    v_fmac_f32 v166, v148, v48
    v_fmac_f32 v167, v149, v48
    v_fmac_f32 v168, v150, v48
    v_fmac_f32 v169, v151, v48
    v_fmac_f32 v170, v152, v48
    v_fmac_f32 v171, v153, v48
    v_fmac_f32 v172, v154, v48
    v_fmac_f32 v173, v155, v48
    v_fmac_f32 v174, v156, v48
    v_fmac_f32 v175, v157, v48
    v_fmac_f32 v176, v158, v48
    v_fmac_f32 v177, v159, v48
    v_fmac_f32 v178, v160, v48
    v_fmac_f32 v179, v161, v48
    v_fmac_f32 v180, v162, v48
    v_fmac_f32 v181, v163, v48
    v_fmac_f32 v166, v149, v47
    v_fmac_f32 v167, v150, v47
    v_fmac_f32 v168, v151, v47
    v_fmac_f32 v169, v152, v47
    v_fmac_f32 v170, v153, v47
    v_fmac_f32 v171, v154, v47
    v_fmac_f32 v172, v155, v47
    v_fmac_f32 v173, v156, v47
    v_fmac_f32 v174, v157, v47
    v_fmac_f32 v175, v158, v47
    v_fmac_f32 v176, v159, v47
    v_fmac_f32 v177, v160, v47
    v_fmac_f32 v178, v161, v47
    v_fmac_f32 v179, v162, v47
    v_fmac_f32 v180, v163, v47
    v_fmac_f32 v181, v164, v47
    v_fmac_f32 v166, v150, v46
    v_fmac_f32 v167, v151, v46
    v_fmac_f32 v168, v152, v46
    v_fmac_f32 v169, v153, v46
    v_fmac_f32 v170, v154, v46
    v_fmac_f32 v171, v155, v46
    v_fmac_f32 v172, v156, v46
    v_fmac_f32 v173, v157, v46
    v_fmac_f32 v174, v158, v46
    v_fmac_f32 v175, v159, v46
    v_fmac_f32 v176, v160, v46
    v_fmac_f32 v177, v161, v46
    v_fmac_f32 v178, v162, v46
    v_fmac_f32 v179, v163, v46
    v_fmac_f32 v180, v164, v46
    v_fmac_f32 v181, v165, v46
    v_lshlrev_b32 v146, 16, v138
    v_and_b32 v147, 0xffff0000, v138
    v_lshlrev_b32 v148, 16, v139
    v_and_b32 v149, 0xffff0000, v139
    v_lshlrev_b32 v150, 16, v140
    v_and_b32 v151, 0xffff0000, v140
    v_lshlrev_b32 v152, 16, v141
    v_and_b32 v153, 0xffff0000, v141
    v_lshlrev_b32 v154, 16, v142
    v_and_b32 v155, 0xffff0000, v142
    v_lshlrev_b32 v156, 16, v143
    v_and_b32 v157, 0xffff0000, v143
    v_lshlrev_b32 v158, 16, v144
    v_and_b32 v159, 0xffff0000, v144
    v_lshlrev_b32 v160, 16, v145
    v_and_b32 v161, 0xffff0000, v145
    v_mul_f32 v166, v166, v146
    v_mul_f32 v167, v167, v147
    v_mul_f32 v168, v168, v148
    v_mul_f32 v169, v169, v149
    v_mul_f32 v170, v170, v150
    v_mul_f32 v171, v171, v151
    v_mul_f32 v172, v172, v152
    v_mul_f32 v173, v173, v153
    v_mul_f32 v174, v174, v154
    v_mul_f32 v175, v175, v155
    v_mul_f32 v176, v176, v156
    v_mul_f32 v177, v177, v157
    v_mul_f32 v178, v178, v158
    v_mul_f32 v179, v179, v159
    v_mul_f32 v180, v180, v160
    v_mul_f32 v181, v181, v161
    v_add_u32 v167, 0x10000, v167
    v_and_b32 v167, 0xfffe0000, v167
    v_add_u32 v169, 0x10000, v169
    v_and_b32 v169, 0xfffe0000, v169
    v_add_u32 v171, 0x10000, v171
    v_and_b32 v171, 0xfffe0000, v171
    v_add_u32 v173, 0x10000, v173
    v_and_b32 v173, 0xfffe0000, v173
    v_add_u32 v175, 0x10000, v175
    v_and_b32 v175, 0xfffe0000, v175
    v_add_u32 v177, 0x10000, v177
    v_and_b32 v177, 0xfffe0000, v177
    v_add_u32 v179, 0x10000, v179
    v_and_b32 v179, 0xfffe0000, v179
    v_add_u32 v181, 0x10000, v181
    v_and_b32 v181, 0xfffe0000, v181
    v_cvt_pk_bf16_f32 v52, v173, v172
    v_cvt_pk_bf16_f32 v53, v171, v170
    v_cvt_pk_bf16_f32 v54, v169, v168
    v_cvt_pk_bf16_f32 v55, v167, v166
    v_cvt_pk_bf16_f32 v56, v181, v180
    v_cvt_pk_bf16_f32 v57, v179, v178
    v_cvt_pk_bf16_f32 v58, v177, v176
    v_cvt_pk_bf16_f32 v59, v175, v174
    s_cmp_lg_u32 s52, 0
    s_cbranch_scc1 HB_q
    s_mov_b32 s53, 0
HB_p:
    buffer_load_dword v14, v10, s[84:87], 0 offen sc1
    s_waitcnt vmcnt(0)
    v_readfirstlane_b32 s52, v14
    s_nop 0
    s_cmp_lg_u32 s52, 0
    s_cbranch_scc1 HB_q
    s_add_u32 s53, s53, 1
    s_cmp_lt_u32 s53, s61
    s_cbranch_scc1 HB_p
    s_mov_b32 s52, 1
    s_mov_b32 s61, 0
HB_q:
    v_permlane32_swap_b32 v52, v56
    v_permlane32_swap_b32 v53, v57
    v_permlane32_swap_b32 v54, v58
    v_permlane32_swap_b32 v55, v59
    v_mov_b32 v14, s52
    buffer_store_dwordx4 v[52:55], v18, s[16:19], s43 offen offset:256 sc1
    buffer_store_dwordx4 v[56:59], v18, s[16:19], s43 offen offset:0 sc1
    s_waitcnt vmcnt(3)
    v_alignbit_b32 v128, v29, v28, 16
    v_mov_b32 v132, v29
    v_alignbit_b32 v136, v30, v29, 16
    v_alignbit_b32 v129, v30, v29, 16
    v_mov_b32 v133, v30
    v_alignbit_b32 v137, v31, v30, 16
    v_alignbit_b32 v130, v31, v30, 16
    v_mov_b32 v134, v31
    v_alignbit_b32 v138, v32, v31, 16
    v_alignbit_b32 v131, v32, v31, 16
    v_mov_b32 v135, v32
    v_alignbit_b32 v139, v33, v32, 16
    ds_write_b128 v20, v[128:131] offset:0
    ds_write_b128 v20, v[132:135] offset:4160
    ds_write_b128 v20, v[136:139] offset:8320
    ds_write_b128 v20, v[30:33] offset:12480
    v_alignbit_b32 v140, v35, v34, 16
    v_mov_b32 v144, v35
    v_alignbit_b32 v148, v36, v35, 16
    v_alignbit_b32 v141, v36, v35, 16
    v_mov_b32 v145, v36
    v_alignbit_b32 v149, v37, v36, 16
    v_alignbit_b32 v142, v37, v36, 16
    v_mov_b32 v146, v37
    v_alignbit_b32 v150, v38, v37, 16
    v_alignbit_b32 v143, v38, v37, 16
    v_mov_b32 v147, v38
    v_alignbit_b32 v151, v39, v38, 16
    ds_write_b128 v20, v[140:143] offset:1024
    ds_write_b128 v20, v[144:147] offset:5184
    ds_write_b128 v20, v[148:151] offset:9344
    ds_write_b128 v20, v[36:39] offset:13504
    s_waitcnt vmcnt(0)
    s_mov_b64 exec, 1
    buffer_store_dword v14, v10, s[56:59], s44 offen sc1
    s_mov_b64 exec, -1
    s_cmp_lg_u32 s30, 5
    s_cbranch_scc1 KV_n3
    s_lshl_b32 s36, s2, 14
    s_add_u32 s36, s36, 29360128
    v_lshrrev_b32 v15, 3, v1
    v_mul_u32_u24 v15, 8064, v15
    v_add_u32 v15, v15, v2
    s_mov_b64 exec, 0xffff
    buffer_store_dwordx4 v[60:63], v15, s[56:59], s36 offen sc1
    s_mov_b64 exec, -1
KV_n3:
    v_alignbit_b32 v152, v41, v40, 16
    v_mov_b32 v156, v41
    v_alignbit_b32 v160, v42, v41, 16
    v_alignbit_b32 v153, v42, v41, 16
    v_mov_b32 v157, v42
    v_alignbit_b32 v161, v43, v42, 16
    v_alignbit_b32 v154, v43, v42, 16
    v_mov_b32 v158, v43
    v_alignbit_b32 v162, v44, v43, 16
    v_alignbit_b32 v155, v44, v43, 16
    v_mov_b32 v159, v44
    v_alignbit_b32 v163, v45, v44, 16
    s_mov_b64 exec, 0xf
    ds_write_b128 v19, v[152:155] offset:4096
    ds_write_b128 v19, v[156:159] offset:8256
    ds_write_b128 v19, v[160:163] offset:12416
    ds_write_b128 v19, v[42:45] offset:16576
    s_mov_b64 exec, -1
    s_waitcnt lgkmcnt(0)
    s_barrier
    s_add_u32 s36, s67, 0
    s_and_b32 s36, s36, 7
    s_lshl_b32 s36, s36, 17
    s_add_u32 s36, s36, s48
    s_add_u32 m0, s49, 90112
    s_nop 0
    buffer_load_dwordx4 v118, s[88:91], s36 offen lds
    s_add_u32 s36, s67, 1
    s_and_b32 s36, s36, 7
    s_lshl_b32 s36, s36, 17
    s_add_u32 s36, s36, s48
    s_add_u32 m0, s49, 98304
    s_nop 0
    buffer_load_dwordx4 v118, s[88:91], s36 offen lds
    s_add_u32 s36, s67, 2
    s_and_b32 s36, s36, 7
    s_lshl_b32 s36, s36, 17
    s_add_u32 s36, s36, s48
    s_add_u32 m0, s49, 106496
    s_nop 0
    buffer_load_dwordx4 v118, s[88:91], s36 offen lds
    s_add_u32 s36, s67, 3
    s_and_b32 s36, s36, 7
    s_lshl_b32 s36, s36, 17
    s_add_u32 s36, s36, s48
    s_add_u32 m0, s49, 114688
    s_nop 0
    buffer_load_dwordx4 v118, s[88:91], s36 offen lds
    s_add_u32 s36, s67, 4
    s_and_b32 s36, s36, 7
    s_lshl_b32 s36, s36, 17
    s_add_u32 s36, s36, s48
    s_add_u32 m0, s49, 122880
    s_nop 0
    buffer_load_dwordx4 v118, s[88:91], s36 offen lds
    s_add_u32 s36, s67, 5
    s_and_b32 s36, s36, 7
    s_lshl_b32 s36, s36, 17
    s_add_u32 s36, s36, s48
    s_add_u32 m0, s49, 131072
    s_nop 0
    buffer_load_dwordx4 v118, s[88:91], s36 offen lds
    s_add_u32 s36, s67, 6
    s_and_b32 s36, s36, 7
    s_lshl_b32 s36, s36, 17
    s_add_u32 s36, s36, s48
    s_add_u32 m0, s49, 139264
    s_nop 0
    buffer_load_dwordx4 v118, s[88:91], s36 offen lds
    s_add_u32 s36, s67, 7
    s_and_b32 s36, s36, 7
    s_lshl_b32 s36, s36, 17
    s_add_u32 s36, s36, s48
    s_add_u32 m0, s49, 147456
    s_nop 0
    buffer_load_dwordx4 v118, s[88:91], s36 offen lds
    s_cmp_ge_u32 s30, 4
    s_cbranch_scc1 FR_b
    s_lshl_b32 s44, s30, 12
    s_mov_b32 s45, 0x07060302
    s_cmp_lg_u32 s30, 0
    s_cbranch_scc1 CV_w
    s_mov_b32 s53, 0
    s_add_u32 s54, s52, 0
    s_bfm_b64 exec, 32, 0
poll_1:
    buffer_load_dword v8, v102, s[56:59], 0 offen sc1
    s_waitcnt vmcnt(0)
    v_cmp_eq_u32 vcc, s54, v8
    s_nop 0
    s_cmp_eq_u64 vcc, exec
    s_cbranch_scc1 pok_2
    s_sleep 5
    s_add_u32 s53, s53, 1
    s_cmp_lt_u32 s53, s61
    s_cbranch_scc1 poll_1
    s_mov_b32 s61, 0
pok_2:
    s_mov_b64 exec, -1
CV_w:
    s_add_u32 m0, s40, 16640
    s_mov_b32 s36, 0
    s_waitcnt vmcnt(0)
    s_barrier
    buffer_load_dwordx4 v97, s[20:23], s36 offen offset:0 sc1 lds
    s_add_u32 s36, s36, 3072
    buffer_load_dwordx4 v97, s[20:23], s36 offen offset:1024 sc1 lds
    s_add_u32 s36, s36, 3072
    buffer_load_dwordx4 v97, s[20:23], s36 offen offset:2048 sc1 lds
    s_add_u32 s36, s36, 3072
    buffer_load_dwordx4 v97, s[20:23], s36 offen offset:3072 sc1 lds
    s_barrier
    buffer_load_dwordx2 v[86:87], v80, s[8:11], 0 offen offset:0 nt
    buffer_load_dwordx2 v[88:89], v80, s[8:11], 0 offen offset:32 nt
    buffer_load_dwordx2 v[90:91], v80, s[8:11], 0 offen offset:128 nt
    buffer_load_dwordx2 v[92:93], v80, s[8:11], 0 offen offset:160 nt
    ds_read_b64 v[120:121], v98 offset:32
    ds_read_b64 v[122:123], v98 offset:40
    ds_read_b64 v[124:125], v98 offset:544
    ds_read_b64 v[126:127], v98 offset:552
    ds_read_b64 v[128:129], v98 offset:1056
    ds_read_b64 v[130:131], v98 offset:1064
    ds_read_b64 v[132:133], v98 offset:1568
    ds_read_b64 v[134:135], v98 offset:1576
    ds_read_b64 v[136:137], v98 offset:2080
    ds_read_b64 v[138:139], v98 offset:2088
    ds_read_b64 v[140:141], v98 offset:2592
    ds_read_b64 v[142:143], v98 offset:2600
    ds_read_b64 v[144:145], v98 offset:3104
    ds_read_b64 v[146:147], v98 offset:3112
    ds_read_b64 v[148:149], v98 offset:3616
    ds_read_b64 v[150:151], v98 offset:3624
    s_waitcnt vmcnt(4)
    ds_read_b128 v[184:187], v99 offset:20224
    ds_read_b128 v[188:191], v99 offset:19712
    ds_read_b128 v[192:195], v99 offset:19200
    ds_read_b128 v[196:199], v99 offset:18688
    ds_read_b128 v[200:203], v99 offset:18176
    ds_read_b128 v[204:207], v99 offset:17664
    ds_read_b128 v[208:211], v99 offset:17152
    ds_read_b128 v[212:215], v99 offset:16640
    s_waitcnt lgkmcnt(0)
    v_mfma_f32_16x16x32_bf16 v[12:15], v[104:107], v[184:187], 0
    v_mfma_f32_16x16x32_bf16 v[16:19], v[104:107], v[188:191], 0
    v_mfma_f32_16x16x32_bf16 v[20:23], v[104:107], v[192:195], 0
    v_mfma_f32_16x16x32_bf16 v[24:27], v[104:107], v[196:199], 0
    v_mfma_f32_16x16x32_bf16 v[28:31], v[104:107], v[200:203], 0
    v_mfma_f32_16x16x32_bf16 v[32:35], v[104:107], v[204:207], 0
    v_mfma_f32_16x16x32_bf16 v[36:39], v[104:107], v[208:211], 0
    v_mfma_f32_16x16x32_bf16 v[40:43], v[104:107], v[212:215], 0
    s_mov_b32 s43, 0
CV_r:
    s_waitcnt lgkmcnt(0)
    v_mfma_f32_16x16x32_bf16 v[12:15], v[120:123], v[184:187], v[12:15]
    v_mfma_f32_16x16x32_bf16 v[16:19], v[120:123], v[188:191], v[16:19]
    v_mfma_f32_16x16x32_bf16 v[20:23], v[120:123], v[192:195], v[20:23]
    v_mfma_f32_16x16x32_bf16 v[24:27], v[120:123], v[196:199], v[24:27]
    v_mfma_f32_16x16x32_bf16 v[28:31], v[120:123], v[200:203], v[28:31]
    v_mfma_f32_16x16x32_bf16 v[32:35], v[120:123], v[204:207], v[32:35]
    v_mfma_f32_16x16x32_bf16 v[36:39], v[120:123], v[208:211], v[36:39]
    v_mfma_f32_16x16x32_bf16 v[40:43], v[120:123], v[212:215], v[40:43]
    v_mfma_f32_16x16x32_bf16 v[16:19], v[124:127], v[184:187], v[16:19]
    v_mfma_f32_16x16x32_bf16 v[20:23], v[124:127], v[188:191], v[20:23]
    v_mfma_f32_16x16x32_bf16 v[24:27], v[124:127], v[192:195], v[24:27]
    v_mfma_f32_16x16x32_bf16 v[28:31], v[124:127], v[196:199], v[28:31]
    v_mfma_f32_16x16x32_bf16 v[32:35], v[124:127], v[200:203], v[32:35]
    v_mfma_f32_16x16x32_bf16 v[36:39], v[124:127], v[204:207], v[36:39]
    v_mfma_f32_16x16x32_bf16 v[40:43], v[124:127], v[208:211], v[40:43]
    v_mfma_f32_16x16x32_bf16 v[20:23], v[128:131], v[184:187], v[20:23]
    v_mfma_f32_16x16x32_bf16 v[24:27], v[128:131], v[188:191], v[24:27]
    v_mfma_f32_16x16x32_bf16 v[28:31], v[128:131], v[192:195], v[28:31]
    v_mfma_f32_16x16x32_bf16 v[32:35], v[128:131], v[196:199], v[32:35]
    v_mfma_f32_16x16x32_bf16 v[36:39], v[128:131], v[200:203], v[36:39]
    v_mfma_f32_16x16x32_bf16 v[40:43], v[128:131], v[204:207], v[40:43]
    v_mfma_f32_16x16x32_bf16 v[24:27], v[132:135], v[184:187], v[24:27]
    v_mfma_f32_16x16x32_bf16 v[28:31], v[132:135], v[188:191], v[28:31]
    v_mfma_f32_16x16x32_bf16 v[32:35], v[132:135], v[192:195], v[32:35]
    v_mfma_f32_16x16x32_bf16 v[36:39], v[132:135], v[196:199], v[36:39]
    v_mfma_f32_16x16x32_bf16 v[40:43], v[132:135], v[200:203], v[40:43]
    v_mfma_f32_16x16x32_bf16 v[28:31], v[136:139], v[184:187], v[28:31]
    v_mfma_f32_16x16x32_bf16 v[32:35], v[136:139], v[188:191], v[32:35]
    v_mfma_f32_16x16x32_bf16 v[36:39], v[136:139], v[192:195], v[36:39]
    v_mfma_f32_16x16x32_bf16 v[40:43], v[136:139], v[196:199], v[40:43]
    v_mfma_f32_16x16x32_bf16 v[32:35], v[140:143], v[184:187], v[32:35]
    v_mfma_f32_16x16x32_bf16 v[36:39], v[140:143], v[188:191], v[36:39]
    v_mfma_f32_16x16x32_bf16 v[40:43], v[140:143], v[192:195], v[40:43]
    v_mfma_f32_16x16x32_bf16 v[36:39], v[144:147], v[184:187], v[36:39]
    v_mfma_f32_16x16x32_bf16 v[40:43], v[144:147], v[188:191], v[40:43]
    v_mfma_f32_16x16x32_bf16 v[40:43], v[148:151], v[184:187], v[40:43]
    ds_read_b128 v[216:219], v99 offset:20288
    ds_read_b128 v[220:223], v99 offset:19776
    ds_read_b128 v[224:227], v99 offset:19264
    ds_read_b128 v[228:231], v99 offset:18752
    ds_read_b128 v[232:235], v99 offset:18240
    ds_read_b128 v[236:239], v99 offset:17728
    ds_read_b128 v[240:243], v99 offset:17216
    ds_read_b128 v[244:247], v99 offset:16704
    ds_read_b64 v[152:153], v98 offset:96
    ds_read_b64 v[154:155], v98 offset:104
    ds_read_b64 v[156:157], v98 offset:608
    ds_read_b64 v[158:159], v98 offset:616
    ds_read_b64 v[160:161], v98 offset:1120
    ds_read_b64 v[162:163], v98 offset:1128
    ds_read_b64 v[164:165], v98 offset:1632
    ds_read_b64 v[166:167], v98 offset:1640
    ds_read_b64 v[168:169], v98 offset:2144
    ds_read_b64 v[170:171], v98 offset:2152
    ds_read_b64 v[172:173], v98 offset:2656
    ds_read_b64 v[174:175], v98 offset:2664
    ds_read_b64 v[176:177], v98 offset:3168
    ds_read_b64 v[178:179], v98 offset:3176
    ds_read_b64 v[180:181], v98 offset:3680
    ds_read_b64 v[182:183], v98 offset:3688
    s_waitcnt lgkmcnt(0)
    v_mfma_f32_16x16x32_bf16 v[12:15], v[152:155], v[216:219], v[12:15]
    v_mfma_f32_16x16x32_bf16 v[16:19], v[152:155], v[220:223], v[16:19]
    v_mfma_f32_16x16x32_bf16 v[20:23], v[152:155], v[224:227], v[20:23]
    v_mfma_f32_16x16x32_bf16 v[24:27], v[152:155], v[228:231], v[24:27]
    v_mfma_f32_16x16x32_bf16 v[28:31], v[152:155], v[232:235], v[28:31]
    v_mfma_f32_16x16x32_bf16 v[32:35], v[152:155], v[236:239], v[32:35]
    v_mfma_f32_16x16x32_bf16 v[36:39], v[152:155], v[240:243], v[36:39]
    v_mfma_f32_16x16x32_bf16 v[40:43], v[152:155], v[244:247], v[40:43]
    v_mfma_f32_16x16x32_bf16 v[16:19], v[156:159], v[216:219], v[16:19]
    v_mfma_f32_16x16x32_bf16 v[20:23], v[156:159], v[220:223], v[20:23]
    v_mfma_f32_16x16x32_bf16 v[24:27], v[156:159], v[224:227], v[24:27]
    v_mfma_f32_16x16x32_bf16 v[28:31], v[156:159], v[228:231], v[28:31]
    v_mfma_f32_16x16x32_bf16 v[32:35], v[156:159], v[232:235], v[32:35]
    v_mfma_f32_16x16x32_bf16 v[36:39], v[156:159], v[236:239], v[36:39]
    v_mfma_f32_16x16x32_bf16 v[40:43], v[156:159], v[240:243], v[40:43]
    v_mfma_f32_16x16x32_bf16 v[20:23], v[160:163], v[216:219], v[20:23]
    v_mfma_f32_16x16x32_bf16 v[24:27], v[160:163], v[220:223], v[24:27]
    v_mfma_f32_16x16x32_bf16 v[28:31], v[160:163], v[224:227], v[28:31]
    v_mfma_f32_16x16x32_bf16 v[32:35], v[160:163], v[228:231], v[32:35]
    v_mfma_f32_16x16x32_bf16 v[36:39], v[160:163], v[232:235], v[36:39]
    v_mfma_f32_16x16x32_bf16 v[40:43], v[160:163], v[236:239], v[40:43]
    v_mfma_f32_16x16x32_bf16 v[24:27], v[164:167], v[216:219], v[24:27]
    v_mfma_f32_16x16x32_bf16 v[28:31], v[164:167], v[220:223], v[28:31]
    v_mfma_f32_16x16x32_bf16 v[32:35], v[164:167], v[224:227], v[32:35]
    v_mfma_f32_16x16x32_bf16 v[36:39], v[164:167], v[228:231], v[36:39]
    v_mfma_f32_16x16x32_bf16 v[40:43], v[164:167], v[232:235], v[40:43]
    v_mfma_f32_16x16x32_bf16 v[28:31], v[168:171], v[216:219], v[28:31]
    v_mfma_f32_16x16x32_bf16 v[32:35], v[168:171], v[220:223], v[32:35]
    v_mfma_f32_16x16x32_bf16 v[36:39], v[168:171], v[224:227], v[36:39]
    v_mfma_f32_16x16x32_bf16 v[40:43], v[168:171], v[228:231], v[40:43]
    v_mfma_f32_16x16x32_bf16 v[32:35], v[172:175], v[216:219], v[32:35]
    v_mfma_f32_16x16x32_bf16 v[36:39], v[172:175], v[220:223], v[36:39]
    v_mfma_f32_16x16x32_bf16 v[40:43], v[172:175], v[224:227], v[40:43]
    v_mfma_f32_16x16x32_bf16 v[36:39], v[176:179], v[216:219], v[36:39]
    v_mfma_f32_16x16x32_bf16 v[40:43], v[176:179], v[220:223], v[40:43]
    v_mfma_f32_16x16x32_bf16 v[40:43], v[180:183], v[216:219], v[40:43]
    ds_read_b128 v[184:187], v99 offset:20352
    ds_read_b128 v[188:191], v99 offset:19840
    ds_read_b128 v[192:195], v99 offset:19328
    ds_read_b128 v[196:199], v99 offset:18816
    ds_read_b128 v[200:203], v99 offset:18304
    ds_read_b128 v[204:207], v99 offset:17792
    ds_read_b128 v[208:211], v99 offset:17280
    ds_read_b128 v[212:215], v99 offset:16768
    ds_read_b64 v[120:121], v98 offset:160
    ds_read_b64 v[122:123], v98 offset:168
    ds_read_b64 v[124:125], v98 offset:672
    ds_read_b64 v[126:127], v98 offset:680
    ds_read_b64 v[128:129], v98 offset:1184
    ds_read_b64 v[130:131], v98 offset:1192
    ds_read_b64 v[132:133], v98 offset:1696
    ds_read_b64 v[134:135], v98 offset:1704
    ds_read_b64 v[136:137], v98 offset:2208
    ds_read_b64 v[138:139], v98 offset:2216
    ds_read_b64 v[140:141], v98 offset:2720
    ds_read_b64 v[142:143], v98 offset:2728
    ds_read_b64 v[144:145], v98 offset:3232
    ds_read_b64 v[146:147], v98 offset:3240
    ds_read_b64 v[148:149], v98 offset:3744
    ds_read_b64 v[150:151], v98 offset:3752
    v_add_u32 v98, 128, v98
    v_add_u32 v99, 128, v99
    s_add_u32 s43, s43, 1
    s_cmp_lt_u32 s43, 2
    s_cbranch_scc1 CV_r
CV_l:
    s_waitcnt lgkmcnt(0)
    v_mfma_f32_16x16x32_bf16 v[12:15], v[120:123], v[184:187], v[12:15]
    ds_read_b128 v[216:219], v99 offset:20288
    v_mfma_f32_16x16x32_bf16 v[16:19], v[120:123], v[188:191], v[16:19]
    ds_read_b128 v[220:223], v99 offset:19776
    v_mfma_f32_16x16x32_bf16 v[20:23], v[120:123], v[192:195], v[20:23]
    ds_read_b128 v[224:227], v99 offset:19264
    v_mfma_f32_16x16x32_bf16 v[24:27], v[120:123], v[196:199], v[24:27]
    ds_read_b128 v[228:231], v99 offset:18752
    v_mfma_f32_16x16x32_bf16 v[28:31], v[120:123], v[200:203], v[28:31]
    ds_read_b128 v[232:235], v99 offset:18240
    v_mfma_f32_16x16x32_bf16 v[32:35], v[120:123], v[204:207], v[32:35]
    ds_read_b128 v[236:239], v99 offset:17728
    v_mfma_f32_16x16x32_bf16 v[36:39], v[120:123], v[208:211], v[36:39]
    ds_read_b128 v[240:243], v99 offset:17216
    v_mfma_f32_16x16x32_bf16 v[40:43], v[120:123], v[212:215], v[40:43]
    ds_read_b128 v[244:247], v99 offset:16704
    v_mfma_f32_16x16x32_bf16 v[16:19], v[124:127], v[184:187], v[16:19]
    ds_read_b64 v[152:153], v98 offset:96
    v_mfma_f32_16x16x32_bf16 v[20:23], v[124:127], v[188:191], v[20:23]
    ds_read_b64 v[154:155], v98 offset:104
    v_mfma_f32_16x16x32_bf16 v[24:27], v[124:127], v[192:195], v[24:27]
    ds_read_b64 v[156:157], v98 offset:608
    v_mfma_f32_16x16x32_bf16 v[28:31], v[124:127], v[196:199], v[28:31]
    ds_read_b64 v[158:159], v98 offset:616
    v_mfma_f32_16x16x32_bf16 v[32:35], v[124:127], v[200:203], v[32:35]
    ds_read_b64 v[160:161], v98 offset:1120
    v_mfma_f32_16x16x32_bf16 v[36:39], v[124:127], v[204:207], v[36:39]
    ds_read_b64 v[162:163], v98 offset:1128
    v_mfma_f32_16x16x32_bf16 v[40:43], v[124:127], v[208:211], v[40:43]
    ds_read_b64 v[164:165], v98 offset:1632
    v_mfma_f32_16x16x32_bf16 v[20:23], v[128:131], v[184:187], v[20:23]
    ds_read_b64 v[166:167], v98 offset:1640
    v_mfma_f32_16x16x32_bf16 v[24:27], v[128:131], v[188:191], v[24:27]
    ds_read_b64 v[168:169], v98 offset:2144
    v_mfma_f32_16x16x32_bf16 v[28:31], v[128:131], v[192:195], v[28:31]
    ds_read_b64 v[170:171], v98 offset:2152
    v_mfma_f32_16x16x32_bf16 v[32:35], v[128:131], v[196:199], v[32:35]
    ds_read_b64 v[172:173], v98 offset:2656
    v_mfma_f32_16x16x32_bf16 v[36:39], v[128:131], v[200:203], v[36:39]
    ds_read_b64 v[174:175], v98 offset:2664
    v_mfma_f32_16x16x32_bf16 v[40:43], v[128:131], v[204:207], v[40:43]
    ds_read_b64 v[176:177], v98 offset:3168
    v_mfma_f32_16x16x32_bf16 v[24:27], v[132:135], v[184:187], v[24:27]
    ds_read_b64 v[178:179], v98 offset:3176
    v_mfma_f32_16x16x32_bf16 v[28:31], v[132:135], v[188:191], v[28:31]
    ds_read_b64 v[180:181], v98 offset:3680
    v_mfma_f32_16x16x32_bf16 v[32:35], v[132:135], v[192:195], v[32:35]
    ds_read_b64 v[182:183], v98 offset:3688
    v_mfma_f32_16x16x32_bf16 v[36:39], v[132:135], v[196:199], v[36:39]
    v_mfma_f32_16x16x32_bf16 v[40:43], v[132:135], v[200:203], v[40:43]
    v_mfma_f32_16x16x32_bf16 v[28:31], v[136:139], v[184:187], v[28:31]
    v_mfma_f32_16x16x32_bf16 v[32:35], v[136:139], v[188:191], v[32:35]
    v_mfma_f32_16x16x32_bf16 v[36:39], v[136:139], v[192:195], v[36:39]
    v_mfma_f32_16x16x32_bf16 v[40:43], v[136:139], v[196:199], v[40:43]
    v_mfma_f32_16x16x32_bf16 v[32:35], v[140:143], v[184:187], v[32:35]
    v_mfma_f32_16x16x32_bf16 v[36:39], v[140:143], v[188:191], v[36:39]
    v_mfma_f32_16x16x32_bf16 v[40:43], v[140:143], v[192:195], v[40:43]
    v_mfma_f32_16x16x32_bf16 v[36:39], v[144:147], v[184:187], v[36:39]
    v_mfma_f32_16x16x32_bf16 v[40:43], v[144:147], v[188:191], v[40:43]
    v_mfma_f32_16x16x32_bf16 v[40:43], v[148:151], v[184:187], v[40:43]
    s_waitcnt lgkmcnt(0)
    v_mfma_f32_16x16x32_bf16 v[12:15], v[152:155], v[216:219], v[12:15]
    ds_read_b128 v[184:187], v99 offset:20352
    v_mfma_f32_16x16x32_bf16 v[16:19], v[152:155], v[220:223], v[16:19]
    ds_read_b128 v[188:191], v99 offset:19840
    v_mfma_f32_16x16x32_bf16 v[20:23], v[152:155], v[224:227], v[20:23]
    ds_read_b128 v[192:195], v99 offset:19328
    v_mfma_f32_16x16x32_bf16 v[24:27], v[152:155], v[228:231], v[24:27]
    ds_read_b128 v[196:199], v99 offset:18816
    v_mfma_f32_16x16x32_bf16 v[28:31], v[152:155], v[232:235], v[28:31]
    ds_read_b128 v[200:203], v99 offset:18304
    v_mfma_f32_16x16x32_bf16 v[32:35], v[152:155], v[236:239], v[32:35]
    ds_read_b128 v[204:207], v99 offset:17792
    v_mfma_f32_16x16x32_bf16 v[36:39], v[152:155], v[240:243], v[36:39]
    ds_read_b128 v[208:211], v99 offset:17280
    v_mfma_f32_16x16x32_bf16 v[40:43], v[152:155], v[244:247], v[40:43]
    ds_read_b128 v[212:215], v99 offset:16768
    v_mfma_f32_16x16x32_bf16 v[16:19], v[156:159], v[216:219], v[16:19]
    ds_read_b64 v[120:121], v98 offset:160
    v_mfma_f32_16x16x32_bf16 v[20:23], v[156:159], v[220:223], v[20:23]
    ds_read_b64 v[122:123], v98 offset:168
    v_mfma_f32_16x16x32_bf16 v[24:27], v[156:159], v[224:227], v[24:27]
    ds_read_b64 v[124:125], v98 offset:672
    v_mfma_f32_16x16x32_bf16 v[28:31], v[156:159], v[228:231], v[28:31]
    ds_read_b64 v[126:127], v98 offset:680
    v_mfma_f32_16x16x32_bf16 v[32:35], v[156:159], v[232:235], v[32:35]
    ds_read_b64 v[128:129], v98 offset:1184
    v_mfma_f32_16x16x32_bf16 v[36:39], v[156:159], v[236:239], v[36:39]
    ds_read_b64 v[130:131], v98 offset:1192
    v_mfma_f32_16x16x32_bf16 v[40:43], v[156:159], v[240:243], v[40:43]
    ds_read_b64 v[132:133], v98 offset:1696
    v_mfma_f32_16x16x32_bf16 v[20:23], v[160:163], v[216:219], v[20:23]
    ds_read_b64 v[134:135], v98 offset:1704
    v_mfma_f32_16x16x32_bf16 v[24:27], v[160:163], v[220:223], v[24:27]
    ds_read_b64 v[136:137], v98 offset:2208
    v_mfma_f32_16x16x32_bf16 v[28:31], v[160:163], v[224:227], v[28:31]
    ds_read_b64 v[138:139], v98 offset:2216
    v_mfma_f32_16x16x32_bf16 v[32:35], v[160:163], v[228:231], v[32:35]
    ds_read_b64 v[140:141], v98 offset:2720
    v_mfma_f32_16x16x32_bf16 v[36:39], v[160:163], v[232:235], v[36:39]
    ds_read_b64 v[142:143], v98 offset:2728
    v_mfma_f32_16x16x32_bf16 v[40:43], v[160:163], v[236:239], v[40:43]
    ds_read_b64 v[144:145], v98 offset:3232
    v_mfma_f32_16x16x32_bf16 v[24:27], v[164:167], v[216:219], v[24:27]
    ds_read_b64 v[146:147], v98 offset:3240
    v_mfma_f32_16x16x32_bf16 v[28:31], v[164:167], v[220:223], v[28:31]
    ds_read_b64 v[148:149], v98 offset:3744
    v_mfma_f32_16x16x32_bf16 v[32:35], v[164:167], v[224:227], v[32:35]
    ds_read_b64 v[150:151], v98 offset:3752
    v_mfma_f32_16x16x32_bf16 v[36:39], v[164:167], v[228:231], v[36:39]
    v_add_u32 v98, 128, v98
    v_mfma_f32_16x16x32_bf16 v[40:43], v[164:167], v[232:235], v[40:43]
    v_add_u32 v99, 128, v99
    v_mfma_f32_16x16x32_bf16 v[28:31], v[168:171], v[216:219], v[28:31]
    s_add_u32 s43, s43, 1
    v_mfma_f32_16x16x32_bf16 v[32:35], v[168:171], v[220:223], v[32:35]
    s_cmp_lt_u32 s43, 4
    v_mfma_f32_16x16x32_bf16 v[36:39], v[168:171], v[224:227], v[36:39]
    v_mfma_f32_16x16x32_bf16 v[40:43], v[168:171], v[228:231], v[40:43]
    v_mfma_f32_16x16x32_bf16 v[32:35], v[172:175], v[216:219], v[32:35]
    v_mfma_f32_16x16x32_bf16 v[36:39], v[172:175], v[220:223], v[36:39]
    v_mfma_f32_16x16x32_bf16 v[40:43], v[172:175], v[224:227], v[40:43]
    v_mfma_f32_16x16x32_bf16 v[36:39], v[176:179], v[216:219], v[36:39]
    v_mfma_f32_16x16x32_bf16 v[40:43], v[176:179], v[220:223], v[40:43]
    v_mfma_f32_16x16x32_bf16 v[40:43], v[180:183], v[216:219], v[40:43]
    s_cbranch_scc1 CV_l
    s_bitcmp1_b32 s30, 0
    s_waitcnt lgkmcnt(0)
    s_cbranch_scc1 CV_o
    v_perm_b32 v12, v14, v12, s45
    v_perm_b32 v13, v15, v13, s45
    v_or_b32 v12, 0x10001, v12
    v_or_b32 v13, 0x10001, v13
    ds_write2_b32 v108, v12, v13 offset0:0 offset1:8
    v_perm_b32 v16, v18, v16, s45
    v_perm_b32 v17, v19, v17, s45
    v_or_b32 v16, 0x10001, v16
    v_or_b32 v17, 0x10001, v17
    ds_write2_b32 v108, v16, v17 offset0:144 offset1:152
    v_perm_b32 v20, v22, v20, s45
    v_perm_b32 v21, v23, v21, s45
    v_or_b32 v20, 0x10001, v20
    v_or_b32 v21, 0x10001, v21
    ds_write2_b32 v109, v20, v21 offset0:0 offset1:8
    v_perm_b32 v24, v26, v24, s45
    v_perm_b32 v25, v27, v25, s45
    v_or_b32 v24, 0x10001, v24
    v_or_b32 v25, 0x10001, v25
    ds_write2_b32 v109, v24, v25 offset0:144 offset1:152
    v_perm_b32 v28, v30, v28, s45
    v_perm_b32 v29, v31, v29, s45
    v_or_b32 v28, 0x10001, v28
    v_or_b32 v29, 0x10001, v29
    ds_write2_b32 v110, v28, v29 offset0:0 offset1:8
    v_perm_b32 v32, v34, v32, s45
    v_perm_b32 v33, v35, v33, s45
    v_or_b32 v32, 0x10001, v32
    v_or_b32 v33, 0x10001, v33
    ds_write2_b32 v110, v32, v33 offset0:144 offset1:152
    v_perm_b32 v36, v38, v36, s45
    v_perm_b32 v37, v39, v37, s45
    v_or_b32 v36, 0x10001, v36
    v_or_b32 v37, 0x10001, v37
    ds_write2_b32 v111, v36, v37 offset0:0 offset1:8
    v_perm_b32 v40, v42, v40, s45
    v_perm_b32 v41, v43, v41, s45
    v_or_b32 v40, 0x10001, v40
    v_or_b32 v41, 0x10001, v41
    ds_write2_b32 v111, v40, v41 offset0:144 offset1:152
    s_branch CV_e
CV_o:
    v_cvt_pk_bf16_f32 v12, v12, v14
    v_cvt_pk_bf16_f32 v13, v13, v15
    ds_write2_b32 v108, v12, v13 offset0:0 offset1:8
    v_cvt_pk_bf16_f32 v16, v16, v18
    v_cvt_pk_bf16_f32 v17, v17, v19
    ds_write2_b32 v108, v16, v17 offset0:144 offset1:152
    v_cvt_pk_bf16_f32 v20, v20, v22
    v_cvt_pk_bf16_f32 v21, v21, v23
    ds_write2_b32 v109, v20, v21 offset0:0 offset1:8
    v_cvt_pk_bf16_f32 v24, v24, v26
    v_cvt_pk_bf16_f32 v25, v25, v27
    ds_write2_b32 v109, v24, v25 offset0:144 offset1:152
    v_cvt_pk_bf16_f32 v28, v28, v30
    v_cvt_pk_bf16_f32 v29, v29, v31
    ds_write2_b32 v110, v28, v29 offset0:0 offset1:8
    v_cvt_pk_bf16_f32 v32, v32, v34
    v_cvt_pk_bf16_f32 v33, v33, v35
    ds_write2_b32 v110, v32, v33 offset0:144 offset1:152
    v_cvt_pk_bf16_f32 v36, v36, v38
    v_cvt_pk_bf16_f32 v37, v37, v39
    ds_write2_b32 v111, v36, v37 offset0:0 offset1:8
    v_cvt_pk_bf16_f32 v40, v40, v42
    v_cvt_pk_bf16_f32 v41, v41, v43
    ds_write2_b32 v111, v40, v41 offset0:144 offset1:152
CV_e:
    v_mov_b32 v8, 162824
    v_mov_b32 v9, 1
    s_waitcnt lgkmcnt(0)
    s_mov_b64 exec, 1
    ds_add_u32 v8, v9
    s_mov_b64 exec, -1
    v_mov_b32 v8, 162824
spin_3:
    ds_read_b32 v9, v8
    s_waitcnt lgkmcnt(0)
    v_readfirstlane_b32 s53, v9
    s_nop 0
    s_cmp_ge_u32 s53, 8
    s_cbranch_scc0 spin_3
    ds_read_b64_tr_b16 v[120:121], v103 offset:0
    ds_read_b64_tr_b16 v[122:123], v103 offset:32
    ds_read_b64_tr_b16 v[124:125], v103 offset:288
    ds_read_b64_tr_b16 v[126:127], v103 offset:320
    ds_read_b64_tr_b16 v[128:129], v103 offset:576
    ds_read_b64_tr_b16 v[130:131], v103 offset:608
    ds_read_b64_tr_b16 v[132:133], v103 offset:864
    ds_read_b64_tr_b16 v[134:135], v103 offset:896
    s_waitcnt lgkmcnt(6)
    buffer_store_dwordx4 v[120:123], v2, s[20:23], s44 offen offset:0 sc1
    s_waitcnt lgkmcnt(4)
    buffer_store_dwordx4 v[124:127], v2, s[20:23], s44 offen offset:1024 sc1
    s_waitcnt lgkmcnt(2)
    buffer_store_dwordx4 v[128:131], v2, s[20:23], s44 offen offset:2048 sc1
    s_waitcnt lgkmcnt(0)
    buffer_store_dwordx4 v[132:135], v2, s[20:23], s44 offen offset:3072 sc1
    s_waitcnt vmcnt(4)
    s_branch FR_end
FR_b:
    v_lshrrev_b32 v10, 2, v1
    v_lshlrev_b32 v74, 7, v10
    v_bfe_u32 v10, v10, 1, 2
    s_and_b32 s35, s30, 2
    v_and_b32 v11, 1, v1
    v_or_b32 v11, s35, v11
    v_xor_b32 v10, v10, v11
    v_lshl_add_u32 v74, v10, 5, v74
    v_and_b32 v10, 2, v1
    v_lshl_add_u32 v74, v10, 2, v74
    s_and_b32 s35, s30, 1
    s_lshl_b32 s35, s35, 4
    v_add_u32 v74, s35, v74
    v_add_u32 v75, 65536, v74
    v_add_u32 v76, 131072, v74
    s_and_b32 s36, s30, 3
    s_lshl_b32 s36, s36, 14
    s_lshl_b32 s48, s29, 7
    s_add_u32 s48, s48, s36
    v_mov_b32 v110, 0
    v_mov_b32 v111, 0
    v_mov_b32 v112, 0
    v_mov_b32 v113, 0
    s_and_b32 s44, s30, 3
    s_lshl2_add_u32 s44, s2, s44
    s_lshl_b32 s44, s44, 12
    s_add_u32 s44, s44, 29360128
    s_cmp_lg_u32 s30, 5
    s_cbranch_scc1 FB_np
    s_waitcnt vmcnt(8)
    s_lshl_b32 s42, s2, 14
    s_add_u32 s42, s42, 29360128
    s_memtime s[34:35]
    s_waitcnt lgkmcnt(0)
    s_load_dword s32, s[4:5], s42 offset:0 glc
    s_waitcnt lgkmcnt(0)
    s_memtime s[40:41]
    s_waitcnt lgkmcnt(0)
    s_sub_u32 s46, s40, s34
    s_memtime s[34:35]
    s_waitcnt lgkmcnt(0)
    s_load_dword s32, s[4:5], s42 offset:8192 glc
    s_waitcnt lgkmcnt(0)
    s_memtime s[40:41]
    s_waitcnt lgkmcnt(0)
    s_sub_u32 s47, s40, s34
    s_cmp_lt_u32 s47, s46
    s_cselect_b32 s45, 1, 0
    s_lshr_b32 s46, s28, 2
    s_xor_b32 s45, s45, s46
    s_lshr_b32 s46, s2, 7
    s_xor_b32 s45, s45, s46
    s_and_b32 s45, s45, 1
    s_lshl_b32 s45, s45, 1
FB_np:
    s_lshr_b32 s53, s28, 3
    s_lshl_b32 s53, s53, 2
    s_and_b32 s54, s28, 3
    s_add_u32 s53, s53, s54
    s_lshl_b32 s53, s53, 23
    s_lshr_b32 s54, s28, 2
    s_xor_b32 s54, s54, s94
    s_and_b32 s54, s54, 1
    s_lshl_b32 s54, s54, 13
    s_add_u32 s37, s53, s54
    s_add_u32 s37, s37, 33554432
    s_andn2_b32 s37, s37, 0x2000
    s_lshl_b32 s43, s29, 7
    s_add_u32 s37, s37, s43
    s_add_u32 s37, s37, 1835008
    s_add_u32 s43, s43, 23068672
    v_mov_b32 v102, s52
    v_and_b32 v103, 1, v1
    v_lshlrev_b32 v103, 13, v103
    v_bfe_u32 v104, v1, 1, 1
    v_lshl_add_u32 v103, v104, 26, v103
    v_lshrrev_b32 v104, 2, v1
    v_lshl_add_u32 v103, v104, 11, v103
    s_waitcnt vmcnt(0) lgkmcnt(0)
    s_barrier
    ds_read_b64_tr_b16 v[132:133], v75 offset:24576
    ds_read_b64_tr_b16 v[134:135], v75 offset:26624
    ds_read_b64_tr_b16 v[140:141], v75 offset:28672
    ds_read_b64_tr_b16 v[142:143], v75 offset:30720
    ds_read_b64_tr_b16 v[148:149], v75 offset:32768
    ds_read_b64_tr_b16 v[150:151], v75 offset:34816
    ds_read_b64_tr_b16 v[156:157], v75 offset:36864
    ds_read_b64_tr_b16 v[158:159], v75 offset:38912
    ds_read_b64_tr_b16 v[164:165], v75 offset:40960
    ds_read_b64_tr_b16 v[166:167], v75 offset:43008
    ds_read_b64_tr_b16 v[172:173], v75 offset:45056
    ds_read_b64_tr_b16 v[174:175], v75 offset:47104
    ds_read_b64_tr_b16 v[180:181], v75 offset:49152
    ds_read_b64_tr_b16 v[182:183], v75 offset:51200
    ds_read_b64_tr_b16 v[188:189], v75 offset:53248
    ds_read_b64_tr_b16 v[190:191], v75 offset:55296
    ds_read_b64_tr_b16 v[196:197], v75 offset:57344
    ds_read_b64_tr_b16 v[198:199], v75 offset:59392
    ds_read_b64_tr_b16 v[204:205], v75 offset:61440
    ds_read_b64_tr_b16 v[206:207], v75 offset:63488
    ds_read_b64_tr_b16 v[212:213], v76 offset:0
    ds_read_b64_tr_b16 v[214:215], v76 offset:2048
    ds_read_b64_tr_b16 v[220:221], v76 offset:4096
    ds_read_b64_tr_b16 v[222:223], v76 offset:6144
    ds_read_b64_tr_b16 v[228:229], v76 offset:8192
    ds_read_b64_tr_b16 v[230:231], v76 offset:10240
    ds_read_b64_tr_b16 v[236:237], v76 offset:12288
    ds_read_b64_tr_b16 v[238:239], v76 offset:14336
    ds_read_b64_tr_b16 v[244:245], v76 offset:16384
    ds_read_b64_tr_b16 v[246:247], v76 offset:18432
    ds_read_b64_tr_b16 v[252:253], v76 offset:20480
    ds_read_b64_tr_b16 v[254:255], v76 offset:22528
    s_waitcnt lgkmcnt(0)
    s_barrier
    s_cmp_lg_u32 s30, 5
    s_cbranch_scc1 FB_na
    s_lshl_b32 s36, s2, 7
    s_add_u32 s36, s36, 23592960
    s_add_u32 s45, s45, s52
    v_mov_b32 v8, s45
    s_mov_b64 exec, 1
    buffer_store_dword v8, v2, s[56:59], s36 offen sc1
    s_mov_b64 exec, -1
FB_na:
    buffer_load_dwordx4 v[12:15], v2, s[80:83], s50 offen
    s_sub_u32 s50, s50, 4096
    buffer_load_dwordx4 v[12:15], v2, s[80:83], s50 offen
    s_sub_u32 s50, s50, 4096
    buffer_load_dwordx2 v[86:87], v80, s[8:11], 0 offen offset:0 nt
    buffer_load_dwordx2 v[88:89], v80, s[8:11], 0 offen offset:32 nt
    buffer_load_dwordx2 v[90:91], v80, s[8:11], 0 offen offset:128 nt
    buffer_load_dwordx2 v[92:93], v80, s[8:11], 0 offen offset:160 nt
    s_setprio 0
    s_cmp_lg_u32 s30, 4
    s_cbranch_scc1 FB_ni
    s_mov_b64 exec, 0xfff
    buffer_store_dword v102, v103, s[56:59], s37 offen sc1
    s_cmp_lg_u32 s28, 0
    s_cbranch_scc1 FB_n2
    s_mov_b64 exec, 3
    buffer_store_dword v102, v103, s[56:59], s43 offen sc1
FB_n2:
    s_mov_b64 exec, -1
FB_ni:
    buffer_store_dwordx4 v[110:113], v2, s[56:59], s44 offen offset:0 sc1
    buffer_store_dwordx4 v[110:113], v2, s[56:59], s44 offen offset:1024 sc1
    buffer_store_dwordx4 v[110:113], v2, s[56:59], s44 offen offset:2048 sc1
    buffer_store_dwordx4 v[110:113], v2, s[56:59], s44 offen offset:3072 sc1
    s_add_u32 s36, s67, 0
    s_and_b32 s36, s36, 7
    s_lshl_b32 s36, s36, 17
    s_add_u32 s36, s36, s48
    buffer_load_dwordx4 v[128:131], v118, s[88:91], s36 offen
    s_add_u32 s36, s36, 65536
    buffer_load_dwordx4 v[136:139], v118, s[88:91], s36 offen
    s_add_u32 s36, s67, 1
    s_and_b32 s36, s36, 7
    s_lshl_b32 s36, s36, 17
    s_add_u32 s36, s36, s48
    buffer_load_dwordx4 v[144:147], v118, s[88:91], s36 offen
    s_add_u32 s36, s36, 65536
    buffer_load_dwordx4 v[152:155], v118, s[88:91], s36 offen
    s_and_b32 s49, s30, 3
    s_lshl_b32 s36, s49, 14
    s_lshl_b32 s48, s29, 7
    s_add_u32 s48, s48, s36
    s_lshl_b32 s49, s49, 10
    s_xor_b32 s48, s48, 128
    s_add_u32 s36, s67, 3
    s_and_b32 s36, s36, 7
    s_lshl_b32 s36, s36, 17
    s_add_u32 s36, s36, s48
    s_add_u32 s36, s36, 1048576
    s_add_u32 m0, s49, 114688
    s_nop 0
    buffer_load_dwordx4 v118, s[80:83], s36 offen lds
    s_add_u32 s36, s36, 65536
    s_add_u32 m0, s49, 118784
    s_nop 0
    buffer_load_dwordx4 v118, s[80:83], s36 offen lds
    s_add_u32 s36, s67, 4
    s_and_b32 s36, s36, 7
    s_lshl_b32 s36, s36, 17
    s_add_u32 s36, s36, s48
    s_add_u32 s36, s36, 1048576
    s_add_u32 m0, s49, 122880
    s_nop 0
    buffer_load_dwordx4 v118, s[80:83], s36 offen lds
    s_add_u32 s36, s36, 65536
    s_add_u32 m0, s49, 126976
    s_nop 0
    buffer_load_dwordx4 v118, s[80:83], s36 offen lds
    s_add_u32 s36, s67, 7
    s_and_b32 s36, s36, 7
    s_lshl_b32 s36, s36, 17
    s_add_u32 s36, s36, s48
    s_add_u32 s36, s36, 1048576
    s_add_u32 m0, s49, 147456
    s_nop 0
    buffer_load_dwordx4 v118, s[80:83], s36 offen lds
    s_add_u32 s36, s36, 65536
    s_add_u32 m0, s49, 151552
    s_nop 0
    buffer_load_dwordx4 v118, s[80:83], s36 offen lds
    s_add_u32 s36, s67, 5
    s_and_b32 s36, s36, 7
    s_lshl_b32 s36, s36, 17
    s_add_u32 s36, s36, s48
    s_add_u32 s36, s36, 1048576
    s_add_u32 m0, s49, 131072
    s_nop 0
    buffer_load_dwordx4 v118, s[80:83], s36 offen lds
    s_add_u32 s36, s36, 65536
    s_add_u32 m0, s49, 135168
    s_nop 0
    buffer_load_dwordx4 v118, s[80:83], s36 offen lds
    s_add_u32 s36, s67, 6
    s_and_b32 s36, s36, 7
    s_lshl_b32 s36, s36, 17
    s_add_u32 s36, s36, s48
    s_add_u32 s36, s36, 1048576
    s_add_u32 m0, s49, 139264
    s_nop 0
    buffer_load_dwordx4 v118, s[80:83], s36 offen lds
    s_add_u32 s36, s36, 65536
    s_add_u32 m0, s49, 143360
    s_nop 0
    buffer_load_dwordx4 v118, s[80:83], s36 offen lds
    s_waitcnt vmcnt(14)
    v_mov_b32 v6, 162824
    v_mov_b32 v7, 1
    s_waitcnt lgkmcnt(0)
    s_mov_b64 exec, 1
    ds_add_u32 v6, v7
    s_mov_b64 exec, -1
    s_add_u32 s36, s67, 3
    s_and_b32 s36, s36, 7
    s_lshl_b32 s36, s36, 17
    s_add_u32 s36, s36, s48
    buffer_load_dwordx4 v[28:31], v118, s[80:83], s36 offen
    s_add_u32 s36, s36, 65536
    buffer_load_dwordx4 v[32:35], v118, s[80:83], s36 offen
    s_add_u32 s36, s67, 4
    s_and_b32 s36, s36, 7
    s_lshl_b32 s36, s36, 17
    s_add_u32 s36, s36, s48
    buffer_load_dwordx4 v[36:39], v118, s[80:83], s36 offen
    s_add_u32 s36, s36, 65536
    buffer_load_dwordx4 v[40:43], v118, s[80:83], s36 offen
    s_add_u32 s36, s67, 5
    s_and_b32 s36, s36, 7
    s_lshl_b32 s36, s36, 17
    s_add_u32 s36, s36, s48
    buffer_load_dwordx4 v[52:55], v118, s[80:83], s36 offen
    s_add_u32 s36, s36, 65536
    buffer_load_dwordx4 v[56:59], v118, s[80:83], s36 offen
    s_add_u32 s36, s67, 6
    s_and_b32 s36, s36, 7
    s_lshl_b32 s36, s36, 17
    s_add_u32 s36, s36, s48
    buffer_load_dwordx4 v[60:63], v118, s[80:83], s36 offen
    s_add_u32 s36, s36, 65536
    buffer_load_dwordx4 v[64:67], v118, s[80:83], s36 offen
    s_add_u32 s36, s67, 0
    s_and_b32 s36, s36, 7
    s_lshl_b32 s36, s36, 17
    s_add_u32 s36, s36, s48
    buffer_load_dwordx4 v[94:97], v118, s[80:83], s36 offen
    s_add_u32 s36, s36, 65536
    buffer_load_dwordx4 v[98:101], v118, s[80:83], s36 offen
    s_xor_b32 s48, s48, 128
    s_add_u32 s36, s67, 2
    s_and_b32 s36, s36, 7
    s_lshl_b32 s36, s36, 17
    s_add_u32 s36, s36, s48
    buffer_load_dwordx4 v[160:163], v118, s[88:91], s36 offen
    s_add_u32 s36, s36, 65536
    buffer_load_dwordx4 v[168:171], v118, s[88:91], s36 offen
    s_add_u32 s36, s67, 3
    s_and_b32 s36, s36, 7
    s_lshl_b32 s36, s36, 17
    s_add_u32 s36, s36, s48
    buffer_load_dwordx4 v[176:179], v118, s[88:91], s36 offen
    s_add_u32 s36, s36, 65536
    buffer_load_dwordx4 v[184:187], v118, s[88:91], s36 offen
    s_add_u32 s36, s67, 4
    s_and_b32 s36, s36, 7
    s_lshl_b32 s36, s36, 17
    s_add_u32 s36, s36, s48
    buffer_load_dwordx4 v[192:195], v118, s[88:91], s36 offen
    s_add_u32 s36, s36, 65536
    buffer_load_dwordx4 v[200:203], v118, s[88:91], s36 offen
    s_and_b32 s42, s30, 3
    s_lshl_b32 s42, s42, 13
    s_add_u32 s42, s42, 23592960
    v_lshlrev_b32 v8, 7, v1
    buffer_load_dword v10, v8, s[56:59], s42 offen sc1
    s_add_u32 s36, s67, 5
    s_and_b32 s36, s36, 7
    s_lshl_b32 s36, s36, 17
    s_add_u32 s36, s36, s48
    buffer_load_dwordx4 v[208:211], v118, s[88:91], s36 offen
    s_add_u32 s36, s36, 65536
    buffer_load_dwordx4 v[216:219], v118, s[88:91], s36 offen
    s_add_u32 s36, s67, 6
    s_and_b32 s36, s36, 7
    s_lshl_b32 s36, s36, 17
    s_add_u32 s36, s36, s48
    buffer_load_dwordx4 v[224:227], v118, s[88:91], s36 offen
    s_add_u32 s36, s36, 65536
    buffer_load_dwordx4 v[232:235], v118, s[88:91], s36 offen
    s_add_u32 s36, s67, 7
    s_and_b32 s36, s36, 7
    s_lshl_b32 s36, s36, 17
    s_add_u32 s36, s36, s48
    buffer_load_dwordx4 v[240:243], v118, s[88:91], s36 offen
    s_add_u32 s36, s36, 65536
    buffer_load_dwordx4 v[248:251], v118, s[88:91], s36 offen
    s_setprio 0
    s_mov_b32 s53, 0
    s_waitcnt vmcnt(6)
R_fp:
    v_and_b32 v11, -3, v10
    v_cmp_eq_u32 vcc, s52, v11
    s_nop 0
    s_cmp_eq_u64 vcc, exec
    s_cbranch_scc1 R_fq
    s_sleep 3
    buffer_load_dword v10, v8, s[56:59], s42 offen sc1
    s_waitcnt vmcnt(0)
    s_add_u32 s53, s53, 1
    s_cmp_lt_u32 s53, s61
    s_cbranch_scc1 R_fp
    s_mov_b32 s61, 0
R_fq:
    v_cmp_ne_u32 vcc, s52, v10
    s_nop 0
    s_bcnt1_i32_b64 s36, vcc
    v_mov_b32 v10, s36
    v_mov_b32 v11, 162844
    s_mov_b64 exec, 1
    ds_add_u32 v11, v10
    s_mov_b64 exec, -1
FR_end:
    v_and_b32 v81, 7, v0
    v_lshlrev_b32 v72, 6, v81
    v_add_u32 v72, 161792, v72
    s_lshl_b32 s35, s30, 3
    v_add_u32 v71, s35, v72
    v_lshlrev_b32 v12, 16, v86
    v_and_b32 v13, 0xffff0000, v86
    v_lshlrev_b32 v14, 16, v87
    v_and_b32 v15, 0xffff0000, v87
    v_lshlrev_b32 v16, 16, v88
    v_and_b32 v17, 0xffff0000, v88
    v_lshlrev_b32 v18, 16, v89
    v_and_b32 v19, 0xffff0000, v89
    v_lshlrev_b32 v20, 16, v90
    v_and_b32 v21, 0xffff0000, v90
    v_lshlrev_b32 v22, 16, v91
    v_and_b32 v23, 0xffff0000, v91
    v_lshlrev_b32 v24, 16, v92
    v_and_b32 v25, 0xffff0000, v92
    v_lshlrev_b32 v26, 16, v93
    v_and_b32 v27, 0xffff0000, v93
    v_pk_add_f32 v[48:49], v[12:13], v[14:15]
    v_pk_mul_f32 v[50:51], v[12:13], v[12:13]
    v_pk_fma_f32 v[50:51], v[14:15], v[14:15], v[50:51]
    v_pk_add_f32 v[48:49], v[48:49], v[16:17]
    v_pk_fma_f32 v[50:51], v[16:17], v[16:17], v[50:51]
    v_pk_add_f32 v[48:49], v[48:49], v[18:19]
    v_pk_fma_f32 v[50:51], v[18:19], v[18:19], v[50:51]
    v_pk_add_f32 v[48:49], v[48:49], v[20:21]
    v_pk_fma_f32 v[50:51], v[20:21], v[20:21], v[50:51]
    v_pk_add_f32 v[48:49], v[48:49], v[22:23]
    v_pk_fma_f32 v[50:51], v[22:23], v[22:23], v[50:51]
    v_pk_add_f32 v[48:49], v[48:49], v[24:25]
    v_pk_fma_f32 v[50:51], v[24:25], v[24:25], v[50:51]
    v_pk_add_f32 v[48:49], v[48:49], v[26:27]
    v_pk_fma_f32 v[50:51], v[26:27], v[26:27], v[50:51]
    v_add_f32 v46, v48, v49
    v_add_f32 v47, v50, v51
    s_nop 0
    v_add_f32_dpp v46, v46, v46 row_ror:8 row_mask:0xf bank_mask:0xf
    v_add_f32_dpp v47, v47, v47 row_ror:8 row_mask:0xf bank_mask:0xf
    v_mov_b32 v48, v46
    v_mov_b32 v49, v47
    s_nop 0
    v_permlane16_swap_b32 v46, v48
    v_permlane16_swap_b32 v47, v49
    v_pk_add_f32 v[46:47], v[46:47], v[48:49]
    v_mov_b32 v48, v46
    v_mov_b32 v49, v47
    s_nop 0
    v_permlane32_swap_b32 v46, v48
    v_permlane32_swap_b32 v47, v49
    v_pk_add_f32 v[46:47], v[46:47], v[48:49]
    ds_write_b64 v71, v[46:47] offset:0
    s_waitcnt lgkmcnt(0)
    s_barrier
LAYER:
    v_and_b32 v81, 7, v0
    v_lshlrev_b32 v72, 6, v81
    v_add_u32 v72, 161792, v72
    s_lshl_b32 s35, s30, 3
    v_add_u32 v71, s35, v72
    v_lshrrev_b32 v6, 2, v1
    v_lshlrev_b32 v74, 7, v6
    v_bfe_u32 v6, v6, 1, 2
    s_and_b32 s35, s30, 2
    v_and_b32 v7, 1, v1
    v_or_b32 v7, s35, v7
    v_xor_b32 v6, v6, v7
    v_lshl_add_u32 v74, v6, 5, v74
    v_and_b32 v6, 2, v1
    v_lshl_add_u32 v74, v6, 2, v74
    s_and_b32 s35, s30, 1
    s_lshl_b32 s35, s35, 4
    v_add_u32 v74, s35, v74
    v_add_u32 v75, 65536, v74
    v_add_u32 v76, 131072, v74
    s_cmp_eq_u32 s60, 0
    s_cbranch_scc1 R_l0
    s_lshr_b32 s37, s28, 3
    s_and_b32 s36, s28, 3
    s_lshl2_add_u32 s36, s37, s36
    s_lshl_b32 s36, s36, 19
    s_xor_b32 s37, s37, s94
    s_lshl_b32 s37, s37, 2
    s_xor_b32 s37, s37, s28
    s_and_b32 s37, s37, 4
    s_lshl_b32 s37, s37, 11
    s_add_u32 s36, s36, s37
    s_add_u32 s36, s36, 29360128
    s_add_u32 s12, s4, s36
    s_addc_u32 s13, s5, 0
    s_mov_b32 s14, 516096
    s_mov_b32 s15, 0x20000
    buffer_load_dwordx4 v[86:89], v78, s[12:15], 0 offen offset:0 sc1
    buffer_load_dwordx4 v[90:93], v78, s[12:15], 0 offen offset:2048 sc1
    s_waitcnt vmcnt(2)
    v_lshlrev_b32 v102, 16, v110
    v_and_b32 v103, 0xffff0000, v110
    v_lshlrev_b32 v104, 16, v111
    v_and_b32 v105, 0xffff0000, v111
    v_lshlrev_b32 v106, 16, v112
    v_and_b32 v107, 0xffff0000, v112
    v_lshlrev_b32 v108, 16, v113
    v_and_b32 v109, 0xffff0000, v113
    v_lshlrev_b32 v110, 16, v114
    v_and_b32 v111, 0xffff0000, v114
    v_lshlrev_b32 v112, 16, v115
    v_and_b32 v113, 0xffff0000, v115
    v_lshlrev_b32 v114, 16, v116
    v_and_b32 v115, 0xffff0000, v116
    v_lshlrev_b32 v116, 16, v117
    v_and_b32 v117, 0xffff0000, v117
    s_mov_b32 s53, 0
dw_4:
    s_waitcnt vmcnt(0)
    v_and_b32 v6, v86, v87
    v_and_b32 v7, v90, v91
    v_bitop3_b32 v6, v88, v89, v6 bitop3:0x80
    v_bitop3_b32 v7, v92, v93, v7 bitop3:0x80
    v_bitop3_b32 v6, v6, v7, 1 bitop3:0x80
    v_cmp_eq_u32 vcc, 0, v6
    s_nop 0
    s_cmp_eq_u64 vcc, 0
    s_cbranch_scc1 dok_5
    s_mov_b64 exec, vcc
    s_sleep 2
    buffer_load_dwordx4 v[86:89], v78, s[12:15], 0 offen offset:0 sc1
    buffer_load_dwordx4 v[90:93], v78, s[12:15], 0 offen offset:2048 sc1
    s_add_u32 s53, s53, 1
    s_cmp_lt_u32 s53, s61
    s_cbranch_scc1 dw_4
    s_mov_b32 s61, 0
    s_waitcnt vmcnt(0)
dok_5:
    s_mov_b64 exec, -1
    v_lshlrev_b32 v12, 16, v86
    v_and_b32 v13, 0xffff0000, v86
    v_lshlrev_b32 v14, 16, v87
    v_and_b32 v15, 0xffff0000, v87
    v_lshlrev_b32 v16, 16, v88
    v_and_b32 v17, 0xffff0000, v88
    v_lshlrev_b32 v18, 16, v89
    v_and_b32 v19, 0xffff0000, v89
    v_lshlrev_b32 v20, 16, v90
    v_and_b32 v21, 0xffff0000, v90
    v_lshlrev_b32 v22, 16, v91
    v_and_b32 v23, 0xffff0000, v91
    v_lshlrev_b32 v24, 16, v92
    v_and_b32 v25, 0xffff0000, v92
    v_lshlrev_b32 v26, 16, v93
    v_and_b32 v27, 0xffff0000, v93
    v_pk_add_f32 v[48:49], v[12:13], v[14:15]
    v_pk_mul_f32 v[50:51], v[12:13], v[12:13]
    v_pk_fma_f32 v[50:51], v[14:15], v[14:15], v[50:51]
    v_pk_add_f32 v[48:49], v[48:49], v[16:17]
    v_pk_fma_f32 v[50:51], v[16:17], v[16:17], v[50:51]
    v_pk_add_f32 v[48:49], v[48:49], v[18:19]
    v_pk_fma_f32 v[50:51], v[18:19], v[18:19], v[50:51]
    v_pk_add_f32 v[48:49], v[48:49], v[20:21]
    v_pk_fma_f32 v[50:51], v[20:21], v[20:21], v[50:51]
    v_pk_add_f32 v[48:49], v[48:49], v[22:23]
    v_pk_fma_f32 v[50:51], v[22:23], v[22:23], v[50:51]
    v_pk_add_f32 v[48:49], v[48:49], v[24:25]
    v_pk_fma_f32 v[50:51], v[24:25], v[24:25], v[50:51]
    v_pk_add_f32 v[48:49], v[48:49], v[26:27]
    v_pk_fma_f32 v[50:51], v[26:27], v[26:27], v[50:51]
    v_add_f32 v46, v48, v49
    v_add_f32 v47, v50, v51
    s_nop 0
    v_add_f32_dpp v46, v46, v46 row_ror:8 row_mask:0xf bank_mask:0xf
    v_add_f32_dpp v47, v47, v47 row_ror:8 row_mask:0xf bank_mask:0xf
    v_mov_b32 v48, v46
    v_mov_b32 v49, v47
    s_nop 0
    v_permlane16_swap_b32 v46, v48
    v_permlane16_swap_b32 v47, v49
    v_pk_add_f32 v[46:47], v[46:47], v[48:49]
    v_mov_b32 v48, v46
    v_mov_b32 v49, v47
    s_nop 0
    v_permlane32_swap_b32 v46, v48
    v_permlane32_swap_b32 v47, v49
    v_pk_add_f32 v[46:47], v[46:47], v[48:49]
    ds_write_b64 v71, v[46:47] offset:0
    s_lshl_b32 s22, s60, 24
    s_lshl_b32 s23, s94, 13
    s_add_u32 s22, s22, s23
    s_add_u32 s22, s22, 167772160
    s_add_u32 s20, s4, s22
    s_addc_u32 s21, s5, 0
    s_mov_b32 s22, 8380416
    s_mov_b32 s23, 0x20000
    s_waitcnt lgkmcnt(0)
    s_barrier
    ds_read_b128 v[52:55], v72 offset:0
    ds_read_b128 v[56:59], v72 offset:16
    ds_read_b128 v[60:63], v72 offset:32
    ds_read_b128 v[64:67], v72 offset:48
    s_waitcnt lgkmcnt(0)
    v_pk_add_f32 v[52:53], v[52:53], v[54:55]
    v_pk_add_f32 v[56:57], v[56:57], v[58:59]
    v_pk_add_f32 v[60:61], v[60:61], v[62:63]
    v_pk_add_f32 v[64:65], v[64:65], v[66:67]
    v_pk_add_f32 v[52:53], v[52:53], v[56:57]
    v_pk_add_f32 v[60:61], v[60:61], v[64:65]
    v_pk_add_f32 v[52:53], v[52:53], v[60:61]
    v_mul_f32 v68, 0x3a800000, v52
    v_mul_f32 v70, 0x3a800000, v53
    v_fma_f32 v70, -v68, v68, v70
    v_max_f32 v70, 0, v70
    v_cvt_pk_bf16_f32 v68, v68, v68
    v_lshlrev_b32 v68, 16, v68
    v_cvt_pk_bf16_f32 v70, v70, v70
    v_lshlrev_b32 v70, 16, v70
    v_add_f32 v70, 0x3727c5ac, v70
    v_cvt_pk_bf16_f32 v70, v70, v70
    v_lshlrev_b32 v70, 16, v70
    v_sqrt_f32 v70, v70
    s_nop 0
    v_cvt_pk_bf16_f32 v70, v70, v70
    v_lshlrev_b32 v70, 16, v70
    v_rcp_f32 v69, v70
    s_nop 0
    v_mul_f32 v68, -v68, v69
    v_pk_fma_f32 v[28:29], v[12:13], v[68:69], v[68:69] op_sel:[0,1,0] op_sel_hi:[1,1,0]
    v_pk_fma_f32 v[30:31], v[14:15], v[68:69], v[68:69] op_sel:[0,1,0] op_sel_hi:[1,1,0]
    v_pk_fma_f32 v[32:33], v[16:17], v[68:69], v[68:69] op_sel:[0,1,0] op_sel_hi:[1,1,0]
    v_pk_fma_f32 v[34:35], v[18:19], v[68:69], v[68:69] op_sel:[0,1,0] op_sel_hi:[1,1,0]
    v_pk_fma_f32 v[36:37], v[20:21], v[68:69], v[68:69] op_sel:[0,1,0] op_sel_hi:[1,1,0]
    v_pk_fma_f32 v[38:39], v[22:23], v[68:69], v[68:69] op_sel:[0,1,0] op_sel_hi:[1,1,0]
    v_pk_fma_f32 v[40:41], v[24:25], v[68:69], v[68:69] op_sel:[0,1,0] op_sel_hi:[1,1,0]
    v_pk_fma_f32 v[42:43], v[26:27], v[68:69], v[68:69] op_sel:[0,1,0] op_sel_hi:[1,1,0]
    s_branch R_s2
R_l0:
    s_cmp_lt_u32 s30, 4
    s_cbranch_scc1 R_f2
    s_and_b32 s36, s30, 3
    s_lshl_b32 s36, s36, 10
    v_add_u32 v8, s36, v2
    v_add_u32 v9, 65536, v8
    ds_write_b128 v8, v[28:31] offset:49152
    ds_write_b128 v8, v[32:35] offset:53248
    ds_write_b128 v8, v[36:39] offset:57344
    ds_write_b128 v8, v[40:43] offset:61440
    ds_write_b128 v9, v[52:55] offset:0
    ds_write_b128 v9, v[56:59] offset:4096
    ds_write_b128 v9, v[60:63] offset:8192
    ds_write_b128 v9, v[64:67] offset:12288
    ds_write_b128 v8, v[94:97] offset:24576
    ds_write_b128 v8, v[98:101] offset:28672
R_f2:
    v_mov_b32 v6, 162844
    ds_read_b32 v7, v6
    ds_read_b128 v[52:55], v72 offset:0
    ds_read_b128 v[56:59], v72 offset:16
    ds_read_b128 v[60:63], v72 offset:32
    ds_read_b128 v[64:67], v72 offset:48
    s_waitcnt lgkmcnt(0)
    v_pk_add_f32 v[52:53], v[52:53], v[54:55]
    v_pk_add_f32 v[56:57], v[56:57], v[58:59]
    v_pk_add_f32 v[60:61], v[60:61], v[62:63]
    v_pk_add_f32 v[64:65], v[64:65], v[66:67]
    v_pk_add_f32 v[52:53], v[52:53], v[56:57]
    v_pk_add_f32 v[60:61], v[60:61], v[64:65]
    v_pk_add_f32 v[52:53], v[52:53], v[60:61]
    v_mul_f32 v68, 0x3a800000, v52
    v_mul_f32 v70, 0x3a800000, v53
    v_fma_f32 v70, -v68, v68, v70
    v_max_f32 v70, 0, v70
    v_cvt_pk_bf16_f32 v68, v68, v68
    v_lshlrev_b32 v68, 16, v68
    v_cvt_pk_bf16_f32 v70, v70, v70
    v_lshlrev_b32 v70, 16, v70
    v_add_f32 v70, 0x3727c5ac, v70
    v_cvt_pk_bf16_f32 v70, v70, v70
    v_lshlrev_b32 v70, 16, v70
    v_sqrt_f32 v70, v70
    s_nop 0
    v_cvt_pk_bf16_f32 v70, v70, v70
    v_lshlrev_b32 v70, 16, v70
    v_rcp_f32 v69, v70
    s_nop 0
    v_mul_f32 v68, -v68, v69
    v_pk_fma_f32 v[28:29], v[12:13], v[68:69], v[68:69] op_sel:[0,1,0] op_sel_hi:[1,1,0]
    v_pk_fma_f32 v[30:31], v[14:15], v[68:69], v[68:69] op_sel:[0,1,0] op_sel_hi:[1,1,0]
    v_pk_fma_f32 v[32:33], v[16:17], v[68:69], v[68:69] op_sel:[0,1,0] op_sel_hi:[1,1,0]
    v_pk_fma_f32 v[34:35], v[18:19], v[68:69], v[68:69] op_sel:[0,1,0] op_sel_hi:[1,1,0]
    v_pk_fma_f32 v[36:37], v[20:21], v[68:69], v[68:69] op_sel:[0,1,0] op_sel_hi:[1,1,0]
    v_pk_fma_f32 v[38:39], v[22:23], v[68:69], v[68:69] op_sel:[0,1,0] op_sel_hi:[1,1,0]
    v_pk_fma_f32 v[40:41], v[24:25], v[68:69], v[68:69] op_sel:[0,1,0] op_sel_hi:[1,1,0]
    v_pk_fma_f32 v[42:43], v[26:27], v[68:69], v[68:69] op_sel:[0,1,0] op_sel_hi:[1,1,0]
    v_readfirstlane_b32 s94, v7
    s_nop 0
    s_cmp_gt_u32 s94, 127
    s_cselect_b32 s94, 1, 0
    s_lshr_b32 s53, s28, 3
    s_lshl_b32 s53, s53, 2
    s_and_b32 s54, s28, 3
    s_add_u32 s53, s53, s54
    s_lshl_b32 s53, s53, 23
    s_lshr_b32 s54, s28, 2
    s_xor_b32 s54, s54, s94
    s_and_b32 s54, s54, 1
    s_lshl_b32 s54, s54, 13
    s_add_u32 s55, s53, s54
    s_add_u32 s55, s55, 33554432
    s_add_u32 s62, s4, s55
    s_addc_u32 s63, s5, 0
    s_sub_u32 s36, s28, 1
    s_max_i32 s36, s36, 0
    s_lshr_b32 s53, s36, 3
    s_lshl_b32 s53, s53, 2
    s_and_b32 s54, s36, 3
    s_add_u32 s53, s53, s54
    s_lshl_b32 s53, s53, 23
    s_lshr_b32 s54, s36, 2
    s_xor_b32 s54, s54, s94
    s_and_b32 s54, s54, 1
    s_lshl_b32 s54, s54, 13
    s_add_u32 s92, s53, s54
    s_add_u32 s92, s92, 33554432
    s_sub_u32 s92, s92, s55
    s_add_u32 s36, s28, 1
    s_min_u32 s36, s36, 15
    s_lshr_b32 s53, s36, 3
    s_lshl_b32 s53, s53, 2
    s_and_b32 s54, s36, 3
    s_add_u32 s53, s53, s54
    s_lshl_b32 s53, s53, 23
    s_lshr_b32 s54, s36, 2
    s_xor_b32 s54, s54, s94
    s_and_b32 s54, s54, 1
    s_lshl_b32 s54, s54, 13
    s_add_u32 s93, s53, s54
    s_add_u32 s93, s93, 33554432
    s_sub_u32 s93, s93, s55
    s_add_u32 s55, s55, 1835008
    s_lshl_b32 s22, s60, 24
    s_lshl_b32 s23, s94, 13
    s_add_u32 s22, s22, s23
    s_add_u32 s22, s22, 167772160
    s_add_u32 s20, s4, s22
    s_addc_u32 s21, s5, 0
    s_mov_b32 s22, 8380416
    s_mov_b32 s23, 0x20000
    s_add_u32 s80, s4, 0x1800000
    s_addc_u32 s81, s5, 0
    s_mov_b32 s82, 0x400000
    s_mov_b32 s83, 0x20000
    s_mov_b32 s78, 0
    buffer_load_dwordx2 v[110:111], v79, s[80:83], s78 offen sc1
    s_mov_b32 s78, 65536
    buffer_load_dwordx2 v[112:113], v79, s[80:83], s78 offen sc1
    s_mov_b32 s78, 262144
    buffer_load_dwordx2 v[114:115], v79, s[80:83], s78 offen sc1
    s_mov_b32 s78, 327680
    buffer_load_dwordx2 v[116:117], v79, s[80:83], s78 offen sc1
    s_cmp_lt_u32 s30, 4
    s_cbranch_scc1 R_f3
    s_waitcnt vmcnt(4)
    s_and_b32 s36, s30, 3
    s_lshl_b32 s36, s36, 10
    v_add_u32 v8, s36, v2
    v_add_u32 v9, 65536, v8
    ds_write_b128 v8, v[128:131] offset:0
    ds_write_b128 v8, v[136:139] offset:4096
    ds_write_b128 v8, v[144:147] offset:8192
    ds_write_b128 v8, v[152:155] offset:12288
    ds_write_b128 v8, v[160:163] offset:16384
    ds_write_b128 v8, v[168:171] offset:20480
    ds_write_b128 v9, v[176:179] offset:16384
    ds_write_b128 v9, v[184:187] offset:20480
    ds_write_b128 v9, v[192:195] offset:24576
    ds_write_b128 v9, v[200:203] offset:28672
    ds_write_b128 v8, v[208:211] offset:32768
    ds_write_b128 v8, v[216:219] offset:36864
    ds_write_b128 v8, v[224:227] offset:40960
    ds_write_b128 v8, v[232:235] offset:45056
    ds_write_b128 v9, v[240:243] offset:32768
    ds_write_b128 v9, v[248:251] offset:36864
R_f3:
    s_mov_b32 s53, 0
dw_6:
    s_waitcnt vmcnt(0)
    v_and_b32 v6, v110, v111
    v_and_b32 v7, v114, v115
    v_bitop3_b32 v6, v112, v113, v6 bitop3:0x80
    v_bitop3_b32 v7, v116, v117, v7 bitop3:0x80
    v_bitop3_b32 v6, v6, v7, 1 bitop3:0x80
    v_cmp_eq_u32 vcc, 0, v6
    s_nop 0
    s_cmp_eq_u64 vcc, 0
    s_cbranch_scc1 dok_7
    s_mov_b64 exec, vcc
    s_sleep 4
    s_mov_b32 s78, 0
    buffer_load_dwordx2 v[110:111], v79, s[80:83], s78 offen sc1
    s_mov_b32 s78, 65536
    buffer_load_dwordx2 v[112:113], v79, s[80:83], s78 offen sc1
    s_mov_b32 s78, 262144
    buffer_load_dwordx2 v[114:115], v79, s[80:83], s78 offen sc1
    s_mov_b32 s78, 327680
    buffer_load_dwordx2 v[116:117], v79, s[80:83], s78 offen sc1
    s_add_u32 s53, s53, 1
    s_cmp_lt_u32 s53, s61
    s_cbranch_scc1 dw_6
    s_mov_b32 s61, 0
    s_waitcnt vmcnt(0)
dok_7:
    s_mov_b64 exec, -1
    v_lshlrev_b32 v102, 16, v110
    v_and_b32 v103, 0xffff0000, v110
    v_lshlrev_b32 v104, 16, v111
    v_and_b32 v105, 0xffff0000, v111
    v_lshlrev_b32 v106, 16, v112
    v_and_b32 v107, 0xffff0000, v112
    v_lshlrev_b32 v108, 16, v113
    v_and_b32 v109, 0xffff0000, v113
    v_lshlrev_b32 v110, 16, v114
    v_and_b32 v111, 0xffff0000, v114
    v_lshlrev_b32 v112, 16, v115
    v_and_b32 v113, 0xffff0000, v115
    v_lshlrev_b32 v114, 16, v116
    v_and_b32 v115, 0xffff0000, v116
    v_lshlrev_b32 v116, 16, v117
    v_and_b32 v117, 0xffff0000, v117
R_s2:
    v_pk_fma_f32 v[12:13], v[28:29], v[102:103], v[12:13]
    v_pk_fma_f32 v[14:15], v[30:31], v[104:105], v[14:15]
    v_pk_fma_f32 v[16:17], v[32:33], v[106:107], v[16:17]
    v_pk_fma_f32 v[18:19], v[34:35], v[108:109], v[18:19]
    v_cvt_pk_bf16_f32 v86, v12, v13
    v_cvt_pk_bf16_f32 v87, v14, v15
    v_cvt_pk_bf16_f32 v88, v16, v17
    v_cvt_pk_bf16_f32 v89, v18, v19
    buffer_store_dwordx4 v[86:89], v82, s[20:23], 0 offen offset:0 sc1
    v_pk_fma_f32 v[20:21], v[36:37], v[110:111], v[20:21]
    v_pk_fma_f32 v[22:23], v[38:39], v[112:113], v[22:23]
    v_pk_fma_f32 v[24:25], v[40:41], v[114:115], v[24:25]
    v_pk_fma_f32 v[26:27], v[42:43], v[116:117], v[26:27]
    v_cvt_pk_bf16_f32 v90, v20, v21
    v_cvt_pk_bf16_f32 v91, v22, v23
    v_cvt_pk_bf16_f32 v92, v24, v25
    v_cvt_pk_bf16_f32 v93, v26, v27
    buffer_store_dwordx4 v[90:93], v82, s[20:23], 0 offen offset:128 sc1
    v_pk_add_f32 v[48:49], v[12:13], v[14:15]
    v_pk_mul_f32 v[50:51], v[12:13], v[12:13]
    v_pk_fma_f32 v[50:51], v[14:15], v[14:15], v[50:51]
    v_pk_add_f32 v[48:49], v[48:49], v[16:17]
    v_pk_fma_f32 v[50:51], v[16:17], v[16:17], v[50:51]
    v_pk_add_f32 v[48:49], v[48:49], v[18:19]
    v_pk_fma_f32 v[50:51], v[18:19], v[18:19], v[50:51]
    v_pk_add_f32 v[48:49], v[48:49], v[20:21]
    v_pk_fma_f32 v[50:51], v[20:21], v[20:21], v[50:51]
    v_pk_add_f32 v[48:49], v[48:49], v[22:23]
    v_pk_fma_f32 v[50:51], v[22:23], v[22:23], v[50:51]
    v_pk_add_f32 v[48:49], v[48:49], v[24:25]
    v_pk_fma_f32 v[50:51], v[24:25], v[24:25], v[50:51]
    v_pk_add_f32 v[48:49], v[48:49], v[26:27]
    v_pk_fma_f32 v[50:51], v[26:27], v[26:27], v[50:51]
    v_add_f32 v46, v48, v49
    v_add_f32 v47, v50, v51
    s_nop 0
    v_add_f32_dpp v46, v46, v46 row_ror:8 row_mask:0xf bank_mask:0xf
    v_add_f32_dpp v47, v47, v47 row_ror:8 row_mask:0xf bank_mask:0xf
    v_mov_b32 v48, v46
    v_mov_b32 v49, v47
    s_nop 0
    v_permlane16_swap_b32 v46, v48
    v_permlane16_swap_b32 v47, v49
    v_pk_add_f32 v[46:47], v[46:47], v[48:49]
    v_mov_b32 v48, v46
    v_mov_b32 v49, v47
    s_nop 0
    v_permlane32_swap_b32 v46, v48
    v_permlane32_swap_b32 v47, v49
    v_pk_add_f32 v[46:47], v[46:47], v[48:49]
    ds_write_b64 v71, v[46:47] offset:1536
    s_waitcnt lgkmcnt(0)
    s_barrier
    s_cmp_ge_u32 s30, 4
    s_cbranch_scc1 LOADERS
    s_cmp_lg_u32 s30, 3
    s_cbranch_scc1 R_nl
    ds_read_b128 v[52:55], v72 offset:1536
    ds_read_b128 v[56:59], v72 offset:1552
    ds_read_b128 v[60:63], v72 offset:1568
    ds_read_b128 v[64:67], v72 offset:1584
    s_waitcnt lgkmcnt(0)
    v_pk_add_f32 v[52:53], v[52:53], v[54:55]
    v_pk_add_f32 v[56:57], v[56:57], v[58:59]
    v_pk_add_f32 v[60:61], v[60:61], v[62:63]
    v_pk_add_f32 v[64:65], v[64:65], v[66:67]
    v_pk_add_f32 v[52:53], v[52:53], v[56:57]
    v_pk_add_f32 v[60:61], v[60:61], v[64:65]
    v_pk_add_f32 v[52:53], v[52:53], v[60:61]
    v_mul_f32 v68, 0x3a800000, v52
    v_mul_f32 v70, 0x3a800000, v53
    v_fma_f32 v70, -v68, v68, v70
    v_max_f32 v70, 0, v70
    v_mov_b32 v32, v68
    v_mov_b32 v33, v70
    v_cvt_pk_bf16_f32 v68, v68, v68
    v_lshlrev_b32 v68, 16, v68
    v_cvt_pk_bf16_f32 v70, v70, v70
    v_lshlrev_b32 v70, 16, v70
    v_add_f32 v70, 0x3727c5ac, v70
    v_cvt_pk_bf16_f32 v70, v70, v70
    v_lshlrev_b32 v70, 16, v70
    v_sqrt_f32 v70, v70
    s_nop 0
    v_cvt_pk_bf16_f32 v70, v70, v70
    v_lshlrev_b32 v70, 16, v70
    v_rcp_f32 v69, v70
    v_sub_f32 v32, v32, v68
    v_mul_f32 v32, v32, v69
    v_mul_f32 v33, v33, v69
    v_mul_f32 v33, v33, v69
    v_cvt_pk_bf16_f32 v32, v32, v32
    v_lshlrev_b32 v32, 16, v32
    v_cvt_pk_bf16_f32 v33, v33, v33
    v_lshlrev_b32 v33, 16, v33
    v_add_f32 v33, 0x3727c5ac, v33
    v_cvt_pk_bf16_f32 v33, v33, v33
    v_lshlrev_b32 v33, 16, v33
    v_sqrt_f32 v33, v33
    s_nop 0
    v_cvt_pk_bf16_f32 v33, v33, v33
    v_lshlrev_b32 v33, 16, v33
    v_cvt_pk_bf16_f32 v28, v68, v70
    v_cvt_pk_bf16_f32 v30, v32, v33
    v_mov_b32 v29, s52
    v_mov_b32 v31, s52
    s_lshl_b32 s26, s60, 15
    s_add_u32 s26, s26, 23199744
    s_add_u32 s24, s4, s26
    s_addc_u32 s25, s5, 0
    s_mov_b32 s26, 32768
    s_mov_b32 s27, 0x20000
    s_lshl_b32 s36, s28, 4
    s_add_u32 s36, s36, s29
    s_lshl_b32 s36, s36, 7
    s_mov_b64 exec, 0xff
    buffer_store_dwordx4 v[28:31], v2, s[24:27], s36 offen sc1
    s_mov_b64 exec, -1
R_nl:
    v_mov_b32 v6, 1
    v_mov_b32 v7, 0
    s_cmp_eq_u32 s30, 3
    s_waitcnt vmcnt(1)
    s_cbranch_scc1 R_n2
    s_waitcnt vmcnt(0)
R_n2:
    s_barrier
    s_cmp_lg_u32 s30, 0
    s_cbranch_scc1 R_n3
    s_mov_b64 exec, 1
    buffer_atomic_add v6, v7, s[56:59], s55 offen sc1
    s_mov_b64 exec, -1
R_n3:
    ds_read_b64_tr_b16 v[180:181], v75 offset:49152
    ds_read_b64_tr_b16 v[182:183], v75 offset:51200
    ds_read_b64_tr_b16 v[188:189], v75 offset:53248
    ds_read_b64_tr_b16 v[190:191], v75 offset:55296
    ds_read_b64_tr_b16 v[196:197], v75 offset:57344
    ds_read_b64_tr_b16 v[198:199], v75 offset:59392
    ds_read_b64_tr_b16 v[204:205], v75 offset:61440
    ds_read_b64_tr_b16 v[206:207], v75 offset:63488
    ds_read_b64_tr_b16 v[244:245], v76 offset:16384
    ds_read_b64_tr_b16 v[246:247], v76 offset:18432
    ds_read_b64_tr_b16 v[252:253], v76 offset:20480
    ds_read_b64_tr_b16 v[254:255], v76 offset:22528
    ds_read_b64_tr_b16 v[212:213], v76 offset:0
    ds_read_b64_tr_b16 v[214:215], v76 offset:2048
    ds_read_b64_tr_b16 v[220:221], v76 offset:4096
    ds_read_b64_tr_b16 v[222:223], v76 offset:6144
    ds_read_b64_tr_b16 v[228:229], v76 offset:8192
    ds_read_b64_tr_b16 v[230:231], v76 offset:10240
    ds_read_b64_tr_b16 v[236:237], v76 offset:12288
    ds_read_b64_tr_b16 v[238:239], v76 offset:14336
    ds_read_b64_tr_b16 v[176:177], v74 offset:49152
    ds_read_b64_tr_b16 v[178:179], v74 offset:51200
    ds_read_b64_tr_b16 v[184:185], v74 offset:53248
    ds_read_b64_tr_b16 v[186:187], v74 offset:55296
    ds_read_b64_tr_b16 v[192:193], v74 offset:57344
    ds_read_b64_tr_b16 v[194:195], v74 offset:59392
    ds_read_b64_tr_b16 v[200:201], v74 offset:61440
    ds_read_b64_tr_b16 v[202:203], v74 offset:63488
    ds_read_b64_tr_b16 v[208:209], v75 offset:0
    ds_read_b64_tr_b16 v[210:211], v75 offset:2048
    ds_read_b64_tr_b16 v[216:217], v75 offset:4096
    ds_read_b64_tr_b16 v[218:219], v75 offset:6144
    ds_read_b64_tr_b16 v[224:225], v75 offset:8192
    ds_read_b64_tr_b16 v[226:227], v75 offset:10240
    ds_read_b64_tr_b16 v[232:233], v75 offset:12288
    ds_read_b64_tr_b16 v[234:235], v75 offset:14336
    ds_read_b64_tr_b16 v[128:129], v74 offset:24576
    ds_read_b64_tr_b16 v[130:131], v74 offset:26624
    ds_read_b64_tr_b16 v[136:137], v74 offset:28672
    ds_read_b64_tr_b16 v[138:139], v74 offset:30720
    v_and_b32 v8, 15, v1
    v_lshrrev_b32 v9, 4, v1
    v_xor_b32 v6, v9, v8
    v_lshlrev_b32 v7, 8, v8
    v_xor_b32 v10, 0, v6
    v_lshl_add_u32 v10, v10, 4, v7
    v_add_u32 v14, 106496, v10
    v_xor_b32 v11, 4, v6
    v_lshl_add_u32 v11, v11, 4, v7
    v_add_u32 v15, 106496, v11
    v_xor_b32 v12, 8, v6
    v_lshl_add_u32 v12, v12, 4, v7
    v_add_u32 v16, 106496, v12
    v_xor_b32 v13, 12, v6
    v_lshl_add_u32 v13, v13, 4, v7
    v_add_u32 v17, 106496, v13
    v_lshlrev_b32 v18, 4, v8
    v_add_u32 v18, 155648, v18
    s_add_u32 s16, s62, 0x400000
    s_addc_u32 s17, s63, 0
    s_mov_b32 s18, 0x7e000
    s_mov_b32 s19, 0x20000
    v_and_b32 v6, 1, v9
    v_lshlrev_b32 v114, 16, v6
    v_lshrrev_b32 v6, 1, v9
    v_lshl_add_u32 v114, v6, 8, v114
    v_lshl_add_u32 v114, v8, 4, v114
    s_bfe_u32 s36, s30, 0x10001
    s_lshl1_add_u32 s36, s29, s36
    s_xor_b32 s36, s36, 2
    s_lshr_b32 s53, s36, 3
    s_lshl_b32 s53, s53, 14
    s_and_b32 s39, s36, 7
    s_lshl_b32 s39, s39, 10
    s_add_u32 s39, s39, s53
    s_and_b32 s36, s30, 1
    s_lshl_b32 s36, s36, 9
    s_add_u32 s39, s39, s36
    s_and_b32 s12, s30, 3
    s_lshl_b32 s12, s12, 15
    s_add_u32 s53, s67, 0
    s_and_b32 s8, s53, 4
    s_and_b32 s53, s53, 2
    s_lshl_b32 s8, s8, 12
    s_lshl_b32 s53, s53, 11
    s_add_u32 s8, s8, s53
    s_add_u32 s8, s8, s12
    s_add_u32 s53, s67, 2
    s_and_b32 s9, s53, 4
    s_and_b32 s53, s53, 2
    s_lshl_b32 s9, s9, 12
    s_lshl_b32 s53, s53, 11
    s_add_u32 s9, s9, s53
    s_add_u32 s9, s9, s12
    s_add_u32 s53, s67, 4
    s_and_b32 s10, s53, 4
    s_and_b32 s53, s53, 2
    s_lshl_b32 s10, s10, 12
    s_lshl_b32 s53, s53, 11
    s_add_u32 s10, s10, s53
    s_add_u32 s10, s10, s12
    s_add_u32 s53, s67, 6
    s_and_b32 s11, s53, 4
    s_and_b32 s53, s53, 2
    s_lshl_b32 s11, s11, 12
    s_lshl_b32 s53, s53, 11
    s_add_u32 s11, s11, s53
    s_add_u32 s11, s11, s12
    s_and_b32 s53, s30, 2
    s_lshl_b32 s53, s53, 11
    s_and_b32 s12, s30, 1
    s_lshl_b32 s12, s12, 13
    s_add_u32 s12, s12, s53
    s_and_b32 s20, s30, 1
    s_lshl_b32 s20, s20, 8
    s_add_u32 s20, s20, s55
    s_add_u32 s21, s52, 16
    v_mov_b32 v112, 0x7f000000
    v_writelane_b32 v112, 0, 0
    v_mov_b32 v113, 1
    s_and_b32 s40, s30, 1
    s_lshl1_add_u32 s40, s31, s40
    s_lshl_b32 s40, s40, 7
    s_add_u32 s40, s40, s55
    s_barrier
    ds_read_b64_tr_b16 v[240:241], v75 offset:16384
    ds_read_b64_tr_b16 v[242:243], v75 offset:18432
    ds_read_b64_tr_b16 v[248:249], v75 offset:20480
    ds_read_b64_tr_b16 v[250:251], v75 offset:22528
    ds_read_b64_tr_b16 v[132:133], v75 offset:24576
    ds_read_b64_tr_b16 v[134:135], v75 offset:26624
    ds_read_b64_tr_b16 v[140:141], v75 offset:28672
    ds_read_b64_tr_b16 v[142:143], v75 offset:30720
    ds_read_b64_tr_b16 v[144:145], v74 offset:32768
    ds_read_b64_tr_b16 v[146:147], v74 offset:34816
    ds_read_b64_tr_b16 v[152:153], v74 offset:36864
    ds_read_b64_tr_b16 v[154:155], v74 offset:38912
    ds_read_b64_tr_b16 v[160:161], v74 offset:40960
    ds_read_b64_tr_b16 v[162:163], v74 offset:43008
    ds_read_b64_tr_b16 v[168:169], v74 offset:45056
    ds_read_b64_tr_b16 v[170:171], v74 offset:47104
    ds_read_b64_tr_b16 v[148:149], v75 offset:32768
    ds_read_b64_tr_b16 v[150:151], v75 offset:34816
    ds_read_b64_tr_b16 v[156:157], v75 offset:36864
    ds_read_b64_tr_b16 v[158:159], v75 offset:38912
    ds_read_b64_tr_b16 v[164:165], v75 offset:40960
    ds_read_b64_tr_b16 v[166:167], v75 offset:43008
    ds_read_b64_tr_b16 v[172:173], v75 offset:45056
    ds_read_b64_tr_b16 v[174:175], v75 offset:47104
    v_mov_b32 v88, 0x3f803f80
    v_mov_b32 v89, 0x3f803f80
    v_mov_b32 v90, 0x3f803f80
    v_mov_b32 v91, 0x3f803f80
    s_cmp_lg_u32 s30, 0
    s_cbranch_scc1 pdone_8
    s_add_u32 s54, s55, 0
    s_bitcmp1_b32 s29, 2
    s_cselect_b32 s53, s93, s92
    s_add_u32 s53, s53, s54
    v_mov_b32 v105, s54
    v_writelane_b32 v105, s53, 1
    s_mov_b32 s53, 0
    s_add_u32 s54, s52, 16
    s_bfm_b64 exec, 2, 0
poll_9:
    buffer_load_dword v104, v105, s[56:59], 0 offen sc1
    s_waitcnt vmcnt(0)
    v_cmp_eq_u32 vcc, s54, v104
    s_nop 0
    s_cmp_eq_u64 vcc, exec
    s_cbranch_scc1 pok_10
    s_sleep 3
    s_add_u32 s53, s53, 1
    s_cmp_lt_u32 s53, s61
    s_cbranch_scc1 poll_9
    s_mov_b32 s61, 0
pok_10:
    s_mov_b64 exec, -1
pdone_8:
    s_waitcnt lgkmcnt(0)
    s_barrier
    v_mfma_f32_16x16x32_bf16 v[84:87], v[128:131], v[88:91], 0
    v_mfma_f32_16x16x32_bf16 v[84:87], v[132:135], v[88:91], v[84:87]
    v_mfma_f32_16x16x32_bf16 v[84:87], v[136:139], v[88:91], v[84:87]
    v_mfma_f32_16x16x32_bf16 v[84:87], v[140:143], v[88:91], v[84:87]
    v_mfma_f32_16x16x32_bf16 v[84:87], v[144:147], v[88:91], v[84:87]
    v_mfma_f32_16x16x32_bf16 v[84:87], v[148:151], v[88:91], v[84:87]
    v_mfma_f32_16x16x32_bf16 v[84:87], v[152:155], v[88:91], v[84:87]
    v_mfma_f32_16x16x32_bf16 v[84:87], v[156:159], v[88:91], v[84:87]
    v_mfma_f32_16x16x32_bf16 v[84:87], v[160:163], v[88:91], v[84:87]
    v_mfma_f32_16x16x32_bf16 v[84:87], v[164:167], v[88:91], v[84:87]
    v_mfma_f32_16x16x32_bf16 v[84:87], v[168:171], v[88:91], v[84:87]
    v_mfma_f32_16x16x32_bf16 v[84:87], v[172:175], v[88:91], v[84:87]
    v_mfma_f32_16x16x32_bf16 v[84:87], v[176:179], v[88:91], v[84:87]
    v_mfma_f32_16x16x32_bf16 v[84:87], v[180:183], v[88:91], v[84:87]
    v_mfma_f32_16x16x32_bf16 v[84:87], v[184:187], v[88:91], v[84:87]
    v_mfma_f32_16x16x32_bf16 v[84:87], v[188:191], v[88:91], v[84:87]
    v_mfma_f32_16x16x32_bf16 v[84:87], v[192:195], v[88:91], v[84:87]
    v_mfma_f32_16x16x32_bf16 v[84:87], v[196:199], v[88:91], v[84:87]
    v_mfma_f32_16x16x32_bf16 v[84:87], v[200:203], v[88:91], v[84:87]
    v_mfma_f32_16x16x32_bf16 v[84:87], v[204:207], v[88:91], v[84:87]
    v_mfma_f32_16x16x32_bf16 v[84:87], v[208:211], v[88:91], v[84:87]
    v_mfma_f32_16x16x32_bf16 v[84:87], v[212:215], v[88:91], v[84:87]
    v_mfma_f32_16x16x32_bf16 v[84:87], v[216:219], v[88:91], v[84:87]
    v_mfma_f32_16x16x32_bf16 v[84:87], v[220:223], v[88:91], v[84:87]
    v_mfma_f32_16x16x32_bf16 v[84:87], v[224:227], v[88:91], v[84:87]
    v_mfma_f32_16x16x32_bf16 v[84:87], v[228:231], v[88:91], v[84:87]
    v_mfma_f32_16x16x32_bf16 v[84:87], v[232:235], v[88:91], v[84:87]
    v_mfma_f32_16x16x32_bf16 v[84:87], v[236:239], v[88:91], v[84:87]
    v_mfma_f32_16x16x32_bf16 v[84:87], v[240:243], v[88:91], v[84:87]
    v_mfma_f32_16x16x32_bf16 v[84:87], v[244:247], v[88:91], v[84:87]
    v_mfma_f32_16x16x32_bf16 v[84:87], v[248:251], v[88:91], v[84:87]
    v_mfma_f32_16x16x32_bf16 v[84:87], v[252:255], v[88:91], v[84:87]
    s_barrier
    ds_read_b128 v[36:39], v10 offset:16384
    ds_read_b128 v[40:43], v10 offset:20480
    ds_read_b128 v[44:47], v10 offset:24576
    ds_read_b128 v[48:51], v10 offset:28672
    ds_read_b128 v[52:55], v11 offset:16384
    ds_read_b128 v[56:59], v11 offset:20480
    ds_read_b128 v[60:63], v11 offset:24576
    ds_read_b128 v[64:67], v11 offset:28672
    s_waitcnt lgkmcnt(4)
    v_mfma_f32_16x16x32_bf16 v[20:23], v[128:131], v[36:39], 0
    ds_read_b128 v[68:71], v12 offset:16384
    v_mfma_f32_16x16x32_bf16 v[24:27], v[128:131], v[40:43], 0
    ds_read_b128 v[72:75], v12 offset:20480
    v_mfma_f32_16x16x32_bf16 v[24:27], v[132:135], v[48:51], v[24:27]
    ds_read_b128 v[76:79], v12 offset:24576
    v_mfma_f32_16x16x32_bf16 v[20:23], v[132:135], v[44:47], v[20:23]
    ds_read_b128 v[80:83], v12 offset:28672
    s_waitcnt lgkmcnt(4)
    v_mfma_f32_16x16x32_bf16 v[20:23], v[136:139], v[52:55], v[20:23]
    ds_read_b128 v[36:39], v13 offset:16384
    v_mfma_f32_16x16x32_bf16 v[24:27], v[136:139], v[56:59], v[24:27]
    ds_read_b128 v[40:43], v13 offset:20480
    v_mfma_f32_16x16x32_bf16 v[24:27], v[140:143], v[64:67], v[24:27]
    ds_read_b128 v[44:47], v13 offset:24576
    v_mfma_f32_16x16x32_bf16 v[20:23], v[140:143], v[60:63], v[20:23]
    ds_read_b128 v[48:51], v13 offset:28672
    s_barrier
    s_waitcnt lgkmcnt(4)
    v_mfma_f32_16x16x32_bf16 v[20:23], v[144:147], v[68:71], v[20:23]
    ds_read_b128 v[52:55], v10 offset:32768
    v_mfma_f32_16x16x32_bf16 v[24:27], v[144:147], v[72:75], v[24:27]
    ds_read_b128 v[56:59], v10 offset:36864
    v_mfma_f32_16x16x32_bf16 v[24:27], v[148:151], v[80:83], v[24:27]
    ds_read_b128 v[60:63], v10 offset:40960
    v_mfma_f32_16x16x32_bf16 v[20:23], v[148:151], v[76:79], v[20:23]
    ds_read_b128 v[64:67], v10 offset:45056
    s_waitcnt lgkmcnt(4)
    v_mfma_f32_16x16x32_bf16 v[20:23], v[152:155], v[36:39], v[20:23]
    ds_read_b128 v[68:71], v11 offset:32768
    v_mfma_f32_16x16x32_bf16 v[24:27], v[152:155], v[40:43], v[24:27]
    ds_read_b128 v[72:75], v11 offset:36864
    v_mfma_f32_16x16x32_bf16 v[24:27], v[156:159], v[48:51], v[24:27]
    ds_read_b128 v[76:79], v11 offset:40960
    v_mfma_f32_16x16x32_bf16 v[20:23], v[156:159], v[44:47], v[20:23]
    ds_read_b128 v[80:83], v11 offset:45056
    s_waitcnt lgkmcnt(4)
    v_mfma_f32_16x16x32_bf16 v[20:23], v[160:163], v[52:55], v[20:23]
    ds_read_b128 v[36:39], v12 offset:32768
    v_mfma_f32_16x16x32_bf16 v[24:27], v[160:163], v[56:59], v[24:27]
    ds_read_b128 v[40:43], v12 offset:36864
    v_mfma_f32_16x16x32_bf16 v[24:27], v[164:167], v[64:67], v[24:27]
    ds_read_b128 v[44:47], v12 offset:40960
    v_mfma_f32_16x16x32_bf16 v[20:23], v[164:167], v[60:63], v[20:23]
    ds_read_b128 v[48:51], v12 offset:45056
    s_waitcnt lgkmcnt(4)
    v_mfma_f32_16x16x32_bf16 v[20:23], v[168:171], v[68:71], v[20:23]
    ds_read_b128 v[52:55], v13 offset:32768
    v_mfma_f32_16x16x32_bf16 v[24:27], v[168:171], v[72:75], v[24:27]
    ds_read_b128 v[56:59], v13 offset:36864
    v_mfma_f32_16x16x32_bf16 v[24:27], v[172:175], v[80:83], v[24:27]
    ds_read_b128 v[60:63], v13 offset:40960
    v_mfma_f32_16x16x32_bf16 v[20:23], v[172:175], v[76:79], v[20:23]
    ds_read_b128 v[64:67], v13 offset:45056
    s_barrier
    s_waitcnt lgkmcnt(4)
    v_mfma_f32_16x16x32_bf16 v[20:23], v[176:179], v[36:39], v[20:23]
    ds_read_b128 v[68:71], v14 offset:0
    v_mfma_f32_16x16x32_bf16 v[24:27], v[176:179], v[40:43], v[24:27]
    ds_read_b128 v[72:75], v14 offset:4096
    v_mfma_f32_16x16x32_bf16 v[24:27], v[180:183], v[48:51], v[24:27]
    ds_read_b128 v[76:79], v14 offset:8192
    v_mfma_f32_16x16x32_bf16 v[20:23], v[180:183], v[44:47], v[20:23]
    ds_read_b128 v[80:83], v14 offset:12288
    s_waitcnt lgkmcnt(4)
    v_mfma_f32_16x16x32_bf16 v[20:23], v[184:187], v[52:55], v[20:23]
    ds_read_b128 v[36:39], v15 offset:0
    v_mfma_f32_16x16x32_bf16 v[24:27], v[184:187], v[56:59], v[24:27]
    ds_read_b128 v[40:43], v15 offset:4096
    v_mfma_f32_16x16x32_bf16 v[24:27], v[188:191], v[64:67], v[24:27]
    ds_read_b128 v[44:47], v15 offset:8192
    v_mfma_f32_16x16x32_bf16 v[20:23], v[188:191], v[60:63], v[20:23]
    ds_read_b128 v[48:51], v15 offset:12288
    s_waitcnt lgkmcnt(4)
    v_mfma_f32_16x16x32_bf16 v[20:23], v[192:195], v[68:71], v[20:23]
    ds_read_b128 v[52:55], v16 offset:0
    v_mfma_f32_16x16x32_bf16 v[24:27], v[192:195], v[72:75], v[24:27]
    ds_read_b128 v[56:59], v16 offset:4096
    v_mfma_f32_16x16x32_bf16 v[24:27], v[196:199], v[80:83], v[24:27]
    ds_read_b128 v[60:63], v16 offset:8192
    v_mfma_f32_16x16x32_bf16 v[20:23], v[196:199], v[76:79], v[20:23]
    ds_read_b128 v[64:67], v16 offset:12288
    s_waitcnt lgkmcnt(4)
    v_mfma_f32_16x16x32_bf16 v[20:23], v[200:203], v[36:39], v[20:23]
    ds_read_b128 v[68:71], v17 offset:0
    v_mfma_f32_16x16x32_bf16 v[24:27], v[200:203], v[40:43], v[24:27]
    ds_read_b128 v[72:75], v17 offset:4096
    v_mfma_f32_16x16x32_bf16 v[24:27], v[204:207], v[48:51], v[24:27]
    ds_read_b128 v[76:79], v17 offset:8192
    v_mfma_f32_16x16x32_bf16 v[20:23], v[204:207], v[44:47], v[20:23]
    ds_read_b128 v[80:83], v17 offset:12288
    s_barrier
    s_waitcnt lgkmcnt(4)
    v_mfma_f32_16x16x32_bf16 v[20:23], v[208:211], v[52:55], v[20:23]
    ds_read_b128 v[36:39], v14 offset:16384
    v_mfma_f32_16x16x32_bf16 v[24:27], v[208:211], v[56:59], v[24:27]
    ds_read_b128 v[40:43], v14 offset:20480
    v_mfma_f32_16x16x32_bf16 v[24:27], v[212:215], v[64:67], v[24:27]
    ds_read_b128 v[44:47], v14 offset:24576
    v_mfma_f32_16x16x32_bf16 v[20:23], v[212:215], v[60:63], v[20:23]
    ds_read_b128 v[48:51], v14 offset:28672
    s_waitcnt lgkmcnt(4)
    v_mfma_f32_16x16x32_bf16 v[20:23], v[216:219], v[68:71], v[20:23]
    ds_read_b128 v[52:55], v15 offset:16384
    v_mfma_f32_16x16x32_bf16 v[24:27], v[216:219], v[72:75], v[24:27]
    ds_read_b128 v[56:59], v15 offset:20480
    v_mfma_f32_16x16x32_bf16 v[24:27], v[220:223], v[80:83], v[24:27]
    ds_read_b128 v[60:63], v15 offset:24576
    v_mfma_f32_16x16x32_bf16 v[20:23], v[220:223], v[76:79], v[20:23]
    ds_read_b128 v[64:67], v15 offset:28672
    s_waitcnt lgkmcnt(4)
    v_mfma_f32_16x16x32_bf16 v[20:23], v[224:227], v[36:39], v[20:23]
    ds_read_b128 v[68:71], v16 offset:16384
    v_mfma_f32_16x16x32_bf16 v[24:27], v[224:227], v[40:43], v[24:27]
    ds_read_b128 v[72:75], v16 offset:20480
    v_mfma_f32_16x16x32_bf16 v[24:27], v[228:231], v[48:51], v[24:27]
    ds_read_b128 v[76:79], v16 offset:24576
    v_mfma_f32_16x16x32_bf16 v[20:23], v[228:231], v[44:47], v[20:23]
    ds_read_b128 v[80:83], v16 offset:28672
    s_waitcnt lgkmcnt(4)
    v_mfma_f32_16x16x32_bf16 v[20:23], v[232:235], v[52:55], v[20:23]
    ds_read_b128 v[36:39], v17 offset:16384
    v_mfma_f32_16x16x32_bf16 v[24:27], v[232:235], v[56:59], v[24:27]
    ds_read_b128 v[40:43], v17 offset:20480
    v_mfma_f32_16x16x32_bf16 v[24:27], v[236:239], v[64:67], v[24:27]
    ds_read_b128 v[44:47], v17 offset:24576
    v_mfma_f32_16x16x32_bf16 v[20:23], v[236:239], v[60:63], v[20:23]
    ds_read_b128 v[48:51], v17 offset:28672
    s_barrier
    ds_read_b128 v[88:91], v18 offset:0
    ds_read_b128 v[92:95], v18 offset:2048
    ds_read_b128 v[96:99], v18 offset:256
    ds_read_b128 v[100:103], v18 offset:2304
    s_waitcnt lgkmcnt(8)
    v_mfma_f32_16x16x32_bf16 v[20:23], v[240:243], v[68:71], v[20:23]
    ds_read_b128 v[52:55], v14 offset:32768
    v_mfma_f32_16x16x32_bf16 v[24:27], v[240:243], v[72:75], v[24:27]
    ds_read_b128 v[56:59], v14 offset:36864
    v_mfma_f32_16x16x32_bf16 v[24:27], v[244:247], v[80:83], v[24:27]
    ds_read_b128 v[60:63], v14 offset:40960
    v_mfma_f32_16x16x32_bf16 v[20:23], v[244:247], v[76:79], v[20:23]
    ds_read_b128 v[64:67], v14 offset:45056
    s_waitcnt lgkmcnt(8)
    v_mfma_f32_16x16x32_bf16 v[20:23], v[248:251], v[36:39], v[20:23]
    ds_read_b128 v[68:71], v15 offset:32768
    v_mfma_f32_16x16x32_bf16 v[24:27], v[248:251], v[40:43], v[24:27]
    ds_read_b128 v[72:75], v15 offset:36864
    v_mfma_f32_16x16x32_bf16 v[24:27], v[252:255], v[48:51], v[24:27]
    ds_read_b128 v[76:79], v15 offset:40960
    v_mfma_f32_16x16x32_bf16 v[20:23], v[252:255], v[44:47], v[20:23]
    ds_read_b128 v[80:83], v15 offset:45056
    s_waitcnt lgkmcnt(4)
    v_mfma_f32_16x16x32_bf16 v[28:31], v[128:131], v[52:55], 0
    ds_read_b128 v[36:39], v16 offset:32768
    v_mfma_f32_16x16x32_bf16 v[32:35], v[128:131], v[56:59], 0
    ds_read_b128 v[40:43], v16 offset:36864
    v_mfma_f32_16x16x32_bf16 v[32:35], v[132:135], v[64:67], v[32:35]
    ds_read_b128 v[44:47], v16 offset:40960
    v_mfma_f32_16x16x32_bf16 v[28:31], v[132:135], v[60:63], v[28:31]
    ds_read_b128 v[48:51], v16 offset:45056
    v_pk_fma_f32 v[20:21], v[88:89], v[84:85], v[20:21]
    v_pk_fma_f32 v[22:23], v[88:89], v[86:87], v[22:23]
    v_pk_fma_f32 v[24:25], v[96:97], v[84:85], v[24:25]
    v_pk_fma_f32 v[26:27], v[96:97], v[86:87], v[26:27]
    v_pk_mul_f32 v[104:105], v[20:21], v[20:21]
    v_pk_mul_f32 v[106:107], v[22:23], v[22:23]
    v_pk_mul_f32 v[108:109], v[24:25], v[24:25]
    v_pk_mul_f32 v[110:111], v[26:27], v[26:27]
    v_pk_fma_f32 v[104:105], v[104:105], v[92:93], v[90:91]
    v_pk_fma_f32 v[106:107], v[106:107], v[92:93], v[90:91]
    v_pk_fma_f32 v[108:109], v[108:109], v[100:101], v[98:99]
    v_pk_fma_f32 v[110:111], v[110:111], v[100:101], v[98:99]
    v_pk_mul_f32 v[104:105], v[104:105], v[20:21]
    v_pk_mul_f32 v[106:107], v[106:107], v[22:23]
    v_pk_mul_f32 v[108:109], v[108:109], v[24:25]
    v_pk_mul_f32 v[110:111], v[110:111], v[26:27]
    v_exp_f32 v104, v104
    v_exp_f32 v105, v105
    v_exp_f32 v106, v106
    v_exp_f32 v107, v107
    v_exp_f32 v108, v108
    v_exp_f32 v109, v109
    v_exp_f32 v110, v110
    v_exp_f32 v111, v111
    v_pk_fma_f32 v[104:105], v[104:105], v[94:95], v[94:95]
    v_pk_fma_f32 v[106:107], v[106:107], v[94:95], v[94:95]
    v_pk_fma_f32 v[108:109], v[108:109], v[102:103], v[102:103]
    v_pk_fma_f32 v[110:111], v[110:111], v[102:103], v[102:103]
    v_rcp_f32 v104, v104
    v_rcp_f32 v105, v105
    v_rcp_f32 v106, v106
    v_rcp_f32 v107, v107
    v_rcp_f32 v108, v108
    v_rcp_f32 v109, v109
    v_rcp_f32 v110, v110
    v_rcp_f32 v111, v111
    v_pk_mul_f32 v[20:21], v[20:21], v[104:105]
    v_pk_mul_f32 v[22:23], v[22:23], v[106:107]
    v_pk_mul_f32 v[24:25], v[24:25], v[108:109]
    v_pk_mul_f32 v[26:27], v[26:27], v[110:111]
    v_add_u32 v20, 0x10000, v20
    v_add_u32 v22, 0x10000, v22
    v_add_u32 v24, 0x10000, v24
    v_add_u32 v26, 0x10000, v26
    v_and_b32 v20, 0xfffe0000, v20
    v_and_b32 v22, 0xfffe0000, v22
    v_and_b32 v24, 0xfffe0000, v24
    v_and_b32 v26, 0xfffe0000, v26
    v_cvt_pk_bf16_f32 v104, v20, v21
    v_cvt_pk_bf16_f32 v105, v22, v23
    v_cvt_pk_bf16_f32 v106, v24, v25
    v_cvt_pk_bf16_f32 v107, v26, v27
    s_add_u32 s36, s39, 0
    v_permlane16_swap_b32 v104, v106
    v_permlane16_swap_b32 v105, v107
    buffer_store_dwordx4 v[104:107], v114, s[16:19], s36 offen sc1
    s_waitcnt lgkmcnt(4)
    v_mfma_f32_16x16x32_bf16 v[28:31], v[136:139], v[68:71], v[28:31]
    ds_read_b128 v[52:55], v17 offset:32768
    v_mfma_f32_16x16x32_bf16 v[32:35], v[136:139], v[72:75], v[32:35]
    ds_read_b128 v[56:59], v17 offset:36864
    v_mfma_f32_16x16x32_bf16 v[32:35], v[140:143], v[80:83], v[32:35]
    ds_read_b128 v[60:63], v17 offset:40960
    v_mfma_f32_16x16x32_bf16 v[28:31], v[140:143], v[76:79], v[28:31]
    ds_read_b128 v[64:67], v17 offset:45056
    s_barrier
    s_waitcnt lgkmcnt(4)
    v_mfma_f32_16x16x32_bf16 v[28:31], v[144:147], v[36:39], v[28:31]
    ds_read_b128 v[68:71], v10 offset:16384
    v_mfma_f32_16x16x32_bf16 v[32:35], v[144:147], v[40:43], v[32:35]
    ds_read_b128 v[72:75], v10 offset:20480
    v_mfma_f32_16x16x32_bf16 v[32:35], v[148:151], v[48:51], v[32:35]
    ds_read_b128 v[76:79], v10 offset:24576
    v_mfma_f32_16x16x32_bf16 v[28:31], v[148:151], v[44:47], v[28:31]
    ds_read_b128 v[80:83], v10 offset:28672
    s_waitcnt lgkmcnt(4)
    v_mfma_f32_16x16x32_bf16 v[28:31], v[152:155], v[52:55], v[28:31]
    ds_read_b128 v[36:39], v11 offset:16384
    v_mfma_f32_16x16x32_bf16 v[32:35], v[152:155], v[56:59], v[32:35]
    ds_read_b128 v[40:43], v11 offset:20480
    v_mfma_f32_16x16x32_bf16 v[32:35], v[156:159], v[64:67], v[32:35]
    ds_read_b128 v[44:47], v11 offset:24576
    v_mfma_f32_16x16x32_bf16 v[28:31], v[156:159], v[60:63], v[28:31]
    ds_read_b128 v[48:51], v11 offset:28672
    s_waitcnt lgkmcnt(4)
    v_mfma_f32_16x16x32_bf16 v[28:31], v[160:163], v[68:71], v[28:31]
    ds_read_b128 v[52:55], v12 offset:16384
    v_mfma_f32_16x16x32_bf16 v[32:35], v[160:163], v[72:75], v[32:35]
    ds_read_b128 v[56:59], v12 offset:20480
    v_mfma_f32_16x16x32_bf16 v[32:35], v[164:167], v[80:83], v[32:35]
    ds_read_b128 v[60:63], v12 offset:24576
    v_mfma_f32_16x16x32_bf16 v[28:31], v[164:167], v[76:79], v[28:31]
    ds_read_b128 v[64:67], v12 offset:28672
    s_waitcnt lgkmcnt(4)
    v_mfma_f32_16x16x32_bf16 v[28:31], v[168:171], v[36:39], v[28:31]
    ds_read_b128 v[68:71], v13 offset:16384
    v_mfma_f32_16x16x32_bf16 v[32:35], v[168:171], v[40:43], v[32:35]
    ds_read_b128 v[72:75], v13 offset:20480
    v_mfma_f32_16x16x32_bf16 v[32:35], v[172:175], v[48:51], v[32:35]
    ds_read_b128 v[76:79], v13 offset:24576
    v_mfma_f32_16x16x32_bf16 v[28:31], v[172:175], v[44:47], v[28:31]
    ds_read_b128 v[80:83], v13 offset:28672
    s_barrier
    s_waitcnt lgkmcnt(4)
    v_mfma_f32_16x16x32_bf16 v[28:31], v[176:179], v[52:55], v[28:31]
    ds_read_b128 v[36:39], v10 offset:32768
    v_mfma_f32_16x16x32_bf16 v[32:35], v[176:179], v[56:59], v[32:35]
    ds_read_b128 v[40:43], v10 offset:36864
    v_mfma_f32_16x16x32_bf16 v[32:35], v[180:183], v[64:67], v[32:35]
    ds_read_b128 v[44:47], v10 offset:40960
    v_mfma_f32_16x16x32_bf16 v[28:31], v[180:183], v[60:63], v[28:31]
    ds_read_b128 v[48:51], v10 offset:45056
    s_waitcnt lgkmcnt(4)
    v_mfma_f32_16x16x32_bf16 v[28:31], v[184:187], v[68:71], v[28:31]
    ds_read_b128 v[52:55], v11 offset:32768
    v_mfma_f32_16x16x32_bf16 v[32:35], v[184:187], v[72:75], v[32:35]
    ds_read_b128 v[56:59], v11 offset:36864
    v_mfma_f32_16x16x32_bf16 v[32:35], v[188:191], v[80:83], v[32:35]
    ds_read_b128 v[60:63], v11 offset:40960
    v_mfma_f32_16x16x32_bf16 v[28:31], v[188:191], v[76:79], v[28:31]
    ds_read_b128 v[64:67], v11 offset:45056
    s_waitcnt lgkmcnt(4)
    v_mfma_f32_16x16x32_bf16 v[28:31], v[192:195], v[36:39], v[28:31]
    ds_read_b128 v[68:71], v12 offset:32768
    v_mfma_f32_16x16x32_bf16 v[32:35], v[192:195], v[40:43], v[32:35]
    ds_read_b128 v[72:75], v12 offset:36864
    v_mfma_f32_16x16x32_bf16 v[32:35], v[196:199], v[48:51], v[32:35]
    ds_read_b128 v[76:79], v12 offset:40960
    v_mfma_f32_16x16x32_bf16 v[28:31], v[196:199], v[44:47], v[28:31]
    ds_read_b128 v[80:83], v12 offset:45056
    s_waitcnt lgkmcnt(4)
    v_mfma_f32_16x16x32_bf16 v[28:31], v[200:203], v[52:55], v[28:31]
    ds_read_b128 v[36:39], v13 offset:32768
    v_mfma_f32_16x16x32_bf16 v[32:35], v[200:203], v[56:59], v[32:35]
    ds_read_b128 v[40:43], v13 offset:36864
    v_mfma_f32_16x16x32_bf16 v[32:35], v[204:207], v[64:67], v[32:35]
    ds_read_b128 v[44:47], v13 offset:40960
    v_mfma_f32_16x16x32_bf16 v[28:31], v[204:207], v[60:63], v[28:31]
    ds_read_b128 v[48:51], v13 offset:45056
    s_barrier
    s_waitcnt lgkmcnt(4)
    v_mfma_f32_16x16x32_bf16 v[28:31], v[208:211], v[68:71], v[28:31]
    ds_read_b128 v[52:55], v14 offset:0
    v_mfma_f32_16x16x32_bf16 v[32:35], v[208:211], v[72:75], v[32:35]
    ds_read_b128 v[56:59], v14 offset:4096
    v_mfma_f32_16x16x32_bf16 v[32:35], v[212:215], v[80:83], v[32:35]
    ds_read_b128 v[60:63], v14 offset:8192
    v_mfma_f32_16x16x32_bf16 v[28:31], v[212:215], v[76:79], v[28:31]
    ds_read_b128 v[64:67], v14 offset:12288
    s_waitcnt lgkmcnt(4)
    v_mfma_f32_16x16x32_bf16 v[28:31], v[216:219], v[36:39], v[28:31]
    ds_read_b128 v[68:71], v15 offset:0
    v_mfma_f32_16x16x32_bf16 v[32:35], v[216:219], v[40:43], v[32:35]
    ds_read_b128 v[72:75], v15 offset:4096
    v_mfma_f32_16x16x32_bf16 v[32:35], v[220:223], v[48:51], v[32:35]
    ds_read_b128 v[76:79], v15 offset:8192
    v_mfma_f32_16x16x32_bf16 v[28:31], v[220:223], v[44:47], v[28:31]
    ds_read_b128 v[80:83], v15 offset:12288
    s_waitcnt lgkmcnt(4)
    v_mfma_f32_16x16x32_bf16 v[28:31], v[224:227], v[52:55], v[28:31]
    ds_read_b128 v[36:39], v16 offset:0
    v_mfma_f32_16x16x32_bf16 v[32:35], v[224:227], v[56:59], v[32:35]
    ds_read_b128 v[40:43], v16 offset:4096
    v_mfma_f32_16x16x32_bf16 v[32:35], v[228:231], v[64:67], v[32:35]
    ds_read_b128 v[44:47], v16 offset:8192
    v_mfma_f32_16x16x32_bf16 v[28:31], v[228:231], v[60:63], v[28:31]
    ds_read_b128 v[48:51], v16 offset:12288
    s_waitcnt lgkmcnt(4)
    v_mfma_f32_16x16x32_bf16 v[28:31], v[232:235], v[68:71], v[28:31]
    ds_read_b128 v[52:55], v17 offset:0
    v_mfma_f32_16x16x32_bf16 v[32:35], v[232:235], v[72:75], v[32:35]
    ds_read_b128 v[56:59], v17 offset:4096
    v_mfma_f32_16x16x32_bf16 v[32:35], v[236:239], v[80:83], v[32:35]
    ds_read_b128 v[60:63], v17 offset:8192
    v_mfma_f32_16x16x32_bf16 v[28:31], v[236:239], v[76:79], v[28:31]
    ds_read_b128 v[64:67], v17 offset:12288
    s_barrier
    ds_read_b128 v[88:91], v18 offset:512
    ds_read_b128 v[92:95], v18 offset:2560
    ds_read_b128 v[96:99], v18 offset:768
    ds_read_b128 v[100:103], v18 offset:2816
    s_waitcnt vmcnt(0)
    buffer_atomic_add v113, v112, s[56:59], s40 offen offset:2048 sc1
    s_waitcnt lgkmcnt(8)
    v_mfma_f32_16x16x32_bf16 v[28:31], v[240:243], v[36:39], v[28:31]
    ds_read_b128 v[68:71], v14 offset:16384
    v_mfma_f32_16x16x32_bf16 v[32:35], v[240:243], v[40:43], v[32:35]
    ds_read_b128 v[72:75], v14 offset:20480
    v_mfma_f32_16x16x32_bf16 v[32:35], v[244:247], v[48:51], v[32:35]
    ds_read_b128 v[76:79], v14 offset:24576
    v_mfma_f32_16x16x32_bf16 v[28:31], v[244:247], v[44:47], v[28:31]
    ds_read_b128 v[80:83], v14 offset:28672
    s_waitcnt lgkmcnt(8)
    v_mfma_f32_16x16x32_bf16 v[28:31], v[248:251], v[52:55], v[28:31]
    ds_read_b128 v[36:39], v15 offset:16384
    v_mfma_f32_16x16x32_bf16 v[32:35], v[248:251], v[56:59], v[32:35]
    ds_read_b128 v[40:43], v15 offset:20480
    v_mfma_f32_16x16x32_bf16 v[32:35], v[252:255], v[64:67], v[32:35]
    ds_read_b128 v[44:47], v15 offset:24576
    v_mfma_f32_16x16x32_bf16 v[28:31], v[252:255], v[60:63], v[28:31]
    ds_read_b128 v[48:51], v15 offset:28672
    s_waitcnt lgkmcnt(4)
    v_mfma_f32_16x16x32_bf16 v[20:23], v[128:131], v[68:71], 0
    ds_read_b128 v[52:55], v16 offset:16384
    v_mfma_f32_16x16x32_bf16 v[24:27], v[128:131], v[72:75], 0
    ds_read_b128 v[56:59], v16 offset:20480
    v_mfma_f32_16x16x32_bf16 v[24:27], v[132:135], v[80:83], v[24:27]
    ds_read_b128 v[60:63], v16 offset:24576
    v_mfma_f32_16x16x32_bf16 v[20:23], v[132:135], v[76:79], v[20:23]
    ds_read_b128 v[64:67], v16 offset:28672
    v_pk_fma_f32 v[28:29], v[88:89], v[84:85], v[28:29]
    v_pk_fma_f32 v[30:31], v[88:89], v[86:87], v[30:31]
    v_pk_fma_f32 v[32:33], v[96:97], v[84:85], v[32:33]
    v_pk_fma_f32 v[34:35], v[96:97], v[86:87], v[34:35]
    v_pk_mul_f32 v[104:105], v[28:29], v[28:29]
    v_pk_mul_f32 v[106:107], v[30:31], v[30:31]
    v_pk_mul_f32 v[108:109], v[32:33], v[32:33]
    v_pk_mul_f32 v[110:111], v[34:35], v[34:35]
    v_pk_fma_f32 v[104:105], v[104:105], v[92:93], v[90:91]
    v_pk_fma_f32 v[106:107], v[106:107], v[92:93], v[90:91]
    v_pk_fma_f32 v[108:109], v[108:109], v[100:101], v[98:99]
    v_pk_fma_f32 v[110:111], v[110:111], v[100:101], v[98:99]
    v_pk_mul_f32 v[104:105], v[104:105], v[28:29]
    v_pk_mul_f32 v[106:107], v[106:107], v[30:31]
    v_pk_mul_f32 v[108:109], v[108:109], v[32:33]
    v_pk_mul_f32 v[110:111], v[110:111], v[34:35]
    v_exp_f32 v104, v104
    v_exp_f32 v105, v105
    v_exp_f32 v106, v106
    v_exp_f32 v107, v107
    v_exp_f32 v108, v108
    v_exp_f32 v109, v109
    v_exp_f32 v110, v110
    v_exp_f32 v111, v111
    v_pk_fma_f32 v[104:105], v[104:105], v[94:95], v[94:95]
    v_pk_fma_f32 v[106:107], v[106:107], v[94:95], v[94:95]
    v_pk_fma_f32 v[108:109], v[108:109], v[102:103], v[102:103]
    v_pk_fma_f32 v[110:111], v[110:111], v[102:103], v[102:103]
    v_rcp_f32 v104, v104
    v_rcp_f32 v105, v105
    v_rcp_f32 v106, v106
    v_rcp_f32 v107, v107
    v_rcp_f32 v108, v108
    v_rcp_f32 v109, v109
    v_rcp_f32 v110, v110
    v_rcp_f32 v111, v111
    v_pk_mul_f32 v[28:29], v[28:29], v[104:105]
    v_pk_mul_f32 v[30:31], v[30:31], v[106:107]
    v_pk_mul_f32 v[32:33], v[32:33], v[108:109]
    v_pk_mul_f32 v[34:35], v[34:35], v[110:111]
    v_add_u32 v28, 0x10000, v28
    v_add_u32 v30, 0x10000, v30
    v_add_u32 v32, 0x10000, v32
    v_add_u32 v34, 0x10000, v34
    v_and_b32 v28, 0xfffe0000, v28
    v_and_b32 v30, 0xfffe0000, v30
    v_and_b32 v32, 0xfffe0000, v32
    v_and_b32 v34, 0xfffe0000, v34
    v_cvt_pk_bf16_f32 v104, v28, v29
    v_cvt_pk_bf16_f32 v105, v30, v31
    v_cvt_pk_bf16_f32 v106, v32, v33
    v_cvt_pk_bf16_f32 v107, v34, v35
    s_add_u32 s36, s39, 131072
    v_permlane16_swap_b32 v104, v106
    v_permlane16_swap_b32 v105, v107
    buffer_store_dwordx4 v[104:107], v114, s[16:19], s36 offen sc1
    s_waitcnt lgkmcnt(4)
    v_mfma_f32_16x16x32_bf16 v[20:23], v[136:139], v[36:39], v[20:23]
    ds_read_b128 v[68:71], v17 offset:16384
    v_mfma_f32_16x16x32_bf16 v[24:27], v[136:139], v[40:43], v[24:27]
    ds_read_b128 v[72:75], v17 offset:20480
    v_mfma_f32_16x16x32_bf16 v[24:27], v[140:143], v[48:51], v[24:27]
    ds_read_b128 v[76:79], v17 offset:24576
    v_mfma_f32_16x16x32_bf16 v[20:23], v[140:143], v[44:47], v[20:23]
    ds_read_b128 v[80:83], v17 offset:28672
    s_barrier
    s_waitcnt lgkmcnt(4)
    v_mfma_f32_16x16x32_bf16 v[20:23], v[144:147], v[52:55], v[20:23]
    ds_read_b128 v[36:39], v14 offset:32768
    v_mfma_f32_16x16x32_bf16 v[24:27], v[144:147], v[56:59], v[24:27]
    ds_read_b128 v[40:43], v14 offset:36864
    v_mfma_f32_16x16x32_bf16 v[24:27], v[148:151], v[64:67], v[24:27]
    ds_read_b128 v[44:47], v14 offset:40960
    v_mfma_f32_16x16x32_bf16 v[20:23], v[148:151], v[60:63], v[20:23]
    ds_read_b128 v[48:51], v14 offset:45056
    s_waitcnt lgkmcnt(4)
    v_mfma_f32_16x16x32_bf16 v[20:23], v[152:155], v[68:71], v[20:23]
    ds_read_b128 v[52:55], v15 offset:32768
    v_mfma_f32_16x16x32_bf16 v[24:27], v[152:155], v[72:75], v[24:27]
    ds_read_b128 v[56:59], v15 offset:36864
    v_mfma_f32_16x16x32_bf16 v[24:27], v[156:159], v[80:83], v[24:27]
    ds_read_b128 v[60:63], v15 offset:40960
    v_mfma_f32_16x16x32_bf16 v[20:23], v[156:159], v[76:79], v[20:23]
    ds_read_b128 v[64:67], v15 offset:45056
    s_waitcnt lgkmcnt(4)
    v_mfma_f32_16x16x32_bf16 v[20:23], v[160:163], v[36:39], v[20:23]
    ds_read_b128 v[68:71], v16 offset:32768
    v_mfma_f32_16x16x32_bf16 v[24:27], v[160:163], v[40:43], v[24:27]
    ds_read_b128 v[72:75], v16 offset:36864
    v_mfma_f32_16x16x32_bf16 v[24:27], v[164:167], v[48:51], v[24:27]
    ds_read_b128 v[76:79], v16 offset:40960
    v_mfma_f32_16x16x32_bf16 v[20:23], v[164:167], v[44:47], v[20:23]
    ds_read_b128 v[80:83], v16 offset:45056
    s_waitcnt lgkmcnt(4)
    v_mfma_f32_16x16x32_bf16 v[20:23], v[168:171], v[52:55], v[20:23]
    ds_read_b128 v[36:39], v17 offset:32768
    v_mfma_f32_16x16x32_bf16 v[24:27], v[168:171], v[56:59], v[24:27]
    ds_read_b128 v[40:43], v17 offset:36864
    v_mfma_f32_16x16x32_bf16 v[24:27], v[172:175], v[64:67], v[24:27]
    ds_read_b128 v[44:47], v17 offset:40960
    v_mfma_f32_16x16x32_bf16 v[20:23], v[172:175], v[60:63], v[20:23]
    ds_read_b128 v[48:51], v17 offset:45056
    s_barrier
    s_waitcnt lgkmcnt(4)
    v_mfma_f32_16x16x32_bf16 v[20:23], v[176:179], v[68:71], v[20:23]
    ds_read_b128 v[52:55], v10 offset:16384
    v_mfma_f32_16x16x32_bf16 v[24:27], v[176:179], v[72:75], v[24:27]
    ds_read_b128 v[56:59], v10 offset:20480
    v_mfma_f32_16x16x32_bf16 v[24:27], v[180:183], v[80:83], v[24:27]
    ds_read_b128 v[60:63], v10 offset:24576
    v_mfma_f32_16x16x32_bf16 v[20:23], v[180:183], v[76:79], v[20:23]
    ds_read_b128 v[64:67], v10 offset:28672
    s_waitcnt lgkmcnt(4)
    v_mfma_f32_16x16x32_bf16 v[20:23], v[184:187], v[36:39], v[20:23]
    ds_read_b128 v[68:71], v11 offset:16384
    v_mfma_f32_16x16x32_bf16 v[24:27], v[184:187], v[40:43], v[24:27]
    ds_read_b128 v[72:75], v11 offset:20480
    v_mfma_f32_16x16x32_bf16 v[24:27], v[188:191], v[48:51], v[24:27]
    ds_read_b128 v[76:79], v11 offset:24576
    v_mfma_f32_16x16x32_bf16 v[20:23], v[188:191], v[44:47], v[20:23]
    ds_read_b128 v[80:83], v11 offset:28672
    s_waitcnt lgkmcnt(4)
    v_mfma_f32_16x16x32_bf16 v[20:23], v[192:195], v[52:55], v[20:23]
    ds_read_b128 v[36:39], v12 offset:16384
    v_mfma_f32_16x16x32_bf16 v[24:27], v[192:195], v[56:59], v[24:27]
    ds_read_b128 v[40:43], v12 offset:20480
    v_mfma_f32_16x16x32_bf16 v[24:27], v[196:199], v[64:67], v[24:27]
    ds_read_b128 v[44:47], v12 offset:24576
    v_mfma_f32_16x16x32_bf16 v[20:23], v[196:199], v[60:63], v[20:23]
    ds_read_b128 v[48:51], v12 offset:28672
    s_waitcnt lgkmcnt(4)
    v_mfma_f32_16x16x32_bf16 v[20:23], v[200:203], v[68:71], v[20:23]
    ds_read_b128 v[52:55], v13 offset:16384
    v_mfma_f32_16x16x32_bf16 v[24:27], v[200:203], v[72:75], v[24:27]
    ds_read_b128 v[56:59], v13 offset:20480
    v_mfma_f32_16x16x32_bf16 v[24:27], v[204:207], v[80:83], v[24:27]
    ds_read_b128 v[60:63], v13 offset:24576
    v_mfma_f32_16x16x32_bf16 v[20:23], v[204:207], v[76:79], v[20:23]
    ds_read_b128 v[64:67], v13 offset:28672
    s_barrier
    s_waitcnt lgkmcnt(4)
    v_mfma_f32_16x16x32_bf16 v[20:23], v[208:211], v[36:39], v[20:23]
    ds_read_b128 v[68:71], v10 offset:32768
    v_mfma_f32_16x16x32_bf16 v[24:27], v[208:211], v[40:43], v[24:27]
    ds_read_b128 v[72:75], v10 offset:36864
    v_mfma_f32_16x16x32_bf16 v[24:27], v[212:215], v[48:51], v[24:27]
    ds_read_b128 v[76:79], v10 offset:40960
    v_mfma_f32_16x16x32_bf16 v[20:23], v[212:215], v[44:47], v[20:23]
    ds_read_b128 v[80:83], v10 offset:45056
    s_waitcnt lgkmcnt(4)
    v_mfma_f32_16x16x32_bf16 v[20:23], v[216:219], v[52:55], v[20:23]
    ds_read_b128 v[36:39], v11 offset:32768
    v_mfma_f32_16x16x32_bf16 v[24:27], v[216:219], v[56:59], v[24:27]
    ds_read_b128 v[40:43], v11 offset:36864
    v_mfma_f32_16x16x32_bf16 v[24:27], v[220:223], v[64:67], v[24:27]
    ds_read_b128 v[44:47], v11 offset:40960
    v_mfma_f32_16x16x32_bf16 v[20:23], v[220:223], v[60:63], v[20:23]
    ds_read_b128 v[48:51], v11 offset:45056
    s_waitcnt lgkmcnt(4)
    v_mfma_f32_16x16x32_bf16 v[20:23], v[224:227], v[68:71], v[20:23]
    ds_read_b128 v[52:55], v12 offset:32768
    v_mfma_f32_16x16x32_bf16 v[24:27], v[224:227], v[72:75], v[24:27]
    ds_read_b128 v[56:59], v12 offset:36864
    v_mfma_f32_16x16x32_bf16 v[24:27], v[228:231], v[80:83], v[24:27]
    ds_read_b128 v[60:63], v12 offset:40960
    v_mfma_f32_16x16x32_bf16 v[20:23], v[228:231], v[76:79], v[20:23]
    ds_read_b128 v[64:67], v12 offset:45056
    s_waitcnt lgkmcnt(4)
    v_mfma_f32_16x16x32_bf16 v[20:23], v[232:235], v[36:39], v[20:23]
    ds_read_b128 v[68:71], v13 offset:32768
    v_mfma_f32_16x16x32_bf16 v[24:27], v[232:235], v[40:43], v[24:27]
    ds_read_b128 v[72:75], v13 offset:36864
    v_mfma_f32_16x16x32_bf16 v[24:27], v[236:239], v[48:51], v[24:27]
    ds_read_b128 v[76:79], v13 offset:40960
    v_mfma_f32_16x16x32_bf16 v[20:23], v[236:239], v[44:47], v[20:23]
    ds_read_b128 v[80:83], v13 offset:45056
    s_barrier
    ds_read_b128 v[88:91], v18 offset:1024
    ds_read_b128 v[92:95], v18 offset:3072
    ds_read_b128 v[96:99], v18 offset:1280
    ds_read_b128 v[100:103], v18 offset:3328
    s_waitcnt vmcnt(0)
    buffer_atomic_add v113, v112, s[56:59], s40 offen offset:2560 sc1
    s_waitcnt lgkmcnt(8)
    v_mfma_f32_16x16x32_bf16 v[20:23], v[240:243], v[52:55], v[20:23]
    ds_read_b128 v[36:39], v14 offset:0
    v_mfma_f32_16x16x32_bf16 v[24:27], v[240:243], v[56:59], v[24:27]
    ds_read_b128 v[40:43], v14 offset:4096
    v_mfma_f32_16x16x32_bf16 v[24:27], v[244:247], v[64:67], v[24:27]
    ds_read_b128 v[44:47], v14 offset:8192
    v_mfma_f32_16x16x32_bf16 v[20:23], v[244:247], v[60:63], v[20:23]
    ds_read_b128 v[48:51], v14 offset:12288
    s_waitcnt lgkmcnt(8)
    v_mfma_f32_16x16x32_bf16 v[20:23], v[248:251], v[68:71], v[20:23]
    ds_read_b128 v[52:55], v15 offset:0
    v_mfma_f32_16x16x32_bf16 v[24:27], v[248:251], v[72:75], v[24:27]
    ds_read_b128 v[56:59], v15 offset:4096
    v_mfma_f32_16x16x32_bf16 v[24:27], v[252:255], v[80:83], v[24:27]
    ds_read_b128 v[60:63], v15 offset:8192
    v_mfma_f32_16x16x32_bf16 v[20:23], v[252:255], v[76:79], v[20:23]
    ds_read_b128 v[64:67], v15 offset:12288
    s_waitcnt lgkmcnt(4)
    v_mfma_f32_16x16x32_bf16 v[28:31], v[128:131], v[36:39], 0
    ds_read_b128 v[68:71], v16 offset:0
    v_mfma_f32_16x16x32_bf16 v[32:35], v[128:131], v[40:43], 0
    ds_read_b128 v[72:75], v16 offset:4096
    v_mfma_f32_16x16x32_bf16 v[32:35], v[132:135], v[48:51], v[32:35]
    ds_read_b128 v[76:79], v16 offset:8192
    v_mfma_f32_16x16x32_bf16 v[28:31], v[132:135], v[44:47], v[28:31]
    ds_read_b128 v[80:83], v16 offset:12288
    v_pk_fma_f32 v[20:21], v[88:89], v[84:85], v[20:21]
    v_pk_fma_f32 v[22:23], v[88:89], v[86:87], v[22:23]
    v_pk_fma_f32 v[24:25], v[96:97], v[84:85], v[24:25]
    v_pk_fma_f32 v[26:27], v[96:97], v[86:87], v[26:27]
    v_pk_mul_f32 v[104:105], v[20:21], v[20:21]
    v_pk_mul_f32 v[106:107], v[22:23], v[22:23]
    v_pk_mul_f32 v[108:109], v[24:25], v[24:25]
    v_pk_mul_f32 v[110:111], v[26:27], v[26:27]
    v_pk_fma_f32 v[104:105], v[104:105], v[92:93], v[90:91]
    v_pk_fma_f32 v[106:107], v[106:107], v[92:93], v[90:91]
    v_pk_fma_f32 v[108:109], v[108:109], v[100:101], v[98:99]
    v_pk_fma_f32 v[110:111], v[110:111], v[100:101], v[98:99]
    v_pk_mul_f32 v[104:105], v[104:105], v[20:21]
    v_pk_mul_f32 v[106:107], v[106:107], v[22:23]
    v_pk_mul_f32 v[108:109], v[108:109], v[24:25]
    v_pk_mul_f32 v[110:111], v[110:111], v[26:27]
    v_exp_f32 v104, v104
    v_exp_f32 v105, v105
    v_exp_f32 v106, v106
    v_exp_f32 v107, v107
    v_exp_f32 v108, v108
    v_exp_f32 v109, v109
    v_exp_f32 v110, v110
    v_exp_f32 v111, v111
    v_pk_fma_f32 v[104:105], v[104:105], v[94:95], v[94:95]
    v_pk_fma_f32 v[106:107], v[106:107], v[94:95], v[94:95]
    v_pk_fma_f32 v[108:109], v[108:109], v[102:103], v[102:103]
    v_pk_fma_f32 v[110:111], v[110:111], v[102:103], v[102:103]
    v_rcp_f32 v104, v104
    v_rcp_f32 v105, v105
    v_rcp_f32 v106, v106
    v_rcp_f32 v107, v107
    v_rcp_f32 v108, v108
    v_rcp_f32 v109, v109
    v_rcp_f32 v110, v110
    v_rcp_f32 v111, v111
    v_pk_mul_f32 v[20:21], v[20:21], v[104:105]
    v_pk_mul_f32 v[22:23], v[22:23], v[106:107]
    v_pk_mul_f32 v[24:25], v[24:25], v[108:109]
    v_pk_mul_f32 v[26:27], v[26:27], v[110:111]
    v_add_u32 v20, 0x10000, v20
    v_add_u32 v22, 0x10000, v22
    v_add_u32 v24, 0x10000, v24
    v_add_u32 v26, 0x10000, v26
    v_and_b32 v20, 0xfffe0000, v20
    v_and_b32 v22, 0xfffe0000, v22
    v_and_b32 v24, 0xfffe0000, v24
    v_and_b32 v26, 0xfffe0000, v26
    v_cvt_pk_bf16_f32 v104, v20, v21
    v_cvt_pk_bf16_f32 v105, v22, v23
    v_cvt_pk_bf16_f32 v106, v24, v25
    v_cvt_pk_bf16_f32 v107, v26, v27
    s_add_u32 s36, s39, 262144
    v_permlane16_swap_b32 v104, v106
    v_permlane16_swap_b32 v105, v107
    buffer_store_dwordx4 v[104:107], v114, s[16:19], s36 offen sc1
    s_waitcnt lgkmcnt(4)
    v_mfma_f32_16x16x32_bf16 v[28:31], v[136:139], v[52:55], v[28:31]
    ds_read_b128 v[36:39], v17 offset:0
    v_mfma_f32_16x16x32_bf16 v[32:35], v[136:139], v[56:59], v[32:35]
    ds_read_b128 v[40:43], v17 offset:4096
    v_mfma_f32_16x16x32_bf16 v[32:35], v[140:143], v[64:67], v[32:35]
    ds_read_b128 v[44:47], v17 offset:8192
    v_mfma_f32_16x16x32_bf16 v[28:31], v[140:143], v[60:63], v[28:31]
    ds_read_b128 v[48:51], v17 offset:12288
    s_barrier
    s_waitcnt lgkmcnt(4)
    v_mfma_f32_16x16x32_bf16 v[28:31], v[144:147], v[68:71], v[28:31]
    ds_read_b128 v[52:55], v14 offset:16384
    v_mfma_f32_16x16x32_bf16 v[32:35], v[144:147], v[72:75], v[32:35]
    ds_read_b128 v[56:59], v14 offset:20480
    v_mfma_f32_16x16x32_bf16 v[32:35], v[148:151], v[80:83], v[32:35]
    ds_read_b128 v[60:63], v14 offset:24576
    v_mfma_f32_16x16x32_bf16 v[28:31], v[148:151], v[76:79], v[28:31]
    ds_read_b128 v[64:67], v14 offset:28672
    s_waitcnt lgkmcnt(4)
    v_mfma_f32_16x16x32_bf16 v[28:31], v[152:155], v[36:39], v[28:31]
    ds_read_b128 v[68:71], v15 offset:16384
    v_mfma_f32_16x16x32_bf16 v[32:35], v[152:155], v[40:43], v[32:35]
    ds_read_b128 v[72:75], v15 offset:20480
    v_mfma_f32_16x16x32_bf16 v[32:35], v[156:159], v[48:51], v[32:35]
    ds_read_b128 v[76:79], v15 offset:24576
    v_mfma_f32_16x16x32_bf16 v[28:31], v[156:159], v[44:47], v[28:31]
    ds_read_b128 v[80:83], v15 offset:28672
    s_waitcnt lgkmcnt(4)
    v_mfma_f32_16x16x32_bf16 v[28:31], v[160:163], v[52:55], v[28:31]
    ds_read_b128 v[36:39], v16 offset:16384
    v_mfma_f32_16x16x32_bf16 v[32:35], v[160:163], v[56:59], v[32:35]
    ds_read_b128 v[40:43], v16 offset:20480
    v_mfma_f32_16x16x32_bf16 v[32:35], v[164:167], v[64:67], v[32:35]
    ds_read_b128 v[44:47], v16 offset:24576
    v_mfma_f32_16x16x32_bf16 v[28:31], v[164:167], v[60:63], v[28:31]
    ds_read_b128 v[48:51], v16 offset:28672
    s_waitcnt lgkmcnt(4)
    v_mfma_f32_16x16x32_bf16 v[28:31], v[168:171], v[68:71], v[28:31]
    ds_read_b128 v[52:55], v17 offset:16384
    v_mfma_f32_16x16x32_bf16 v[32:35], v[168:171], v[72:75], v[32:35]
    ds_read_b128 v[56:59], v17 offset:20480
    v_mfma_f32_16x16x32_bf16 v[32:35], v[172:175], v[80:83], v[32:35]
    ds_read_b128 v[60:63], v17 offset:24576
    v_mfma_f32_16x16x32_bf16 v[28:31], v[172:175], v[76:79], v[28:31]
    ds_read_b128 v[64:67], v17 offset:28672
    s_barrier
    s_waitcnt lgkmcnt(4)
    v_mfma_f32_16x16x32_bf16 v[28:31], v[176:179], v[36:39], v[28:31]
    ds_read_b128 v[68:71], v14 offset:32768
    v_mfma_f32_16x16x32_bf16 v[32:35], v[176:179], v[40:43], v[32:35]
    ds_read_b128 v[72:75], v14 offset:36864
    v_mfma_f32_16x16x32_bf16 v[32:35], v[180:183], v[48:51], v[32:35]
    ds_read_b128 v[76:79], v14 offset:40960
    v_mfma_f32_16x16x32_bf16 v[28:31], v[180:183], v[44:47], v[28:31]
    ds_read_b128 v[80:83], v14 offset:45056
    s_waitcnt lgkmcnt(4)
    v_mfma_f32_16x16x32_bf16 v[28:31], v[184:187], v[52:55], v[28:31]
    ds_read_b128 v[36:39], v15 offset:32768
    v_mfma_f32_16x16x32_bf16 v[32:35], v[184:187], v[56:59], v[32:35]
    ds_read_b128 v[40:43], v15 offset:36864
    v_mfma_f32_16x16x32_bf16 v[32:35], v[188:191], v[64:67], v[32:35]
    ds_read_b128 v[44:47], v15 offset:40960
    v_mfma_f32_16x16x32_bf16 v[28:31], v[188:191], v[60:63], v[28:31]
    ds_read_b128 v[48:51], v15 offset:45056
    s_waitcnt lgkmcnt(4)
    v_mfma_f32_16x16x32_bf16 v[28:31], v[192:195], v[68:71], v[28:31]
    ds_read_b128 v[52:55], v16 offset:32768
    v_mfma_f32_16x16x32_bf16 v[32:35], v[192:195], v[72:75], v[32:35]
    ds_read_b128 v[56:59], v16 offset:36864
    v_mfma_f32_16x16x32_bf16 v[32:35], v[196:199], v[80:83], v[32:35]
    ds_read_b128 v[60:63], v16 offset:40960
    v_mfma_f32_16x16x32_bf16 v[28:31], v[196:199], v[76:79], v[28:31]
    ds_read_b128 v[64:67], v16 offset:45056
    s_waitcnt lgkmcnt(4)
    v_mfma_f32_16x16x32_bf16 v[28:31], v[200:203], v[36:39], v[28:31]
    ds_read_b128 v[68:71], v17 offset:32768
    v_mfma_f32_16x16x32_bf16 v[32:35], v[200:203], v[40:43], v[32:35]
    ds_read_b128 v[72:75], v17 offset:36864
    v_mfma_f32_16x16x32_bf16 v[32:35], v[204:207], v[48:51], v[32:35]
    ds_read_b128 v[76:79], v17 offset:40960
    v_mfma_f32_16x16x32_bf16 v[28:31], v[204:207], v[44:47], v[28:31]
    ds_read_b128 v[80:83], v17 offset:45056
    s_barrier
    s_waitcnt lgkmcnt(4)
    v_mfma_f32_16x16x32_bf16 v[28:31], v[208:211], v[52:55], v[28:31]
    ds_read_b128 v[36:39], v10 offset:16384
    v_mfma_f32_16x16x32_bf16 v[32:35], v[208:211], v[56:59], v[32:35]
    ds_read_b128 v[40:43], v10 offset:20480
    v_mfma_f32_16x16x32_bf16 v[32:35], v[212:215], v[64:67], v[32:35]
    ds_read_b128 v[44:47], v10 offset:24576
    v_mfma_f32_16x16x32_bf16 v[28:31], v[212:215], v[60:63], v[28:31]
    ds_read_b128 v[48:51], v10 offset:28672
    s_waitcnt lgkmcnt(4)
    v_mfma_f32_16x16x32_bf16 v[28:31], v[216:219], v[68:71], v[28:31]
    ds_read_b128 v[52:55], v11 offset:16384
    v_mfma_f32_16x16x32_bf16 v[32:35], v[216:219], v[72:75], v[32:35]
    ds_read_b128 v[56:59], v11 offset:20480
    v_mfma_f32_16x16x32_bf16 v[32:35], v[220:223], v[80:83], v[32:35]
    ds_read_b128 v[60:63], v11 offset:24576
    v_mfma_f32_16x16x32_bf16 v[28:31], v[220:223], v[76:79], v[28:31]
    ds_read_b128 v[64:67], v11 offset:28672
    s_waitcnt vmcnt(0)
    buffer_atomic_add v113, v112, s[56:59], s40 offen offset:3072 sc1
    s_waitcnt lgkmcnt(4)
    v_mfma_f32_16x16x32_bf16 v[28:31], v[224:227], v[36:39], v[28:31]
    ds_read_b128 v[68:71], v12 offset:16384
    v_mfma_f32_16x16x32_bf16 v[32:35], v[224:227], v[40:43], v[32:35]
    ds_read_b128 v[72:75], v12 offset:20480
    v_mfma_f32_16x16x32_bf16 v[32:35], v[228:231], v[48:51], v[32:35]
    ds_read_b128 v[76:79], v12 offset:24576
    v_mfma_f32_16x16x32_bf16 v[28:31], v[228:231], v[44:47], v[28:31]
    ds_read_b128 v[80:83], v12 offset:28672
    s_waitcnt lgkmcnt(4)
    v_mfma_f32_16x16x32_bf16 v[28:31], v[232:235], v[52:55], v[28:31]
    ds_read_b128 v[36:39], v13 offset:16384
    v_mfma_f32_16x16x32_bf16 v[32:35], v[232:235], v[56:59], v[32:35]
    ds_read_b128 v[40:43], v13 offset:20480
    v_mfma_f32_16x16x32_bf16 v[32:35], v[236:239], v[64:67], v[32:35]
    ds_read_b128 v[44:47], v13 offset:24576
    v_mfma_f32_16x16x32_bf16 v[28:31], v[236:239], v[60:63], v[28:31]
    ds_read_b128 v[48:51], v13 offset:28672
    s_barrier
    ds_read_b128 v[88:91], v18 offset:1536
    ds_read_b128 v[92:95], v18 offset:3584
    ds_read_b128 v[96:99], v18 offset:1792
    ds_read_b128 v[100:103], v18 offset:3840
    s_waitcnt lgkmcnt(8)
    v_mfma_f32_16x16x32_bf16 v[28:31], v[240:243], v[68:71], v[28:31]
    v_mfma_f32_16x16x32_bf16 v[32:35], v[240:243], v[72:75], v[32:35]
    v_mfma_f32_16x16x32_bf16 v[32:35], v[244:247], v[80:83], v[32:35]
    v_mfma_f32_16x16x32_bf16 v[28:31], v[244:247], v[76:79], v[28:31]
    s_waitcnt lgkmcnt(4)
    v_mfma_f32_16x16x32_bf16 v[28:31], v[248:251], v[36:39], v[28:31]
    v_mfma_f32_16x16x32_bf16 v[32:35], v[248:251], v[40:43], v[32:35]
    v_mfma_f32_16x16x32_bf16 v[32:35], v[252:255], v[48:51], v[32:35]
    v_mfma_f32_16x16x32_bf16 v[28:31], v[252:255], v[44:47], v[28:31]
    s_setprio 1
    s_waitcnt lgkmcnt(0)
    s_load_dword s32, s[4:5], s20 offset:2560
    s_load_dword s3, s[4:5], s20 offset:2688
    s_add_u32 m0, s12, 139264
    s_add_u32 s49, s11, 0
    buffer_load_dwordx4 v2, s[16:19], s49 offen offset:0 sc1 lds
    buffer_load_dwordx4 v2, s[16:19], s49 offen offset:1024 sc1 lds
    buffer_load_dwordx4 v2, s[16:19], s49 offen offset:2048 sc1 lds
    buffer_load_dwordx4 v2, s[16:19], s49 offen offset:3072 sc1 lds
    v_pk_fma_f32 v[28:29], v[88:89], v[84:85], v[28:29]
    v_pk_fma_f32 v[30:31], v[88:89], v[86:87], v[30:31]
    v_pk_fma_f32 v[32:33], v[96:97], v[84:85], v[32:33]
    v_pk_fma_f32 v[34:35], v[96:97], v[86:87], v[34:35]
    v_pk_mul_f32 v[104:105], v[28:29], v[28:29]
    v_pk_mul_f32 v[106:107], v[30:31], v[30:31]
    v_pk_mul_f32 v[108:109], v[32:33], v[32:33]
    v_pk_mul_f32 v[110:111], v[34:35], v[34:35]
    v_pk_fma_f32 v[104:105], v[104:105], v[92:93], v[90:91]
    v_pk_fma_f32 v[106:107], v[106:107], v[92:93], v[90:91]
    v_pk_fma_f32 v[108:109], v[108:109], v[100:101], v[98:99]
    v_pk_fma_f32 v[110:111], v[110:111], v[100:101], v[98:99]
    v_pk_mul_f32 v[104:105], v[104:105], v[28:29]
    v_pk_mul_f32 v[106:107], v[106:107], v[30:31]
    v_pk_mul_f32 v[108:109], v[108:109], v[32:33]
    v_pk_mul_f32 v[110:111], v[110:111], v[34:35]
    v_exp_f32 v104, v104
    v_exp_f32 v105, v105
    v_exp_f32 v106, v106
    v_exp_f32 v107, v107
    v_exp_f32 v108, v108
    v_exp_f32 v109, v109
    v_exp_f32 v110, v110
    v_exp_f32 v111, v111
    v_pk_fma_f32 v[104:105], v[104:105], v[94:95], v[94:95]
    v_pk_fma_f32 v[106:107], v[106:107], v[94:95], v[94:95]
    v_pk_fma_f32 v[108:109], v[108:109], v[102:103], v[102:103]
    v_pk_fma_f32 v[110:111], v[110:111], v[102:103], v[102:103]
    v_rcp_f32 v104, v104
    v_rcp_f32 v105, v105
    v_rcp_f32 v106, v106
    v_rcp_f32 v107, v107
    v_rcp_f32 v108, v108
    v_rcp_f32 v109, v109
    v_rcp_f32 v110, v110
    v_rcp_f32 v111, v111
    v_pk_mul_f32 v[28:29], v[28:29], v[104:105]
    v_pk_mul_f32 v[30:31], v[30:31], v[106:107]
    v_pk_mul_f32 v[32:33], v[32:33], v[108:109]
    v_pk_mul_f32 v[34:35], v[34:35], v[110:111]
    v_add_u32 v28, 0x10000, v28
    v_add_u32 v30, 0x10000, v30
    v_add_u32 v32, 0x10000, v32
    v_add_u32 v34, 0x10000, v34
    v_and_b32 v28, 0xfffe0000, v28
    v_and_b32 v30, 0xfffe0000, v30
    v_and_b32 v32, 0xfffe0000, v32
    v_and_b32 v34, 0xfffe0000, v34
    v_cvt_pk_bf16_f32 v104, v28, v29
    v_cvt_pk_bf16_f32 v105, v30, v31
    v_cvt_pk_bf16_f32 v106, v32, v33
    v_cvt_pk_bf16_f32 v107, v34, v35
    s_add_u32 s36, s39, 393216
    v_permlane16_swap_b32 v104, v106
    v_permlane16_swap_b32 v105, v107
    buffer_store_dwordx4 v[104:107], v114, s[16:19], s36 offen sc1
    s_add_u32 m0, s12, 16384
    s_add_u32 s49, s8, 131072
    s_barrier
    s_waitcnt lgkmcnt(0)
    s_cmp_eq_u32 s32, s21
    s_cselect_b32 s32, s3, 0
    s_cmp_eq_u32 s32, s21
    s_cbranch_scc1 hok_11
    s_add_u32 s53, s20, 2560
    v_lshlrev_b32 v85, 7, v1
    v_add_u32 v85, s53, v85
    s_mov_b32 s53, 0
    s_add_u32 s54, s52, 16
    s_bfm_b64 exec, 2, 0
poll_12:
    buffer_load_dword v84, v85, s[56:59], 0 offen sc1
    s_waitcnt vmcnt(0)
    v_cmp_eq_u32 vcc, s54, v84
    s_nop 0
    s_cmp_eq_u64 vcc, exec
    s_cbranch_scc1 pok_13
    s_sleep 8
    s_add_u32 s53, s53, 1
    s_cmp_lt_u32 s53, s61
    s_cbranch_scc1 poll_12
    s_mov_b32 s61, 0
pok_13:
    s_mov_b64 exec, -1
hok_11:
    buffer_load_dwordx4 v2, s[16:19], s49 offen offset:0 sc1 lds
    buffer_load_dwordx4 v2, s[16:19], s49 offen offset:1024 sc1 lds
    buffer_load_dwordx4 v2, s[16:19], s49 offen offset:2048 sc1 lds
    buffer_load_dwordx4 v2, s[16:19], s49 offen offset:3072 sc1 lds
    s_add_u32 m0, s12, 32768
    s_add_u32 s49, s9, 131072
    s_barrier
    buffer_load_dwordx4 v2, s[16:19], s49 offen offset:0 sc1 lds
    buffer_load_dwordx4 v2, s[16:19], s49 offen offset:1024 sc1 lds
    buffer_load_dwordx4 v2, s[16:19], s49 offen offset:2048 sc1 lds
    buffer_load_dwordx4 v2, s[16:19], s49 offen offset:3072 sc1 lds
    s_add_u32 m0, s12, 106496
    s_add_u32 s49, s10, 131072
    s_waitcnt vmcnt(9)
    s_barrier
    s_waitcnt vmcnt(8)
    buffer_atomic_add v113, v112, s[56:59], s40 offen offset:3584 sc1
    buffer_load_dwordx4 v2, s[16:19], s49 offen offset:0 sc1 lds
    buffer_load_dwordx4 v2, s[16:19], s49 offen offset:1024 sc1 lds
    buffer_load_dwordx4 v2, s[16:19], s49 offen offset:2048 sc1 lds
    buffer_load_dwordx4 v2, s[16:19], s49 offen offset:3072 sc1 lds
    s_add_u32 m0, s12, 122880
    s_add_u32 s49, s11, 131072
    s_waitcnt vmcnt(9)
    s_barrier
    s_load_dword s32, s[4:5], s20 offset:3072
    s_load_dword s3, s[4:5], s20 offset:3200
    buffer_load_dwordx4 v2, s[16:19], s49 offen offset:0 sc1 lds
    buffer_load_dwordx4 v2, s[16:19], s49 offen offset:1024 sc1 lds
    buffer_load_dwordx4 v2, s[16:19], s49 offen offset:2048 sc1 lds
    buffer_load_dwordx4 v2, s[16:19], s49 offen offset:3072 sc1 lds
    s_add_u32 m0, s12, 139264
    s_add_u32 s49, s8, 262144
    s_waitcnt vmcnt(9)
    s_barrier
    s_waitcnt lgkmcnt(0)
    s_cmp_eq_u32 s32, s21
    s_cselect_b32 s32, s3, 0
    s_cmp_eq_u32 s32, s21
    s_cbranch_scc1 hok_14
    s_add_u32 s53, s20, 3072
    v_lshlrev_b32 v85, 7, v1
    v_add_u32 v85, s53, v85
    s_mov_b32 s53, 0
    s_add_u32 s54, s52, 16
    s_bfm_b64 exec, 2, 0
poll_15:
    buffer_load_dword v84, v85, s[56:59], 0 offen sc1
    s_waitcnt vmcnt(0)
    v_cmp_eq_u32 vcc, s54, v84
    s_nop 0
    s_cmp_eq_u64 vcc, exec
    s_cbranch_scc1 pok_16
    s_sleep 8
    s_add_u32 s53, s53, 1
    s_cmp_lt_u32 s53, s61
    s_cbranch_scc1 poll_15
    s_mov_b32 s61, 0
pok_16:
    s_mov_b64 exec, -1
hok_14:
    buffer_load_dwordx4 v2, s[16:19], s49 offen offset:0 sc1 lds
    buffer_load_dwordx4 v2, s[16:19], s49 offen offset:1024 sc1 lds
    buffer_load_dwordx4 v2, s[16:19], s49 offen offset:2048 sc1 lds
    buffer_load_dwordx4 v2, s[16:19], s49 offen offset:3072 sc1 lds
    s_add_u32 m0, s12, 16384
    s_add_u32 s49, s9, 262144
    s_waitcnt vmcnt(8)
    s_barrier
    buffer_load_dwordx4 v2, s[16:19], s49 offen offset:0 sc1 lds
    buffer_load_dwordx4 v2, s[16:19], s49 offen offset:1024 sc1 lds
    buffer_load_dwordx4 v2, s[16:19], s49 offen offset:2048 sc1 lds
    buffer_load_dwordx4 v2, s[16:19], s49 offen offset:3072 sc1 lds
    s_add_u32 m0, s12, 32768
    s_add_u32 s49, s10, 262144
    s_waitcnt vmcnt(8)
    s_barrier
    buffer_load_dwordx4 v2, s[16:19], s49 offen offset:0 sc1 lds
    buffer_load_dwordx4 v2, s[16:19], s49 offen offset:1024 sc1 lds
    buffer_load_dwordx4 v2, s[16:19], s49 offen offset:2048 sc1 lds
    buffer_load_dwordx4 v2, s[16:19], s49 offen offset:3072 sc1 lds
    s_add_u32 m0, s12, 106496
    s_add_u32 s49, s11, 262144
    s_waitcnt vmcnt(8)
    s_barrier
    s_load_dword s32, s[4:5], s20 offset:3584
    s_load_dword s3, s[4:5], s20 offset:3712
    buffer_load_dwordx4 v2, s[16:19], s49 offen offset:0 sc1 lds
    buffer_load_dwordx4 v2, s[16:19], s49 offen offset:1024 sc1 lds
    buffer_load_dwordx4 v2, s[16:19], s49 offen offset:2048 sc1 lds
    buffer_load_dwordx4 v2, s[16:19], s49 offen offset:3072 sc1 lds
    s_add_u32 m0, s12, 122880
    s_add_u32 s49, s8, 393216
    s_waitcnt vmcnt(8)
    s_barrier
    s_waitcnt lgkmcnt(0)
    s_cmp_eq_u32 s32, s21
    s_cselect_b32 s32, s3, 0
    s_cmp_eq_u32 s32, s21
    s_cbranch_scc1 hok_17
    s_add_u32 s53, s20, 3584
    v_lshlrev_b32 v85, 7, v1
    v_add_u32 v85, s53, v85
    s_mov_b32 s53, 0
    s_add_u32 s54, s52, 16
    s_bfm_b64 exec, 2, 0
poll_18:
    buffer_load_dword v84, v85, s[56:59], 0 offen sc1
    s_waitcnt vmcnt(0)
    v_cmp_eq_u32 vcc, s54, v84
    s_nop 0
    s_cmp_eq_u64 vcc, exec
    s_cbranch_scc1 pok_19
    s_sleep 8
    s_add_u32 s53, s53, 1
    s_cmp_lt_u32 s53, s61
    s_cbranch_scc1 poll_18
    s_mov_b32 s61, 0
pok_19:
    s_mov_b64 exec, -1
hok_17:
    buffer_load_dwordx4 v2, s[16:19], s49 offen offset:0 sc1 lds
    buffer_load_dwordx4 v2, s[16:19], s49 offen offset:1024 sc1 lds
    buffer_load_dwordx4 v2, s[16:19], s49 offen offset:2048 sc1 lds
    buffer_load_dwordx4 v2, s[16:19], s49 offen offset:3072 sc1 lds
    s_add_u32 m0, s12, 139264
    s_add_u32 s49, s9, 393216
    s_waitcnt vmcnt(8)
    s_barrier
    buffer_load_dwordx4 v2, s[16:19], s49 offen offset:0 sc1 lds
    buffer_load_dwordx4 v2, s[16:19], s49 offen offset:1024 sc1 lds
    buffer_load_dwordx4 v2, s[16:19], s49 offen offset:2048 sc1 lds
    buffer_load_dwordx4 v2, s[16:19], s49 offen offset:3072 sc1 lds
    s_add_u32 m0, s12, 16384
    s_add_u32 s49, s10, 393216
    s_waitcnt vmcnt(8)
    s_barrier
    buffer_load_dwordx4 v2, s[16:19], s49 offen offset:0 sc1 lds
    buffer_load_dwordx4 v2, s[16:19], s49 offen offset:1024 sc1 lds
    buffer_load_dwordx4 v2, s[16:19], s49 offen offset:2048 sc1 lds
    buffer_load_dwordx4 v2, s[16:19], s49 offen offset:3072 sc1 lds
    s_add_u32 m0, s12, 32768
    s_add_u32 s49, s11, 393216
    s_waitcnt vmcnt(8)
    s_barrier
    buffer_load_dwordx4 v2, s[16:19], s49 offen offset:0 sc1 lds
    buffer_load_dwordx4 v2, s[16:19], s49 offen offset:1024 sc1 lds
    buffer_load_dwordx4 v2, s[16:19], s49 offen offset:2048 sc1 lds
    buffer_load_dwordx4 v2, s[16:19], s49 offen offset:3072 sc1 lds
    s_waitcnt vmcnt(8)
    s_barrier
    s_lshr_b32 s34, s30, 1
    s_and_b32 s35, s30, 1
    v_and_b32 v22, 15, v1
    v_lshrrev_b32 v23, 4, v1
    s_mul_i32 s37, s34, 4
    s_mul_i32 s36, s34, 8192
    v_add_u32 v12, s36, v2
    v_lshrrev_b32 v18, 2, v1
    v_mul_u32_u24 v13, 448, v18
    v_and_b32 v19, 3, v1
    v_lshl_add_u32 v13, v19, 3, v13
    v_add_u32 v13, 49152, v13
    v_mul_u32_u24 v15, 448, v18
    v_and_b32 v19, 2, v1
    v_lshl_add_u32 v15, v19, 2, v15
    v_bfe_u32 v18, v1, 4, 1
    v_and_b32 v19, 1, v1
    v_xor_b32 v19, v19, v18
    v_lshl_add_u32 v15, v19, 5, v15
    s_lshl_b32 s36, s35, 4
    s_add_u32 s36, s36, 49344
    v_add_u32 v15, s36, v15
    s_lshl_b32 s36, s35, 8
    v_add_u32 v13, s36, v13
    v_lshlrev_b32 v18, 5, v18
    v_sub_u32 v14, v13, v18
    v_add_u32 v13, v13, v18
    s_mov_b32 s42, 0
    s_mov_b32 s43, 0
    s_mov_b32 s48, 0
    v_mov_b32 v17, v12
    v_mov_b32 v18, v13
    v_mov_b32 v19, v14
    v_mov_b32 v20, v15
    s_waitcnt vmcnt(4)
    s_barrier
    s_waitcnt vmcnt(0)
    s_barrier
    s_setprio 0
    s_waitcnt lgkmcnt(0)
    s_barrier
    ds_read_b128 v[136:139], v17 offset:0
    ds_read_b128 v[140:143], v17 offset:2048
    ds_read_b128 v[144:147], v17 offset:4096
    ds_read_b128 v[148:151], v17 offset:6144
    ds_read_b64_tr_b16 v[152:153], v18 offset:0
    ds_read_b64_tr_b16 v[154:155], v18 offset:7168
    ds_read_b64_tr_b16 v[156:157], v19 offset:32
    ds_read_b64_tr_b16 v[158:159], v19 offset:7200
    ds_read_b64_tr_b16 v[160:161], v18 offset:64
    ds_read_b64_tr_b16 v[162:163], v18 offset:7232
    ds_read_b64_tr_b16 v[164:165], v19 offset:96
    ds_read_b64_tr_b16 v[166:167], v19 offset:7264
    ds_read_b64_tr_b16 v[168:169], v18 offset:128
    ds_read_b64_tr_b16 v[170:171], v18 offset:7296
    ds_read_b64_tr_b16 v[172:173], v19 offset:160
    ds_read_b64_tr_b16 v[174:175], v19 offset:7328
    ds_read_b64_tr_b16 v[176:177], v20 offset:0
    ds_read_b64_tr_b16 v[178:179], v20 offset:7168
    s_waitcnt lgkmcnt(0)
    v_mfma_f32_16x16x32_bf16 v[24:27], v[152:155], v[136:139], 0
    ds_read_b128 v[180:183], v17 offset:1024
    v_mfma_f32_16x16x32_bf16 v[52:55], v[152:155], v[140:143], 0
    ds_read_b128 v[184:187], v17 offset:3072
    v_mfma_f32_16x16x32_bf16 v[80:83], v[152:155], v[144:147], 0
    ds_read_b128 v[188:191], v17 offset:5120
    v_mfma_f32_16x16x32_bf16 v[108:111], v[152:155], v[148:151], 0
    ds_read_b128 v[192:195], v17 offset:7168
    v_mfma_f32_16x16x32_bf16 v[112:115], v[156:159], v[148:151], 0
    ds_read_b64_tr_b16 v[196:197], v18 offset:14336
    v_mfma_f32_16x16x32_bf16 v[84:87], v[156:159], v[144:147], 0
    ds_read_b64_tr_b16 v[198:199], v18 offset:21504
    v_mfma_f32_16x16x32_bf16 v[56:59], v[156:159], v[140:143], 0
    v_mfma_f32_16x16x32_bf16 v[28:31], v[156:159], v[136:139], 0
    ds_read_b64_tr_b16 v[200:201], v19 offset:14368
    v_mfma_f32_16x16x32_bf16 v[32:35], v[160:163], v[136:139], 0
    ds_read_b64_tr_b16 v[202:203], v19 offset:21536
    v_mfma_f32_16x16x32_bf16 v[60:63], v[160:163], v[140:143], 0
    ds_read_b64_tr_b16 v[204:205], v18 offset:14400
    v_mfma_f32_16x16x32_bf16 v[88:91], v[160:163], v[144:147], 0
    ds_read_b64_tr_b16 v[206:207], v18 offset:21568
    v_mfma_f32_16x16x32_bf16 v[116:119], v[160:163], v[148:151], 0
    ds_read_b64_tr_b16 v[208:209], v19 offset:14432
    v_mfma_f32_16x16x32_bf16 v[120:123], v[164:167], v[148:151], 0
    ds_read_b64_tr_b16 v[210:211], v19 offset:21600
    v_mfma_f32_16x16x32_bf16 v[92:95], v[164:167], v[144:147], 0
    v_mfma_f32_16x16x32_bf16 v[64:67], v[164:167], v[140:143], 0
    ds_read_b64_tr_b16 v[212:213], v18 offset:14464
    v_mfma_f32_16x16x32_bf16 v[36:39], v[164:167], v[136:139], 0
    ds_read_b64_tr_b16 v[214:215], v18 offset:21632
    v_mfma_f32_16x16x32_bf16 v[40:43], v[168:171], v[136:139], 0
    ds_read_b64_tr_b16 v[216:217], v19 offset:14496
    v_mfma_f32_16x16x32_bf16 v[68:71], v[168:171], v[140:143], 0
    ds_read_b64_tr_b16 v[218:219], v19 offset:21664
    v_mfma_f32_16x16x32_bf16 v[96:99], v[168:171], v[144:147], 0
    ds_read_b64_tr_b16 v[220:221], v20 offset:14336
    v_mfma_f32_16x16x32_bf16 v[124:127], v[168:171], v[148:151], 0
    ds_read_b64_tr_b16 v[222:223], v20 offset:21504
    v_mfma_f32_16x16x32_bf16 v[128:131], v[172:175], v[148:151], 0
    s_add_u32 s42, s42, 16384
    s_cmp_eq_u32 s42, 49152
    v_mfma_f32_16x16x32_bf16 v[100:103], v[172:175], v[144:147], 0
    s_cselect_b32 s42, 0, s42
    s_add_u32 s48, s48, 28672
    v_mfma_f32_16x16x32_bf16 v[72:75], v[172:175], v[140:143], 0
    s_cmp_eq_u32 s48, 86016
    s_cselect_b32 s48, 0, s48
    v_mfma_f32_16x16x32_bf16 v[44:47], v[172:175], v[136:139], 0
    v_add_u32 v17, s42, v12
    v_add_u32 v18, s48, v13
    v_mfma_f32_16x16x32_bf16 v[48:51], v[176:179], v[136:139], 0
    v_add_u32 v19, s48, v14
    v_add_u32 v20, s48, v15
    v_mfma_f32_16x16x32_bf16 v[76:79], v[176:179], v[140:143], 0
    v_mfma_f32_16x16x32_bf16 v[104:107], v[176:179], v[144:147], 0
    v_mfma_f32_16x16x32_bf16 v[132:135], v[176:179], v[148:151], 0
    s_waitcnt lgkmcnt(0)
    v_mfma_f32_16x16x32_bf16 v[24:27], v[196:199], v[180:183], v[24:27]
    v_mfma_f32_16x16x32_bf16 v[52:55], v[196:199], v[184:187], v[52:55]
    v_mfma_f32_16x16x32_bf16 v[80:83], v[196:199], v[188:191], v[80:83]
    v_mfma_f32_16x16x32_bf16 v[108:111], v[196:199], v[192:195], v[108:111]
    v_mfma_f32_16x16x32_bf16 v[112:115], v[200:203], v[192:195], v[112:115]
    v_mfma_f32_16x16x32_bf16 v[84:87], v[200:203], v[188:191], v[84:87]
    v_mfma_f32_16x16x32_bf16 v[56:59], v[200:203], v[184:187], v[56:59]
    v_mfma_f32_16x16x32_bf16 v[28:31], v[200:203], v[180:183], v[28:31]
    v_mfma_f32_16x16x32_bf16 v[32:35], v[204:207], v[180:183], v[32:35]
    v_mfma_f32_16x16x32_bf16 v[60:63], v[204:207], v[184:187], v[60:63]
    v_mfma_f32_16x16x32_bf16 v[88:91], v[204:207], v[188:191], v[88:91]
    v_mfma_f32_16x16x32_bf16 v[116:119], v[204:207], v[192:195], v[116:119]
    v_mfma_f32_16x16x32_bf16 v[120:123], v[208:211], v[192:195], v[120:123]
    v_mfma_f32_16x16x32_bf16 v[92:95], v[208:211], v[188:191], v[92:95]
    v_mfma_f32_16x16x32_bf16 v[64:67], v[208:211], v[184:187], v[64:67]
    v_mfma_f32_16x16x32_bf16 v[36:39], v[208:211], v[180:183], v[36:39]
    v_mfma_f32_16x16x32_bf16 v[40:43], v[212:215], v[180:183], v[40:43]
    v_mfma_f32_16x16x32_bf16 v[68:71], v[212:215], v[184:187], v[68:71]
    v_mfma_f32_16x16x32_bf16 v[96:99], v[212:215], v[188:191], v[96:99]
    v_mfma_f32_16x16x32_bf16 v[124:127], v[212:215], v[192:195], v[124:127]
    v_mfma_f32_16x16x32_bf16 v[128:131], v[216:219], v[192:195], v[128:131]
    s_add_u32 s43, s43, 1
    v_mfma_f32_16x16x32_bf16 v[100:103], v[216:219], v[188:191], v[100:103]
    v_mfma_f32_16x16x32_bf16 v[72:75], v[216:219], v[184:187], v[72:75]
    v_mfma_f32_16x16x32_bf16 v[44:47], v[216:219], v[180:183], v[44:47]
    v_mfma_f32_16x16x32_bf16 v[48:51], v[220:223], v[180:183], v[48:51]
    v_mfma_f32_16x16x32_bf16 v[76:79], v[220:223], v[184:187], v[76:79]
    v_mfma_f32_16x16x32_bf16 v[104:107], v[220:223], v[188:191], v[104:107]
    v_mfma_f32_16x16x32_bf16 v[132:135], v[220:223], v[192:195], v[132:135]
    s_load_dwordx2 s[6:7], s[0:1], 88
    s_mov_b32 s16, s62
    s_mov_b32 s17, s63
    s_mov_b32 s18, 0x1be000
    s_mov_b32 s19, 0x20000
    s_mul_i32 s39, s37, 229376
    s_mul_i32 s40, s29, 7
    s_lshl2_add_u32 s41, s35, s40
    s_add_u32 s36, s41, 0
    s_lshr_b32 s53, s36, 3
    s_lshl_b32 s53, s53, 14
    s_and_b32 s44, s36, 7
    s_lshl_b32 s44, s44, 10
    s_add_u32 s44, s44, s53
    s_add_u32 s44, s44, s39
    s_add_u32 s36, s41, 1
    s_lshr_b32 s53, s36, 3
    s_lshl_b32 s53, s53, 14
    s_and_b32 s45, s36, 7
    s_lshl_b32 s45, s45, 10
    s_add_u32 s45, s45, s53
    s_add_u32 s45, s45, s39
    s_add_u32 s36, s41, 2
    s_lshr_b32 s53, s36, 3
    s_lshl_b32 s53, s53, 14
    s_and_b32 s46, s36, 7
    s_lshl_b32 s46, s46, 10
    s_add_u32 s46, s46, s53
    s_add_u32 s46, s46, s39
    s_add_u32 s36, s40, 3
    s_lshr_b32 s53, s36, 3
    s_lshl_b32 s53, s53, 14
    s_and_b32 s47, s36, 7
    s_lshl_b32 s47, s47, 10
    s_add_u32 s47, s47, s53
    s_add_u32 s47, s47, s39
    s_lshl_b32 s36, s35, 9
    s_add_u32 s47, s47, s36
    s_lshl1_add_u32 s49, s31, s34
    s_lshl_b32 s49, s49, 7
    s_add_u32 s49, s49, s55
    s_add_u32 s49, s49, 0x1000
    s_lshl_b32 s86, s60, 24
    s_lshl_b32 s87, s94, 13
    s_add_u32 s86, s86, s87
    s_add_u32 s86, s86, 167772160
    s_add_u32 s84, s4, s86
    s_addc_u32 s85, s5, 0
    s_mov_b32 s86, 8380416
    s_mov_b32 s87, 0x20000
    s_add_u32 s88, s62, 0x480000
    s_addc_u32 s89, s63, 0
    s_mov_b32 s90, 0x7e000
    s_mov_b32 s91, 0x20000
    s_add_u32 s24, s62, 0x400000
    s_addc_u32 s25, s63, 0
    s_mov_b32 s26, 0x7e000
    s_mov_b32 s27, 0x20000
    s_lshl1_add_u32 s39, s33, s35
    s_lshl_b32 s36, s39, 1
    s_lshr_b32 s53, s36, 3
    s_lshl_b32 s53, s53, 14
    s_and_b32 s40, s36, 7
    s_lshl_b32 s40, s40, 10
    s_add_u32 s40, s40, s53
    s_lshl1_add_u32 s38, s31, s37
    s_lshl_b32 s36, s38, 16
    s_add_u32 s40, s40, s36
    s_add_u32 s12, s40, 65536
    s_xor_b32 s41, s40, 0x20000
    s_lshl3_add_u32 s38, s28, s38
    s_lshl_b32 s39, s39, 7
    s_lshl_b32 s13, s38, 16
    s_add_u32 s13, s13, s39
    s_add_u32 s14, s13, 65536
    s_lshl_b32 s38, s38, 15
    s_add_u32 s38, s38, s39
    s_add_u32 s39, s38, 32768
    s_mov_b32 s15, 0xffff0000
    s_lshr_b32 s53, s28, 3
    s_and_b32 s36, s28, 3
    s_lshl2_add_u32 s36, s53, s36
    s_lshl_b32 s36, s36, 19
    s_xor_b32 s53, s53, s94
    s_lshl_b32 s53, s53, 2
    s_xor_b32 s53, s53, s28
    s_and_b32 s53, s53, 4
    s_lshl_b32 s53, s53, 11
    s_add_u32 s36, s36, s53
    s_add_u32 s36, s36, 29360128
    s_add_u32 s8, s4, s36
    s_addc_u32 s9, s5, 0
    s_mov_b32 s10, 516096
    s_mov_b32 s11, 0x20000
    s_waitcnt lgkmcnt(0)
    s_mov_b32 s20, s6
    s_mov_b32 s21, s7
    s_mov_b32 s22, 0x400000
    s_mov_b32 s23, 0x20000
    v_lshrrev_b32 v254, 1, v23
    v_lshlrev_b32 v254, 8, v254
    v_lshl_add_u32 v254, v22, 4, v254
    v_and_b32 v6, 1, v23
    v_lshl_add_u32 v254, v6, 3, v254
    v_lshrrev_b32 v6, 2, v22
    v_cmp_eq_u32 vcc, v6, v23
    v_and_b32 v6, 1, v22
    v_lshlrev_b32 v6, 4, v6
    v_mov_b32 v224, 0x3f80
    v_lshlrev_b32 v6, v6, v224
    v_cndmask_b32 v6, 0, v6, vcc
    v_and_b32 v224, 2, v22
    v_cmp_eq_u32 vcc, 0, v224
    v_mov_b32 v224, 0
    v_mov_b32 v225, 0
    v_mov_b32 v228, 0
    v_mov_b32 v229, 0
    v_cndmask_b32 v226, 0, v6, vcc
    v_cndmask_b32 v227, v6, v224, vcc
    v_and_b32 v6, 3, v22
    v_lshrrev_b32 v255, 2, v22
    v_lshlrev_b32 v255, 14, v255
    v_lshl_add_u32 v255, v6, 11, v255
    v_lshl_add_u32 v255, v23, 4, v255
    v_mov_b32 v8, 1
    v_mov_b32 v9, 0x7f000000
    v_writelane_b32 v9, 0, 0
    v_and_b32 v11, 1, v23
    v_lshlrev_b32 v10, 11, v22
    v_lshl_add_u32 v10, v11, 5, v10
    v_lshrrev_b32 v11, 1, v23
    v_lshl_add_u32 v10, v11, 4, v10
    v_cmp_gt_u32 s[50:51], 8, v22
    v_lshrrev_b32 v11, 3, v22
    v_mul_u32_u24 v11, 16320, v11
    v_sub_u32 v10, v10, v11
    v_add_u32 v11, 16384, v10
    s_mul_i32 s36, s35, 448
    s_add_u32 s36, s36, 159744
    v_lshlrev_b32 v6, 4, v23
    v_add_u32 v6, s36, v6
    s_lshl_b32 s36, s34, 10
    s_add_u32 s36, s36, 160768
    v_lshlrev_b32 v7, 4, v22
    v_add_u32 v7, s36, v7
    s_lshl1_add_u32 s36, s37, s35
    s_lshl2_add_u32 s36, s31, s36
    s_lshl_b32 s36, s36, 10
    v_add_u32 v22, s36, v2
    v_xor_b32 v23, 4096, v22
    s_barrier
    ds_read_b128 v[136:139], v17 offset:0
    ds_read_b128 v[140:143], v17 offset:2048
    ds_read_b128 v[144:147], v17 offset:4096
    ds_read_b128 v[148:151], v17 offset:6144
    ds_read_b64_tr_b16 v[152:153], v18 offset:0
    ds_read_b64_tr_b16 v[154:155], v18 offset:7168
    ds_read_b64_tr_b16 v[156:157], v19 offset:32
    ds_read_b64_tr_b16 v[158:159], v19 offset:7200
    ds_read_b64_tr_b16 v[160:161], v18 offset:64
    ds_read_b64_tr_b16 v[162:163], v18 offset:7232
    ds_read_b64_tr_b16 v[164:165], v19 offset:96
    ds_read_b64_tr_b16 v[166:167], v19 offset:7264
    ds_read_b64_tr_b16 v[168:169], v18 offset:128
    ds_read_b64_tr_b16 v[170:171], v18 offset:7296
    ds_read_b64_tr_b16 v[172:173], v19 offset:160
    ds_read_b64_tr_b16 v[174:175], v19 offset:7328
    ds_read_b64_tr_b16 v[176:177], v20 offset:0
    ds_read_b64_tr_b16 v[178:179], v20 offset:7168
mm_20:
    s_waitcnt lgkmcnt(0)
    v_mfma_f32_16x16x32_bf16 v[24:27], v[152:155], v[136:139], v[24:27]
    ds_read_b128 v[180:183], v17 offset:1024
    v_mfma_f32_16x16x32_bf16 v[52:55], v[152:155], v[140:143], v[52:55]
    ds_read_b128 v[184:187], v17 offset:3072
    v_mfma_f32_16x16x32_bf16 v[80:83], v[152:155], v[144:147], v[80:83]
    ds_read_b128 v[188:191], v17 offset:5120
    v_mfma_f32_16x16x32_bf16 v[108:111], v[152:155], v[148:151], v[108:111]
    ds_read_b128 v[192:195], v17 offset:7168
    v_mfma_f32_16x16x32_bf16 v[112:115], v[156:159], v[148:151], v[112:115]
    ds_read_b64_tr_b16 v[196:197], v18 offset:14336
    v_mfma_f32_16x16x32_bf16 v[84:87], v[156:159], v[144:147], v[84:87]
    ds_read_b64_tr_b16 v[198:199], v18 offset:21504
    v_mfma_f32_16x16x32_bf16 v[56:59], v[156:159], v[140:143], v[56:59]
    v_mfma_f32_16x16x32_bf16 v[28:31], v[156:159], v[136:139], v[28:31]
    ds_read_b64_tr_b16 v[200:201], v19 offset:14368
    v_mfma_f32_16x16x32_bf16 v[32:35], v[160:163], v[136:139], v[32:35]
    ds_read_b64_tr_b16 v[202:203], v19 offset:21536
    v_mfma_f32_16x16x32_bf16 v[60:63], v[160:163], v[140:143], v[60:63]
    ds_read_b64_tr_b16 v[204:205], v18 offset:14400
    v_mfma_f32_16x16x32_bf16 v[88:91], v[160:163], v[144:147], v[88:91]
    ds_read_b64_tr_b16 v[206:207], v18 offset:21568
    v_mfma_f32_16x16x32_bf16 v[116:119], v[160:163], v[148:151], v[116:119]
    ds_read_b64_tr_b16 v[208:209], v19 offset:14432
    v_mfma_f32_16x16x32_bf16 v[120:123], v[164:167], v[148:151], v[120:123]
    ds_read_b64_tr_b16 v[210:211], v19 offset:21600
    v_mfma_f32_16x16x32_bf16 v[92:95], v[164:167], v[144:147], v[92:95]
    v_mfma_f32_16x16x32_bf16 v[64:67], v[164:167], v[140:143], v[64:67]
    ds_read_b64_tr_b16 v[212:213], v18 offset:14464
    v_mfma_f32_16x16x32_bf16 v[36:39], v[164:167], v[136:139], v[36:39]
    ds_read_b64_tr_b16 v[214:215], v18 offset:21632
    v_mfma_f32_16x16x32_bf16 v[40:43], v[168:171], v[136:139], v[40:43]
    ds_read_b64_tr_b16 v[216:217], v19 offset:14496
    v_mfma_f32_16x16x32_bf16 v[68:71], v[168:171], v[140:143], v[68:71]
    ds_read_b64_tr_b16 v[218:219], v19 offset:21664
    v_mfma_f32_16x16x32_bf16 v[96:99], v[168:171], v[144:147], v[96:99]
    ds_read_b64_tr_b16 v[220:221], v20 offset:14336
    v_mfma_f32_16x16x32_bf16 v[124:127], v[168:171], v[148:151], v[124:127]
    ds_read_b64_tr_b16 v[222:223], v20 offset:21504
    v_mfma_f32_16x16x32_bf16 v[128:131], v[172:175], v[148:151], v[128:131]
    s_add_u32 s42, s42, 16384
    s_cmp_eq_u32 s42, 49152
    v_mfma_f32_16x16x32_bf16 v[100:103], v[172:175], v[144:147], v[100:103]
    s_cselect_b32 s42, 0, s42
    s_add_u32 s48, s48, 28672
    v_mfma_f32_16x16x32_bf16 v[72:75], v[172:175], v[140:143], v[72:75]
    s_cmp_eq_u32 s48, 86016
    s_cselect_b32 s48, 0, s48
    v_mfma_f32_16x16x32_bf16 v[44:47], v[172:175], v[136:139], v[44:47]
    v_add_u32 v17, s42, v12
    v_add_u32 v18, s48, v13
    v_mfma_f32_16x16x32_bf16 v[48:51], v[176:179], v[136:139], v[48:51]
    v_add_u32 v19, s48, v14
    v_add_u32 v20, s48, v15
    v_mfma_f32_16x16x32_bf16 v[76:79], v[176:179], v[140:143], v[76:79]
    v_mfma_f32_16x16x32_bf16 v[104:107], v[176:179], v[144:147], v[104:107]
    v_mfma_f32_16x16x32_bf16 v[132:135], v[176:179], v[148:151], v[132:135]
    s_waitcnt lgkmcnt(0)
    s_barrier
    v_mfma_f32_16x16x32_bf16 v[24:27], v[196:199], v[180:183], v[24:27]
    ds_read_b128 v[136:139], v17 offset:0
    v_mfma_f32_16x16x32_bf16 v[52:55], v[196:199], v[184:187], v[52:55]
    ds_read_b128 v[140:143], v17 offset:2048
    v_mfma_f32_16x16x32_bf16 v[80:83], v[196:199], v[188:191], v[80:83]
    ds_read_b128 v[144:147], v17 offset:4096
    v_mfma_f32_16x16x32_bf16 v[108:111], v[196:199], v[192:195], v[108:111]
    ds_read_b128 v[148:151], v17 offset:6144
    v_mfma_f32_16x16x32_bf16 v[112:115], v[200:203], v[192:195], v[112:115]
    ds_read_b64_tr_b16 v[152:153], v18 offset:0
    v_mfma_f32_16x16x32_bf16 v[84:87], v[200:203], v[188:191], v[84:87]
    ds_read_b64_tr_b16 v[154:155], v18 offset:7168
    v_mfma_f32_16x16x32_bf16 v[56:59], v[200:203], v[184:187], v[56:59]
    v_mfma_f32_16x16x32_bf16 v[28:31], v[200:203], v[180:183], v[28:31]
    ds_read_b64_tr_b16 v[156:157], v19 offset:32
    v_mfma_f32_16x16x32_bf16 v[32:35], v[204:207], v[180:183], v[32:35]
    ds_read_b64_tr_b16 v[158:159], v19 offset:7200
    v_mfma_f32_16x16x32_bf16 v[60:63], v[204:207], v[184:187], v[60:63]
    ds_read_b64_tr_b16 v[160:161], v18 offset:64
    v_mfma_f32_16x16x32_bf16 v[88:91], v[204:207], v[188:191], v[88:91]
    ds_read_b64_tr_b16 v[162:163], v18 offset:7232
    v_mfma_f32_16x16x32_bf16 v[116:119], v[204:207], v[192:195], v[116:119]
    ds_read_b64_tr_b16 v[164:165], v19 offset:96
    v_mfma_f32_16x16x32_bf16 v[120:123], v[208:211], v[192:195], v[120:123]
    ds_read_b64_tr_b16 v[166:167], v19 offset:7264
    v_mfma_f32_16x16x32_bf16 v[92:95], v[208:211], v[188:191], v[92:95]
    v_mfma_f32_16x16x32_bf16 v[64:67], v[208:211], v[184:187], v[64:67]
    ds_read_b64_tr_b16 v[168:169], v18 offset:128
    v_mfma_f32_16x16x32_bf16 v[36:39], v[208:211], v[180:183], v[36:39]
    ds_read_b64_tr_b16 v[170:171], v18 offset:7296
    v_mfma_f32_16x16x32_bf16 v[40:43], v[212:215], v[180:183], v[40:43]
    ds_read_b64_tr_b16 v[172:173], v19 offset:160
    v_mfma_f32_16x16x32_bf16 v[68:71], v[212:215], v[184:187], v[68:71]
    ds_read_b64_tr_b16 v[174:175], v19 offset:7328
    v_mfma_f32_16x16x32_bf16 v[96:99], v[212:215], v[188:191], v[96:99]
    ds_read_b64_tr_b16 v[176:177], v20 offset:0
    v_mfma_f32_16x16x32_bf16 v[124:127], v[212:215], v[192:195], v[124:127]
    ds_read_b64_tr_b16 v[178:179], v20 offset:7168
    v_mfma_f32_16x16x32_bf16 v[128:131], v[216:219], v[192:195], v[128:131]
    s_add_u32 s43, s43, 1
    v_mfma_f32_16x16x32_bf16 v[100:103], v[216:219], v[188:191], v[100:103]
    s_cmp_lt_u32 s43, 15
    v_mfma_f32_16x16x32_bf16 v[72:75], v[216:219], v[184:187], v[72:75]
    v_mfma_f32_16x16x32_bf16 v[44:47], v[216:219], v[180:183], v[44:47]
    v_mfma_f32_16x16x32_bf16 v[48:51], v[220:223], v[180:183], v[48:51]
    v_mfma_f32_16x16x32_bf16 v[76:79], v[220:223], v[184:187], v[76:79]
    v_mfma_f32_16x16x32_bf16 v[104:107], v[220:223], v[188:191], v[104:107]
    v_mfma_f32_16x16x32_bf16 v[132:135], v[220:223], v[192:195], v[132:135]
    s_cbranch_scc1 mm_20
    s_waitcnt lgkmcnt(0)
    v_mfma_f32_16x16x32_bf16 v[24:27], v[152:155], v[136:139], v[24:27]
    ds_read_b128 v[180:183], v17 offset:1024
    v_mfma_f32_16x16x32_bf16 v[52:55], v[152:155], v[140:143], v[52:55]
    ds_read_b128 v[184:187], v17 offset:3072
    v_mfma_f32_16x16x32_bf16 v[80:83], v[152:155], v[144:147], v[80:83]
    ds_read_b128 v[188:191], v17 offset:5120
    v_mfma_f32_16x16x32_bf16 v[108:111], v[152:155], v[148:151], v[108:111]
    ds_read_b128 v[192:195], v17 offset:7168
    v_mfma_f32_16x16x32_bf16 v[112:115], v[156:159], v[148:151], v[112:115]
    ds_read_b64_tr_b16 v[196:197], v18 offset:14336
    v_mfma_f32_16x16x32_bf16 v[84:87], v[156:159], v[144:147], v[84:87]
    ds_read_b64_tr_b16 v[198:199], v18 offset:21504
    v_mfma_f32_16x16x32_bf16 v[56:59], v[156:159], v[140:143], v[56:59]
    v_mfma_f32_16x16x32_bf16 v[28:31], v[156:159], v[136:139], v[28:31]
    ds_read_b64_tr_b16 v[200:201], v19 offset:14368
    v_mfma_f32_16x16x32_bf16 v[32:35], v[160:163], v[136:139], v[32:35]
    ds_read_b64_tr_b16 v[202:203], v19 offset:21536
    v_mfma_f32_16x16x32_bf16 v[60:63], v[160:163], v[140:143], v[60:63]
    ds_read_b64_tr_b16 v[204:205], v18 offset:14400
    v_mfma_f32_16x16x32_bf16 v[88:91], v[160:163], v[144:147], v[88:91]
    ds_read_b64_tr_b16 v[206:207], v18 offset:21568
    v_mfma_f32_16x16x32_bf16 v[116:119], v[160:163], v[148:151], v[116:119]
    ds_read_b64_tr_b16 v[208:209], v19 offset:14432
    v_mfma_f32_16x16x32_bf16 v[120:123], v[164:167], v[148:151], v[120:123]
    ds_read_b64_tr_b16 v[210:211], v19 offset:21600
    v_mfma_f32_16x16x32_bf16 v[92:95], v[164:167], v[144:147], v[92:95]
    v_mfma_f32_16x16x32_bf16 v[64:67], v[164:167], v[140:143], v[64:67]
    ds_read_b64_tr_b16 v[212:213], v18 offset:14464
    v_mfma_f32_16x16x32_bf16 v[36:39], v[164:167], v[136:139], v[36:39]
    ds_read_b64_tr_b16 v[214:215], v18 offset:21632
    v_mfma_f32_16x16x32_bf16 v[40:43], v[168:171], v[136:139], v[40:43]
    ds_read_b64_tr_b16 v[216:217], v19 offset:14496
    v_mfma_f32_16x16x32_bf16 v[68:71], v[168:171], v[140:143], v[68:71]
    ds_read_b64_tr_b16 v[218:219], v19 offset:21664
    v_mfma_f32_16x16x32_bf16 v[96:99], v[168:171], v[144:147], v[96:99]
    ds_read_b64_tr_b16 v[220:221], v20 offset:14336
    v_mfma_f32_16x16x32_bf16 v[124:127], v[168:171], v[148:151], v[124:127]
    ds_read_b64_tr_b16 v[222:223], v20 offset:21504
    v_mfma_f32_16x16x32_bf16 v[128:131], v[172:175], v[148:151], v[128:131]
    v_mfma_f32_16x16x32_bf16 v[100:103], v[172:175], v[144:147], v[100:103]
    v_mfma_f32_16x16x32_bf16 v[72:75], v[172:175], v[140:143], v[72:75]
    v_mfma_f32_16x16x32_bf16 v[44:47], v[172:175], v[136:139], v[44:47]
    v_mfma_f32_16x16x32_bf16 v[48:51], v[176:179], v[136:139], v[48:51]
    v_mfma_f32_16x16x32_bf16 v[76:79], v[176:179], v[140:143], v[76:79]
    v_mfma_f32_16x16x32_bf16 v[104:107], v[176:179], v[144:147], v[104:107]
    v_mfma_f32_16x16x32_bf16 v[132:135], v[176:179], v[148:151], v[132:135]
    s_waitcnt lgkmcnt(0)
    s_barrier
    v_mfma_f32_16x16x32_bf16 v[24:27], v[196:199], v[180:183], v[24:27]
    ds_read_b128 v[136:139], v6 offset:0
    v_mfma_f32_16x16x32_bf16 v[52:55], v[196:199], v[184:187], v[52:55]
    ds_read_b128 v[140:143], v6 offset:64
    v_mfma_f32_16x16x32_bf16 v[80:83], v[196:199], v[188:191], v[80:83]
    v_mfma_f32_16x16x32_bf16 v[108:111], v[196:199], v[192:195], v[108:111]
    ds_read_b128 v[144:147], v6 offset:128
    v_mfma_f32_16x16x32_bf16 v[112:115], v[200:203], v[192:195], v[112:115]
    v_mfma_f32_16x16x32_bf16 v[84:87], v[200:203], v[188:191], v[84:87]
    ds_read_b128 v[148:151], v6 offset:192
    v_mfma_f32_16x16x32_bf16 v[56:59], v[200:203], v[184:187], v[56:59]
    v_mfma_f32_16x16x32_bf16 v[28:31], v[200:203], v[180:183], v[28:31]
    ds_read_b128 v[152:155], v6 offset:256
    v_mfma_f32_16x16x32_bf16 v[32:35], v[204:207], v[180:183], v[32:35]
    v_mfma_f32_16x16x32_bf16 v[60:63], v[204:207], v[184:187], v[60:63]
    ds_read_b128 v[156:159], v6 offset:320
    v_mfma_f32_16x16x32_bf16 v[88:91], v[204:207], v[188:191], v[88:91]
    v_mfma_f32_16x16x32_bf16 v[116:119], v[204:207], v[192:195], v[116:119]
    ds_read_b128 v[160:163], v6 offset:384
    v_mfma_f32_16x16x32_bf16 v[120:123], v[208:211], v[192:195], v[120:123]
    v_mfma_f32_16x16x32_bf16 v[92:95], v[208:211], v[188:191], v[92:95]
    ds_read_b128 v[164:167], v7 offset:0
    v_mfma_f32_16x16x32_bf16 v[64:67], v[208:211], v[184:187], v[64:67]
    v_mfma_f32_16x16x32_bf16 v[36:39], v[208:211], v[180:183], v[36:39]
    ds_read_b128 v[168:171], v7 offset:256
    v_mfma_f32_16x16x32_bf16 v[40:43], v[212:215], v[180:183], v[40:43]
    v_mfma_f32_16x16x32_bf16 v[68:71], v[212:215], v[184:187], v[68:71]
    ds_read_b128 v[172:175], v7 offset:512
    v_mfma_f32_16x16x32_bf16 v[96:99], v[212:215], v[188:191], v[96:99]
    v_mfma_f32_16x16x32_bf16 v[124:127], v[212:215], v[192:195], v[124:127]
    ds_read_b128 v[176:179], v7 offset:768
    v_mfma_f32_16x16x32_bf16 v[128:131], v[216:219], v[192:195], v[128:131]
    v_mfma_f32_16x16x32_bf16 v[100:103], v[216:219], v[188:191], v[100:103]
    v_mfma_f32_16x16x32_bf16 v[72:75], v[216:219], v[184:187], v[72:75]
    v_mfma_f32_16x16x32_bf16 v[44:47], v[216:219], v[180:183], v[44:47]
    v_mfma_f32_16x16x32_bf16 v[48:51], v[220:223], v[180:183], v[48:51]
    v_mfma_f32_16x16x32_bf16 v[76:79], v[220:223], v[184:187], v[76:79]
    v_mfma_f32_16x16x32_bf16 v[104:107], v[220:223], v[188:191], v[104:107]
    v_mfma_f32_16x16x32_bf16 v[132:135], v[220:223], v[192:195], v[132:135]
    s_waitcnt lgkmcnt(0)
    s_nop 7
    v_pk_fma_f32 v[24:25], v[164:165], v[136:137], v[24:25] op_sel_hi:[0,1,1] neg_lo:[1,0,0] neg_hi:[1,0,0]
    v_pk_fma_f32 v[26:27], v[164:165], v[138:139], v[26:27] op_sel_hi:[0,1,1] neg_lo:[1,0,0] neg_hi:[1,0,0]
    v_pk_fma_f32 v[28:29], v[164:165], v[140:141], v[28:29] op_sel_hi:[0,1,1] neg_lo:[1,0,0] neg_hi:[1,0,0]
    v_pk_fma_f32 v[30:31], v[164:165], v[142:143], v[30:31] op_sel_hi:[0,1,1] neg_lo:[1,0,0] neg_hi:[1,0,0]
    v_pk_mul_f32 v[192:193], v[24:25], v[24:25]
    v_pk_mul_f32 v[194:195], v[26:27], v[26:27]
    v_pk_mul_f32 v[196:197], v[28:29], v[28:29]
    v_pk_mul_f32 v[198:199], v[30:31], v[30:31]
    v_pk_fma_f32 v[192:193], v[192:193], v[166:167], v[166:167] op_sel:[0,1,0] op_sel_hi:[1,1,0]
    v_pk_fma_f32 v[194:195], v[194:195], v[166:167], v[166:167] op_sel:[0,1,0] op_sel_hi:[1,1,0]
    v_pk_fma_f32 v[196:197], v[196:197], v[166:167], v[166:167] op_sel:[0,1,0] op_sel_hi:[1,1,0]
    v_pk_fma_f32 v[198:199], v[198:199], v[166:167], v[166:167] op_sel:[0,1,0] op_sel_hi:[1,1,0]
    v_pk_mul_f32 v[192:193], v[192:193], v[24:25]
    v_pk_mul_f32 v[194:195], v[194:195], v[26:27]
    v_pk_mul_f32 v[196:197], v[196:197], v[28:29]
    v_pk_mul_f32 v[198:199], v[198:199], v[30:31]
    v_exp_f32 v192, v192
    v_exp_f32 v193, v193
    v_exp_f32 v194, v194
    v_exp_f32 v195, v195
    v_exp_f32 v196, v196
    v_exp_f32 v197, v197
    v_exp_f32 v198, v198
    v_exp_f32 v199, v199
    v_pk_fma_f32 v[192:193], v[192:193], v[164:165], v[164:165] op_sel:[0,1,1] op_sel_hi:[1,1,1]
    v_pk_fma_f32 v[194:195], v[194:195], v[164:165], v[164:165] op_sel:[0,1,1] op_sel_hi:[1,1,1]
    v_pk_fma_f32 v[196:197], v[196:197], v[164:165], v[164:165] op_sel:[0,1,1] op_sel_hi:[1,1,1]
    v_pk_fma_f32 v[198:199], v[198:199], v[164:165], v[164:165] op_sel:[0,1,1] op_sel_hi:[1,1,1]
    v_rcp_f32 v192, v192
    v_rcp_f32 v193, v193
    v_rcp_f32 v194, v194
    v_rcp_f32 v195, v195
    v_rcp_f32 v196, v196
    v_rcp_f32 v197, v197
    v_rcp_f32 v198, v198
    v_rcp_f32 v199, v199
    v_pk_mul_f32 v[24:25], v[24:25], v[192:193]
    v_pk_mul_f32 v[26:27], v[26:27], v[194:195]
    v_pk_mul_f32 v[28:29], v[28:29], v[196:197]
    v_pk_mul_f32 v[30:31], v[30:31], v[198:199]
    v_cvt_pk_bf16_f32 v24, v24, v25
    v_cvt_pk_bf16_f32 v25, v26, v27
    v_cvt_pk_bf16_f32 v26, v28, v29
    v_cvt_pk_bf16_f32 v27, v30, v31
    ds_write_b128 v22, v[24:27] offset:0
    s_add_u32 s36, s44, 0
    buffer_store_dwordx4 v[24:27], v2, s[16:19], s36 offen sc1
    v_pk_fma_f32 v[52:53], v[168:169], v[136:137], v[52:53] op_sel_hi:[0,1,1] neg_lo:[1,0,0] neg_hi:[1,0,0]
    v_pk_fma_f32 v[54:55], v[168:169], v[138:139], v[54:55] op_sel_hi:[0,1,1] neg_lo:[1,0,0] neg_hi:[1,0,0]
    v_pk_fma_f32 v[56:57], v[168:169], v[140:141], v[56:57] op_sel_hi:[0,1,1] neg_lo:[1,0,0] neg_hi:[1,0,0]
    v_pk_fma_f32 v[58:59], v[168:169], v[142:143], v[58:59] op_sel_hi:[0,1,1] neg_lo:[1,0,0] neg_hi:[1,0,0]
    v_pk_mul_f32 v[192:193], v[52:53], v[52:53]
    v_pk_mul_f32 v[194:195], v[54:55], v[54:55]
    v_pk_mul_f32 v[196:197], v[56:57], v[56:57]
    v_pk_mul_f32 v[198:199], v[58:59], v[58:59]
    v_pk_fma_f32 v[192:193], v[192:193], v[170:171], v[170:171] op_sel:[0,1,0] op_sel_hi:[1,1,0]
    v_pk_fma_f32 v[194:195], v[194:195], v[170:171], v[170:171] op_sel:[0,1,0] op_sel_hi:[1,1,0]
    v_pk_fma_f32 v[196:197], v[196:197], v[170:171], v[170:171] op_sel:[0,1,0] op_sel_hi:[1,1,0]
    v_pk_fma_f32 v[198:199], v[198:199], v[170:171], v[170:171] op_sel:[0,1,0] op_sel_hi:[1,1,0]
    v_pk_mul_f32 v[192:193], v[192:193], v[52:53]
    v_pk_mul_f32 v[194:195], v[194:195], v[54:55]
    v_pk_mul_f32 v[196:197], v[196:197], v[56:57]
    v_pk_mul_f32 v[198:199], v[198:199], v[58:59]
    v_exp_f32 v192, v192
    v_exp_f32 v193, v193
    v_exp_f32 v194, v194
    v_exp_f32 v195, v195
    v_exp_f32 v196, v196
    v_exp_f32 v197, v197
    v_exp_f32 v198, v198
    v_exp_f32 v199, v199
    v_pk_fma_f32 v[192:193], v[192:193], v[168:169], v[168:169] op_sel:[0,1,1] op_sel_hi:[1,1,1]
    v_pk_fma_f32 v[194:195], v[194:195], v[168:169], v[168:169] op_sel:[0,1,1] op_sel_hi:[1,1,1]
    v_pk_fma_f32 v[196:197], v[196:197], v[168:169], v[168:169] op_sel:[0,1,1] op_sel_hi:[1,1,1]
    v_pk_fma_f32 v[198:199], v[198:199], v[168:169], v[168:169] op_sel:[0,1,1] op_sel_hi:[1,1,1]
    v_rcp_f32 v192, v192
    v_rcp_f32 v193, v193
    v_rcp_f32 v194, v194
    v_rcp_f32 v195, v195
    v_rcp_f32 v196, v196
    v_rcp_f32 v197, v197
    v_rcp_f32 v198, v198
    v_rcp_f32 v199, v199
    v_pk_mul_f32 v[52:53], v[52:53], v[192:193]
    v_pk_mul_f32 v[54:55], v[54:55], v[194:195]
    v_pk_mul_f32 v[56:57], v[56:57], v[196:197]
    v_pk_mul_f32 v[58:59], v[58:59], v[198:199]
    v_cvt_pk_bf16_f32 v52, v52, v53
    v_cvt_pk_bf16_f32 v53, v54, v55
    v_cvt_pk_bf16_f32 v54, v56, v57
    v_cvt_pk_bf16_f32 v55, v58, v59
    ds_write_b128 v22, v[52:55] offset:2048
    s_add_u32 s36, s44, 229376
    buffer_store_dwordx4 v[52:55], v2, s[16:19], s36 offen sc1
    v_pk_fma_f32 v[80:81], v[172:173], v[136:137], v[80:81] op_sel_hi:[0,1,1] neg_lo:[1,0,0] neg_hi:[1,0,0]
    v_pk_fma_f32 v[82:83], v[172:173], v[138:139], v[82:83] op_sel_hi:[0,1,1] neg_lo:[1,0,0] neg_hi:[1,0,0]
    v_pk_fma_f32 v[84:85], v[172:173], v[140:141], v[84:85] op_sel_hi:[0,1,1] neg_lo:[1,0,0] neg_hi:[1,0,0]
    v_pk_fma_f32 v[86:87], v[172:173], v[142:143], v[86:87] op_sel_hi:[0,1,1] neg_lo:[1,0,0] neg_hi:[1,0,0]
    v_pk_mul_f32 v[192:193], v[80:81], v[80:81]
    v_pk_mul_f32 v[194:195], v[82:83], v[82:83]
    v_pk_mul_f32 v[196:197], v[84:85], v[84:85]
    v_pk_mul_f32 v[198:199], v[86:87], v[86:87]
    v_pk_fma_f32 v[192:193], v[192:193], v[174:175], v[174:175] op_sel:[0,1,0] op_sel_hi:[1,1,0]
    v_pk_fma_f32 v[194:195], v[194:195], v[174:175], v[174:175] op_sel:[0,1,0] op_sel_hi:[1,1,0]
    v_pk_fma_f32 v[196:197], v[196:197], v[174:175], v[174:175] op_sel:[0,1,0] op_sel_hi:[1,1,0]
    v_pk_fma_f32 v[198:199], v[198:199], v[174:175], v[174:175] op_sel:[0,1,0] op_sel_hi:[1,1,0]
    v_pk_mul_f32 v[192:193], v[192:193], v[80:81]
    v_pk_mul_f32 v[194:195], v[194:195], v[82:83]
    v_pk_mul_f32 v[196:197], v[196:197], v[84:85]
    v_pk_mul_f32 v[198:199], v[198:199], v[86:87]
    v_exp_f32 v192, v192
    v_exp_f32 v193, v193
    v_exp_f32 v194, v194
    v_exp_f32 v195, v195
    v_exp_f32 v196, v196
    v_exp_f32 v197, v197
    v_exp_f32 v198, v198
    v_exp_f32 v199, v199
    v_pk_fma_f32 v[192:193], v[192:193], v[172:173], v[172:173] op_sel:[0,1,1] op_sel_hi:[1,1,1]
    v_pk_fma_f32 v[194:195], v[194:195], v[172:173], v[172:173] op_sel:[0,1,1] op_sel_hi:[1,1,1]
    v_pk_fma_f32 v[196:197], v[196:197], v[172:173], v[172:173] op_sel:[0,1,1] op_sel_hi:[1,1,1]
    v_pk_fma_f32 v[198:199], v[198:199], v[172:173], v[172:173] op_sel:[0,1,1] op_sel_hi:[1,1,1]
    v_rcp_f32 v192, v192
    v_rcp_f32 v193, v193
    v_rcp_f32 v194, v194
    v_rcp_f32 v195, v195
    v_rcp_f32 v196, v196
    v_rcp_f32 v197, v197
    v_rcp_f32 v198, v198
    v_rcp_f32 v199, v199
    v_pk_mul_f32 v[80:81], v[80:81], v[192:193]
    v_pk_mul_f32 v[82:83], v[82:83], v[194:195]
    v_pk_mul_f32 v[84:85], v[84:85], v[196:197]
    v_pk_mul_f32 v[86:87], v[86:87], v[198:199]
    v_cvt_pk_bf16_f32 v80, v80, v81
    v_cvt_pk_bf16_f32 v81, v82, v83
    v_cvt_pk_bf16_f32 v82, v84, v85
    v_cvt_pk_bf16_f32 v83, v86, v87
    ds_write_b128 v23, v[80:83] offset:0
    s_add_u32 s36, s44, 458752
    buffer_store_dwordx4 v[80:83], v2, s[16:19], s36 offen sc1
    v_pk_fma_f32 v[108:109], v[176:177], v[136:137], v[108:109] op_sel_hi:[0,1,1] neg_lo:[1,0,0] neg_hi:[1,0,0]
    v_pk_fma_f32 v[110:111], v[176:177], v[138:139], v[110:111] op_sel_hi:[0,1,1] neg_lo:[1,0,0] neg_hi:[1,0,0]
    v_pk_fma_f32 v[112:113], v[176:177], v[140:141], v[112:113] op_sel_hi:[0,1,1] neg_lo:[1,0,0] neg_hi:[1,0,0]
    v_pk_fma_f32 v[114:115], v[176:177], v[142:143], v[114:115] op_sel_hi:[0,1,1] neg_lo:[1,0,0] neg_hi:[1,0,0]
    v_pk_mul_f32 v[192:193], v[108:109], v[108:109]
    v_pk_mul_f32 v[194:195], v[110:111], v[110:111]
    v_pk_mul_f32 v[196:197], v[112:113], v[112:113]
    v_pk_mul_f32 v[198:199], v[114:115], v[114:115]
    v_pk_fma_f32 v[192:193], v[192:193], v[178:179], v[178:179] op_sel:[0,1,0] op_sel_hi:[1,1,0]
    v_pk_fma_f32 v[194:195], v[194:195], v[178:179], v[178:179] op_sel:[0,1,0] op_sel_hi:[1,1,0]
    v_pk_fma_f32 v[196:197], v[196:197], v[178:179], v[178:179] op_sel:[0,1,0] op_sel_hi:[1,1,0]
    v_pk_fma_f32 v[198:199], v[198:199], v[178:179], v[178:179] op_sel:[0,1,0] op_sel_hi:[1,1,0]
    v_pk_mul_f32 v[192:193], v[192:193], v[108:109]
    v_pk_mul_f32 v[194:195], v[194:195], v[110:111]
    v_pk_mul_f32 v[196:197], v[196:197], v[112:113]
    v_pk_mul_f32 v[198:199], v[198:199], v[114:115]
    v_exp_f32 v192, v192
    v_exp_f32 v193, v193
    v_exp_f32 v194, v194
    v_exp_f32 v195, v195
    v_exp_f32 v196, v196
    v_exp_f32 v197, v197
    v_exp_f32 v198, v198
    v_exp_f32 v199, v199
    v_pk_fma_f32 v[192:193], v[192:193], v[176:177], v[176:177] op_sel:[0,1,1] op_sel_hi:[1,1,1]
    v_pk_fma_f32 v[194:195], v[194:195], v[176:177], v[176:177] op_sel:[0,1,1] op_sel_hi:[1,1,1]
    v_pk_fma_f32 v[196:197], v[196:197], v[176:177], v[176:177] op_sel:[0,1,1] op_sel_hi:[1,1,1]
    v_pk_fma_f32 v[198:199], v[198:199], v[176:177], v[176:177] op_sel:[0,1,1] op_sel_hi:[1,1,1]
    v_rcp_f32 v192, v192
    v_rcp_f32 v193, v193
    v_rcp_f32 v194, v194
    v_rcp_f32 v195, v195
    v_rcp_f32 v196, v196
    v_rcp_f32 v197, v197
    v_rcp_f32 v198, v198
    v_rcp_f32 v199, v199
    v_pk_mul_f32 v[108:109], v[108:109], v[192:193]
    v_pk_mul_f32 v[110:111], v[110:111], v[194:195]
    v_pk_mul_f32 v[112:113], v[112:113], v[196:197]
    v_pk_mul_f32 v[114:115], v[114:115], v[198:199]
    v_cvt_pk_bf16_f32 v108, v108, v109
    v_cvt_pk_bf16_f32 v109, v110, v111
    v_cvt_pk_bf16_f32 v110, v112, v113
    v_cvt_pk_bf16_f32 v111, v114, v115
    ds_write_b128 v23, v[108:111] offset:2048
    s_add_u32 s36, s44, 688128
    buffer_store_dwordx4 v[108:111], v2, s[16:19], s36 offen sc1
    v_pk_fma_f32 v[32:33], v[164:165], v[144:145], v[32:33] op_sel_hi:[0,1,1] neg_lo:[1,0,0] neg_hi:[1,0,0]
    v_pk_fma_f32 v[34:35], v[164:165], v[146:147], v[34:35] op_sel_hi:[0,1,1] neg_lo:[1,0,0] neg_hi:[1,0,0]
    v_pk_fma_f32 v[36:37], v[164:165], v[148:149], v[36:37] op_sel_hi:[0,1,1] neg_lo:[1,0,0] neg_hi:[1,0,0]
    v_pk_fma_f32 v[38:39], v[164:165], v[150:151], v[38:39] op_sel_hi:[0,1,1] neg_lo:[1,0,0] neg_hi:[1,0,0]
    v_pk_mul_f32 v[192:193], v[32:33], v[32:33]
    v_pk_mul_f32 v[194:195], v[34:35], v[34:35]
    v_pk_mul_f32 v[196:197], v[36:37], v[36:37]
    v_pk_mul_f32 v[198:199], v[38:39], v[38:39]
    v_pk_fma_f32 v[192:193], v[192:193], v[166:167], v[166:167] op_sel:[0,1,0] op_sel_hi:[1,1,0]
    v_pk_fma_f32 v[194:195], v[194:195], v[166:167], v[166:167] op_sel:[0,1,0] op_sel_hi:[1,1,0]
    v_pk_fma_f32 v[196:197], v[196:197], v[166:167], v[166:167] op_sel:[0,1,0] op_sel_hi:[1,1,0]
    v_pk_fma_f32 v[198:199], v[198:199], v[166:167], v[166:167] op_sel:[0,1,0] op_sel_hi:[1,1,0]
    v_pk_mul_f32 v[192:193], v[192:193], v[32:33]
    v_pk_mul_f32 v[194:195], v[194:195], v[34:35]
    v_pk_mul_f32 v[196:197], v[196:197], v[36:37]
    v_pk_mul_f32 v[198:199], v[198:199], v[38:39]
    v_exp_f32 v192, v192
    v_exp_f32 v193, v193
    v_exp_f32 v194, v194
    v_exp_f32 v195, v195
    v_exp_f32 v196, v196
    v_exp_f32 v197, v197
    v_exp_f32 v198, v198
    v_exp_f32 v199, v199
    v_pk_fma_f32 v[192:193], v[192:193], v[164:165], v[164:165] op_sel:[0,1,1] op_sel_hi:[1,1,1]
    v_pk_fma_f32 v[194:195], v[194:195], v[164:165], v[164:165] op_sel:[0,1,1] op_sel_hi:[1,1,1]
    v_pk_fma_f32 v[196:197], v[196:197], v[164:165], v[164:165] op_sel:[0,1,1] op_sel_hi:[1,1,1]
    v_pk_fma_f32 v[198:199], v[198:199], v[164:165], v[164:165] op_sel:[0,1,1] op_sel_hi:[1,1,1]
    v_rcp_f32 v192, v192
    v_rcp_f32 v193, v193
    v_rcp_f32 v194, v194
    v_rcp_f32 v195, v195
    v_rcp_f32 v196, v196
    v_rcp_f32 v197, v197
    v_rcp_f32 v198, v198
    v_rcp_f32 v199, v199
    v_pk_mul_f32 v[32:33], v[32:33], v[192:193]
    v_pk_mul_f32 v[34:35], v[34:35], v[194:195]
    v_pk_mul_f32 v[36:37], v[36:37], v[196:197]
    v_pk_mul_f32 v[38:39], v[38:39], v[198:199]
    v_cvt_pk_bf16_f32 v32, v32, v33
    v_cvt_pk_bf16_f32 v33, v34, v35
    v_cvt_pk_bf16_f32 v34, v36, v37
    v_cvt_pk_bf16_f32 v35, v38, v39
    ds_write_b128 v22, v[32:35] offset:16384
    v_pk_fma_f32 v[60:61], v[168:169], v[144:145], v[60:61] op_sel_hi:[0,1,1] neg_lo:[1,0,0] neg_hi:[1,0,0]
    v_pk_fma_f32 v[62:63], v[168:169], v[146:147], v[62:63] op_sel_hi:[0,1,1] neg_lo:[1,0,0] neg_hi:[1,0,0]
    v_pk_fma_f32 v[64:65], v[168:169], v[148:149], v[64:65] op_sel_hi:[0,1,1] neg_lo:[1,0,0] neg_hi:[1,0,0]
    v_pk_fma_f32 v[66:67], v[168:169], v[150:151], v[66:67] op_sel_hi:[0,1,1] neg_lo:[1,0,0] neg_hi:[1,0,0]
    v_pk_mul_f32 v[192:193], v[60:61], v[60:61]
    v_pk_mul_f32 v[194:195], v[62:63], v[62:63]
    v_pk_mul_f32 v[196:197], v[64:65], v[64:65]
    v_pk_mul_f32 v[198:199], v[66:67], v[66:67]
    v_pk_fma_f32 v[192:193], v[192:193], v[170:171], v[170:171] op_sel:[0,1,0] op_sel_hi:[1,1,0]
    v_pk_fma_f32 v[194:195], v[194:195], v[170:171], v[170:171] op_sel:[0,1,0] op_sel_hi:[1,1,0]
    v_pk_fma_f32 v[196:197], v[196:197], v[170:171], v[170:171] op_sel:[0,1,0] op_sel_hi:[1,1,0]
    v_pk_fma_f32 v[198:199], v[198:199], v[170:171], v[170:171] op_sel:[0,1,0] op_sel_hi:[1,1,0]
    v_pk_mul_f32 v[192:193], v[192:193], v[60:61]
    v_pk_mul_f32 v[194:195], v[194:195], v[62:63]
    v_pk_mul_f32 v[196:197], v[196:197], v[64:65]
    v_pk_mul_f32 v[198:199], v[198:199], v[66:67]
    v_exp_f32 v192, v192
    v_exp_f32 v193, v193
    v_exp_f32 v194, v194
    v_exp_f32 v195, v195
    v_exp_f32 v196, v196
    v_exp_f32 v197, v197
    v_exp_f32 v198, v198
    v_exp_f32 v199, v199
    v_pk_fma_f32 v[192:193], v[192:193], v[168:169], v[168:169] op_sel:[0,1,1] op_sel_hi:[1,1,1]
    v_pk_fma_f32 v[194:195], v[194:195], v[168:169], v[168:169] op_sel:[0,1,1] op_sel_hi:[1,1,1]
    v_pk_fma_f32 v[196:197], v[196:197], v[168:169], v[168:169] op_sel:[0,1,1] op_sel_hi:[1,1,1]
    v_pk_fma_f32 v[198:199], v[198:199], v[168:169], v[168:169] op_sel:[0,1,1] op_sel_hi:[1,1,1]
    v_rcp_f32 v192, v192
    v_rcp_f32 v193, v193
    v_rcp_f32 v194, v194
    v_rcp_f32 v195, v195
    v_rcp_f32 v196, v196
    v_rcp_f32 v197, v197
    v_rcp_f32 v198, v198
    v_rcp_f32 v199, v199
    v_pk_mul_f32 v[60:61], v[60:61], v[192:193]
    v_pk_mul_f32 v[62:63], v[62:63], v[194:195]
    v_pk_mul_f32 v[64:65], v[64:65], v[196:197]
    v_pk_mul_f32 v[66:67], v[66:67], v[198:199]
    v_cvt_pk_bf16_f32 v60, v60, v61
    v_cvt_pk_bf16_f32 v61, v62, v63
    v_cvt_pk_bf16_f32 v62, v64, v65
    v_cvt_pk_bf16_f32 v63, v66, v67
    ds_write_b128 v22, v[60:63] offset:18432
    v_pk_fma_f32 v[88:89], v[172:173], v[144:145], v[88:89] op_sel_hi:[0,1,1] neg_lo:[1,0,0] neg_hi:[1,0,0]
    v_pk_fma_f32 v[90:91], v[172:173], v[146:147], v[90:91] op_sel_hi:[0,1,1] neg_lo:[1,0,0] neg_hi:[1,0,0]
    v_pk_fma_f32 v[92:93], v[172:173], v[148:149], v[92:93] op_sel_hi:[0,1,1] neg_lo:[1,0,0] neg_hi:[1,0,0]
    v_pk_fma_f32 v[94:95], v[172:173], v[150:151], v[94:95] op_sel_hi:[0,1,1] neg_lo:[1,0,0] neg_hi:[1,0,0]
    v_pk_mul_f32 v[192:193], v[88:89], v[88:89]
    v_pk_mul_f32 v[194:195], v[90:91], v[90:91]
    v_pk_mul_f32 v[196:197], v[92:93], v[92:93]
    v_pk_mul_f32 v[198:199], v[94:95], v[94:95]
    v_pk_fma_f32 v[192:193], v[192:193], v[174:175], v[174:175] op_sel:[0,1,0] op_sel_hi:[1,1,0]
    v_pk_fma_f32 v[194:195], v[194:195], v[174:175], v[174:175] op_sel:[0,1,0] op_sel_hi:[1,1,0]
    v_pk_fma_f32 v[196:197], v[196:197], v[174:175], v[174:175] op_sel:[0,1,0] op_sel_hi:[1,1,0]
    v_pk_fma_f32 v[198:199], v[198:199], v[174:175], v[174:175] op_sel:[0,1,0] op_sel_hi:[1,1,0]
    v_pk_mul_f32 v[192:193], v[192:193], v[88:89]
    v_pk_mul_f32 v[194:195], v[194:195], v[90:91]
    v_pk_mul_f32 v[196:197], v[196:197], v[92:93]
    v_pk_mul_f32 v[198:199], v[198:199], v[94:95]
    v_exp_f32 v192, v192
    v_exp_f32 v193, v193
    v_exp_f32 v194, v194
    v_exp_f32 v195, v195
    v_exp_f32 v196, v196
    v_exp_f32 v197, v197
    v_exp_f32 v198, v198
    v_exp_f32 v199, v199
    v_pk_fma_f32 v[192:193], v[192:193], v[172:173], v[172:173] op_sel:[0,1,1] op_sel_hi:[1,1,1]
    v_pk_fma_f32 v[194:195], v[194:195], v[172:173], v[172:173] op_sel:[0,1,1] op_sel_hi:[1,1,1]
    v_pk_fma_f32 v[196:197], v[196:197], v[172:173], v[172:173] op_sel:[0,1,1] op_sel_hi:[1,1,1]
    v_pk_fma_f32 v[198:199], v[198:199], v[172:173], v[172:173] op_sel:[0,1,1] op_sel_hi:[1,1,1]
    v_rcp_f32 v192, v192
    v_rcp_f32 v193, v193
    v_rcp_f32 v194, v194
    v_rcp_f32 v195, v195
    v_rcp_f32 v196, v196
    v_rcp_f32 v197, v197
    v_rcp_f32 v198, v198
    v_rcp_f32 v199, v199
    v_pk_mul_f32 v[88:89], v[88:89], v[192:193]
    v_pk_mul_f32 v[90:91], v[90:91], v[194:195]
    v_pk_mul_f32 v[92:93], v[92:93], v[196:197]
    v_pk_mul_f32 v[94:95], v[94:95], v[198:199]
    v_cvt_pk_bf16_f32 v88, v88, v89
    v_cvt_pk_bf16_f32 v89, v90, v91
    v_cvt_pk_bf16_f32 v90, v92, v93
    v_cvt_pk_bf16_f32 v91, v94, v95
    ds_write_b128 v23, v[88:91] offset:16384
    s_waitcnt vmcnt(0)
    buffer_atomic_add v8, v9, s[56:59], s49 offen offset:0 sc1
    buffer_load_dwordx4 v[180:183], v255, s[84:87], s13 offen offset:0 sc1
    buffer_load_dwordx4 v[184:187], v2, s[88:91], s40 offen offset:0 sc1
    v_pk_fma_f32 v[116:117], v[176:177], v[144:145], v[116:117] op_sel_hi:[0,1,1] neg_lo:[1,0,0] neg_hi:[1,0,0]
    v_pk_fma_f32 v[118:119], v[176:177], v[146:147], v[118:119] op_sel_hi:[0,1,1] neg_lo:[1,0,0] neg_hi:[1,0,0]
    v_pk_fma_f32 v[120:121], v[176:177], v[148:149], v[120:121] op_sel_hi:[0,1,1] neg_lo:[1,0,0] neg_hi:[1,0,0]
    v_pk_fma_f32 v[122:123], v[176:177], v[150:151], v[122:123] op_sel_hi:[0,1,1] neg_lo:[1,0,0] neg_hi:[1,0,0]
    v_pk_mul_f32 v[192:193], v[116:117], v[116:117]
    v_pk_mul_f32 v[194:195], v[118:119], v[118:119]
    v_pk_mul_f32 v[196:197], v[120:121], v[120:121]
    v_pk_mul_f32 v[198:199], v[122:123], v[122:123]
    v_pk_fma_f32 v[192:193], v[192:193], v[178:179], v[178:179] op_sel:[0,1,0] op_sel_hi:[1,1,0]
    v_pk_fma_f32 v[194:195], v[194:195], v[178:179], v[178:179] op_sel:[0,1,0] op_sel_hi:[1,1,0]
    v_pk_fma_f32 v[196:197], v[196:197], v[178:179], v[178:179] op_sel:[0,1,0] op_sel_hi:[1,1,0]
    v_pk_fma_f32 v[198:199], v[198:199], v[178:179], v[178:179] op_sel:[0,1,0] op_sel_hi:[1,1,0]
    v_pk_mul_f32 v[192:193], v[192:193], v[116:117]
    v_pk_mul_f32 v[194:195], v[194:195], v[118:119]
    v_pk_mul_f32 v[196:197], v[196:197], v[120:121]
    v_pk_mul_f32 v[198:199], v[198:199], v[122:123]
    v_exp_f32 v192, v192
    v_exp_f32 v193, v193
    v_exp_f32 v194, v194
    v_exp_f32 v195, v195
    v_exp_f32 v196, v196
    v_exp_f32 v197, v197
    v_exp_f32 v198, v198
    v_exp_f32 v199, v199
    v_pk_fma_f32 v[192:193], v[192:193], v[176:177], v[176:177] op_sel:[0,1,1] op_sel_hi:[1,1,1]
    v_pk_fma_f32 v[194:195], v[194:195], v[176:177], v[176:177] op_sel:[0,1,1] op_sel_hi:[1,1,1]
    v_pk_fma_f32 v[196:197], v[196:197], v[176:177], v[176:177] op_sel:[0,1,1] op_sel_hi:[1,1,1]
    v_pk_fma_f32 v[198:199], v[198:199], v[176:177], v[176:177] op_sel:[0,1,1] op_sel_hi:[1,1,1]
    v_rcp_f32 v192, v192
    v_rcp_f32 v193, v193
    v_rcp_f32 v194, v194
    v_rcp_f32 v195, v195
    v_rcp_f32 v196, v196
    v_rcp_f32 v197, v197
    v_rcp_f32 v198, v198
    v_rcp_f32 v199, v199
    v_pk_mul_f32 v[116:117], v[116:117], v[192:193]
    v_pk_mul_f32 v[118:119], v[118:119], v[194:195]
    v_pk_mul_f32 v[120:121], v[120:121], v[196:197]
    v_pk_mul_f32 v[122:123], v[122:123], v[198:199]
    v_cvt_pk_bf16_f32 v116, v116, v117
    v_cvt_pk_bf16_f32 v117, v118, v119
    v_cvt_pk_bf16_f32 v118, v120, v121
    v_cvt_pk_bf16_f32 v119, v122, v123
    ds_write_b128 v23, v[116:119] offset:18432
    buffer_load_dwordx4 v[200:203], v255, s[84:87], s13 offen offset:64 sc1
    buffer_load_dwordx4 v[204:207], v2, s[88:91], s40 offen offset:1024 sc1
    v_pk_fma_f32 v[40:41], v[164:165], v[152:153], v[40:41] op_sel_hi:[0,1,1] neg_lo:[1,0,0] neg_hi:[1,0,0]
    v_pk_fma_f32 v[42:43], v[164:165], v[154:155], v[42:43] op_sel_hi:[0,1,1] neg_lo:[1,0,0] neg_hi:[1,0,0]
    v_pk_fma_f32 v[44:45], v[164:165], v[156:157], v[44:45] op_sel_hi:[0,1,1] neg_lo:[1,0,0] neg_hi:[1,0,0]
    v_pk_fma_f32 v[46:47], v[164:165], v[158:159], v[46:47] op_sel_hi:[0,1,1] neg_lo:[1,0,0] neg_hi:[1,0,0]
    v_pk_mul_f32 v[192:193], v[40:41], v[40:41]
    v_pk_mul_f32 v[194:195], v[42:43], v[42:43]
    v_pk_mul_f32 v[196:197], v[44:45], v[44:45]
    v_pk_mul_f32 v[198:199], v[46:47], v[46:47]
    v_pk_fma_f32 v[192:193], v[192:193], v[166:167], v[166:167] op_sel:[0,1,0] op_sel_hi:[1,1,0]
    v_pk_fma_f32 v[194:195], v[194:195], v[166:167], v[166:167] op_sel:[0,1,0] op_sel_hi:[1,1,0]
    v_pk_fma_f32 v[196:197], v[196:197], v[166:167], v[166:167] op_sel:[0,1,0] op_sel_hi:[1,1,0]
    v_pk_fma_f32 v[198:199], v[198:199], v[166:167], v[166:167] op_sel:[0,1,0] op_sel_hi:[1,1,0]
    v_pk_mul_f32 v[192:193], v[192:193], v[40:41]
    v_pk_mul_f32 v[194:195], v[194:195], v[42:43]
    v_pk_mul_f32 v[196:197], v[196:197], v[44:45]
    v_pk_mul_f32 v[198:199], v[198:199], v[46:47]
    v_exp_f32 v192, v192
    v_exp_f32 v193, v193
    v_exp_f32 v194, v194
    v_exp_f32 v195, v195
    v_exp_f32 v196, v196
    v_exp_f32 v197, v197
    v_exp_f32 v198, v198
    v_exp_f32 v199, v199
    v_pk_fma_f32 v[192:193], v[192:193], v[164:165], v[164:165] op_sel:[0,1,1] op_sel_hi:[1,1,1]
    v_pk_fma_f32 v[194:195], v[194:195], v[164:165], v[164:165] op_sel:[0,1,1] op_sel_hi:[1,1,1]
    v_pk_fma_f32 v[196:197], v[196:197], v[164:165], v[164:165] op_sel:[0,1,1] op_sel_hi:[1,1,1]
    v_pk_fma_f32 v[198:199], v[198:199], v[164:165], v[164:165] op_sel:[0,1,1] op_sel_hi:[1,1,1]
    v_rcp_f32 v192, v192
    v_rcp_f32 v193, v193
    v_rcp_f32 v194, v194
    v_rcp_f32 v195, v195
    v_rcp_f32 v196, v196
    v_rcp_f32 v197, v197
    v_rcp_f32 v198, v198
    v_rcp_f32 v199, v199
    v_pk_mul_f32 v[40:41], v[40:41], v[192:193]
    v_pk_mul_f32 v[42:43], v[42:43], v[194:195]
    v_pk_mul_f32 v[44:45], v[44:45], v[196:197]
    v_pk_mul_f32 v[46:47], v[46:47], v[198:199]
    v_cvt_pk_bf16_f32 v230, v40, v41
    v_cvt_pk_bf16_f32 v231, v42, v43
    v_cvt_pk_bf16_f32 v232, v44, v45
    v_cvt_pk_bf16_f32 v233, v46, v47
    ds_write_b128 v22, v[230:233] offset:32768
    buffer_load_dwordx4 v[208:211], v255, s[84:87], s14 offen offset:0 sc1
    buffer_load_dwordx4 v[212:215], v2, s[88:91], s12 offen offset:0 sc1
    v_pk_fma_f32 v[68:69], v[168:169], v[152:153], v[68:69] op_sel_hi:[0,1,1] neg_lo:[1,0,0] neg_hi:[1,0,0]
    v_pk_fma_f32 v[70:71], v[168:169], v[154:155], v[70:71] op_sel_hi:[0,1,1] neg_lo:[1,0,0] neg_hi:[1,0,0]
    v_pk_fma_f32 v[72:73], v[168:169], v[156:157], v[72:73] op_sel_hi:[0,1,1] neg_lo:[1,0,0] neg_hi:[1,0,0]
    v_pk_fma_f32 v[74:75], v[168:169], v[158:159], v[74:75] op_sel_hi:[0,1,1] neg_lo:[1,0,0] neg_hi:[1,0,0]
    v_pk_mul_f32 v[192:193], v[68:69], v[68:69]
    v_pk_mul_f32 v[194:195], v[70:71], v[70:71]
    v_pk_mul_f32 v[196:197], v[72:73], v[72:73]
    v_pk_mul_f32 v[198:199], v[74:75], v[74:75]
    v_pk_fma_f32 v[192:193], v[192:193], v[170:171], v[170:171] op_sel:[0,1,0] op_sel_hi:[1,1,0]
    v_pk_fma_f32 v[194:195], v[194:195], v[170:171], v[170:171] op_sel:[0,1,0] op_sel_hi:[1,1,0]
    v_pk_fma_f32 v[196:197], v[196:197], v[170:171], v[170:171] op_sel:[0,1,0] op_sel_hi:[1,1,0]
    v_pk_fma_f32 v[198:199], v[198:199], v[170:171], v[170:171] op_sel:[0,1,0] op_sel_hi:[1,1,0]
    v_pk_mul_f32 v[192:193], v[192:193], v[68:69]
    v_pk_mul_f32 v[194:195], v[194:195], v[70:71]
    v_pk_mul_f32 v[196:197], v[196:197], v[72:73]
    v_pk_mul_f32 v[198:199], v[198:199], v[74:75]
    v_exp_f32 v192, v192
    v_exp_f32 v193, v193
    v_exp_f32 v194, v194
    v_exp_f32 v195, v195
    v_exp_f32 v196, v196
    v_exp_f32 v197, v197
    v_exp_f32 v198, v198
    v_exp_f32 v199, v199
    v_pk_fma_f32 v[192:193], v[192:193], v[168:169], v[168:169] op_sel:[0,1,1] op_sel_hi:[1,1,1]
    v_pk_fma_f32 v[194:195], v[194:195], v[168:169], v[168:169] op_sel:[0,1,1] op_sel_hi:[1,1,1]
    v_pk_fma_f32 v[196:197], v[196:197], v[168:169], v[168:169] op_sel:[0,1,1] op_sel_hi:[1,1,1]
    v_pk_fma_f32 v[198:199], v[198:199], v[168:169], v[168:169] op_sel:[0,1,1] op_sel_hi:[1,1,1]
    v_rcp_f32 v192, v192
    v_rcp_f32 v193, v193
    v_rcp_f32 v194, v194
    v_rcp_f32 v195, v195
    v_rcp_f32 v196, v196
    v_rcp_f32 v197, v197
    v_rcp_f32 v198, v198
    v_rcp_f32 v199, v199
    v_pk_mul_f32 v[68:69], v[68:69], v[192:193]
    v_pk_mul_f32 v[70:71], v[70:71], v[194:195]
    v_pk_mul_f32 v[72:73], v[72:73], v[196:197]
    v_pk_mul_f32 v[74:75], v[74:75], v[198:199]
    v_cvt_pk_bf16_f32 v234, v68, v69
    v_cvt_pk_bf16_f32 v235, v70, v71
    v_cvt_pk_bf16_f32 v236, v72, v73
    v_cvt_pk_bf16_f32 v237, v74, v75
    ds_write_b128 v22, v[234:237] offset:34816
    buffer_load_dwordx4 v[216:219], v255, s[84:87], s14 offen offset:64 sc1
    buffer_load_dwordx4 v[220:223], v2, s[88:91], s12 offen offset:1024 sc1
    v_pk_fma_f32 v[96:97], v[172:173], v[152:153], v[96:97] op_sel_hi:[0,1,1] neg_lo:[1,0,0] neg_hi:[1,0,0]
    v_pk_fma_f32 v[98:99], v[172:173], v[154:155], v[98:99] op_sel_hi:[0,1,1] neg_lo:[1,0,0] neg_hi:[1,0,0]
    v_pk_fma_f32 v[100:101], v[172:173], v[156:157], v[100:101] op_sel_hi:[0,1,1] neg_lo:[1,0,0] neg_hi:[1,0,0]
    v_pk_fma_f32 v[102:103], v[172:173], v[158:159], v[102:103] op_sel_hi:[0,1,1] neg_lo:[1,0,0] neg_hi:[1,0,0]
    v_pk_mul_f32 v[192:193], v[96:97], v[96:97]
    v_pk_mul_f32 v[194:195], v[98:99], v[98:99]
    v_pk_mul_f32 v[196:197], v[100:101], v[100:101]
    v_pk_mul_f32 v[198:199], v[102:103], v[102:103]
    v_pk_fma_f32 v[192:193], v[192:193], v[174:175], v[174:175] op_sel:[0,1,0] op_sel_hi:[1,1,0]
    v_pk_fma_f32 v[194:195], v[194:195], v[174:175], v[174:175] op_sel:[0,1,0] op_sel_hi:[1,1,0]
    v_pk_fma_f32 v[196:197], v[196:197], v[174:175], v[174:175] op_sel:[0,1,0] op_sel_hi:[1,1,0]
    v_pk_fma_f32 v[198:199], v[198:199], v[174:175], v[174:175] op_sel:[0,1,0] op_sel_hi:[1,1,0]
    v_pk_mul_f32 v[192:193], v[192:193], v[96:97]
    v_pk_mul_f32 v[194:195], v[194:195], v[98:99]
    v_pk_mul_f32 v[196:197], v[196:197], v[100:101]
    v_pk_mul_f32 v[198:199], v[198:199], v[102:103]
    v_exp_f32 v192, v192
    v_exp_f32 v193, v193
    v_exp_f32 v194, v194
    v_exp_f32 v195, v195
    v_exp_f32 v196, v196
    v_exp_f32 v197, v197
    v_exp_f32 v198, v198
    v_exp_f32 v199, v199
    v_pk_fma_f32 v[192:193], v[192:193], v[172:173], v[172:173] op_sel:[0,1,1] op_sel_hi:[1,1,1]
    v_pk_fma_f32 v[194:195], v[194:195], v[172:173], v[172:173] op_sel:[0,1,1] op_sel_hi:[1,1,1]
    v_pk_fma_f32 v[196:197], v[196:197], v[172:173], v[172:173] op_sel:[0,1,1] op_sel_hi:[1,1,1]
    v_pk_fma_f32 v[198:199], v[198:199], v[172:173], v[172:173] op_sel:[0,1,1] op_sel_hi:[1,1,1]
    v_rcp_f32 v192, v192
    v_rcp_f32 v193, v193
    v_rcp_f32 v194, v194
    v_rcp_f32 v195, v195
    v_rcp_f32 v196, v196
    v_rcp_f32 v197, v197
    v_rcp_f32 v198, v198
    v_rcp_f32 v199, v199
    v_pk_mul_f32 v[96:97], v[96:97], v[192:193]
    v_pk_mul_f32 v[98:99], v[98:99], v[194:195]
    v_pk_mul_f32 v[100:101], v[100:101], v[196:197]
    v_pk_mul_f32 v[102:103], v[102:103], v[198:199]
    v_cvt_pk_bf16_f32 v238, v96, v97
    v_cvt_pk_bf16_f32 v239, v98, v99
    v_cvt_pk_bf16_f32 v240, v100, v101
    v_cvt_pk_bf16_f32 v241, v102, v103
    ds_write_b128 v23, v[238:241] offset:32768
    v_pk_fma_f32 v[124:125], v[176:177], v[152:153], v[124:125] op_sel_hi:[0,1,1] neg_lo:[1,0,0] neg_hi:[1,0,0]
    v_pk_fma_f32 v[126:127], v[176:177], v[154:155], v[126:127] op_sel_hi:[0,1,1] neg_lo:[1,0,0] neg_hi:[1,0,0]
    v_pk_fma_f32 v[128:129], v[176:177], v[156:157], v[128:129] op_sel_hi:[0,1,1] neg_lo:[1,0,0] neg_hi:[1,0,0]
    v_pk_fma_f32 v[130:131], v[176:177], v[158:159], v[130:131] op_sel_hi:[0,1,1] neg_lo:[1,0,0] neg_hi:[1,0,0]
    v_pk_mul_f32 v[192:193], v[124:125], v[124:125]
    v_pk_mul_f32 v[194:195], v[126:127], v[126:127]
    v_pk_mul_f32 v[196:197], v[128:129], v[128:129]
    v_pk_mul_f32 v[198:199], v[130:131], v[130:131]
    v_pk_fma_f32 v[192:193], v[192:193], v[178:179], v[178:179] op_sel:[0,1,0] op_sel_hi:[1,1,0]
    v_pk_fma_f32 v[194:195], v[194:195], v[178:179], v[178:179] op_sel:[0,1,0] op_sel_hi:[1,1,0]
    v_pk_fma_f32 v[196:197], v[196:197], v[178:179], v[178:179] op_sel:[0,1,0] op_sel_hi:[1,1,0]
    v_pk_fma_f32 v[198:199], v[198:199], v[178:179], v[178:179] op_sel:[0,1,0] op_sel_hi:[1,1,0]
    v_pk_mul_f32 v[192:193], v[192:193], v[124:125]
    v_pk_mul_f32 v[194:195], v[194:195], v[126:127]
    v_pk_mul_f32 v[196:197], v[196:197], v[128:129]
    v_pk_mul_f32 v[198:199], v[198:199], v[130:131]
    v_exp_f32 v192, v192
    v_exp_f32 v193, v193
    v_exp_f32 v194, v194
    v_exp_f32 v195, v195
    v_exp_f32 v196, v196
    v_exp_f32 v197, v197
    v_exp_f32 v198, v198
    v_exp_f32 v199, v199
    v_pk_fma_f32 v[192:193], v[192:193], v[176:177], v[176:177] op_sel:[0,1,1] op_sel_hi:[1,1,1]
    v_pk_fma_f32 v[194:195], v[194:195], v[176:177], v[176:177] op_sel:[0,1,1] op_sel_hi:[1,1,1]
    v_pk_fma_f32 v[196:197], v[196:197], v[176:177], v[176:177] op_sel:[0,1,1] op_sel_hi:[1,1,1]
    v_pk_fma_f32 v[198:199], v[198:199], v[176:177], v[176:177] op_sel:[0,1,1] op_sel_hi:[1,1,1]
    v_rcp_f32 v192, v192
    v_rcp_f32 v193, v193
    v_rcp_f32 v194, v194
    v_rcp_f32 v195, v195
    v_rcp_f32 v196, v196
    v_rcp_f32 v197, v197
    v_rcp_f32 v198, v198
    v_rcp_f32 v199, v199
    v_pk_mul_f32 v[124:125], v[124:125], v[192:193]
    v_pk_mul_f32 v[126:127], v[126:127], v[194:195]
    v_pk_mul_f32 v[128:129], v[128:129], v[196:197]
    v_pk_mul_f32 v[130:131], v[130:131], v[198:199]
    v_cvt_pk_bf16_f32 v242, v124, v125
    v_cvt_pk_bf16_f32 v243, v126, v127
    v_cvt_pk_bf16_f32 v244, v128, v129
    v_cvt_pk_bf16_f32 v245, v130, v131
    ds_write_b128 v23, v[242:245] offset:34816
    v_pk_fma_f32 v[48:49], v[164:165], v[160:161], v[48:49] op_sel_hi:[0,1,1] neg_lo:[1,0,0] neg_hi:[1,0,0]
    v_pk_fma_f32 v[50:51], v[164:165], v[162:163], v[50:51] op_sel_hi:[0,1,1] neg_lo:[1,0,0] neg_hi:[1,0,0]
    v_pk_fma_f32 v[76:77], v[168:169], v[160:161], v[76:77] op_sel_hi:[0,1,1] neg_lo:[1,0,0] neg_hi:[1,0,0]
    v_pk_fma_f32 v[78:79], v[168:169], v[162:163], v[78:79] op_sel_hi:[0,1,1] neg_lo:[1,0,0] neg_hi:[1,0,0]
    v_pk_mul_f32 v[192:193], v[48:49], v[48:49]
    v_pk_mul_f32 v[194:195], v[50:51], v[50:51]
    v_pk_mul_f32 v[196:197], v[76:77], v[76:77]
    v_pk_mul_f32 v[198:199], v[78:79], v[78:79]
    v_pk_fma_f32 v[192:193], v[192:193], v[166:167], v[166:167] op_sel:[0,1,0] op_sel_hi:[1,1,0]
    v_pk_fma_f32 v[194:195], v[194:195], v[166:167], v[166:167] op_sel:[0,1,0] op_sel_hi:[1,1,0]
    v_pk_fma_f32 v[196:197], v[196:197], v[170:171], v[170:171] op_sel:[0,1,0] op_sel_hi:[1,1,0]
    v_pk_fma_f32 v[198:199], v[198:199], v[170:171], v[170:171] op_sel:[0,1,0] op_sel_hi:[1,1,0]
    v_pk_mul_f32 v[192:193], v[192:193], v[48:49]
    v_pk_mul_f32 v[194:195], v[194:195], v[50:51]
    v_pk_mul_f32 v[196:197], v[196:197], v[76:77]
    v_pk_mul_f32 v[198:199], v[198:199], v[78:79]
    v_exp_f32 v192, v192
    v_exp_f32 v193, v193
    v_exp_f32 v194, v194
    v_exp_f32 v195, v195
    v_exp_f32 v196, v196
    v_exp_f32 v197, v197
    v_exp_f32 v198, v198
    v_exp_f32 v199, v199
    v_pk_fma_f32 v[192:193], v[192:193], v[164:165], v[164:165] op_sel:[0,1,1] op_sel_hi:[1,1,1]
    v_pk_fma_f32 v[194:195], v[194:195], v[164:165], v[164:165] op_sel:[0,1,1] op_sel_hi:[1,1,1]
    v_pk_fma_f32 v[196:197], v[196:197], v[168:169], v[168:169] op_sel:[0,1,1] op_sel_hi:[1,1,1]
    v_pk_fma_f32 v[198:199], v[198:199], v[168:169], v[168:169] op_sel:[0,1,1] op_sel_hi:[1,1,1]
    v_rcp_f32 v192, v192
    v_rcp_f32 v193, v193
    v_rcp_f32 v194, v194
    v_rcp_f32 v195, v195
    v_rcp_f32 v196, v196
    v_rcp_f32 v197, v197
    v_rcp_f32 v198, v198
    v_rcp_f32 v199, v199
    v_pk_mul_f32 v[48:49], v[48:49], v[192:193]
    v_pk_mul_f32 v[50:51], v[50:51], v[194:195]
    v_pk_mul_f32 v[76:77], v[76:77], v[196:197]
    v_pk_mul_f32 v[78:79], v[78:79], v[198:199]
    v_cvt_pk_bf16_f32 v246, v48, v49
    v_cvt_pk_bf16_f32 v247, v50, v51
    s_add_u32 s36, s45, 0
    buffer_store_dwordx4 v[32:35], v2, s[16:19], s36 offen sc1
    v_cvt_pk_bf16_f32 v248, v76, v77
    v_cvt_pk_bf16_f32 v249, v78, v79
    s_add_u32 s36, s45, 229376
    buffer_store_dwordx4 v[60:63], v2, s[16:19], s36 offen sc1
    v_pk_fma_f32 v[104:105], v[172:173], v[160:161], v[104:105] op_sel_hi:[0,1,1] neg_lo:[1,0,0] neg_hi:[1,0,0]
    v_pk_fma_f32 v[106:107], v[172:173], v[162:163], v[106:107] op_sel_hi:[0,1,1] neg_lo:[1,0,0] neg_hi:[1,0,0]
    v_pk_fma_f32 v[132:133], v[176:177], v[160:161], v[132:133] op_sel_hi:[0,1,1] neg_lo:[1,0,0] neg_hi:[1,0,0]
    v_pk_fma_f32 v[134:135], v[176:177], v[162:163], v[134:135] op_sel_hi:[0,1,1] neg_lo:[1,0,0] neg_hi:[1,0,0]
    v_pk_mul_f32 v[192:193], v[104:105], v[104:105]
    v_pk_mul_f32 v[194:195], v[106:107], v[106:107]
    v_pk_mul_f32 v[196:197], v[132:133], v[132:133]
    v_pk_mul_f32 v[198:199], v[134:135], v[134:135]
    v_pk_fma_f32 v[192:193], v[192:193], v[174:175], v[174:175] op_sel:[0,1,0] op_sel_hi:[1,1,0]
    v_pk_fma_f32 v[194:195], v[194:195], v[174:175], v[174:175] op_sel:[0,1,0] op_sel_hi:[1,1,0]
    v_pk_fma_f32 v[196:197], v[196:197], v[178:179], v[178:179] op_sel:[0,1,0] op_sel_hi:[1,1,0]
    v_pk_fma_f32 v[198:199], v[198:199], v[178:179], v[178:179] op_sel:[0,1,0] op_sel_hi:[1,1,0]
    v_pk_mul_f32 v[192:193], v[192:193], v[104:105]
    v_pk_mul_f32 v[194:195], v[194:195], v[106:107]
    v_pk_mul_f32 v[196:197], v[196:197], v[132:133]
    v_pk_mul_f32 v[198:199], v[198:199], v[134:135]
    v_exp_f32 v192, v192
    v_exp_f32 v193, v193
    v_exp_f32 v194, v194
    v_exp_f32 v195, v195
    v_exp_f32 v196, v196
    v_exp_f32 v197, v197
    v_exp_f32 v198, v198
    v_exp_f32 v199, v199
    v_pk_fma_f32 v[192:193], v[192:193], v[172:173], v[172:173] op_sel:[0,1,1] op_sel_hi:[1,1,1]
    v_pk_fma_f32 v[194:195], v[194:195], v[172:173], v[172:173] op_sel:[0,1,1] op_sel_hi:[1,1,1]
    v_pk_fma_f32 v[196:197], v[196:197], v[176:177], v[176:177] op_sel:[0,1,1] op_sel_hi:[1,1,1]
    v_pk_fma_f32 v[198:199], v[198:199], v[176:177], v[176:177] op_sel:[0,1,1] op_sel_hi:[1,1,1]
    v_rcp_f32 v192, v192
    v_rcp_f32 v193, v193
    v_rcp_f32 v194, v194
    v_rcp_f32 v195, v195
    v_rcp_f32 v196, v196
    v_rcp_f32 v197, v197
    v_rcp_f32 v198, v198
    v_rcp_f32 v199, v199
    v_pk_mul_f32 v[104:105], v[104:105], v[192:193]
    v_pk_mul_f32 v[106:107], v[106:107], v[194:195]
    v_pk_mul_f32 v[132:133], v[132:133], v[196:197]
    v_pk_mul_f32 v[134:135], v[134:135], v[198:199]
    v_cvt_pk_bf16_f32 v250, v104, v105
    v_cvt_pk_bf16_f32 v251, v106, v107
    s_add_u32 s36, s45, 458752
    buffer_store_dwordx4 v[88:91], v2, s[16:19], s36 offen sc1
    v_cvt_pk_bf16_f32 v252, v132, v133
    v_cvt_pk_bf16_f32 v253, v134, v135
    s_add_u32 s36, s45, 688128
    buffer_store_dwordx4 v[116:119], v2, s[16:19], s36 offen sc1
    s_waitcnt vmcnt(4) lgkmcnt(0)
    v_lshrrev_b32 v18, 2, v1
    v_mul_u32_u24 v13, 256, v18
    v_and_b32 v19, 3, v1
    v_lshl_add_u32 v13, v19, 3, v13
    v_add_u32 v13, 49152, v13
    v_and_b32 v18, 7, v18
    s_mul_i32 s36, s35, 4
    s_add_u32 s36, s36, 3
    v_xor_b32 v19, s36, v18
    v_lshl_add_u32 v16, v19, 5, v13
    s_mul_i32 s36, s35, 4
    s_add_u32 s36, s36, 2
    v_xor_b32 v19, s36, v18
    v_lshl_add_u32 v15, v19, 5, v13
    s_mul_i32 s36, s35, 4
    s_add_u32 s36, s36, 1
    v_xor_b32 v19, s36, v18
    v_lshl_add_u32 v14, v19, 5, v13
    s_mul_i32 s36, s35, 4
    s_add_u32 s36, s36, 0
    v_xor_b32 v19, s36, v18
    v_lshl_add_u32 v13, v19, 5, v13
    s_mov_b32 s42, 0
    s_mov_b32 s43, 0
    s_mov_b32 s48, 0
    v_mov_b32 v17, v12
    v_mov_b32 v18, v13
    v_mov_b32 v19, v14
    v_mov_b32 v20, v15
    v_mov_b32 v21, v16
    v_mov_b32 v56, 0x10000
    s_waitcnt lgkmcnt(0)
    s_barrier
    ds_read_b128 v[24:27], v17 offset:0
    ds_read_b128 v[28:31], v17 offset:2048
    ds_read_b128 v[32:35], v17 offset:4096
    ds_read_b128 v[36:39], v17 offset:6144
    ds_read_b64_tr_b16 v[40:41], v18 offset:0
    ds_read_b64_tr_b16 v[42:43], v18 offset:4096
    ds_read_b64_tr_b16 v[44:45], v19 offset:0
    ds_read_b64_tr_b16 v[46:47], v19 offset:4096
    ds_read_b64_tr_b16 v[48:49], v20 offset:0
    ds_read_b64_tr_b16 v[50:51], v20 offset:4096
    ds_read_b64_tr_b16 v[52:53], v21 offset:0
    ds_read_b64_tr_b16 v[54:55], v21 offset:4096
    v_mfma_f32_16x16x32_bf16 v[120:123], v[226:229], v[180:183], 0
    v_mfma_f32_16x16x32_bf16 v[124:127], v[224:227], v[180:183], 0
    v_mfma_f32_16x16x32_bf16 v[128:131], v[226:229], v[200:203], 0
    v_mfma_f32_16x16x32_bf16 v[132:135], v[224:227], v[200:203], 0
    v_mfma_f32_16x16x32_bf16 v[136:139], v[226:229], v[208:211], 0
    v_mfma_f32_16x16x32_bf16 v[140:143], v[224:227], v[208:211], 0
    v_mfma_f32_16x16x32_bf16 v[144:147], v[226:229], v[216:219], 0
    v_mfma_f32_16x16x32_bf16 v[148:151], v[224:227], v[216:219], 0
    v_mfma_f32_16x16x32_bf16 v[120:123], v[226:229], v[184:187], v[120:123]
    v_mfma_f32_16x16x32_bf16 v[124:127], v[224:227], v[184:187], v[124:127]
    v_mfma_f32_16x16x32_bf16 v[128:131], v[226:229], v[204:207], v[128:131]
    v_mfma_f32_16x16x32_bf16 v[132:135], v[224:227], v[204:207], v[132:135]
    v_mfma_f32_16x16x32_bf16 v[136:139], v[226:229], v[212:215], v[136:139]
    v_mfma_f32_16x16x32_bf16 v[140:143], v[224:227], v[212:215], v[140:143]
    v_mfma_f32_16x16x32_bf16 v[144:147], v[226:229], v[220:223], v[144:147]
    v_mfma_f32_16x16x32_bf16 v[148:151], v[224:227], v[220:223], v[148:151]
    s_waitcnt lgkmcnt(0)
    v_mfma_f32_16x16x32_bf16 v[120:123], v[40:43], v[24:27], v[120:123]
    ds_read_b128 v[184:187], v17 offset:1024
    ds_read_b128 v[188:191], v17 offset:3072
    v_mfma_f32_16x16x32_bf16 v[136:139], v[40:43], v[28:31], v[136:139]
    ds_read_b128 v[192:195], v17 offset:5120
    v_mfma_f32_16x16x32_bf16 v[152:155], v[40:43], v[32:35], 0
    ds_read_b128 v[196:199], v17 offset:7168
    v_mfma_f32_16x16x32_bf16 v[168:171], v[40:43], v[36:39], 0
    s_add_u32 s36, s46, 0
    buffer_store_dwordx4 v[230:233], v2, s[16:19], s36 offen sc1
    v_mfma_f32_16x16x32_bf16 v[172:175], v[44:47], v[36:39], 0
    ds_read_b64_tr_b16 v[200:201], v18 offset:8192
    v_mfma_f32_16x16x32_bf16 v[156:159], v[44:47], v[32:35], 0
    ds_read_b64_tr_b16 v[202:203], v18 offset:12288
    v_mfma_f32_16x16x32_bf16 v[140:143], v[44:47], v[28:31], v[140:143]
    ds_read_b64_tr_b16 v[204:205], v19 offset:8192
    s_add_u32 s36, s47, 0
    buffer_store_dwordx2 v[246:247], v254, s[16:19], s36 offen sc1
    v_mfma_f32_16x16x32_bf16 v[124:127], v[44:47], v[24:27], v[124:127]
    ds_read_b64_tr_b16 v[206:207], v19 offset:12288
    v_mfma_f32_16x16x32_bf16 v[128:131], v[48:51], v[24:27], v[128:131]
    ds_read_b64_tr_b16 v[208:209], v20 offset:8192
    v_mfma_f32_16x16x32_bf16 v[144:147], v[48:51], v[28:31], v[144:147]
    ds_read_b64_tr_b16 v[210:211], v20 offset:12288
    v_mfma_f32_16x16x32_bf16 v[160:163], v[48:51], v[32:35], 0
    ds_read_b64_tr_b16 v[212:213], v21 offset:8192
    v_mfma_f32_16x16x32_bf16 v[176:179], v[48:51], v[36:39], 0
    ds_read_b64_tr_b16 v[214:215], v21 offset:12288
    s_add_u32 s42, s42, 16384
    s_cmp_eq_u32 s42, 49152
    s_cselect_b32 s42, 0, s42
    v_mfma_f32_16x16x32_bf16 v[180:183], v[52:55], v[36:39], 0
    s_add_u32 s48, s48, 16384
    s_cmp_eq_u32 s48, 98304
    s_cselect_b32 s48, 0, s48
    v_mfma_f32_16x16x32_bf16 v[164:167], v[52:55], v[32:35], 0
    v_add_u32 v17, s42, v12
    v_add_u32 v18, s48, v13
    v_add_u32 v19, s48, v14
    v_mfma_f32_16x16x32_bf16 v[148:151], v[52:55], v[28:31], v[148:151]
    v_add_u32 v20, s48, v15
    v_add_u32 v21, s48, v16
    v_mfma_f32_16x16x32_bf16 v[132:135], v[52:55], v[24:27], v[132:135]
    s_waitcnt lgkmcnt(0)
    s_barrier
    v_mfma_f32_16x16x32_bf16 v[120:123], v[200:203], v[184:187], v[120:123]
    ds_read_b128 v[24:27], v17 offset:0
    ds_read_b128 v[28:31], v17 offset:2048
    v_mfma_f32_16x16x32_bf16 v[136:139], v[200:203], v[188:191], v[136:139]
    ds_read_b128 v[32:35], v17 offset:4096
    v_mfma_f32_16x16x32_bf16 v[152:155], v[200:203], v[192:195], v[152:155]
    ds_read_b128 v[36:39], v17 offset:6144
    v_mfma_f32_16x16x32_bf16 v[168:171], v[200:203], v[196:199], v[168:171]
    s_add_u32 s36, s46, 229376
    buffer_store_dwordx4 v[234:237], v2, s[16:19], s36 offen sc1
    v_mfma_f32_16x16x32_bf16 v[172:175], v[204:207], v[196:199], v[172:175]
    ds_read_b64_tr_b16 v[40:41], v18 offset:0
    v_mfma_f32_16x16x32_bf16 v[156:159], v[204:207], v[192:195], v[156:159]
    ds_read_b64_tr_b16 v[42:43], v18 offset:4096
    v_mfma_f32_16x16x32_bf16 v[140:143], v[204:207], v[188:191], v[140:143]
    ds_read_b64_tr_b16 v[44:45], v19 offset:0
    s_add_u32 s36, s47, 229376
    buffer_store_dwordx2 v[248:249], v254, s[16:19], s36 offen sc1
    v_mfma_f32_16x16x32_bf16 v[124:127], v[204:207], v[184:187], v[124:127]
    ds_read_b64_tr_b16 v[46:47], v19 offset:4096
    v_mfma_f32_16x16x32_bf16 v[128:131], v[208:211], v[184:187], v[128:131]
    ds_read_b64_tr_b16 v[48:49], v20 offset:0
    v_mfma_f32_16x16x32_bf16 v[144:147], v[208:211], v[188:191], v[144:147]
    ds_read_b64_tr_b16 v[50:51], v20 offset:4096
    v_mfma_f32_16x16x32_bf16 v[160:163], v[208:211], v[192:195], v[160:163]
    ds_read_b64_tr_b16 v[52:53], v21 offset:0
    v_mfma_f32_16x16x32_bf16 v[176:179], v[208:211], v[196:199], v[176:179]
    ds_read_b64_tr_b16 v[54:55], v21 offset:4096
    s_add_u32 s43, s43, 1
    v_mfma_f32_16x16x32_bf16 v[180:183], v[212:215], v[196:199], v[180:183]
    s_cmp_lt_u32 s43, 27
    v_mfma_f32_16x16x32_bf16 v[164:167], v[212:215], v[192:195], v[164:167]
    v_mfma_f32_16x16x32_bf16 v[148:151], v[212:215], v[188:191], v[148:151]
    v_mfma_f32_16x16x32_bf16 v[132:135], v[212:215], v[184:187], v[132:135]
    s_waitcnt lgkmcnt(0)
    v_mfma_f32_16x16x32_bf16 v[120:123], v[40:43], v[24:27], v[120:123]
    ds_read_b128 v[184:187], v17 offset:1024
    ds_read_b128 v[188:191], v17 offset:3072
    v_mfma_f32_16x16x32_bf16 v[136:139], v[40:43], v[28:31], v[136:139]
    ds_read_b128 v[192:195], v17 offset:5120
    v_mfma_f32_16x16x32_bf16 v[152:155], v[40:43], v[32:35], v[152:155]
    ds_read_b128 v[196:199], v17 offset:7168
    v_mfma_f32_16x16x32_bf16 v[168:171], v[40:43], v[36:39], v[168:171]
    s_add_u32 s36, s46, 458752
    buffer_store_dwordx4 v[238:241], v2, s[16:19], s36 offen sc1
    v_mfma_f32_16x16x32_bf16 v[172:175], v[44:47], v[36:39], v[172:175]
    ds_read_b64_tr_b16 v[200:201], v18 offset:8192
    v_mfma_f32_16x16x32_bf16 v[156:159], v[44:47], v[32:35], v[156:159]
    ds_read_b64_tr_b16 v[202:203], v18 offset:12288
    v_mfma_f32_16x16x32_bf16 v[140:143], v[44:47], v[28:31], v[140:143]
    ds_read_b64_tr_b16 v[204:205], v19 offset:8192
    s_add_u32 s36, s47, 458752
    buffer_store_dwordx2 v[250:251], v254, s[16:19], s36 offen sc1
    v_mfma_f32_16x16x32_bf16 v[124:127], v[44:47], v[24:27], v[124:127]
    ds_read_b64_tr_b16 v[206:207], v19 offset:12288
    v_mfma_f32_16x16x32_bf16 v[128:131], v[48:51], v[24:27], v[128:131]
    ds_read_b64_tr_b16 v[208:209], v20 offset:8192
    v_mfma_f32_16x16x32_bf16 v[144:147], v[48:51], v[28:31], v[144:147]
    ds_read_b64_tr_b16 v[210:211], v20 offset:12288
    v_mfma_f32_16x16x32_bf16 v[160:163], v[48:51], v[32:35], v[160:163]
    ds_read_b64_tr_b16 v[212:213], v21 offset:8192
    v_mfma_f32_16x16x32_bf16 v[176:179], v[48:51], v[36:39], v[176:179]
    ds_read_b64_tr_b16 v[214:215], v21 offset:12288
    s_add_u32 s42, s42, 16384
    s_cmp_eq_u32 s42, 49152
    s_cselect_b32 s42, 0, s42
    v_mfma_f32_16x16x32_bf16 v[180:183], v[52:55], v[36:39], v[180:183]
    s_add_u32 s48, s48, 16384
    s_cmp_eq_u32 s48, 98304
    s_cselect_b32 s48, 0, s48
    v_mfma_f32_16x16x32_bf16 v[164:167], v[52:55], v[32:35], v[164:167]
    v_add_u32 v17, s42, v12
    v_add_u32 v18, s48, v13
    v_add_u32 v19, s48, v14
    v_mfma_f32_16x16x32_bf16 v[148:151], v[52:55], v[28:31], v[148:151]
    v_add_u32 v20, s48, v15
    v_add_u32 v21, s48, v16
    v_mfma_f32_16x16x32_bf16 v[132:135], v[52:55], v[24:27], v[132:135]
    s_waitcnt lgkmcnt(0)
    s_barrier
    v_mfma_f32_16x16x32_bf16 v[120:123], v[200:203], v[184:187], v[120:123]
    ds_read_b128 v[24:27], v17 offset:0
    ds_read_b128 v[28:31], v17 offset:2048
    v_mfma_f32_16x16x32_bf16 v[136:139], v[200:203], v[188:191], v[136:139]
    ds_read_b128 v[32:35], v17 offset:4096
    v_mfma_f32_16x16x32_bf16 v[152:155], v[200:203], v[192:195], v[152:155]
    ds_read_b128 v[36:39], v17 offset:6144
    v_mfma_f32_16x16x32_bf16 v[168:171], v[200:203], v[196:199], v[168:171]
    s_add_u32 s36, s46, 688128
    buffer_store_dwordx4 v[242:245], v2, s[16:19], s36 offen sc1
    v_mfma_f32_16x16x32_bf16 v[172:175], v[204:207], v[196:199], v[172:175]
    ds_read_b64_tr_b16 v[40:41], v18 offset:0
    v_mfma_f32_16x16x32_bf16 v[156:159], v[204:207], v[192:195], v[156:159]
    ds_read_b64_tr_b16 v[42:43], v18 offset:4096
    v_mfma_f32_16x16x32_bf16 v[140:143], v[204:207], v[188:191], v[140:143]
    ds_read_b64_tr_b16 v[44:45], v19 offset:0
    s_add_u32 s36, s47, 688128
    buffer_store_dwordx2 v[252:253], v254, s[16:19], s36 offen sc1
    v_mfma_f32_16x16x32_bf16 v[124:127], v[204:207], v[184:187], v[124:127]
    ds_read_b64_tr_b16 v[46:47], v19 offset:4096
    v_mfma_f32_16x16x32_bf16 v[128:131], v[208:211], v[184:187], v[128:131]
    ds_read_b64_tr_b16 v[48:49], v20 offset:0
    v_mfma_f32_16x16x32_bf16 v[144:147], v[208:211], v[188:191], v[144:147]
    ds_read_b64_tr_b16 v[50:51], v20 offset:4096
    v_mfma_f32_16x16x32_bf16 v[160:163], v[208:211], v[192:195], v[160:163]
    ds_read_b64_tr_b16 v[52:53], v21 offset:0
    v_mfma_f32_16x16x32_bf16 v[176:179], v[208:211], v[196:199], v[176:179]
    ds_read_b64_tr_b16 v[54:55], v21 offset:4096
    s_add_u32 s43, s43, 1
    v_mfma_f32_16x16x32_bf16 v[180:183], v[212:215], v[196:199], v[180:183]
    s_cmp_lt_u32 s43, 27
    v_mfma_f32_16x16x32_bf16 v[164:167], v[212:215], v[192:195], v[164:167]
    v_mfma_f32_16x16x32_bf16 v[148:151], v[212:215], v[188:191], v[148:151]
    v_mfma_f32_16x16x32_bf16 v[132:135], v[212:215], v[184:187], v[132:135]
    s_waitcnt vmcnt(8)
    buffer_atomic_add v8, v9, s[56:59], s49 offen offset:512 sc1
mm_21:
    s_waitcnt lgkmcnt(0)
    v_mfma_f32_16x16x32_bf16 v[120:123], v[40:43], v[24:27], v[120:123]
    ds_read_b128 v[184:187], v17 offset:1024
    v_mfma_f32_16x16x32_bf16 v[136:139], v[40:43], v[28:31], v[136:139]
    ds_read_b128 v[188:191], v17 offset:3072
    v_mfma_f32_16x16x32_bf16 v[152:155], v[40:43], v[32:35], v[152:155]
    ds_read_b128 v[192:195], v17 offset:5120
    v_mfma_f32_16x16x32_bf16 v[168:171], v[40:43], v[36:39], v[168:171]
    ds_read_b128 v[196:199], v17 offset:7168
    v_mfma_f32_16x16x32_bf16 v[172:175], v[44:47], v[36:39], v[172:175]
    ds_read_b64_tr_b16 v[200:201], v18 offset:8192
    v_mfma_f32_16x16x32_bf16 v[156:159], v[44:47], v[32:35], v[156:159]
    ds_read_b64_tr_b16 v[202:203], v18 offset:12288
    v_mfma_f32_16x16x32_bf16 v[140:143], v[44:47], v[28:31], v[140:143]
    ds_read_b64_tr_b16 v[204:205], v19 offset:8192
    v_mfma_f32_16x16x32_bf16 v[124:127], v[44:47], v[24:27], v[124:127]
    ds_read_b64_tr_b16 v[206:207], v19 offset:12288
    v_mfma_f32_16x16x32_bf16 v[128:131], v[48:51], v[24:27], v[128:131]
    ds_read_b64_tr_b16 v[208:209], v20 offset:8192
    v_mfma_f32_16x16x32_bf16 v[144:147], v[48:51], v[28:31], v[144:147]
    ds_read_b64_tr_b16 v[210:211], v20 offset:12288
    v_mfma_f32_16x16x32_bf16 v[160:163], v[48:51], v[32:35], v[160:163]
    ds_read_b64_tr_b16 v[212:213], v21 offset:8192
    v_mfma_f32_16x16x32_bf16 v[176:179], v[48:51], v[36:39], v[176:179]
    ds_read_b64_tr_b16 v[214:215], v21 offset:12288
    s_add_u32 s42, s42, 16384
    s_cmp_eq_u32 s42, 49152
    s_cselect_b32 s42, 0, s42
    v_mfma_f32_16x16x32_bf16 v[180:183], v[52:55], v[36:39], v[180:183]
    s_add_u32 s48, s48, 16384
    s_cmp_eq_u32 s48, 98304
    s_cselect_b32 s48, 0, s48
    v_mfma_f32_16x16x32_bf16 v[164:167], v[52:55], v[32:35], v[164:167]
    v_add_u32 v17, s42, v12
    v_add_u32 v18, s48, v13
    v_add_u32 v19, s48, v14
    v_mfma_f32_16x16x32_bf16 v[148:151], v[52:55], v[28:31], v[148:151]
    v_add_u32 v20, s48, v15
    v_add_u32 v21, s48, v16
    v_mfma_f32_16x16x32_bf16 v[132:135], v[52:55], v[24:27], v[132:135]
    s_waitcnt lgkmcnt(0)
    s_barrier
    v_mfma_f32_16x16x32_bf16 v[120:123], v[200:203], v[184:187], v[120:123]
    ds_read_b128 v[24:27], v17 offset:0
    v_mfma_f32_16x16x32_bf16 v[136:139], v[200:203], v[188:191], v[136:139]
    ds_read_b128 v[28:31], v17 offset:2048
    v_mfma_f32_16x16x32_bf16 v[152:155], v[200:203], v[192:195], v[152:155]
    ds_read_b128 v[32:35], v17 offset:4096
    v_mfma_f32_16x16x32_bf16 v[168:171], v[200:203], v[196:199], v[168:171]
    ds_read_b128 v[36:39], v17 offset:6144
    v_mfma_f32_16x16x32_bf16 v[172:175], v[204:207], v[196:199], v[172:175]
    ds_read_b64_tr_b16 v[40:41], v18 offset:0
    v_mfma_f32_16x16x32_bf16 v[156:159], v[204:207], v[192:195], v[156:159]
    ds_read_b64_tr_b16 v[42:43], v18 offset:4096
    v_mfma_f32_16x16x32_bf16 v[140:143], v[204:207], v[188:191], v[140:143]
    ds_read_b64_tr_b16 v[44:45], v19 offset:0
    v_mfma_f32_16x16x32_bf16 v[124:127], v[204:207], v[184:187], v[124:127]
    ds_read_b64_tr_b16 v[46:47], v19 offset:4096
    v_mfma_f32_16x16x32_bf16 v[128:131], v[208:211], v[184:187], v[128:131]
    ds_read_b64_tr_b16 v[48:49], v20 offset:0
    v_mfma_f32_16x16x32_bf16 v[144:147], v[208:211], v[188:191], v[144:147]
    ds_read_b64_tr_b16 v[50:51], v20 offset:4096
    v_mfma_f32_16x16x32_bf16 v[160:163], v[208:211], v[192:195], v[160:163]
    ds_read_b64_tr_b16 v[52:53], v21 offset:0
    v_mfma_f32_16x16x32_bf16 v[176:179], v[208:211], v[196:199], v[176:179]
    ds_read_b64_tr_b16 v[54:55], v21 offset:4096
    s_add_u32 s43, s43, 1
    v_mfma_f32_16x16x32_bf16 v[180:183], v[212:215], v[196:199], v[180:183]
    s_cmp_lt_u32 s43, 4
    v_mfma_f32_16x16x32_bf16 v[164:167], v[212:215], v[192:195], v[164:167]
    v_mfma_f32_16x16x32_bf16 v[148:151], v[212:215], v[188:191], v[148:151]
    v_mfma_f32_16x16x32_bf16 v[132:135], v[212:215], v[184:187], v[132:135]
    s_cbranch_scc1 mm_21
    s_waitcnt vmcnt(0)
    buffer_atomic_add v8, v9, s[56:59], s49 offen offset:1024 sc1
mm_22:
    s_waitcnt lgkmcnt(0)
    v_mfma_f32_16x16x32_bf16 v[120:123], v[40:43], v[24:27], v[120:123]
    ds_read_b128 v[184:187], v17 offset:1024
    v_mfma_f32_16x16x32_bf16 v[136:139], v[40:43], v[28:31], v[136:139]
    ds_read_b128 v[188:191], v17 offset:3072
    v_mfma_f32_16x16x32_bf16 v[152:155], v[40:43], v[32:35], v[152:155]
    ds_read_b128 v[192:195], v17 offset:5120
    v_mfma_f32_16x16x32_bf16 v[168:171], v[40:43], v[36:39], v[168:171]
    ds_read_b128 v[196:199], v17 offset:7168
    v_mfma_f32_16x16x32_bf16 v[172:175], v[44:47], v[36:39], v[172:175]
    ds_read_b64_tr_b16 v[200:201], v18 offset:8192
    v_mfma_f32_16x16x32_bf16 v[156:159], v[44:47], v[32:35], v[156:159]
    ds_read_b64_tr_b16 v[202:203], v18 offset:12288
    v_mfma_f32_16x16x32_bf16 v[140:143], v[44:47], v[28:31], v[140:143]
    ds_read_b64_tr_b16 v[204:205], v19 offset:8192
    v_mfma_f32_16x16x32_bf16 v[124:127], v[44:47], v[24:27], v[124:127]
    ds_read_b64_tr_b16 v[206:207], v19 offset:12288
    v_mfma_f32_16x16x32_bf16 v[128:131], v[48:51], v[24:27], v[128:131]
    ds_read_b64_tr_b16 v[208:209], v20 offset:8192
    v_mfma_f32_16x16x32_bf16 v[144:147], v[48:51], v[28:31], v[144:147]
    ds_read_b64_tr_b16 v[210:211], v20 offset:12288
    v_mfma_f32_16x16x32_bf16 v[160:163], v[48:51], v[32:35], v[160:163]
    ds_read_b64_tr_b16 v[212:213], v21 offset:8192
    v_mfma_f32_16x16x32_bf16 v[176:179], v[48:51], v[36:39], v[176:179]
    ds_read_b64_tr_b16 v[214:215], v21 offset:12288
    s_add_u32 s42, s42, 16384
    s_cmp_eq_u32 s42, 49152
    s_cselect_b32 s42, 0, s42
    v_mfma_f32_16x16x32_bf16 v[180:183], v[52:55], v[36:39], v[180:183]
    s_add_u32 s48, s48, 16384
    s_cmp_eq_u32 s48, 98304
    s_cselect_b32 s48, 0, s48
    v_mfma_f32_16x16x32_bf16 v[164:167], v[52:55], v[32:35], v[164:167]
    v_add_u32 v17, s42, v12
    v_add_u32 v18, s48, v13
    v_add_u32 v19, s48, v14
    v_mfma_f32_16x16x32_bf16 v[148:151], v[52:55], v[28:31], v[148:151]
    v_add_u32 v20, s48, v15
    v_add_u32 v21, s48, v16
    v_mfma_f32_16x16x32_bf16 v[132:135], v[52:55], v[24:27], v[132:135]
    s_waitcnt lgkmcnt(0)
    s_barrier
    v_mfma_f32_16x16x32_bf16 v[120:123], v[200:203], v[184:187], v[120:123]
    ds_read_b128 v[24:27], v17 offset:0
    v_mfma_f32_16x16x32_bf16 v[136:139], v[200:203], v[188:191], v[136:139]
    ds_read_b128 v[28:31], v17 offset:2048
    v_mfma_f32_16x16x32_bf16 v[152:155], v[200:203], v[192:195], v[152:155]
    ds_read_b128 v[32:35], v17 offset:4096
    v_mfma_f32_16x16x32_bf16 v[168:171], v[200:203], v[196:199], v[168:171]
    ds_read_b128 v[36:39], v17 offset:6144
    v_mfma_f32_16x16x32_bf16 v[172:175], v[204:207], v[196:199], v[172:175]
    ds_read_b64_tr_b16 v[40:41], v18 offset:0
    v_mfma_f32_16x16x32_bf16 v[156:159], v[204:207], v[192:195], v[156:159]
    ds_read_b64_tr_b16 v[42:43], v18 offset:4096
    v_mfma_f32_16x16x32_bf16 v[140:143], v[204:207], v[188:191], v[140:143]
    ds_read_b64_tr_b16 v[44:45], v19 offset:0
    v_mfma_f32_16x16x32_bf16 v[124:127], v[204:207], v[184:187], v[124:127]
    ds_read_b64_tr_b16 v[46:47], v19 offset:4096
    v_mfma_f32_16x16x32_bf16 v[128:131], v[208:211], v[184:187], v[128:131]
    ds_read_b64_tr_b16 v[48:49], v20 offset:0
    v_mfma_f32_16x16x32_bf16 v[144:147], v[208:211], v[188:191], v[144:147]
    ds_read_b64_tr_b16 v[50:51], v20 offset:4096
    v_mfma_f32_16x16x32_bf16 v[160:163], v[208:211], v[192:195], v[160:163]
    ds_read_b64_tr_b16 v[52:53], v21 offset:0
    v_mfma_f32_16x16x32_bf16 v[176:179], v[208:211], v[196:199], v[176:179]
    ds_read_b64_tr_b16 v[54:55], v21 offset:4096
    s_add_u32 s43, s43, 1
    v_mfma_f32_16x16x32_bf16 v[180:183], v[212:215], v[196:199], v[180:183]
    s_cmp_lt_u32 s43, 21
    v_mfma_f32_16x16x32_bf16 v[164:167], v[212:215], v[192:195], v[164:167]
    v_mfma_f32_16x16x32_bf16 v[148:151], v[212:215], v[188:191], v[148:151]
    v_mfma_f32_16x16x32_bf16 v[132:135], v[212:215], v[184:187], v[132:135]
    s_cbranch_scc1 mm_22
    s_waitcnt lgkmcnt(0)
    v_mfma_f32_16x16x32_bf16 v[120:123], v[40:43], v[24:27], v[120:123]
    ds_read_b128 v[184:187], v17 offset:1024
    v_mfma_f32_16x16x32_bf16 v[136:139], v[40:43], v[28:31], v[136:139]
    ds_read_b128 v[188:191], v17 offset:3072
    v_mfma_f32_16x16x32_bf16 v[152:155], v[40:43], v[32:35], v[152:155]
    ds_read_b128 v[192:195], v17 offset:5120
    v_mfma_f32_16x16x32_bf16 v[168:171], v[40:43], v[36:39], v[168:171]
    ds_read_b128 v[196:199], v17 offset:7168
    v_mfma_f32_16x16x32_bf16 v[172:175], v[44:47], v[36:39], v[172:175]
    ds_read_b64_tr_b16 v[200:201], v18 offset:8192
    v_mfma_f32_16x16x32_bf16 v[156:159], v[44:47], v[32:35], v[156:159]
    ds_read_b64_tr_b16 v[202:203], v18 offset:12288
    v_mfma_f32_16x16x32_bf16 v[140:143], v[44:47], v[28:31], v[140:143]
    ds_read_b64_tr_b16 v[204:205], v19 offset:8192
    v_mfma_f32_16x16x32_bf16 v[124:127], v[44:47], v[24:27], v[124:127]
    ds_read_b64_tr_b16 v[206:207], v19 offset:12288
    v_mfma_f32_16x16x32_bf16 v[128:131], v[48:51], v[24:27], v[128:131]
    ds_read_b64_tr_b16 v[208:209], v20 offset:8192
    v_mfma_f32_16x16x32_bf16 v[144:147], v[48:51], v[28:31], v[144:147]
    ds_read_b64_tr_b16 v[210:211], v20 offset:12288
    v_mfma_f32_16x16x32_bf16 v[160:163], v[48:51], v[32:35], v[160:163]
    ds_read_b64_tr_b16 v[212:213], v21 offset:8192
    v_mfma_f32_16x16x32_bf16 v[176:179], v[48:51], v[36:39], v[176:179]
    ds_read_b64_tr_b16 v[214:215], v21 offset:12288
    v_add_u32 v18, 49152, v13
    v_mfma_f32_16x16x32_bf16 v[180:183], v[52:55], v[36:39], v[180:183]
    v_add_u32 v19, 49152, v14
    v_mfma_f32_16x16x32_bf16 v[164:167], v[52:55], v[32:35], v[164:167]
    v_add_u32 v20, 49152, v15
    v_mfma_f32_16x16x32_bf16 v[148:151], v[52:55], v[28:31], v[148:151]
    v_add_u32 v21, 49152, v16
    v_mfma_f32_16x16x32_bf16 v[132:135], v[52:55], v[24:27], v[132:135]
    s_waitcnt lgkmcnt(0)
    s_barrier
    v_mfma_f32_16x16x32_bf16 v[120:123], v[200:203], v[184:187], v[120:123]
    ds_read_b128 v[232:235], v12 offset:16384
    ds_read_b128 v[236:239], v12 offset:18432
    v_mfma_f32_16x16x32_bf16 v[136:139], v[200:203], v[188:191], v[136:139]
    ds_read_b128 v[240:243], v12 offset:17408
    ds_read_b128 v[244:247], v12 offset:19456
    v_mfma_f32_16x16x32_bf16 v[152:155], v[200:203], v[192:195], v[152:155]
    ds_read_b64_tr_b16 v[24:25], v18 offset:16384
    v_mfma_f32_16x16x32_bf16 v[168:171], v[200:203], v[196:199], v[168:171]
    ds_read_b64_tr_b16 v[26:27], v18 offset:20480
    ds_read_b64_tr_b16 v[28:29], v19 offset:16384
    v_mfma_f32_16x16x32_bf16 v[172:175], v[204:207], v[196:199], v[172:175]
    ds_read_b64_tr_b16 v[30:31], v19 offset:20480
    ds_read_b64_tr_b16 v[32:33], v20 offset:16384
    v_mfma_f32_16x16x32_bf16 v[156:159], v[204:207], v[192:195], v[156:159]
    ds_read_b64_tr_b16 v[34:35], v20 offset:20480
    v_mfma_f32_16x16x32_bf16 v[140:143], v[204:207], v[188:191], v[140:143]
    ds_read_b64_tr_b16 v[36:37], v21 offset:16384
    ds_read_b64_tr_b16 v[38:39], v21 offset:20480
    v_mfma_f32_16x16x32_bf16 v[124:127], v[204:207], v[184:187], v[124:127]
    ds_read_b64_tr_b16 v[40:41], v18 offset:24576
    ds_read_b64_tr_b16 v[42:43], v18 offset:28672
    v_mfma_f32_16x16x32_bf16 v[128:131], v[208:211], v[184:187], v[128:131]
    ds_read_b64_tr_b16 v[44:45], v19 offset:24576
    v_mfma_f32_16x16x32_bf16 v[144:147], v[208:211], v[188:191], v[144:147]
    ds_read_b64_tr_b16 v[46:47], v19 offset:28672
    ds_read_b64_tr_b16 v[48:49], v20 offset:24576
    v_mfma_f32_16x16x32_bf16 v[160:163], v[208:211], v[192:195], v[160:163]
    ds_read_b64_tr_b16 v[50:51], v20 offset:28672
    ds_read_b64_tr_b16 v[52:53], v21 offset:24576
    v_mfma_f32_16x16x32_bf16 v[176:179], v[208:211], v[196:199], v[176:179]
    ds_read_b64_tr_b16 v[54:55], v21 offset:28672
    v_mfma_f32_16x16x32_bf16 v[180:183], v[212:215], v[196:199], v[180:183]
    v_mfma_f32_16x16x32_bf16 v[164:167], v[212:215], v[192:195], v[164:167]
    v_mfma_f32_16x16x32_bf16 v[148:151], v[212:215], v[188:191], v[148:151]
    v_mfma_f32_16x16x32_bf16 v[132:135], v[212:215], v[184:187], v[132:135]
    s_waitcnt lgkmcnt(8)
    v_mfma_f32_16x16x32_bf16 v[152:155], v[24:27], v[232:235], v[152:155]
    ds_read_b128 v[88:91], v12 offset:20480
    ds_read_b128 v[92:95], v12 offset:22528
    v_mfma_f32_16x16x32_bf16 v[168:171], v[24:27], v[236:239], v[168:171]
    ds_read_b128 v[96:99], v12 offset:21504
    v_mfma_f32_16x16x32_bf16 v[172:175], v[28:31], v[236:239], v[172:175]
    ds_read_b128 v[100:103], v12 offset:23552
    v_mfma_f32_16x16x32_bf16 v[156:159], v[28:31], v[232:235], v[156:159]
    ds_read_b64_tr_b16 v[184:185], v18 offset:32768
    v_mfma_f32_16x16x32_bf16 v[160:163], v[32:35], v[232:235], v[160:163]
    ds_read_b64_tr_b16 v[186:187], v18 offset:36864
    ds_read_b64_tr_b16 v[188:189], v19 offset:32768
    v_mfma_f32_16x16x32_bf16 v[176:179], v[32:35], v[236:239], v[176:179]
    ds_read_b64_tr_b16 v[190:191], v19 offset:36864
    v_mfma_f32_16x16x32_bf16 v[180:183], v[36:39], v[236:239], v[180:183]
    ds_read_b64_tr_b16 v[192:193], v20 offset:32768
    v_mfma_f32_16x16x32_bf16 v[164:167], v[36:39], v[232:235], v[164:167]
    ds_read_b64_tr_b16 v[194:195], v20 offset:36864
    s_waitcnt lgkmcnt(10)
    v_mfma_f32_16x16x32_bf16 v[152:155], v[40:43], v[240:243], v[152:155]
    ds_read_b64_tr_b16 v[196:197], v21 offset:32768
    ds_read_b64_tr_b16 v[198:199], v21 offset:36864
    v_mfma_f32_16x16x32_bf16 v[168:171], v[40:43], v[244:247], v[168:171]
    ds_read_b64_tr_b16 v[200:201], v18 offset:40960
    v_mfma_f32_16x16x32_bf16 v[172:175], v[44:47], v[244:247], v[172:175]
    ds_read_b64_tr_b16 v[202:203], v18 offset:45056
    v_mfma_f32_16x16x32_bf16 v[156:159], v[44:47], v[240:243], v[156:159]
    ds_read_b64_tr_b16 v[204:205], v19 offset:40960
    v_mfma_f32_16x16x32_bf16 v[160:163], v[48:51], v[240:243], v[160:163]
    ds_read_b64_tr_b16 v[206:207], v19 offset:45056
    ds_read_b64_tr_b16 v[208:209], v20 offset:40960
    v_mfma_f32_16x16x32_bf16 v[176:179], v[48:51], v[244:247], v[176:179]
    ds_read_b64_tr_b16 v[210:211], v20 offset:45056
    v_mfma_f32_16x16x32_bf16 v[180:183], v[52:55], v[244:247], v[180:183]
    ds_read_b64_tr_b16 v[212:213], v21 offset:40960
    v_mfma_f32_16x16x32_bf16 v[164:167], v[52:55], v[240:243], v[164:167]
    ds_read_b64_tr_b16 v[214:215], v21 offset:45056
    s_waitcnt lgkmcnt(8)
    s_barrier
    v_mfma_f32_16x16x32_bf16 v[152:155], v[184:187], v[88:91], v[152:155]
    ds_read_b128 v[232:235], v12 offset:32768
    ds_read_b128 v[236:239], v12 offset:34816
    v_mfma_f32_16x16x32_bf16 v[168:171], v[184:187], v[92:95], v[168:171]
    ds_read_b128 v[240:243], v12 offset:33792
    v_mfma_f32_16x16x32_bf16 v[172:175], v[188:191], v[92:95], v[172:175]
    ds_read_b128 v[244:247], v12 offset:35840
    v_mfma_f32_16x16x32_bf16 v[156:159], v[188:191], v[88:91], v[156:159]
    ds_read_b64_tr_b16 v[24:25], v13 offset:0
    v_mfma_f32_16x16x32_bf16 v[160:163], v[192:195], v[88:91], v[160:163]
    ds_read_b64_tr_b16 v[26:27], v13 offset:4096
    ds_read_b64_tr_b16 v[28:29], v14 offset:0
    v_mfma_f32_16x16x32_bf16 v[176:179], v[192:195], v[92:95], v[176:179]
    ds_read_b64_tr_b16 v[30:31], v14 offset:4096
    v_mfma_f32_16x16x32_bf16 v[180:183], v[196:199], v[92:95], v[180:183]
    ds_read_b64_tr_b16 v[32:33], v15 offset:0
    v_mfma_f32_16x16x32_bf16 v[164:167], v[196:199], v[88:91], v[164:167]
    ds_read_b64_tr_b16 v[34:35], v15 offset:4096
    s_waitcnt lgkmcnt(10)
    v_mfma_f32_16x16x32_bf16 v[152:155], v[200:203], v[96:99], v[152:155]
    ds_read_b64_tr_b16 v[36:37], v16 offset:0
    ds_read_b64_tr_b16 v[38:39], v16 offset:4096
    v_mfma_f32_16x16x32_bf16 v[168:171], v[200:203], v[100:103], v[168:171]
    ds_read_b64_tr_b16 v[40:41], v13 offset:8192
    v_mfma_f32_16x16x32_bf16 v[172:175], v[204:207], v[100:103], v[172:175]
    ds_read_b64_tr_b16 v[42:43], v13 offset:12288
    v_mfma_f32_16x16x32_bf16 v[156:159], v[204:207], v[96:99], v[156:159]
    ds_read_b64_tr_b16 v[44:45], v14 offset:8192
    v_mfma_f32_16x16x32_bf16 v[160:163], v[208:211], v[96:99], v[160:163]
    ds_read_b64_tr_b16 v[46:47], v14 offset:12288
    ds_read_b64_tr_b16 v[48:49], v15 offset:8192
    v_mfma_f32_16x16x32_bf16 v[176:179], v[208:211], v[100:103], v[176:179]
    ds_read_b64_tr_b16 v[50:51], v15 offset:12288
    v_mfma_f32_16x16x32_bf16 v[180:183], v[212:215], v[100:103], v[180:183]
    ds_read_b64_tr_b16 v[52:53], v16 offset:8192
    v_mfma_f32_16x16x32_bf16 v[164:167], v[212:215], v[96:99], v[164:167]
    ds_read_b64_tr_b16 v[54:55], v16 offset:12288
    s_waitcnt lgkmcnt(8)
    v_mfma_f32_16x16x32_bf16 v[152:155], v[24:27], v[232:235], v[152:155]
    ds_read_b128 v[88:91], v12 offset:36864
    ds_read_b128 v[92:95], v12 offset:38912
    v_mfma_f32_16x16x32_bf16 v[168:171], v[24:27], v[236:239], v[168:171]
    ds_read_b128 v[96:99], v12 offset:37888
    v_mfma_f32_16x16x32_bf16 v[172:175], v[28:31], v[236:239], v[172:175]
    ds_read_b128 v[100:103], v12 offset:39936
    v_mfma_f32_16x16x32_bf16 v[156:159], v[28:31], v[232:235], v[156:159]
    ds_read_b64_tr_b16 v[184:185], v13 offset:16384
    v_mfma_f32_16x16x32_bf16 v[160:163], v[32:35], v[232:235], v[160:163]
    ds_read_b64_tr_b16 v[186:187], v13 offset:20480
    ds_read_b64_tr_b16 v[188:189], v14 offset:16384
    v_mfma_f32_16x16x32_bf16 v[176:179], v[32:35], v[236:239], v[176:179]
    ds_read_b64_tr_b16 v[190:191], v14 offset:20480
    v_mfma_f32_16x16x32_bf16 v[180:183], v[36:39], v[236:239], v[180:183]
    ds_read_b64_tr_b16 v[192:193], v15 offset:16384
    v_mfma_f32_16x16x32_bf16 v[164:167], v[36:39], v[232:235], v[164:167]
    ds_read_b64_tr_b16 v[194:195], v15 offset:20480
    s_waitcnt lgkmcnt(10)
    v_mfma_f32_16x16x32_bf16 v[152:155], v[40:43], v[240:243], v[152:155]
    ds_read_b64_tr_b16 v[196:197], v16 offset:16384
    ds_read_b64_tr_b16 v[198:199], v16 offset:20480
    v_mfma_f32_16x16x32_bf16 v[168:171], v[40:43], v[244:247], v[168:171]
    ds_read_b64_tr_b16 v[200:201], v13 offset:24576
    v_mfma_f32_16x16x32_bf16 v[172:175], v[44:47], v[244:247], v[172:175]
    ds_read_b64_tr_b16 v[202:203], v13 offset:28672
    v_mfma_f32_16x16x32_bf16 v[156:159], v[44:47], v[240:243], v[156:159]
    ds_read_b64_tr_b16 v[204:205], v14 offset:24576
    v_mfma_f32_16x16x32_bf16 v[160:163], v[48:51], v[240:243], v[160:163]
    ds_read_b64_tr_b16 v[206:207], v14 offset:28672
    ds_read_b64_tr_b16 v[208:209], v15 offset:24576
    v_mfma_f32_16x16x32_bf16 v[176:179], v[48:51], v[244:247], v[176:179]
    ds_read_b64_tr_b16 v[210:211], v15 offset:28672
    v_mfma_f32_16x16x32_bf16 v[180:183], v[52:55], v[244:247], v[180:183]
    ds_read_b64_tr_b16 v[212:213], v16 offset:24576
    v_mfma_f32_16x16x32_bf16 v[164:167], v[52:55], v[240:243], v[164:167]
    ds_read_b64_tr_b16 v[214:215], v16 offset:28672
    s_waitcnt lgkmcnt(8)
    s_barrier
    v_mfma_f32_16x16x32_bf16 v[152:155], v[184:187], v[88:91], v[152:155]
    ds_read_b128 v[232:235], v12 offset:0
    ds_read_b128 v[236:239], v12 offset:2048
    v_mfma_f32_16x16x32_bf16 v[168:171], v[184:187], v[92:95], v[168:171]
    ds_read_b128 v[240:243], v12 offset:1024
    v_mfma_f32_16x16x32_bf16 v[172:175], v[188:191], v[92:95], v[172:175]
    ds_read_b128 v[244:247], v12 offset:3072
    v_mfma_f32_16x16x32_bf16 v[156:159], v[188:191], v[88:91], v[156:159]
    ds_read_b64_tr_b16 v[24:25], v13 offset:32768
    v_mfma_f32_16x16x32_bf16 v[160:163], v[192:195], v[88:91], v[160:163]
    ds_read_b64_tr_b16 v[26:27], v13 offset:36864
    ds_read_b64_tr_b16 v[28:29], v14 offset:32768
    v_mfma_f32_16x16x32_bf16 v[176:179], v[192:195], v[92:95], v[176:179]
    ds_read_b64_tr_b16 v[30:31], v14 offset:36864
    v_mfma_f32_16x16x32_bf16 v[180:183], v[196:199], v[92:95], v[180:183]
    ds_read_b64_tr_b16 v[32:33], v15 offset:32768
    v_mfma_f32_16x16x32_bf16 v[164:167], v[196:199], v[88:91], v[164:167]
    ds_read_b64_tr_b16 v[34:35], v15 offset:36864
    s_waitcnt lgkmcnt(10)
    v_mfma_f32_16x16x32_bf16 v[152:155], v[200:203], v[96:99], v[152:155]
    ds_read_b64_tr_b16 v[36:37], v16 offset:32768
    ds_read_b64_tr_b16 v[38:39], v16 offset:36864
    v_mfma_f32_16x16x32_bf16 v[168:171], v[200:203], v[100:103], v[168:171]
    ds_read_b64_tr_b16 v[40:41], v13 offset:40960
    v_mfma_f32_16x16x32_bf16 v[172:175], v[204:207], v[100:103], v[172:175]
    ds_read_b64_tr_b16 v[42:43], v13 offset:45056
    v_mfma_f32_16x16x32_bf16 v[156:159], v[204:207], v[96:99], v[156:159]
    ds_read_b64_tr_b16 v[44:45], v14 offset:40960
    v_mfma_f32_16x16x32_bf16 v[160:163], v[208:211], v[96:99], v[160:163]
    ds_read_b64_tr_b16 v[46:47], v14 offset:45056
    ds_read_b64_tr_b16 v[48:49], v15 offset:40960
    v_mfma_f32_16x16x32_bf16 v[176:179], v[208:211], v[100:103], v[176:179]
    ds_read_b64_tr_b16 v[50:51], v15 offset:45056
    v_mfma_f32_16x16x32_bf16 v[180:183], v[212:215], v[100:103], v[180:183]
    ds_read_b64_tr_b16 v[52:53], v16 offset:40960
    v_mfma_f32_16x16x32_bf16 v[164:167], v[212:215], v[96:99], v[164:167]
    ds_read_b64_tr_b16 v[54:55], v16 offset:45056
    s_waitcnt lgkmcnt(8)
    v_mfma_f32_16x16x32_bf16 v[152:155], v[24:27], v[232:235], v[152:155]
    ds_read_b128 v[88:91], v12 offset:4096
    ds_read_b128 v[92:95], v12 offset:6144
    v_mfma_f32_16x16x32_bf16 v[168:171], v[24:27], v[236:239], v[168:171]
    ds_read_b128 v[96:99], v12 offset:5120
    v_mfma_f32_16x16x32_bf16 v[172:175], v[28:31], v[236:239], v[172:175]
    ds_read_b128 v[100:103], v12 offset:7168
    v_mfma_f32_16x16x32_bf16 v[156:159], v[28:31], v[232:235], v[156:159]
    ds_read_b64_tr_b16 v[184:185], v18 offset:0
    v_mfma_f32_16x16x32_bf16 v[160:163], v[32:35], v[232:235], v[160:163]
    ds_read_b64_tr_b16 v[186:187], v18 offset:4096
    ds_read_b64_tr_b16 v[188:189], v19 offset:0
    v_mfma_f32_16x16x32_bf16 v[176:179], v[32:35], v[236:239], v[176:179]
    ds_read_b64_tr_b16 v[190:191], v19 offset:4096
    v_mfma_f32_16x16x32_bf16 v[180:183], v[36:39], v[236:239], v[180:183]
    ds_read_b64_tr_b16 v[192:193], v20 offset:0
    v_mfma_f32_16x16x32_bf16 v[164:167], v[36:39], v[232:235], v[164:167]
    ds_read_b64_tr_b16 v[194:195], v20 offset:4096
    s_waitcnt lgkmcnt(10)
    v_mfma_f32_16x16x32_bf16 v[152:155], v[40:43], v[240:243], v[152:155]
    ds_read_b64_tr_b16 v[196:197], v21 offset:0
    ds_read_b64_tr_b16 v[198:199], v21 offset:4096
    v_mfma_f32_16x16x32_bf16 v[168:171], v[40:43], v[244:247], v[168:171]
    ds_read_b64_tr_b16 v[200:201], v18 offset:8192
    v_mfma_f32_16x16x32_bf16 v[172:175], v[44:47], v[244:247], v[172:175]
    ds_read_b64_tr_b16 v[202:203], v18 offset:12288
    v_mfma_f32_16x16x32_bf16 v[156:159], v[44:47], v[240:243], v[156:159]
    ds_read_b64_tr_b16 v[204:205], v19 offset:8192
    v_mfma_f32_16x16x32_bf16 v[160:163], v[48:51], v[240:243], v[160:163]
    ds_read_b64_tr_b16 v[206:207], v19 offset:12288
    ds_read_b64_tr_b16 v[208:209], v20 offset:8192
    v_mfma_f32_16x16x32_bf16 v[176:179], v[48:51], v[244:247], v[176:179]
    ds_read_b64_tr_b16 v[210:211], v20 offset:12288
    v_mfma_f32_16x16x32_bf16 v[180:183], v[52:55], v[244:247], v[180:183]
    ds_read_b64_tr_b16 v[212:213], v21 offset:8192
    v_mfma_f32_16x16x32_bf16 v[164:167], v[52:55], v[240:243], v[164:167]
    ds_read_b64_tr_b16 v[214:215], v21 offset:12288
    s_waitcnt lgkmcnt(8)
    s_barrier
    v_mfma_f32_16x16x32_bf16 v[152:155], v[184:187], v[88:91], v[152:155]
    ds_read_b128 v[232:235], v12 offset:16384
    ds_read_b128 v[236:239], v12 offset:18432
    v_mfma_f32_16x16x32_bf16 v[168:171], v[184:187], v[92:95], v[168:171]
    ds_read_b128 v[240:243], v12 offset:17408
    v_mfma_f32_16x16x32_bf16 v[172:175], v[188:191], v[92:95], v[172:175]
    ds_read_b128 v[244:247], v12 offset:19456
    v_mfma_f32_16x16x32_bf16 v[156:159], v[188:191], v[88:91], v[156:159]
    ds_read_b64_tr_b16 v[24:25], v18 offset:16384
    v_mfma_f32_16x16x32_bf16 v[160:163], v[192:195], v[88:91], v[160:163]
    ds_read_b64_tr_b16 v[26:27], v18 offset:20480
    ds_read_b64_tr_b16 v[28:29], v19 offset:16384
    v_mfma_f32_16x16x32_bf16 v[176:179], v[192:195], v[92:95], v[176:179]
    ds_read_b64_tr_b16 v[30:31], v19 offset:20480
    v_mfma_f32_16x16x32_bf16 v[180:183], v[196:199], v[92:95], v[180:183]
    ds_read_b64_tr_b16 v[32:33], v20 offset:16384
    v_mfma_f32_16x16x32_bf16 v[164:167], v[196:199], v[88:91], v[164:167]
    ds_read_b64_tr_b16 v[34:35], v20 offset:20480
    s_waitcnt lgkmcnt(10)
    v_mfma_f32_16x16x32_bf16 v[152:155], v[200:203], v[96:99], v[152:155]
    ds_read_b64_tr_b16 v[36:37], v21 offset:16384
    ds_read_b64_tr_b16 v[38:39], v21 offset:20480
    v_mfma_f32_16x16x32_bf16 v[168:171], v[200:203], v[100:103], v[168:171]
    ds_read_b64_tr_b16 v[40:41], v18 offset:24576
    v_mfma_f32_16x16x32_bf16 v[172:175], v[204:207], v[100:103], v[172:175]
    ds_read_b64_tr_b16 v[42:43], v18 offset:28672
    v_mfma_f32_16x16x32_bf16 v[156:159], v[204:207], v[96:99], v[156:159]
    ds_read_b64_tr_b16 v[44:45], v19 offset:24576
    v_mfma_f32_16x16x32_bf16 v[160:163], v[208:211], v[96:99], v[160:163]
    ds_read_b64_tr_b16 v[46:47], v19 offset:28672
    ds_read_b64_tr_b16 v[48:49], v20 offset:24576
    v_mfma_f32_16x16x32_bf16 v[176:179], v[208:211], v[100:103], v[176:179]
    ds_read_b64_tr_b16 v[50:51], v20 offset:28672
    v_mfma_f32_16x16x32_bf16 v[180:183], v[212:215], v[100:103], v[180:183]
    ds_read_b64_tr_b16 v[52:53], v21 offset:24576
    v_mfma_f32_16x16x32_bf16 v[164:167], v[212:215], v[96:99], v[164:167]
    ds_read_b64_tr_b16 v[54:55], v21 offset:28672
    s_waitcnt lgkmcnt(8)
    v_mfma_f32_16x16x32_bf16 v[120:123], v[24:27], v[232:235], v[120:123]
    ds_read_b128 v[88:91], v12 offset:20480
    ds_read_b128 v[92:95], v12 offset:22528
    v_mfma_f32_16x16x32_bf16 v[136:139], v[24:27], v[236:239], v[136:139]
    ds_read_b128 v[96:99], v12 offset:21504
    v_mfma_f32_16x16x32_bf16 v[140:143], v[28:31], v[236:239], v[140:143]
    ds_read_b128 v[100:103], v12 offset:23552
    v_mfma_f32_16x16x32_bf16 v[124:127], v[28:31], v[232:235], v[124:127]
    ds_read_b64_tr_b16 v[184:185], v18 offset:32768
    v_and_or_b32 v152, v152, s15, v56
    v_and_or_b32 v154, v154, s15, v56
    v_and_or_b32 v156, v156, s15, v56
    v_and_or_b32 v158, v158, s15, v56
    v_cvt_pk_bf16_f32 v152, v152, v153
    v_cvt_pk_bf16_f32 v153, v154, v155
    v_cvt_pk_bf16_f32 v154, v156, v157
    v_cvt_pk_bf16_f32 v155, v158, v159
    buffer_store_dwordx4 v[152:155], v2, s[24:27], s41 offen offset:0 sc1
    v_and_or_b32 v160, v160, s15, v56
    v_and_or_b32 v162, v162, s15, v56
    v_and_or_b32 v164, v164, s15, v56
    v_and_or_b32 v166, v166, s15, v56
    v_cvt_pk_bf16_f32 v160, v160, v161
    v_cvt_pk_bf16_f32 v161, v162, v163
    v_cvt_pk_bf16_f32 v162, v164, v165
    v_cvt_pk_bf16_f32 v163, v166, v167
    buffer_store_dwordx4 v[160:163], v2, s[24:27], s41 offen offset:1024 sc1
    s_add_u32 s36, s41, 65536
    v_and_or_b32 v168, v168, s15, v56
    v_and_or_b32 v170, v170, s15, v56
    v_and_or_b32 v172, v172, s15, v56
    v_and_or_b32 v174, v174, s15, v56
    v_cvt_pk_bf16_f32 v168, v168, v169
    v_cvt_pk_bf16_f32 v169, v170, v171
    v_cvt_pk_bf16_f32 v170, v172, v173
    v_cvt_pk_bf16_f32 v171, v174, v175
    buffer_store_dwordx4 v[168:171], v2, s[24:27], s36 offen offset:0 sc1
    v_and_or_b32 v176, v176, s15, v56
    v_and_or_b32 v178, v178, s15, v56
    v_and_or_b32 v180, v180, s15, v56
    v_and_or_b32 v182, v182, s15, v56
    v_cvt_pk_bf16_f32 v176, v176, v177
    v_cvt_pk_bf16_f32 v177, v178, v179
    v_cvt_pk_bf16_f32 v178, v180, v181
    v_cvt_pk_bf16_f32 v179, v182, v183
    buffer_store_dwordx4 v[176:179], v2, s[24:27], s36 offen offset:1024 sc1
    v_mfma_f32_16x16x32_bf16 v[128:131], v[32:35], v[232:235], v[128:131]
    ds_read_b64_tr_b16 v[186:187], v18 offset:36864
    ds_read_b64_tr_b16 v[188:189], v19 offset:32768
    v_mfma_f32_16x16x32_bf16 v[144:147], v[32:35], v[236:239], v[144:147]
    ds_read_b64_tr_b16 v[190:191], v19 offset:36864
    v_mfma_f32_16x16x32_bf16 v[148:151], v[36:39], v[236:239], v[148:151]
    ds_read_b64_tr_b16 v[192:193], v20 offset:32768
    v_mfma_f32_16x16x32_bf16 v[132:135], v[36:39], v[232:235], v[132:135]
    ds_read_b64_tr_b16 v[194:195], v20 offset:36864
    s_waitcnt lgkmcnt(10)
    v_mfma_f32_16x16x32_bf16 v[120:123], v[40:43], v[240:243], v[120:123]
    ds_read_b64_tr_b16 v[196:197], v21 offset:32768
    ds_read_b64_tr_b16 v[198:199], v21 offset:36864
    v_mfma_f32_16x16x32_bf16 v[136:139], v[40:43], v[244:247], v[136:139]
    ds_read_b64_tr_b16 v[200:201], v18 offset:40960
    v_mfma_f32_16x16x32_bf16 v[140:143], v[44:47], v[244:247], v[140:143]
    ds_read_b64_tr_b16 v[202:203], v18 offset:45056
    v_mfma_f32_16x16x32_bf16 v[124:127], v[44:47], v[240:243], v[124:127]
    ds_read_b64_tr_b16 v[204:205], v19 offset:40960
    v_mfma_f32_16x16x32_bf16 v[128:131], v[48:51], v[240:243], v[128:131]
    ds_read_b64_tr_b16 v[206:207], v19 offset:45056
    ds_read_b64_tr_b16 v[208:209], v20 offset:40960
    v_mfma_f32_16x16x32_bf16 v[144:147], v[48:51], v[244:247], v[144:147]
    ds_read_b64_tr_b16 v[210:211], v20 offset:45056
    v_mfma_f32_16x16x32_bf16 v[148:151], v[52:55], v[244:247], v[148:151]
    ds_read_b64_tr_b16 v[212:213], v21 offset:40960
    v_mfma_f32_16x16x32_bf16 v[132:135], v[52:55], v[240:243], v[132:135]
    ds_read_b64_tr_b16 v[214:215], v21 offset:45056
    s_waitcnt lgkmcnt(8)
    s_barrier
    v_mfma_f32_16x16x32_bf16 v[120:123], v[184:187], v[88:91], v[120:123]
    ds_read_b128 v[232:235], v12 offset:32768
    ds_read_b128 v[236:239], v12 offset:34816
    v_mfma_f32_16x16x32_bf16 v[136:139], v[184:187], v[92:95], v[136:139]
    ds_read_b128 v[240:243], v12 offset:33792
    v_mfma_f32_16x16x32_bf16 v[140:143], v[188:191], v[92:95], v[140:143]
    ds_read_b128 v[244:247], v12 offset:35840
    v_mfma_f32_16x16x32_bf16 v[124:127], v[188:191], v[88:91], v[124:127]
    ds_read_b64_tr_b16 v[24:25], v13 offset:0
    v_mfma_f32_16x16x32_bf16 v[128:131], v[192:195], v[88:91], v[128:131]
    ds_read_b64_tr_b16 v[26:27], v13 offset:4096
    ds_read_b64_tr_b16 v[28:29], v14 offset:0
    v_mfma_f32_16x16x32_bf16 v[144:147], v[192:195], v[92:95], v[144:147]
    ds_read_b64_tr_b16 v[30:31], v14 offset:4096
    v_mfma_f32_16x16x32_bf16 v[148:151], v[196:199], v[92:95], v[148:151]
    ds_read_b64_tr_b16 v[32:33], v15 offset:0
    v_mfma_f32_16x16x32_bf16 v[132:135], v[196:199], v[88:91], v[132:135]
    ds_read_b64_tr_b16 v[34:35], v15 offset:4096
    s_waitcnt lgkmcnt(10)
    v_mfma_f32_16x16x32_bf16 v[120:123], v[200:203], v[96:99], v[120:123]
    ds_read_b64_tr_b16 v[36:37], v16 offset:0
    ds_read_b64_tr_b16 v[38:39], v16 offset:4096
    v_mfma_f32_16x16x32_bf16 v[136:139], v[200:203], v[100:103], v[136:139]
    ds_read_b64_tr_b16 v[40:41], v13 offset:8192
    v_mfma_f32_16x16x32_bf16 v[140:143], v[204:207], v[100:103], v[140:143]
    ds_read_b64_tr_b16 v[42:43], v13 offset:12288
    v_mfma_f32_16x16x32_bf16 v[124:127], v[204:207], v[96:99], v[124:127]
    ds_read_b64_tr_b16 v[44:45], v14 offset:8192
    v_mfma_f32_16x16x32_bf16 v[128:131], v[208:211], v[96:99], v[128:131]
    ds_read_b64_tr_b16 v[46:47], v14 offset:12288
    ds_read_b64_tr_b16 v[48:49], v15 offset:8192
    v_mfma_f32_16x16x32_bf16 v[144:147], v[208:211], v[100:103], v[144:147]
    ds_read_b64_tr_b16 v[50:51], v15 offset:12288
    v_mfma_f32_16x16x32_bf16 v[148:151], v[212:215], v[100:103], v[148:151]
    ds_read_b64_tr_b16 v[52:53], v16 offset:8192
    v_mfma_f32_16x16x32_bf16 v[132:135], v[212:215], v[96:99], v[132:135]
    ds_read_b64_tr_b16 v[54:55], v16 offset:12288
    s_waitcnt lgkmcnt(8)
    v_mfma_f32_16x16x32_bf16 v[120:123], v[24:27], v[232:235], v[120:123]
    ds_read_b128 v[88:91], v12 offset:36864
    ds_read_b128 v[92:95], v12 offset:38912
    v_mfma_f32_16x16x32_bf16 v[136:139], v[24:27], v[236:239], v[136:139]
    ds_read_b128 v[96:99], v12 offset:37888
    v_mfma_f32_16x16x32_bf16 v[140:143], v[28:31], v[236:239], v[140:143]
    ds_read_b128 v[100:103], v12 offset:39936
    v_mfma_f32_16x16x32_bf16 v[124:127], v[28:31], v[232:235], v[124:127]
    ds_read_b64_tr_b16 v[184:185], v13 offset:16384
    v_mfma_f32_16x16x32_bf16 v[128:131], v[32:35], v[232:235], v[128:131]
    ds_read_b64_tr_b16 v[186:187], v13 offset:20480
    ds_read_b64_tr_b16 v[188:189], v14 offset:16384
    v_mfma_f32_16x16x32_bf16 v[144:147], v[32:35], v[236:239], v[144:147]
    ds_read_b64_tr_b16 v[190:191], v14 offset:20480
    v_mfma_f32_16x16x32_bf16 v[148:151], v[36:39], v[236:239], v[148:151]
    ds_read_b64_tr_b16 v[192:193], v15 offset:16384
    v_mfma_f32_16x16x32_bf16 v[132:135], v[36:39], v[232:235], v[132:135]
    ds_read_b64_tr_b16 v[194:195], v15 offset:20480
    s_waitcnt lgkmcnt(10)
    v_mfma_f32_16x16x32_bf16 v[120:123], v[40:43], v[240:243], v[120:123]
    ds_read_b64_tr_b16 v[196:197], v16 offset:16384
    ds_read_b64_tr_b16 v[198:199], v16 offset:20480
    v_mfma_f32_16x16x32_bf16 v[136:139], v[40:43], v[244:247], v[136:139]
    ds_read_b64_tr_b16 v[200:201], v13 offset:24576
    v_mfma_f32_16x16x32_bf16 v[140:143], v[44:47], v[244:247], v[140:143]
    ds_read_b64_tr_b16 v[202:203], v13 offset:28672
    v_mfma_f32_16x16x32_bf16 v[124:127], v[44:47], v[240:243], v[124:127]
    ds_read_b64_tr_b16 v[204:205], v14 offset:24576
    v_mfma_f32_16x16x32_bf16 v[128:131], v[48:51], v[240:243], v[128:131]
    ds_read_b64_tr_b16 v[206:207], v14 offset:28672
    ds_read_b64_tr_b16 v[208:209], v15 offset:24576
    v_mfma_f32_16x16x32_bf16 v[144:147], v[48:51], v[244:247], v[144:147]
    ds_read_b64_tr_b16 v[210:211], v15 offset:28672
    v_mfma_f32_16x16x32_bf16 v[148:151], v[52:55], v[244:247], v[148:151]
    ds_read_b64_tr_b16 v[212:213], v16 offset:24576
    v_mfma_f32_16x16x32_bf16 v[132:135], v[52:55], v[240:243], v[132:135]
    ds_read_b64_tr_b16 v[214:215], v16 offset:28672
    s_waitcnt lgkmcnt(8)
    s_barrier
    v_mfma_f32_16x16x32_bf16 v[120:123], v[184:187], v[88:91], v[120:123]
    ds_read_b128 v[232:235], v12 offset:0
    ds_read_b128 v[236:239], v12 offset:2048
    v_mfma_f32_16x16x32_bf16 v[136:139], v[184:187], v[92:95], v[136:139]
    ds_read_b128 v[240:243], v12 offset:1024
    v_mfma_f32_16x16x32_bf16 v[140:143], v[188:191], v[92:95], v[140:143]
    ds_read_b128 v[244:247], v12 offset:3072
    v_mfma_f32_16x16x32_bf16 v[124:127], v[188:191], v[88:91], v[124:127]
    ds_read_b64_tr_b16 v[24:25], v13 offset:32768
    v_mfma_f32_16x16x32_bf16 v[128:131], v[192:195], v[88:91], v[128:131]
    ds_read_b64_tr_b16 v[26:27], v13 offset:36864
    ds_read_b64_tr_b16 v[28:29], v14 offset:32768
    v_mfma_f32_16x16x32_bf16 v[144:147], v[192:195], v[92:95], v[144:147]
    ds_read_b64_tr_b16 v[30:31], v14 offset:36864
    v_mfma_f32_16x16x32_bf16 v[148:151], v[196:199], v[92:95], v[148:151]
    ds_read_b64_tr_b16 v[32:33], v15 offset:32768
    v_mfma_f32_16x16x32_bf16 v[132:135], v[196:199], v[88:91], v[132:135]
    ds_read_b64_tr_b16 v[34:35], v15 offset:36864
    s_waitcnt lgkmcnt(10)
    v_mfma_f32_16x16x32_bf16 v[120:123], v[200:203], v[96:99], v[120:123]
    ds_read_b64_tr_b16 v[36:37], v16 offset:32768
    ds_read_b64_tr_b16 v[38:39], v16 offset:36864
    v_mfma_f32_16x16x32_bf16 v[136:139], v[200:203], v[100:103], v[136:139]
    ds_read_b64_tr_b16 v[40:41], v13 offset:40960
    v_mfma_f32_16x16x32_bf16 v[140:143], v[204:207], v[100:103], v[140:143]
    ds_read_b64_tr_b16 v[42:43], v13 offset:45056
    v_mfma_f32_16x16x32_bf16 v[124:127], v[204:207], v[96:99], v[124:127]
    ds_read_b64_tr_b16 v[44:45], v14 offset:40960
    v_mfma_f32_16x16x32_bf16 v[128:131], v[208:211], v[96:99], v[128:131]
    ds_read_b64_tr_b16 v[46:47], v14 offset:45056
    ds_read_b64_tr_b16 v[48:49], v15 offset:40960
    v_mfma_f32_16x16x32_bf16 v[144:147], v[208:211], v[100:103], v[144:147]
    ds_read_b64_tr_b16 v[50:51], v15 offset:45056
    v_mfma_f32_16x16x32_bf16 v[148:151], v[212:215], v[100:103], v[148:151]
    ds_read_b64_tr_b16 v[52:53], v16 offset:40960
    v_mfma_f32_16x16x32_bf16 v[132:135], v[212:215], v[96:99], v[132:135]
    ds_read_b64_tr_b16 v[54:55], v16 offset:45056
    s_waitcnt lgkmcnt(8)
    v_mfma_f32_16x16x32_bf16 v[120:123], v[24:27], v[232:235], v[120:123]
    ds_read_b128 v[88:91], v12 offset:4096
    ds_read_b128 v[92:95], v12 offset:6144
    v_mfma_f32_16x16x32_bf16 v[136:139], v[24:27], v[236:239], v[136:139]
    ds_read_b128 v[96:99], v12 offset:5120
    v_mfma_f32_16x16x32_bf16 v[140:143], v[28:31], v[236:239], v[140:143]
    ds_read_b128 v[100:103], v12 offset:7168
    v_mfma_f32_16x16x32_bf16 v[124:127], v[28:31], v[232:235], v[124:127]
    ds_read_b64_tr_b16 v[184:185], v18 offset:0
    buffer_load_dwordx4 v[152:155], v2, s[24:27], s40 offen offset:0 sc1
    buffer_load_dwordx4 v[156:159], v2, s[24:27], s40 offen offset:1024 sc1
    buffer_load_dwordx4 v[160:163], v2, s[24:27], s12 offen offset:0 sc1
    buffer_load_dwordx4 v[164:167], v2, s[24:27], s12 offen offset:1024 sc1
    v_mfma_f32_16x16x32_bf16 v[128:131], v[32:35], v[232:235], v[128:131]
    ds_read_b64_tr_b16 v[186:187], v18 offset:4096
    ds_read_b64_tr_b16 v[188:189], v19 offset:0
    v_mfma_f32_16x16x32_bf16 v[144:147], v[32:35], v[236:239], v[144:147]
    ds_read_b64_tr_b16 v[190:191], v19 offset:4096
    v_mfma_f32_16x16x32_bf16 v[148:151], v[36:39], v[236:239], v[148:151]
    ds_read_b64_tr_b16 v[192:193], v20 offset:0
    v_mfma_f32_16x16x32_bf16 v[132:135], v[36:39], v[232:235], v[132:135]
    ds_read_b64_tr_b16 v[194:195], v20 offset:4096
    s_waitcnt lgkmcnt(10)
    v_mfma_f32_16x16x32_bf16 v[120:123], v[40:43], v[240:243], v[120:123]
    ds_read_b64_tr_b16 v[196:197], v21 offset:0
    ds_read_b64_tr_b16 v[198:199], v21 offset:4096
    v_mfma_f32_16x16x32_bf16 v[136:139], v[40:43], v[244:247], v[136:139]
    ds_read_b64_tr_b16 v[200:201], v18 offset:8192
    v_mfma_f32_16x16x32_bf16 v[140:143], v[44:47], v[244:247], v[140:143]
    ds_read_b64_tr_b16 v[202:203], v18 offset:12288
    v_mfma_f32_16x16x32_bf16 v[124:127], v[44:47], v[240:243], v[124:127]
    ds_read_b64_tr_b16 v[204:205], v19 offset:8192
    v_mfma_f32_16x16x32_bf16 v[128:131], v[48:51], v[240:243], v[128:131]
    ds_read_b64_tr_b16 v[206:207], v19 offset:12288
    ds_read_b64_tr_b16 v[208:209], v20 offset:8192
    v_mfma_f32_16x16x32_bf16 v[144:147], v[48:51], v[244:247], v[144:147]
    ds_read_b64_tr_b16 v[210:211], v20 offset:12288
    v_mfma_f32_16x16x32_bf16 v[148:151], v[52:55], v[244:247], v[148:151]
    ds_read_b64_tr_b16 v[212:213], v21 offset:8192
    v_mfma_f32_16x16x32_bf16 v[132:135], v[52:55], v[240:243], v[132:135]
    ds_read_b64_tr_b16 v[214:215], v21 offset:12288
    s_waitcnt lgkmcnt(8)
    v_mfma_f32_16x16x32_bf16 v[120:123], v[184:187], v[88:91], v[120:123]
    v_mfma_f32_16x16x32_bf16 v[136:139], v[184:187], v[92:95], v[136:139]
    v_mfma_f32_16x16x32_bf16 v[140:143], v[188:191], v[92:95], v[140:143]
    v_mfma_f32_16x16x32_bf16 v[124:127], v[188:191], v[88:91], v[124:127]
    v_mfma_f32_16x16x32_bf16 v[128:131], v[192:195], v[88:91], v[128:131]
    v_mfma_f32_16x16x32_bf16 v[144:147], v[192:195], v[92:95], v[144:147]
    v_mfma_f32_16x16x32_bf16 v[148:151], v[196:199], v[92:95], v[148:151]
    v_mfma_f32_16x16x32_bf16 v[132:135], v[196:199], v[88:91], v[132:135]
    s_waitcnt lgkmcnt(0)
    s_barrier
    v_mfma_f32_16x16x32_bf16 v[120:123], v[200:203], v[96:99], v[120:123]
    v_mfma_f32_16x16x32_bf16 v[136:139], v[200:203], v[100:103], v[136:139]
    v_mfma_f32_16x16x32_bf16 v[140:143], v[204:207], v[100:103], v[140:143]
    v_mfma_f32_16x16x32_bf16 v[124:127], v[204:207], v[96:99], v[124:127]
    v_mfma_f32_16x16x32_bf16 v[128:131], v[208:211], v[96:99], v[128:131]
    v_mfma_f32_16x16x32_bf16 v[144:147], v[208:211], v[100:103], v[144:147]
    v_mfma_f32_16x16x32_bf16 v[148:151], v[212:215], v[100:103], v[148:151]
    v_mfma_f32_16x16x32_bf16 v[132:135], v[212:215], v[96:99], v[132:135]
    s_mov_b32 s53, 0
dw_23:
    s_waitcnt vmcnt(0)
    v_and_b32 v6, v152, v153
    v_and_b32 v7, v160, v161
    v_bitop3_b32 v6, v154, v155, v6 bitop3:0x80
    v_bitop3_b32 v7, v162, v163, v7 bitop3:0x80
    v_bitop3_b32 v6, v156, v157, v6 bitop3:0x80
    v_bitop3_b32 v7, v164, v165, v7 bitop3:0x80
    v_bitop3_b32 v6, v158, v159, v6 bitop3:0x80
    v_bitop3_b32 v7, v166, v167, v7 bitop3:0x80
    v_bitop3_b32 v6, v6, v7, 1 bitop3:0x80
    v_cmp_eq_u32 vcc, 0, v6
    s_nop 0
    s_cmp_eq_u64 vcc, 0
    s_cbranch_scc1 dok_24
    s_mov_b64 exec, vcc
    s_sleep 1
    buffer_load_dwordx4 v[152:155], v2, s[24:27], s40 offen offset:0 sc1
    buffer_load_dwordx4 v[156:159], v2, s[24:27], s40 offen offset:1024 sc1
    buffer_load_dwordx4 v[160:163], v2, s[24:27], s12 offen offset:0 sc1
    buffer_load_dwordx4 v[164:167], v2, s[24:27], s12 offen offset:1024 sc1
    s_add_u32 s53, s53, 1
    s_cmp_lt_u32 s53, s61
    s_cbranch_scc1 dw_23
    s_mov_b32 s61, 0
    s_waitcnt vmcnt(0)
dok_24:
    s_mov_b64 exec, -1
    v_mfma_f32_16x16x32_bf16 v[120:123], v[226:229], v[152:155], v[120:123]
    v_mfma_f32_16x16x32_bf16 v[124:127], v[224:227], v[152:155], v[124:127]
    v_mfma_f32_16x16x32_bf16 v[128:131], v[226:229], v[156:159], v[128:131]
    v_mfma_f32_16x16x32_bf16 v[132:135], v[224:227], v[156:159], v[132:135]
    v_mfma_f32_16x16x32_bf16 v[136:139], v[226:229], v[160:163], v[136:139]
    v_mfma_f32_16x16x32_bf16 v[140:143], v[224:227], v[160:163], v[140:143]
    v_mfma_f32_16x16x32_bf16 v[144:147], v[226:229], v[164:167], v[144:147]
    v_mfma_f32_16x16x32_bf16 v[148:151], v[224:227], v[164:167], v[148:151]
    s_cmp_eq_u32 s60, 1
    s_cbranch_scc1 G4_last
    v_and_or_b32 v120, v120, s15, v56
    v_and_or_b32 v122, v122, s15, v56
    v_and_or_b32 v124, v124, s15, v56
    v_and_or_b32 v126, v126, s15, v56
    v_cvt_pk_bf16_f32 v120, v120, v121
    v_cvt_pk_bf16_f32 v121, v122, v123
    v_cvt_pk_bf16_f32 v122, v124, v125
    v_cvt_pk_bf16_f32 v123, v126, v127
    buffer_store_dwordx4 v[120:123], v2, s[8:11], s40 offen offset:0 sc1
    v_and_or_b32 v128, v128, s15, v56
    v_and_or_b32 v130, v130, s15, v56
    v_and_or_b32 v132, v132, s15, v56
    v_and_or_b32 v134, v134, s15, v56
    v_cvt_pk_bf16_f32 v128, v128, v129
    v_cvt_pk_bf16_f32 v129, v130, v131
    v_cvt_pk_bf16_f32 v130, v132, v133
    v_cvt_pk_bf16_f32 v131, v134, v135
    buffer_store_dwordx4 v[128:131], v2, s[8:11], s40 offen offset:1024 sc1
    s_add_u32 s36, s40, 65536
    v_and_or_b32 v136, v136, s15, v56
    v_and_or_b32 v138, v138, s15, v56
    v_and_or_b32 v140, v140, s15, v56
    v_and_or_b32 v142, v142, s15, v56
    v_cvt_pk_bf16_f32 v136, v136, v137
    v_cvt_pk_bf16_f32 v137, v138, v139
    v_cvt_pk_bf16_f32 v138, v140, v141
    v_cvt_pk_bf16_f32 v139, v142, v143
    buffer_store_dwordx4 v[136:139], v2, s[8:11], s36 offen offset:0 sc1
    v_and_or_b32 v144, v144, s15, v56
    v_and_or_b32 v146, v146, s15, v56
    v_and_or_b32 v148, v148, s15, v56
    v_and_or_b32 v150, v150, s15, v56
    v_cvt_pk_bf16_f32 v144, v144, v145
    v_cvt_pk_bf16_f32 v145, v146, v147
    v_cvt_pk_bf16_f32 v146, v148, v149
    v_cvt_pk_bf16_f32 v147, v150, v151
    buffer_store_dwordx4 v[144:147], v2, s[8:11], s36 offen offset:1024 sc1
    v_and_b32 v81, 7, v0
    v_lshrrev_b32 v84, 6, v0
    v_lshlrev_b32 v84, 4, v84
    v_bfe_u32 v85, v0, 3, 3
    v_add_u32 v84, v84, v85
    s_lshr_b32 s78, s29, 1
    s_lshl_b32 s78, s78, 16
    s_and_b32 s79, s29, 1
    s_lshl_b32 s79, s79, 7
    s_add_u32 s78, s78, s79
    s_lshr_b32 s79, s30, 1
    s_lshl_b32 s79, s79, 13
    s_add_u32 s78, s78, s79
    v_lshlrev_b32 v78, 8, v84
    v_lshl_add_u32 v78, v81, 4, v78
    v_add_u32 v78, s78, v78
    s_lshl_b32 s78, s28, 7
    s_lshl_b32 s79, s29, 3
    s_add_u32 s78, s78, s79
    v_add_u32 v79, s78, v81
    v_lshlrev_b32 v80, 11, v79
    v_and_b32 v85, 3, v79
    v_lshrrev_b32 v82, 2, v79
    v_lshlrev_b32 v82, 14, v82
    v_lshl_add_u32 v82, v85, 11, v82
    v_lshl_add_u32 v82, v84, 4, v82
    v_lshrrev_b32 v85, 2, v84
    v_lshlrev_b32 v85, 3, v85
    v_and_b32 v84, 3, v84
    v_add_u32 v84, v84, v85
    v_lshl_add_u32 v80, v84, 3, v80
    v_lshlrev_b32 v79, 3, v79
    v_lshl_add_u32 v79, v84, 14, v79
    s_add_u32 s80, s4, 0x1800000
    s_addc_u32 s81, s5, 0
    s_mov_b32 s82, 0x400000
    s_mov_b32 s83, 0x20000
    s_mov_b32 s78, 0
    buffer_load_dwordx2 v[110:111], v79, s[80:83], s78 offen sc1
    s_mov_b32 s78, 65536
    buffer_load_dwordx2 v[112:113], v79, s[80:83], s78 offen sc1
    s_mov_b32 s78, 262144
    buffer_load_dwordx2 v[114:115], v79, s[80:83], s78 offen sc1
    s_mov_b32 s78, 327680
    buffer_load_dwordx2 v[116:117], v79, s[80:83], s78 offen sc1
    s_branch NEXT
G4_last:
    v_cvt_pk_bf16_f32 v120, v120, v121
    v_cvt_pk_bf16_f32 v121, v122, v123
    v_cvt_pk_bf16_f32 v122, v124, v125
    v_cvt_pk_bf16_f32 v123, v126, v127
    s_nop 0
    v_permlane16_swap_b32 v120, v122
    v_permlane16_swap_b32 v121, v123
    v_cvt_pk_bf16_f32 v128, v128, v129
    v_cvt_pk_bf16_f32 v129, v130, v131
    v_cvt_pk_bf16_f32 v130, v132, v133
    v_cvt_pk_bf16_f32 v131, v134, v135
    s_nop 0
    v_permlane16_swap_b32 v128, v130
    v_permlane16_swap_b32 v129, v131
    v_cndmask_b32 v132, v120, v128, s[50:51]
    v_cndmask_b32 v133, v121, v129, s[50:51]
    v_cndmask_b32 v134, v122, v130, s[50:51]
    v_cndmask_b32 v135, v123, v131, s[50:51]
    v_mov_b32_dpp v124, v132 row_ror:8 row_mask:0xf bank_mask:0xf
    v_mov_b32_dpp v125, v133 row_ror:8 row_mask:0xf bank_mask:0xf
    v_mov_b32_dpp v126, v134 row_ror:8 row_mask:0xf bank_mask:0xf
    v_mov_b32_dpp v127, v135 row_ror:8 row_mask:0xf bank_mask:0xf
    v_cndmask_b32 v120, v124, v120, s[50:51]
    v_cndmask_b32 v128, v128, v124, s[50:51]
    v_cndmask_b32 v121, v125, v121, s[50:51]
    v_cndmask_b32 v129, v129, v125, s[50:51]
    v_cndmask_b32 v122, v126, v122, s[50:51]
    v_cndmask_b32 v130, v130, v126, s[50:51]
    v_cndmask_b32 v123, v127, v123, s[50:51]
    v_cndmask_b32 v131, v131, v127, s[50:51]
    buffer_store_dwordx4 v[120:123], v10, s[20:23], s38 offen sc1
    buffer_store_dwordx4 v[128:131], v11, s[20:23], s38 offen sc1
    v_cvt_pk_bf16_f32 v136, v136, v137
    v_cvt_pk_bf16_f32 v137, v138, v139
    v_cvt_pk_bf16_f32 v138, v140, v141
    v_cvt_pk_bf16_f32 v139, v142, v143
    s_nop 0
    v_permlane16_swap_b32 v136, v138
    v_permlane16_swap_b32 v137, v139
    v_cvt_pk_bf16_f32 v144, v144, v145
    v_cvt_pk_bf16_f32 v145, v146, v147
    v_cvt_pk_bf16_f32 v146, v148, v149
    v_cvt_pk_bf16_f32 v147, v150, v151
    s_nop 0
    v_permlane16_swap_b32 v144, v146
    v_permlane16_swap_b32 v145, v147
    v_cndmask_b32 v148, v136, v144, s[50:51]
    v_cndmask_b32 v149, v137, v145, s[50:51]
    v_cndmask_b32 v150, v138, v146, s[50:51]
    v_cndmask_b32 v151, v139, v147, s[50:51]
    v_mov_b32_dpp v140, v148 row_ror:8 row_mask:0xf bank_mask:0xf
    v_mov_b32_dpp v141, v149 row_ror:8 row_mask:0xf bank_mask:0xf
    v_mov_b32_dpp v142, v150 row_ror:8 row_mask:0xf bank_mask:0xf
    v_mov_b32_dpp v143, v151 row_ror:8 row_mask:0xf bank_mask:0xf
    v_cndmask_b32 v136, v140, v136, s[50:51]
    v_cndmask_b32 v144, v144, v140, s[50:51]
    v_cndmask_b32 v137, v141, v137, s[50:51]
    v_cndmask_b32 v145, v145, v141, s[50:51]
    v_cndmask_b32 v138, v142, v138, s[50:51]
    v_cndmask_b32 v146, v146, v142, s[50:51]
    v_cndmask_b32 v139, v143, v139, s[50:51]
    v_cndmask_b32 v147, v147, v143, s[50:51]
    buffer_store_dwordx4 v[136:139], v10, s[20:23], s39 offen sc1
    buffer_store_dwordx4 v[144:147], v11, s[20:23], s39 offen sc1
    s_branch K_fin
LOADERS:
    s_cmp_lg_u32 s60, 0
    s_cbranch_scc1 WY_1
    ds_read_b64_tr_b16 v[128:129], v74 offset:0
    ds_read_b64_tr_b16 v[130:131], v74 offset:2048
    ds_read_b64_tr_b16 v[136:137], v74 offset:4096
    ds_read_b64_tr_b16 v[138:139], v74 offset:6144
    ds_read_b64_tr_b16 v[144:145], v74 offset:8192
    ds_read_b64_tr_b16 v[146:147], v74 offset:10240
    ds_read_b64_tr_b16 v[152:153], v74 offset:12288
    ds_read_b64_tr_b16 v[154:155], v74 offset:14336
    ds_read_b64_tr_b16 v[160:161], v74 offset:16384
    ds_read_b64_tr_b16 v[162:163], v74 offset:18432
    ds_read_b64_tr_b16 v[168:169], v74 offset:20480
    ds_read_b64_tr_b16 v[170:171], v74 offset:22528
    ds_read_b64_tr_b16 v[176:177], v75 offset:16384
    ds_read_b64_tr_b16 v[178:179], v75 offset:18432
    ds_read_b64_tr_b16 v[184:185], v75 offset:20480
    ds_read_b64_tr_b16 v[186:187], v75 offset:22528
    ds_read_b64_tr_b16 v[192:193], v75 offset:24576
    ds_read_b64_tr_b16 v[194:195], v75 offset:26624
    ds_read_b64_tr_b16 v[200:201], v75 offset:28672
    ds_read_b64_tr_b16 v[202:203], v75 offset:30720
    ds_read_b64_tr_b16 v[208:209], v74 offset:32768
    ds_read_b64_tr_b16 v[210:211], v74 offset:34816
    ds_read_b64_tr_b16 v[216:217], v74 offset:36864
    ds_read_b64_tr_b16 v[218:219], v74 offset:38912
    ds_read_b64_tr_b16 v[224:225], v74 offset:40960
    ds_read_b64_tr_b16 v[226:227], v74 offset:43008
    ds_read_b64_tr_b16 v[232:233], v74 offset:45056
    ds_read_b64_tr_b16 v[234:235], v74 offset:47104
    ds_read_b64_tr_b16 v[240:241], v75 offset:32768
    ds_read_b64_tr_b16 v[242:243], v75 offset:34816
    ds_read_b64_tr_b16 v[248:249], v75 offset:36864
    ds_read_b64_tr_b16 v[250:251], v75 offset:38912
    s_mov_b64 s[80:81], s[68:69]
    s_mov_b32 s82, 2097152
    s_mov_b32 s83, 0x20000
    s_waitcnt vmcnt(0) lgkmcnt(0)
    s_barrier
    s_and_b32 s49, s30, 3
    s_lshl_b32 s36, s49, 14
    s_lshl_b32 s48, s29, 7
    s_add_u32 s48, s48, s36
    s_lshl_b32 s49, s49, 10
    s_xor_b32 s48, s48, 128
    s_add_u32 s36, s67, 7
    s_and_b32 s36, s36, 7
    s_lshl_b32 s36, s36, 17
    s_add_u32 s36, s36, s48
    s_add_u32 m0, s49, 81920
    s_nop 0
    buffer_load_dwordx4 v118, s[80:83], s36 offen lds
    s_add_u32 s36, s36, 65536
    s_add_u32 m0, s49, 86016
    s_nop 0
    buffer_load_dwordx4 v118, s[80:83], s36 offen lds
    s_add_u32 s36, s67, 0
    s_and_b32 s36, s36, 7
    s_lshl_b32 s36, s36, 17
    s_add_u32 s36, s36, s48
    s_add_u32 s36, s36, 1048576
    s_add_u32 m0, s49, 90112
    s_nop 0
    buffer_load_dwordx4 v118, s[80:83], s36 offen lds
    s_add_u32 s36, s36, 65536
    s_add_u32 m0, s49, 94208
    s_nop 0
    buffer_load_dwordx4 v118, s[80:83], s36 offen lds
    s_add_u32 s36, s67, 1
    s_and_b32 s36, s36, 7
    s_lshl_b32 s36, s36, 17
    s_add_u32 s36, s36, s48
    s_add_u32 m0, s49, 32768
    s_nop 0
    buffer_load_dwordx4 v118, s[80:83], s36 offen lds
    s_add_u32 s36, s36, 65536
    s_add_u32 m0, s49, 36864
    s_nop 0
    buffer_load_dwordx4 v118, s[80:83], s36 offen lds
    s_add_u32 s36, s67, 2
    s_and_b32 s36, s36, 7
    s_lshl_b32 s36, s36, 17
    s_add_u32 s36, s36, s48
    s_add_u32 m0, s49, 40960
    s_nop 0
    buffer_load_dwordx4 v118, s[80:83], s36 offen lds
    s_add_u32 s36, s36, 65536
    s_add_u32 m0, s49, 45056
    s_nop 0
    buffer_load_dwordx4 v118, s[80:83], s36 offen lds
    s_add_u32 s36, s67, 1
    s_and_b32 s36, s36, 7
    s_lshl_b32 s36, s36, 17
    s_add_u32 s36, s36, s48
    s_add_u32 s36, s36, 1048576
    s_add_u32 m0, s49, 98304
    s_nop 0
    buffer_load_dwordx4 v118, s[80:83], s36 offen lds
    s_add_u32 s36, s36, 65536
    s_add_u32 m0, s49, 102400
    s_nop 0
    buffer_load_dwordx4 v118, s[80:83], s36 offen lds
    s_add_u32 s36, s67, 2
    s_and_b32 s36, s36, 7
    s_lshl_b32 s36, s36, 17
    s_add_u32 s36, s36, s48
    s_add_u32 s36, s36, 1048576
    s_add_u32 m0, s49, 106496
    s_nop 0
    buffer_load_dwordx4 v118, s[80:83], s36 offen lds
    s_add_u32 s36, s36, 65536
    s_add_u32 m0, s49, 110592
    s_nop 0
    buffer_load_dwordx4 v118, s[80:83], s36 offen lds
    s_branch WY_2
WY_1:
    s_mov_b64 s[80:81], s[68:69]
    s_mov_b32 s82, 2097152
    s_mov_b32 s83, 0x20000
    s_and_b32 s49, s30, 3
    s_lshl_b32 s36, s49, 14
    s_lshl_b32 s48, s29, 7
    s_add_u32 s48, s48, s36
    s_lshl_b32 s49, s49, 10
    s_xor_b32 s48, s48, 128
    s_add_u32 s36, s67, 7
    s_and_b32 s36, s36, 7
    s_lshl_b32 s36, s36, 17
    s_add_u32 s36, s36, s48
    s_add_u32 m0, s49, 81920
    s_nop 0
    buffer_load_dwordx4 v118, s[80:83], s36 offen lds
    s_add_u32 s36, s36, 65536
    s_add_u32 m0, s49, 86016
    s_nop 0
    buffer_load_dwordx4 v118, s[80:83], s36 offen lds
    s_add_u32 s36, s67, 0
    s_and_b32 s36, s36, 7
    s_lshl_b32 s36, s36, 17
    s_add_u32 s36, s36, s48
    s_add_u32 s36, s36, 1048576
    s_add_u32 m0, s49, 90112
    s_nop 0
    buffer_load_dwordx4 v118, s[80:83], s36 offen lds
    s_add_u32 s36, s36, 65536
    s_add_u32 m0, s49, 94208
    s_nop 0
    buffer_load_dwordx4 v118, s[80:83], s36 offen lds
    s_add_u32 s36, s67, 1
    s_and_b32 s36, s36, 7
    s_lshl_b32 s36, s36, 17
    s_add_u32 s36, s36, s48
    s_add_u32 m0, s49, 32768
    s_nop 0
    buffer_load_dwordx4 v118, s[80:83], s36 offen lds
    s_add_u32 s36, s36, 65536
    s_add_u32 m0, s49, 36864
    s_nop 0
    buffer_load_dwordx4 v118, s[80:83], s36 offen lds
    s_waitcnt vmcnt(6)
    s_barrier
    s_and_b32 s49, s30, 3
    s_lshl_b32 s36, s49, 14
    s_lshl_b32 s48, s29, 7
    s_add_u32 s48, s48, s36
    s_lshl_b32 s49, s49, 10
    s_xor_b32 s48, s48, 128
    s_add_u32 s36, s67, 2
    s_and_b32 s36, s36, 7
    s_lshl_b32 s36, s36, 17
    s_add_u32 s36, s36, s48
    s_add_u32 m0, s49, 40960
    s_nop 0
    buffer_load_dwordx4 v118, s[80:83], s36 offen lds
    s_add_u32 s36, s36, 65536
    s_add_u32 m0, s49, 45056
    s_nop 0
    buffer_load_dwordx4 v118, s[80:83], s36 offen lds
    s_add_u32 s36, s67, 1
    s_and_b32 s36, s36, 7
    s_lshl_b32 s36, s36, 17
    s_add_u32 s36, s36, s48
    s_add_u32 s36, s36, 1048576
    s_add_u32 m0, s49, 98304
    s_nop 0
    buffer_load_dwordx4 v118, s[80:83], s36 offen lds
    s_add_u32 s36, s36, 65536
    s_add_u32 m0, s49, 102400
    s_nop 0
    buffer_load_dwordx4 v118, s[80:83], s36 offen lds
    s_add_u32 s36, s67, 2
    s_and_b32 s36, s36, 7
    s_lshl_b32 s36, s36, 17
    s_add_u32 s36, s36, s48
    s_add_u32 s36, s36, 1048576
    s_add_u32 m0, s49, 106496
    s_nop 0
    buffer_load_dwordx4 v118, s[80:83], s36 offen lds
    s_add_u32 s36, s36, 65536
    s_add_u32 m0, s49, 110592
    s_nop 0
    buffer_load_dwordx4 v118, s[80:83], s36 offen lds
WY_2:
    v_and_b32 v8, 15, v1
    v_lshrrev_b32 v9, 4, v1
    s_and_b32 s34, s30, 1
    s_and_b32 s37, s30, 3
    s_lshr_b32 s38, s29, 3
    s_add_u32 s38, s38, 1
    s_sub_u32 s39, 0, s38
    s_bitcmp1_b32 s29, 2
    s_cselect_b32 s38, s38, s39
    s_lshl_b32 s48, s28, 7
    s_cmp_lt_u32 s37, 2
    s_cselect_b32 s36, s38, 0
    s_add_u32 s36, s36, s48
    s_lshl_b32 s45, s34, 6
    s_add_u32 s36, s36, s45
    v_add_u32 v72, s36, v1
    s_movk_i32 s45, 2048
    v_cmp_gt_u32 s[46:47], s45, v72
    v_lshlrev_b32 v72, 4, v72
    s_lshl_b32 s22, s60, 15
    s_add_u32 s22, s22, 23199744
    s_add_u32 s20, s4, s22
    s_addc_u32 s21, s5, 0
    s_mov_b32 s22, 32768
    s_mov_b32 s23, 0x20000
    s_lshl_b32 s36, s37, 2
    v_add_u32 v6, s36, v9
    v_xor_b32 v10, v6, v8
    s_add_u32 s36, s48, s38
    s_add_u32 s36, s36, 16
    v_add_u32 v6, s36, v6
    v_and_b32 v7, 3, v6
    v_lshrrev_b32 v11, 2, v6
    v_lshlrev_b32 v11, 14, v11
    v_lshl_add_u32 v11, v7, 11, v11
    v_lshl_add_u32 v11, v10, 4, v11
    v_subrev_u32 v10, 65536, v11
    s_add_u32 s40, s67, 0
    s_and_b32 s40, s40, 6
    s_lshl_b32 s40, s40, 7
    s_add_u32 s41, s67, 2
    s_and_b32 s41, s41, 6
    s_lshl_b32 s41, s41, 7
    s_add_u32 s42, s67, 4
    s_and_b32 s42, s42, 6
    s_lshl_b32 s42, s42, 7
    s_add_u32 s43, s67, 6
    s_and_b32 s43, s43, 6
    s_lshl_b32 s43, s43, 7
    s_lshl_b32 s44, s37, 10
    v_lshrrev_b32 v6, 3, v1
    v_and_b32 v17, 7, v1
    v_xor_b32 v17, v17, v6
    s_lshl_b32 s36, s37, 3
    s_add_u32 s36, s36, s48
    v_add_u32 v6, s36, v6
    v_and_b32 v7, 3, v6
    v_lshrrev_b32 v12, 2, v6
    v_lshlrev_b32 v12, 14, v12
    v_lshl_add_u32 v12, v7, 11, v12
    s_lshl_b32 s36, s29, 7
    v_lshl_add_u32 v12, v17, 4, v12
    v_add_u32 v12, s36, v12
    v_lshrrev_b32 v6, 1, v9
    s_lshl_b32 s36, s37, 1
    v_add_u32 v6, s36, v6
    v_and_b32 v7, 7, v8
    v_xor_b32 v6, v6, v7
    v_lshlrev_b32 v17, 7, v8
    v_lshl_add_u32 v17, v6, 4, v17
    v_and_b32 v6, 1, v9
    v_lshl_add_u32 v17, v6, 3, v17
    v_and_b32 v6, 1, v9
    v_lshlrev_b32 v13, 16, v6
    v_lshrrev_b32 v6, 1, v9
    v_lshl_add_u32 v13, v6, 8, v13
    v_lshl_add_u32 v13, v8, 4, v13
    s_bfe_u32 s36, s30, 0x10001
    s_lshl1_add_u32 s36, s29, s36
    s_lshr_b32 s53, s36, 3
    s_lshl_b32 s53, s53, 14
    s_and_b32 s39, s36, 7
    s_lshl_b32 s39, s39, 10
    s_add_u32 s39, s39, s53
    s_and_b32 s36, s30, 1
    s_lshl_b32 s36, s36, 9
    s_add_u32 s39, s39, s36
    v_mov_b32 v14, v2
    v_add_u32 v15, 106496, v2
    v_lshrrev_b32 v6, 5, v13
    v_and_b32 v6, 2048, v6
    v_and_b32 v16, 511, v13
    v_add_u32 v16, v16, v6
    s_lshl_b32 s36, s37, 9
    v_add_u32 v16, s36, v16
    s_lshl_b32 s14, s60, 24
    s_lshl_b32 s15, s94, 13
    s_add_u32 s14, s14, s15
    s_add_u32 s14, s14, 167772160
    s_add_u32 s12, s4, s14
    s_addc_u32 s13, s5, 0
    s_mov_b32 s14, 8380416
    s_mov_b32 s15, 0x20000
    s_add_u32 s16, s62, 0x400000
    s_addc_u32 s17, s63, 0
    s_mov_b32 s18, 0x7e000
    s_mov_b32 s19, 0x20000
    s_add_u32 s24, s62, 0x480000
    s_addc_u32 s25, s63, 0
    s_mov_b32 s26, 0x7e000
    s_mov_b32 s27, 0x20000
    s_and_b32 s82, s30, 3
    s_lshl_b32 s82, s82, 15
    s_add_u32 s53, s67, 0
    s_and_b32 s78, s53, 4
    s_and_b32 s53, s53, 2
    s_lshl_b32 s78, s78, 12
    s_lshl_b32 s53, s53, 11
    s_add_u32 s78, s78, s53
    s_add_u32 s78, s78, s82
    s_add_u32 s53, s67, 2
    s_and_b32 s79, s53, 4
    s_and_b32 s53, s53, 2
    s_lshl_b32 s79, s79, 12
    s_lshl_b32 s53, s53, 11
    s_add_u32 s79, s79, s53
    s_add_u32 s79, s79, s82
    s_add_u32 s53, s67, 4
    s_and_b32 s80, s53, 4
    s_and_b32 s53, s53, 2
    s_lshl_b32 s80, s80, 12
    s_lshl_b32 s53, s53, 11
    s_add_u32 s80, s80, s53
    s_add_u32 s80, s80, s82
    s_add_u32 s53, s67, 6
    s_and_b32 s81, s53, 4
    s_and_b32 s53, s53, 2
    s_lshl_b32 s81, s81, 12
    s_lshl_b32 s53, s53, 11
    s_add_u32 s81, s81, s53
    s_add_u32 s81, s81, s82
    s_and_b32 s53, s30, 2
    s_lshl_b32 s53, s53, 11
    s_and_b32 s82, s30, 1
    s_lshl_b32 s82, s82, 13
    s_add_u32 s82, s82, s53
    s_and_b32 s84, s30, 1
    s_lshl_b32 s84, s84, 8
    s_add_u32 s84, s84, s55
    s_add_u32 s85, s52, 16
    s_mov_b64 s[8:9], s[72:73]
    s_mov_b32 s10, 7340032
    s_mov_b32 s11, 0x20000
    s_add_u32 s89, s29, 1
    s_and_b32 s89, s89, 15
    s_cmp_lg_u32 s28, s29
    s_cselect_b32 s89, s28, s89
    s_and_b32 s90, s30, 3
    s_mul_i32 s36, s29, 448
    s_lshl2_add_u32 s88, s29, s90
    s_mul_i32 s88, s88, 114688
    s_add_u32 s88, s88, s36
    s_lshl2_add_u32 s89, s89, s90
    s_mul_i32 s89, s89, 114688
    s_add_u32 s89, s89, s36
    s_mul_i32 s90, s90, 7168
    s_waitcnt vmcnt(0) lgkmcnt(0)
    s_barrier
    s_setprio 1
    s_add_u32 m0, s44, 16384
    s_add_u32 s49, s40, 0
    s_barrier
    buffer_load_dwordx4 v[52:55], v72, s[20:23], 0 offen sc1
    buffer_load_dwordx4 v10, s[12:15], s49 offen offset:0 sc1 lds
    s_add_u32 m0, s44, 23552
    s_nop 0
    buffer_load_dwordx4 v10, s[12:15], s49 offen offset:1024 sc1 lds
    s_add_u32 m0, s44, 20480
    s_nop 0
    buffer_load_dwordx4 v11, s[12:15], s49 offen offset:0 sc1 lds
    s_add_u32 m0, s44, 27648
    s_nop 0
    buffer_load_dwordx4 v11, s[12:15], s49 offen offset:1024 sc1 lds
    s_add_u32 m0, s44, 32768
    s_add_u32 s49, s41, 0
    buffer_load_dwordx4 v10, s[12:15], s49 offen offset:0 sc1 lds
    s_add_u32 m0, s44, 39936
    s_nop 0
    buffer_load_dwordx4 v10, s[12:15], s49 offen offset:1024 sc1 lds
    s_add_u32 m0, s44, 36864
    s_nop 0
    buffer_load_dwordx4 v11, s[12:15], s49 offen offset:0 sc1 lds
    s_add_u32 m0, s44, 44032
    s_nop 0
    buffer_load_dwordx4 v11, s[12:15], s49 offen offset:1024 sc1 lds
    s_waitcnt vmcnt(8)
    s_mov_b32 s53, 0
lns_25:
    v_cmp_eq_u32 vcc, s52, v53
    v_cmp_eq_u32 s[50:51], s52, v55
    s_nop 0
    s_and_b64 vcc, vcc, s[50:51]
    s_orn2_b64 vcc, vcc, s[46:47]
    s_cmp_eq_u64 vcc, -1
    s_cbranch_scc1 lnk_26
    buffer_load_dwordx4 v[52:55], v72, s[20:23], 0 offen sc1
    s_waitcnt vmcnt(0)
    s_add_u32 s53, s53, 1
    s_cmp_lt_u32 s53, s61
    s_cbranch_scc1 lns_25
    s_mov_b32 s61, 0
lnk_26:
    v_lshlrev_b32 v56, 16, v52
    v_and_b32 v57, 0xffff0000, v52
    v_lshlrev_b32 v58, 16, v54
    v_and_b32 v59, 0xffff0000, v54
    v_cndmask_b32 v57, 1.0, v57, s[46:47]
    v_cndmask_b32 v59, 1.0, v59, s[46:47]
    s_lshl_b32 s36, s34, 10
    s_add_u32 s36, s36, 155648
    v_add_u32 v6, s36, v2
    s_cmp_ge_u32 s37, 2
    s_cbranch_scc1 lnx_27
    v_mul_f32 v66, v57, v59
    v_fma_f32 v60, -v58, v57, -v56
    v_rcp_f32 v7, v66
    v_mov_b32 v67, v66
    v_mov_b32 v61, v60
    v_mul_f32 v62, 0xc0135761, v7
    v_mul_f32 v7, v7, v7
    v_mov_b32 v63, v62
    v_mul_f32 v7, 0x3d372713, v7
    v_mul_f32 v64, v7, v62
    v_mov_b32 v65, v64
    ds_write_b128 v6, v[60:63] offset:0
    ds_write_b128 v6, v[64:67] offset:2048
    s_branch lnd_28
lnx_27:
    v_rcp_f32 v60, v57
    s_nop 0
    v_mul_f32 v62, -v56, v60
    v_mov_b32 v61, v60
    v_mov_b32 v63, v62
    ds_write_b128 v6, v[60:63] offset:5120
lnd_28:
    v_lshlrev_b32 v7, 4, v8
    v_add_u32 v7, 160768, v7
    s_add_u32 m0, s44, 106496
    s_add_u32 s49, s42, 0
    buffer_load_dwordx4 v10, s[12:15], s49 offen offset:0 sc1 lds
    s_add_u32 m0, s44, 113664
    s_nop 0
    buffer_load_dwordx4 v10, s[12:15], s49 offen offset:1024 sc1 lds
    s_add_u32 m0, s44, 110592
    s_nop 0
    buffer_load_dwordx4 v11, s[12:15], s49 offen offset:0 sc1 lds
    s_add_u32 m0, s44, 117760
    s_nop 0
    buffer_load_dwordx4 v11, s[12:15], s49 offen offset:1024 sc1 lds
    s_add_u32 m0, s44, 122880
    s_add_u32 s49, s43, 0
    s_waitcnt vmcnt(8)
    s_barrier
    buffer_load_dwordx4 v10, s[12:15], s49 offen offset:0 sc1 lds
    s_add_u32 m0, s44, 130048
    s_nop 0
    buffer_load_dwordx4 v10, s[12:15], s49 offen offset:1024 sc1 lds
    s_add_u32 m0, s44, 126976
    s_nop 0
    buffer_load_dwordx4 v11, s[12:15], s49 offen offset:0 sc1 lds
    s_add_u32 m0, s44, 134144
    s_nop 0
    buffer_load_dwordx4 v11, s[12:15], s49 offen offset:1024 sc1 lds
    v_mov_b32 v10, v11
    v_add_u32 v11, 65536, v11
    s_add_u32 m0, s44, 139264
    s_add_u32 s49, s40, 65536
    s_waitcnt vmcnt(8)
    s_barrier
    buffer_load_dwordx4 v10, s[12:15], s49 offen offset:0 sc1 lds
    s_add_u32 m0, s44, 146432
    s_nop 0
    buffer_load_dwordx4 v10, s[12:15], s49 offen offset:1024 sc1 lds
    s_add_u32 m0, s44, 143360
    s_nop 0
    buffer_load_dwordx4 v11, s[12:15], s49 offen offset:0 sc1 lds
    s_add_u32 m0, s44, 150528
    s_nop 0
    buffer_load_dwordx4 v11, s[12:15], s49 offen offset:1024 sc1 lds
    s_add_u32 m0, s44, 16384
    s_add_u32 s49, s41, 65536
    s_waitcnt vmcnt(8)
    s_barrier
    buffer_load_dwordx4 v10, s[12:15], s49 offen offset:0 sc1 lds
    s_add_u32 m0, s44, 23552
    s_nop 0
    buffer_load_dwordx4 v10, s[12:15], s49 offen offset:1024 sc1 lds
    s_add_u32 m0, s44, 20480
    s_nop 0
    buffer_load_dwordx4 v11, s[12:15], s49 offen offset:0 sc1 lds
    s_add_u32 m0, s44, 27648
    s_nop 0
    buffer_load_dwordx4 v11, s[12:15], s49 offen offset:1024 sc1 lds
    s_add_u32 m0, s44, 32768
    s_add_u32 s49, s42, 65536
    s_waitcnt vmcnt(8)
    s_barrier
    buffer_load_dwordx4 v10, s[12:15], s49 offen offset:0 sc1 lds
    s_add_u32 m0, s44, 39936
    s_nop 0
    buffer_load_dwordx4 v10, s[12:15], s49 offen offset:1024 sc1 lds
    s_add_u32 m0, s44, 36864
    s_nop 0
    buffer_load_dwordx4 v11, s[12:15], s49 offen offset:0 sc1 lds
    s_add_u32 m0, s44, 44032
    s_nop 0
    buffer_load_dwordx4 v11, s[12:15], s49 offen offset:1024 sc1 lds
    s_waitcnt lgkmcnt(0)
    s_add_u32 m0, s44, 106496
    s_add_u32 s49, s43, 65536
    s_waitcnt vmcnt(8)
    s_barrier
    buffer_load_dwordx4 v10, s[12:15], s49 offen offset:0 sc1 lds
    s_add_u32 m0, s44, 113664
    s_nop 0
    buffer_load_dwordx4 v10, s[12:15], s49 offen offset:1024 sc1 lds
    s_add_u32 m0, s44, 110592
    s_nop 0
    buffer_load_dwordx4 v11, s[12:15], s49 offen offset:0 sc1 lds
    s_add_u32 m0, s44, 117760
    s_nop 0
    buffer_load_dwordx4 v11, s[12:15], s49 offen offset:1024 sc1 lds
    s_add_u32 m0, s44, 0
    s_mov_b32 s36, 0
    buffer_load_dwordx4 v12, s[12:15], s36 offen sc1 lds
    s_add_u32 m0, s44, 4096
    s_mov_b32 s36, 131072
    buffer_load_dwordx4 v12, s[12:15], s36 offen sc1 lds
    s_add_u32 m0, s44, 8192
    s_mov_b32 s36, 262144
    buffer_load_dwordx4 v12, s[12:15], s36 offen sc1 lds
    s_add_u32 m0, s44, 12288
    s_mov_b32 s36, 393216
    buffer_load_dwordx4 v12, s[12:15], s36 offen sc1 lds
    s_add_u32 m0, s90, 77824
    s_nop 0
    buffer_load_dwordx4 v121, s[8:11], s89 offen lds
    s_add_u32 m0, s90, 78848
    s_nop 0
    buffer_load_dwordx4 v122, s[8:11], s89 offen lds
    s_add_u32 m0, s44, 122880
    s_add_u32 s49, s40, 196608
    s_waitcnt vmcnt(14)
    s_barrier
    buffer_load_dwordx4 v10, s[12:15], s49 offen offset:0 sc1 lds
    s_add_u32 m0, s44, 130048
    s_nop 0
    buffer_load_dwordx4 v10, s[12:15], s49 offen offset:1024 sc1 lds
    s_add_u32 m0, s44, 126976
    s_nop 0
    buffer_load_dwordx4 v11, s[12:15], s49 offen offset:0 sc1 lds
    s_add_u32 m0, s44, 134144
    s_nop 0
    buffer_load_dwordx4 v11, s[12:15], s49 offen offset:1024 sc1 lds
    s_add_u32 m0, s44, 139264
    s_add_u32 s49, s41, 196608
    s_waitcnt vmcnt(14)
    s_barrier
    buffer_load_dwordx4 v10, s[12:15], s49 offen offset:0 sc1 lds
    s_add_u32 m0, s44, 146432
    s_nop 0
    buffer_load_dwordx4 v10, s[12:15], s49 offen offset:1024 sc1 lds
    s_add_u32 m0, s44, 143360
    s_nop 0
    buffer_load_dwordx4 v11, s[12:15], s49 offen offset:0 sc1 lds
    s_add_u32 m0, s44, 150528
    s_nop 0
    buffer_load_dwordx4 v11, s[12:15], s49 offen offset:1024 sc1 lds
    s_add_u32 m0, s44, 16384
    s_add_u32 s49, s42, 196608
    s_waitcnt vmcnt(10)
    s_barrier
    buffer_load_dwordx4 v10, s[12:15], s49 offen offset:0 sc1 lds
    s_add_u32 m0, s44, 23552
    s_nop 0
    buffer_load_dwordx4 v10, s[12:15], s49 offen offset:1024 sc1 lds
    s_add_u32 m0, s44, 20480
    s_nop 0
    buffer_load_dwordx4 v11, s[12:15], s49 offen offset:0 sc1 lds
    s_add_u32 m0, s44, 27648
    s_nop 0
    buffer_load_dwordx4 v11, s[12:15], s49 offen offset:1024 sc1 lds
    ds_read_b64 v[22:23], v17 offset:0
    ds_read_b128 v[60:63], v7 offset:0
    ds_read_b64 v[26:27], v17 offset:2048
    ds_read_b128 v[64:67], v7 offset:256
    s_add_u32 m0, s44, 32768
    s_add_u32 s49, s43, 196608
    s_waitcnt vmcnt(8)
    s_barrier
    buffer_load_dwordx4 v10, s[12:15], s49 offen offset:0 sc1 lds
    s_waitcnt lgkmcnt(0)
    v_lshlrev_b32 v20, 16, v22
    v_and_b32 v21, 0xffff0000, v22
    v_lshlrev_b32 v22, 16, v23
    v_and_b32 v23, 0xffff0000, v23
    s_add_u32 m0, s44, 39936
    s_nop 0
    buffer_load_dwordx4 v10, s[12:15], s49 offen offset:1024 sc1 lds
    v_pk_fma_f32 v[20:21], v[20:21], v[60:61], v[62:63]
    v_pk_fma_f32 v[22:23], v[22:23], v[60:61], v[62:63]
    v_lshlrev_b32 v24, 16, v26
    v_and_b32 v25, 0xffff0000, v26
    v_lshlrev_b32 v26, 16, v27
    s_add_u32 m0, s44, 36864
    s_nop 0
    buffer_load_dwordx4 v11, s[12:15], s49 offen offset:0 sc1 lds
    v_and_b32 v27, 0xffff0000, v27
    v_pk_fma_f32 v[24:25], v[24:25], v[64:65], v[66:67]
    v_pk_fma_f32 v[26:27], v[26:27], v[64:65], v[66:67]
    s_add_u32 m0, s44, 44032
    s_nop 0
    buffer_load_dwordx4 v11, s[12:15], s49 offen offset:1024 sc1 lds
    ds_read_b64 v[30:31], v17 offset:4096
    ds_read_b128 v[60:63], v7 offset:512
    ds_read_b64 v[34:35], v17 offset:6144
    ds_read_b128 v[64:67], v7 offset:768
    s_add_u32 m0, s90, 79872
    s_nop 0
    buffer_load_dwordx4 v123, s[8:11], s89 offen lds
    s_add_u32 m0, s90, 80896
    s_nop 0
    buffer_load_dwordx4 v124, s[8:11], s89 offen lds
    s_add_u32 m0, s90, 81920
    s_nop 0
    buffer_load_dwordx4 v125, s[8:11], s89 offen lds
    s_add_u32 m0, s90, 82944
    s_nop 0
    buffer_load_dwordx4 v126, s[8:11], s89 offen lds
    s_add_u32 m0, s90, 83968
    s_nop 0
    buffer_load_dwordx4 v127, s[8:11], s89 offen lds
    s_add_u32 m0, s90, 49152
    s_nop 0
    buffer_load_dwordx4 v121, s[8:11], s88 offen lds
    s_add_u32 m0, s44, 106496
    s_add_u32 s49, s40, 327680
    s_waitcnt vmcnt(14)
    s_barrier
    buffer_load_dwordx4 v10, s[12:15], s49 offen offset:0 sc1 lds
    s_waitcnt lgkmcnt(0)
    v_lshlrev_b32 v28, 16, v30
    v_and_b32 v29, 0xffff0000, v30
    v_lshlrev_b32 v30, 16, v31
    v_and_b32 v31, 0xffff0000, v31
    s_add_u32 m0, s44, 113664
    s_nop 0
    buffer_load_dwordx4 v10, s[12:15], s49 offen offset:1024 sc1 lds
    v_pk_fma_f32 v[28:29], v[28:29], v[60:61], v[62:63]
    v_pk_fma_f32 v[30:31], v[30:31], v[60:61], v[62:63]
    v_lshlrev_b32 v32, 16, v34
    v_and_b32 v33, 0xffff0000, v34
    v_lshlrev_b32 v34, 16, v35
    s_add_u32 m0, s44, 110592
    s_nop 0
    buffer_load_dwordx4 v11, s[12:15], s49 offen offset:0 sc1 lds
    v_and_b32 v35, 0xffff0000, v35
    v_pk_fma_f32 v[32:33], v[32:33], v[64:65], v[66:67]
    v_pk_fma_f32 v[34:35], v[34:35], v[64:65], v[66:67]
    s_add_u32 m0, s44, 117760
    s_nop 0
    buffer_load_dwordx4 v11, s[12:15], s49 offen offset:1024 sc1 lds
    ds_read_b64 v[38:39], v17 offset:8192
    ds_read_b128 v[60:63], v7 offset:1024
    ds_read_b64 v[42:43], v17 offset:10240
    ds_read_b128 v[64:67], v7 offset:1280
    s_add_u32 m0, s44, 122880
    s_add_u32 s49, s41, 327680
    s_waitcnt vmcnt(14)
    s_barrier
    buffer_load_dwordx4 v10, s[12:15], s49 offen offset:0 sc1 lds
    s_waitcnt lgkmcnt(0)
    v_lshlrev_b32 v36, 16, v38
    v_and_b32 v37, 0xffff0000, v38
    v_lshlrev_b32 v38, 16, v39
    v_and_b32 v39, 0xffff0000, v39
    s_add_u32 m0, s44, 130048
    s_nop 0
    buffer_load_dwordx4 v10, s[12:15], s49 offen offset:1024 sc1 lds
    v_pk_fma_f32 v[36:37], v[36:37], v[60:61], v[62:63]
    v_pk_fma_f32 v[38:39], v[38:39], v[60:61], v[62:63]
    v_lshlrev_b32 v40, 16, v42
    v_and_b32 v41, 0xffff0000, v42
    v_lshlrev_b32 v42, 16, v43
    s_add_u32 m0, s44, 126976
    s_nop 0
    buffer_load_dwordx4 v11, s[12:15], s49 offen offset:0 sc1 lds
    v_and_b32 v43, 0xffff0000, v43
    v_pk_fma_f32 v[40:41], v[40:41], v[64:65], v[66:67]
    v_pk_fma_f32 v[42:43], v[42:43], v[64:65], v[66:67]
    s_add_u32 m0, s44, 134144
    s_nop 0
    buffer_load_dwordx4 v11, s[12:15], s49 offen offset:1024 sc1 lds
    ds_read_b64 v[46:47], v17 offset:12288
    ds_read_b128 v[60:63], v7 offset:1536
    ds_read_b64 v[50:51], v17 offset:14336
    ds_read_b128 v[64:67], v7 offset:1792
    s_add_u32 m0, s44, 139264
    s_add_u32 s49, s42, 327680
    s_waitcnt vmcnt(14)
    s_barrier
    buffer_load_dwordx4 v10, s[12:15], s49 offen offset:0 sc1 lds
    s_waitcnt lgkmcnt(0)
    v_lshlrev_b32 v44, 16, v46
    v_and_b32 v45, 0xffff0000, v46
    v_lshlrev_b32 v46, 16, v47
    v_and_b32 v47, 0xffff0000, v47
    s_add_u32 m0, s44, 146432
    s_nop 0
    buffer_load_dwordx4 v10, s[12:15], s49 offen offset:1024 sc1 lds
    v_pk_fma_f32 v[44:45], v[44:45], v[60:61], v[62:63]
    v_pk_fma_f32 v[46:47], v[46:47], v[60:61], v[62:63]
    v_lshlrev_b32 v48, 16, v50
    v_and_b32 v49, 0xffff0000, v50
    v_lshlrev_b32 v50, 16, v51
    s_add_u32 m0, s44, 143360
    s_nop 0
    buffer_load_dwordx4 v11, s[12:15], s49 offen offset:0 sc1 lds
    v_and_b32 v51, 0xffff0000, v51
    v_pk_fma_f32 v[48:49], v[48:49], v[64:65], v[66:67]
    v_pk_fma_f32 v[50:51], v[50:51], v[64:65], v[66:67]
    s_add_u32 m0, s44, 150528
    s_nop 0
    buffer_load_dwordx4 v11, s[12:15], s49 offen offset:1024 sc1 lds
    s_add_u32 m0, s44, 16384
    s_add_u32 s49, s43, 327680
    s_waitcnt vmcnt(8)
    s_barrier
    s_load_dword s32, s[4:5], s84 offset:2048
    s_load_dword s3, s[4:5], s84 offset:2176
    buffer_load_dwordx4 v10, s[12:15], s49 offen offset:0 sc1 lds
    s_add_u32 m0, s44, 23552
    s_nop 0
    buffer_load_dwordx4 v10, s[12:15], s49 offen offset:1024 sc1 lds
    s_add_u32 m0, s44, 20480
    s_nop 0
    buffer_load_dwordx4 v11, s[12:15], s49 offen offset:0 sc1 lds
    s_add_u32 m0, s44, 27648
    s_nop 0
    buffer_load_dwordx4 v11, s[12:15], s49 offen offset:1024 sc1 lds
    s_add_u32 m0, s90, 50176
    s_nop 0
    buffer_load_dwordx4 v122, s[8:11], s88 offen lds
    s_add_u32 m0, s90, 51200
    s_nop 0
    buffer_load_dwordx4 v123, s[8:11], s88 offen lds
    s_add_u32 m0, s90, 52224
    s_nop 0
    buffer_load_dwordx4 v124, s[8:11], s88 offen lds
    s_add_u32 m0, s90, 53248
    s_nop 0
    buffer_load_dwordx4 v125, s[8:11], s88 offen lds
    s_add_u32 m0, s90, 54272
    s_nop 0
    buffer_load_dwordx4 v126, s[8:11], s88 offen lds
    s_add_u32 m0, s90, 55296
    s_nop 0
    buffer_load_dwordx4 v127, s[8:11], s88 offen lds
    s_add_u32 m0, s82, 32768
    s_add_u32 s49, s78, 0
    s_waitcnt vmcnt(14)
    s_barrier
    s_waitcnt lgkmcnt(0)
    s_cmp_eq_u32 s32, s85
    s_cselect_b32 s32, s3, 0
    s_cmp_eq_u32 s32, s85
    s_cbranch_scc1 hok_29
    s_add_u32 s53, s84, 2048
    v_lshlrev_b32 v109, 7, v1
    v_add_u32 v109, s53, v109
    s_mov_b32 s53, 0
    s_add_u32 s54, s52, 16
    s_bfm_b64 exec, 2, 0
poll_30:
    buffer_load_dword v108, v109, s[56:59], 0 offen sc1
    s_waitcnt vmcnt(0)
    v_cmp_eq_u32 vcc, s54, v108
    s_nop 0
    s_cmp_eq_u64 vcc, exec
    s_cbranch_scc1 pok_31
    s_sleep 8
    s_add_u32 s53, s53, 1
    s_cmp_lt_u32 s53, s61
    s_cbranch_scc1 poll_30
    s_mov_b32 s61, 0
pok_31:
    s_mov_b64 exec, -1
hok_29:
    buffer_load_dwordx4 v2, s[16:19], s49 offen offset:0 sc1 lds
    buffer_load_dwordx4 v2, s[16:19], s49 offen offset:1024 sc1 lds
    buffer_load_dwordx4 v2, s[16:19], s49 offen offset:2048 sc1 lds
    buffer_load_dwordx4 v2, s[16:19], s49 offen offset:3072 sc1 lds
    s_add_u32 m0, s82, 106496
    s_add_u32 s49, s79, 0
    s_waitcnt vmcnt(14)
    s_barrier
    buffer_load_dwordx4 v2, s[16:19], s49 offen offset:0 sc1 lds
    buffer_load_dwordx4 v2, s[16:19], s49 offen offset:1024 sc1 lds
    buffer_load_dwordx4 v2, s[16:19], s49 offen offset:2048 sc1 lds
    buffer_load_dwordx4 v2, s[16:19], s49 offen offset:3072 sc1 lds
    s_add_u32 m0, s82, 122880
    s_add_u32 s49, s80, 0
    s_waitcnt vmcnt(14)
    s_barrier
    buffer_load_dwordx4 v2, s[16:19], s49 offen offset:0 sc1 lds
    buffer_load_dwordx4 v2, s[16:19], s49 offen offset:1024 sc1 lds
    buffer_load_dwordx4 v2, s[16:19], s49 offen offset:2048 sc1 lds
    buffer_load_dwordx4 v2, s[16:19], s49 offen offset:3072 sc1 lds
    s_setprio 0
    s_waitcnt vmcnt(8)
    s_barrier
    ds_read_b128 v[52:55], v14 offset:32768
    ds_read_b128 v[56:59], v14 offset:36864
    ds_read_b128 v[60:63], v14 offset:40960
    ds_read_b128 v[64:67], v14 offset:45056
    ds_read_b128 v[68:71], v14 offset:33792
    ds_read_b128 v[72:75], v14 offset:37888
    ds_read_b128 v[76:79], v14 offset:41984
    ds_read_b128 v[80:83], v14 offset:46080
    s_waitcnt lgkmcnt(4)
    v_mfma_f32_16x16x32_bf16 v[20:23], v[128:131], v[52:55], v[20:23]
    ds_read_b128 v[84:87], v14 offset:34816
    v_mfma_f32_16x16x32_bf16 v[24:27], v[128:131], v[56:59], v[24:27]
    ds_read_b128 v[88:91], v14 offset:38912
    v_mfma_f32_16x16x32_bf16 v[24:27], v[132:135], v[64:67], v[24:27]
    ds_read_b128 v[92:95], v14 offset:43008
    v_mfma_f32_16x16x32_bf16 v[20:23], v[132:135], v[60:63], v[20:23]
    ds_read_b128 v[96:99], v14 offset:47104
    s_waitcnt lgkmcnt(4)
    v_mfma_f32_16x16x32_bf16 v[20:23], v[136:139], v[68:71], v[20:23]
    ds_read_b128 v[52:55], v14 offset:35840
    v_mfma_f32_16x16x32_bf16 v[24:27], v[136:139], v[72:75], v[24:27]
    ds_read_b128 v[56:59], v14 offset:39936
    v_mfma_f32_16x16x32_bf16 v[24:27], v[140:143], v[80:83], v[24:27]
    ds_read_b128 v[60:63], v14 offset:44032
    v_mfma_f32_16x16x32_bf16 v[20:23], v[140:143], v[76:79], v[20:23]
    ds_read_b128 v[64:67], v14 offset:48128
    s_waitcnt vmcnt(4)
    s_barrier
    s_waitcnt lgkmcnt(4)
    v_mfma_f32_16x16x32_bf16 v[20:23], v[144:147], v[84:87], v[20:23]
    ds_read_b128 v[68:71], v15 offset:0
    v_mfma_f32_16x16x32_bf16 v[24:27], v[144:147], v[88:91], v[24:27]
    ds_read_b128 v[72:75], v15 offset:4096
    v_mfma_f32_16x16x32_bf16 v[24:27], v[148:151], v[96:99], v[24:27]
    ds_read_b128 v[76:79], v15 offset:8192
    v_mfma_f32_16x16x32_bf16 v[20:23], v[148:151], v[92:95], v[20:23]
    ds_read_b128 v[80:83], v15 offset:12288
    s_waitcnt lgkmcnt(4)
    v_mfma_f32_16x16x32_bf16 v[20:23], v[152:155], v[52:55], v[20:23]
    ds_read_b128 v[84:87], v15 offset:1024
    v_mfma_f32_16x16x32_bf16 v[24:27], v[152:155], v[56:59], v[24:27]
    ds_read_b128 v[88:91], v15 offset:5120
    v_mfma_f32_16x16x32_bf16 v[24:27], v[156:159], v[64:67], v[24:27]
    ds_read_b128 v[92:95], v15 offset:9216
    v_mfma_f32_16x16x32_bf16 v[20:23], v[156:159], v[60:63], v[20:23]
    ds_read_b128 v[96:99], v15 offset:13312
    s_waitcnt lgkmcnt(4)
    v_mfma_f32_16x16x32_bf16 v[20:23], v[160:163], v[68:71], v[20:23]
    ds_read_b128 v[52:55], v15 offset:2048
    v_mfma_f32_16x16x32_bf16 v[24:27], v[160:163], v[72:75], v[24:27]
    ds_read_b128 v[56:59], v15 offset:6144
    v_mfma_f32_16x16x32_bf16 v[24:27], v[164:167], v[80:83], v[24:27]
    ds_read_b128 v[60:63], v15 offset:10240
    v_mfma_f32_16x16x32_bf16 v[20:23], v[164:167], v[76:79], v[20:23]
    ds_read_b128 v[64:67], v15 offset:14336
    s_waitcnt lgkmcnt(4)
    v_mfma_f32_16x16x32_bf16 v[20:23], v[168:171], v[84:87], v[20:23]
    ds_read_b128 v[68:71], v15 offset:3072
    v_mfma_f32_16x16x32_bf16 v[24:27], v[168:171], v[88:91], v[24:27]
    ds_read_b128 v[72:75], v15 offset:7168
    v_mfma_f32_16x16x32_bf16 v[24:27], v[172:175], v[96:99], v[24:27]
    ds_read_b128 v[76:79], v15 offset:11264
    v_mfma_f32_16x16x32_bf16 v[20:23], v[172:175], v[92:95], v[20:23]
    ds_read_b128 v[80:83], v15 offset:15360
    s_waitcnt vmcnt(0)
    s_barrier
    s_waitcnt lgkmcnt(4)
    v_mfma_f32_16x16x32_bf16 v[20:23], v[176:179], v[52:55], v[20:23]
    ds_read_b128 v[84:87], v15 offset:16384
    v_mfma_f32_16x16x32_bf16 v[24:27], v[176:179], v[56:59], v[24:27]
    ds_read_b128 v[88:91], v15 offset:20480
    v_mfma_f32_16x16x32_bf16 v[24:27], v[180:183], v[64:67], v[24:27]
    ds_read_b128 v[92:95], v15 offset:24576
    v_mfma_f32_16x16x32_bf16 v[20:23], v[180:183], v[60:63], v[20:23]
    ds_read_b128 v[96:99], v15 offset:28672
    s_waitcnt lgkmcnt(4)
    v_mfma_f32_16x16x32_bf16 v[20:23], v[184:187], v[68:71], v[20:23]
    ds_read_b128 v[52:55], v15 offset:17408
    v_mfma_f32_16x16x32_bf16 v[24:27], v[184:187], v[72:75], v[24:27]
    ds_read_b128 v[56:59], v15 offset:21504
    v_mfma_f32_16x16x32_bf16 v[24:27], v[188:191], v[80:83], v[24:27]
    ds_read_b128 v[60:63], v15 offset:25600
    v_mfma_f32_16x16x32_bf16 v[20:23], v[188:191], v[76:79], v[20:23]
    ds_read_b128 v[64:67], v15 offset:29696
    s_waitcnt lgkmcnt(4)
    v_mfma_f32_16x16x32_bf16 v[20:23], v[192:195], v[84:87], v[20:23]
    ds_read_b128 v[68:71], v15 offset:18432
    v_mfma_f32_16x16x32_bf16 v[24:27], v[192:195], v[88:91], v[24:27]
    ds_read_b128 v[72:75], v15 offset:22528
    v_mfma_f32_16x16x32_bf16 v[24:27], v[196:199], v[96:99], v[24:27]
    ds_read_b128 v[76:79], v15 offset:26624
    v_mfma_f32_16x16x32_bf16 v[20:23], v[196:199], v[92:95], v[20:23]
    ds_read_b128 v[80:83], v15 offset:30720
    s_waitcnt lgkmcnt(4)
    v_mfma_f32_16x16x32_bf16 v[20:23], v[200:203], v[52:55], v[20:23]
    ds_read_b128 v[84:87], v15 offset:19456
    v_mfma_f32_16x16x32_bf16 v[24:27], v[200:203], v[56:59], v[24:27]
    ds_read_b128 v[88:91], v15 offset:23552
    v_mfma_f32_16x16x32_bf16 v[24:27], v[204:207], v[64:67], v[24:27]
    ds_read_b128 v[92:95], v15 offset:27648
    v_mfma_f32_16x16x32_bf16 v[20:23], v[204:207], v[60:63], v[20:23]
    ds_read_b128 v[96:99], v15 offset:31744
    s_barrier
    s_waitcnt lgkmcnt(4)
    v_mfma_f32_16x16x32_bf16 v[20:23], v[208:211], v[68:71], v[20:23]
    ds_read_b128 v[52:55], v15 offset:32768
    v_mfma_f32_16x16x32_bf16 v[24:27], v[208:211], v[72:75], v[24:27]
    ds_read_b128 v[56:59], v15 offset:36864
    v_mfma_f32_16x16x32_bf16 v[24:27], v[212:215], v[80:83], v[24:27]
    ds_read_b128 v[60:63], v15 offset:40960
    v_mfma_f32_16x16x32_bf16 v[20:23], v[212:215], v[76:79], v[20:23]
    ds_read_b128 v[64:67], v15 offset:45056
    s_waitcnt lgkmcnt(4)
    v_mfma_f32_16x16x32_bf16 v[20:23], v[216:219], v[84:87], v[20:23]
    ds_read_b128 v[68:71], v15 offset:33792
    v_mfma_f32_16x16x32_bf16 v[24:27], v[216:219], v[88:91], v[24:27]
    ds_read_b128 v[72:75], v15 offset:37888
    v_mfma_f32_16x16x32_bf16 v[24:27], v[220:223], v[96:99], v[24:27]
    ds_read_b128 v[76:79], v15 offset:41984
    v_mfma_f32_16x16x32_bf16 v[20:23], v[220:223], v[92:95], v[20:23]
    ds_read_b128 v[80:83], v15 offset:46080
    s_waitcnt lgkmcnt(4)
    v_mfma_f32_16x16x32_bf16 v[20:23], v[224:227], v[52:55], v[20:23]
    ds_read_b128 v[84:87], v15 offset:34816
    v_mfma_f32_16x16x32_bf16 v[24:27], v[224:227], v[56:59], v[24:27]
    ds_read_b128 v[88:91], v15 offset:38912
    v_mfma_f32_16x16x32_bf16 v[24:27], v[228:231], v[64:67], v[24:27]
    ds_read_b128 v[92:95], v15 offset:43008
    v_mfma_f32_16x16x32_bf16 v[20:23], v[228:231], v[60:63], v[20:23]
    ds_read_b128 v[96:99], v15 offset:47104
    s_waitcnt lgkmcnt(4)
    v_mfma_f32_16x16x32_bf16 v[20:23], v[232:235], v[68:71], v[20:23]
    ds_read_b128 v[52:55], v15 offset:35840
    v_mfma_f32_16x16x32_bf16 v[24:27], v[232:235], v[72:75], v[24:27]
    ds_read_b128 v[56:59], v15 offset:39936
    v_mfma_f32_16x16x32_bf16 v[24:27], v[236:239], v[80:83], v[24:27]
    ds_read_b128 v[60:63], v15 offset:44032
    v_mfma_f32_16x16x32_bf16 v[20:23], v[236:239], v[76:79], v[20:23]
    ds_read_b128 v[64:67], v15 offset:48128
    s_barrier
    s_waitcnt lgkmcnt(4)
    v_mfma_f32_16x16x32_bf16 v[20:23], v[240:243], v[84:87], v[20:23]
    ds_read_b128 v[68:71], v14 offset:16384
    v_mfma_f32_16x16x32_bf16 v[24:27], v[240:243], v[88:91], v[24:27]
    ds_read_b128 v[72:75], v14 offset:20480
    v_mfma_f32_16x16x32_bf16 v[24:27], v[244:247], v[96:99], v[24:27]
    ds_read_b128 v[76:79], v14 offset:24576
    v_mfma_f32_16x16x32_bf16 v[20:23], v[244:247], v[92:95], v[20:23]
    ds_read_b128 v[80:83], v14 offset:28672
    s_waitcnt lgkmcnt(4)
    v_mfma_f32_16x16x32_bf16 v[20:23], v[248:251], v[52:55], v[20:23]
    ds_read_b128 v[84:87], v14 offset:17408
    v_mfma_f32_16x16x32_bf16 v[24:27], v[248:251], v[56:59], v[24:27]
    ds_read_b128 v[88:91], v14 offset:21504
    v_mfma_f32_16x16x32_bf16 v[24:27], v[252:255], v[64:67], v[24:27]
    ds_read_b128 v[92:95], v14 offset:25600
    v_mfma_f32_16x16x32_bf16 v[20:23], v[252:255], v[60:63], v[20:23]
    ds_read_b128 v[96:99], v14 offset:29696
    s_waitcnt lgkmcnt(4)
    v_mfma_f32_16x16x32_bf16 v[28:31], v[128:131], v[68:71], v[28:31]
    ds_read_b128 v[52:55], v14 offset:18432
    v_mfma_f32_16x16x32_bf16 v[32:35], v[128:131], v[72:75], v[32:35]
    ds_read_b128 v[56:59], v14 offset:22528
    v_mfma_f32_16x16x32_bf16 v[32:35], v[132:135], v[80:83], v[32:35]
    ds_read_b128 v[60:63], v14 offset:26624
    v_mfma_f32_16x16x32_bf16 v[28:31], v[132:135], v[76:79], v[28:31]
    ds_read_b128 v[64:67], v14 offset:30720
    v_cvt_pk_bf16_f32 v20, v20, v21
    v_cvt_pk_bf16_f32 v21, v22, v23
    v_cvt_pk_bf16_f32 v22, v24, v25
    v_cvt_pk_bf16_f32 v23, v26, v27
    s_add_u32 s36, s39, 0
    v_permlane16_swap_b32 v20, v22
    v_permlane16_swap_b32 v21, v23
    s_waitcnt lgkmcnt(4)
    v_mfma_f32_16x16x32_bf16 v[28:31], v[136:139], v[84:87], v[28:31]
    ds_read_b128 v[68:71], v14 offset:19456
    v_mfma_f32_16x16x32_bf16 v[32:35], v[136:139], v[88:91], v[32:35]
    ds_read_b128 v[72:75], v14 offset:23552
    v_mfma_f32_16x16x32_bf16 v[32:35], v[140:143], v[96:99], v[32:35]
    ds_read_b128 v[76:79], v14 offset:27648
    v_mfma_f32_16x16x32_bf16 v[28:31], v[140:143], v[92:95], v[28:31]
    ds_read_b128 v[80:83], v14 offset:31744
    s_barrier
    s_waitcnt lgkmcnt(4)
    v_mfma_f32_16x16x32_bf16 v[28:31], v[144:147], v[52:55], v[28:31]
    ds_read_b128 v[84:87], v14 offset:32768
    v_mfma_f32_16x16x32_bf16 v[32:35], v[144:147], v[56:59], v[32:35]
    ds_read_b128 v[88:91], v14 offset:36864
    v_mfma_f32_16x16x32_bf16 v[32:35], v[148:151], v[64:67], v[32:35]
    ds_read_b128 v[92:95], v14 offset:40960
    v_mfma_f32_16x16x32_bf16 v[28:31], v[148:151], v[60:63], v[28:31]
    ds_read_b128 v[96:99], v14 offset:45056
    s_waitcnt lgkmcnt(4)
    v_mfma_f32_16x16x32_bf16 v[28:31], v[152:155], v[68:71], v[28:31]
    ds_read_b128 v[52:55], v14 offset:33792
    v_mfma_f32_16x16x32_bf16 v[32:35], v[152:155], v[72:75], v[32:35]
    ds_read_b128 v[56:59], v14 offset:37888
    v_mfma_f32_16x16x32_bf16 v[32:35], v[156:159], v[80:83], v[32:35]
    ds_read_b128 v[60:63], v14 offset:41984
    v_mfma_f32_16x16x32_bf16 v[28:31], v[156:159], v[76:79], v[28:31]
    ds_read_b128 v[64:67], v14 offset:46080
    s_waitcnt lgkmcnt(4)
    v_mfma_f32_16x16x32_bf16 v[28:31], v[160:163], v[84:87], v[28:31]
    ds_read_b128 v[68:71], v14 offset:34816
    v_mfma_f32_16x16x32_bf16 v[32:35], v[160:163], v[88:91], v[32:35]
    ds_read_b128 v[72:75], v14 offset:38912
    v_mfma_f32_16x16x32_bf16 v[32:35], v[164:167], v[96:99], v[32:35]
    ds_read_b128 v[76:79], v14 offset:43008
    v_mfma_f32_16x16x32_bf16 v[28:31], v[164:167], v[92:95], v[28:31]
    ds_read_b128 v[80:83], v14 offset:47104
    s_waitcnt lgkmcnt(4)
    v_mfma_f32_16x16x32_bf16 v[28:31], v[168:171], v[52:55], v[28:31]
    ds_read_b128 v[84:87], v14 offset:35840
    v_mfma_f32_16x16x32_bf16 v[32:35], v[168:171], v[56:59], v[32:35]
    ds_read_b128 v[88:91], v14 offset:39936
    v_mfma_f32_16x16x32_bf16 v[32:35], v[172:175], v[64:67], v[32:35]
    ds_read_b128 v[92:95], v14 offset:44032
    v_mfma_f32_16x16x32_bf16 v[28:31], v[172:175], v[60:63], v[28:31]
    ds_read_b128 v[96:99], v14 offset:48128
    s_barrier
    s_waitcnt lgkmcnt(4)
    v_mfma_f32_16x16x32_bf16 v[28:31], v[176:179], v[68:71], v[28:31]
    ds_read_b128 v[52:55], v15 offset:0
    v_mfma_f32_16x16x32_bf16 v[32:35], v[176:179], v[72:75], v[32:35]
    ds_read_b128 v[56:59], v15 offset:4096
    v_mfma_f32_16x16x32_bf16 v[32:35], v[180:183], v[80:83], v[32:35]
    ds_read_b128 v[60:63], v15 offset:8192
    v_mfma_f32_16x16x32_bf16 v[28:31], v[180:183], v[76:79], v[28:31]
    ds_read_b128 v[64:67], v15 offset:12288
    s_waitcnt lgkmcnt(4)
    v_mfma_f32_16x16x32_bf16 v[28:31], v[184:187], v[84:87], v[28:31]
    ds_read_b128 v[68:71], v15 offset:1024
    v_mfma_f32_16x16x32_bf16 v[32:35], v[184:187], v[88:91], v[32:35]
    ds_read_b128 v[72:75], v15 offset:5120
    v_mfma_f32_16x16x32_bf16 v[32:35], v[188:191], v[96:99], v[32:35]
    ds_read_b128 v[76:79], v15 offset:9216
    v_mfma_f32_16x16x32_bf16 v[28:31], v[188:191], v[92:95], v[28:31]
    ds_read_b128 v[80:83], v15 offset:13312
    s_waitcnt lgkmcnt(4)
    v_mfma_f32_16x16x32_bf16 v[28:31], v[192:195], v[52:55], v[28:31]
    ds_read_b128 v[84:87], v15 offset:2048
    v_mfma_f32_16x16x32_bf16 v[32:35], v[192:195], v[56:59], v[32:35]
    ds_read_b128 v[88:91], v15 offset:6144
    v_mfma_f32_16x16x32_bf16 v[32:35], v[196:199], v[64:67], v[32:35]
    ds_read_b128 v[92:95], v15 offset:10240
    v_mfma_f32_16x16x32_bf16 v[28:31], v[196:199], v[60:63], v[28:31]
    ds_read_b128 v[96:99], v15 offset:14336
    s_waitcnt lgkmcnt(4)
    v_mfma_f32_16x16x32_bf16 v[28:31], v[200:203], v[68:71], v[28:31]
    ds_read_b128 v[52:55], v15 offset:3072
    v_mfma_f32_16x16x32_bf16 v[32:35], v[200:203], v[72:75], v[32:35]
    ds_read_b128 v[56:59], v15 offset:7168
    v_mfma_f32_16x16x32_bf16 v[32:35], v[204:207], v[80:83], v[32:35]
    ds_read_b128 v[60:63], v15 offset:11264
    v_mfma_f32_16x16x32_bf16 v[28:31], v[204:207], v[76:79], v[28:31]
    ds_read_b128 v[64:67], v15 offset:15360
    s_barrier
    s_waitcnt lgkmcnt(4)
    v_mfma_f32_16x16x32_bf16 v[28:31], v[208:211], v[84:87], v[28:31]
    ds_read_b128 v[68:71], v15 offset:16384
    v_mfma_f32_16x16x32_bf16 v[32:35], v[208:211], v[88:91], v[32:35]
    ds_read_b128 v[72:75], v15 offset:20480
    v_mfma_f32_16x16x32_bf16 v[32:35], v[212:215], v[96:99], v[32:35]
    ds_read_b128 v[76:79], v15 offset:24576
    v_mfma_f32_16x16x32_bf16 v[28:31], v[212:215], v[92:95], v[28:31]
    ds_read_b128 v[80:83], v15 offset:28672
    s_waitcnt lgkmcnt(4)
    v_mfma_f32_16x16x32_bf16 v[28:31], v[216:219], v[52:55], v[28:31]
    ds_read_b128 v[84:87], v15 offset:17408
    v_mfma_f32_16x16x32_bf16 v[32:35], v[216:219], v[56:59], v[32:35]
    ds_read_b128 v[88:91], v15 offset:21504
    v_mfma_f32_16x16x32_bf16 v[32:35], v[220:223], v[64:67], v[32:35]
    ds_read_b128 v[92:95], v15 offset:25600
    v_mfma_f32_16x16x32_bf16 v[28:31], v[220:223], v[60:63], v[28:31]
    ds_read_b128 v[96:99], v15 offset:29696
    s_waitcnt lgkmcnt(4)
    v_mfma_f32_16x16x32_bf16 v[28:31], v[224:227], v[68:71], v[28:31]
    ds_read_b128 v[52:55], v15 offset:18432
    v_mfma_f32_16x16x32_bf16 v[32:35], v[224:227], v[72:75], v[32:35]
    ds_read_b128 v[56:59], v15 offset:22528
    v_mfma_f32_16x16x32_bf16 v[32:35], v[228:231], v[80:83], v[32:35]
    ds_read_b128 v[60:63], v15 offset:26624
    v_mfma_f32_16x16x32_bf16 v[28:31], v[228:231], v[76:79], v[28:31]
    ds_read_b128 v[64:67], v15 offset:30720
    s_waitcnt lgkmcnt(4)
    v_mfma_f32_16x16x32_bf16 v[28:31], v[232:235], v[84:87], v[28:31]
    ds_read_b128 v[68:71], v15 offset:19456
    v_mfma_f32_16x16x32_bf16 v[32:35], v[232:235], v[88:91], v[32:35]
    ds_read_b128 v[72:75], v15 offset:23552
    v_mfma_f32_16x16x32_bf16 v[32:35], v[236:239], v[96:99], v[32:35]
    ds_read_b128 v[76:79], v15 offset:27648
    v_mfma_f32_16x16x32_bf16 v[28:31], v[236:239], v[92:95], v[28:31]
    ds_read_b128 v[80:83], v15 offset:31744
    s_barrier
    s_waitcnt lgkmcnt(4)
    v_mfma_f32_16x16x32_bf16 v[28:31], v[240:243], v[52:55], v[28:31]
    ds_read_b128 v[84:87], v15 offset:32768
    v_mfma_f32_16x16x32_bf16 v[32:35], v[240:243], v[56:59], v[32:35]
    ds_read_b128 v[88:91], v15 offset:36864
    v_mfma_f32_16x16x32_bf16 v[32:35], v[244:247], v[64:67], v[32:35]
    ds_read_b128 v[92:95], v15 offset:40960
    v_mfma_f32_16x16x32_bf16 v[28:31], v[244:247], v[60:63], v[28:31]
    ds_read_b128 v[96:99], v15 offset:45056
    s_waitcnt lgkmcnt(4)
    v_mfma_f32_16x16x32_bf16 v[28:31], v[248:251], v[68:71], v[28:31]
    ds_read_b128 v[52:55], v15 offset:33792
    v_mfma_f32_16x16x32_bf16 v[32:35], v[248:251], v[72:75], v[32:35]
    ds_read_b128 v[56:59], v15 offset:37888
    v_mfma_f32_16x16x32_bf16 v[32:35], v[252:255], v[80:83], v[32:35]
    ds_read_b128 v[60:63], v15 offset:41984
    v_mfma_f32_16x16x32_bf16 v[28:31], v[252:255], v[76:79], v[28:31]
    ds_read_b128 v[64:67], v15 offset:46080
    s_waitcnt lgkmcnt(4)
    v_mfma_f32_16x16x32_bf16 v[36:39], v[128:131], v[84:87], v[36:39]
    ds_read_b128 v[68:71], v15 offset:34816
    v_mfma_f32_16x16x32_bf16 v[40:43], v[128:131], v[88:91], v[40:43]
    ds_read_b128 v[72:75], v15 offset:38912
    v_mfma_f32_16x16x32_bf16 v[40:43], v[132:135], v[96:99], v[40:43]
    ds_read_b128 v[76:79], v15 offset:43008
    v_mfma_f32_16x16x32_bf16 v[36:39], v[132:135], v[92:95], v[36:39]
    ds_read_b128 v[80:83], v15 offset:47104
    v_cvt_pk_bf16_f32 v28, v28, v29
    v_cvt_pk_bf16_f32 v29, v30, v31
    v_cvt_pk_bf16_f32 v30, v32, v33
    v_cvt_pk_bf16_f32 v31, v34, v35
    s_add_u32 s36, s39, 131072
    v_permlane16_swap_b32 v28, v30
    v_permlane16_swap_b32 v29, v31
    s_waitcnt lgkmcnt(4)
    v_mfma_f32_16x16x32_bf16 v[36:39], v[136:139], v[52:55], v[36:39]
    ds_read_b128 v[84:87], v15 offset:35840
    v_mfma_f32_16x16x32_bf16 v[40:43], v[136:139], v[56:59], v[40:43]
    ds_read_b128 v[88:91], v15 offset:39936
    v_mfma_f32_16x16x32_bf16 v[40:43], v[140:143], v[64:67], v[40:43]
    ds_read_b128 v[92:95], v15 offset:44032
    v_mfma_f32_16x16x32_bf16 v[36:39], v[140:143], v[60:63], v[36:39]
    ds_read_b128 v[96:99], v15 offset:48128
    s_barrier
    s_waitcnt lgkmcnt(4)
    v_mfma_f32_16x16x32_bf16 v[36:39], v[144:147], v[68:71], v[36:39]
    ds_read_b128 v[52:55], v14 offset:16384
    v_mfma_f32_16x16x32_bf16 v[40:43], v[144:147], v[72:75], v[40:43]
    ds_read_b128 v[56:59], v14 offset:20480
    v_mfma_f32_16x16x32_bf16 v[40:43], v[148:151], v[80:83], v[40:43]
    ds_read_b128 v[60:63], v14 offset:24576
    v_mfma_f32_16x16x32_bf16 v[36:39], v[148:151], v[76:79], v[36:39]
    ds_read_b128 v[64:67], v14 offset:28672
    s_waitcnt lgkmcnt(4)
    v_mfma_f32_16x16x32_bf16 v[36:39], v[152:155], v[84:87], v[36:39]
    ds_read_b128 v[68:71], v14 offset:17408
    v_mfma_f32_16x16x32_bf16 v[40:43], v[152:155], v[88:91], v[40:43]
    ds_read_b128 v[72:75], v14 offset:21504
    v_mfma_f32_16x16x32_bf16 v[40:43], v[156:159], v[96:99], v[40:43]
    ds_read_b128 v[76:79], v14 offset:25600
    v_mfma_f32_16x16x32_bf16 v[36:39], v[156:159], v[92:95], v[36:39]
    ds_read_b128 v[80:83], v14 offset:29696
    s_waitcnt lgkmcnt(4)
    v_mfma_f32_16x16x32_bf16 v[36:39], v[160:163], v[52:55], v[36:39]
    ds_read_b128 v[84:87], v14 offset:18432
    v_mfma_f32_16x16x32_bf16 v[40:43], v[160:163], v[56:59], v[40:43]
    ds_read_b128 v[88:91], v14 offset:22528
    v_mfma_f32_16x16x32_bf16 v[40:43], v[164:167], v[64:67], v[40:43]
    ds_read_b128 v[92:95], v14 offset:26624
    v_mfma_f32_16x16x32_bf16 v[36:39], v[164:167], v[60:63], v[36:39]
    ds_read_b128 v[96:99], v14 offset:30720
    s_waitcnt lgkmcnt(4)
    v_mfma_f32_16x16x32_bf16 v[36:39], v[168:171], v[68:71], v[36:39]
    ds_read_b128 v[52:55], v14 offset:19456
    v_mfma_f32_16x16x32_bf16 v[40:43], v[168:171], v[72:75], v[40:43]
    ds_read_b128 v[56:59], v14 offset:23552
    v_mfma_f32_16x16x32_bf16 v[40:43], v[172:175], v[80:83], v[40:43]
    ds_read_b128 v[60:63], v14 offset:27648
    v_mfma_f32_16x16x32_bf16 v[36:39], v[172:175], v[76:79], v[36:39]
    ds_read_b128 v[64:67], v14 offset:31744
    s_barrier
    s_waitcnt lgkmcnt(4)
    v_mfma_f32_16x16x32_bf16 v[36:39], v[176:179], v[84:87], v[36:39]
    ds_read_b128 v[68:71], v14 offset:32768
    v_mfma_f32_16x16x32_bf16 v[40:43], v[176:179], v[88:91], v[40:43]
    ds_read_b128 v[72:75], v14 offset:36864
    v_mfma_f32_16x16x32_bf16 v[40:43], v[180:183], v[96:99], v[40:43]
    ds_read_b128 v[76:79], v14 offset:40960
    v_mfma_f32_16x16x32_bf16 v[36:39], v[180:183], v[92:95], v[36:39]
    ds_read_b128 v[80:83], v14 offset:45056
    s_waitcnt lgkmcnt(4)
    v_mfma_f32_16x16x32_bf16 v[36:39], v[184:187], v[52:55], v[36:39]
    ds_read_b128 v[84:87], v14 offset:33792
    v_mfma_f32_16x16x32_bf16 v[40:43], v[184:187], v[56:59], v[40:43]
    ds_read_b128 v[88:91], v14 offset:37888
    v_mfma_f32_16x16x32_bf16 v[40:43], v[188:191], v[64:67], v[40:43]
    ds_read_b128 v[92:95], v14 offset:41984
    v_mfma_f32_16x16x32_bf16 v[36:39], v[188:191], v[60:63], v[36:39]
    ds_read_b128 v[96:99], v14 offset:46080
    s_waitcnt lgkmcnt(4)
    v_mfma_f32_16x16x32_bf16 v[36:39], v[192:195], v[68:71], v[36:39]
    ds_read_b128 v[52:55], v14 offset:34816
    v_mfma_f32_16x16x32_bf16 v[40:43], v[192:195], v[72:75], v[40:43]
    ds_read_b128 v[56:59], v14 offset:38912
    v_mfma_f32_16x16x32_bf16 v[40:43], v[196:199], v[80:83], v[40:43]
    ds_read_b128 v[60:63], v14 offset:43008
    v_mfma_f32_16x16x32_bf16 v[36:39], v[196:199], v[76:79], v[36:39]
    ds_read_b128 v[64:67], v14 offset:47104
    s_waitcnt lgkmcnt(4)
    v_mfma_f32_16x16x32_bf16 v[36:39], v[200:203], v[84:87], v[36:39]
    ds_read_b128 v[68:71], v14 offset:35840
    v_mfma_f32_16x16x32_bf16 v[40:43], v[200:203], v[88:91], v[40:43]
    ds_read_b128 v[72:75], v14 offset:39936
    v_mfma_f32_16x16x32_bf16 v[40:43], v[204:207], v[96:99], v[40:43]
    ds_read_b128 v[76:79], v14 offset:44032
    v_mfma_f32_16x16x32_bf16 v[36:39], v[204:207], v[92:95], v[36:39]
    ds_read_b128 v[80:83], v14 offset:48128
    s_barrier
    s_waitcnt lgkmcnt(4)
    v_mfma_f32_16x16x32_bf16 v[36:39], v[208:211], v[52:55], v[36:39]
    ds_read_b128 v[84:87], v15 offset:0
    v_mfma_f32_16x16x32_bf16 v[40:43], v[208:211], v[56:59], v[40:43]
    ds_read_b128 v[88:91], v15 offset:4096
    v_mfma_f32_16x16x32_bf16 v[40:43], v[212:215], v[64:67], v[40:43]
    ds_read_b128 v[92:95], v15 offset:8192
    v_mfma_f32_16x16x32_bf16 v[36:39], v[212:215], v[60:63], v[36:39]
    ds_read_b128 v[96:99], v15 offset:12288
    s_waitcnt lgkmcnt(4)
    v_mfma_f32_16x16x32_bf16 v[36:39], v[216:219], v[68:71], v[36:39]
    ds_read_b128 v[52:55], v15 offset:1024
    v_mfma_f32_16x16x32_bf16 v[40:43], v[216:219], v[72:75], v[40:43]
    ds_read_b128 v[56:59], v15 offset:5120
    v_mfma_f32_16x16x32_bf16 v[40:43], v[220:223], v[80:83], v[40:43]
    ds_read_b128 v[60:63], v15 offset:9216
    v_mfma_f32_16x16x32_bf16 v[36:39], v[220:223], v[76:79], v[36:39]
    ds_read_b128 v[64:67], v15 offset:13312
    s_waitcnt lgkmcnt(4)
    v_mfma_f32_16x16x32_bf16 v[36:39], v[224:227], v[84:87], v[36:39]
    ds_read_b128 v[68:71], v15 offset:2048
    v_mfma_f32_16x16x32_bf16 v[40:43], v[224:227], v[88:91], v[40:43]
    ds_read_b128 v[72:75], v15 offset:6144
    v_mfma_f32_16x16x32_bf16 v[40:43], v[228:231], v[96:99], v[40:43]
    ds_read_b128 v[76:79], v15 offset:10240
    v_mfma_f32_16x16x32_bf16 v[36:39], v[228:231], v[92:95], v[36:39]
    ds_read_b128 v[80:83], v15 offset:14336
    s_waitcnt lgkmcnt(4)
    v_mfma_f32_16x16x32_bf16 v[36:39], v[232:235], v[52:55], v[36:39]
    ds_read_b128 v[84:87], v15 offset:3072
    v_mfma_f32_16x16x32_bf16 v[40:43], v[232:235], v[56:59], v[40:43]
    ds_read_b128 v[88:91], v15 offset:7168
    v_mfma_f32_16x16x32_bf16 v[40:43], v[236:239], v[64:67], v[40:43]
    ds_read_b128 v[92:95], v15 offset:11264
    v_mfma_f32_16x16x32_bf16 v[36:39], v[236:239], v[60:63], v[36:39]
    ds_read_b128 v[96:99], v15 offset:15360
    s_barrier
    s_waitcnt lgkmcnt(4)
    v_mfma_f32_16x16x32_bf16 v[36:39], v[240:243], v[68:71], v[36:39]
    ds_read_b128 v[52:55], v15 offset:16384
    v_mfma_f32_16x16x32_bf16 v[40:43], v[240:243], v[72:75], v[40:43]
    ds_read_b128 v[56:59], v15 offset:20480
    v_mfma_f32_16x16x32_bf16 v[40:43], v[244:247], v[80:83], v[40:43]
    ds_read_b128 v[60:63], v15 offset:24576
    v_mfma_f32_16x16x32_bf16 v[36:39], v[244:247], v[76:79], v[36:39]
    ds_read_b128 v[64:67], v15 offset:28672
    s_waitcnt lgkmcnt(4)
    v_mfma_f32_16x16x32_bf16 v[36:39], v[248:251], v[84:87], v[36:39]
    ds_read_b128 v[68:71], v15 offset:17408
    v_mfma_f32_16x16x32_bf16 v[40:43], v[248:251], v[88:91], v[40:43]
    ds_read_b128 v[72:75], v15 offset:21504
    v_mfma_f32_16x16x32_bf16 v[40:43], v[252:255], v[96:99], v[40:43]
    ds_read_b128 v[76:79], v15 offset:25600
    v_mfma_f32_16x16x32_bf16 v[36:39], v[252:255], v[92:95], v[36:39]
    ds_read_b128 v[80:83], v15 offset:29696
    s_waitcnt lgkmcnt(4)
    v_mfma_f32_16x16x32_bf16 v[44:47], v[128:131], v[52:55], v[44:47]
    ds_read_b128 v[84:87], v15 offset:18432
    v_mfma_f32_16x16x32_bf16 v[48:51], v[128:131], v[56:59], v[48:51]
    ds_read_b128 v[88:91], v15 offset:22528
    v_mfma_f32_16x16x32_bf16 v[48:51], v[132:135], v[64:67], v[48:51]
    ds_read_b128 v[92:95], v15 offset:26624
    v_mfma_f32_16x16x32_bf16 v[44:47], v[132:135], v[60:63], v[44:47]
    ds_read_b128 v[96:99], v15 offset:30720
    v_cvt_pk_bf16_f32 v36, v36, v37
    v_cvt_pk_bf16_f32 v37, v38, v39
    v_cvt_pk_bf16_f32 v38, v40, v41
    v_cvt_pk_bf16_f32 v39, v42, v43
    s_add_u32 s36, s39, 262144
    v_permlane16_swap_b32 v36, v38
    v_permlane16_swap_b32 v37, v39
    s_waitcnt lgkmcnt(4)
    v_mfma_f32_16x16x32_bf16 v[44:47], v[136:139], v[68:71], v[44:47]
    ds_read_b128 v[52:55], v15 offset:19456
    v_mfma_f32_16x16x32_bf16 v[48:51], v[136:139], v[72:75], v[48:51]
    ds_read_b128 v[56:59], v15 offset:23552
    v_mfma_f32_16x16x32_bf16 v[48:51], v[140:143], v[80:83], v[48:51]
    ds_read_b128 v[60:63], v15 offset:27648
    v_mfma_f32_16x16x32_bf16 v[44:47], v[140:143], v[76:79], v[44:47]
    ds_read_b128 v[64:67], v15 offset:31744
    s_barrier
    s_waitcnt lgkmcnt(4)
    v_mfma_f32_16x16x32_bf16 v[44:47], v[144:147], v[84:87], v[44:47]
    ds_read_b128 v[68:71], v15 offset:32768
    v_mfma_f32_16x16x32_bf16 v[48:51], v[144:147], v[88:91], v[48:51]
    ds_read_b128 v[72:75], v15 offset:36864
    v_mfma_f32_16x16x32_bf16 v[48:51], v[148:151], v[96:99], v[48:51]
    ds_read_b128 v[76:79], v15 offset:40960
    v_mfma_f32_16x16x32_bf16 v[44:47], v[148:151], v[92:95], v[44:47]
    ds_read_b128 v[80:83], v15 offset:45056
    s_add_u32 s36, s39, 0
    buffer_store_dwordx4 v[20:23], v13, s[24:27], s36 offen sc1
    s_waitcnt lgkmcnt(4)
    v_mfma_f32_16x16x32_bf16 v[44:47], v[152:155], v[52:55], v[44:47]
    ds_read_b128 v[84:87], v15 offset:33792
    v_mfma_f32_16x16x32_bf16 v[48:51], v[152:155], v[56:59], v[48:51]
    ds_read_b128 v[88:91], v15 offset:37888
    v_mfma_f32_16x16x32_bf16 v[48:51], v[156:159], v[64:67], v[48:51]
    ds_read_b128 v[92:95], v15 offset:41984
    v_mfma_f32_16x16x32_bf16 v[44:47], v[156:159], v[60:63], v[44:47]
    ds_read_b128 v[96:99], v15 offset:46080
    s_add_u32 s36, s39, 131072
    buffer_store_dwordx4 v[28:31], v13, s[24:27], s36 offen sc1
    s_waitcnt lgkmcnt(4)
    v_mfma_f32_16x16x32_bf16 v[44:47], v[160:163], v[68:71], v[44:47]
    ds_read_b128 v[52:55], v15 offset:34816
    v_mfma_f32_16x16x32_bf16 v[48:51], v[160:163], v[72:75], v[48:51]
    ds_read_b128 v[56:59], v15 offset:38912
    v_mfma_f32_16x16x32_bf16 v[48:51], v[164:167], v[80:83], v[48:51]
    ds_read_b128 v[60:63], v15 offset:43008
    v_mfma_f32_16x16x32_bf16 v[44:47], v[164:167], v[76:79], v[44:47]
    ds_read_b128 v[64:67], v15 offset:47104
    s_add_u32 s36, s39, 262144
    buffer_store_dwordx4 v[36:39], v13, s[24:27], s36 offen sc1
    s_waitcnt lgkmcnt(4)
    v_mfma_f32_16x16x32_bf16 v[44:47], v[168:171], v[84:87], v[44:47]
    ds_read_b128 v[68:71], v15 offset:35840
    v_mfma_f32_16x16x32_bf16 v[48:51], v[168:171], v[88:91], v[48:51]
    ds_read_b128 v[72:75], v15 offset:39936
    v_mfma_f32_16x16x32_bf16 v[48:51], v[172:175], v[96:99], v[48:51]
    ds_read_b128 v[76:79], v15 offset:44032
    v_mfma_f32_16x16x32_bf16 v[44:47], v[172:175], v[92:95], v[44:47]
    ds_read_b128 v[80:83], v15 offset:48128
    s_barrier
    s_waitcnt lgkmcnt(4)
    v_mfma_f32_16x16x32_bf16 v[44:47], v[176:179], v[52:55], v[44:47]
    ds_read_b128 v[84:87], v14 offset:16384
    v_mfma_f32_16x16x32_bf16 v[48:51], v[176:179], v[56:59], v[48:51]
    ds_read_b128 v[88:91], v14 offset:20480
    v_mfma_f32_16x16x32_bf16 v[48:51], v[180:183], v[64:67], v[48:51]
    ds_read_b128 v[92:95], v14 offset:24576
    v_mfma_f32_16x16x32_bf16 v[44:47], v[180:183], v[60:63], v[44:47]
    ds_read_b128 v[96:99], v14 offset:28672
    s_waitcnt lgkmcnt(4)
    v_mfma_f32_16x16x32_bf16 v[44:47], v[184:187], v[68:71], v[44:47]
    ds_read_b128 v[52:55], v14 offset:17408
    v_mfma_f32_16x16x32_bf16 v[48:51], v[184:187], v[72:75], v[48:51]
    ds_read_b128 v[56:59], v14 offset:21504
    v_mfma_f32_16x16x32_bf16 v[48:51], v[188:191], v[80:83], v[48:51]
    ds_read_b128 v[60:63], v14 offset:25600
    v_mfma_f32_16x16x32_bf16 v[44:47], v[188:191], v[76:79], v[44:47]
    ds_read_b128 v[64:67], v14 offset:29696
    s_waitcnt lgkmcnt(4)
    v_mfma_f32_16x16x32_bf16 v[44:47], v[192:195], v[84:87], v[44:47]
    ds_read_b128 v[68:71], v14 offset:18432
    v_mfma_f32_16x16x32_bf16 v[48:51], v[192:195], v[88:91], v[48:51]
    ds_read_b128 v[72:75], v14 offset:22528
    v_mfma_f32_16x16x32_bf16 v[48:51], v[196:199], v[96:99], v[48:51]
    ds_read_b128 v[76:79], v14 offset:26624
    v_mfma_f32_16x16x32_bf16 v[44:47], v[196:199], v[92:95], v[44:47]
    ds_read_b128 v[80:83], v14 offset:30720
    s_waitcnt lgkmcnt(4)
    v_mfma_f32_16x16x32_bf16 v[44:47], v[200:203], v[52:55], v[44:47]
    ds_read_b128 v[84:87], v14 offset:19456
    v_mfma_f32_16x16x32_bf16 v[48:51], v[200:203], v[56:59], v[48:51]
    ds_read_b128 v[88:91], v14 offset:23552
    v_mfma_f32_16x16x32_bf16 v[48:51], v[204:207], v[64:67], v[48:51]
    ds_read_b128 v[92:95], v14 offset:27648
    v_mfma_f32_16x16x32_bf16 v[44:47], v[204:207], v[60:63], v[44:47]
    ds_read_b128 v[96:99], v14 offset:31744
    s_barrier
    s_waitcnt lgkmcnt(4)
    v_mfma_f32_16x16x32_bf16 v[44:47], v[208:211], v[68:71], v[44:47]
    ds_read_b128 v[52:55], v14 offset:32768
    v_mfma_f32_16x16x32_bf16 v[48:51], v[208:211], v[72:75], v[48:51]
    ds_read_b128 v[56:59], v14 offset:36864
    v_mfma_f32_16x16x32_bf16 v[48:51], v[212:215], v[80:83], v[48:51]
    ds_read_b128 v[60:63], v14 offset:40960
    v_mfma_f32_16x16x32_bf16 v[44:47], v[212:215], v[76:79], v[44:47]
    ds_read_b128 v[64:67], v14 offset:45056
    s_waitcnt lgkmcnt(4)
    v_mfma_f32_16x16x32_bf16 v[44:47], v[216:219], v[84:87], v[44:47]
    ds_read_b128 v[68:71], v14 offset:33792
    v_mfma_f32_16x16x32_bf16 v[48:51], v[216:219], v[88:91], v[48:51]
    ds_read_b128 v[72:75], v14 offset:37888
    v_mfma_f32_16x16x32_bf16 v[48:51], v[220:223], v[96:99], v[48:51]
    ds_read_b128 v[76:79], v14 offset:41984
    v_mfma_f32_16x16x32_bf16 v[44:47], v[220:223], v[92:95], v[44:47]
    ds_read_b128 v[80:83], v14 offset:46080
    s_waitcnt lgkmcnt(4)
    v_mfma_f32_16x16x32_bf16 v[44:47], v[224:227], v[52:55], v[44:47]
    ds_read_b128 v[84:87], v14 offset:34816
    v_mfma_f32_16x16x32_bf16 v[48:51], v[224:227], v[56:59], v[48:51]
    ds_read_b128 v[88:91], v14 offset:38912
    v_mfma_f32_16x16x32_bf16 v[48:51], v[228:231], v[64:67], v[48:51]
    ds_read_b128 v[92:95], v14 offset:43008
    v_mfma_f32_16x16x32_bf16 v[44:47], v[228:231], v[60:63], v[44:47]
    ds_read_b128 v[96:99], v14 offset:47104
    s_waitcnt lgkmcnt(4)
    v_mfma_f32_16x16x32_bf16 v[44:47], v[232:235], v[68:71], v[44:47]
    ds_read_b128 v[52:55], v14 offset:35840
    v_mfma_f32_16x16x32_bf16 v[48:51], v[232:235], v[72:75], v[48:51]
    ds_read_b128 v[56:59], v14 offset:39936
    v_mfma_f32_16x16x32_bf16 v[48:51], v[236:239], v[80:83], v[48:51]
    ds_read_b128 v[60:63], v14 offset:44032
    v_mfma_f32_16x16x32_bf16 v[44:47], v[236:239], v[76:79], v[44:47]
    ds_read_b128 v[64:67], v14 offset:48128
    ds_write_b128 v16, v[20:23] offset:0
    ds_write_b128 v16, v[28:31] offset:4096
    ds_write_b128 v16, v[36:39] offset:8192
    s_waitcnt lgkmcnt(7)
    v_mfma_f32_16x16x32_bf16 v[44:47], v[240:243], v[84:87], v[44:47]
    v_mfma_f32_16x16x32_bf16 v[48:51], v[240:243], v[88:91], v[48:51]
    v_mfma_f32_16x16x32_bf16 v[48:51], v[244:247], v[96:99], v[48:51]
    v_mfma_f32_16x16x32_bf16 v[44:47], v[244:247], v[92:95], v[44:47]
    s_waitcnt lgkmcnt(3)
    v_mfma_f32_16x16x32_bf16 v[44:47], v[248:251], v[52:55], v[44:47]
    v_mfma_f32_16x16x32_bf16 v[48:51], v[248:251], v[56:59], v[48:51]
    v_mfma_f32_16x16x32_bf16 v[48:51], v[252:255], v[64:67], v[48:51]
    v_mfma_f32_16x16x32_bf16 v[44:47], v[252:255], v[60:63], v[44:47]
    s_setprio 0
    s_nop 6
    v_cvt_pk_bf16_f32 v44, v44, v45
    v_cvt_pk_bf16_f32 v45, v46, v47
    v_cvt_pk_bf16_f32 v46, v48, v49
    v_cvt_pk_bf16_f32 v47, v50, v51
    s_add_u32 s36, s39, 393216
    v_permlane16_swap_b32 v44, v46
    v_permlane16_swap_b32 v45, v47
    s_add_u32 s36, s39, 393216
    buffer_store_dwordx4 v[44:47], v13, s[24:27], s36 offen sc1
    ds_write_b128 v16, v[44:47] offset:12288
    s_waitcnt lgkmcnt(0)
    s_barrier
    s_cmp_ge_u32 s30, 6
    s_cbranch_scc1 WLOAD
    s_and_b32 s35, s30, 1
    s_add_u32 s12, s62, 0x480000
    s_addc_u32 s13, s63, 0
    s_mov_b32 s14, 0x7e000
    s_mov_b32 s15, 0x20000
    s_mul_i32 s38, s35, 262144
    s_lshl_b32 s41, s35, 13
    s_mov_b32 s42, 0
    s_mov_b32 s44, s29
    s_add_u32 s54, s55, 1024
    v_mov_b32 v9, s54
    v_lshl_add_u32 v9, v1, 7, v9
    s_add_u32 s44, s44, 1
    s_and_b32 s44, s44, 15
    s_add_u32 s46, s29, 1
    s_and_b32 s46, s46, 15
    s_cmp_eq_u32 s28, s29
    s_cselect_b32 s47, s46, s28
    s_mov_b32 s42, 16384
    s_and_b32 s35, s30, 1
    s_lshl_b32 s35, s35, 7
    s_add_u32 s35, s35, s55
    s_add_u32 s35, s35, 0x1600
    s_and_b32 s40, s30, 1
    s_lshl_b32 s40, s40, 13
    s_lshl_b32 s53, s29, 7
    s_add_u32 s40, s40, s53
    s_add_u32 s40, s40, 23068672
    v_lshlrev_b32 v10, 3, v1
    s_add_u32 s20, s62, 0x1c8000
    s_addc_u32 s21, s63, 0
    s_mov_b32 s22, 0x6000
    s_mov_b32 s23, 0x20000
    s_and_b32 s34, s30, 1
    s_lshl_b32 s34, s34, 9
    s_call_b64 s[76:77], PREP_a_issue_3
    s_mov_b32 m0, s19
    s_mov_b32 s39, s16
    s_and_b32 s53, s30, 3
    s_lshl_b32 s53, s53, 7
    s_add_u32 s53, s53, s55
    s_add_u32 s53, s53, 0x400
    v_mov_b32 v14, 1
    v_mov_b32 v15, 0
    s_mov_b64 exec, 1
    s_waitcnt vmcnt(0)
    buffer_atomic_add v14, v15, s[56:59], s53 offen sc1
    s_mov_b64 exec, -1
    s_call_b64 s[76:77], SUB_rest_2
    s_waitcnt lgkmcnt(0)
    s_mov_b32 s53, 0
    s_add_u32 s54, s52, 16
    s_bfm_b64 exec, 4, 0
poll_32:
    buffer_load_dword v8, v9, s[56:59], 0 offen sc1
    s_waitcnt vmcnt(0)
    v_cmp_eq_u32 vcc, s54, v8
    s_nop 0
    s_cmp_eq_u64 vcc, exec
    s_cbranch_scc1 pok_33
    s_sleep 5
    s_add_u32 s53, s53, 1
    s_cmp_lt_u32 s53, s61
    s_cbranch_scc1 poll_32
    s_mov_b32 s61, 0
pok_33:
    s_mov_b64 exec, -1
    buffer_load_dwordx4 v2, s[12:15], s39 offen sc1 lds
    buffer_load_dwordx4 v2, s[12:15], s39 offen offset:1024 sc1 lds
    s_call_b64 s[76:77], PREP_a_issue_3
    s_add_u32 m0, m0, 2048
    s_add_u32 s39, s39, 65536
    buffer_load_dwordx4 v2, s[12:15], s39 offen sc1 lds
    buffer_load_dwordx4 v2, s[12:15], s39 offen offset:1024 sc1 lds
    s_add_u32 m0, m0, 2048
    s_add_u32 s39, s39, 65536
    buffer_load_dwordx4 v2, s[12:15], s39 offen sc1 lds
    buffer_load_dwordx4 v2, s[12:15], s39 offen offset:1024 sc1 lds
    s_add_u32 m0, m0, 2048
    s_add_u32 s39, s39, 65536
    buffer_load_dwordx4 v2, s[12:15], s39 offen sc1 lds
    buffer_load_dwordx4 v2, s[12:15], s39 offen offset:1024 sc1 lds
    s_mov_b32 m0, s19
    s_mov_b32 s39, s16
    buffer_load_dwordx4 v2, s[12:15], s39 offen sc1 lds
    buffer_load_dwordx4 v2, s[12:15], s39 offen offset:1024 sc1 lds
    s_call_b64 s[76:77], PREP_a_issue_3
    s_add_u32 m0, m0, 2048
    s_add_u32 s39, s39, 65536
    buffer_load_dwordx4 v2, s[12:15], s39 offen sc1 lds
    buffer_load_dwordx4 v2, s[12:15], s39 offen offset:1024 sc1 lds
    s_add_u32 m0, m0, 2048
    s_add_u32 s39, s39, 65536
    buffer_load_dwordx4 v2, s[12:15], s39 offen sc1 lds
    buffer_load_dwordx4 v2, s[12:15], s39 offen offset:1024 sc1 lds
    s_add_u32 m0, m0, 2048
    s_add_u32 s39, s39, 65536
    buffer_load_dwordx4 v2, s[12:15], s39 offen sc1 lds
    buffer_load_dwordx4 v2, s[12:15], s39 offen offset:1024 sc1 lds
    s_mov_b32 m0, s19
    s_mov_b32 s39, s16
    s_waitcnt vmcnt(8)
    s_barrier
    buffer_load_dwordx4 v2, s[12:15], s39 offen sc1 lds
    buffer_load_dwordx4 v2, s[12:15], s39 offen offset:1024 sc1 lds
    s_call_b64 s[76:77], PREP_a_issue_3
    s_add_u32 m0, m0, 2048
    s_add_u32 s39, s39, 65536
    buffer_load_dwordx4 v2, s[12:15], s39 offen sc1 lds
    buffer_load_dwordx4 v2, s[12:15], s39 offen offset:1024 sc1 lds
    s_add_u32 m0, m0, 2048
    s_add_u32 s39, s39, 65536
    buffer_load_dwordx4 v2, s[12:15], s39 offen sc1 lds
    buffer_load_dwordx4 v2, s[12:15], s39 offen offset:1024 sc1 lds
    s_add_u32 m0, m0, 2048
    s_add_u32 s39, s39, 65536
    buffer_load_dwordx4 v2, s[12:15], s39 offen sc1 lds
    buffer_load_dwordx4 v2, s[12:15], s39 offen offset:1024 sc1 lds
    s_mov_b32 m0, s19
    s_mov_b32 s39, s16
    s_add_u32 s36, s34, 155648
    v_add_u32 v51, s36, v10
    ds_read_b64 v[18:19], v51 offset:0
    ds_read_b64 v[20:21], v51 offset:1024
    ds_read_b64 v[22:23], v51 offset:2048
    ds_read_b64 v[24:25], v51 offset:3072
    s_lshr_b32 s53, s29, 3
    s_lshl_b32 s53, s53, 14
    s_and_b32 s36, s29, 7
    s_lshl_b32 s36, s36, 10
    s_add_u32 s36, s36, s53
    s_add_u32 s36, s36, s34
    s_waitcnt lgkmcnt(0)
    v_pk_add_f32 v[18:19], v[18:19], v[20:21]
    v_pk_add_f32 v[18:19], v[18:19], v[22:23]
    v_pk_add_f32 v[18:19], v[18:19], v[24:25]
    buffer_store_dwordx2 v[18:19], v10, s[20:23], s36 offen sc1
    s_waitcnt vmcnt(9)
    s_barrier
    buffer_load_dwordx4 v2, s[12:15], s39 offen sc1 lds
    buffer_load_dwordx4 v2, s[12:15], s39 offen offset:1024 sc1 lds
    s_call_b64 s[76:77], PREP_a_issue_3
    s_add_u32 m0, m0, 2048
    s_add_u32 s39, s39, 65536
    buffer_load_dwordx4 v2, s[12:15], s39 offen sc1 lds
    buffer_load_dwordx4 v2, s[12:15], s39 offen offset:1024 sc1 lds
    s_add_u32 m0, m0, 2048
    s_add_u32 s39, s39, 65536
    buffer_load_dwordx4 v2, s[12:15], s39 offen sc1 lds
    buffer_load_dwordx4 v2, s[12:15], s39 offen offset:1024 sc1 lds
    s_add_u32 m0, m0, 2048
    s_add_u32 s39, s39, 65536
    buffer_load_dwordx4 v2, s[12:15], s39 offen sc1 lds
    buffer_load_dwordx4 v2, s[12:15], s39 offen offset:1024 sc1 lds
    s_mov_b32 m0, s19
    s_mov_b32 s39, s16
    s_waitcnt vmcnt(9)
    s_barrier
    buffer_load_dwordx4 v2, s[12:15], s39 offen sc1 lds
    buffer_load_dwordx4 v2, s[12:15], s39 offen offset:1024 sc1 lds
    s_call_b64 s[76:77], PREP_a_issue_3
    s_add_u32 m0, m0, 2048
    s_add_u32 s39, s39, 65536
    buffer_load_dwordx4 v2, s[12:15], s39 offen sc1 lds
    buffer_load_dwordx4 v2, s[12:15], s39 offen offset:1024 sc1 lds
    s_add_u32 m0, m0, 2048
    s_add_u32 s39, s39, 65536
    buffer_load_dwordx4 v2, s[12:15], s39 offen sc1 lds
    buffer_load_dwordx4 v2, s[12:15], s39 offen offset:1024 sc1 lds
    s_add_u32 m0, m0, 2048
    s_add_u32 s39, s39, 65536
    buffer_load_dwordx4 v2, s[12:15], s39 offen sc1 lds
    buffer_load_dwordx4 v2, s[12:15], s39 offen offset:1024 sc1 lds
    s_mov_b32 m0, s19
    s_mov_b32 s39, s16
    s_waitcnt vmcnt(16)
    s_and_b32 s53, s30, 1
    s_lshl_b32 s53, s53, 7
    s_add_u32 s53, s53, s55
    s_add_u32 s53, s53, 0x1600
    v_mov_b32 v14, 1
    v_mov_b32 v15, 0
    s_mov_b64 exec, 1
    buffer_atomic_add v14, v15, s[56:59], s53 offen sc1
    s_mov_b64 exec, -1
    s_waitcnt vmcnt(9)
    s_barrier
    buffer_load_dwordx4 v2, s[12:15], s39 offen sc1 lds
    buffer_load_dwordx4 v2, s[12:15], s39 offen offset:1024 sc1 lds
    s_call_b64 s[76:77], PREP_a_issue_3
    s_add_u32 m0, m0, 2048
    s_add_u32 s39, s39, 65536
    buffer_load_dwordx4 v2, s[12:15], s39 offen sc1 lds
    buffer_load_dwordx4 v2, s[12:15], s39 offen offset:1024 sc1 lds
    s_add_u32 m0, m0, 2048
    s_add_u32 s39, s39, 65536
    buffer_load_dwordx4 v2, s[12:15], s39 offen sc1 lds
    buffer_load_dwordx4 v2, s[12:15], s39 offen offset:1024 sc1 lds
    s_add_u32 m0, m0, 2048
    s_add_u32 s39, s39, 65536
    buffer_load_dwordx4 v2, s[12:15], s39 offen sc1 lds
    buffer_load_dwordx4 v2, s[12:15], s39 offen offset:1024 sc1 lds
    s_mov_b32 m0, s19
    s_mov_b32 s39, s16
    s_waitcnt vmcnt(9)
    s_barrier
    buffer_load_dwordx4 v2, s[12:15], s39 offen sc1 lds
    buffer_load_dwordx4 v2, s[12:15], s39 offen offset:1024 sc1 lds
    s_call_b64 s[76:77], PREP_a_issue_3
    s_add_u32 m0, m0, 2048
    s_add_u32 s39, s39, 65536
    buffer_load_dwordx4 v2, s[12:15], s39 offen sc1 lds
    buffer_load_dwordx4 v2, s[12:15], s39 offen offset:1024 sc1 lds
    s_add_u32 m0, m0, 2048
    s_add_u32 s39, s39, 65536
    buffer_load_dwordx4 v2, s[12:15], s39 offen sc1 lds
    buffer_load_dwordx4 v2, s[12:15], s39 offen offset:1024 sc1 lds
    s_add_u32 m0, m0, 2048
    s_add_u32 s39, s39, 65536
    buffer_load_dwordx4 v2, s[12:15], s39 offen sc1 lds
    buffer_load_dwordx4 v2, s[12:15], s39 offen offset:1024 sc1 lds
    s_mov_b32 m0, s19
    s_mov_b32 s39, s16
    s_waitcnt vmcnt(8)
    s_barrier
    buffer_load_dwordx4 v2, s[12:15], s39 offen sc1 lds
    buffer_load_dwordx4 v2, s[12:15], s39 offen offset:1024 sc1 lds
    s_call_b64 s[76:77], PREP_a_issue_3
    s_add_u32 m0, m0, 2048
    s_add_u32 s39, s39, 65536
    buffer_load_dwordx4 v2, s[12:15], s39 offen sc1 lds
    buffer_load_dwordx4 v2, s[12:15], s39 offen offset:1024 sc1 lds
    s_add_u32 m0, m0, 2048
    s_add_u32 s39, s39, 65536
    buffer_load_dwordx4 v2, s[12:15], s39 offen sc1 lds
    buffer_load_dwordx4 v2, s[12:15], s39 offen offset:1024 sc1 lds
    s_add_u32 m0, m0, 2048
    s_add_u32 s39, s39, 65536
    buffer_load_dwordx4 v2, s[12:15], s39 offen sc1 lds
    buffer_load_dwordx4 v2, s[12:15], s39 offen offset:1024 sc1 lds
    s_mov_b32 m0, s19
    s_mov_b32 s39, s16
    s_waitcnt vmcnt(8)
    s_barrier
    buffer_load_dwordx4 v2, s[12:15], s39 offen sc1 lds
    buffer_load_dwordx4 v2, s[12:15], s39 offen offset:1024 sc1 lds
    s_call_b64 s[76:77], PREP_a_issue_3
    s_add_u32 m0, m0, 2048
    s_add_u32 s39, s39, 65536
    buffer_load_dwordx4 v2, s[12:15], s39 offen sc1 lds
    buffer_load_dwordx4 v2, s[12:15], s39 offen offset:1024 sc1 lds
    s_add_u32 m0, m0, 2048
    s_add_u32 s39, s39, 65536
    buffer_load_dwordx4 v2, s[12:15], s39 offen sc1 lds
    buffer_load_dwordx4 v2, s[12:15], s39 offen offset:1024 sc1 lds
    s_add_u32 m0, m0, 2048
    s_add_u32 s39, s39, 65536
    buffer_load_dwordx4 v2, s[12:15], s39 offen sc1 lds
    buffer_load_dwordx4 v2, s[12:15], s39 offen offset:1024 sc1 lds
    s_mov_b32 m0, s19
    s_mov_b32 s39, s16
    s_load_dword s32, s[4:5], s35
    s_load_dword s3, s[4:5], s40
    s_waitcnt vmcnt(8)
    s_barrier
    buffer_load_dwordx4 v2, s[12:15], s39 offen sc1 lds
    buffer_load_dwordx4 v2, s[12:15], s39 offen offset:1024 sc1 lds
    s_call_b64 s[76:77], PREP_a_issue_3
    s_add_u32 m0, m0, 2048
    s_add_u32 s39, s39, 65536
    buffer_load_dwordx4 v2, s[12:15], s39 offen sc1 lds
    buffer_load_dwordx4 v2, s[12:15], s39 offen offset:1024 sc1 lds
    s_add_u32 m0, m0, 2048
    s_add_u32 s39, s39, 65536
    buffer_load_dwordx4 v2, s[12:15], s39 offen sc1 lds
    buffer_load_dwordx4 v2, s[12:15], s39 offen offset:1024 sc1 lds
    s_add_u32 m0, m0, 2048
    s_add_u32 s39, s39, 65536
    buffer_load_dwordx4 v2, s[12:15], s39 offen sc1 lds
    buffer_load_dwordx4 v2, s[12:15], s39 offen offset:1024 sc1 lds
    s_mov_b32 m0, s19
    s_mov_b32 s39, s16
    s_add_u32 s54, s52, 16
    s_waitcnt lgkmcnt(0)
    s_cmp_eq_u32 s32, s54
    s_cbranch_scc1 fok_34
    v_mov_b32 v15, s35
    s_mov_b32 s53, 0
    s_add_u32 s54, s52, 16
    s_bfm_b64 exec, 1, 0
poll_35:
    buffer_load_dword v14, v15, s[56:59], 0 offen sc1
    s_waitcnt vmcnt(0)
    v_cmp_eq_u32 vcc, s54, v14
    s_nop 0
    s_cmp_eq_u64 vcc, exec
    s_cbranch_scc1 pok_36
    s_sleep 5
    s_add_u32 s53, s53, 1
    s_cmp_lt_u32 s53, s61
    s_cbranch_scc1 poll_35
    s_mov_b32 s61, 0
pok_36:
    s_mov_b64 exec, -1
fok_34:
    s_add_u32 s36, s34, 0
    buffer_load_dwordx2 v[18:19], v10, s[20:23], s36 offen offset:0 sc1
    buffer_load_dwordx2 v[20:21], v10, s[20:23], s36 offen offset:1024 sc1
    buffer_load_dwordx2 v[22:23], v10, s[20:23], s36 offen offset:2048 sc1
    buffer_load_dwordx2 v[24:25], v10, s[20:23], s36 offen offset:3072 sc1
    s_add_u32 s36, s36, 4096
    buffer_load_dwordx2 v[26:27], v10, s[20:23], s36 offen offset:0 sc1
    buffer_load_dwordx2 v[28:29], v10, s[20:23], s36 offen offset:1024 sc1
    buffer_load_dwordx2 v[30:31], v10, s[20:23], s36 offen offset:2048 sc1
    buffer_load_dwordx2 v[32:33], v10, s[20:23], s36 offen offset:3072 sc1
    s_waitcnt vmcnt(16)
    s_barrier
    buffer_load_dwordx4 v2, s[12:15], s39 offen sc1 lds
    buffer_load_dwordx4 v2, s[12:15], s39 offen offset:1024 sc1 lds
    s_call_b64 s[76:77], PREP_a_issue_3
    s_add_u32 m0, m0, 2048
    s_add_u32 s39, s39, 65536
    buffer_load_dwordx4 v2, s[12:15], s39 offen sc1 lds
    buffer_load_dwordx4 v2, s[12:15], s39 offen offset:1024 sc1 lds
    s_add_u32 m0, m0, 2048
    s_add_u32 s39, s39, 65536
    buffer_load_dwordx4 v2, s[12:15], s39 offen sc1 lds
    buffer_load_dwordx4 v2, s[12:15], s39 offen offset:1024 sc1 lds
    s_add_u32 m0, m0, 2048
    s_add_u32 s39, s39, 65536
    buffer_load_dwordx4 v2, s[12:15], s39 offen sc1 lds
    buffer_load_dwordx4 v2, s[12:15], s39 offen offset:1024 sc1 lds
    s_mov_b32 m0, s19
    s_mov_b32 s39, s16
    s_add_u32 s36, s34, 16384
    buffer_load_dwordx2 v[34:35], v10, s[20:23], s36 offen offset:0 sc1
    buffer_load_dwordx2 v[36:37], v10, s[20:23], s36 offen offset:1024 sc1
    buffer_load_dwordx2 v[38:39], v10, s[20:23], s36 offen offset:2048 sc1
    buffer_load_dwordx2 v[40:41], v10, s[20:23], s36 offen offset:3072 sc1
    s_add_u32 s36, s36, 4096
    buffer_load_dwordx2 v[42:43], v10, s[20:23], s36 offen offset:0 sc1
    buffer_load_dwordx2 v[44:45], v10, s[20:23], s36 offen offset:1024 sc1
    buffer_load_dwordx2 v[46:47], v10, s[20:23], s36 offen offset:2048 sc1
    buffer_load_dwordx2 v[48:49], v10, s[20:23], s36 offen offset:3072 sc1
    s_waitcnt vmcnt(24)
    s_barrier
    buffer_load_dwordx4 v2, s[12:15], s39 offen sc1 lds
    buffer_load_dwordx4 v2, s[12:15], s39 offen offset:1024 sc1 lds
    s_call_b64 s[76:77], PREP_a_issue_3
    s_add_u32 m0, m0, 2048
    s_add_u32 s39, s39, 65536
    buffer_load_dwordx4 v2, s[12:15], s39 offen sc1 lds
    buffer_load_dwordx4 v2, s[12:15], s39 offen offset:1024 sc1 lds
    s_add_u32 m0, m0, 2048
    s_add_u32 s39, s39, 65536
    buffer_load_dwordx4 v2, s[12:15], s39 offen sc1 lds
    buffer_load_dwordx4 v2, s[12:15], s39 offen offset:1024 sc1 lds
    s_add_u32 m0, m0, 2048
    s_add_u32 s39, s39, 65536
    buffer_load_dwordx4 v2, s[12:15], s39 offen sc1 lds
    buffer_load_dwordx4 v2, s[12:15], s39 offen offset:1024 sc1 lds
    s_mov_b32 m0, s19
    s_mov_b32 s39, s16
    s_add_u32 s54, s52, 16
    s_waitcnt lgkmcnt(0)
    s_cmp_eq_u32 s3, s54
    s_cbranch_scc1 fok_37
    v_mov_b32 v15, s40
    s_mov_b32 s53, 0
    s_add_u32 s54, s52, 16
    s_bfm_b64 exec, 1, 0
poll_38:
    buffer_load_dword v14, v15, s[56:59], 0 offen sc1
    s_waitcnt vmcnt(0)
    v_cmp_eq_u32 vcc, s54, v14
    s_nop 0
    s_cmp_eq_u64 vcc, exec
    s_cbranch_scc1 pok_39
    s_sleep 5
    s_add_u32 s53, s53, 1
    s_cmp_lt_u32 s53, s61
    s_cbranch_scc1 poll_38
    s_mov_b32 s61, 0
pok_39:
    s_mov_b64 exec, -1
fok_37:
    s_add_u32 s24, s4, 0x1420000
    s_addc_u32 s25, s5, 0
    s_mov_b32 s26, 0x38000
    s_mov_b32 s27, 0x20000
    s_cmp_eq_u32 s60, 0
    s_cselect_b32 s26, s26, 0
    s_and_b32 s36, s30, 1
    s_mul_i32 s36, s36, 448
    s_mul_i32 s37, s29, 896
    s_add_u32 s37, s36, s37
    v_lshrrev_b32 v13, 5, v1
    v_mul_u32_u24 v13, 14336, v13
    v_and_b32 v6, 496, v2
    v_add_u32 v13, v13, v6
    buffer_load_dwordx4 v[54:57], v13, s[24:27], s37 offen sc1
    s_add_u32 s37, s37, 28672
    buffer_load_dwordx4 v[58:61], v13, s[24:27], s37 offen sc1
    s_add_u32 s37, s37, 28672
    buffer_load_dwordx4 v[62:65], v13, s[24:27], s37 offen sc1
    s_add_u32 s37, s37, 28672
    buffer_load_dwordx4 v[66:69], v13, s[24:27], s37 offen sc1
    s_add_u32 s37, s37, 28672
    buffer_load_dwordx4 v[70:73], v13, s[24:27], s37 offen sc1
    s_add_u32 s37, s37, 28672
    buffer_load_dwordx4 v[74:77], v13, s[24:27], s37 offen sc1
    s_add_u32 s37, s37, 28672
    buffer_load_dwordx4 v[78:81], v13, s[24:27], s37 offen sc1
    s_add_u32 s37, s37, 28672
    buffer_load_dwordx4 v[82:85], v13, s[24:27], s37 offen sc1
    s_add_u32 s37, s37, 28672
    s_waitcnt vmcnt(24)
    s_barrier
    buffer_load_dwordx4 v2, s[12:15], s39 offen sc1 lds
    buffer_load_dwordx4 v2, s[12:15], s39 offen offset:1024 sc1 lds
    s_call_b64 s[76:77], PREP_a_issue_3
    s_add_u32 m0, m0, 2048
    s_add_u32 s39, s39, 65536
    buffer_load_dwordx4 v2, s[12:15], s39 offen sc1 lds
    buffer_load_dwordx4 v2, s[12:15], s39 offen offset:1024 sc1 lds
    s_add_u32 m0, m0, 2048
    s_add_u32 s39, s39, 65536
    buffer_load_dwordx4 v2, s[12:15], s39 offen sc1 lds
    buffer_load_dwordx4 v2, s[12:15], s39 offen offset:1024 sc1 lds
    s_add_u32 m0, m0, 2048
    s_add_u32 s39, s39, 65536
    buffer_load_dwordx4 v2, s[12:15], s39 offen sc1 lds
    buffer_load_dwordx4 v2, s[12:15], s39 offen offset:1024 sc1 lds
    s_mov_b32 m0, s19
    s_mov_b32 s39, s16
    s_waitcnt vmcnt(24)
    v_pk_add_f32 v[18:19], v[18:19], v[34:35]
    v_pk_add_f32 v[20:21], v[20:21], v[36:37]
    v_pk_add_f32 v[22:23], v[22:23], v[38:39]
    v_pk_add_f32 v[24:25], v[24:25], v[40:41]
    v_pk_add_f32 v[26:27], v[26:27], v[42:43]
    v_pk_add_f32 v[28:29], v[28:29], v[44:45]
    v_pk_add_f32 v[30:31], v[30:31], v[46:47]
    v_pk_add_f32 v[32:33], v[32:33], v[48:49]
    v_pk_add_f32 v[18:19], v[18:19], v[26:27]
    v_pk_add_f32 v[20:21], v[20:21], v[28:29]
    v_pk_add_f32 v[22:23], v[22:23], v[30:31]
    v_pk_add_f32 v[24:25], v[24:25], v[32:33]
    v_pk_add_f32 v[18:19], v[18:19], v[22:23]
    v_pk_add_f32 v[20:21], v[20:21], v[24:25]
    s_waitcnt vmcnt(16)
    s_barrier
    buffer_load_dwordx4 v2, s[12:15], s39 offen sc1 lds
    buffer_load_dwordx4 v2, s[12:15], s39 offen offset:1024 sc1 lds
    s_call_b64 s[76:77], PREP_a_issue_3
    s_add_u32 m0, m0, 2048
    s_add_u32 s39, s39, 65536
    buffer_load_dwordx4 v2, s[12:15], s39 offen sc1 lds
    buffer_load_dwordx4 v2, s[12:15], s39 offen offset:1024 sc1 lds
    s_add_u32 m0, m0, 2048
    s_add_u32 s39, s39, 65536
    buffer_load_dwordx4 v2, s[12:15], s39 offen sc1 lds
    buffer_load_dwordx4 v2, s[12:15], s39 offen offset:1024 sc1 lds
    s_add_u32 m0, m0, 2048
    s_add_u32 s39, s39, 65536
    buffer_load_dwordx4 v2, s[12:15], s39 offen sc1 lds
    buffer_load_dwordx4 v2, s[12:15], s39 offen offset:1024 sc1 lds
    s_mov_b32 m0, s19
    s_mov_b32 s39, s16
    v_pk_add_f32 v[18:19], v[18:19], v[20:21]
    v_mul_f32 v52, 0x3a800000, v18
    v_mul_f32 v50, 0x3a800000, v19
    v_fma_f32 v50, -v52, v52, v50
    v_max_f32 v50, 0, v50
    v_cvt_pk_bf16_f32 v52, v52, v52
    v_lshlrev_b32 v52, 16, v52
    v_cvt_pk_bf16_f32 v50, v50, v50
    v_lshlrev_b32 v50, 16, v50
    v_add_f32 v50, 0x3727c5ac, v50
    v_cvt_pk_bf16_f32 v50, v50, v50
    v_lshlrev_b32 v50, 16, v50
    v_sqrt_f32 v50, v50
    s_nop 0
    v_cvt_pk_bf16_f32 v50, v50, v50
    s_waitcnt vmcnt(8)
    s_barrier
    buffer_load_dwordx4 v2, s[12:15], s39 offen sc1 lds
    buffer_load_dwordx4 v2, s[12:15], s39 offen offset:1024 sc1 lds
    s_add_u32 m0, m0, 2048
    s_add_u32 s39, s39, 65536
    buffer_load_dwordx4 v2, s[12:15], s39 offen sc1 lds
    buffer_load_dwordx4 v2, s[12:15], s39 offen offset:1024 sc1 lds
    s_add_u32 m0, m0, 2048
    s_add_u32 s39, s39, 65536
    buffer_load_dwordx4 v2, s[12:15], s39 offen sc1 lds
    buffer_load_dwordx4 v2, s[12:15], s39 offen offset:1024 sc1 lds
    s_add_u32 m0, m0, 2048
    s_add_u32 s39, s39, 65536
    buffer_load_dwordx4 v2, s[12:15], s39 offen sc1 lds
    buffer_load_dwordx4 v2, s[12:15], s39 offen offset:1024 sc1 lds
    s_waitcnt vmcnt(24)
    v_lshlrev_b32 v50, 16, v50
    v_rcp_f32 v53, v50
    v_mov_b32 v18, v52
    v_mov_b32 v19, v50
    v_mul_f32 v20, 0xc0135761, v53
    v_mul_f32 v53, v53, v53
    v_mul_f32 v53, 0x3d372713, v53
    v_mul_f32 v21, v53, v20
    s_lshl1_add_u32 s36, s34, 160768
    v_add_u32 v51, s36, v2
    ds_write_b128 v51, v[18:21]
    s_cmp_lg_u32 s60, 0
    s_cbranch_scc1 pc_43
    v_pk_add_f32 v[54:55], v[54:55], v[58:59]
    v_pk_add_f32 v[56:57], v[56:57], v[60:61]
    v_pk_add_f32 v[54:55], v[54:55], v[62:63]
    v_pk_add_f32 v[56:57], v[56:57], v[64:65]
    v_pk_add_f32 v[54:55], v[54:55], v[66:67]
    v_pk_add_f32 v[56:57], v[56:57], v[68:69]
    v_pk_add_f32 v[54:55], v[54:55], v[70:71]
    v_pk_add_f32 v[56:57], v[56:57], v[72:73]
pc_43:
    s_waitcnt vmcnt(8)
    s_barrier
    s_cmp_lg_u32 s60, 0
    s_cbranch_scc1 pc_44
    v_pk_add_f32 v[54:55], v[54:55], v[74:75]
    v_pk_add_f32 v[56:57], v[56:57], v[76:77]
    v_pk_add_f32 v[54:55], v[54:55], v[78:79]
    v_pk_add_f32 v[56:57], v[56:57], v[80:81]
    v_pk_add_f32 v[54:55], v[54:55], v[82:83]
    v_pk_add_f32 v[56:57], v[56:57], v[84:85]
    v_mov_b32 v58, v54
    v_mov_b32 v59, v55
    v_mov_b32 v60, v56
    v_mov_b32 v61, v57
    v_permlane32_swap_b32 v54, v58
    v_permlane32_swap_b32 v55, v59
    v_permlane32_swap_b32 v56, v60
    v_permlane32_swap_b32 v57, v61
    v_pk_add_f32 v[54:55], v[54:55], v[58:59]
    v_pk_add_f32 v[56:57], v[56:57], v[60:61]
    s_and_b32 s36, s30, 1
    s_mul_i32 s36, s36, 448
    s_add_u32 s36, s36, 159744
    v_add_u32 v6, s36, v2
    s_bfm_b64 exec, 28, 0
    ds_write_b128 v6, v[54:57]
    s_mov_b64 exec, -1
    s_waitcnt lgkmcnt(0)
pc_44:
    s_waitcnt lgkmcnt(0)
    s_waitcnt vmcnt(0)
    s_barrier
    s_cmp_lg_u32 s60, 0
    s_cbranch_scc1 tw4_46
    s_mov_b64 s[48:49], s[74:75]
    s_lshl_b32 s45, s2, 1
    s_and_b32 s50, s30, 1
    s_add_u32 s45, s45, s50
    s_mul_i32 s45, s45, 14336
    s_mov_b32 s50, 7340032
    s_mov_b32 s51, 0x20000
    buffer_load_dwordx4 v[60:63], v2, s[48:51], s45 offen offset:0
    buffer_load_dwordx4 v[60:63], v2, s[48:51], s45 offen offset:1024
    buffer_load_dwordx4 v[60:63], v2, s[48:51], s45 offen offset:2048
    buffer_load_dwordx4 v[60:63], v2, s[48:51], s45 offen offset:3072
    s_add_u32 s45, s45, 4096
    buffer_load_dwordx4 v[60:63], v2, s[48:51], s45 offen offset:0
    buffer_load_dwordx4 v[60:63], v2, s[48:51], s45 offen offset:1024
    buffer_load_dwordx4 v[60:63], v2, s[48:51], s45 offen offset:2048
    buffer_load_dwordx4 v[60:63], v2, s[48:51], s45 offen offset:3072
    s_add_u32 s45, s45, 4096
    buffer_load_dwordx4 v[60:63], v2, s[48:51], s45 offen offset:0
    buffer_load_dwordx4 v[60:63], v2, s[48:51], s45 offen offset:1024
    buffer_load_dwordx4 v[60:63], v2, s[48:51], s45 offen offset:2048
    buffer_load_dwordx4 v[60:63], v2, s[48:51], s45 offen offset:3072
    s_add_u32 s45, s45, 4096
    buffer_load_dwordx4 v[60:63], v2, s[48:51], s45 offen offset:0
    buffer_load_dwordx4 v[60:63], v2, s[48:51], s45 offen offset:1024
tw4_46:
    s_barrier
    s_and_b32 s35, s30, 1
    s_mov_b32 s12, s62
    s_mov_b32 s13, s63
    s_mov_b32 s14, 0x1be000
    s_mov_b32 s15, 0x20000
    s_mul_i32 s38, s35, 917504
    s_mul_i32 s36, s31, 573440
    s_add_u32 s38, s38, s36
    s_mul_i32 s37, s31, 917504
    s_sub_u32 s37, 229376, s37
    s_lshl_b32 s41, s35, 13
    s_mov_b32 s42, 0
    s_mov_b32 s44, 0
    s_and_b32 s34, s30, 1
    s_lshl1_add_u32 s34, s31, s34
    s_lshl_b32 s34, s34, 7
    s_add_u32 s34, s34, s55
    s_add_u32 s34, s34, 0x1200
    s_and_b32 s35, s30, 1
    s_lshl1_add_u32 s35, s31, s35
    s_lshl_b32 s35, s35, 7
    s_add_u32 s35, s35, s55
    s_add_u32 s35, s35, 0x1400
    s_sub_u32 s48, s34, 512
    s_mov_b32 s44, 3
    s_add_u32 s36, s33, 4
    s_and_b32 s36, s36, 7
    s_mul_i32 s36, s36, 7
    s_add_u32 s36, s36, 2
    s_lshr_b32 s53, s36, 3
    s_lshl_b32 s53, s53, 14
    s_and_b32 s78, s36, 7
    s_lshl_b32 s78, s78, 10
    s_add_u32 s78, s78, s53
    s_add_u32 s36, s33, 4
    s_and_b32 s36, s36, 7
    s_mul_i32 s36, s36, 7
    s_add_u32 s36, s36, 6
    s_lshr_b32 s53, s36, 3
    s_lshl_b32 s53, s53, 14
    s_and_b32 s79, s36, 7
    s_lshl_b32 s79, s79, 10
    s_add_u32 s79, s79, s53
    s_add_u32 s36, s33, 4
    s_and_b32 s36, s36, 7
    s_mul_i32 s36, s36, 7
    s_add_u32 s36, s36, 3
    s_lshr_b32 s53, s36, 3
    s_lshl_b32 s53, s53, 14
    s_and_b32 s80, s36, 7
    s_lshl_b32 s80, s80, 10
    s_add_u32 s80, s80, s53
    s_add_u32 s36, s33, 5
    s_and_b32 s36, s36, 7
    s_mul_i32 s36, s36, 7
    s_add_u32 s36, s36, 2
    s_lshr_b32 s53, s36, 3
    s_lshl_b32 s53, s53, 14
    s_and_b32 s81, s36, 7
    s_lshl_b32 s81, s81, 10
    s_add_u32 s81, s81, s53
    s_add_u32 s36, s33, 5
    s_and_b32 s36, s36, 7
    s_mul_i32 s36, s36, 7
    s_add_u32 s36, s36, 6
    s_lshr_b32 s53, s36, 3
    s_lshl_b32 s53, s53, 14
    s_and_b32 s82, s36, 7
    s_lshl_b32 s82, s82, 10
    s_add_u32 s82, s82, s53
    s_add_u32 s36, s33, 5
    s_and_b32 s36, s36, 7
    s_mul_i32 s36, s36, 7
    s_add_u32 s36, s36, 3
    s_lshr_b32 s53, s36, 3
    s_lshl_b32 s53, s53, 14
    s_and_b32 s83, s36, 7
    s_lshl_b32 s83, s83, 10
    s_add_u32 s83, s83, s53
    s_add_u32 s36, s33, 6
    s_and_b32 s36, s36, 7
    s_mul_i32 s36, s36, 7
    s_add_u32 s36, s36, 2
    s_lshr_b32 s53, s36, 3
    s_lshl_b32 s53, s53, 14
    s_and_b32 s84, s36, 7
    s_lshl_b32 s84, s84, 10
    s_add_u32 s84, s84, s53
    s_add_u32 s36, s33, 6
    s_and_b32 s36, s36, 7
    s_mul_i32 s36, s36, 7
    s_add_u32 s36, s36, 6
    s_lshr_b32 s53, s36, 3
    s_lshl_b32 s53, s53, 14
    s_and_b32 s85, s36, 7
    s_lshl_b32 s85, s85, 10
    s_add_u32 s85, s85, s53
    s_add_u32 s36, s33, 6
    s_and_b32 s36, s36, 7
    s_mul_i32 s36, s36, 7
    s_add_u32 s36, s36, 3
    s_lshr_b32 s53, s36, 3
    s_lshl_b32 s53, s53, 14
    s_and_b32 s86, s36, 7
    s_lshl_b32 s86, s86, 10
    s_add_u32 s86, s86, s53
    s_add_u32 s36, s33, 7
    s_and_b32 s36, s36, 7
    s_mul_i32 s36, s36, 7
    s_add_u32 s36, s36, 2
    s_lshr_b32 s53, s36, 3
    s_lshl_b32 s53, s53, 14
    s_and_b32 s87, s36, 7
    s_lshl_b32 s87, s87, 10
    s_add_u32 s87, s87, s53
    s_add_u32 s36, s33, 7
    s_and_b32 s36, s36, 7
    s_mul_i32 s36, s36, 7
    s_add_u32 s36, s36, 6
    s_lshr_b32 s53, s36, 3
    s_lshl_b32 s53, s53, 14
    s_and_b32 s88, s36, 7
    s_lshl_b32 s88, s88, 10
    s_add_u32 s88, s88, s53
    s_add_u32 s36, s33, 7
    s_and_b32 s36, s36, 7
    s_mul_i32 s36, s36, 7
    s_add_u32 s36, s36, 3
    s_lshr_b32 s53, s36, 3
    s_lshl_b32 s53, s53, 14
    s_and_b32 s89, s36, 7
    s_lshl_b32 s89, s89, 10
    s_add_u32 s89, s89, s53
    s_mov_b64 s[8:9], s[68:69]
    s_mov_b32 s10, 2097152
    s_mov_b32 s11, 0x20000
    s_and_b32 s3, s30, 3
    s_lshl_b32 s36, s3, 14
    s_lshl_b32 s90, s29, 7
    s_add_u32 s90, s90, s36
    s_xor_b32 s90, s90, 128
    s_lshl_b32 s3, s3, 10
    s_call_b64 s[76:77], PREP_a_issue_4
    s_mov_b32 m0, s19
    s_mov_b32 s39, s16
    s_mov_b32 s40, s17
    s_waitcnt vmcnt(16)
    s_barrier
    s_load_dword s32, s[4:5], s48
    s_waitcnt vmcnt(8)
    s_barrier
    s_add_u32 s54, s52, 16
    s_waitcnt lgkmcnt(0)
    s_cmp_eq_u32 s32, s54
    s_cbranch_scc1 fok_47
    v_mov_b32 v9, s48
    s_mov_b32 s53, 0
    s_add_u32 s54, s52, 16
    s_bfm_b64 exec, 1, 0
poll_48:
    buffer_load_dword v8, v9, s[56:59], 0 offen sc1
    s_waitcnt vmcnt(0)
    v_cmp_eq_u32 vcc, s54, v8
    s_nop 0
    s_cmp_eq_u64 vcc, exec
    s_cbranch_scc1 pok_49
    s_sleep 5
    s_add_u32 s53, s53, 1
    s_cmp_lt_u32 s53, s61
    s_cbranch_scc1 poll_48
    s_mov_b32 s61, 0
pok_49:
    s_mov_b64 exec, -1
fok_47:
    buffer_load_dwordx4 v2, s[12:15], s39 offen sc1 lds
    s_add_u32 m0, m0, 1024
    s_nop 0
    buffer_load_dwordx4 v2, s[12:15], s40 offen sc1 lds
    s_call_b64 s[76:77], PREP_a_issue_4
    s_add_u32 m0, m0, 1024
    s_add_u32 s39, s39, 229376
    buffer_load_dwordx4 v2, s[12:15], s39 offen sc1 lds
    s_add_u32 m0, m0, 1024
    s_add_u32 s40, s40, 229376
    buffer_load_dwordx4 v2, s[12:15], s40 offen sc1 lds
    s_add_u32 m0, m0, 1024
    s_add_u32 s39, s39, s37
    buffer_load_dwordx4 v2, s[12:15], s39 offen sc1 lds
    s_add_u32 m0, m0, 1024
    s_add_u32 s40, s40, s37
    buffer_load_dwordx4 v2, s[12:15], s40 offen sc1 lds
    s_add_u32 m0, m0, 1024
    s_add_u32 s39, s39, 229376
    buffer_load_dwordx4 v2, s[12:15], s39 offen sc1 lds
    s_add_u32 m0, m0, 1024
    s_add_u32 s40, s40, 229376
    buffer_load_dwordx4 v2, s[12:15], s40 offen sc1 lds
    s_mov_b32 m0, s19
    s_mov_b32 s39, s16
    s_mov_b32 s40, s17
    s_waitcnt vmcnt(8)
    s_barrier
    buffer_load_dwordx4 v2, s[12:15], s39 offen sc1 lds
    s_add_u32 m0, m0, 1024
    s_nop 0
    buffer_load_dwordx4 v2, s[12:15], s40 offen sc1 lds
    s_mov_b32 s43, 1
ld_50:
    s_add_u32 s19, s41, s42
    s_lshl_b32 s45, s44, 1
    s_add_u32 s45, s45, 0
    s_sub_u32 s45, s45, 32
    s_mul_i32 s46, s45, 86
    s_lshr_b32 s46, s46, 8
    s_mul_i32 s47, s46, 3
    s_sub_u32 s47, s45, s47
    s_lshl_b32 s47, s47, 2
    s_lshr_b32 s47, 0x362, s47
    s_and_b32 s47, s47, 7
    s_cmp_ge_u32 s44, 10
    s_cselect_b32 s45, 9, 2
    s_cselect_b32 s51, 1, 0
    s_sub_u32 s45, s44, s45
    s_cmp_lt_u32 s44, 3
    s_cselect_b32 s45, 0, s45
    s_cselect_b32 s51, s44, s51
    s_lshl2_add_u32 s51, 0, s51
    s_cmp_lt_u32 s44, 17
    s_cselect_b32 s47, s51, s47
    s_cselect_b32 s46, s45, s46
    s_add_u32 s46, s46, s33
    s_and_b32 s46, s46, 7
    s_mul_i32 s46, s46, 7
    s_add_u32 s16, s46, s47
    s_lshr_b32 s53, s16, 3
    s_lshl_b32 s53, s53, 14
    s_and_b32 s16, s16, 7
    s_lshl_b32 s16, s16, 10
    s_add_u32 s16, s16, s53
    s_add_u32 s16, s16, s38
    s_lshl_b32 s45, s44, 1
    s_add_u32 s45, s45, 1
    s_sub_u32 s45, s45, 32
    s_mul_i32 s46, s45, 86
    s_lshr_b32 s46, s46, 8
    s_mul_i32 s47, s46, 3
    s_sub_u32 s47, s45, s47
    s_lshl_b32 s47, s47, 2
    s_lshr_b32 s47, 0x362, s47
    s_and_b32 s47, s47, 7
    s_cmp_ge_u32 s44, 10
    s_cselect_b32 s45, 9, 2
    s_cselect_b32 s51, 1, 0
    s_sub_u32 s45, s44, s45
    s_cmp_lt_u32 s44, 3
    s_cselect_b32 s45, 0, s45
    s_cselect_b32 s51, s44, s51
    s_lshl2_add_u32 s51, 1, s51
    s_cmp_lt_u32 s44, 17
    s_cselect_b32 s47, s51, s47
    s_cselect_b32 s46, s45, s46
    s_add_u32 s46, s46, s33
    s_and_b32 s46, s46, 7
    s_mul_i32 s46, s46, 7
    s_add_u32 s17, s46, s47
    s_lshr_b32 s53, s17, 3
    s_lshl_b32 s53, s53, 14
    s_and_b32 s17, s17, 7
    s_lshl_b32 s17, s17, 10
    s_add_u32 s17, s17, s53
    s_add_u32 s17, s17, s38
    s_add_u32 s44, s44, 1
    s_add_u32 s42, s42, 16384
    s_cmp_eq_u32 s42, 49152
    s_cselect_b32 s42, 0, s42
    s_add_u32 m0, m0, 1024
    s_add_u32 s39, s39, 229376
    buffer_load_dwordx4 v2, s[12:15], s39 offen sc1 lds
    s_add_u32 m0, m0, 1024
    s_add_u32 s40, s40, 229376
    buffer_load_dwordx4 v2, s[12:15], s40 offen sc1 lds
    s_add_u32 m0, m0, 1024
    s_add_u32 s39, s39, s37
    buffer_load_dwordx4 v2, s[12:15], s39 offen sc1 lds
    s_add_u32 m0, m0, 1024
    s_add_u32 s40, s40, s37
    buffer_load_dwordx4 v2, s[12:15], s40 offen sc1 lds
    s_add_u32 m0, m0, 1024
    s_add_u32 s39, s39, 229376
    buffer_load_dwordx4 v2, s[12:15], s39 offen sc1 lds
    s_add_u32 m0, m0, 1024
    s_add_u32 s40, s40, 229376
    buffer_load_dwordx4 v2, s[12:15], s40 offen sc1 lds
    s_mov_b32 m0, s19
    s_mov_b32 s39, s16
    s_mov_b32 s40, s17
    s_waitcnt vmcnt(8)
    s_barrier
    buffer_load_dwordx4 v2, s[12:15], s39 offen sc1 lds
    s_add_u32 m0, m0, 1024
    s_nop 0
    buffer_load_dwordx4 v2, s[12:15], s40 offen sc1 lds
    s_add_u32 s43, s43, 1
    s_cmp_lt_u32 s43, 4
    s_cbranch_scc1 ld_50
    s_call_b64 s[76:77], PREP_a_issue_4
    s_add_u32 m0, m0, 1024
    s_add_u32 s39, s39, 229376
    buffer_load_dwordx4 v2, s[12:15], s39 offen sc1 lds
    s_add_u32 m0, m0, 1024
    s_add_u32 s40, s40, 229376
    buffer_load_dwordx4 v2, s[12:15], s40 offen sc1 lds
    s_add_u32 m0, m0, 1024
    s_add_u32 s39, s39, s37
    buffer_load_dwordx4 v2, s[12:15], s39 offen sc1 lds
    s_add_u32 m0, m0, 1024
    s_add_u32 s40, s40, s37
    buffer_load_dwordx4 v2, s[12:15], s40 offen sc1 lds
    s_add_u32 m0, m0, 1024
    s_add_u32 s39, s39, 229376
    buffer_load_dwordx4 v2, s[12:15], s39 offen sc1 lds
    s_add_u32 m0, m0, 1024
    s_add_u32 s40, s40, 229376
    buffer_load_dwordx4 v2, s[12:15], s40 offen sc1 lds
    s_mov_b32 m0, s19
    s_mov_b32 s39, s16
    s_mov_b32 s40, s17
    s_waitcnt vmcnt(8)
    s_barrier
    buffer_load_dwordx4 v2, s[12:15], s39 offen sc1 lds
    s_add_u32 m0, m0, 1024
    s_nop 0
    buffer_load_dwordx4 v2, s[12:15], s40 offen sc1 lds
    s_load_dword s32, s[4:5], s34
    s_call_b64 s[76:77], PREP_a_issue_4
    s_add_u32 m0, m0, 1024
    s_add_u32 s39, s39, 229376
    buffer_load_dwordx4 v2, s[12:15], s39 offen sc1 lds
    s_add_u32 m0, m0, 1024
    s_add_u32 s40, s40, 229376
    buffer_load_dwordx4 v2, s[12:15], s40 offen sc1 lds
    s_add_u32 m0, m0, 1024
    s_add_u32 s39, s39, s37
    buffer_load_dwordx4 v2, s[12:15], s39 offen sc1 lds
    s_add_u32 m0, m0, 1024
    s_add_u32 s40, s40, s37
    buffer_load_dwordx4 v2, s[12:15], s40 offen sc1 lds
    s_add_u32 m0, m0, 1024
    s_add_u32 s39, s39, 229376
    buffer_load_dwordx4 v2, s[12:15], s39 offen sc1 lds
    s_add_u32 m0, m0, 1024
    s_add_u32 s40, s40, 229376
    buffer_load_dwordx4 v2, s[12:15], s40 offen sc1 lds
    s_mov_b32 m0, s19
    s_mov_b32 s39, s16
    s_mov_b32 s40, s17
    s_waitcnt vmcnt(8)
    s_barrier
    buffer_load_dwordx4 v2, s[12:15], s39 offen sc1 lds
    s_add_u32 m0, m0, 1024
    s_nop 0
    buffer_load_dwordx4 v2, s[12:15], s40 offen sc1 lds
    s_add_u32 s54, s52, 16
    s_waitcnt lgkmcnt(0)
    s_cmp_eq_u32 s32, s54
    s_cbranch_scc1 fok_51
    v_mov_b32 v9, s34
    s_mov_b32 s53, 0
    s_add_u32 s54, s52, 16
    s_bfm_b64 exec, 1, 0
poll_52:
    buffer_load_dword v8, v9, s[56:59], 0 offen sc1
    s_waitcnt vmcnt(0)
    v_cmp_eq_u32 vcc, s54, v8
    s_nop 0
    s_cmp_eq_u64 vcc, exec
    s_cbranch_scc1 pok_53
    s_sleep 5
    s_add_u32 s53, s53, 1
    s_cmp_lt_u32 s53, s61
    s_cbranch_scc1 poll_52
    s_mov_b32 s61, 0
pok_53:
    s_mov_b64 exec, -1
fok_51:
    s_call_b64 s[76:77], PREP_a_issue_4
    s_add_u32 m0, m0, 1024
    s_add_u32 s39, s39, 229376
    buffer_load_dwordx4 v2, s[12:15], s39 offen sc1 lds
    s_add_u32 m0, m0, 1024
    s_add_u32 s40, s40, 229376
    buffer_load_dwordx4 v2, s[12:15], s40 offen sc1 lds
    s_add_u32 m0, m0, 1024
    s_add_u32 s39, s39, s37
    buffer_load_dwordx4 v2, s[12:15], s39 offen sc1 lds
    s_add_u32 m0, m0, 1024
    s_add_u32 s40, s40, s37
    buffer_load_dwordx4 v2, s[12:15], s40 offen sc1 lds
    s_add_u32 m0, m0, 1024
    s_add_u32 s39, s39, 229376
    buffer_load_dwordx4 v2, s[12:15], s39 offen sc1 lds
    s_add_u32 m0, m0, 1024
    s_add_u32 s40, s40, 229376
    buffer_load_dwordx4 v2, s[12:15], s40 offen sc1 lds
    s_mov_b32 m0, s19
    s_mov_b32 s39, s16
    s_mov_b32 s40, s17
    s_waitcnt vmcnt(8)
    s_barrier
    buffer_load_dwordx4 v2, s[12:15], s39 offen sc1 lds
    s_add_u32 m0, m0, 1024
    s_nop 0
    buffer_load_dwordx4 v2, s[12:15], s40 offen sc1 lds
    s_mov_b32 s43, 1
ld_54:
    s_add_u32 s19, s41, s42
    s_lshl_b32 s45, s44, 1
    s_add_u32 s45, s45, 0
    s_sub_u32 s45, s45, 32
    s_mul_i32 s46, s45, 86
    s_lshr_b32 s46, s46, 8
    s_mul_i32 s47, s46, 3
    s_sub_u32 s47, s45, s47
    s_lshl_b32 s47, s47, 2
    s_lshr_b32 s47, 0x362, s47
    s_and_b32 s47, s47, 7
    s_cmp_ge_u32 s44, 10
    s_cselect_b32 s45, 9, 2
    s_cselect_b32 s51, 1, 0
    s_sub_u32 s45, s44, s45
    s_cmp_lt_u32 s44, 3
    s_cselect_b32 s45, 0, s45
    s_cselect_b32 s51, s44, s51
    s_lshl2_add_u32 s51, 0, s51
    s_cmp_lt_u32 s44, 17
    s_cselect_b32 s47, s51, s47
    s_cselect_b32 s46, s45, s46
    s_add_u32 s46, s46, s33
    s_and_b32 s46, s46, 7
    s_mul_i32 s46, s46, 7
    s_add_u32 s16, s46, s47
    s_lshr_b32 s53, s16, 3
    s_lshl_b32 s53, s53, 14
    s_and_b32 s16, s16, 7
    s_lshl_b32 s16, s16, 10
    s_add_u32 s16, s16, s53
    s_add_u32 s16, s16, s38
    s_lshl_b32 s45, s44, 1
    s_add_u32 s45, s45, 1
    s_sub_u32 s45, s45, 32
    s_mul_i32 s46, s45, 86
    s_lshr_b32 s46, s46, 8
    s_mul_i32 s47, s46, 3
    s_sub_u32 s47, s45, s47
    s_lshl_b32 s47, s47, 2
    s_lshr_b32 s47, 0x362, s47
    s_and_b32 s47, s47, 7
    s_cmp_ge_u32 s44, 10
    s_cselect_b32 s45, 9, 2
    s_cselect_b32 s51, 1, 0
    s_sub_u32 s45, s44, s45
    s_cmp_lt_u32 s44, 3
    s_cselect_b32 s45, 0, s45
    s_cselect_b32 s51, s44, s51
    s_lshl2_add_u32 s51, 1, s51
    s_cmp_lt_u32 s44, 17
    s_cselect_b32 s47, s51, s47
    s_cselect_b32 s46, s45, s46
    s_add_u32 s46, s46, s33
    s_and_b32 s46, s46, 7
    s_mul_i32 s46, s46, 7
    s_add_u32 s17, s46, s47
    s_lshr_b32 s53, s17, 3
    s_lshl_b32 s53, s53, 14
    s_and_b32 s17, s17, 7
    s_lshl_b32 s17, s17, 10
    s_add_u32 s17, s17, s53
    s_add_u32 s17, s17, s38
    s_add_u32 s44, s44, 1
    s_add_u32 s42, s42, 16384
    s_cmp_eq_u32 s42, 49152
    s_cselect_b32 s42, 0, s42
    s_add_u32 m0, m0, 1024
    s_add_u32 s39, s39, 229376
    buffer_load_dwordx4 v2, s[12:15], s39 offen sc1 lds
    s_add_u32 m0, m0, 1024
    s_add_u32 s40, s40, 229376
    buffer_load_dwordx4 v2, s[12:15], s40 offen sc1 lds
    s_add_u32 m0, m0, 1024
    s_add_u32 s39, s39, s37
    buffer_load_dwordx4 v2, s[12:15], s39 offen sc1 lds
    s_add_u32 m0, m0, 1024
    s_add_u32 s40, s40, s37
    buffer_load_dwordx4 v2, s[12:15], s40 offen sc1 lds
    s_add_u32 m0, m0, 1024
    s_add_u32 s39, s39, 229376
    buffer_load_dwordx4 v2, s[12:15], s39 offen sc1 lds
    s_add_u32 m0, m0, 1024
    s_add_u32 s40, s40, 229376
    buffer_load_dwordx4 v2, s[12:15], s40 offen sc1 lds
    s_mov_b32 m0, s19
    s_mov_b32 s39, s16
    s_mov_b32 s40, s17
    s_waitcnt vmcnt(8)
    s_barrier
    buffer_load_dwordx4 v2, s[12:15], s39 offen sc1 lds
    s_add_u32 m0, m0, 1024
    s_nop 0
    buffer_load_dwordx4 v2, s[12:15], s40 offen sc1 lds
    s_add_u32 s43, s43, 1
    s_cmp_lt_u32 s43, 5
    s_cbranch_scc1 ld_54
    s_call_b64 s[76:77], PREP_a_issue_4
    s_add_u32 m0, m0, 1024
    s_add_u32 s39, s39, 229376
    buffer_load_dwordx4 v2, s[12:15], s39 offen sc1 lds
    s_add_u32 m0, m0, 1024
    s_add_u32 s40, s40, 229376
    buffer_load_dwordx4 v2, s[12:15], s40 offen sc1 lds
    s_add_u32 m0, m0, 1024
    s_add_u32 s39, s39, s37
    buffer_load_dwordx4 v2, s[12:15], s39 offen sc1 lds
    s_add_u32 m0, m0, 1024
    s_add_u32 s40, s40, s37
    buffer_load_dwordx4 v2, s[12:15], s40 offen sc1 lds
    s_add_u32 m0, m0, 1024
    s_add_u32 s39, s39, 229376
    buffer_load_dwordx4 v2, s[12:15], s39 offen sc1 lds
    s_add_u32 m0, m0, 1024
    s_add_u32 s40, s40, 229376
    buffer_load_dwordx4 v2, s[12:15], s40 offen sc1 lds
    s_mov_b32 m0, s19
    s_mov_b32 s39, s16
    s_mov_b32 s40, s17
    s_waitcnt vmcnt(8)
    s_barrier
    buffer_load_dwordx4 v2, s[12:15], s39 offen sc1 lds
    s_add_u32 m0, m0, 1024
    s_nop 0
    buffer_load_dwordx4 v2, s[12:15], s40 offen sc1 lds
    s_load_dword s32, s[4:5], s35
    s_call_b64 s[76:77], PREP_a_issue_4
    s_add_u32 m0, m0, 1024
    s_add_u32 s39, s39, 229376
    buffer_load_dwordx4 v2, s[12:15], s39 offen sc1 lds
    s_add_u32 m0, m0, 1024
    s_add_u32 s40, s40, 229376
    buffer_load_dwordx4 v2, s[12:15], s40 offen sc1 lds
    s_add_u32 m0, m0, 1024
    s_add_u32 s39, s39, s37
    buffer_load_dwordx4 v2, s[12:15], s39 offen sc1 lds
    s_add_u32 m0, m0, 1024
    s_add_u32 s40, s40, s37
    buffer_load_dwordx4 v2, s[12:15], s40 offen sc1 lds
    s_add_u32 m0, m0, 1024
    s_add_u32 s39, s39, 229376
    buffer_load_dwordx4 v2, s[12:15], s39 offen sc1 lds
    s_add_u32 m0, m0, 1024
    s_add_u32 s40, s40, 229376
    buffer_load_dwordx4 v2, s[12:15], s40 offen sc1 lds
    s_mov_b32 m0, s19
    s_mov_b32 s39, s16
    s_mov_b32 s40, s17
    s_waitcnt vmcnt(8)
    s_barrier
    buffer_load_dwordx4 v2, s[12:15], s39 offen sc1 lds
    s_add_u32 m0, m0, 1024
    s_nop 0
    buffer_load_dwordx4 v2, s[12:15], s40 offen sc1 lds
    s_add_u32 s54, s52, 16
    s_waitcnt lgkmcnt(0)
    s_cmp_eq_u32 s32, s54
    s_cbranch_scc1 fok_55
    v_mov_b32 v9, s35
    s_mov_b32 s53, 0
    s_add_u32 s54, s52, 16
    s_bfm_b64 exec, 1, 0
poll_56:
    buffer_load_dword v8, v9, s[56:59], 0 offen sc1
    s_waitcnt vmcnt(0)
    v_cmp_eq_u32 vcc, s54, v8
    s_nop 0
    s_cmp_eq_u64 vcc, exec
    s_cbranch_scc1 pok_57
    s_sleep 5
    s_add_u32 s53, s53, 1
    s_cmp_lt_u32 s53, s61
    s_cbranch_scc1 poll_56
    s_mov_b32 s61, 0
pok_57:
    s_mov_b64 exec, -1
fok_55:
    s_call_b64 s[76:77], PREP_a_issue_4
    s_add_u32 m0, m0, 1024
    s_add_u32 s39, s39, 229376
    buffer_load_dwordx4 v2, s[12:15], s39 offen sc1 lds
    s_add_u32 m0, m0, 1024
    s_add_u32 s40, s40, 229376
    buffer_load_dwordx4 v2, s[12:15], s40 offen sc1 lds
    s_add_u32 m0, m0, 1024
    s_add_u32 s39, s39, s37
    buffer_load_dwordx4 v2, s[12:15], s39 offen sc1 lds
    s_add_u32 m0, m0, 1024
    s_add_u32 s40, s40, s37
    buffer_load_dwordx4 v2, s[12:15], s40 offen sc1 lds
    s_add_u32 m0, m0, 1024
    s_add_u32 s39, s39, 229376
    buffer_load_dwordx4 v2, s[12:15], s39 offen sc1 lds
    s_add_u32 m0, m0, 1024
    s_add_u32 s40, s40, 229376
    buffer_load_dwordx4 v2, s[12:15], s40 offen sc1 lds
    s_mov_b32 m0, s19
    s_mov_b32 s39, s16
    s_mov_b32 s40, s17
    s_waitcnt vmcnt(8)
    s_barrier
    buffer_load_dwordx4 v2, s[12:15], s39 offen sc1 lds
    s_add_u32 m0, m0, 1024
    s_nop 0
    buffer_load_dwordx4 v2, s[12:15], s40 offen sc1 lds
    s_mov_b32 s43, 1
ld_58:
    s_add_u32 s19, s41, s42
    s_lshl_b32 s45, s44, 1
    s_add_u32 s45, s45, 0
    s_sub_u32 s45, s45, 32
    s_mul_i32 s46, s45, 86
    s_lshr_b32 s46, s46, 8
    s_mul_i32 s47, s46, 3
    s_sub_u32 s47, s45, s47
    s_lshl_b32 s47, s47, 2
    s_lshr_b32 s47, 0x362, s47
    s_and_b32 s47, s47, 7
    s_cmp_ge_u32 s44, 10
    s_cselect_b32 s45, 9, 2
    s_cselect_b32 s51, 1, 0
    s_sub_u32 s45, s44, s45
    s_cmp_lt_u32 s44, 3
    s_cselect_b32 s45, 0, s45
    s_cselect_b32 s51, s44, s51
    s_lshl2_add_u32 s51, 0, s51
    s_cmp_lt_u32 s44, 17
    s_cselect_b32 s47, s51, s47
    s_cselect_b32 s46, s45, s46
    s_add_u32 s46, s46, s33
    s_and_b32 s46, s46, 7
    s_mul_i32 s46, s46, 7
    s_add_u32 s16, s46, s47
    s_lshr_b32 s53, s16, 3
    s_lshl_b32 s53, s53, 14
    s_and_b32 s16, s16, 7
    s_lshl_b32 s16, s16, 10
    s_add_u32 s16, s16, s53
    s_add_u32 s16, s16, s38
    s_lshl_b32 s45, s44, 1
    s_add_u32 s45, s45, 1
    s_sub_u32 s45, s45, 32
    s_mul_i32 s46, s45, 86
    s_lshr_b32 s46, s46, 8
    s_mul_i32 s47, s46, 3
    s_sub_u32 s47, s45, s47
    s_lshl_b32 s47, s47, 2
    s_lshr_b32 s47, 0x362, s47
    s_and_b32 s47, s47, 7
    s_cmp_ge_u32 s44, 10
    s_cselect_b32 s45, 9, 2
    s_cselect_b32 s51, 1, 0
    s_sub_u32 s45, s44, s45
    s_cmp_lt_u32 s44, 3
    s_cselect_b32 s45, 0, s45
    s_cselect_b32 s51, s44, s51
    s_lshl2_add_u32 s51, 1, s51
    s_cmp_lt_u32 s44, 17
    s_cselect_b32 s47, s51, s47
    s_cselect_b32 s46, s45, s46
    s_add_u32 s46, s46, s33
    s_and_b32 s46, s46, 7
    s_mul_i32 s46, s46, 7
    s_add_u32 s17, s46, s47
    s_lshr_b32 s53, s17, 3
    s_lshl_b32 s53, s53, 14
    s_and_b32 s17, s17, 7
    s_lshl_b32 s17, s17, 10
    s_add_u32 s17, s17, s53
    s_add_u32 s17, s17, s38
    s_add_u32 s44, s44, 1
    s_add_u32 s42, s42, 16384
    s_cmp_eq_u32 s42, 49152
    s_cselect_b32 s42, 0, s42
    s_add_u32 m0, m0, 1024
    s_add_u32 s39, s39, 229376
    buffer_load_dwordx4 v2, s[12:15], s39 offen sc1 lds
    s_add_u32 m0, m0, 1024
    s_add_u32 s40, s40, 229376
    buffer_load_dwordx4 v2, s[12:15], s40 offen sc1 lds
    s_add_u32 m0, m0, 1024
    s_add_u32 s39, s39, s37
    buffer_load_dwordx4 v2, s[12:15], s39 offen sc1 lds
    s_add_u32 m0, m0, 1024
    s_add_u32 s40, s40, s37
    buffer_load_dwordx4 v2, s[12:15], s40 offen sc1 lds
    s_add_u32 m0, m0, 1024
    s_add_u32 s39, s39, 229376
    buffer_load_dwordx4 v2, s[12:15], s39 offen sc1 lds
    s_add_u32 m0, m0, 1024
    s_add_u32 s40, s40, 229376
    buffer_load_dwordx4 v2, s[12:15], s40 offen sc1 lds
    s_mov_b32 m0, s19
    s_mov_b32 s39, s16
    s_mov_b32 s40, s17
    s_waitcnt vmcnt(8)
    s_barrier
    buffer_load_dwordx4 v2, s[12:15], s39 offen sc1 lds
    s_add_u32 m0, m0, 1024
    s_nop 0
    buffer_load_dwordx4 v2, s[12:15], s40 offen sc1 lds
    s_add_u32 s43, s43, 1
    s_cmp_lt_u32 s43, 5
    s_cbranch_scc1 ld_58
    s_call_b64 s[76:77], PREP_a_issue_4
    s_add_u32 m0, m0, 1024
    s_add_u32 s39, s39, 229376
    buffer_load_dwordx4 v2, s[12:15], s39 offen sc1 lds
    s_add_u32 m0, m0, 1024
    s_add_u32 s40, s40, 229376
    buffer_load_dwordx4 v2, s[12:15], s40 offen sc1 lds
    s_add_u32 m0, m0, 1024
    s_add_u32 s39, s39, s37
    buffer_load_dwordx4 v2, s[12:15], s39 offen sc1 lds
    s_add_u32 m0, m0, 1024
    s_add_u32 s40, s40, s37
    buffer_load_dwordx4 v2, s[12:15], s40 offen sc1 lds
    s_add_u32 m0, m0, 1024
    s_add_u32 s39, s39, 229376
    buffer_load_dwordx4 v2, s[12:15], s39 offen sc1 lds
    s_add_u32 m0, m0, 1024
    s_add_u32 s40, s40, 229376
    buffer_load_dwordx4 v2, s[12:15], s40 offen sc1 lds
    s_mov_b32 m0, s19
    s_mov_b32 s39, s16
    s_mov_b32 s40, s17
    s_waitcnt vmcnt(8)
    s_barrier
    s_add_u32 s39, s38, s37
    s_add_u32 s39, s39, 229376
    s_add_u32 m0, s41, 16384
    s_add_u32 s16, s39, s78
    s_add_u32 s17, s39, s79
    buffer_load_dwordx4 v2, s[12:15], s16 offen sc1 lds
    s_add_u32 m0, m0, 1024
    s_nop 0
    buffer_load_dwordx4 v2, s[12:15], s17 offen sc1 lds
    s_add_u32 m0, m0, 1024
    s_add_u32 s16, s16, 229376
    buffer_load_dwordx4 v2, s[12:15], s16 offen sc1 lds
    s_add_u32 m0, m0, 1024
    s_add_u32 s17, s17, 229376
    buffer_load_dwordx4 v2, s[12:15], s17 offen sc1 lds
    s_add_u32 m0, m0, 1024
    s_add_u32 s16, s39, s80
    s_add_u32 s17, s39, s81
    buffer_load_dwordx4 v2, s[12:15], s16 offen sc1 lds
    s_add_u32 m0, m0, 1024
    s_nop 0
    buffer_load_dwordx4 v2, s[12:15], s17 offen sc1 lds
    s_add_u32 m0, m0, 1024
    s_add_u32 s16, s16, 229376
    buffer_load_dwordx4 v2, s[12:15], s16 offen sc1 lds
    s_add_u32 m0, m0, 1024
    s_add_u32 s17, s17, 229376
    buffer_load_dwordx4 v2, s[12:15], s17 offen sc1 lds
    s_waitcnt vmcnt(8)
    s_barrier
    s_add_u32 m0, s41, 32768
    s_add_u32 s16, s39, s82
    s_add_u32 s17, s39, s83
    buffer_load_dwordx4 v2, s[12:15], s16 offen sc1 lds
    s_add_u32 m0, m0, 1024
    s_nop 0
    buffer_load_dwordx4 v2, s[12:15], s17 offen sc1 lds
    s_add_u32 m0, m0, 1024
    s_add_u32 s16, s16, 229376
    buffer_load_dwordx4 v2, s[12:15], s16 offen sc1 lds
    s_add_u32 m0, m0, 1024
    s_add_u32 s17, s17, 229376
    buffer_load_dwordx4 v2, s[12:15], s17 offen sc1 lds
    s_add_u32 m0, m0, 1024
    s_add_u32 s16, s39, s84
    s_add_u32 s17, s39, s85
    buffer_load_dwordx4 v2, s[12:15], s16 offen sc1 lds
    s_add_u32 m0, m0, 1024
    s_nop 0
    buffer_load_dwordx4 v2, s[12:15], s17 offen sc1 lds
    s_add_u32 m0, m0, 1024
    s_add_u32 s16, s16, 229376
    buffer_load_dwordx4 v2, s[12:15], s16 offen sc1 lds
    s_add_u32 m0, m0, 1024
    s_add_u32 s17, s17, 229376
    buffer_load_dwordx4 v2, s[12:15], s17 offen sc1 lds
    s_waitcnt vmcnt(8)
    s_barrier
    s_add_u32 m0, s41, 0
    s_add_u32 s16, s39, s86
    s_add_u32 s17, s39, s87
    buffer_load_dwordx4 v2, s[12:15], s16 offen sc1 lds
    s_add_u32 m0, m0, 1024
    s_nop 0
    buffer_load_dwordx4 v2, s[12:15], s17 offen sc1 lds
    s_add_u32 m0, m0, 1024
    s_add_u32 s16, s16, 229376
    buffer_load_dwordx4 v2, s[12:15], s16 offen sc1 lds
    s_add_u32 m0, m0, 1024
    s_add_u32 s17, s17, 229376
    buffer_load_dwordx4 v2, s[12:15], s17 offen sc1 lds
    s_add_u32 m0, m0, 1024
    s_add_u32 s16, s39, s88
    s_add_u32 s17, s39, s89
    buffer_load_dwordx4 v2, s[12:15], s16 offen sc1 lds
    s_add_u32 m0, m0, 1024
    s_nop 0
    buffer_load_dwordx4 v2, s[12:15], s17 offen sc1 lds
    s_add_u32 m0, m0, 1024
    s_add_u32 s16, s16, 229376
    buffer_load_dwordx4 v2, s[12:15], s16 offen sc1 lds
    s_add_u32 m0, m0, 1024
    s_add_u32 s17, s17, 229376
    buffer_load_dwordx4 v2, s[12:15], s17 offen sc1 lds
    s_cmp_lg_u32 s60, 0
    s_cbranch_scc1 tl_59
    s_call_b64 s[76:77], SUB_w1_piece_23
    s_waitcnt vmcnt(10)
    s_branch tz_60
tl_59:
    s_waitcnt vmcnt(8)
tz_60:
    s_barrier
    s_mov_b32 s39, s38
    s_add_u32 m0, s41, 16384
    s_add_u32 s16, s39, s78
    s_add_u32 s17, s39, s79
    buffer_load_dwordx4 v2, s[12:15], s16 offen sc1 lds
    s_add_u32 m0, m0, 1024
    s_nop 0
    buffer_load_dwordx4 v2, s[12:15], s17 offen sc1 lds
    s_add_u32 m0, m0, 1024
    s_add_u32 s16, s16, 229376
    buffer_load_dwordx4 v2, s[12:15], s16 offen sc1 lds
    s_add_u32 m0, m0, 1024
    s_add_u32 s17, s17, 229376
    buffer_load_dwordx4 v2, s[12:15], s17 offen sc1 lds
    s_add_u32 m0, m0, 1024
    s_add_u32 s16, s39, s80
    s_add_u32 s17, s39, s81
    buffer_load_dwordx4 v2, s[12:15], s16 offen sc1 lds
    s_add_u32 m0, m0, 1024
    s_nop 0
    buffer_load_dwordx4 v2, s[12:15], s17 offen sc1 lds
    s_add_u32 m0, m0, 1024
    s_add_u32 s16, s16, 229376
    buffer_load_dwordx4 v2, s[12:15], s16 offen sc1 lds
    s_add_u32 m0, m0, 1024
    s_add_u32 s17, s17, 229376
    buffer_load_dwordx4 v2, s[12:15], s17 offen sc1 lds
    s_cmp_lg_u32 s60, 0
    s_cbranch_scc1 tl_61
    s_call_b64 s[76:77], SUB_w1_piece_24
    s_waitcnt vmcnt(14)
    s_branch tz_62
tl_61:
    s_waitcnt vmcnt(8)
tz_62:
    s_barrier
    s_add_u32 m0, s41, 32768
    s_add_u32 s16, s39, s82
    s_add_u32 s17, s39, s83
    buffer_load_dwordx4 v2, s[12:15], s16 offen sc1 lds
    s_add_u32 m0, m0, 1024
    s_nop 0
    buffer_load_dwordx4 v2, s[12:15], s17 offen sc1 lds
    s_add_u32 m0, m0, 1024
    s_add_u32 s16, s16, 229376
    buffer_load_dwordx4 v2, s[12:15], s16 offen sc1 lds
    s_add_u32 m0, m0, 1024
    s_add_u32 s17, s17, 229376
    buffer_load_dwordx4 v2, s[12:15], s17 offen sc1 lds
    s_add_u32 m0, m0, 1024
    s_add_u32 s16, s39, s84
    s_add_u32 s17, s39, s85
    buffer_load_dwordx4 v2, s[12:15], s16 offen sc1 lds
    s_add_u32 m0, m0, 1024
    s_nop 0
    buffer_load_dwordx4 v2, s[12:15], s17 offen sc1 lds
    s_add_u32 m0, m0, 1024
    s_add_u32 s16, s16, 229376
    buffer_load_dwordx4 v2, s[12:15], s16 offen sc1 lds
    s_add_u32 m0, m0, 1024
    s_add_u32 s17, s17, 229376
    buffer_load_dwordx4 v2, s[12:15], s17 offen sc1 lds
    s_cmp_lg_u32 s60, 0
    s_cbranch_scc1 tl_63
    s_call_b64 s[76:77], SUB_w1_piece_25
    s_waitcnt vmcnt(16)
    s_branch tz_64
tl_63:
    s_waitcnt vmcnt(8)
tz_64:
    s_barrier
    s_add_u32 m0, s41, 0
    s_add_u32 s16, s39, s86
    s_add_u32 s17, s39, s87
    buffer_load_dwordx4 v2, s[12:15], s16 offen sc1 lds
    s_add_u32 m0, m0, 1024
    s_nop 0
    buffer_load_dwordx4 v2, s[12:15], s17 offen sc1 lds
    s_add_u32 m0, m0, 1024
    s_add_u32 s16, s16, 229376
    buffer_load_dwordx4 v2, s[12:15], s16 offen sc1 lds
    s_add_u32 m0, m0, 1024
    s_add_u32 s17, s17, 229376
    buffer_load_dwordx4 v2, s[12:15], s17 offen sc1 lds
    s_add_u32 m0, m0, 1024
    s_add_u32 s16, s39, s88
    s_add_u32 s17, s39, s89
    buffer_load_dwordx4 v2, s[12:15], s16 offen sc1 lds
    s_add_u32 m0, m0, 1024
    s_nop 0
    buffer_load_dwordx4 v2, s[12:15], s17 offen sc1 lds
    s_add_u32 m0, m0, 1024
    s_add_u32 s16, s16, 229376
    buffer_load_dwordx4 v2, s[12:15], s16 offen sc1 lds
    s_add_u32 m0, m0, 1024
    s_add_u32 s17, s17, 229376
    buffer_load_dwordx4 v2, s[12:15], s17 offen sc1 lds
    s_cmp_lg_u32 s60, 0
    s_cbranch_scc1 tl_65
    s_call_b64 s[76:77], SUB_w1_piece_26
    s_waitcnt vmcnt(18)
    s_branch tz_66
tl_65:
    s_waitcnt vmcnt(8)
tz_66:
    s_barrier
    s_cmp_lg_u32 s60, 0
    s_cbranch_scc1 tl_67
    s_call_b64 s[76:77], SUB_w1_piece_27
    s_waitcnt vmcnt(10)
    s_branch tz_68
tl_67:
    s_waitcnt vmcnt(0)
tz_68:
    s_barrier
    s_cmp_eq_u32 s60, 1
    s_cbranch_scc1 K_fin
    s_branch Y_END
WLOAD:
    s_mov_b64 s[12:13], s[72:73]
    s_mov_b32 s14, 7340032
    s_mov_b32 s15, 0x20000
    s_and_b32 s35, s30, 1
    s_mul_i32 s38, s29, 448
    s_mul_i32 s41, s35, 229376
    s_add_u32 s38, s38, s41
    s_mul_i32 s41, s35, 14336
    s_add_u32 s41, s41, 49152
    s_mov_b32 s42, 0
    s_mov_b32 s44, s29
    s_add_u32 s44, s44, 1
    s_and_b32 s44, s44, 15
    s_add_u32 s44, s44, 1
    s_and_b32 s44, s44, 15
    s_add_u32 s46, s29, 1
    s_and_b32 s46, s46, 15
    s_cmp_eq_u32 s28, s29
    s_cselect_b32 s47, s46, s28
    s_mov_b32 s42, 57344
    s_call_b64 s[76:77], PREP_w_issue_3
    s_mov_b32 m0, s19
    s_mov_b32 s39, s16
    s_waitcnt vmcnt(0)
    s_and_b32 s53, s30, 3
    s_lshl_b32 s53, s53, 7
    s_add_u32 s53, s53, s55
    s_add_u32 s53, s53, 0x400
    v_mov_b32 v14, 1
    v_mov_b32 v15, 0
    s_mov_b64 exec, 1
    buffer_atomic_add v14, v15, s[56:59], s53 offen sc1
    s_mov_b64 exec, -1
    s_call_b64 s[76:77], SUB_rest_2
    s_waitcnt lgkmcnt(0)
    buffer_load_dwordx4 v121, s[12:15], s39 offen  lds
    s_add_u32 m0, m0, 1024
    s_nop 0
    buffer_load_dwordx4 v122, s[12:15], s39 offen  lds
    s_add_u32 m0, m0, 1024
    s_nop 0
    buffer_load_dwordx4 v123, s[12:15], s39 offen  lds
    s_call_b64 s[76:77], PREP_w_issue_3
    s_add_u32 m0, m0, 1024
    s_nop 0
    buffer_load_dwordx4 v124, s[12:15], s39 offen  lds
    s_add_u32 m0, m0, 1024
    s_nop 0
    buffer_load_dwordx4 v125, s[12:15], s39 offen  lds
    s_add_u32 m0, m0, 1024
    s_nop 0
    buffer_load_dwordx4 v126, s[12:15], s39 offen  lds
    s_add_u32 m0, m0, 1024
    s_nop 0
    buffer_load_dwordx4 v127, s[12:15], s39 offen  lds
    s_add_u32 m0, m0, 1024
    s_add_u32 s39, s39, 114688
    buffer_load_dwordx4 v121, s[12:15], s39 offen  lds
    s_add_u32 m0, m0, 1024
    s_nop 0
    buffer_load_dwordx4 v122, s[12:15], s39 offen  lds
    s_add_u32 m0, m0, 1024
    s_nop 0
    buffer_load_dwordx4 v123, s[12:15], s39 offen  lds
    s_add_u32 m0, m0, 1024
    s_nop 0
    buffer_load_dwordx4 v124, s[12:15], s39 offen  lds
    s_add_u32 m0, m0, 1024
    s_nop 0
    buffer_load_dwordx4 v125, s[12:15], s39 offen  lds
    s_add_u32 m0, m0, 1024
    s_nop 0
    buffer_load_dwordx4 v126, s[12:15], s39 offen  lds
    s_add_u32 m0, m0, 1024
    s_nop 0
    buffer_load_dwordx4 v127, s[12:15], s39 offen  lds
    s_mov_b32 m0, s19
    s_mov_b32 s39, s16
    s_cmp_lg_u32 s60, 0
    s_cbranch_scc1 cs_69
    s_and_b32 s35, s30, 1
    v_lshrrev_b32 v112, 2, v1
    v_mul_u32_u24 v104, 448, v112
    v_and_b32 v113, 3, v1
    v_lshl_add_u32 v104, v113, 3, v104
    v_add_u32 v104, 49152, v104
    v_mul_u32_u24 v106, 448, v112
    v_and_b32 v113, 2, v1
    v_lshl_add_u32 v106, v113, 2, v106
    v_bfe_u32 v112, v1, 4, 1
    v_and_b32 v113, 1, v1
    v_xor_b32 v113, v113, v112
    v_lshl_add_u32 v106, v113, 5, v106
    s_lshl_b32 s36, s35, 4
    s_add_u32 s36, s36, 49344
    v_add_u32 v106, s36, v106
    s_lshl_b32 s36, s35, 8
    v_add_u32 v104, s36, v104
    v_lshlrev_b32 v112, 5, v112
    v_sub_u32 v105, v104, v112
    v_add_u32 v104, v104, v112
    s_cmp_eq_u32 s28, s29
    s_cselect_b32 s36, 0, 28672
    v_add_u32 v104, s36, v104
    v_add_u32 v105, s36, v105
    v_add_u32 v106, s36, v106
    ds_read_b64_tr_b16 v[48:49], v104 offset:0
    ds_read_b64_tr_b16 v[50:51], v104 offset:7168
    ds_read_b64_tr_b16 v[52:53], v104 offset:14336
    ds_read_b64_tr_b16 v[54:55], v104 offset:21504
    ds_read_b64_tr_b16 v[56:57], v105 offset:32
    ds_read_b64_tr_b16 v[58:59], v105 offset:7200
    ds_read_b64_tr_b16 v[60:61], v105 offset:14368
    ds_read_b64_tr_b16 v[62:63], v105 offset:21536
    ds_read_b64_tr_b16 v[64:65], v104 offset:64
    ds_read_b64_tr_b16 v[66:67], v104 offset:7232
    ds_read_b64_tr_b16 v[68:69], v104 offset:14400
    ds_read_b64_tr_b16 v[70:71], v104 offset:21568
    ds_read_b64_tr_b16 v[72:73], v105 offset:96
    ds_read_b64_tr_b16 v[74:75], v105 offset:7264
    ds_read_b64_tr_b16 v[76:77], v105 offset:14432
    ds_read_b64_tr_b16 v[78:79], v105 offset:21600
    ds_read_b64_tr_b16 v[80:81], v104 offset:128
    ds_read_b64_tr_b16 v[82:83], v104 offset:7296
    ds_read_b64_tr_b16 v[84:85], v104 offset:14464
    ds_read_b64_tr_b16 v[86:87], v104 offset:21632
    ds_read_b64_tr_b16 v[88:89], v105 offset:160
    ds_read_b64_tr_b16 v[90:91], v105 offset:7328
    ds_read_b64_tr_b16 v[92:93], v105 offset:14496
    ds_read_b64_tr_b16 v[94:95], v105 offset:21664
    ds_read_b64_tr_b16 v[96:97], v106 offset:0
    ds_read_b64_tr_b16 v[98:99], v106 offset:7168
    ds_read_b64_tr_b16 v[100:101], v106 offset:14336
    ds_read_b64_tr_b16 v[102:103], v106 offset:21504
    v_and_b32 v112, 15, v1
    v_mov_b32 v113, 0x3f803f80
    v_cmp_eq_u32 vcc, 0, v112
    s_nop 1
    v_cndmask_b32 v20, 0, v113, vcc
    v_cndmask_b32 v21, 0, v113, vcc
    v_cndmask_b32 v22, 0, v113, vcc
    v_cndmask_b32 v23, 0, v113, vcc
    v_cmp_eq_u32 vcc, 1, v112
    s_nop 1
    v_cndmask_b32 v24, 0, v113, vcc
    v_cndmask_b32 v25, 0, v113, vcc
    v_cndmask_b32 v26, 0, v113, vcc
    v_cndmask_b32 v27, 0, v113, vcc
    v_cmp_eq_u32 vcc, 2, v112
    s_nop 1
    v_cndmask_b32 v28, 0, v113, vcc
    v_cndmask_b32 v29, 0, v113, vcc
    v_cndmask_b32 v30, 0, v113, vcc
    v_cndmask_b32 v31, 0, v113, vcc
    v_cmp_eq_u32 vcc, 3, v112
    s_nop 1
    v_cndmask_b32 v32, 0, v113, vcc
    v_cndmask_b32 v33, 0, v113, vcc
    v_cndmask_b32 v34, 0, v113, vcc
    v_cndmask_b32 v35, 0, v113, vcc
    v_cmp_eq_u32 vcc, 4, v112
    s_nop 1
    v_cndmask_b32 v36, 0, v113, vcc
    v_cndmask_b32 v37, 0, v113, vcc
    v_cndmask_b32 v38, 0, v113, vcc
    v_cndmask_b32 v39, 0, v113, vcc
    v_cmp_eq_u32 vcc, 5, v112
    s_nop 1
    v_cndmask_b32 v40, 0, v113, vcc
    v_cndmask_b32 v41, 0, v113, vcc
    v_cndmask_b32 v42, 0, v113, vcc
    v_cndmask_b32 v43, 0, v113, vcc
    v_cmp_eq_u32 vcc, 6, v112
    s_nop 1
    v_cndmask_b32 v44, 0, v113, vcc
    v_cndmask_b32 v45, 0, v113, vcc
    v_cndmask_b32 v46, 0, v113, vcc
    v_cndmask_b32 v47, 0, v113, vcc
    v_and_b32 v114, 48, v1
    v_lshl_add_u32 v114, v112, 6, v114
    v_mov_b32 v113, 0x7f000000
    v_cmp_gt_u32 vcc, 7, v112
    s_nop 1
    v_cndmask_b32 v114, v113, v114, vcc
    s_add_u32 s20, s4, 0x1420000
    s_addc_u32 s21, s5, 0
    s_mov_b32 s22, 0x38000
    s_mov_b32 s23, 0x20000
    s_mul_i32 s36, s28, 14336
    s_lshl1_add_u32 s35, s29, s35
    s_mul_i32 s35, s35, 448
    s_add_u32 s35, s35, s36
    s_waitcnt lgkmcnt(0)
    v_mfma_f32_16x16x32_bf16 v[108:111], v[48:51], v[20:23], 0
    v_mfma_f32_16x16x32_bf16 v[108:111], v[52:55], v[20:23], v[108:111]
    v_mfma_f32_16x16x32_bf16 v[108:111], v[56:59], v[24:27], v[108:111]
    v_mfma_f32_16x16x32_bf16 v[108:111], v[60:63], v[24:27], v[108:111]
    v_mfma_f32_16x16x32_bf16 v[108:111], v[64:67], v[28:31], v[108:111]
    v_mfma_f32_16x16x32_bf16 v[108:111], v[68:71], v[28:31], v[108:111]
    v_mfma_f32_16x16x32_bf16 v[108:111], v[72:75], v[32:35], v[108:111]
    v_mfma_f32_16x16x32_bf16 v[108:111], v[76:79], v[32:35], v[108:111]
    v_mfma_f32_16x16x32_bf16 v[108:111], v[80:83], v[36:39], v[108:111]
    v_mfma_f32_16x16x32_bf16 v[108:111], v[84:87], v[36:39], v[108:111]
    v_mfma_f32_16x16x32_bf16 v[108:111], v[88:91], v[40:43], v[108:111]
    v_mfma_f32_16x16x32_bf16 v[108:111], v[92:95], v[40:43], v[108:111]
    v_mfma_f32_16x16x32_bf16 v[108:111], v[96:99], v[44:47], v[108:111]
    v_mfma_f32_16x16x32_bf16 v[108:111], v[100:103], v[44:47], v[108:111]
    s_nop 7
    buffer_store_dwordx4 v[108:111], v114, s[20:23], s35 offen sc1
cs_69:
    s_waitcnt vmcnt(15)
    s_barrier
    buffer_load_dwordx4 v121, s[12:15], s39 offen  lds
    s_add_u32 m0, m0, 1024
    s_nop 0
    buffer_load_dwordx4 v122, s[12:15], s39 offen  lds
    s_add_u32 m0, m0, 1024
    s_nop 0
    buffer_load_dwordx4 v123, s[12:15], s39 offen  lds
    s_call_b64 s[76:77], PREP_w_issue_3
    s_add_u32 m0, m0, 1024
    s_nop 0
    buffer_load_dwordx4 v124, s[12:15], s39 offen  lds
    s_add_u32 m0, m0, 1024
    s_nop 0
    buffer_load_dwordx4 v125, s[12:15], s39 offen  lds
    s_add_u32 m0, m0, 1024
    s_nop 0
    buffer_load_dwordx4 v126, s[12:15], s39 offen  lds
    s_add_u32 m0, m0, 1024
    s_nop 0
    buffer_load_dwordx4 v127, s[12:15], s39 offen  lds
    s_add_u32 m0, m0, 1024
    s_add_u32 s39, s39, 114688
    buffer_load_dwordx4 v121, s[12:15], s39 offen  lds
    s_add_u32 m0, m0, 1024
    s_nop 0
    buffer_load_dwordx4 v122, s[12:15], s39 offen  lds
    s_add_u32 m0, m0, 1024
    s_nop 0
    buffer_load_dwordx4 v123, s[12:15], s39 offen  lds
    s_add_u32 m0, m0, 1024
    s_nop 0
    buffer_load_dwordx4 v124, s[12:15], s39 offen  lds
    s_add_u32 m0, m0, 1024
    s_nop 0
    buffer_load_dwordx4 v125, s[12:15], s39 offen  lds
    s_add_u32 m0, m0, 1024
    s_nop 0
    buffer_load_dwordx4 v126, s[12:15], s39 offen  lds
    s_add_u32 m0, m0, 1024
    s_nop 0
    buffer_load_dwordx4 v127, s[12:15], s39 offen  lds
    s_mov_b32 m0, s19
    s_mov_b32 s39, s16
    s_waitcnt vmcnt(14)
    s_barrier
    buffer_load_dwordx4 v121, s[12:15], s39 offen  lds
    s_add_u32 m0, m0, 1024
    s_nop 0
    buffer_load_dwordx4 v122, s[12:15], s39 offen  lds
    s_add_u32 m0, m0, 1024
    s_nop 0
    buffer_load_dwordx4 v123, s[12:15], s39 offen  lds
    s_call_b64 s[76:77], PREP_w_issue_3
    s_add_u32 m0, m0, 1024
    s_nop 0
    buffer_load_dwordx4 v124, s[12:15], s39 offen  lds
    s_add_u32 m0, m0, 1024
    s_nop 0
    buffer_load_dwordx4 v125, s[12:15], s39 offen  lds
    s_add_u32 m0, m0, 1024
    s_nop 0
    buffer_load_dwordx4 v126, s[12:15], s39 offen  lds
    s_add_u32 m0, m0, 1024
    s_nop 0
    buffer_load_dwordx4 v127, s[12:15], s39 offen  lds
    s_add_u32 m0, m0, 1024
    s_add_u32 s39, s39, 114688
    buffer_load_dwordx4 v121, s[12:15], s39 offen  lds
    s_add_u32 m0, m0, 1024
    s_nop 0
    buffer_load_dwordx4 v122, s[12:15], s39 offen  lds
    s_add_u32 m0, m0, 1024
    s_nop 0
    buffer_load_dwordx4 v123, s[12:15], s39 offen  lds
    s_add_u32 m0, m0, 1024
    s_nop 0
    buffer_load_dwordx4 v124, s[12:15], s39 offen  lds
    s_add_u32 m0, m0, 1024
    s_nop 0
    buffer_load_dwordx4 v125, s[12:15], s39 offen  lds
    s_add_u32 m0, m0, 1024
    s_nop 0
    buffer_load_dwordx4 v126, s[12:15], s39 offen  lds
    s_add_u32 m0, m0, 1024
    s_nop 0
    buffer_load_dwordx4 v127, s[12:15], s39 offen  lds
    s_mov_b32 m0, s19
    s_mov_b32 s39, s16
    s_waitcnt vmcnt(14)
    s_barrier
    buffer_load_dwordx4 v121, s[12:15], s39 offen  lds
    s_add_u32 m0, m0, 1024
    s_nop 0
    buffer_load_dwordx4 v122, s[12:15], s39 offen  lds
    s_add_u32 m0, m0, 1024
    s_nop 0
    buffer_load_dwordx4 v123, s[12:15], s39 offen  lds
    s_call_b64 s[76:77], PREP_w_issue_3
    s_add_u32 m0, m0, 1024
    s_nop 0
    buffer_load_dwordx4 v124, s[12:15], s39 offen  lds
    s_add_u32 m0, m0, 1024
    s_nop 0
    buffer_load_dwordx4 v125, s[12:15], s39 offen  lds
    s_add_u32 m0, m0, 1024
    s_nop 0
    buffer_load_dwordx4 v126, s[12:15], s39 offen  lds
    s_add_u32 m0, m0, 1024
    s_nop 0
    buffer_load_dwordx4 v127, s[12:15], s39 offen  lds
    s_add_u32 m0, m0, 1024
    s_add_u32 s39, s39, 114688
    buffer_load_dwordx4 v121, s[12:15], s39 offen  lds
    s_add_u32 m0, m0, 1024
    s_nop 0
    buffer_load_dwordx4 v122, s[12:15], s39 offen  lds
    s_add_u32 m0, m0, 1024
    s_nop 0
    buffer_load_dwordx4 v123, s[12:15], s39 offen  lds
    s_add_u32 m0, m0, 1024
    s_nop 0
    buffer_load_dwordx4 v124, s[12:15], s39 offen  lds
    s_add_u32 m0, m0, 1024
    s_nop 0
    buffer_load_dwordx4 v125, s[12:15], s39 offen  lds
    s_add_u32 m0, m0, 1024
    s_nop 0
    buffer_load_dwordx4 v126, s[12:15], s39 offen  lds
    s_add_u32 m0, m0, 1024
    s_nop 0
    buffer_load_dwordx4 v127, s[12:15], s39 offen  lds
    s_mov_b32 m0, s19
    s_mov_b32 s39, s16
    s_waitcnt vmcnt(28)
    s_cmp_lg_u32 s60, 0
    s_cbranch_scc1 cs_70
    s_and_b32 s36, s30, 1
    s_lshl_b32 s36, s36, 13
    s_lshl_b32 s53, s29, 7
    s_add_u32 s36, s36, s53
    s_add_u32 s36, s36, 23068672
    v_mov_b32 v14, 1
    v_mov_b32 v15, 0
    s_mov_b64 exec, 1
    buffer_atomic_add v14, v15, s[56:59], s36 offen sc1
    s_mov_b64 exec, -1
cs_70:
    s_waitcnt vmcnt(14)
    s_barrier
    buffer_load_dwordx4 v121, s[12:15], s39 offen  lds
    s_add_u32 m0, m0, 1024
    s_nop 0
    buffer_load_dwordx4 v122, s[12:15], s39 offen  lds
    s_add_u32 m0, m0, 1024
    s_nop 0
    buffer_load_dwordx4 v123, s[12:15], s39 offen  lds
    s_mov_b32 s43, 1
ld_71:
    s_add_u32 s19, s41, s42
    s_cmp_eq_u32 s44, s47
    s_cselect_b32 s16, s46, s44
    s_mul_i32 s16, s16, 458752
    s_add_u32 s16, s16, s38
    s_add_u32 s44, s44, 1
    s_and_b32 s44, s44, 15
    s_add_u32 s42, s42, 28672
    s_cmp_eq_u32 s42, 86016
    s_cselect_b32 s42, 0, s42
    s_add_u32 m0, m0, 1024
    s_nop 0
    buffer_load_dwordx4 v124, s[12:15], s39 offen  lds
    s_add_u32 m0, m0, 1024
    s_nop 0
    buffer_load_dwordx4 v125, s[12:15], s39 offen  lds
    s_add_u32 m0, m0, 1024
    s_nop 0
    buffer_load_dwordx4 v126, s[12:15], s39 offen  lds
    s_add_u32 m0, m0, 1024
    s_nop 0
    buffer_load_dwordx4 v127, s[12:15], s39 offen  lds
    s_add_u32 m0, m0, 1024
    s_add_u32 s39, s39, 114688
    buffer_load_dwordx4 v121, s[12:15], s39 offen  lds
    s_add_u32 m0, m0, 1024
    s_nop 0
    buffer_load_dwordx4 v122, s[12:15], s39 offen  lds
    s_add_u32 m0, m0, 1024
    s_nop 0
    buffer_load_dwordx4 v123, s[12:15], s39 offen  lds
    s_add_u32 m0, m0, 1024
    s_nop 0
    buffer_load_dwordx4 v124, s[12:15], s39 offen  lds
    s_add_u32 m0, m0, 1024
    s_nop 0
    buffer_load_dwordx4 v125, s[12:15], s39 offen  lds
    s_add_u32 m0, m0, 1024
    s_nop 0
    buffer_load_dwordx4 v126, s[12:15], s39 offen  lds
    s_add_u32 m0, m0, 1024
    s_nop 0
    buffer_load_dwordx4 v127, s[12:15], s39 offen  lds
    s_mov_b32 m0, s19
    s_mov_b32 s39, s16
    s_waitcnt vmcnt(14)
    s_barrier
    buffer_load_dwordx4 v121, s[12:15], s39 offen  lds
    s_add_u32 m0, m0, 1024
    s_nop 0
    buffer_load_dwordx4 v122, s[12:15], s39 offen  lds
    s_add_u32 m0, m0, 1024
    s_nop 0
    buffer_load_dwordx4 v123, s[12:15], s39 offen  lds
    s_add_u32 s43, s43, 1
    s_cmp_lt_u32 s43, 9
    s_cbranch_scc1 ld_71
    s_call_b64 s[76:77], PREP_w_issue_3
    s_add_u32 m0, m0, 1024
    s_nop 0
    buffer_load_dwordx4 v124, s[12:15], s39 offen  lds
    s_add_u32 m0, m0, 1024
    s_nop 0
    buffer_load_dwordx4 v125, s[12:15], s39 offen  lds
    s_add_u32 m0, m0, 1024
    s_nop 0
    buffer_load_dwordx4 v126, s[12:15], s39 offen  lds
    s_add_u32 m0, m0, 1024
    s_nop 0
    buffer_load_dwordx4 v127, s[12:15], s39 offen  lds
    s_add_u32 m0, m0, 1024
    s_add_u32 s39, s39, 114688
    buffer_load_dwordx4 v121, s[12:15], s39 offen  lds
    s_add_u32 m0, m0, 1024
    s_nop 0
    buffer_load_dwordx4 v122, s[12:15], s39 offen  lds
    s_add_u32 m0, m0, 1024
    s_nop 0
    buffer_load_dwordx4 v123, s[12:15], s39 offen  lds
    s_add_u32 m0, m0, 1024
    s_nop 0
    buffer_load_dwordx4 v124, s[12:15], s39 offen  lds
    s_add_u32 m0, m0, 1024
    s_nop 0
    buffer_load_dwordx4 v125, s[12:15], s39 offen  lds
    s_add_u32 m0, m0, 1024
    s_nop 0
    buffer_load_dwordx4 v126, s[12:15], s39 offen  lds
    s_add_u32 m0, m0, 1024
    s_nop 0
    buffer_load_dwordx4 v127, s[12:15], s39 offen  lds
    s_mov_b32 m0, s19
    s_mov_b32 s39, s16
    s_waitcnt vmcnt(14)
    s_barrier
    buffer_load_dwordx4 v121, s[12:15], s39 offen  lds
    s_add_u32 m0, m0, 1024
    s_nop 0
    buffer_load_dwordx4 v122, s[12:15], s39 offen  lds
    s_add_u32 m0, m0, 1024
    s_nop 0
    buffer_load_dwordx4 v123, s[12:15], s39 offen  lds
    s_add_u32 m0, m0, 1024
    s_nop 0
    buffer_load_dwordx4 v124, s[12:15], s39 offen  lds
    s_add_u32 m0, m0, 1024
    s_nop 0
    buffer_load_dwordx4 v125, s[12:15], s39 offen  lds
    s_add_u32 m0, m0, 1024
    s_nop 0
    buffer_load_dwordx4 v126, s[12:15], s39 offen  lds
    s_add_u32 m0, m0, 1024
    s_nop 0
    buffer_load_dwordx4 v127, s[12:15], s39 offen  lds
    s_add_u32 m0, m0, 1024
    s_add_u32 s39, s39, 114688
    buffer_load_dwordx4 v121, s[12:15], s39 offen  lds
    s_add_u32 m0, m0, 1024
    s_nop 0
    buffer_load_dwordx4 v122, s[12:15], s39 offen  lds
    s_add_u32 m0, m0, 1024
    s_nop 0
    buffer_load_dwordx4 v123, s[12:15], s39 offen  lds
    s_add_u32 m0, m0, 1024
    s_nop 0
    buffer_load_dwordx4 v124, s[12:15], s39 offen  lds
    s_add_u32 m0, m0, 1024
    s_nop 0
    buffer_load_dwordx4 v125, s[12:15], s39 offen  lds
    s_add_u32 m0, m0, 1024
    s_nop 0
    buffer_load_dwordx4 v126, s[12:15], s39 offen  lds
    s_add_u32 m0, m0, 1024
    s_nop 0
    buffer_load_dwordx4 v127, s[12:15], s39 offen  lds
    s_waitcnt vmcnt(14)
    s_barrier
    s_waitcnt vmcnt(0)
    s_barrier
    s_barrier
    s_mov_b64 s[12:13], s[74:75]
    s_mov_b32 s14, 7340032
    s_mov_b32 s15, 0x20000
    s_and_b32 s35, s30, 1
    s_mul_i32 s38, s33, 256
    s_mul_i32 s41, s31, 3670016
    s_add_u32 s38, s38, s41
    s_mul_i32 s41, s35, 8192
    s_add_u32 s41, s41, 49152
    s_mov_b32 s42, 0
    s_mov_b32 s44, 0
    s_mov_b32 s49, s44
    s_and_b32 s43, s28, 0
    s_mul_i32 s43, s43, 6
    s_lshr_b32 s43, s43, 2
    s_mov_b32 s50, 0
wpre_72:
    s_mul_i32 s42, s43, 16384
    s_add_u32 s44, s49, s43
    s_add_u32 s19, s41, s42
    s_and_b32 s40, s30, 1
    s_lshl_b32 s45, s44, 1
    s_add_u32 s45, s45, s40
    s_sub_u32 s45, s45, 32
    s_mul_i32 s46, s45, 86
    s_lshr_b32 s46, s46, 8
    s_mul_i32 s47, s46, 3
    s_sub_u32 s47, s45, s47
    s_lshl_b32 s47, s47, 2
    s_lshr_b32 s47, 0x362, s47
    s_and_b32 s47, s47, 7
    s_cmp_ge_u32 s44, 10
    s_cselect_b32 s45, 9, 2
    s_cselect_b32 s51, 1, 0
    s_sub_u32 s45, s44, s45
    s_cmp_lt_u32 s44, 3
    s_cselect_b32 s45, 0, s45
    s_cselect_b32 s51, s44, s51
    s_lshl2_add_u32 s51, s40, s51
    s_cmp_lt_u32 s44, 17
    s_cselect_b32 s47, s51, s47
    s_cselect_b32 s46, s45, s46
    s_add_u32 s46, s46, s33
    s_and_b32 s46, s46, 7
    s_mul_i32 s46, s46, 7
    s_add_u32 s16, s46, s47
    s_mul_i32 s16, s16, 65536
    s_add_u32 s16, s16, s38
    s_add_u32 s44, s44, 1
    s_add_u32 s42, s42, 16384
    s_cmp_eq_u32 s42, 98304
    s_cselect_b32 s42, 0, s42
    s_mov_b32 m0, s19
    s_mov_b32 s39, s16
    buffer_load_dwordx4 v119, s[12:15], s39 offen  lds
    s_add_u32 m0, m0, 1024
    s_add_u32 s39, s39, 8192
    buffer_load_dwordx4 v120, s[12:15], s39 offen  lds
    s_add_u32 m0, m0, 1024
    s_add_u32 s39, s39, 8192
    buffer_load_dwordx4 v119, s[12:15], s39 offen  lds
    s_add_u32 m0, m0, 1024
    s_add_u32 s39, s39, 8192
    buffer_load_dwordx4 v120, s[12:15], s39 offen  lds
    s_waitcnt vmcnt(8)
    s_add_u32 m0, m0, 1024
    s_add_u32 s39, s39, 8192
    buffer_load_dwordx4 v119, s[12:15], s39 offen  lds
    s_add_u32 m0, m0, 1024
    s_add_u32 s39, s39, 8192
    buffer_load_dwordx4 v120, s[12:15], s39 offen  lds
    s_add_u32 m0, m0, 1024
    s_add_u32 s39, s39, 8192
    buffer_load_dwordx4 v119, s[12:15], s39 offen  lds
    s_add_u32 m0, m0, 1024
    s_add_u32 s39, s39, 8192
    buffer_load_dwordx4 v120, s[12:15], s39 offen  lds
    s_waitcnt vmcnt(8)
    s_add_u32 s43, s43, 1
    s_cmp_eq_u32 s43, 6
    s_cselect_b32 s43, 0, s43
    s_add_u32 s50, s50, 1
    s_cmp_lt_u32 s50, 6
    s_cbranch_scc1 wpre_72
    s_mov_b32 s42, 0
    s_add_u32 s44, s49, 6
    s_mov_b64 s[8:9], s[68:69]
    s_mov_b32 s10, 2097152
    s_mov_b32 s11, 0x20000
    s_and_b32 s3, s30, 3
    s_lshl_b32 s36, s3, 14
    s_lshl_b32 s90, s29, 7
    s_add_u32 s90, s90, s36
    s_xor_b32 s90, s90, 128
    s_lshl_b32 s3, s3, 10
    s_call_b64 s[76:77], PREP_w_issue_4
    s_mov_b32 m0, s19
    s_mov_b32 s39, s16
    s_waitcnt vmcnt(40)
    s_barrier
    s_waitcnt vmcnt(32)
    s_barrier
    buffer_load_dwordx4 v119, s[12:15], s39 offen  lds
    s_add_u32 m0, m0, 1024
    s_add_u32 s39, s39, 8192
    buffer_load_dwordx4 v120, s[12:15], s39 offen  lds
    s_mov_b32 s43, 1
ld_73:
    s_add_u32 s19, s41, s42
    s_and_b32 s40, s30, 1
    s_lshl_b32 s45, s44, 1
    s_add_u32 s45, s45, s40
    s_sub_u32 s45, s45, 32
    s_mul_i32 s46, s45, 86
    s_lshr_b32 s46, s46, 8
    s_mul_i32 s47, s46, 3
    s_sub_u32 s47, s45, s47
    s_lshl_b32 s47, s47, 2
    s_lshr_b32 s47, 0x362, s47
    s_and_b32 s47, s47, 7
    s_cmp_ge_u32 s44, 10
    s_cselect_b32 s45, 9, 2
    s_cselect_b32 s51, 1, 0
    s_sub_u32 s45, s44, s45
    s_cmp_lt_u32 s44, 3
    s_cselect_b32 s45, 0, s45
    s_cselect_b32 s51, s44, s51
    s_lshl2_add_u32 s51, s40, s51
    s_cmp_lt_u32 s44, 17
    s_cselect_b32 s47, s51, s47
    s_cselect_b32 s46, s45, s46
    s_add_u32 s46, s46, s33
    s_and_b32 s46, s46, 7
    s_mul_i32 s46, s46, 7
    s_add_u32 s16, s46, s47
    s_mul_i32 s16, s16, 65536
    s_add_u32 s16, s16, s38
    s_add_u32 s44, s44, 1
    s_add_u32 s42, s42, 16384
    s_cmp_eq_u32 s42, 98304
    s_cselect_b32 s42, 0, s42
    s_add_u32 m0, m0, 1024
    s_add_u32 s39, s39, 8192
    buffer_load_dwordx4 v119, s[12:15], s39 offen  lds
    s_add_u32 m0, m0, 1024
    s_add_u32 s39, s39, 8192
    buffer_load_dwordx4 v120, s[12:15], s39 offen  lds
    s_add_u32 m0, m0, 1024
    s_add_u32 s39, s39, 8192
    buffer_load_dwordx4 v119, s[12:15], s39 offen  lds
    s_add_u32 m0, m0, 1024
    s_add_u32 s39, s39, 8192
    buffer_load_dwordx4 v120, s[12:15], s39 offen  lds
    s_add_u32 m0, m0, 1024
    s_add_u32 s39, s39, 8192
    buffer_load_dwordx4 v119, s[12:15], s39 offen  lds
    s_add_u32 m0, m0, 1024
    s_add_u32 s39, s39, 8192
    buffer_load_dwordx4 v120, s[12:15], s39 offen  lds
    s_mov_b32 m0, s19
    s_mov_b32 s39, s16
    s_waitcnt vmcnt(32)
    s_barrier
    buffer_load_dwordx4 v119, s[12:15], s39 offen  lds
    s_add_u32 m0, m0, 1024
    s_add_u32 s39, s39, 8192
    buffer_load_dwordx4 v120, s[12:15], s39 offen  lds
    s_add_u32 s43, s43, 1
    s_cmp_lt_u32 s43, 20
    s_cbranch_scc1 ld_73
    s_call_b64 s[76:77], PREP_w_issue_4
    s_add_u32 m0, m0, 1024
    s_add_u32 s39, s39, 8192
    buffer_load_dwordx4 v119, s[12:15], s39 offen  lds
    s_add_u32 m0, m0, 1024
    s_add_u32 s39, s39, 8192
    buffer_load_dwordx4 v120, s[12:15], s39 offen  lds
    s_add_u32 m0, m0, 1024
    s_add_u32 s39, s39, 8192
    buffer_load_dwordx4 v119, s[12:15], s39 offen  lds
    s_add_u32 m0, m0, 1024
    s_add_u32 s39, s39, 8192
    buffer_load_dwordx4 v120, s[12:15], s39 offen  lds
    s_add_u32 m0, m0, 1024
    s_add_u32 s39, s39, 8192
    buffer_load_dwordx4 v119, s[12:15], s39 offen  lds
    s_add_u32 m0, m0, 1024
    s_add_u32 s39, s39, 8192
    buffer_load_dwordx4 v120, s[12:15], s39 offen  lds
    s_mov_b32 m0, s19
    s_mov_b32 s39, s16
    s_waitcnt vmcnt(32)
    s_barrier
    buffer_load_dwordx4 v119, s[12:15], s39 offen  lds
    s_add_u32 m0, m0, 1024
    s_add_u32 s39, s39, 8192
    buffer_load_dwordx4 v120, s[12:15], s39 offen  lds
    s_add_u32 m0, m0, 1024
    s_add_u32 s39, s39, 8192
    buffer_load_dwordx4 v119, s[12:15], s39 offen  lds
    s_add_u32 m0, m0, 1024
    s_add_u32 s39, s39, 8192
    buffer_load_dwordx4 v120, s[12:15], s39 offen  lds
    s_add_u32 m0, m0, 1024
    s_add_u32 s39, s39, 8192
    buffer_load_dwordx4 v119, s[12:15], s39 offen  lds
    s_add_u32 m0, m0, 1024
    s_add_u32 s39, s39, 8192
    buffer_load_dwordx4 v120, s[12:15], s39 offen  lds
    s_add_u32 m0, m0, 1024
    s_add_u32 s39, s39, 8192
    buffer_load_dwordx4 v119, s[12:15], s39 offen  lds
    s_add_u32 m0, m0, 1024
    s_add_u32 s39, s39, 8192
    buffer_load_dwordx4 v120, s[12:15], s39 offen  lds
    s_call_b64 s[76:77], PREP_w_issue_4
    s_mov_b32 m0, s19
    s_mov_b32 s39, s16
    s_waitcnt vmcnt(24)
    s_barrier
    buffer_load_dwordx4 v119, s[12:15], s39 offen  lds
    s_add_u32 m0, m0, 1024
    s_add_u32 s39, s39, 8192
    buffer_load_dwordx4 v120, s[12:15], s39 offen  lds
    s_add_u32 m0, m0, 1024
    s_add_u32 s39, s39, 8192
    buffer_load_dwordx4 v119, s[12:15], s39 offen  lds
    s_add_u32 m0, m0, 1024
    s_add_u32 s39, s39, 8192
    buffer_load_dwordx4 v120, s[12:15], s39 offen  lds
    s_add_u32 m0, m0, 1024
    s_add_u32 s39, s39, 8192
    buffer_load_dwordx4 v119, s[12:15], s39 offen  lds
    s_add_u32 m0, m0, 1024
    s_add_u32 s39, s39, 8192
    buffer_load_dwordx4 v120, s[12:15], s39 offen  lds
    s_add_u32 m0, m0, 1024
    s_add_u32 s39, s39, 8192
    buffer_load_dwordx4 v119, s[12:15], s39 offen  lds
    s_add_u32 m0, m0, 1024
    s_add_u32 s39, s39, 8192
    buffer_load_dwordx4 v120, s[12:15], s39 offen  lds
    s_cmp_lg_u32 s60, 0
    s_cbranch_scc1 tl_74
    s_call_b64 s[76:77], SUB_w1_piece_23
    s_waitcnt vmcnt(18)
    s_branch tz_75
tl_74:
    s_waitcnt vmcnt(16)
tz_75:
    s_barrier
    s_cmp_lg_u32 s60, 0
    s_cbranch_scc1 tl_76
    s_call_b64 s[76:77], SUB_w1_piece_24
    s_waitcnt vmcnt(6)
    s_branch tz_77
tl_76:
    s_waitcnt vmcnt(0)
tz_77:
    s_barrier
    s_cmp_lg_u32 s60, 0
    s_cbranch_scc1 tl_78
    s_call_b64 s[76:77], SUB_w1_piece_25
tl_78:
tz_79:
    s_barrier
    s_cmp_lg_u32 s60, 0
    s_cbranch_scc1 tl_80
    s_call_b64 s[76:77], SUB_w1_piece_26
tl_80:
tz_81:
    s_barrier
    s_cmp_lg_u32 s60, 0
    s_cbranch_scc1 tl_82
    s_call_b64 s[76:77], SUB_w1_piece_27
tl_82:
tz_83:
    s_barrier
    s_cmp_eq_u32 s60, 1
    s_cbranch_scc1 K_fin
    s_branch Y_END
Y_END:
    v_and_b32 v81, 7, v0
    v_lshrrev_b32 v84, 6, v0
    v_lshlrev_b32 v84, 4, v84
    v_bfe_u32 v85, v0, 3, 3
    v_add_u32 v84, v84, v85
    s_lshr_b32 s78, s29, 1
    s_lshl_b32 s78, s78, 16
    s_and_b32 s79, s29, 1
    s_lshl_b32 s79, s79, 7
    s_add_u32 s78, s78, s79
    s_lshr_b32 s79, s30, 1
    s_lshl_b32 s79, s79, 13
    s_add_u32 s78, s78, s79
    v_lshlrev_b32 v78, 8, v84
    v_lshl_add_u32 v78, v81, 4, v78
    v_add_u32 v78, s78, v78
    s_lshl_b32 s78, s28, 7
    s_lshl_b32 s79, s29, 3
    s_add_u32 s78, s78, s79
    v_add_u32 v79, s78, v81
    v_lshlrev_b32 v80, 11, v79
    v_and_b32 v85, 3, v79
    v_lshrrev_b32 v82, 2, v79
    v_lshlrev_b32 v82, 14, v82
    v_lshl_add_u32 v82, v85, 11, v82
    v_lshl_add_u32 v82, v84, 4, v82
    v_lshrrev_b32 v85, 2, v84
    v_lshlrev_b32 v85, 3, v85
    v_and_b32 v84, 3, v84
    v_add_u32 v84, v84, v85
    v_lshl_add_u32 v80, v84, 3, v80
    v_lshlrev_b32 v79, 3, v79
    v_lshl_add_u32 v79, v84, 14, v79
    s_add_u32 s80, s4, 0x1800000
    s_addc_u32 s81, s5, 0
    s_mov_b32 s82, 0x400000
    s_mov_b32 s83, 0x20000
    s_mov_b32 s78, 0
    buffer_load_dwordx2 v[110:111], v79, s[80:83], s78 offen sc1
    s_mov_b32 s78, 65536
    buffer_load_dwordx2 v[112:113], v79, s[80:83], s78 offen sc1
    s_mov_b32 s78, 262144
    buffer_load_dwordx2 v[114:115], v79, s[80:83], s78 offen sc1
    s_mov_b32 s78, 327680
    buffer_load_dwordx2 v[116:117], v79, s[80:83], s78 offen sc1
    s_waitcnt vmcnt(10)
    s_barrier
    s_and_b32 s36, s30, 3
    s_lshl_b32 s36, s36, 10
    v_add_u32 v8, s36, v2
    v_add_u32 v9, 65536, v8
    v_add_u32 v10, 131072, v8
    ds_write_b128 v8, v[12:15] offset:49152
    ds_write_b128 v8, v[16:19] offset:53248
    ds_write_b128 v8, v[20:23] offset:57344
    ds_write_b128 v8, v[24:27] offset:61440
    ds_write_b128 v9, v[28:31] offset:0
    ds_write_b128 v9, v[32:35] offset:4096
    ds_write_b128 v9, v[36:39] offset:8192
    ds_write_b128 v9, v[40:43] offset:12288
    ds_write_b128 v10, v[44:47] offset:0
    ds_write_b128 v10, v[48:51] offset:4096
    ds_write_b128 v10, v[52:55] offset:8192
    ds_write_b128 v10, v[56:59] offset:12288
    ds_write_b128 v8, v[60:63] offset:24576
    ds_write_b128 v8, v[64:67] offset:28672
    s_waitcnt lgkmcnt(0)
NEXT:
    s_setprio 0
    s_add_u32 s60, s60, 1
    s_add_u32 s55, s55, 67108864
    s_add_u32 s62, s62, 67108864
    s_addc_u32 s63, s63, 0
    s_branch LAYER
K_fin:
    s_endpgm
PREP_a_issue_3:
    s_add_u32 s19, s41, s42
    s_cmp_eq_u32 s44, s47
    s_cselect_b32 s16, s46, s44
    s_cmp_eq_u32 s44, s46
    s_cselect_b32 s16, s47, s16
    s_lshr_b32 s45, s16, 2
    s_lshl_b32 s45, s45, 14
    s_and_b32 s16, s16, 3
    s_lshl_b32 s16, s16, 11
    s_add_u32 s16, s16, s45
    s_add_u32 s16, s16, s38
    s_add_u32 s44, s44, 1
    s_and_b32 s44, s44, 15
    s_add_u32 s42, s42, 16384
    s_cmp_eq_u32 s42, 49152
    s_cselect_b32 s42, 0, s42
    s_setpc_b64 s[76:77]
SUB_rest_2:
    v_lshlrev_b32 v108, 16, v20
    v_and_b32 v109, 0xffff0000, v20
    v_lshlrev_b32 v110, 16, v21
    v_and_b32 v111, 0xffff0000, v21
    v_lshlrev_b32 v112, 16, v22
    v_and_b32 v113, 0xffff0000, v22
    v_lshlrev_b32 v114, 16, v23
    v_and_b32 v115, 0xffff0000, v23
    v_pk_add_f32 v[24:25], v[108:109], v[110:111]
    v_pk_mul_f32 v[26:27], v[108:109], v[108:109]
    v_pk_fma_f32 v[26:27], v[110:111], v[110:111], v[26:27]
    v_pk_add_f32 v[24:25], v[24:25], v[112:113]
    v_pk_fma_f32 v[26:27], v[112:113], v[112:113], v[26:27]
    v_pk_add_f32 v[24:25], v[24:25], v[114:115]
    v_pk_fma_f32 v[26:27], v[114:115], v[114:115], v[26:27]
    v_add_f32 v100, v24, v25
    v_add_f32 v101, v26, v27
    v_lshlrev_b32 v108, 16, v28
    v_and_b32 v109, 0xffff0000, v28
    v_lshlrev_b32 v110, 16, v29
    v_and_b32 v111, 0xffff0000, v29
    v_lshlrev_b32 v112, 16, v30
    v_and_b32 v113, 0xffff0000, v30
    v_lshlrev_b32 v114, 16, v31
    v_and_b32 v115, 0xffff0000, v31
    v_pk_add_f32 v[32:33], v[108:109], v[110:111]
    v_pk_mul_f32 v[34:35], v[108:109], v[108:109]
    v_pk_fma_f32 v[34:35], v[110:111], v[110:111], v[34:35]
    v_pk_add_f32 v[32:33], v[32:33], v[112:113]
    v_pk_fma_f32 v[34:35], v[112:113], v[112:113], v[34:35]
    v_pk_add_f32 v[32:33], v[32:33], v[114:115]
    v_pk_fma_f32 v[34:35], v[114:115], v[114:115], v[34:35]
    v_add_f32 v102, v32, v33
    v_add_f32 v103, v34, v35
    v_lshlrev_b32 v108, 16, v36
    v_and_b32 v109, 0xffff0000, v36
    v_lshlrev_b32 v110, 16, v37
    v_and_b32 v111, 0xffff0000, v37
    v_lshlrev_b32 v112, 16, v38
    v_and_b32 v113, 0xffff0000, v38
    v_lshlrev_b32 v114, 16, v39
    v_and_b32 v115, 0xffff0000, v39
    v_pk_add_f32 v[40:41], v[108:109], v[110:111]
    v_pk_mul_f32 v[42:43], v[108:109], v[108:109]
    v_pk_fma_f32 v[42:43], v[110:111], v[110:111], v[42:43]
    v_pk_add_f32 v[40:41], v[40:41], v[112:113]
    v_pk_fma_f32 v[42:43], v[112:113], v[112:113], v[42:43]
    v_pk_add_f32 v[40:41], v[40:41], v[114:115]
    v_pk_fma_f32 v[42:43], v[114:115], v[114:115], v[42:43]
    v_add_f32 v104, v40, v41
    v_add_f32 v105, v42, v43
    v_lshlrev_b32 v108, 16, v44
    v_and_b32 v109, 0xffff0000, v44
    v_lshlrev_b32 v110, 16, v45
    v_and_b32 v111, 0xffff0000, v45
    v_lshlrev_b32 v112, 16, v46
    v_and_b32 v113, 0xffff0000, v46
    v_lshlrev_b32 v114, 16, v47
    v_and_b32 v115, 0xffff0000, v47
    v_pk_add_f32 v[48:49], v[108:109], v[110:111]
    v_pk_mul_f32 v[50:51], v[108:109], v[108:109]
    v_pk_fma_f32 v[50:51], v[110:111], v[110:111], v[50:51]
    v_pk_add_f32 v[48:49], v[48:49], v[112:113]
    v_pk_fma_f32 v[50:51], v[112:113], v[112:113], v[50:51]
    v_pk_add_f32 v[48:49], v[48:49], v[114:115]
    v_pk_fma_f32 v[50:51], v[114:115], v[114:115], v[50:51]
    v_add_f32 v106, v48, v49
    v_add_f32 v107, v50, v51
    s_and_b32 s36, s30, 3
    s_lshl_b32 s36, s36, 10
    s_add_u32 s36, s36, 155648
    v_lshlrev_b32 v6, 3, v1
    v_add_u32 v6, s36, v6
    v_permlane32_swap_b32 v100, v102
    v_permlane32_swap_b32 v104, v106
    v_permlane32_swap_b32 v101, v103
    v_permlane32_swap_b32 v105, v107
    v_pk_add_f32 v[100:101], v[100:101], v[102:103]
    v_pk_add_f32 v[104:105], v[104:105], v[106:107]
    ds_write_b64 v6, v[100:101] offset:0
    ds_write_b64 v6, v[104:105] offset:512
    s_setpc_b64 s[76:77]
PREP_a_issue_4:
    s_add_u32 s19, s41, s42
    s_lshl_b32 s45, s44, 1
    s_add_u32 s45, s45, 0
    s_sub_u32 s45, s45, 32
    s_mul_i32 s46, s45, 86
    s_lshr_b32 s46, s46, 8
    s_mul_i32 s47, s46, 3
    s_sub_u32 s47, s45, s47
    s_lshl_b32 s47, s47, 2
    s_lshr_b32 s47, 0x362, s47
    s_and_b32 s47, s47, 7
    s_cmp_ge_u32 s44, 10
    s_cselect_b32 s45, 9, 2
    s_cselect_b32 s51, 1, 0
    s_sub_u32 s45, s44, s45
    s_cmp_lt_u32 s44, 3
    s_cselect_b32 s45, 0, s45
    s_cselect_b32 s51, s44, s51
    s_lshl2_add_u32 s51, 0, s51
    s_cmp_lt_u32 s44, 17
    s_cselect_b32 s47, s51, s47
    s_cselect_b32 s46, s45, s46
    s_add_u32 s46, s46, s33
    s_and_b32 s46, s46, 7
    s_mul_i32 s46, s46, 7
    s_add_u32 s16, s46, s47
    s_lshr_b32 s53, s16, 3
    s_lshl_b32 s53, s53, 14
    s_and_b32 s16, s16, 7
    s_lshl_b32 s16, s16, 10
    s_add_u32 s16, s16, s53
    s_add_u32 s16, s16, s38
    s_lshl_b32 s45, s44, 1
    s_add_u32 s45, s45, 1
    s_sub_u32 s45, s45, 32
    s_mul_i32 s46, s45, 86
    s_lshr_b32 s46, s46, 8
    s_mul_i32 s47, s46, 3
    s_sub_u32 s47, s45, s47
    s_lshl_b32 s47, s47, 2
    s_lshr_b32 s47, 0x362, s47
    s_and_b32 s47, s47, 7
    s_cmp_ge_u32 s44, 10
    s_cselect_b32 s45, 9, 2
    s_cselect_b32 s51, 1, 0
    s_sub_u32 s45, s44, s45
    s_cmp_lt_u32 s44, 3
    s_cselect_b32 s45, 0, s45
    s_cselect_b32 s51, s44, s51
    s_lshl2_add_u32 s51, 1, s51
    s_cmp_lt_u32 s44, 17
    s_cselect_b32 s47, s51, s47
    s_cselect_b32 s46, s45, s46
    s_add_u32 s46, s46, s33
    s_and_b32 s46, s46, 7
    s_mul_i32 s46, s46, 7
    s_add_u32 s17, s46, s47
    s_lshr_b32 s53, s17, 3
    s_lshl_b32 s53, s53, 14
    s_and_b32 s17, s17, 7
    s_lshl_b32 s17, s17, 10
    s_add_u32 s17, s17, s53
    s_add_u32 s17, s17, s38
    s_add_u32 s44, s44, 1
    s_add_u32 s42, s42, 16384
    s_cmp_eq_u32 s42, 49152
    s_cselect_b32 s42, 0, s42
    s_setpc_b64 s[76:77]
SUB_w1_piece_23:
    s_add_u32 s36, s67, 3
    s_and_b32 s36, s36, 7
    s_lshl_b32 s36, s36, 17
    s_add_u32 s36, s36, s90
    buffer_load_dwordx4 v[12:15], v118, s[8:11], s36 offen
    s_add_u32 s36, s36, 65536
    buffer_load_dwordx4 v[16:19], v118, s[8:11], s36 offen
    s_setpc_b64 s[76:77]
SUB_w1_piece_24:
    s_add_u32 s36, s67, 4
    s_and_b32 s36, s36, 7
    s_lshl_b32 s36, s36, 17
    s_add_u32 s36, s36, s90
    buffer_load_dwordx4 v[20:23], v118, s[8:11], s36 offen
    s_add_u32 s36, s36, 65536
    buffer_load_dwordx4 v[24:27], v118, s[8:11], s36 offen
    s_add_u32 s36, s67, 5
    s_and_b32 s36, s36, 7
    s_lshl_b32 s36, s36, 17
    s_add_u32 s36, s36, s90
    buffer_load_dwordx4 v[28:31], v118, s[8:11], s36 offen
    s_add_u32 s36, s36, 65536
    buffer_load_dwordx4 v[32:35], v118, s[8:11], s36 offen
    s_setpc_b64 s[76:77]
SUB_w1_piece_25:
    s_add_u32 s36, s67, 6
    s_and_b32 s36, s36, 7
    s_lshl_b32 s36, s36, 17
    s_add_u32 s36, s36, s90
    buffer_load_dwordx4 v[36:39], v118, s[8:11], s36 offen
    s_add_u32 s36, s36, 65536
    buffer_load_dwordx4 v[40:43], v118, s[8:11], s36 offen
    s_add_u32 s36, s67, 5
    s_and_b32 s36, s36, 7
    s_lshl_b32 s36, s36, 17
    s_add_u32 s36, s36, s90
    s_add_u32 s36, s36, 1048576
    buffer_load_dwordx4 v[44:47], v118, s[8:11], s36 offen
    s_add_u32 s36, s36, 65536
    buffer_load_dwordx4 v[48:51], v118, s[8:11], s36 offen
    s_setpc_b64 s[76:77]
SUB_w1_piece_26:
    s_add_u32 s36, s67, 6
    s_and_b32 s36, s36, 7
    s_lshl_b32 s36, s36, 17
    s_add_u32 s36, s36, s90
    s_add_u32 s36, s36, 1048576
    buffer_load_dwordx4 v[52:55], v118, s[8:11], s36 offen
    s_add_u32 s36, s36, 65536
    buffer_load_dwordx4 v[56:59], v118, s[8:11], s36 offen
    s_add_u32 s36, s67, 0
    s_and_b32 s36, s36, 7
    s_lshl_b32 s36, s36, 17
    s_add_u32 s36, s36, s90
    buffer_load_dwordx4 v[60:63], v118, s[8:11], s36 offen
    s_add_u32 s36, s36, 65536
    buffer_load_dwordx4 v[64:67], v118, s[8:11], s36 offen
    s_add_u32 s36, s67, 7
    s_and_b32 s36, s36, 7
    s_lshl_b32 s36, s36, 17
    s_add_u32 s36, s36, s90
    s_add_u32 s36, s36, 1048576
    s_add_u32 m0, s3, 147456
    s_nop 0
    buffer_load_dwordx4 v118, s[8:11], s36 offen lds
    s_add_u32 s36, s36, 65536
    s_add_u32 m0, s3, 151552
    s_nop 0
    buffer_load_dwordx4 v118, s[8:11], s36 offen lds
    s_setpc_b64 s[76:77]
SUB_w1_piece_27:
    s_add_u32 s36, s67, 3
    s_and_b32 s36, s36, 7
    s_lshl_b32 s36, s36, 17
    s_add_u32 s36, s36, s90
    s_add_u32 s36, s36, 1048576
    s_add_u32 m0, s3, 114688
    s_nop 0
    buffer_load_dwordx4 v118, s[8:11], s36 offen lds
    s_add_u32 s36, s36, 65536
    s_add_u32 m0, s3, 118784
    s_nop 0
    buffer_load_dwordx4 v118, s[8:11], s36 offen lds
    s_add_u32 s36, s67, 4
    s_and_b32 s36, s36, 7
    s_lshl_b32 s36, s36, 17
    s_add_u32 s36, s36, s90
    s_add_u32 s36, s36, 1048576
    s_add_u32 m0, s3, 122880
    s_nop 0
    buffer_load_dwordx4 v118, s[8:11], s36 offen lds
    s_add_u32 s36, s36, 65536
    s_add_u32 m0, s3, 126976
    s_nop 0
    buffer_load_dwordx4 v118, s[8:11], s36 offen lds
    s_setpc_b64 s[76:77]
PREP_w_issue_3:
    s_add_u32 s19, s41, s42
    s_cmp_eq_u32 s44, s47
    s_cselect_b32 s16, s46, s44
    s_mul_i32 s16, s16, 458752
    s_add_u32 s16, s16, s38
    s_add_u32 s44, s44, 1
    s_and_b32 s44, s44, 15
    s_add_u32 s42, s42, 28672
    s_cmp_eq_u32 s42, 86016
    s_cselect_b32 s42, 0, s42
    s_setpc_b64 s[76:77]
PREP_w_issue_4:
    s_add_u32 s19, s41, s42
    s_and_b32 s40, s30, 1
    s_lshl_b32 s45, s44, 1
    s_add_u32 s45, s45, s40
    s_sub_u32 s45, s45, 32
    s_mul_i32 s46, s45, 86
    s_lshr_b32 s46, s46, 8
    s_mul_i32 s47, s46, 3
    s_sub_u32 s47, s45, s47
    s_lshl_b32 s47, s47, 2
    s_lshr_b32 s47, 0x362, s47
    s_and_b32 s47, s47, 7
    s_cmp_ge_u32 s44, 10
    s_cselect_b32 s45, 9, 2
    s_cselect_b32 s51, 1, 0
    s_sub_u32 s45, s44, s45
    s_cmp_lt_u32 s44, 3
    s_cselect_b32 s45, 0, s45
    s_cselect_b32 s51, s44, s51
    s_lshl2_add_u32 s51, s40, s51
    s_cmp_lt_u32 s44, 17
    s_cselect_b32 s47, s51, s47
    s_cselect_b32 s46, s45, s46
    s_add_u32 s46, s46, s33
    s_and_b32 s46, s46, 7
    s_mul_i32 s46, s46, 7
    s_add_u32 s16, s46, s47
    s_mul_i32 s16, s16, 65536
    s_add_u32 s16, s16, s38
    s_add_u32 s44, s44, 1
    s_add_u32 s42, s42, 16384
    s_cmp_eq_u32 s42, 98304
    s_cselect_b32 s42, 0, s42
    s_setpc_b64 s[76:77]
K_end:
    s_endpgm
.section .rodata,"a"
.p2align 6
.amdhsa_kernel interleave_layers__ssm_conv_h3__mixer_s_mlp__prompt_kernel
  .amdhsa_next_free_vgpr 256
  .amdhsa_next_free_sgpr 102
  .amdhsa_accum_offset 256
  .amdhsa_group_segment_fixed_size 0
  .amdhsa_kernarg_size 112
  .amdhsa_user_sgpr_count 2
  .amdhsa_user_sgpr_kernarg_segment_ptr 1
  .amdhsa_system_sgpr_workgroup_id_x 1
  .amdhsa_float_denorm_mode_32 3
.end_amdhsa_kernel
```

```asm
; @launch grid=(256,1,1) block=(512,1,1) lds=163840
.amdgcn_target "amdgcn-amd-amdhsa--gfx950"
.text
.globl interleave_layers__ssm_conv_h3__mixer_s_mlp__prompt_kernel
.p2align 8
.type interleave_layers__ssm_conv_h3__mixer_s_mlp__prompt_kernel,@function
interleave_layers__ssm_conv_h3__mixer_s_mlp__prompt_kernel:
    s_cmp_ge_u32 s2, 256
    s_cbranch_scc1 K_end
    s_load_dwordx8 s[8:15], s[0:1], 8
    s_load_dwordx2 s[6:7], s[0:1], 0
    s_load_dwordx8 s[68:75], s[0:1], 56
    s_load_dwordx2 s[4:5], s[0:1], 104
    s_load_dwordx2 s[84:85], s[0:1], 96
    s_memrealtime s[46:47]
    s_load_dwordx2 s[76:77], s[0:1], 40
    v_lshrrev_b32 v1, 6, v0
    s_nop 0
    v_readfirstlane_b32 s30, v1
    s_getpc_b64 s[48:49]
K_pc:
    s_lshr_b32 s36, s2, 3
    s_lshl_b32 s36, s36, 12
    v_lshlrev_b32 v252, 3, v0
    v_add_u32 v252, s36, v252
    v_cmp_gt_u32 vcc, K_end-K_pc-8, v252
    s_nop 0
    s_and_saveexec_b64 s[36:37], vcc
    s_cbranch_execz K_3
    v_mov_b32 v253, s49
    v_add_co_u32 v252, vcc, s48, v252
    s_nop 1
    v_addc_co_u32 v253, vcc, 0, v253, vcc
    global_load_dword v250, v[252:253], off
K_3:
    s_mov_b64 exec, -1
    v_bfe_u32 v8, v0, 4, 2
    v_and_b32 v9, 15, v0
    v_lshlrev_b32 v6, 11, v8
    v_lshlrev_b32 v8, 1, v8
    v_xor_b32 v8, v8, v9
    v_lshl_add_u32 v8, v8, 4, v6
    s_and_b32 s34, s2, 7
    s_lshr_b32 s35, s2, 3
    s_lshl_b32 s36, s35, 17
    s_lshl_b32 s37, s34, 8
    s_add_u32 s36, s36, s37
    s_lshl_b32 s37, s30, 6
    s_and_b32 s38, s37, 128
    s_add_u32 s37, s37, 64
    s_and_b32 s37, s37, 128
    v_xor_b32 v6, s38, v8
    v_xor_b32 v7, s37, v8
    s_lshl_b32 s37, s30, 14
    s_add_u32 s37, s37, s36
    s_add_u32 s38, s37, 8192
    s_lshl_b32 s39, s30, 11
    s_mov_b32 s18, 4194304
    s_mov_b32 s19, 0x20000
    s_mov_b32 s22, s18
    s_mov_b32 s23, s19
    s_add_u32 m0, s39, 99328
    s_waitcnt lgkmcnt(0)
    s_mov_b64 s[16:17], s[8:9]
    s_mov_b64 s[20:21], s[10:11]
    buffer_load_dwordx4 v6, s[16:19], s37 offen nt lds
    s_add_u32 m0, m0, 1024
    s_nop 0
    buffer_load_dwordx4 v7, s[16:19], s38 offen nt lds
    s_add_u32 m0, s39, 115712
    s_nop 0
    buffer_load_dwordx4 v6, s[20:23], s37 offen nt lds
    s_add_u32 m0, m0, 1024
    s_nop 0
    buffer_load_dwordx4 v6, s[20:23], s38 offen nt lds
    s_mov_b32 s86, 256
    s_mov_b32 s87, 0x20000
    v_mov_b32 v10, 0
    s_cmp_lg_u32 s30, 0
    s_cbranch_scc1 KV_t0
    s_sub_u32 s36, s36, 8192
    v_add_u32 v8, s36, v8
    s_mov_b32 m0, 98304
    s_nop 0
    buffer_load_dwordx4 v8, s[16:19], 0 offen nt lds
    s_cmp_lg_u32 s2, 0
    s_cbranch_scc1 KV_t0
    s_lshl_b32 s44, s46, 6
    s_or_b32 s44, s44, 1
    v_mov_b32 v9, s44
    s_mov_b64 exec, 1
    buffer_store_dword v9, v10, s[84:87], 0 offen sc1
    s_mov_b64 exec, -1
KV_t0:
    s_lshl_b32 s37, s34, 10
    s_lshl_b32 s38, s30, 7
    s_add_u32 s37, s37, s38
    v_and_b32 v9, 15, v0
    v_lshlrev_b32 v9, 3, v9
    s_mov_b32 s24, s12
    s_mov_b32 s25, s13
    s_mov_b32 s26, 0x2000
    s_mov_b32 s27, 0x20000
    buffer_load_dwordx2 v[12:13], v9, s[24:27], s37 offen
    v_and_b32 v1, 63, v0
    v_lshlrev_b32 v2, 4, v1
    v_lshlrev_b32 v3, 2, v1
    s_and_b32 s32, s2, 7
    s_lshr_b32 s33, s2, 3
    s_and_b32 s28, s32, 2
    s_lshr_b32 s34, s32, 2
    s_or_b32 s28, s28, s34
    s_lshl_b32 s28, s28, 2
    s_and_b32 s34, s33, 3
    s_add_u32 s28, s28, s34
    s_and_b32 s31, s32, 1
    s_lshr_b32 s33, s33, 2
    s_lshl_b32 s29, s31, 3
    s_add_u32 s29, s29, s33
    s_mov_b32 s60, 0
    s_mov_b32 s61, 40000
    s_mov_b32 s52, 0
    s_mov_b32 s55, 0
    s_mov_b32 s92, 0
    s_mov_b32 s93, 0
    s_mov_b32 s94, 0
    s_mov_b32 s56, s4
    s_mov_b32 s57, s5
    s_mov_b32 s58, 0xa000000
    s_mov_b32 s59, 0x20000
    s_add_u32 s62, s4, 33554432
    s_addc_u32 s63, s5, 0
    s_cmp_lg_u32 s30, 4
    s_cbranch_scc1 HB_1
    v_add_u32 v14, 162816, v3
    ds_write_b32 v14, v10
HB_1:
    s_mov_b64 s[88:89], s[70:71]
    s_mov_b32 s90, 2097152
    s_mov_b32 s91, 0x20000
    s_lshl3_add_u32 s36, s2, s30
    s_lshl_b32 s36, s36, 10
    s_mov_b64 s[80:81], s[68:69]
    s_mov_b32 s82, 2097152
    s_mov_b32 s83, 0x20000
    s_mov_b32 s50, s36
    v_lshrrev_b32 v14, 3, v1
    v_lshlrev_b32 v118, 11, v14
    v_and_b32 v14, 6, v14
    v_and_b32 v15, 7, v1
    v_xor_b32 v14, v14, v15
    v_lshl_add_u32 v118, v14, 4, v118
    v_mov_b32 v119, 0
    v_mov_b32 v120, 0
    v_mov_b32 v121, 0
    v_mov_b32 v122, 0
    v_mov_b32 v123, 0
    v_mov_b32 v124, 0
    v_mov_b32 v125, 0
    v_mov_b32 v126, 0
    v_mov_b32 v127, 0
    s_lshl_b32 s48, s29, 7
    s_lshl_b32 s36, s30, 14
    s_add_u32 s48, s48, s36
    s_lshl_b32 s49, s30, 10
    s_add_u32 s48, s48, 1048576
    s_and_b32 s41, s30, 3
    s_and_b32 s38, s2, 7
    s_lshl_b32 s38, s38, 5
    s_lshr_b32 s39, s2, 3
    s_add_u32 s38, s38, s39
    s_lshl_b32 s39, s38, 2
    s_add_u32 s39, s39, s41
    s_mul_i32 s40, s41, 21504
    s_lshl_b32 s36, s39, 12
    s_add_u32 s12, s14, s36
    s_addc_u32 s13, s15, 0
    s_mov_b32 s14, 4096
    s_mov_b32 s15, 0x20000
    s_lshr_b32 s45, s30, 2
    s_lshl_b32 s45, s45, 11
    s_add_u32 s36, s45, 0xffffffc0
    v_add_u32 v22, s36, v2
    v_add_u32 v23, 16, v22
    s_add_u32 s36, s45, 0x3c0
    v_add_u32 v24, s36, v2
    v_add_u32 v25, 16, v24
    s_mov_b32 s36, 4032
    v_add_u32 v26, s36, v2
    v_add_u32 v27, 16, v26
    v_add_u32 v19, s40, v2
    v_add_u32 v20, s45, v19
    s_lshl_b32 s36, s38, 14
    s_add_u32 s36, s36, 25165824
    s_add_u32 s20, s4, s36
    s_addc_u32 s21, s5, 0
    s_mov_b32 s22, 16384
    s_mov_b32 s23, 0x20000
    s_lshl_b32 s36, s30, 6
    v_lshrrev_b32 v94, 2, v1
    v_and_b32 v97, 48, v2
    v_lshl_add_u32 v97, v94, 8, v97
    v_add_u32 v97, s36, v97
    s_lshr_b32 s36, s39, 1
    s_lshl_b32 s36, s36, 2
    s_load_dword s41, s[76:77], s36
    v_and_b32 v100, 15, v1
    v_lshrrev_b32 v101, 4, v1
    v_and_b32 v94, 3, v100
    v_mul_u32_u24 v98, 4160, v94
    v_lshl_add_u32 v98, v101, 4, v98
    v_lshrrev_b32 v94, 2, v100
    v_lshl_add_u32 v98, v94, 3, v98
    v_add_u32 v98, s40, v98
    v_sub_u32 v94, 15, v100
    v_lshlrev_b32 v99, 5, v94
    v_add_u32 v99, s40, v99
    v_lshl_add_u32 v99, v101, 4, v99
    s_lshr_b32 s36, s38, 2
    s_lshl_b32 s36, s36, 12
    s_add_u32 s36, s36, 23330816
    v_lshlrev_b32 v102, 7, v1
    v_add_u32 v102, s36, v102
    v_and_b32 v81, 7, v0
    v_lshrrev_b32 v84, 6, v0
    v_lshlrev_b32 v84, 4, v84
    v_bfe_u32 v85, v0, 3, 3
    v_add_u32 v84, v84, v85
    s_lshr_b32 s78, s29, 1
    s_lshl_b32 s78, s78, 16
    s_and_b32 s79, s29, 1
    s_lshl_b32 s79, s79, 7
    s_add_u32 s78, s78, s79
    s_lshr_b32 s79, s30, 1
    s_lshl_b32 s79, s79, 13
    s_add_u32 s78, s78, s79
    v_lshlrev_b32 v78, 8, v84
    v_lshl_add_u32 v78, v81, 4, v78
    v_add_u32 v78, s78, v78
    s_lshl_b32 s78, s28, 7
    s_lshl_b32 s79, s29, 3
    s_add_u32 s78, s78, s79
    v_add_u32 v79, s78, v81
    v_lshlrev_b32 v80, 11, v79
    v_and_b32 v85, 3, v79
    v_lshrrev_b32 v82, 2, v79
    v_lshlrev_b32 v82, 14, v82
    v_lshl_add_u32 v82, v85, 11, v82
    v_lshl_add_u32 v82, v84, 4, v82
    v_lshrrev_b32 v85, 2, v84
    v_lshlrev_b32 v85, 3, v85
    v_and_b32 v84, 3, v84
    v_add_u32 v84, v84, v85
    v_lshl_add_u32 v80, v84, 3, v80
    v_lshlrev_b32 v79, 3, v79
    v_lshl_add_u32 v79, v84, 14, v79
    s_mov_b32 s8, s6
    s_mov_b32 s9, s7
    s_mov_b32 s10, 0x400000
    s_mov_b32 s11, 0x20000
    v_mov_b32 v60, 0
    v_mov_b32 v61, 0
    v_mov_b32 v62, 0
    v_mov_b32 v63, 0
    s_bfm_b64 exec, 40, 0
    ds_write_b128 v19, v[60:63] offset:20736
    s_mov_b64 exec, -1
    s_and_b32 s34, s2, 7
    s_lshr_b32 s35, s2, 3
    v_bfe_u32 v14, v1, 2, 3
    v_xor_b32 v14, s30, v14
    v_lshlrev_b32 v16, 5, v14
    v_and_b32 v14, 3, v1
    v_lshl_add_u32 v16, v14, 3, v16
    v_bfe_u32 v14, v1, 2, 2
    v_lshl_add_u32 v16, v14, 8, v16
    v_lshrrev_b32 v14, 4, v1
    v_lshl_add_u32 v16, v14, 12, v16
    v_add_u32 v16, 98304, v16
    v_xor_b32 v17, 128, v16
    s_add_u32 s16, s4, 0x1800000
    s_addc_u32 s17, s5, 0
    s_mov_b32 s18, 0x400000
    s_mov_b32 s19, 0x20000
    v_bfe_u32 v18, v1, 2, 2
    v_lshlrev_b32 v18, 14, v18
    v_and_b32 v14, 3, v1
    v_lshl_add_u32 v18, v14, 6, v18
    v_bfe_u32 v14, v1, 4, 1
    v_lshrrev_b32 v15, 5, v1
    v_lshl_add_u32 v14, v14, 1, v15
    v_xor_b32 v14, 3, v14
    v_lshl_add_u32 v18, v14, 4, v18
    s_lshl3_add_u32 s42, s34, s30
    s_lshl_b32 s43, s42, 16
    s_sub_u32 s37, 31, s35
    s_lshl_b32 s37, s37, 9
    s_add_u32 s43, s43, s37
    s_lshl_b32 s44, s42, 5
    s_add_u32 s44, s44, s35
    s_lshl_b32 s44, s44, 7
    s_add_u32 s44, s44, 23330816
    s_cmp_lt_u32 s30, 4
    s_cbranch_scc1 HB_4
    v_lshrrev_b32 v14, 4, v1
    v_lshlrev_b32 v119, 11, v14
    v_add_u32 v14, 0, v14
    v_lshlrev_b32 v14, 1, v14
    v_and_b32 v15, 15, v1
    v_xor_b32 v14, v14, v15
    v_lshl_add_u32 v119, v14, 4, v119
    v_lshrrev_b32 v14, 4, v1
    v_lshlrev_b32 v120, 11, v14
    v_add_u32 v14, 4, v14
    v_lshlrev_b32 v14, 1, v14
    v_and_b32 v15, 15, v1
    v_xor_b32 v14, v14, v15
    v_lshl_add_u32 v120, v14, 4, v120
    v_add_u32 v15, 0, v1
    v_mul_u32_u24 v14, 2341, v15
    v_lshrrev_b32 v14, 16, v14
    v_mul_u32_u24 v121, 28, v14
    v_sub_u32 v15, v15, v121
    v_mul_u32_u24 v121, 7168, v14
    v_lshrrev_b32 v14, 1, v14
    v_and_b32 v14, 2, v14
    v_xor_b32 v15, v15, v14
    v_lshl_add_u32 v121, v15, 4, v121
    v_add_u32 v15, 64, v1
    v_mul_u32_u24 v14, 2341, v15
    v_lshrrev_b32 v14, 16, v14
    v_mul_u32_u24 v122, 28, v14
    v_sub_u32 v15, v15, v122
    v_mul_u32_u24 v122, 7168, v14
    v_lshrrev_b32 v14, 1, v14
    v_and_b32 v14, 2, v14
    v_xor_b32 v15, v15, v14
    v_lshl_add_u32 v122, v15, 4, v122
    v_add_u32 v15, 128, v1
    v_mul_u32_u24 v14, 2341, v15
    v_lshrrev_b32 v14, 16, v14
    v_mul_u32_u24 v123, 28, v14
    v_sub_u32 v15, v15, v123
    v_mul_u32_u24 v123, 7168, v14
    v_lshrrev_b32 v14, 1, v14
    v_and_b32 v14, 2, v14
    v_xor_b32 v15, v15, v14
    v_lshl_add_u32 v123, v15, 4, v123
    v_add_u32 v15, 192, v1
    v_mul_u32_u24 v14, 2341, v15
    v_lshrrev_b32 v14, 16, v14
    v_mul_u32_u24 v124, 28, v14
    v_sub_u32 v15, v15, v124
    v_mul_u32_u24 v124, 7168, v14
    v_lshrrev_b32 v14, 1, v14
    v_and_b32 v14, 2, v14
    v_xor_b32 v15, v15, v14
    v_lshl_add_u32 v124, v15, 4, v124
    v_add_u32 v15, 256, v1
    v_mul_u32_u24 v14, 2341, v15
    v_lshrrev_b32 v14, 16, v14
    v_mul_u32_u24 v125, 28, v14
    v_sub_u32 v15, v15, v125
    v_mul_u32_u24 v125, 7168, v14
    v_lshrrev_b32 v14, 1, v14
    v_and_b32 v14, 2, v14
    v_xor_b32 v15, v15, v14
    v_lshl_add_u32 v125, v15, 4, v125
    v_add_u32 v15, 320, v1
    v_mul_u32_u24 v14, 2341, v15
    v_lshrrev_b32 v14, 16, v14
    v_mul_u32_u24 v126, 28, v14
    v_sub_u32 v15, v15, v126
    v_mul_u32_u24 v126, 7168, v14
    v_lshrrev_b32 v14, 1, v14
    v_and_b32 v14, 2, v14
    v_xor_b32 v15, v15, v14
    v_lshl_add_u32 v126, v15, 4, v126
    v_add_u32 v15, 384, v1
    v_mul_u32_u24 v14, 2341, v15
    v_lshrrev_b32 v14, 16, v14
    v_mul_u32_u24 v127, 28, v14
    v_sub_u32 v15, v15, v127
    v_mul_u32_u24 v127, 7168, v14
    v_lshrrev_b32 v14, 1, v14
    v_and_b32 v14, 2, v14
    v_xor_b32 v15, v15, v14
    v_lshl_add_u32 v127, v15, 4, v127
HB_4:
    buffer_load_dwordx4 v[28:31], v22, s[12:15], 0 offen nt
    buffer_load_dwordx2 v[32:33], v23, s[12:15], 0 offen nt
    buffer_load_dwordx4 v[34:37], v24, s[12:15], 0 offen nt
    buffer_load_dwordx2 v[38:39], v25, s[12:15], 0 offen nt
    buffer_load_dwordx4 v[40:43], v26, s[12:15], 0 offen nt
    buffer_load_dwordx2 v[44:45], v27, s[12:15], 0 offen nt
    buffer_load_dwordx4 v[240:243], v2, s[88:91], s50 offen
    s_cmp_ge_u32 s30, 4
    s_cbranch_scc1 HB_3
    s_mul_i32 s36, s30, 21568
    v_lshrrev_b32 v94, 1, v100
    v_mul_u32_u24 v108, 72, v94
    v_and_b32 v94, 1, v100
    v_lshl_add_u32 v108, v94, 4, v108
    v_lshl_add_u32 v108, v101, 2, v108
    v_add_u32 v108, s36, v108
    v_add_u32 v109, 1152, v108
    v_add_u32 v110, 2304, v108
    v_add_u32 v111, 3456, v108
    v_bfe_u32 v94, v1, 2, 2
    v_mul_u32_u24 v103, 21568, v94
    v_mul_u32_u24 v94, 72, v101
    v_add_u32 v103, v103, v94
    v_and_b32 v94, 3, v1
    v_lshl_add_u32 v103, v94, 3, v103
    s_mul_i32 s36, s30, 1152
    v_add_u32 v103, s36, v103
    s_waitcnt lgkmcnt(0)
    s_bitcmp1_b32 s39, 0
    s_cselect_b32 s36, 0, 16
    s_lshl_b32 s41, s41, s36
    s_and_b32 s41, s41, 0xffff0000
    s_lshr_b32 s36, s41, 16
    v_lshl_add_u32 v94, v101, 3, v100
    v_sub_u32 v94, 15, v94
    v_and_b32 v95, 1, v94
    v_cmp_eq_u32 vcc, 1, v95
    v_mov_b32 v95, s36
    v_mov_b32 v96, s41
    v_cndmask_b32 v95, v95, v96, vcc
    v_ashrrev_i32 v94, 1, v94
    v_cmp_eq_u32 vcc, 0, v94
    s_nop 1
    v_cndmask_b32 v104, 0, v95, vcc
    v_cmp_eq_u32 vcc, 1, v94
    s_nop 1
    v_cndmask_b32 v105, 0, v95, vcc
    v_cmp_eq_u32 vcc, 2, v94
    s_nop 1
    v_cndmask_b32 v106, 0, v95, vcc
    v_cmp_eq_u32 vcc, 3, v94
    s_nop 1
    v_cndmask_b32 v107, 0, v95, vcc
HB_3:
    s_waitcnt vmcnt(7) lgkmcnt(0)
    s_barrier
    ds_read_b64_tr_b16 v[128:129], v16 offset:0
    ds_read_b64_tr_b16 v[130:131], v16 offset:1024
    ds_read_b64_tr_b16 v[132:133], v16 offset:2048
    ds_read_b64_tr_b16 v[134:135], v16 offset:3072
    ds_read_b64_tr_b16 v[136:137], v17 offset:4096
    ds_read_b64_tr_b16 v[138:139], v16 offset:17408
    ds_read_b64_tr_b16 v[140:141], v16 offset:18432
    ds_read_b64_tr_b16 v[142:143], v16 offset:19456
    ds_read_b64_tr_b16 v[144:145], v16 offset:20480
    s_load_dword s52, s[84:85], 0
    v_lshlrev_b32 v46, 16, v12
    v_and_b32 v47, 0xffff0000, v12
    v_lshlrev_b32 v48, 16, v13
    v_and_b32 v49, 0xffff0000, v13
    s_waitcnt lgkmcnt(0)
    v_lshlrev_b32 v146, 16, v128
    v_and_b32 v147, 0xffff0000, v128
    v_lshlrev_b32 v148, 16, v129
    v_and_b32 v149, 0xffff0000, v129
    v_lshlrev_b32 v150, 16, v130
    v_and_b32 v151, 0xffff0000, v130
    v_lshlrev_b32 v152, 16, v131
    v_and_b32 v153, 0xffff0000, v131
    v_lshlrev_b32 v154, 16, v132
    v_and_b32 v155, 0xffff0000, v132
    v_lshlrev_b32 v156, 16, v133
    v_and_b32 v157, 0xffff0000, v133
    v_lshlrev_b32 v158, 16, v134
    v_and_b32 v159, 0xffff0000, v134
    v_lshlrev_b32 v160, 16, v135
    v_and_b32 v161, 0xffff0000, v135
    v_lshlrev_b32 v162, 16, v136
    v_and_b32 v163, 0xffff0000, v136
    v_lshlrev_b32 v164, 16, v137
    v_and_b32 v165, 0xffff0000, v137
    v_mul_f32 v166, v147, v49
    v_mul_f32 v167, v148, v49
    v_mul_f32 v168, v149, v49
    v_mul_f32 v169, v150, v49
    v_mul_f32 v170, v151, v49
    v_mul_f32 v171, v152, v49
    v_mul_f32 v172, v153, v49
    v_mul_f32 v173, v154, v49
    v_mul_f32 v174, v155, v49
    v_mul_f32 v175, v156, v49
    v_mul_f32 v176, v157, v49
    v_mul_f32 v177, v158, v49
    v_mul_f32 v178, v159, v49
    v_mul_f32 v179, v160, v49
    v_mul_f32 v180, v161, v49
    v_mul_f32 v181, v162, v49
    v_fmac_f32 v166, v148, v48
    v_fmac_f32 v167, v149, v48
    v_fmac_f32 v168, v150, v48
    v_fmac_f32 v169, v151, v48
    v_fmac_f32 v170, v152, v48
    v_fmac_f32 v171, v153, v48
    v_fmac_f32 v172, v154, v48
    v_fmac_f32 v173, v155, v48
    v_fmac_f32 v174, v156, v48
    v_fmac_f32 v175, v157, v48
    v_fmac_f32 v176, v158, v48
    v_fmac_f32 v177, v159, v48
    v_fmac_f32 v178, v160, v48
    v_fmac_f32 v179, v161, v48
    v_fmac_f32 v180, v162, v48
    v_fmac_f32 v181, v163, v48
    v_fmac_f32 v166, v149, v47
    v_fmac_f32 v167, v150, v47
    v_fmac_f32 v168, v151, v47
    v_fmac_f32 v169, v152, v47
    v_fmac_f32 v170, v153, v47
    v_fmac_f32 v171, v154, v47
    v_fmac_f32 v172, v155, v47
    v_fmac_f32 v173, v156, v47
    v_fmac_f32 v174, v157, v47
    v_fmac_f32 v175, v158, v47
    v_fmac_f32 v176, v159, v47
    v_fmac_f32 v177, v160, v47
    v_fmac_f32 v178, v161, v47
    v_fmac_f32 v179, v162, v47
    v_fmac_f32 v180, v163, v47
    v_fmac_f32 v181, v164, v47
    v_fmac_f32 v166, v150, v46
    v_fmac_f32 v167, v151, v46
    v_fmac_f32 v168, v152, v46
    v_fmac_f32 v169, v153, v46
    v_fmac_f32 v170, v154, v46
    v_fmac_f32 v171, v155, v46
    v_fmac_f32 v172, v156, v46
    v_fmac_f32 v173, v157, v46
    v_fmac_f32 v174, v158, v46
    v_fmac_f32 v175, v159, v46
    v_fmac_f32 v176, v160, v46
    v_fmac_f32 v177, v161, v46
    v_fmac_f32 v178, v162, v46
    v_fmac_f32 v179, v163, v46
    v_fmac_f32 v180, v164, v46
    v_fmac_f32 v181, v165, v46
    v_lshlrev_b32 v146, 16, v138
    v_and_b32 v147, 0xffff0000, v138
    v_lshlrev_b32 v148, 16, v139
    v_and_b32 v149, 0xffff0000, v139
    v_lshlrev_b32 v150, 16, v140
    v_and_b32 v151, 0xffff0000, v140
    v_lshlrev_b32 v152, 16, v141
    v_and_b32 v153, 0xffff0000, v141
    v_lshlrev_b32 v154, 16, v142
    v_and_b32 v155, 0xffff0000, v142
    v_lshlrev_b32 v156, 16, v143
    v_and_b32 v157, 0xffff0000, v143
    v_lshlrev_b32 v158, 16, v144
    v_and_b32 v159, 0xffff0000, v144
    v_lshlrev_b32 v160, 16, v145
    v_and_b32 v161, 0xffff0000, v145
    v_mul_f32 v166, v166, v146
    v_mul_f32 v167, v167, v147
    v_mul_f32 v168, v168, v148
    v_mul_f32 v169, v169, v149
    v_mul_f32 v170, v170, v150
    v_mul_f32 v171, v171, v151
    v_mul_f32 v172, v172, v152
    v_mul_f32 v173, v173, v153
    v_mul_f32 v174, v174, v154
    v_mul_f32 v175, v175, v155
    v_mul_f32 v176, v176, v156
    v_mul_f32 v177, v177, v157
    v_mul_f32 v178, v178, v158
    v_mul_f32 v179, v179, v159
    v_mul_f32 v180, v180, v160
    v_mul_f32 v181, v181, v161
    v_add_u32 v167, 0x10000, v167
    v_and_b32 v167, 0xfffe0000, v167
    v_add_u32 v169, 0x10000, v169
    v_and_b32 v169, 0xfffe0000, v169
    v_add_u32 v171, 0x10000, v171
    v_and_b32 v171, 0xfffe0000, v171
    v_add_u32 v173, 0x10000, v173
    v_and_b32 v173, 0xfffe0000, v173
    v_add_u32 v175, 0x10000, v175
    v_and_b32 v175, 0xfffe0000, v175
    v_add_u32 v177, 0x10000, v177
    v_and_b32 v177, 0xfffe0000, v177
    v_add_u32 v179, 0x10000, v179
    v_and_b32 v179, 0xfffe0000, v179
    v_add_u32 v181, 0x10000, v181
    v_and_b32 v181, 0xfffe0000, v181
    v_cvt_pk_bf16_f32 v52, v173, v172
    v_cvt_pk_bf16_f32 v53, v171, v170
    v_cvt_pk_bf16_f32 v54, v169, v168
    v_cvt_pk_bf16_f32 v55, v167, v166
    v_cvt_pk_bf16_f32 v56, v181, v180
    v_cvt_pk_bf16_f32 v57, v179, v178
    v_cvt_pk_bf16_f32 v58, v177, v176
    v_cvt_pk_bf16_f32 v59, v175, v174
    s_cmp_lg_u32 s52, 0
    s_cbranch_scc1 HB_q
    s_mov_b32 s53, 0
HB_p:
    buffer_load_dword v14, v10, s[84:87], 0 offen sc1
    s_waitcnt vmcnt(0)
    v_readfirstlane_b32 s52, v14
    s_nop 0
    s_cmp_lg_u32 s52, 0
    s_cbranch_scc1 HB_q
    s_add_u32 s53, s53, 1
    s_cmp_lt_u32 s53, s61
    s_cbranch_scc1 HB_p
    s_mov_b32 s52, 1
    s_mov_b32 s61, 0
HB_q:
    v_permlane32_swap_b32 v52, v56
    v_permlane32_swap_b32 v53, v57
    v_permlane32_swap_b32 v54, v58
    v_permlane32_swap_b32 v55, v59
    v_mov_b32 v14, s52
    buffer_store_dwordx4 v[52:55], v18, s[16:19], s43 offen offset:256 sc1
    buffer_store_dwordx4 v[56:59], v18, s[16:19], s43 offen offset:0 sc1
    s_waitcnt vmcnt(3)
    v_alignbit_b32 v128, v29, v28, 16
    v_mov_b32 v132, v29
    v_alignbit_b32 v136, v30, v29, 16
    v_alignbit_b32 v129, v30, v29, 16
    v_mov_b32 v133, v30
    v_alignbit_b32 v137, v31, v30, 16
    v_alignbit_b32 v130, v31, v30, 16
    v_mov_b32 v134, v31
    v_alignbit_b32 v138, v32, v31, 16
    v_alignbit_b32 v131, v32, v31, 16
    v_mov_b32 v135, v32
    v_alignbit_b32 v139, v33, v32, 16
    ds_write_b128 v20, v[128:131] offset:0
    ds_write_b128 v20, v[132:135] offset:4160
    ds_write_b128 v20, v[136:139] offset:8320
    ds_write_b128 v20, v[30:33] offset:12480
    v_alignbit_b32 v140, v35, v34, 16
    v_mov_b32 v144, v35
    v_alignbit_b32 v148, v36, v35, 16
    v_alignbit_b32 v141, v36, v35, 16
    v_mov_b32 v145, v36
    v_alignbit_b32 v149, v37, v36, 16
    v_alignbit_b32 v142, v37, v36, 16
    v_mov_b32 v146, v37
    v_alignbit_b32 v150, v38, v37, 16
    v_alignbit_b32 v143, v38, v37, 16
    v_mov_b32 v147, v38
    v_alignbit_b32 v151, v39, v38, 16
    ds_write_b128 v20, v[140:143] offset:1024
    ds_write_b128 v20, v[144:147] offset:5184
    ds_write_b128 v20, v[148:151] offset:9344
    ds_write_b128 v20, v[36:39] offset:13504
    s_waitcnt vmcnt(0)
    s_mov_b64 exec, 1
    buffer_store_dword v14, v10, s[56:59], s44 offen sc1
    s_mov_b64 exec, -1
    s_cmp_lg_u32 s30, 5
    s_cbranch_scc1 KV_n3
    s_lshl_b32 s36, s2, 14
    s_add_u32 s36, s36, 29360128
    v_lshrrev_b32 v15, 3, v1
    v_mul_u32_u24 v15, 8064, v15
    v_add_u32 v15, v15, v2
    s_mov_b64 exec, 0xffff
    buffer_store_dwordx4 v[60:63], v15, s[56:59], s36 offen sc1
    s_mov_b64 exec, -1
KV_n3:
    v_alignbit_b32 v152, v41, v40, 16
    v_mov_b32 v156, v41
    v_alignbit_b32 v160, v42, v41, 16
    v_alignbit_b32 v153, v42, v41, 16
    v_mov_b32 v157, v42
    v_alignbit_b32 v161, v43, v42, 16
    v_alignbit_b32 v154, v43, v42, 16
    v_mov_b32 v158, v43
    v_alignbit_b32 v162, v44, v43, 16
    v_alignbit_b32 v155, v44, v43, 16
    v_mov_b32 v159, v44
    v_alignbit_b32 v163, v45, v44, 16
    s_mov_b64 exec, 0xf
    ds_write_b128 v19, v[152:155] offset:4096
    ds_write_b128 v19, v[156:159] offset:8256
    ds_write_b128 v19, v[160:163] offset:12416
    ds_write_b128 v19, v[42:45] offset:16576
    s_mov_b64 exec, -1
    s_waitcnt lgkmcnt(0)
    s_barrier
    s_add_u32 s36, s48, 0
    s_add_u32 m0, s49, 90112
    s_nop 0
    buffer_load_dwordx4 v118, s[88:91], s36 offen lds
    s_add_u32 s36, s48, 131072
    s_add_u32 m0, s49, 98304
    s_nop 0
    buffer_load_dwordx4 v118, s[88:91], s36 offen lds
    s_add_u32 s36, s48, 262144
    s_add_u32 m0, s49, 106496
    s_nop 0
    buffer_load_dwordx4 v118, s[88:91], s36 offen lds
    s_add_u32 s36, s48, 393216
    s_add_u32 m0, s49, 114688
    s_nop 0
    buffer_load_dwordx4 v118, s[88:91], s36 offen lds
    s_add_u32 s36, s48, 524288
    s_add_u32 m0, s49, 122880
    s_nop 0
    buffer_load_dwordx4 v118, s[88:91], s36 offen lds
    s_add_u32 s36, s48, 655360
    s_add_u32 m0, s49, 131072
    s_nop 0
    buffer_load_dwordx4 v118, s[88:91], s36 offen lds
    s_add_u32 s36, s48, 786432
    s_add_u32 m0, s49, 139264
    s_nop 0
    buffer_load_dwordx4 v118, s[88:91], s36 offen lds
    s_add_u32 s36, s48, 917504
    s_add_u32 m0, s49, 147456
    s_nop 0
    buffer_load_dwordx4 v118, s[88:91], s36 offen lds
    s_cmp_ge_u32 s30, 4
    s_cbranch_scc1 FR_b
    s_lshl_b32 s44, s30, 12
    s_mov_b32 s45, 0x07060302
    s_cmp_lg_u32 s30, 0
    s_cbranch_scc1 CV_w
    s_mov_b32 s53, 0
    s_add_u32 s54, s52, 0
    s_bfm_b64 exec, 32, 0
poll_1:
    buffer_load_dword v8, v102, s[56:59], 0 offen sc1
    s_waitcnt vmcnt(0)
    v_cmp_eq_u32 vcc, s54, v8
    s_nop 0
    s_cmp_eq_u64 vcc, exec
    s_cbranch_scc1 pok_2
    s_sleep 5
    s_add_u32 s53, s53, 1
    s_cmp_lt_u32 s53, s61
    s_cbranch_scc1 poll_1
    s_mov_b32 s61, 0
pok_2:
    s_mov_b64 exec, -1
CV_w:
    s_add_u32 m0, s40, 16640
    s_mov_b32 s36, 0
    s_waitcnt vmcnt(0)
    s_barrier
    buffer_load_dwordx4 v97, s[20:23], s36 offen offset:0 sc1 lds
    s_add_u32 s36, s36, 3072
    buffer_load_dwordx4 v97, s[20:23], s36 offen offset:1024 sc1 lds
    s_add_u32 s36, s36, 3072
    buffer_load_dwordx4 v97, s[20:23], s36 offen offset:2048 sc1 lds
    s_add_u32 s36, s36, 3072
    buffer_load_dwordx4 v97, s[20:23], s36 offen offset:3072 sc1 lds
    s_barrier
    buffer_load_dwordx2 v[86:87], v80, s[8:11], 0 offen offset:0 nt
    buffer_load_dwordx2 v[88:89], v80, s[8:11], 0 offen offset:32 nt
    buffer_load_dwordx2 v[90:91], v80, s[8:11], 0 offen offset:128 nt
    buffer_load_dwordx2 v[92:93], v80, s[8:11], 0 offen offset:160 nt
    ds_read_b64 v[120:121], v98 offset:32
    ds_read_b64 v[122:123], v98 offset:40
    ds_read_b64 v[124:125], v98 offset:544
    ds_read_b64 v[126:127], v98 offset:552
    ds_read_b64 v[128:129], v98 offset:1056
    ds_read_b64 v[130:131], v98 offset:1064
    ds_read_b64 v[132:133], v98 offset:1568
    ds_read_b64 v[134:135], v98 offset:1576
    ds_read_b64 v[136:137], v98 offset:2080
    ds_read_b64 v[138:139], v98 offset:2088
    ds_read_b64 v[140:141], v98 offset:2592
    ds_read_b64 v[142:143], v98 offset:2600
    ds_read_b64 v[144:145], v98 offset:3104
    ds_read_b64 v[146:147], v98 offset:3112
    ds_read_b64 v[148:149], v98 offset:3616
    ds_read_b64 v[150:151], v98 offset:3624
    s_waitcnt vmcnt(4)
    ds_read_b128 v[184:187], v99 offset:20224
    ds_read_b128 v[188:191], v99 offset:19712
    ds_read_b128 v[192:195], v99 offset:19200
    ds_read_b128 v[196:199], v99 offset:18688
    ds_read_b128 v[200:203], v99 offset:18176
    ds_read_b128 v[204:207], v99 offset:17664
    ds_read_b128 v[208:211], v99 offset:17152
    ds_read_b128 v[212:215], v99 offset:16640
    s_waitcnt lgkmcnt(0)
    v_mfma_f32_16x16x32_bf16 v[12:15], v[104:107], v[184:187], 0
    v_mfma_f32_16x16x32_bf16 v[16:19], v[104:107], v[188:191], 0
    v_mfma_f32_16x16x32_bf16 v[20:23], v[104:107], v[192:195], 0
    v_mfma_f32_16x16x32_bf16 v[24:27], v[104:107], v[196:199], 0
    v_mfma_f32_16x16x32_bf16 v[28:31], v[104:107], v[200:203], 0
    v_mfma_f32_16x16x32_bf16 v[32:35], v[104:107], v[204:207], 0
    v_mfma_f32_16x16x32_bf16 v[36:39], v[104:107], v[208:211], 0
    v_mfma_f32_16x16x32_bf16 v[40:43], v[104:107], v[212:215], 0
    s_mov_b32 s43, 0
CV_r:
    s_waitcnt lgkmcnt(0)
    v_mfma_f32_16x16x32_bf16 v[12:15], v[120:123], v[184:187], v[12:15]
    v_mfma_f32_16x16x32_bf16 v[16:19], v[120:123], v[188:191], v[16:19]
    v_mfma_f32_16x16x32_bf16 v[20:23], v[120:123], v[192:195], v[20:23]
    v_mfma_f32_16x16x32_bf16 v[24:27], v[120:123], v[196:199], v[24:27]
    v_mfma_f32_16x16x32_bf16 v[28:31], v[120:123], v[200:203], v[28:31]
    v_mfma_f32_16x16x32_bf16 v[32:35], v[120:123], v[204:207], v[32:35]
    v_mfma_f32_16x16x32_bf16 v[36:39], v[120:123], v[208:211], v[36:39]
    v_mfma_f32_16x16x32_bf16 v[40:43], v[120:123], v[212:215], v[40:43]
    v_mfma_f32_16x16x32_bf16 v[16:19], v[124:127], v[184:187], v[16:19]
    v_mfma_f32_16x16x32_bf16 v[20:23], v[124:127], v[188:191], v[20:23]
    v_mfma_f32_16x16x32_bf16 v[24:27], v[124:127], v[192:195], v[24:27]
    v_mfma_f32_16x16x32_bf16 v[28:31], v[124:127], v[196:199], v[28:31]
    v_mfma_f32_16x16x32_bf16 v[32:35], v[124:127], v[200:203], v[32:35]
    v_mfma_f32_16x16x32_bf16 v[36:39], v[124:127], v[204:207], v[36:39]
    v_mfma_f32_16x16x32_bf16 v[40:43], v[124:127], v[208:211], v[40:43]
    v_mfma_f32_16x16x32_bf16 v[20:23], v[128:131], v[184:187], v[20:23]
    v_mfma_f32_16x16x32_bf16 v[24:27], v[128:131], v[188:191], v[24:27]
    v_mfma_f32_16x16x32_bf16 v[28:31], v[128:131], v[192:195], v[28:31]
    v_mfma_f32_16x16x32_bf16 v[32:35], v[128:131], v[196:199], v[32:35]
    v_mfma_f32_16x16x32_bf16 v[36:39], v[128:131], v[200:203], v[36:39]
    v_mfma_f32_16x16x32_bf16 v[40:43], v[128:131], v[204:207], v[40:43]
    v_mfma_f32_16x16x32_bf16 v[24:27], v[132:135], v[184:187], v[24:27]
    v_mfma_f32_16x16x32_bf16 v[28:31], v[132:135], v[188:191], v[28:31]
    v_mfma_f32_16x16x32_bf16 v[32:35], v[132:135], v[192:195], v[32:35]
    v_mfma_f32_16x16x32_bf16 v[36:39], v[132:135], v[196:199], v[36:39]
    v_mfma_f32_16x16x32_bf16 v[40:43], v[132:135], v[200:203], v[40:43]
    v_mfma_f32_16x16x32_bf16 v[28:31], v[136:139], v[184:187], v[28:31]
    v_mfma_f32_16x16x32_bf16 v[32:35], v[136:139], v[188:191], v[32:35]
    v_mfma_f32_16x16x32_bf16 v[36:39], v[136:139], v[192:195], v[36:39]
    v_mfma_f32_16x16x32_bf16 v[40:43], v[136:139], v[196:199], v[40:43]
    v_mfma_f32_16x16x32_bf16 v[32:35], v[140:143], v[184:187], v[32:35]
    v_mfma_f32_16x16x32_bf16 v[36:39], v[140:143], v[188:191], v[36:39]
    v_mfma_f32_16x16x32_bf16 v[40:43], v[140:143], v[192:195], v[40:43]
    v_mfma_f32_16x16x32_bf16 v[36:39], v[144:147], v[184:187], v[36:39]
    v_mfma_f32_16x16x32_bf16 v[40:43], v[144:147], v[188:191], v[40:43]
    v_mfma_f32_16x16x32_bf16 v[40:43], v[148:151], v[184:187], v[40:43]
    ds_read_b128 v[216:219], v99 offset:20288
    ds_read_b128 v[220:223], v99 offset:19776
    ds_read_b128 v[224:227], v99 offset:19264
    ds_read_b128 v[228:231], v99 offset:18752
    ds_read_b128 v[232:235], v99 offset:18240
    ds_read_b128 v[236:239], v99 offset:17728
    ds_read_b128 v[240:243], v99 offset:17216
    ds_read_b128 v[244:247], v99 offset:16704
    ds_read_b64 v[152:153], v98 offset:96
    ds_read_b64 v[154:155], v98 offset:104
    ds_read_b64 v[156:157], v98 offset:608
    ds_read_b64 v[158:159], v98 offset:616
    ds_read_b64 v[160:161], v98 offset:1120
    ds_read_b64 v[162:163], v98 offset:1128
    ds_read_b64 v[164:165], v98 offset:1632
    ds_read_b64 v[166:167], v98 offset:1640
    ds_read_b64 v[168:169], v98 offset:2144
    ds_read_b64 v[170:171], v98 offset:2152
    ds_read_b64 v[172:173], v98 offset:2656
    ds_read_b64 v[174:175], v98 offset:2664
    ds_read_b64 v[176:177], v98 offset:3168
    ds_read_b64 v[178:179], v98 offset:3176
    ds_read_b64 v[180:181], v98 offset:3680
    ds_read_b64 v[182:183], v98 offset:3688
    s_waitcnt lgkmcnt(0)
    v_mfma_f32_16x16x32_bf16 v[12:15], v[152:155], v[216:219], v[12:15]
    v_mfma_f32_16x16x32_bf16 v[16:19], v[152:155], v[220:223], v[16:19]
    v_mfma_f32_16x16x32_bf16 v[20:23], v[152:155], v[224:227], v[20:23]
    v_mfma_f32_16x16x32_bf16 v[24:27], v[152:155], v[228:231], v[24:27]
    v_mfma_f32_16x16x32_bf16 v[28:31], v[152:155], v[232:235], v[28:31]
    v_mfma_f32_16x16x32_bf16 v[32:35], v[152:155], v[236:239], v[32:35]
    v_mfma_f32_16x16x32_bf16 v[36:39], v[152:155], v[240:243], v[36:39]
    v_mfma_f32_16x16x32_bf16 v[40:43], v[152:155], v[244:247], v[40:43]
    v_mfma_f32_16x16x32_bf16 v[16:19], v[156:159], v[216:219], v[16:19]
    v_mfma_f32_16x16x32_bf16 v[20:23], v[156:159], v[220:223], v[20:23]
    v_mfma_f32_16x16x32_bf16 v[24:27], v[156:159], v[224:227], v[24:27]
    v_mfma_f32_16x16x32_bf16 v[28:31], v[156:159], v[228:231], v[28:31]
    v_mfma_f32_16x16x32_bf16 v[32:35], v[156:159], v[232:235], v[32:35]
    v_mfma_f32_16x16x32_bf16 v[36:39], v[156:159], v[236:239], v[36:39]
    v_mfma_f32_16x16x32_bf16 v[40:43], v[156:159], v[240:243], v[40:43]
    v_mfma_f32_16x16x32_bf16 v[20:23], v[160:163], v[216:219], v[20:23]
    v_mfma_f32_16x16x32_bf16 v[24:27], v[160:163], v[220:223], v[24:27]
    v_mfma_f32_16x16x32_bf16 v[28:31], v[160:163], v[224:227], v[28:31]
    v_mfma_f32_16x16x32_bf16 v[32:35], v[160:163], v[228:231], v[32:35]
    v_mfma_f32_16x16x32_bf16 v[36:39], v[160:163], v[232:235], v[36:39]
    v_mfma_f32_16x16x32_bf16 v[40:43], v[160:163], v[236:239], v[40:43]
    v_mfma_f32_16x16x32_bf16 v[24:27], v[164:167], v[216:219], v[24:27]
    v_mfma_f32_16x16x32_bf16 v[28:31], v[164:167], v[220:223], v[28:31]
    v_mfma_f32_16x16x32_bf16 v[32:35], v[164:167], v[224:227], v[32:35]
    v_mfma_f32_16x16x32_bf16 v[36:39], v[164:167], v[228:231], v[36:39]
    v_mfma_f32_16x16x32_bf16 v[40:43], v[164:167], v[232:235], v[40:43]
    v_mfma_f32_16x16x32_bf16 v[28:31], v[168:171], v[216:219], v[28:31]
    v_mfma_f32_16x16x32_bf16 v[32:35], v[168:171], v[220:223], v[32:35]
    v_mfma_f32_16x16x32_bf16 v[36:39], v[168:171], v[224:227], v[36:39]
    v_mfma_f32_16x16x32_bf16 v[40:43], v[168:171], v[228:231], v[40:43]
    v_mfma_f32_16x16x32_bf16 v[32:35], v[172:175], v[216:219], v[32:35]
    v_mfma_f32_16x16x32_bf16 v[36:39], v[172:175], v[220:223], v[36:39]
    v_mfma_f32_16x16x32_bf16 v[40:43], v[172:175], v[224:227], v[40:43]
    v_mfma_f32_16x16x32_bf16 v[36:39], v[176:179], v[216:219], v[36:39]
    v_mfma_f32_16x16x32_bf16 v[40:43], v[176:179], v[220:223], v[40:43]
    v_mfma_f32_16x16x32_bf16 v[40:43], v[180:183], v[216:219], v[40:43]
    ds_read_b128 v[184:187], v99 offset:20352
    ds_read_b128 v[188:191], v99 offset:19840
    ds_read_b128 v[192:195], v99 offset:19328
    ds_read_b128 v[196:199], v99 offset:18816
    ds_read_b128 v[200:203], v99 offset:18304
    ds_read_b128 v[204:207], v99 offset:17792
    ds_read_b128 v[208:211], v99 offset:17280
    ds_read_b128 v[212:215], v99 offset:16768
    ds_read_b64 v[120:121], v98 offset:160
    ds_read_b64 v[122:123], v98 offset:168
    ds_read_b64 v[124:125], v98 offset:672
    ds_read_b64 v[126:127], v98 offset:680
    ds_read_b64 v[128:129], v98 offset:1184
    ds_read_b64 v[130:131], v98 offset:1192
    ds_read_b64 v[132:133], v98 offset:1696
    ds_read_b64 v[134:135], v98 offset:1704
    ds_read_b64 v[136:137], v98 offset:2208
    ds_read_b64 v[138:139], v98 offset:2216
    ds_read_b64 v[140:141], v98 offset:2720
    ds_read_b64 v[142:143], v98 offset:2728
    ds_read_b64 v[144:145], v98 offset:3232
    ds_read_b64 v[146:147], v98 offset:3240
    ds_read_b64 v[148:149], v98 offset:3744
    ds_read_b64 v[150:151], v98 offset:3752
    v_add_u32 v98, 128, v98
    v_add_u32 v99, 128, v99
    s_add_u32 s43, s43, 1
    s_cmp_lt_u32 s43, 2
    s_cbranch_scc1 CV_r
CV_l:
    s_waitcnt lgkmcnt(0)
    v_mfma_f32_16x16x32_bf16 v[12:15], v[120:123], v[184:187], v[12:15]
    ds_read_b128 v[216:219], v99 offset:20288
    v_mfma_f32_16x16x32_bf16 v[16:19], v[120:123], v[188:191], v[16:19]
    ds_read_b128 v[220:223], v99 offset:19776
    v_mfma_f32_16x16x32_bf16 v[20:23], v[120:123], v[192:195], v[20:23]
    ds_read_b128 v[224:227], v99 offset:19264
    v_mfma_f32_16x16x32_bf16 v[24:27], v[120:123], v[196:199], v[24:27]
    ds_read_b128 v[228:231], v99 offset:18752
    v_mfma_f32_16x16x32_bf16 v[28:31], v[120:123], v[200:203], v[28:31]
    ds_read_b128 v[232:235], v99 offset:18240
    v_mfma_f32_16x16x32_bf16 v[32:35], v[120:123], v[204:207], v[32:35]
    ds_read_b128 v[236:239], v99 offset:17728
    v_mfma_f32_16x16x32_bf16 v[36:39], v[120:123], v[208:211], v[36:39]
    ds_read_b128 v[240:243], v99 offset:17216
    v_mfma_f32_16x16x32_bf16 v[40:43], v[120:123], v[212:215], v[40:43]
    ds_read_b128 v[244:247], v99 offset:16704
    v_mfma_f32_16x16x32_bf16 v[16:19], v[124:127], v[184:187], v[16:19]
    ds_read_b64 v[152:153], v98 offset:96
    v_mfma_f32_16x16x32_bf16 v[20:23], v[124:127], v[188:191], v[20:23]
    ds_read_b64 v[154:155], v98 offset:104
    v_mfma_f32_16x16x32_bf16 v[24:27], v[124:127], v[192:195], v[24:27]
    ds_read_b64 v[156:157], v98 offset:608
    v_mfma_f32_16x16x32_bf16 v[28:31], v[124:127], v[196:199], v[28:31]
    ds_read_b64 v[158:159], v98 offset:616
    v_mfma_f32_16x16x32_bf16 v[32:35], v[124:127], v[200:203], v[32:35]
    ds_read_b64 v[160:161], v98 offset:1120
    v_mfma_f32_16x16x32_bf16 v[36:39], v[124:127], v[204:207], v[36:39]
    ds_read_b64 v[162:163], v98 offset:1128
    v_mfma_f32_16x16x32_bf16 v[40:43], v[124:127], v[208:211], v[40:43]
    ds_read_b64 v[164:165], v98 offset:1632
    v_mfma_f32_16x16x32_bf16 v[20:23], v[128:131], v[184:187], v[20:23]
    ds_read_b64 v[166:167], v98 offset:1640
    v_mfma_f32_16x16x32_bf16 v[24:27], v[128:131], v[188:191], v[24:27]
    ds_read_b64 v[168:169], v98 offset:2144
    v_mfma_f32_16x16x32_bf16 v[28:31], v[128:131], v[192:195], v[28:31]
    ds_read_b64 v[170:171], v98 offset:2152
    v_mfma_f32_16x16x32_bf16 v[32:35], v[128:131], v[196:199], v[32:35]
    ds_read_b64 v[172:173], v98 offset:2656
    v_mfma_f32_16x16x32_bf16 v[36:39], v[128:131], v[200:203], v[36:39]
    ds_read_b64 v[174:175], v98 offset:2664
    v_mfma_f32_16x16x32_bf16 v[40:43], v[128:131], v[204:207], v[40:43]
    ds_read_b64 v[176:177], v98 offset:3168
    v_mfma_f32_16x16x32_bf16 v[24:27], v[132:135], v[184:187], v[24:27]
    ds_read_b64 v[178:179], v98 offset:3176
    v_mfma_f32_16x16x32_bf16 v[28:31], v[132:135], v[188:191], v[28:31]
    ds_read_b64 v[180:181], v98 offset:3680
    v_mfma_f32_16x16x32_bf16 v[32:35], v[132:135], v[192:195], v[32:35]
    ds_read_b64 v[182:183], v98 offset:3688
    v_mfma_f32_16x16x32_bf16 v[36:39], v[132:135], v[196:199], v[36:39]
    v_mfma_f32_16x16x32_bf16 v[40:43], v[132:135], v[200:203], v[40:43]
    v_mfma_f32_16x16x32_bf16 v[28:31], v[136:139], v[184:187], v[28:31]
    v_mfma_f32_16x16x32_bf16 v[32:35], v[136:139], v[188:191], v[32:35]
    v_mfma_f32_16x16x32_bf16 v[36:39], v[136:139], v[192:195], v[36:39]
    v_mfma_f32_16x16x32_bf16 v[40:43], v[136:139], v[196:199], v[40:43]
    v_mfma_f32_16x16x32_bf16 v[32:35], v[140:143], v[184:187], v[32:35]
    v_mfma_f32_16x16x32_bf16 v[36:39], v[140:143], v[188:191], v[36:39]
    v_mfma_f32_16x16x32_bf16 v[40:43], v[140:143], v[192:195], v[40:43]
    v_mfma_f32_16x16x32_bf16 v[36:39], v[144:147], v[184:187], v[36:39]
    v_mfma_f32_16x16x32_bf16 v[40:43], v[144:147], v[188:191], v[40:43]
    v_mfma_f32_16x16x32_bf16 v[40:43], v[148:151], v[184:187], v[40:43]
    s_waitcnt lgkmcnt(0)
    v_mfma_f32_16x16x32_bf16 v[12:15], v[152:155], v[216:219], v[12:15]
    ds_read_b128 v[184:187], v99 offset:20352
    v_mfma_f32_16x16x32_bf16 v[16:19], v[152:155], v[220:223], v[16:19]
    ds_read_b128 v[188:191], v99 offset:19840
    v_mfma_f32_16x16x32_bf16 v[20:23], v[152:155], v[224:227], v[20:23]
    ds_read_b128 v[192:195], v99 offset:19328
    v_mfma_f32_16x16x32_bf16 v[24:27], v[152:155], v[228:231], v[24:27]
    ds_read_b128 v[196:199], v99 offset:18816
    v_mfma_f32_16x16x32_bf16 v[28:31], v[152:155], v[232:235], v[28:31]
    ds_read_b128 v[200:203], v99 offset:18304
    v_mfma_f32_16x16x32_bf16 v[32:35], v[152:155], v[236:239], v[32:35]
    ds_read_b128 v[204:207], v99 offset:17792
    v_mfma_f32_16x16x32_bf16 v[36:39], v[152:155], v[240:243], v[36:39]
    ds_read_b128 v[208:211], v99 offset:17280
    v_mfma_f32_16x16x32_bf16 v[40:43], v[152:155], v[244:247], v[40:43]
    ds_read_b128 v[212:215], v99 offset:16768
    v_mfma_f32_16x16x32_bf16 v[16:19], v[156:159], v[216:219], v[16:19]
    ds_read_b64 v[120:121], v98 offset:160
    v_mfma_f32_16x16x32_bf16 v[20:23], v[156:159], v[220:223], v[20:23]
    ds_read_b64 v[122:123], v98 offset:168
    v_mfma_f32_16x16x32_bf16 v[24:27], v[156:159], v[224:227], v[24:27]
    ds_read_b64 v[124:125], v98 offset:672
    v_mfma_f32_16x16x32_bf16 v[28:31], v[156:159], v[228:231], v[28:31]
    ds_read_b64 v[126:127], v98 offset:680
    v_mfma_f32_16x16x32_bf16 v[32:35], v[156:159], v[232:235], v[32:35]
    ds_read_b64 v[128:129], v98 offset:1184
    v_mfma_f32_16x16x32_bf16 v[36:39], v[156:159], v[236:239], v[36:39]
    ds_read_b64 v[130:131], v98 offset:1192
    v_mfma_f32_16x16x32_bf16 v[40:43], v[156:159], v[240:243], v[40:43]
    ds_read_b64 v[132:133], v98 offset:1696
    v_mfma_f32_16x16x32_bf16 v[20:23], v[160:163], v[216:219], v[20:23]
    ds_read_b64 v[134:135], v98 offset:1704
    v_mfma_f32_16x16x32_bf16 v[24:27], v[160:163], v[220:223], v[24:27]
    ds_read_b64 v[136:137], v98 offset:2208
    v_mfma_f32_16x16x32_bf16 v[28:31], v[160:163], v[224:227], v[28:31]
    ds_read_b64 v[138:139], v98 offset:2216
    v_mfma_f32_16x16x32_bf16 v[32:35], v[160:163], v[228:231], v[32:35]
    ds_read_b64 v[140:141], v98 offset:2720
    v_mfma_f32_16x16x32_bf16 v[36:39], v[160:163], v[232:235], v[36:39]
    ds_read_b64 v[142:143], v98 offset:2728
    v_mfma_f32_16x16x32_bf16 v[40:43], v[160:163], v[236:239], v[40:43]
    ds_read_b64 v[144:145], v98 offset:3232
    v_mfma_f32_16x16x32_bf16 v[24:27], v[164:167], v[216:219], v[24:27]
    ds_read_b64 v[146:147], v98 offset:3240
    v_mfma_f32_16x16x32_bf16 v[28:31], v[164:167], v[220:223], v[28:31]
    ds_read_b64 v[148:149], v98 offset:3744
    v_mfma_f32_16x16x32_bf16 v[32:35], v[164:167], v[224:227], v[32:35]
    ds_read_b64 v[150:151], v98 offset:3752
    v_mfma_f32_16x16x32_bf16 v[36:39], v[164:167], v[228:231], v[36:39]
    v_add_u32 v98, 128, v98
    v_mfma_f32_16x16x32_bf16 v[40:43], v[164:167], v[232:235], v[40:43]
    v_add_u32 v99, 128, v99
    v_mfma_f32_16x16x32_bf16 v[28:31], v[168:171], v[216:219], v[28:31]
    s_add_u32 s43, s43, 1
    v_mfma_f32_16x16x32_bf16 v[32:35], v[168:171], v[220:223], v[32:35]
    s_cmp_lt_u32 s43, 4
    v_mfma_f32_16x16x32_bf16 v[36:39], v[168:171], v[224:227], v[36:39]
    v_mfma_f32_16x16x32_bf16 v[40:43], v[168:171], v[228:231], v[40:43]
    v_mfma_f32_16x16x32_bf16 v[32:35], v[172:175], v[216:219], v[32:35]
    v_mfma_f32_16x16x32_bf16 v[36:39], v[172:175], v[220:223], v[36:39]
    v_mfma_f32_16x16x32_bf16 v[40:43], v[172:175], v[224:227], v[40:43]
    v_mfma_f32_16x16x32_bf16 v[36:39], v[176:179], v[216:219], v[36:39]
    v_mfma_f32_16x16x32_bf16 v[40:43], v[176:179], v[220:223], v[40:43]
    v_mfma_f32_16x16x32_bf16 v[40:43], v[180:183], v[216:219], v[40:43]
    s_cbranch_scc1 CV_l
    s_bitcmp1_b32 s30, 0
    s_waitcnt lgkmcnt(0)
    s_cbranch_scc1 CV_o
    v_perm_b32 v12, v14, v12, s45
    v_perm_b32 v13, v15, v13, s45
    v_or_b32 v12, 0x10001, v12
    v_or_b32 v13, 0x10001, v13
    ds_write2_b32 v108, v12, v13 offset0:0 offset1:8
    v_perm_b32 v16, v18, v16, s45
    v_perm_b32 v17, v19, v17, s45
    v_or_b32 v16, 0x10001, v16
    v_or_b32 v17, 0x10001, v17
    ds_write2_b32 v108, v16, v17 offset0:144 offset1:152
    v_perm_b32 v20, v22, v20, s45
    v_perm_b32 v21, v23, v21, s45
    v_or_b32 v20, 0x10001, v20
    v_or_b32 v21, 0x10001, v21
    ds_write2_b32 v109, v20, v21 offset0:0 offset1:8
    v_perm_b32 v24, v26, v24, s45
    v_perm_b32 v25, v27, v25, s45
    v_or_b32 v24, 0x10001, v24
    v_or_b32 v25, 0x10001, v25
    ds_write2_b32 v109, v24, v25 offset0:144 offset1:152
    v_perm_b32 v28, v30, v28, s45
    v_perm_b32 v29, v31, v29, s45
    v_or_b32 v28, 0x10001, v28
    v_or_b32 v29, 0x10001, v29
    ds_write2_b32 v110, v28, v29 offset0:0 offset1:8
    v_perm_b32 v32, v34, v32, s45
    v_perm_b32 v33, v35, v33, s45
    v_or_b32 v32, 0x10001, v32
    v_or_b32 v33, 0x10001, v33
    ds_write2_b32 v110, v32, v33 offset0:144 offset1:152
    v_perm_b32 v36, v38, v36, s45
    v_perm_b32 v37, v39, v37, s45
    v_or_b32 v36, 0x10001, v36
    v_or_b32 v37, 0x10001, v37
    ds_write2_b32 v111, v36, v37 offset0:0 offset1:8
    v_perm_b32 v40, v42, v40, s45
    v_perm_b32 v41, v43, v41, s45
    v_or_b32 v40, 0x10001, v40
    v_or_b32 v41, 0x10001, v41
    ds_write2_b32 v111, v40, v41 offset0:144 offset1:152
    s_branch CV_e
CV_o:
    v_cvt_pk_bf16_f32 v12, v12, v14
    v_cvt_pk_bf16_f32 v13, v13, v15
    ds_write2_b32 v108, v12, v13 offset0:0 offset1:8
    v_cvt_pk_bf16_f32 v16, v16, v18
    v_cvt_pk_bf16_f32 v17, v17, v19
    ds_write2_b32 v108, v16, v17 offset0:144 offset1:152
    v_cvt_pk_bf16_f32 v20, v20, v22
    v_cvt_pk_bf16_f32 v21, v21, v23
    ds_write2_b32 v109, v20, v21 offset0:0 offset1:8
    v_cvt_pk_bf16_f32 v24, v24, v26
    v_cvt_pk_bf16_f32 v25, v25, v27
    ds_write2_b32 v109, v24, v25 offset0:144 offset1:152
    v_cvt_pk_bf16_f32 v28, v28, v30
    v_cvt_pk_bf16_f32 v29, v29, v31
    ds_write2_b32 v110, v28, v29 offset0:0 offset1:8
    v_cvt_pk_bf16_f32 v32, v32, v34
    v_cvt_pk_bf16_f32 v33, v33, v35
    ds_write2_b32 v110, v32, v33 offset0:144 offset1:152
    v_cvt_pk_bf16_f32 v36, v36, v38
    v_cvt_pk_bf16_f32 v37, v37, v39
    ds_write2_b32 v111, v36, v37 offset0:0 offset1:8
    v_cvt_pk_bf16_f32 v40, v40, v42
    v_cvt_pk_bf16_f32 v41, v41, v43
    ds_write2_b32 v111, v40, v41 offset0:144 offset1:152
CV_e:
    v_mov_b32 v8, 162824
    v_mov_b32 v9, 1
    s_waitcnt lgkmcnt(0)
    s_mov_b64 exec, 1
    ds_add_u32 v8, v9
    s_mov_b64 exec, -1
    v_mov_b32 v8, 162824
spin_3:
    ds_read_b32 v9, v8
    s_waitcnt lgkmcnt(0)
    v_readfirstlane_b32 s53, v9
    s_nop 0
    s_cmp_ge_u32 s53, 8
    s_cbranch_scc0 spin_3
    ds_read_b64_tr_b16 v[120:121], v103 offset:0
    ds_read_b64_tr_b16 v[122:123], v103 offset:32
    ds_read_b64_tr_b16 v[124:125], v103 offset:288
    ds_read_b64_tr_b16 v[126:127], v103 offset:320
    ds_read_b64_tr_b16 v[128:129], v103 offset:576
    ds_read_b64_tr_b16 v[130:131], v103 offset:608
    ds_read_b64_tr_b16 v[132:133], v103 offset:864
    ds_read_b64_tr_b16 v[134:135], v103 offset:896
    s_waitcnt lgkmcnt(6)
    buffer_store_dwordx4 v[120:123], v2, s[20:23], s44 offen offset:0 sc1
    s_waitcnt lgkmcnt(4)
    buffer_store_dwordx4 v[124:127], v2, s[20:23], s44 offen offset:1024 sc1
    s_waitcnt lgkmcnt(2)
    buffer_store_dwordx4 v[128:131], v2, s[20:23], s44 offen offset:2048 sc1
    s_waitcnt lgkmcnt(0)
    buffer_store_dwordx4 v[132:135], v2, s[20:23], s44 offen offset:3072 sc1
    s_waitcnt vmcnt(4)
    s_branch FR_end
FR_b:
    v_lshrrev_b32 v10, 2, v1
    v_lshlrev_b32 v74, 7, v10
    v_bfe_u32 v10, v10, 1, 2
    s_and_b32 s35, s30, 2
    v_and_b32 v11, 1, v1
    v_or_b32 v11, s35, v11
    v_xor_b32 v10, v10, v11
    v_lshl_add_u32 v74, v10, 5, v74
    v_and_b32 v10, 2, v1
    v_lshl_add_u32 v74, v10, 2, v74
    s_and_b32 s35, s30, 1
    s_lshl_b32 s35, s35, 4
    v_add_u32 v74, s35, v74
    v_add_u32 v75, 65536, v74
    v_add_u32 v76, 131072, v74
    s_and_b32 s36, s30, 3
    s_lshl_b32 s36, s36, 14
    s_lshl_b32 s48, s29, 7
    s_add_u32 s48, s48, s36
    s_cmp_lg_u32 s30, 5
    s_cbranch_scc1 FB_np
    s_waitcnt vmcnt(8)
    s_lshl_b32 s42, s2, 14
    s_add_u32 s42, s42, 29360128
    s_memtime s[34:35]
    s_waitcnt lgkmcnt(0)
    s_load_dword s32, s[4:5], s42 offset:0 glc
    s_waitcnt lgkmcnt(0)
    s_memtime s[40:41]
    s_waitcnt lgkmcnt(0)
    s_sub_u32 s46, s40, s34
    s_memtime s[34:35]
    s_waitcnt lgkmcnt(0)
    s_load_dword s32, s[4:5], s42 offset:8192 glc
    s_waitcnt lgkmcnt(0)
    s_memtime s[40:41]
    s_waitcnt lgkmcnt(0)
    s_sub_u32 s47, s40, s34
    s_cmp_lt_u32 s47, s46
    s_cselect_b32 s45, 1, 0
    s_lshr_b32 s46, s28, 2
    s_xor_b32 s45, s45, s46
    s_lshr_b32 s46, s2, 7
    s_xor_b32 s45, s45, s46
    s_and_b32 s45, s45, 1
    s_lshl_b32 s45, s45, 1
FB_np:
    s_lshr_b32 s53, s28, 3
    s_lshl_b32 s53, s53, 2
    s_and_b32 s54, s28, 3
    s_add_u32 s53, s53, s54
    s_lshl_b32 s53, s53, 23
    s_lshr_b32 s54, s28, 2
    s_xor_b32 s54, s54, s94
    s_and_b32 s54, s54, 1
    s_lshl_b32 s54, s54, 13
    s_add_u32 s37, s53, s54
    s_add_u32 s37, s37, 33554432
    s_andn2_b32 s37, s37, 0x2000
    s_lshl_b32 s43, s29, 7
    s_add_u32 s37, s37, s43
    s_add_u32 s37, s37, 1835008
    s_add_u32 s43, s43, 23068672
    v_mov_b32 v102, s52
    v_and_b32 v103, 1, v1
    v_lshlrev_b32 v103, 13, v103
    v_bfe_u32 v104, v1, 1, 1
    v_lshl_add_u32 v103, v104, 26, v103
    v_lshrrev_b32 v104, 2, v1
    v_lshl_add_u32 v103, v104, 11, v103
    s_waitcnt vmcnt(0) lgkmcnt(0)
    s_barrier
    ds_read_b64_tr_b16 v[132:133], v75 offset:24576
    ds_read_b64_tr_b16 v[134:135], v75 offset:26624
    ds_read_b64_tr_b16 v[140:141], v75 offset:28672
    ds_read_b64_tr_b16 v[142:143], v75 offset:30720
    ds_read_b64_tr_b16 v[148:149], v75 offset:32768
    ds_read_b64_tr_b16 v[150:151], v75 offset:34816
    ds_read_b64_tr_b16 v[156:157], v75 offset:36864
    ds_read_b64_tr_b16 v[158:159], v75 offset:38912
    ds_read_b64_tr_b16 v[164:165], v75 offset:40960
    ds_read_b64_tr_b16 v[166:167], v75 offset:43008
    ds_read_b64_tr_b16 v[172:173], v75 offset:45056
    ds_read_b64_tr_b16 v[174:175], v75 offset:47104
    ds_read_b64_tr_b16 v[180:181], v75 offset:49152
    ds_read_b64_tr_b16 v[182:183], v75 offset:51200
    ds_read_b64_tr_b16 v[188:189], v75 offset:53248
    ds_read_b64_tr_b16 v[190:191], v75 offset:55296
    ds_read_b64_tr_b16 v[196:197], v75 offset:57344
    ds_read_b64_tr_b16 v[198:199], v75 offset:59392
    ds_read_b64_tr_b16 v[204:205], v75 offset:61440
    ds_read_b64_tr_b16 v[206:207], v75 offset:63488
    ds_read_b64_tr_b16 v[212:213], v76 offset:0
    ds_read_b64_tr_b16 v[214:215], v76 offset:2048
    ds_read_b64_tr_b16 v[220:221], v76 offset:4096
    ds_read_b64_tr_b16 v[222:223], v76 offset:6144
    ds_read_b64_tr_b16 v[228:229], v76 offset:8192
    ds_read_b64_tr_b16 v[230:231], v76 offset:10240
    ds_read_b64_tr_b16 v[236:237], v76 offset:12288
    ds_read_b64_tr_b16 v[238:239], v76 offset:14336
    ds_read_b64_tr_b16 v[244:245], v76 offset:16384
    ds_read_b64_tr_b16 v[246:247], v76 offset:18432
    ds_read_b64_tr_b16 v[252:253], v76 offset:20480
    ds_read_b64_tr_b16 v[254:255], v76 offset:22528
    s_waitcnt lgkmcnt(0)
    s_barrier
    s_cmp_lg_u32 s30, 5
    s_cbranch_scc1 FB_na
    s_lshl_b32 s36, s2, 7
    s_add_u32 s36, s36, 23592960
    s_add_u32 s45, s45, s52
    v_mov_b32 v8, s45
    s_mov_b64 exec, 1
    buffer_store_dword v8, v2, s[56:59], s36 offen sc1
    s_mov_b64 exec, -1
FB_na:
    buffer_load_dwordx4 v[12:15], v2, s[80:83], s50 offen
    s_sub_u32 s50, s50, 4096
    buffer_load_dwordx4 v[12:15], v2, s[80:83], s50 offen
    s_sub_u32 s50, s50, 4096
    buffer_load_dwordx2 v[86:87], v80, s[8:11], 0 offen offset:0 nt
    buffer_load_dwordx2 v[88:89], v80, s[8:11], 0 offen offset:32 nt
    buffer_load_dwordx2 v[90:91], v80, s[8:11], 0 offen offset:128 nt
    buffer_load_dwordx2 v[92:93], v80, s[8:11], 0 offen offset:160 nt
    s_setprio 0
    s_cmp_lg_u32 s30, 4
    s_cbranch_scc1 FB_ni
    s_mov_b64 exec, 0xfff
    buffer_store_dword v102, v103, s[56:59], s37 offen sc1
    s_cmp_lg_u32 s28, 0
    s_cbranch_scc1 FB_n2
    s_mov_b64 exec, 3
    buffer_store_dword v102, v103, s[56:59], s43 offen sc1
FB_n2:
    s_mov_b64 exec, -1
FB_ni:
    s_add_u32 s36, s48, 0
    buffer_load_dwordx4 v[128:131], v118, s[88:91], s36 offen
    s_add_u32 s36, s36, 65536
    buffer_load_dwordx4 v[136:139], v118, s[88:91], s36 offen
    s_add_u32 s36, s48, 131072
    buffer_load_dwordx4 v[144:147], v118, s[88:91], s36 offen
    s_add_u32 s36, s36, 65536
    buffer_load_dwordx4 v[152:155], v118, s[88:91], s36 offen
    s_and_b32 s49, s30, 3
    s_lshl_b32 s36, s49, 14
    s_lshl_b32 s48, s29, 7
    s_add_u32 s48, s48, s36
    s_lshl_b32 s49, s49, 10
    s_xor_b32 s48, s48, 128
    s_add_u32 s36, s48, 1441792
    s_add_u32 m0, s49, 114688
    s_nop 0
    buffer_load_dwordx4 v118, s[80:83], s36 offen lds
    s_add_u32 s36, s36, 65536
    s_add_u32 m0, s49, 118784
    s_nop 0
    buffer_load_dwordx4 v118, s[80:83], s36 offen lds
    s_add_u32 s36, s48, 1572864
    s_add_u32 m0, s49, 122880
    s_nop 0
    buffer_load_dwordx4 v118, s[80:83], s36 offen lds
    s_add_u32 s36, s36, 65536
    s_add_u32 m0, s49, 126976
    s_nop 0
    buffer_load_dwordx4 v118, s[80:83], s36 offen lds
    s_add_u32 s36, s48, 1966080
    s_add_u32 m0, s49, 147456
    s_nop 0
    buffer_load_dwordx4 v118, s[80:83], s36 offen lds
    s_add_u32 s36, s36, 65536
    s_add_u32 m0, s49, 151552
    s_nop 0
    buffer_load_dwordx4 v118, s[80:83], s36 offen lds
    s_add_u32 s36, s48, 1703936
    s_add_u32 m0, s49, 131072
    s_nop 0
    buffer_load_dwordx4 v118, s[80:83], s36 offen lds
    s_add_u32 s36, s36, 65536
    s_add_u32 m0, s49, 135168
    s_nop 0
    buffer_load_dwordx4 v118, s[80:83], s36 offen lds
    s_add_u32 s36, s48, 1835008
    s_add_u32 m0, s49, 139264
    s_nop 0
    buffer_load_dwordx4 v118, s[80:83], s36 offen lds
    s_add_u32 s36, s36, 65536
    s_add_u32 m0, s49, 143360
    s_nop 0
    buffer_load_dwordx4 v118, s[80:83], s36 offen lds
    s_waitcnt vmcnt(14)
    v_mov_b32 v6, 162824
    v_mov_b32 v7, 1
    s_waitcnt lgkmcnt(0)
    s_mov_b64 exec, 1
    ds_add_u32 v6, v7
    s_mov_b64 exec, -1
    s_add_u32 s36, s48, 393216
    buffer_load_dwordx4 v[28:31], v118, s[80:83], s36 offen
    s_add_u32 s36, s36, 65536
    buffer_load_dwordx4 v[32:35], v118, s[80:83], s36 offen
    s_add_u32 s36, s48, 524288
    buffer_load_dwordx4 v[36:39], v118, s[80:83], s36 offen
    s_add_u32 s36, s36, 65536
    buffer_load_dwordx4 v[40:43], v118, s[80:83], s36 offen
    s_add_u32 s36, s48, 655360
    buffer_load_dwordx4 v[52:55], v118, s[80:83], s36 offen
    s_add_u32 s36, s36, 65536
    buffer_load_dwordx4 v[56:59], v118, s[80:83], s36 offen
    s_add_u32 s36, s48, 786432
    buffer_load_dwordx4 v[60:63], v118, s[80:83], s36 offen
    s_add_u32 s36, s36, 65536
    buffer_load_dwordx4 v[64:67], v118, s[80:83], s36 offen
    s_add_u32 s36, s48, 0
    buffer_load_dwordx4 v[94:97], v118, s[80:83], s36 offen
    s_add_u32 s36, s36, 65536
    buffer_load_dwordx4 v[98:101], v118, s[80:83], s36 offen
    s_xor_b32 s48, s48, 128
    s_add_u32 s36, s48, 262144
    buffer_load_dwordx4 v[160:163], v118, s[88:91], s36 offen
    s_add_u32 s36, s36, 65536
    buffer_load_dwordx4 v[168:171], v118, s[88:91], s36 offen
    s_add_u32 s36, s48, 393216
    buffer_load_dwordx4 v[176:179], v118, s[88:91], s36 offen
    s_add_u32 s36, s36, 65536
    buffer_load_dwordx4 v[184:187], v118, s[88:91], s36 offen
    s_add_u32 s36, s48, 524288
    buffer_load_dwordx4 v[192:195], v118, s[88:91], s36 offen
    s_add_u32 s36, s36, 65536
    buffer_load_dwordx4 v[200:203], v118, s[88:91], s36 offen
    s_and_b32 s42, s30, 3
    s_lshl_b32 s42, s42, 13
    s_add_u32 s42, s42, 23592960
    v_lshlrev_b32 v8, 7, v1
    buffer_load_dword v10, v8, s[56:59], s42 offen sc1
    s_add_u32 s36, s48, 655360
    buffer_load_dwordx4 v[208:211], v118, s[88:91], s36 offen
    s_add_u32 s36, s36, 65536
    buffer_load_dwordx4 v[216:219], v118, s[88:91], s36 offen
    s_add_u32 s36, s48, 786432
    buffer_load_dwordx4 v[224:227], v118, s[88:91], s36 offen
    s_add_u32 s36, s36, 65536
    buffer_load_dwordx4 v[232:235], v118, s[88:91], s36 offen
    s_add_u32 s36, s48, 917504
    buffer_load_dwordx4 v[240:243], v118, s[88:91], s36 offen
    s_add_u32 s36, s36, 65536
    buffer_load_dwordx4 v[248:251], v118, s[88:91], s36 offen
    s_setprio 0
    s_mov_b32 s53, 0
    s_waitcnt vmcnt(6)
R_fp:
    v_and_b32 v11, -3, v10
    v_cmp_eq_u32 vcc, s52, v11
    s_nop 0
    s_cmp_eq_u64 vcc, exec
    s_cbranch_scc1 R_fq
    s_sleep 3
    buffer_load_dword v10, v8, s[56:59], s42 offen sc1
    s_waitcnt vmcnt(0)
    s_add_u32 s53, s53, 1
    s_cmp_lt_u32 s53, s61
    s_cbranch_scc1 R_fp
    s_mov_b32 s61, 0
R_fq:
    v_cmp_ne_u32 vcc, s52, v10
    s_nop 0
    s_bcnt1_i32_b64 s36, vcc
    v_mov_b32 v10, s36
    v_mov_b32 v11, 162844
    s_mov_b64 exec, 1
    ds_add_u32 v11, v10
    s_mov_b64 exec, -1
FR_end:
    v_and_b32 v81, 7, v0
    v_lshlrev_b32 v72, 6, v81
    v_add_u32 v72, 161792, v72
    s_lshl_b32 s35, s30, 3
    v_add_u32 v71, s35, v72
    v_lshlrev_b32 v12, 16, v86
    v_and_b32 v13, 0xffff0000, v86
    v_lshlrev_b32 v14, 16, v87
    v_and_b32 v15, 0xffff0000, v87
    v_lshlrev_b32 v16, 16, v88
    v_and_b32 v17, 0xffff0000, v88
    v_lshlrev_b32 v18, 16, v89
    v_and_b32 v19, 0xffff0000, v89
    v_lshlrev_b32 v20, 16, v90
    v_and_b32 v21, 0xffff0000, v90
    v_lshlrev_b32 v22, 16, v91
    v_and_b32 v23, 0xffff0000, v91
    v_lshlrev_b32 v24, 16, v92
    v_and_b32 v25, 0xffff0000, v92
    v_lshlrev_b32 v26, 16, v93
    v_and_b32 v27, 0xffff0000, v93
    v_pk_add_f32 v[48:49], v[12:13], v[14:15]
    v_pk_mul_f32 v[50:51], v[12:13], v[12:13]
    v_pk_fma_f32 v[50:51], v[14:15], v[14:15], v[50:51]
    v_pk_add_f32 v[48:49], v[48:49], v[16:17]
    v_pk_fma_f32 v[50:51], v[16:17], v[16:17], v[50:51]
    v_pk_add_f32 v[48:49], v[48:49], v[18:19]
    v_pk_fma_f32 v[50:51], v[18:19], v[18:19], v[50:51]
    v_pk_add_f32 v[48:49], v[48:49], v[20:21]
    v_pk_fma_f32 v[50:51], v[20:21], v[20:21], v[50:51]
    v_pk_add_f32 v[48:49], v[48:49], v[22:23]
    v_pk_fma_f32 v[50:51], v[22:23], v[22:23], v[50:51]
    v_pk_add_f32 v[48:49], v[48:49], v[24:25]
    v_pk_fma_f32 v[50:51], v[24:25], v[24:25], v[50:51]
    v_pk_add_f32 v[48:49], v[48:49], v[26:27]
    v_pk_fma_f32 v[50:51], v[26:27], v[26:27], v[50:51]
    v_add_f32 v46, v48, v49
    v_add_f32 v47, v50, v51
    s_nop 0
    v_add_f32_dpp v46, v46, v46 row_ror:8 row_mask:0xf bank_mask:0xf
    v_add_f32_dpp v47, v47, v47 row_ror:8 row_mask:0xf bank_mask:0xf
    v_mov_b32 v48, v46
    v_mov_b32 v49, v47
    s_nop 0
    v_permlane16_swap_b32 v46, v48
    v_permlane16_swap_b32 v47, v49
    v_pk_add_f32 v[46:47], v[46:47], v[48:49]
    v_mov_b32 v48, v46
    v_mov_b32 v49, v47
    s_nop 0
    v_permlane32_swap_b32 v46, v48
    v_permlane32_swap_b32 v47, v49
    v_pk_add_f32 v[46:47], v[46:47], v[48:49]
    ds_write_b64 v71, v[46:47] offset:0
    s_waitcnt lgkmcnt(0)
    s_barrier
LAYER:
    v_and_b32 v81, 7, v0
    v_lshlrev_b32 v72, 6, v81
    v_add_u32 v72, 161792, v72
    s_lshl_b32 s35, s30, 3
    v_add_u32 v71, s35, v72
    v_lshrrev_b32 v6, 2, v1
    v_lshlrev_b32 v74, 7, v6
    v_bfe_u32 v6, v6, 1, 2
    s_and_b32 s35, s30, 2
    v_and_b32 v7, 1, v1
    v_or_b32 v7, s35, v7
    v_xor_b32 v6, v6, v7
    v_lshl_add_u32 v74, v6, 5, v74
    v_and_b32 v6, 2, v1
    v_lshl_add_u32 v74, v6, 2, v74
    s_and_b32 s35, s30, 1
    s_lshl_b32 s35, s35, 4
    v_add_u32 v74, s35, v74
    v_add_u32 v75, 65536, v74
    v_add_u32 v76, 131072, v74
    s_cmp_eq_u32 s60, 0
    s_cbranch_scc1 R_l0
    s_sub_u32 s12, s62, 0x3b80000
    s_subb_u32 s13, s63, 0
    s_mov_b32 s14, 0x7e000
    s_mov_b32 s15, 0x20000
    buffer_load_dwordx4 v[86:89], v78, s[12:15], 0 offen offset:0 sc1
    buffer_load_dwordx4 v[90:93], v78, s[12:15], 0 offen offset:2048 sc1
    s_waitcnt vmcnt(2)
    v_lshlrev_b32 v102, 16, v110
    v_and_b32 v103, 0xffff0000, v110
    v_lshlrev_b32 v104, 16, v111
    v_and_b32 v105, 0xffff0000, v111
    v_lshlrev_b32 v106, 16, v112
    v_and_b32 v107, 0xffff0000, v112
    v_lshlrev_b32 v108, 16, v113
    v_and_b32 v109, 0xffff0000, v113
    v_lshlrev_b32 v110, 16, v114
    v_and_b32 v111, 0xffff0000, v114
    v_lshlrev_b32 v112, 16, v115
    v_and_b32 v113, 0xffff0000, v115
    v_lshlrev_b32 v114, 16, v116
    v_and_b32 v115, 0xffff0000, v116
    v_lshlrev_b32 v116, 16, v117
    v_and_b32 v117, 0xffff0000, v117
    s_mov_b32 s53, 0
dw_4:
    s_waitcnt vmcnt(0)
    v_and_b32 v6, v86, v87
    v_and_b32 v7, v90, v91
    v_bitop3_b32 v6, v88, v89, v6 bitop3:0x80
    v_bitop3_b32 v7, v92, v93, v7 bitop3:0x80
    v_bitop3_b32 v6, v6, v7, 1 bitop3:0x80
    v_cmp_eq_u32 vcc, 0, v6
    s_nop 0
    s_cmp_eq_u64 vcc, 0
    s_cbranch_scc1 dok_5
    s_mov_b64 exec, vcc
    s_sleep 2
    buffer_load_dwordx4 v[86:89], v78, s[12:15], 0 offen offset:0 sc1
    buffer_load_dwordx4 v[90:93], v78, s[12:15], 0 offen offset:2048 sc1
    s_add_u32 s53, s53, 1
    s_cmp_lt_u32 s53, s61
    s_cbranch_scc1 dw_4
    s_mov_b32 s61, 0
    s_waitcnt vmcnt(0)
dok_5:
    s_mov_b64 exec, -1
    v_lshlrev_b32 v12, 16, v86
    v_and_b32 v13, 0xffff0000, v86
    v_lshlrev_b32 v14, 16, v87
    v_and_b32 v15, 0xffff0000, v87
    v_lshlrev_b32 v16, 16, v88
    v_and_b32 v17, 0xffff0000, v88
    v_lshlrev_b32 v18, 16, v89
    v_and_b32 v19, 0xffff0000, v89
    v_lshlrev_b32 v20, 16, v90
    v_and_b32 v21, 0xffff0000, v90
    v_lshlrev_b32 v22, 16, v91
    v_and_b32 v23, 0xffff0000, v91
    v_lshlrev_b32 v24, 16, v92
    v_and_b32 v25, 0xffff0000, v92
    v_lshlrev_b32 v26, 16, v93
    v_and_b32 v27, 0xffff0000, v93
    v_pk_add_f32 v[48:49], v[12:13], v[14:15]
    v_pk_mul_f32 v[50:51], v[12:13], v[12:13]
    v_pk_fma_f32 v[50:51], v[14:15], v[14:15], v[50:51]
    v_pk_add_f32 v[48:49], v[48:49], v[16:17]
    v_pk_fma_f32 v[50:51], v[16:17], v[16:17], v[50:51]
    v_pk_add_f32 v[48:49], v[48:49], v[18:19]
    v_pk_fma_f32 v[50:51], v[18:19], v[18:19], v[50:51]
    v_pk_add_f32 v[48:49], v[48:49], v[20:21]
    v_pk_fma_f32 v[50:51], v[20:21], v[20:21], v[50:51]
    v_pk_add_f32 v[48:49], v[48:49], v[22:23]
    v_pk_fma_f32 v[50:51], v[22:23], v[22:23], v[50:51]
    v_pk_add_f32 v[48:49], v[48:49], v[24:25]
    v_pk_fma_f32 v[50:51], v[24:25], v[24:25], v[50:51]
    v_pk_add_f32 v[48:49], v[48:49], v[26:27]
    v_pk_fma_f32 v[50:51], v[26:27], v[26:27], v[50:51]
    v_add_f32 v46, v48, v49
    v_add_f32 v47, v50, v51
    s_nop 0
    v_add_f32_dpp v46, v46, v46 row_ror:8 row_mask:0xf bank_mask:0xf
    v_add_f32_dpp v47, v47, v47 row_ror:8 row_mask:0xf bank_mask:0xf
    v_mov_b32 v48, v46
    v_mov_b32 v49, v47
    s_nop 0
    v_permlane16_swap_b32 v46, v48
    v_permlane16_swap_b32 v47, v49
    v_pk_add_f32 v[46:47], v[46:47], v[48:49]
    v_mov_b32 v48, v46
    v_mov_b32 v49, v47
    s_nop 0
    v_permlane32_swap_b32 v46, v48
    v_permlane32_swap_b32 v47, v49
    v_pk_add_f32 v[46:47], v[46:47], v[48:49]
    ds_write_b64 v71, v[46:47] offset:0
    s_lshl_b32 s22, s60, 24
    s_lshl_b32 s23, s94, 13
    s_add_u32 s22, s22, s23
    s_add_u32 s22, s22, 167772160
    s_add_u32 s20, s4, s22
    s_addc_u32 s21, s5, 0
    s_mov_b32 s22, 8380416
    s_mov_b32 s23, 0x20000
    s_waitcnt lgkmcnt(0)
    s_barrier
    ds_read_b128 v[52:55], v72 offset:0
    ds_read_b128 v[56:59], v72 offset:16
    ds_read_b128 v[60:63], v72 offset:32
    ds_read_b128 v[64:67], v72 offset:48
    s_waitcnt lgkmcnt(0)
    v_pk_add_f32 v[52:53], v[52:53], v[54:55]
    v_pk_add_f32 v[56:57], v[56:57], v[58:59]
    v_pk_add_f32 v[60:61], v[60:61], v[62:63]
    v_pk_add_f32 v[64:65], v[64:65], v[66:67]
    v_pk_add_f32 v[52:53], v[52:53], v[56:57]
    v_pk_add_f32 v[60:61], v[60:61], v[64:65]
    v_pk_add_f32 v[52:53], v[52:53], v[60:61]
    v_mul_f32 v68, 0x3a800000, v52
    v_mul_f32 v70, 0x3a800000, v53
    v_fma_f32 v70, -v68, v68, v70
    v_max_f32 v70, 0, v70
    v_cvt_pk_bf16_f32 v68, v68, v68
    v_lshlrev_b32 v68, 16, v68
    v_cvt_pk_bf16_f32 v70, v70, v70
    v_lshlrev_b32 v70, 16, v70
    v_add_f32 v70, 0x3727c5ac, v70
    v_cvt_pk_bf16_f32 v70, v70, v70
    v_lshlrev_b32 v70, 16, v70
    v_sqrt_f32 v70, v70
    s_nop 0
    v_cvt_pk_bf16_f32 v70, v70, v70
    v_lshlrev_b32 v70, 16, v70
    v_rcp_f32 v69, v70
    s_nop 0
    v_mul_f32 v68, -v68, v69
    v_pk_fma_f32 v[28:29], v[12:13], v[68:69], v[68:69] op_sel:[0,1,0] op_sel_hi:[1,1,0]
    v_pk_fma_f32 v[30:31], v[14:15], v[68:69], v[68:69] op_sel:[0,1,0] op_sel_hi:[1,1,0]
    v_pk_fma_f32 v[32:33], v[16:17], v[68:69], v[68:69] op_sel:[0,1,0] op_sel_hi:[1,1,0]
    v_pk_fma_f32 v[34:35], v[18:19], v[68:69], v[68:69] op_sel:[0,1,0] op_sel_hi:[1,1,0]
    v_pk_fma_f32 v[36:37], v[20:21], v[68:69], v[68:69] op_sel:[0,1,0] op_sel_hi:[1,1,0]
    v_pk_fma_f32 v[38:39], v[22:23], v[68:69], v[68:69] op_sel:[0,1,0] op_sel_hi:[1,1,0]
    v_pk_fma_f32 v[40:41], v[24:25], v[68:69], v[68:69] op_sel:[0,1,0] op_sel_hi:[1,1,0]
    v_pk_fma_f32 v[42:43], v[26:27], v[68:69], v[68:69] op_sel:[0,1,0] op_sel_hi:[1,1,0]
    s_branch R_s2
R_l0:
    s_cmp_lt_u32 s30, 4
    s_cbranch_scc1 R_f2
    s_and_b32 s36, s30, 3
    s_lshl_b32 s36, s36, 10
    v_add_u32 v8, s36, v2
    v_add_u32 v9, 65536, v8
    ds_write_b128 v8, v[28:31] offset:49152
    ds_write_b128 v8, v[32:35] offset:53248
    ds_write_b128 v8, v[36:39] offset:57344
    ds_write_b128 v8, v[40:43] offset:61440
    ds_write_b128 v9, v[52:55] offset:0
    ds_write_b128 v9, v[56:59] offset:4096
    ds_write_b128 v9, v[60:63] offset:8192
    ds_write_b128 v9, v[64:67] offset:12288
    ds_write_b128 v8, v[94:97] offset:24576
    ds_write_b128 v8, v[98:101] offset:28672
R_f2:
    v_mov_b32 v6, 162844
    ds_read_b32 v7, v6
    ds_read_b128 v[52:55], v72 offset:0
    ds_read_b128 v[56:59], v72 offset:16
    ds_read_b128 v[60:63], v72 offset:32
    ds_read_b128 v[64:67], v72 offset:48
    s_waitcnt lgkmcnt(0)
    v_pk_add_f32 v[52:53], v[52:53], v[54:55]
    v_pk_add_f32 v[56:57], v[56:57], v[58:59]
    v_pk_add_f32 v[60:61], v[60:61], v[62:63]
    v_pk_add_f32 v[64:65], v[64:65], v[66:67]
    v_pk_add_f32 v[52:53], v[52:53], v[56:57]
    v_pk_add_f32 v[60:61], v[60:61], v[64:65]
    v_pk_add_f32 v[52:53], v[52:53], v[60:61]
    v_mul_f32 v68, 0x3a800000, v52
    v_mul_f32 v70, 0x3a800000, v53
    v_fma_f32 v70, -v68, v68, v70
    v_max_f32 v70, 0, v70
    v_cvt_pk_bf16_f32 v68, v68, v68
    v_lshlrev_b32 v68, 16, v68
    v_cvt_pk_bf16_f32 v70, v70, v70
    v_lshlrev_b32 v70, 16, v70
    v_add_f32 v70, 0x3727c5ac, v70
    v_cvt_pk_bf16_f32 v70, v70, v70
    v_lshlrev_b32 v70, 16, v70
    v_sqrt_f32 v70, v70
    s_nop 0
    v_cvt_pk_bf16_f32 v70, v70, v70
    v_lshlrev_b32 v70, 16, v70
    v_rcp_f32 v69, v70
    s_nop 0
    v_mul_f32 v68, -v68, v69
    v_pk_fma_f32 v[28:29], v[12:13], v[68:69], v[68:69] op_sel:[0,1,0] op_sel_hi:[1,1,0]
    v_pk_fma_f32 v[30:31], v[14:15], v[68:69], v[68:69] op_sel:[0,1,0] op_sel_hi:[1,1,0]
    v_pk_fma_f32 v[32:33], v[16:17], v[68:69], v[68:69] op_sel:[0,1,0] op_sel_hi:[1,1,0]
    v_pk_fma_f32 v[34:35], v[18:19], v[68:69], v[68:69] op_sel:[0,1,0] op_sel_hi:[1,1,0]
    v_pk_fma_f32 v[36:37], v[20:21], v[68:69], v[68:69] op_sel:[0,1,0] op_sel_hi:[1,1,0]
    v_pk_fma_f32 v[38:39], v[22:23], v[68:69], v[68:69] op_sel:[0,1,0] op_sel_hi:[1,1,0]
    v_pk_fma_f32 v[40:41], v[24:25], v[68:69], v[68:69] op_sel:[0,1,0] op_sel_hi:[1,1,0]
    v_pk_fma_f32 v[42:43], v[26:27], v[68:69], v[68:69] op_sel:[0,1,0] op_sel_hi:[1,1,0]
    v_readfirstlane_b32 s94, v7
    s_nop 0
    s_cmp_gt_u32 s94, 127
    s_cselect_b32 s94, 1, 0
    s_lshr_b32 s53, s28, 3
    s_lshl_b32 s53, s53, 2
    s_and_b32 s54, s28, 3
    s_add_u32 s53, s53, s54
    s_lshl_b32 s53, s53, 23
    s_lshr_b32 s54, s28, 2
    s_xor_b32 s54, s54, s94
    s_and_b32 s54, s54, 1
    s_lshl_b32 s54, s54, 13
    s_add_u32 s55, s53, s54
    s_add_u32 s55, s55, 33554432
    s_add_u32 s62, s4, s55
    s_addc_u32 s63, s5, 0
    s_sub_u32 s36, s28, 1
    s_max_i32 s36, s36, 0
    s_lshr_b32 s53, s36, 3
    s_lshl_b32 s53, s53, 2
    s_and_b32 s54, s36, 3
    s_add_u32 s53, s53, s54
    s_lshl_b32 s53, s53, 23
    s_lshr_b32 s54, s36, 2
    s_xor_b32 s54, s54, s94
    s_and_b32 s54, s54, 1
    s_lshl_b32 s54, s54, 13
    s_add_u32 s92, s53, s54
    s_add_u32 s92, s92, 33554432
    s_sub_u32 s92, s92, s55
    s_add_u32 s36, s28, 1
    s_min_u32 s36, s36, 15
    s_lshr_b32 s53, s36, 3
    s_lshl_b32 s53, s53, 2
    s_and_b32 s54, s36, 3
    s_add_u32 s53, s53, s54
    s_lshl_b32 s53, s53, 23
    s_lshr_b32 s54, s36, 2
    s_xor_b32 s54, s54, s94
    s_and_b32 s54, s54, 1
    s_lshl_b32 s54, s54, 13
    s_add_u32 s93, s53, s54
    s_add_u32 s93, s93, 33554432
    s_sub_u32 s93, s93, s55
    s_add_u32 s55, s55, 1835008
    s_lshl_b32 s22, s60, 24
    s_lshl_b32 s23, s94, 13
    s_add_u32 s22, s22, s23
    s_add_u32 s22, s22, 167772160
    s_add_u32 s20, s4, s22
    s_addc_u32 s21, s5, 0
    s_mov_b32 s22, 8380416
    s_mov_b32 s23, 0x20000
    s_add_u32 s80, s4, 0x1800000
    s_addc_u32 s81, s5, 0
    s_mov_b32 s82, 0x400000
    s_mov_b32 s83, 0x20000
    s_mov_b32 s78, 0
    buffer_load_dwordx2 v[110:111], v79, s[80:83], s78 offen sc1
    s_mov_b32 s78, 65536
    buffer_load_dwordx2 v[112:113], v79, s[80:83], s78 offen sc1
    s_mov_b32 s78, 262144
    buffer_load_dwordx2 v[114:115], v79, s[80:83], s78 offen sc1
    s_mov_b32 s78, 327680
    buffer_load_dwordx2 v[116:117], v79, s[80:83], s78 offen sc1
    s_cmp_lt_u32 s30, 4
    s_cbranch_scc1 R_f3
    s_waitcnt vmcnt(4)
    s_and_b32 s36, s30, 3
    s_lshl_b32 s36, s36, 10
    v_add_u32 v8, s36, v2
    v_add_u32 v9, 65536, v8
    ds_write_b128 v8, v[128:131] offset:0
    ds_write_b128 v8, v[136:139] offset:4096
    ds_write_b128 v8, v[144:147] offset:8192
    ds_write_b128 v8, v[152:155] offset:12288
    ds_write_b128 v8, v[160:163] offset:16384
    ds_write_b128 v8, v[168:171] offset:20480
    ds_write_b128 v9, v[176:179] offset:16384
    ds_write_b128 v9, v[184:187] offset:20480
    ds_write_b128 v9, v[192:195] offset:24576
    ds_write_b128 v9, v[200:203] offset:28672
    ds_write_b128 v8, v[208:211] offset:32768
    ds_write_b128 v8, v[216:219] offset:36864
    ds_write_b128 v8, v[224:227] offset:40960
    ds_write_b128 v8, v[232:235] offset:45056
    ds_write_b128 v9, v[240:243] offset:32768
    ds_write_b128 v9, v[248:251] offset:36864
R_f3:
    s_mov_b32 s53, 0
dw_6:
    s_waitcnt vmcnt(0)
    v_and_b32 v6, v110, v111
    v_and_b32 v7, v114, v115
    v_bitop3_b32 v6, v112, v113, v6 bitop3:0x80
    v_bitop3_b32 v7, v116, v117, v7 bitop3:0x80
    v_bitop3_b32 v6, v6, v7, 1 bitop3:0x80
    v_cmp_eq_u32 vcc, 0, v6
    s_nop 0
    s_cmp_eq_u64 vcc, 0
    s_cbranch_scc1 dok_7
    s_mov_b64 exec, vcc
    s_sleep 4
    s_mov_b32 s78, 0
    buffer_load_dwordx2 v[110:111], v79, s[80:83], s78 offen sc1
    s_mov_b32 s78, 65536
    buffer_load_dwordx2 v[112:113], v79, s[80:83], s78 offen sc1
    s_mov_b32 s78, 262144
    buffer_load_dwordx2 v[114:115], v79, s[80:83], s78 offen sc1
    s_mov_b32 s78, 327680
    buffer_load_dwordx2 v[116:117], v79, s[80:83], s78 offen sc1
    s_add_u32 s53, s53, 1
    s_cmp_lt_u32 s53, s61
    s_cbranch_scc1 dw_6
    s_mov_b32 s61, 0
    s_waitcnt vmcnt(0)
dok_7:
    s_mov_b64 exec, -1
    v_lshlrev_b32 v102, 16, v110
    v_and_b32 v103, 0xffff0000, v110
    v_lshlrev_b32 v104, 16, v111
    v_and_b32 v105, 0xffff0000, v111
    v_lshlrev_b32 v106, 16, v112
    v_and_b32 v107, 0xffff0000, v112
    v_lshlrev_b32 v108, 16, v113
    v_and_b32 v109, 0xffff0000, v113
    v_lshlrev_b32 v110, 16, v114
    v_and_b32 v111, 0xffff0000, v114
    v_lshlrev_b32 v112, 16, v115
    v_and_b32 v113, 0xffff0000, v115
    v_lshlrev_b32 v114, 16, v116
    v_and_b32 v115, 0xffff0000, v116
    v_lshlrev_b32 v116, 16, v117
    v_and_b32 v117, 0xffff0000, v117
R_s2:
    v_pk_fma_f32 v[12:13], v[28:29], v[102:103], v[12:13]
    v_pk_fma_f32 v[14:15], v[30:31], v[104:105], v[14:15]
    v_pk_fma_f32 v[16:17], v[32:33], v[106:107], v[16:17]
    v_pk_fma_f32 v[18:19], v[34:35], v[108:109], v[18:19]
    v_cvt_pk_bf16_f32 v86, v12, v13
    v_cvt_pk_bf16_f32 v87, v14, v15
    v_cvt_pk_bf16_f32 v88, v16, v17
    v_cvt_pk_bf16_f32 v89, v18, v19
    buffer_store_dwordx4 v[86:89], v82, s[20:23], 0 offen offset:0 sc1
    v_pk_fma_f32 v[20:21], v[36:37], v[110:111], v[20:21]
    v_pk_fma_f32 v[22:23], v[38:39], v[112:113], v[22:23]
    v_pk_fma_f32 v[24:25], v[40:41], v[114:115], v[24:25]
    v_pk_fma_f32 v[26:27], v[42:43], v[116:117], v[26:27]
    v_cvt_pk_bf16_f32 v90, v20, v21
    v_cvt_pk_bf16_f32 v91, v22, v23
    v_cvt_pk_bf16_f32 v92, v24, v25
    v_cvt_pk_bf16_f32 v93, v26, v27
    buffer_store_dwordx4 v[90:93], v82, s[20:23], 0 offen offset:128 sc1
    v_pk_add_f32 v[48:49], v[12:13], v[14:15]
    v_pk_mul_f32 v[50:51], v[12:13], v[12:13]
    v_pk_fma_f32 v[50:51], v[14:15], v[14:15], v[50:51]
    v_pk_add_f32 v[48:49], v[48:49], v[16:17]
    v_pk_fma_f32 v[50:51], v[16:17], v[16:17], v[50:51]
    v_pk_add_f32 v[48:49], v[48:49], v[18:19]
    v_pk_fma_f32 v[50:51], v[18:19], v[18:19], v[50:51]
    v_pk_add_f32 v[48:49], v[48:49], v[20:21]
    v_pk_fma_f32 v[50:51], v[20:21], v[20:21], v[50:51]
    v_pk_add_f32 v[48:49], v[48:49], v[22:23]
    v_pk_fma_f32 v[50:51], v[22:23], v[22:23], v[50:51]
    v_pk_add_f32 v[48:49], v[48:49], v[24:25]
    v_pk_fma_f32 v[50:51], v[24:25], v[24:25], v[50:51]
    v_pk_add_f32 v[48:49], v[48:49], v[26:27]
    v_pk_fma_f32 v[50:51], v[26:27], v[26:27], v[50:51]
    v_add_f32 v46, v48, v49
    v_add_f32 v47, v50, v51
    s_nop 0
    v_add_f32_dpp v46, v46, v46 row_ror:8 row_mask:0xf bank_mask:0xf
    v_add_f32_dpp v47, v47, v47 row_ror:8 row_mask:0xf bank_mask:0xf
    v_mov_b32 v48, v46
    v_mov_b32 v49, v47
    s_nop 0
    v_permlane16_swap_b32 v46, v48
    v_permlane16_swap_b32 v47, v49
    v_pk_add_f32 v[46:47], v[46:47], v[48:49]
    v_mov_b32 v48, v46
    v_mov_b32 v49, v47
    s_nop 0
    v_permlane32_swap_b32 v46, v48
    v_permlane32_swap_b32 v47, v49
    v_pk_add_f32 v[46:47], v[46:47], v[48:49]
    ds_write_b64 v71, v[46:47] offset:1536
    s_waitcnt lgkmcnt(0)
    s_barrier
    s_cmp_ge_u32 s30, 4
    s_cbranch_scc1 LOADERS
    s_cmp_lg_u32 s30, 3
    s_cbranch_scc1 R_nl
    ds_read_b128 v[52:55], v72 offset:1536
    ds_read_b128 v[56:59], v72 offset:1552
    ds_read_b128 v[60:63], v72 offset:1568
    ds_read_b128 v[64:67], v72 offset:1584
    s_waitcnt lgkmcnt(0)
    v_pk_add_f32 v[52:53], v[52:53], v[54:55]
    v_pk_add_f32 v[56:57], v[56:57], v[58:59]
    v_pk_add_f32 v[60:61], v[60:61], v[62:63]
    v_pk_add_f32 v[64:65], v[64:65], v[66:67]
    v_pk_add_f32 v[52:53], v[52:53], v[56:57]
    v_pk_add_f32 v[60:61], v[60:61], v[64:65]
    v_pk_add_f32 v[52:53], v[52:53], v[60:61]
    v_mul_f32 v68, 0x3a800000, v52
    v_mul_f32 v70, 0x3a800000, v53
    v_fma_f32 v70, -v68, v68, v70
    v_max_f32 v70, 0, v70
    v_mov_b32 v32, v68
    v_mov_b32 v33, v70
    v_cvt_pk_bf16_f32 v68, v68, v68
    v_lshlrev_b32 v68, 16, v68
    v_cvt_pk_bf16_f32 v70, v70, v70
    v_lshlrev_b32 v70, 16, v70
    v_add_f32 v70, 0x3727c5ac, v70
    v_cvt_pk_bf16_f32 v70, v70, v70
    v_lshlrev_b32 v70, 16, v70
    v_sqrt_f32 v70, v70
    s_nop 0
    v_cvt_pk_bf16_f32 v70, v70, v70
    v_lshlrev_b32 v70, 16, v70
    v_rcp_f32 v69, v70
    v_sub_f32 v32, v32, v68
    v_mul_f32 v32, v32, v69
    v_mul_f32 v33, v33, v69
    v_mul_f32 v33, v33, v69
    v_cvt_pk_bf16_f32 v32, v32, v32
    v_lshlrev_b32 v32, 16, v32
    v_cvt_pk_bf16_f32 v33, v33, v33
    v_lshlrev_b32 v33, 16, v33
    v_add_f32 v33, 0x3727c5ac, v33
    v_cvt_pk_bf16_f32 v33, v33, v33
    v_lshlrev_b32 v33, 16, v33
    v_sqrt_f32 v33, v33
    s_nop 0
    v_cvt_pk_bf16_f32 v33, v33, v33
    v_lshlrev_b32 v33, 16, v33
    v_cvt_pk_bf16_f32 v28, v68, v70
    v_cvt_pk_bf16_f32 v30, v32, v33
    v_mov_b32 v29, s52
    v_mov_b32 v31, s52
    s_lshl_b32 s26, s60, 15
    s_add_u32 s26, s26, 23199744
    s_add_u32 s24, s4, s26
    s_addc_u32 s25, s5, 0
    s_mov_b32 s26, 32768
    s_mov_b32 s27, 0x20000
    s_lshl_b32 s36, s28, 4
    s_add_u32 s36, s36, s29
    s_lshl_b32 s36, s36, 7
    s_mov_b64 exec, 0xff
    buffer_store_dwordx4 v[28:31], v2, s[24:27], s36 offen sc1
    s_mov_b64 exec, -1
R_nl:
    v_mov_b32 v6, 1
    v_mov_b32 v7, 0
    s_cmp_eq_u32 s30, 3
    s_waitcnt vmcnt(1)
    s_cbranch_scc1 R_n2
    s_waitcnt vmcnt(0)
R_n2:
    s_barrier
    s_cmp_lg_u32 s30, 0
    s_cbranch_scc1 R_n3
    s_mov_b64 exec, 1
    buffer_atomic_add v6, v7, s[56:59], s55 offen sc1
    s_mov_b64 exec, -1
R_n3:
    ds_read_b64_tr_b16 v[180:181], v75 offset:49152
    ds_read_b64_tr_b16 v[182:183], v75 offset:51200
    ds_read_b64_tr_b16 v[188:189], v75 offset:53248
    ds_read_b64_tr_b16 v[190:191], v75 offset:55296
    ds_read_b64_tr_b16 v[196:197], v75 offset:57344
    ds_read_b64_tr_b16 v[198:199], v75 offset:59392
    ds_read_b64_tr_b16 v[204:205], v75 offset:61440
    ds_read_b64_tr_b16 v[206:207], v75 offset:63488
    ds_read_b64_tr_b16 v[244:245], v76 offset:16384
    ds_read_b64_tr_b16 v[246:247], v76 offset:18432
    ds_read_b64_tr_b16 v[252:253], v76 offset:20480
    ds_read_b64_tr_b16 v[254:255], v76 offset:22528
    ds_read_b64_tr_b16 v[212:213], v76 offset:0
    ds_read_b64_tr_b16 v[214:215], v76 offset:2048
    ds_read_b64_tr_b16 v[220:221], v76 offset:4096
    ds_read_b64_tr_b16 v[222:223], v76 offset:6144
    ds_read_b64_tr_b16 v[228:229], v76 offset:8192
    ds_read_b64_tr_b16 v[230:231], v76 offset:10240
    ds_read_b64_tr_b16 v[236:237], v76 offset:12288
    ds_read_b64_tr_b16 v[238:239], v76 offset:14336
    ds_read_b64_tr_b16 v[176:177], v74 offset:49152
    ds_read_b64_tr_b16 v[178:179], v74 offset:51200
    ds_read_b64_tr_b16 v[184:185], v74 offset:53248
    ds_read_b64_tr_b16 v[186:187], v74 offset:55296
    ds_read_b64_tr_b16 v[192:193], v74 offset:57344
    ds_read_b64_tr_b16 v[194:195], v74 offset:59392
    ds_read_b64_tr_b16 v[200:201], v74 offset:61440
    ds_read_b64_tr_b16 v[202:203], v74 offset:63488
    ds_read_b64_tr_b16 v[208:209], v75 offset:0
    ds_read_b64_tr_b16 v[210:211], v75 offset:2048
    ds_read_b64_tr_b16 v[216:217], v75 offset:4096
    ds_read_b64_tr_b16 v[218:219], v75 offset:6144
    ds_read_b64_tr_b16 v[224:225], v75 offset:8192
    ds_read_b64_tr_b16 v[226:227], v75 offset:10240
    ds_read_b64_tr_b16 v[232:233], v75 offset:12288
    ds_read_b64_tr_b16 v[234:235], v75 offset:14336
    ds_read_b64_tr_b16 v[128:129], v74 offset:24576
    ds_read_b64_tr_b16 v[130:131], v74 offset:26624
    ds_read_b64_tr_b16 v[136:137], v74 offset:28672
    ds_read_b64_tr_b16 v[138:139], v74 offset:30720
    v_and_b32 v8, 15, v1
    v_lshrrev_b32 v9, 4, v1
    v_xor_b32 v6, v9, v8
    v_lshlrev_b32 v7, 8, v8
    v_xor_b32 v10, 0, v6
    v_lshl_add_u32 v10, v10, 4, v7
    v_add_u32 v14, 106496, v10
    v_xor_b32 v11, 4, v6
    v_lshl_add_u32 v11, v11, 4, v7
    v_add_u32 v15, 106496, v11
    v_xor_b32 v12, 8, v6
    v_lshl_add_u32 v12, v12, 4, v7
    v_add_u32 v16, 106496, v12
    v_xor_b32 v13, 12, v6
    v_lshl_add_u32 v13, v13, 4, v7
    v_add_u32 v17, 106496, v13
    v_lshlrev_b32 v18, 4, v8
    v_add_u32 v18, 155648, v18
    s_add_u32 s16, s62, 0x400000
    s_addc_u32 s17, s63, 0
    s_mov_b32 s18, 0x7e000
    s_mov_b32 s19, 0x20000
    v_and_b32 v6, 1, v9
    v_lshlrev_b32 v114, 16, v6
    v_lshrrev_b32 v6, 1, v9
    v_lshl_add_u32 v114, v6, 8, v114
    v_lshl_add_u32 v114, v8, 4, v114
    s_bfe_u32 s36, s30, 0x10001
    s_lshl1_add_u32 s36, s29, s36
    s_xor_b32 s36, s36, 2
    s_lshr_b32 s53, s36, 3
    s_lshl_b32 s53, s53, 14
    s_and_b32 s39, s36, 7
    s_lshl_b32 s39, s39, 10
    s_add_u32 s39, s39, s53
    s_and_b32 s36, s30, 1
    s_lshl_b32 s36, s36, 9
    s_add_u32 s39, s39, s36
    s_and_b32 s8, s30, 3
    s_lshl_b32 s8, s8, 15
    s_and_b32 s53, s30, 2
    s_lshl_b32 s53, s53, 11
    s_and_b32 s12, s30, 1
    s_lshl_b32 s12, s12, 13
    s_add_u32 s12, s12, s53
    s_and_b32 s20, s30, 1
    s_lshl_b32 s20, s20, 8
    s_add_u32 s20, s20, s55
    s_add_u32 s21, s52, 16
    v_mov_b32 v112, 0x7f000000
    v_writelane_b32 v112, 0, 0
    v_mov_b32 v113, 1
    s_and_b32 s40, s30, 1
    s_lshl1_add_u32 s40, s31, s40
    s_lshl_b32 s40, s40, 7
    s_add_u32 s40, s40, s55
    v_mov_b32 v88, 0x3f803f80
    v_mov_b32 v89, 0x3f803f80
    v_mov_b32 v90, 0x3f803f80
    v_mov_b32 v91, 0x3f803f80
    s_waitcnt lgkmcnt(0)
    s_nop 0
    v_mfma_f32_16x16x32_bf16 v[84:87], v[180:183], v[88:91], 0
    v_mfma_f32_16x16x32_bf16 v[84:87], v[188:191], v[88:91], v[84:87]
    v_mfma_f32_16x16x32_bf16 v[84:87], v[196:199], v[88:91], v[84:87]
    v_mfma_f32_16x16x32_bf16 v[84:87], v[204:207], v[88:91], v[84:87]
    v_mfma_f32_16x16x32_bf16 v[84:87], v[244:247], v[88:91], v[84:87]
    v_mfma_f32_16x16x32_bf16 v[84:87], v[252:255], v[88:91], v[84:87]
    v_mfma_f32_16x16x32_bf16 v[84:87], v[212:215], v[88:91], v[84:87]
    v_mfma_f32_16x16x32_bf16 v[84:87], v[220:223], v[88:91], v[84:87]
    v_mfma_f32_16x16x32_bf16 v[84:87], v[228:231], v[88:91], v[84:87]
    v_mfma_f32_16x16x32_bf16 v[84:87], v[236:239], v[88:91], v[84:87]
    v_mfma_f32_16x16x32_bf16 v[84:87], v[176:179], v[88:91], v[84:87]
    v_mfma_f32_16x16x32_bf16 v[84:87], v[184:187], v[88:91], v[84:87]
    v_mfma_f32_16x16x32_bf16 v[84:87], v[192:195], v[88:91], v[84:87]
    v_mfma_f32_16x16x32_bf16 v[84:87], v[200:203], v[88:91], v[84:87]
    v_mfma_f32_16x16x32_bf16 v[84:87], v[208:211], v[88:91], v[84:87]
    v_mfma_f32_16x16x32_bf16 v[84:87], v[216:219], v[88:91], v[84:87]
    v_mfma_f32_16x16x32_bf16 v[84:87], v[224:227], v[88:91], v[84:87]
    v_mfma_f32_16x16x32_bf16 v[84:87], v[232:235], v[88:91], v[84:87]
    v_mfma_f32_16x16x32_bf16 v[84:87], v[128:131], v[88:91], v[84:87]
    v_mfma_f32_16x16x32_bf16 v[84:87], v[136:139], v[88:91], v[84:87]
    s_cmp_lg_u32 s30, 0
    s_cbranch_scc1 pdone_8
    s_add_u32 s54, s55, 0
    s_bitcmp1_b32 s29, 2
    s_cselect_b32 s53, s93, s92
    s_add_u32 s53, s53, s54
    v_mov_b32 v105, s54
    v_writelane_b32 v105, s53, 1
    s_mov_b32 s53, 0
    s_add_u32 s54, s52, 16
    s_bfm_b64 exec, 2, 0
poll_9:
    buffer_load_dword v104, v105, s[56:59], 0 offen sc1
    s_waitcnt vmcnt(0)
    v_cmp_eq_u32 vcc, s54, v104
    s_nop 0
    s_cmp_eq_u64 vcc, exec
    s_cbranch_scc1 pok_10
    s_sleep 3
    s_add_u32 s53, s53, 1
    s_cmp_lt_u32 s53, s61
    s_cbranch_scc1 poll_9
    s_mov_b32 s61, 0
pok_10:
    s_mov_b64 exec, -1
pdone_8:
    s_waitcnt lgkmcnt(0)
    s_barrier
    ds_read_b64_tr_b16 v[240:241], v75 offset:16384
    ds_read_b64_tr_b16 v[242:243], v75 offset:18432
    ds_read_b64_tr_b16 v[248:249], v75 offset:20480
    ds_read_b64_tr_b16 v[250:251], v75 offset:22528
    ds_read_b64_tr_b16 v[132:133], v75 offset:24576
    ds_read_b64_tr_b16 v[134:135], v75 offset:26624
    ds_read_b64_tr_b16 v[140:141], v75 offset:28672
    ds_read_b64_tr_b16 v[142:143], v75 offset:30720
    ds_read_b64_tr_b16 v[144:145], v74 offset:32768
    ds_read_b64_tr_b16 v[146:147], v74 offset:34816
    ds_read_b64_tr_b16 v[152:153], v74 offset:36864
    ds_read_b64_tr_b16 v[154:155], v74 offset:38912
    ds_read_b64_tr_b16 v[160:161], v74 offset:40960
    ds_read_b64_tr_b16 v[162:163], v74 offset:43008
    ds_read_b64_tr_b16 v[168:169], v74 offset:45056
    ds_read_b64_tr_b16 v[170:171], v74 offset:47104
    ds_read_b64_tr_b16 v[148:149], v75 offset:32768
    ds_read_b64_tr_b16 v[150:151], v75 offset:34816
    ds_read_b64_tr_b16 v[156:157], v75 offset:36864
    ds_read_b64_tr_b16 v[158:159], v75 offset:38912
    ds_read_b64_tr_b16 v[164:165], v75 offset:40960
    ds_read_b64_tr_b16 v[166:167], v75 offset:43008
    ds_read_b64_tr_b16 v[172:173], v75 offset:45056
    ds_read_b64_tr_b16 v[174:175], v75 offset:47104
    s_waitcnt lgkmcnt(12)
    v_mfma_f32_16x16x32_bf16 v[84:87], v[240:243], v[88:91], v[84:87]
    v_mfma_f32_16x16x32_bf16 v[84:87], v[248:251], v[88:91], v[84:87]
    v_mfma_f32_16x16x32_bf16 v[84:87], v[132:135], v[88:91], v[84:87]
    v_mfma_f32_16x16x32_bf16 v[84:87], v[140:143], v[88:91], v[84:87]
    v_mfma_f32_16x16x32_bf16 v[84:87], v[144:147], v[88:91], v[84:87]
    v_mfma_f32_16x16x32_bf16 v[84:87], v[152:155], v[88:91], v[84:87]
    s_waitcnt lgkmcnt(0)
    v_mfma_f32_16x16x32_bf16 v[84:87], v[160:163], v[88:91], v[84:87]
    v_mfma_f32_16x16x32_bf16 v[84:87], v[168:171], v[88:91], v[84:87]
    v_mfma_f32_16x16x32_bf16 v[84:87], v[148:151], v[88:91], v[84:87]
    v_mfma_f32_16x16x32_bf16 v[84:87], v[156:159], v[88:91], v[84:87]
    v_mfma_f32_16x16x32_bf16 v[84:87], v[164:167], v[88:91], v[84:87]
    v_mfma_f32_16x16x32_bf16 v[84:87], v[172:175], v[88:91], v[84:87]
    s_barrier
    ds_read_b128 v[36:39], v14 offset:16384
    ds_read_b128 v[40:43], v14 offset:20480
    ds_read_b128 v[44:47], v14 offset:24576
    ds_read_b128 v[48:51], v14 offset:28672
    ds_read_b128 v[52:55], v15 offset:16384
    ds_read_b128 v[56:59], v15 offset:20480
    ds_read_b128 v[60:63], v15 offset:24576
    ds_read_b128 v[64:67], v15 offset:28672
    s_waitcnt lgkmcnt(4)
    v_mfma_f32_16x16x32_bf16 v[20:23], v[128:131], v[36:39], 0
    ds_read_b128 v[68:71], v16 offset:16384
    v_mfma_f32_16x16x32_bf16 v[24:27], v[128:131], v[40:43], 0
    ds_read_b128 v[72:75], v16 offset:20480
    v_mfma_f32_16x16x32_bf16 v[24:27], v[132:135], v[48:51], v[24:27]
    ds_read_b128 v[76:79], v16 offset:24576
    v_mfma_f32_16x16x32_bf16 v[20:23], v[132:135], v[44:47], v[20:23]
    ds_read_b128 v[80:83], v16 offset:28672
    s_waitcnt lgkmcnt(4)
    v_mfma_f32_16x16x32_bf16 v[20:23], v[136:139], v[52:55], v[20:23]
    ds_read_b128 v[36:39], v17 offset:16384
    v_mfma_f32_16x16x32_bf16 v[24:27], v[136:139], v[56:59], v[24:27]
    ds_read_b128 v[40:43], v17 offset:20480
    v_mfma_f32_16x16x32_bf16 v[24:27], v[140:143], v[64:67], v[24:27]
    ds_read_b128 v[44:47], v17 offset:24576
    v_mfma_f32_16x16x32_bf16 v[20:23], v[140:143], v[60:63], v[20:23]
    ds_read_b128 v[48:51], v17 offset:28672
    s_barrier
    s_waitcnt lgkmcnt(4)
    v_mfma_f32_16x16x32_bf16 v[20:23], v[144:147], v[68:71], v[20:23]
    ds_read_b128 v[52:55], v14 offset:32768
    v_mfma_f32_16x16x32_bf16 v[24:27], v[144:147], v[72:75], v[24:27]
    ds_read_b128 v[56:59], v14 offset:36864
    v_mfma_f32_16x16x32_bf16 v[24:27], v[148:151], v[80:83], v[24:27]
    ds_read_b128 v[60:63], v14 offset:40960
    v_mfma_f32_16x16x32_bf16 v[20:23], v[148:151], v[76:79], v[20:23]
    ds_read_b128 v[64:67], v14 offset:45056
    s_waitcnt lgkmcnt(4)
    v_mfma_f32_16x16x32_bf16 v[20:23], v[152:155], v[36:39], v[20:23]
    ds_read_b128 v[68:71], v15 offset:32768
    v_mfma_f32_16x16x32_bf16 v[24:27], v[152:155], v[40:43], v[24:27]
    ds_read_b128 v[72:75], v15 offset:36864
    v_mfma_f32_16x16x32_bf16 v[24:27], v[156:159], v[48:51], v[24:27]
    ds_read_b128 v[76:79], v15 offset:40960
    v_mfma_f32_16x16x32_bf16 v[20:23], v[156:159], v[44:47], v[20:23]
    ds_read_b128 v[80:83], v15 offset:45056
    s_waitcnt lgkmcnt(4)
    v_mfma_f32_16x16x32_bf16 v[20:23], v[160:163], v[52:55], v[20:23]
    ds_read_b128 v[36:39], v16 offset:32768
    v_mfma_f32_16x16x32_bf16 v[24:27], v[160:163], v[56:59], v[24:27]
    ds_read_b128 v[40:43], v16 offset:36864
    v_mfma_f32_16x16x32_bf16 v[24:27], v[164:167], v[64:67], v[24:27]
    ds_read_b128 v[44:47], v16 offset:40960
    v_mfma_f32_16x16x32_bf16 v[20:23], v[164:167], v[60:63], v[20:23]
    ds_read_b128 v[48:51], v16 offset:45056
    s_waitcnt lgkmcnt(4)
    v_mfma_f32_16x16x32_bf16 v[20:23], v[168:171], v[68:71], v[20:23]
    ds_read_b128 v[52:55], v17 offset:32768
    v_mfma_f32_16x16x32_bf16 v[24:27], v[168:171], v[72:75], v[24:27]
    ds_read_b128 v[56:59], v17 offset:36864
    v_mfma_f32_16x16x32_bf16 v[24:27], v[172:175], v[80:83], v[24:27]
    ds_read_b128 v[60:63], v17 offset:40960
    v_mfma_f32_16x16x32_bf16 v[20:23], v[172:175], v[76:79], v[20:23]
    ds_read_b128 v[64:67], v17 offset:45056
    s_barrier
    s_waitcnt lgkmcnt(4)
    v_mfma_f32_16x16x32_bf16 v[20:23], v[176:179], v[36:39], v[20:23]
    ds_read_b128 v[68:71], v10 offset:16384
    v_mfma_f32_16x16x32_bf16 v[24:27], v[176:179], v[40:43], v[24:27]
    ds_read_b128 v[72:75], v10 offset:20480
    v_mfma_f32_16x16x32_bf16 v[24:27], v[180:183], v[48:51], v[24:27]
    ds_read_b128 v[76:79], v10 offset:24576
    v_mfma_f32_16x16x32_bf16 v[20:23], v[180:183], v[44:47], v[20:23]
    ds_read_b128 v[80:83], v10 offset:28672
    s_waitcnt lgkmcnt(4)
    v_mfma_f32_16x16x32_bf16 v[20:23], v[184:187], v[52:55], v[20:23]
    ds_read_b128 v[36:39], v11 offset:16384
    v_mfma_f32_16x16x32_bf16 v[24:27], v[184:187], v[56:59], v[24:27]
    ds_read_b128 v[40:43], v11 offset:20480
    v_mfma_f32_16x16x32_bf16 v[24:27], v[188:191], v[64:67], v[24:27]
    ds_read_b128 v[44:47], v11 offset:24576
    v_mfma_f32_16x16x32_bf16 v[20:23], v[188:191], v[60:63], v[20:23]
    ds_read_b128 v[48:51], v11 offset:28672
    s_waitcnt lgkmcnt(4)
    v_mfma_f32_16x16x32_bf16 v[20:23], v[192:195], v[68:71], v[20:23]
    ds_read_b128 v[52:55], v12 offset:16384
    v_mfma_f32_16x16x32_bf16 v[24:27], v[192:195], v[72:75], v[24:27]
    ds_read_b128 v[56:59], v12 offset:20480
    v_mfma_f32_16x16x32_bf16 v[24:27], v[196:199], v[80:83], v[24:27]
    ds_read_b128 v[60:63], v12 offset:24576
    v_mfma_f32_16x16x32_bf16 v[20:23], v[196:199], v[76:79], v[20:23]
    ds_read_b128 v[64:67], v12 offset:28672
    s_waitcnt lgkmcnt(4)
    v_mfma_f32_16x16x32_bf16 v[20:23], v[200:203], v[36:39], v[20:23]
    ds_read_b128 v[68:71], v13 offset:16384
    v_mfma_f32_16x16x32_bf16 v[24:27], v[200:203], v[40:43], v[24:27]
    ds_read_b128 v[72:75], v13 offset:20480
    v_mfma_f32_16x16x32_bf16 v[24:27], v[204:207], v[48:51], v[24:27]
    ds_read_b128 v[76:79], v13 offset:24576
    v_mfma_f32_16x16x32_bf16 v[20:23], v[204:207], v[44:47], v[20:23]
    ds_read_b128 v[80:83], v13 offset:28672
    s_barrier
    s_waitcnt lgkmcnt(4)
    v_mfma_f32_16x16x32_bf16 v[20:23], v[208:211], v[52:55], v[20:23]
    ds_read_b128 v[36:39], v10 offset:32768
    v_mfma_f32_16x16x32_bf16 v[24:27], v[208:211], v[56:59], v[24:27]
    ds_read_b128 v[40:43], v10 offset:36864
    v_mfma_f32_16x16x32_bf16 v[24:27], v[212:215], v[64:67], v[24:27]
    ds_read_b128 v[44:47], v10 offset:40960
    v_mfma_f32_16x16x32_bf16 v[20:23], v[212:215], v[60:63], v[20:23]
    ds_read_b128 v[48:51], v10 offset:45056
    s_waitcnt lgkmcnt(4)
    v_mfma_f32_16x16x32_bf16 v[20:23], v[216:219], v[68:71], v[20:23]
    ds_read_b128 v[52:55], v11 offset:32768
    v_mfma_f32_16x16x32_bf16 v[24:27], v[216:219], v[72:75], v[24:27]
    ds_read_b128 v[56:59], v11 offset:36864
    v_mfma_f32_16x16x32_bf16 v[24:27], v[220:223], v[80:83], v[24:27]
    ds_read_b128 v[60:63], v11 offset:40960
    v_mfma_f32_16x16x32_bf16 v[20:23], v[220:223], v[76:79], v[20:23]
    ds_read_b128 v[64:67], v11 offset:45056
    s_waitcnt lgkmcnt(4)
    v_mfma_f32_16x16x32_bf16 v[20:23], v[224:227], v[36:39], v[20:23]
    ds_read_b128 v[68:71], v12 offset:32768
    v_mfma_f32_16x16x32_bf16 v[24:27], v[224:227], v[40:43], v[24:27]
    ds_read_b128 v[72:75], v12 offset:36864
    v_mfma_f32_16x16x32_bf16 v[24:27], v[228:231], v[48:51], v[24:27]
    ds_read_b128 v[76:79], v12 offset:40960
    v_mfma_f32_16x16x32_bf16 v[20:23], v[228:231], v[44:47], v[20:23]
    ds_read_b128 v[80:83], v12 offset:45056
    s_waitcnt lgkmcnt(4)
    v_mfma_f32_16x16x32_bf16 v[20:23], v[232:235], v[52:55], v[20:23]
    ds_read_b128 v[36:39], v13 offset:32768
    v_mfma_f32_16x16x32_bf16 v[24:27], v[232:235], v[56:59], v[24:27]
    ds_read_b128 v[40:43], v13 offset:36864
    v_mfma_f32_16x16x32_bf16 v[24:27], v[236:239], v[64:67], v[24:27]
    ds_read_b128 v[44:47], v13 offset:40960
    v_mfma_f32_16x16x32_bf16 v[20:23], v[236:239], v[60:63], v[20:23]
    ds_read_b128 v[48:51], v13 offset:45056
    s_barrier
    ds_read_b128 v[88:91], v18 offset:0
    ds_read_b128 v[92:95], v18 offset:2048
    ds_read_b128 v[96:99], v18 offset:256
    ds_read_b128 v[100:103], v18 offset:2304
    s_waitcnt lgkmcnt(8)
    v_mfma_f32_16x16x32_bf16 v[20:23], v[240:243], v[68:71], v[20:23]
    ds_read_b128 v[52:55], v14 offset:0
    v_mfma_f32_16x16x32_bf16 v[24:27], v[240:243], v[72:75], v[24:27]
    ds_read_b128 v[56:59], v14 offset:4096
    v_mfma_f32_16x16x32_bf16 v[24:27], v[244:247], v[80:83], v[24:27]
    ds_read_b128 v[60:63], v14 offset:8192
    v_mfma_f32_16x16x32_bf16 v[20:23], v[244:247], v[76:79], v[20:23]
    ds_read_b128 v[64:67], v14 offset:12288
    s_waitcnt lgkmcnt(8)
    v_mfma_f32_16x16x32_bf16 v[20:23], v[248:251], v[36:39], v[20:23]
    ds_read_b128 v[68:71], v15 offset:0
    v_mfma_f32_16x16x32_bf16 v[24:27], v[248:251], v[40:43], v[24:27]
    ds_read_b128 v[72:75], v15 offset:4096
    v_mfma_f32_16x16x32_bf16 v[24:27], v[252:255], v[48:51], v[24:27]
    ds_read_b128 v[76:79], v15 offset:8192
    v_mfma_f32_16x16x32_bf16 v[20:23], v[252:255], v[44:47], v[20:23]
    ds_read_b128 v[80:83], v15 offset:12288
    s_waitcnt lgkmcnt(4)
    v_mfma_f32_16x16x32_bf16 v[28:31], v[128:131], v[52:55], 0
    ds_read_b128 v[36:39], v16 offset:0
    v_mfma_f32_16x16x32_bf16 v[32:35], v[128:131], v[56:59], 0
    ds_read_b128 v[40:43], v16 offset:4096
    v_mfma_f32_16x16x32_bf16 v[32:35], v[132:135], v[64:67], v[32:35]
    ds_read_b128 v[44:47], v16 offset:8192
    v_mfma_f32_16x16x32_bf16 v[28:31], v[132:135], v[60:63], v[28:31]
    ds_read_b128 v[48:51], v16 offset:12288
    v_pk_fma_f32 v[20:21], v[88:89], v[84:85], v[20:21]
    v_pk_fma_f32 v[22:23], v[88:89], v[86:87], v[22:23]
    v_pk_fma_f32 v[24:25], v[96:97], v[84:85], v[24:25]
    v_pk_fma_f32 v[26:27], v[96:97], v[86:87], v[26:27]
    v_pk_mul_f32 v[104:105], v[20:21], v[20:21]
    v_pk_mul_f32 v[106:107], v[22:23], v[22:23]
    v_pk_mul_f32 v[108:109], v[24:25], v[24:25]
    v_pk_mul_f32 v[110:111], v[26:27], v[26:27]
    v_pk_fma_f32 v[104:105], v[104:105], v[92:93], v[90:91]
    v_pk_fma_f32 v[106:107], v[106:107], v[92:93], v[90:91]
    v_pk_fma_f32 v[108:109], v[108:109], v[100:101], v[98:99]
    v_pk_fma_f32 v[110:111], v[110:111], v[100:101], v[98:99]
    v_pk_mul_f32 v[104:105], v[104:105], v[20:21]
    v_pk_mul_f32 v[106:107], v[106:107], v[22:23]
    v_pk_mul_f32 v[108:109], v[108:109], v[24:25]
    v_pk_mul_f32 v[110:111], v[110:111], v[26:27]
    v_exp_f32 v104, v104
    v_exp_f32 v105, v105
    v_exp_f32 v106, v106
    v_exp_f32 v107, v107
    v_exp_f32 v108, v108
    v_exp_f32 v109, v109
    v_exp_f32 v110, v110
    v_exp_f32 v111, v111
    v_pk_fma_f32 v[104:105], v[104:105], v[94:95], v[94:95]
    v_pk_fma_f32 v[106:107], v[106:107], v[94:95], v[94:95]
    v_pk_fma_f32 v[108:109], v[108:109], v[102:103], v[102:103]
    v_pk_fma_f32 v[110:111], v[110:111], v[102:103], v[102:103]
    v_rcp_f32 v104, v104
    v_rcp_f32 v105, v105
    v_rcp_f32 v106, v106
    v_rcp_f32 v107, v107
    v_rcp_f32 v108, v108
    v_rcp_f32 v109, v109
    v_rcp_f32 v110, v110
    v_rcp_f32 v111, v111
    v_pk_mul_f32 v[20:21], v[20:21], v[104:105]
    v_pk_mul_f32 v[22:23], v[22:23], v[106:107]
    v_pk_mul_f32 v[24:25], v[24:25], v[108:109]
    v_pk_mul_f32 v[26:27], v[26:27], v[110:111]
    v_add_u32 v20, 0x10000, v20
    v_add_u32 v22, 0x10000, v22
    v_add_u32 v24, 0x10000, v24
    v_add_u32 v26, 0x10000, v26
    v_and_b32 v20, 0xfffe0000, v20
    v_and_b32 v22, 0xfffe0000, v22
    v_and_b32 v24, 0xfffe0000, v24
    v_and_b32 v26, 0xfffe0000, v26
    v_cvt_pk_bf16_f32 v104, v20, v21
    v_cvt_pk_bf16_f32 v105, v22, v23
    v_cvt_pk_bf16_f32 v106, v24, v25
    v_cvt_pk_bf16_f32 v107, v26, v27
    s_add_u32 s36, s39, 0
    v_permlane16_swap_b32 v104, v106
    v_permlane16_swap_b32 v105, v107
    buffer_store_dwordx4 v[104:107], v114, s[16:19], s36 offen sc1
    s_waitcnt lgkmcnt(4)
    v_mfma_f32_16x16x32_bf16 v[28:31], v[136:139], v[68:71], v[28:31]
    ds_read_b128 v[52:55], v17 offset:0
    v_mfma_f32_16x16x32_bf16 v[32:35], v[136:139], v[72:75], v[32:35]
    ds_read_b128 v[56:59], v17 offset:4096
    v_mfma_f32_16x16x32_bf16 v[32:35], v[140:143], v[80:83], v[32:35]
    ds_read_b128 v[60:63], v17 offset:8192
    v_mfma_f32_16x16x32_bf16 v[28:31], v[140:143], v[76:79], v[28:31]
    ds_read_b128 v[64:67], v17 offset:12288
    s_barrier
    s_waitcnt lgkmcnt(4)
    v_mfma_f32_16x16x32_bf16 v[28:31], v[144:147], v[36:39], v[28:31]
    ds_read_b128 v[68:71], v14 offset:16384
    v_mfma_f32_16x16x32_bf16 v[32:35], v[144:147], v[40:43], v[32:35]
    ds_read_b128 v[72:75], v14 offset:20480
    v_mfma_f32_16x16x32_bf16 v[32:35], v[148:151], v[48:51], v[32:35]
    ds_read_b128 v[76:79], v14 offset:24576
    v_mfma_f32_16x16x32_bf16 v[28:31], v[148:151], v[44:47], v[28:31]
    ds_read_b128 v[80:83], v14 offset:28672
    s_waitcnt lgkmcnt(4)
    v_mfma_f32_16x16x32_bf16 v[28:31], v[152:155], v[52:55], v[28:31]
    ds_read_b128 v[36:39], v15 offset:16384
    v_mfma_f32_16x16x32_bf16 v[32:35], v[152:155], v[56:59], v[32:35]
    ds_read_b128 v[40:43], v15 offset:20480
    v_mfma_f32_16x16x32_bf16 v[32:35], v[156:159], v[64:67], v[32:35]
    ds_read_b128 v[44:47], v15 offset:24576
    v_mfma_f32_16x16x32_bf16 v[28:31], v[156:159], v[60:63], v[28:31]
    ds_read_b128 v[48:51], v15 offset:28672
    s_waitcnt lgkmcnt(4)
    v_mfma_f32_16x16x32_bf16 v[28:31], v[160:163], v[68:71], v[28:31]
    ds_read_b128 v[52:55], v16 offset:16384
    v_mfma_f32_16x16x32_bf16 v[32:35], v[160:163], v[72:75], v[32:35]
    ds_read_b128 v[56:59], v16 offset:20480
    v_mfma_f32_16x16x32_bf16 v[32:35], v[164:167], v[80:83], v[32:35]
    ds_read_b128 v[60:63], v16 offset:24576
    v_mfma_f32_16x16x32_bf16 v[28:31], v[164:167], v[76:79], v[28:31]
    ds_read_b128 v[64:67], v16 offset:28672
    s_waitcnt lgkmcnt(4)
    v_mfma_f32_16x16x32_bf16 v[28:31], v[168:171], v[36:39], v[28:31]
    ds_read_b128 v[68:71], v17 offset:16384
    v_mfma_f32_16x16x32_bf16 v[32:35], v[168:171], v[40:43], v[32:35]
    ds_read_b128 v[72:75], v17 offset:20480
    v_mfma_f32_16x16x32_bf16 v[32:35], v[172:175], v[48:51], v[32:35]
    ds_read_b128 v[76:79], v17 offset:24576
    v_mfma_f32_16x16x32_bf16 v[28:31], v[172:175], v[44:47], v[28:31]
    ds_read_b128 v[80:83], v17 offset:28672
    s_barrier
    s_waitcnt lgkmcnt(4)
    v_mfma_f32_16x16x32_bf16 v[28:31], v[176:179], v[52:55], v[28:31]
    ds_read_b128 v[36:39], v14 offset:32768
    v_mfma_f32_16x16x32_bf16 v[32:35], v[176:179], v[56:59], v[32:35]
    ds_read_b128 v[40:43], v14 offset:36864
    v_mfma_f32_16x16x32_bf16 v[32:35], v[180:183], v[64:67], v[32:35]
    ds_read_b128 v[44:47], v14 offset:40960
    v_mfma_f32_16x16x32_bf16 v[28:31], v[180:183], v[60:63], v[28:31]
    ds_read_b128 v[48:51], v14 offset:45056
    s_waitcnt lgkmcnt(4)
    v_mfma_f32_16x16x32_bf16 v[28:31], v[184:187], v[68:71], v[28:31]
    ds_read_b128 v[52:55], v15 offset:32768
    v_mfma_f32_16x16x32_bf16 v[32:35], v[184:187], v[72:75], v[32:35]
    ds_read_b128 v[56:59], v15 offset:36864
    v_mfma_f32_16x16x32_bf16 v[32:35], v[188:191], v[80:83], v[32:35]
    ds_read_b128 v[60:63], v15 offset:40960
    v_mfma_f32_16x16x32_bf16 v[28:31], v[188:191], v[76:79], v[28:31]
    ds_read_b128 v[64:67], v15 offset:45056
    s_waitcnt lgkmcnt(4)
    v_mfma_f32_16x16x32_bf16 v[28:31], v[192:195], v[36:39], v[28:31]
    ds_read_b128 v[68:71], v16 offset:32768
    v_mfma_f32_16x16x32_bf16 v[32:35], v[192:195], v[40:43], v[32:35]
    ds_read_b128 v[72:75], v16 offset:36864
    v_mfma_f32_16x16x32_bf16 v[32:35], v[196:199], v[48:51], v[32:35]
    ds_read_b128 v[76:79], v16 offset:40960
    v_mfma_f32_16x16x32_bf16 v[28:31], v[196:199], v[44:47], v[28:31]
    ds_read_b128 v[80:83], v16 offset:45056
    s_waitcnt lgkmcnt(4)
    v_mfma_f32_16x16x32_bf16 v[28:31], v[200:203], v[52:55], v[28:31]
    ds_read_b128 v[36:39], v17 offset:32768
    v_mfma_f32_16x16x32_bf16 v[32:35], v[200:203], v[56:59], v[32:35]
    ds_read_b128 v[40:43], v17 offset:36864
    v_mfma_f32_16x16x32_bf16 v[32:35], v[204:207], v[64:67], v[32:35]
    ds_read_b128 v[44:47], v17 offset:40960
    v_mfma_f32_16x16x32_bf16 v[28:31], v[204:207], v[60:63], v[28:31]
    ds_read_b128 v[48:51], v17 offset:45056
    s_barrier
    s_waitcnt lgkmcnt(4)
    v_mfma_f32_16x16x32_bf16 v[28:31], v[208:211], v[68:71], v[28:31]
    ds_read_b128 v[52:55], v10 offset:16384
    v_mfma_f32_16x16x32_bf16 v[32:35], v[208:211], v[72:75], v[32:35]
    ds_read_b128 v[56:59], v10 offset:20480
    v_mfma_f32_16x16x32_bf16 v[32:35], v[212:215], v[80:83], v[32:35]
    ds_read_b128 v[60:63], v10 offset:24576
    v_mfma_f32_16x16x32_bf16 v[28:31], v[212:215], v[76:79], v[28:31]
    ds_read_b128 v[64:67], v10 offset:28672
    s_waitcnt lgkmcnt(4)
    v_mfma_f32_16x16x32_bf16 v[28:31], v[216:219], v[36:39], v[28:31]
    ds_read_b128 v[68:71], v11 offset:16384
    v_mfma_f32_16x16x32_bf16 v[32:35], v[216:219], v[40:43], v[32:35]
    ds_read_b128 v[72:75], v11 offset:20480
    v_mfma_f32_16x16x32_bf16 v[32:35], v[220:223], v[48:51], v[32:35]
    ds_read_b128 v[76:79], v11 offset:24576
    v_mfma_f32_16x16x32_bf16 v[28:31], v[220:223], v[44:47], v[28:31]
    ds_read_b128 v[80:83], v11 offset:28672
    s_waitcnt lgkmcnt(4)
    v_mfma_f32_16x16x32_bf16 v[28:31], v[224:227], v[52:55], v[28:31]
    ds_read_b128 v[36:39], v12 offset:16384
    v_mfma_f32_16x16x32_bf16 v[32:35], v[224:227], v[56:59], v[32:35]
    ds_read_b128 v[40:43], v12 offset:20480
    v_mfma_f32_16x16x32_bf16 v[32:35], v[228:231], v[64:67], v[32:35]
    ds_read_b128 v[44:47], v12 offset:24576
    v_mfma_f32_16x16x32_bf16 v[28:31], v[228:231], v[60:63], v[28:31]
    ds_read_b128 v[48:51], v12 offset:28672
    s_waitcnt lgkmcnt(4)
    v_mfma_f32_16x16x32_bf16 v[28:31], v[232:235], v[68:71], v[28:31]
    ds_read_b128 v[52:55], v13 offset:16384
    v_mfma_f32_16x16x32_bf16 v[32:35], v[232:235], v[72:75], v[32:35]
    ds_read_b128 v[56:59], v13 offset:20480
    v_mfma_f32_16x16x32_bf16 v[32:35], v[236:239], v[80:83], v[32:35]
    ds_read_b128 v[60:63], v13 offset:24576
    v_mfma_f32_16x16x32_bf16 v[28:31], v[236:239], v[76:79], v[28:31]
    ds_read_b128 v[64:67], v13 offset:28672
    s_barrier
    ds_read_b128 v[88:91], v18 offset:512
    ds_read_b128 v[92:95], v18 offset:2560
    ds_read_b128 v[96:99], v18 offset:768
    ds_read_b128 v[100:103], v18 offset:2816
    s_waitcnt vmcnt(0)
    buffer_atomic_add v113, v112, s[56:59], s40 offen offset:2048 sc1
    s_waitcnt lgkmcnt(8)
    v_mfma_f32_16x16x32_bf16 v[28:31], v[240:243], v[36:39], v[28:31]
    ds_read_b128 v[68:71], v10 offset:32768
    v_mfma_f32_16x16x32_bf16 v[32:35], v[240:243], v[40:43], v[32:35]
    ds_read_b128 v[72:75], v10 offset:36864
    v_mfma_f32_16x16x32_bf16 v[32:35], v[244:247], v[48:51], v[32:35]
    ds_read_b128 v[76:79], v10 offset:40960
    v_mfma_f32_16x16x32_bf16 v[28:31], v[244:247], v[44:47], v[28:31]
    ds_read_b128 v[80:83], v10 offset:45056
    s_waitcnt lgkmcnt(8)
    v_mfma_f32_16x16x32_bf16 v[28:31], v[248:251], v[52:55], v[28:31]
    ds_read_b128 v[36:39], v11 offset:32768
    v_mfma_f32_16x16x32_bf16 v[32:35], v[248:251], v[56:59], v[32:35]
    ds_read_b128 v[40:43], v11 offset:36864
    v_mfma_f32_16x16x32_bf16 v[32:35], v[252:255], v[64:67], v[32:35]
    ds_read_b128 v[44:47], v11 offset:40960
    v_mfma_f32_16x16x32_bf16 v[28:31], v[252:255], v[60:63], v[28:31]
    ds_read_b128 v[48:51], v11 offset:45056
    s_waitcnt lgkmcnt(4)
    v_mfma_f32_16x16x32_bf16 v[20:23], v[128:131], v[68:71], 0
    ds_read_b128 v[52:55], v12 offset:32768
    v_mfma_f32_16x16x32_bf16 v[24:27], v[128:131], v[72:75], 0
    ds_read_b128 v[56:59], v12 offset:36864
    v_mfma_f32_16x16x32_bf16 v[24:27], v[132:135], v[80:83], v[24:27]
    ds_read_b128 v[60:63], v12 offset:40960
    v_mfma_f32_16x16x32_bf16 v[20:23], v[132:135], v[76:79], v[20:23]
    ds_read_b128 v[64:67], v12 offset:45056
    v_pk_fma_f32 v[28:29], v[88:89], v[84:85], v[28:29]
    v_pk_fma_f32 v[30:31], v[88:89], v[86:87], v[30:31]
    v_pk_fma_f32 v[32:33], v[96:97], v[84:85], v[32:33]
    v_pk_fma_f32 v[34:35], v[96:97], v[86:87], v[34:35]
    v_pk_mul_f32 v[104:105], v[28:29], v[28:29]
    v_pk_mul_f32 v[106:107], v[30:31], v[30:31]
    v_pk_mul_f32 v[108:109], v[32:33], v[32:33]
    v_pk_mul_f32 v[110:111], v[34:35], v[34:35]
    v_pk_fma_f32 v[104:105], v[104:105], v[92:93], v[90:91]
    v_pk_fma_f32 v[106:107], v[106:107], v[92:93], v[90:91]
    v_pk_fma_f32 v[108:109], v[108:109], v[100:101], v[98:99]
    v_pk_fma_f32 v[110:111], v[110:111], v[100:101], v[98:99]
    v_pk_mul_f32 v[104:105], v[104:105], v[28:29]
    v_pk_mul_f32 v[106:107], v[106:107], v[30:31]
    v_pk_mul_f32 v[108:109], v[108:109], v[32:33]
    v_pk_mul_f32 v[110:111], v[110:111], v[34:35]
    v_exp_f32 v104, v104
    v_exp_f32 v105, v105
    v_exp_f32 v106, v106
    v_exp_f32 v107, v107
    v_exp_f32 v108, v108
    v_exp_f32 v109, v109
    v_exp_f32 v110, v110
    v_exp_f32 v111, v111
    v_pk_fma_f32 v[104:105], v[104:105], v[94:95], v[94:95]
    v_pk_fma_f32 v[106:107], v[106:107], v[94:95], v[94:95]
    v_pk_fma_f32 v[108:109], v[108:109], v[102:103], v[102:103]
    v_pk_fma_f32 v[110:111], v[110:111], v[102:103], v[102:103]
    v_rcp_f32 v104, v104
    v_rcp_f32 v105, v105
    v_rcp_f32 v106, v106
    v_rcp_f32 v107, v107
    v_rcp_f32 v108, v108
    v_rcp_f32 v109, v109
    v_rcp_f32 v110, v110
    v_rcp_f32 v111, v111
    v_pk_mul_f32 v[28:29], v[28:29], v[104:105]
    v_pk_mul_f32 v[30:31], v[30:31], v[106:107]
    v_pk_mul_f32 v[32:33], v[32:33], v[108:109]
    v_pk_mul_f32 v[34:35], v[34:35], v[110:111]
    v_add_u32 v28, 0x10000, v28
    v_add_u32 v30, 0x10000, v30
    v_add_u32 v32, 0x10000, v32
    v_add_u32 v34, 0x10000, v34
    v_and_b32 v28, 0xfffe0000, v28
    v_and_b32 v30, 0xfffe0000, v30
    v_and_b32 v32, 0xfffe0000, v32
    v_and_b32 v34, 0xfffe0000, v34
    v_cvt_pk_bf16_f32 v104, v28, v29
    v_cvt_pk_bf16_f32 v105, v30, v31
    v_cvt_pk_bf16_f32 v106, v32, v33
    v_cvt_pk_bf16_f32 v107, v34, v35
    s_add_u32 s36, s39, 131072
    v_permlane16_swap_b32 v104, v106
    v_permlane16_swap_b32 v105, v107
    buffer_store_dwordx4 v[104:107], v114, s[16:19], s36 offen sc1
    s_waitcnt lgkmcnt(4)
    v_mfma_f32_16x16x32_bf16 v[20:23], v[136:139], v[36:39], v[20:23]
    ds_read_b128 v[68:71], v13 offset:32768
    v_mfma_f32_16x16x32_bf16 v[24:27], v[136:139], v[40:43], v[24:27]
    ds_read_b128 v[72:75], v13 offset:36864
    v_mfma_f32_16x16x32_bf16 v[24:27], v[140:143], v[48:51], v[24:27]
    ds_read_b128 v[76:79], v13 offset:40960
    v_mfma_f32_16x16x32_bf16 v[20:23], v[140:143], v[44:47], v[20:23]
    ds_read_b128 v[80:83], v13 offset:45056
    s_barrier
    s_waitcnt lgkmcnt(4)
    v_mfma_f32_16x16x32_bf16 v[20:23], v[144:147], v[52:55], v[20:23]
    ds_read_b128 v[36:39], v14 offset:0
    v_mfma_f32_16x16x32_bf16 v[24:27], v[144:147], v[56:59], v[24:27]
    ds_read_b128 v[40:43], v14 offset:4096
    v_mfma_f32_16x16x32_bf16 v[24:27], v[148:151], v[64:67], v[24:27]
    ds_read_b128 v[44:47], v14 offset:8192
    v_mfma_f32_16x16x32_bf16 v[20:23], v[148:151], v[60:63], v[20:23]
    ds_read_b128 v[48:51], v14 offset:12288
    s_waitcnt lgkmcnt(4)
    v_mfma_f32_16x16x32_bf16 v[20:23], v[152:155], v[68:71], v[20:23]
    ds_read_b128 v[52:55], v15 offset:0
    v_mfma_f32_16x16x32_bf16 v[24:27], v[152:155], v[72:75], v[24:27]
    ds_read_b128 v[56:59], v15 offset:4096
    v_mfma_f32_16x16x32_bf16 v[24:27], v[156:159], v[80:83], v[24:27]
    ds_read_b128 v[60:63], v15 offset:8192
    v_mfma_f32_16x16x32_bf16 v[20:23], v[156:159], v[76:79], v[20:23]
    ds_read_b128 v[64:67], v15 offset:12288
    s_waitcnt lgkmcnt(4)
    v_mfma_f32_16x16x32_bf16 v[20:23], v[160:163], v[36:39], v[20:23]
    ds_read_b128 v[68:71], v16 offset:0
    v_mfma_f32_16x16x32_bf16 v[24:27], v[160:163], v[40:43], v[24:27]
    ds_read_b128 v[72:75], v16 offset:4096
    v_mfma_f32_16x16x32_bf16 v[24:27], v[164:167], v[48:51], v[24:27]
    ds_read_b128 v[76:79], v16 offset:8192
    v_mfma_f32_16x16x32_bf16 v[20:23], v[164:167], v[44:47], v[20:23]
    ds_read_b128 v[80:83], v16 offset:12288
    s_waitcnt lgkmcnt(4)
    v_mfma_f32_16x16x32_bf16 v[20:23], v[168:171], v[52:55], v[20:23]
    ds_read_b128 v[36:39], v17 offset:0
    v_mfma_f32_16x16x32_bf16 v[24:27], v[168:171], v[56:59], v[24:27]
    ds_read_b128 v[40:43], v17 offset:4096
    v_mfma_f32_16x16x32_bf16 v[24:27], v[172:175], v[64:67], v[24:27]
    ds_read_b128 v[44:47], v17 offset:8192
    v_mfma_f32_16x16x32_bf16 v[20:23], v[172:175], v[60:63], v[20:23]
    ds_read_b128 v[48:51], v17 offset:12288
    s_barrier
    s_waitcnt lgkmcnt(4)
    v_mfma_f32_16x16x32_bf16 v[20:23], v[176:179], v[68:71], v[20:23]
    ds_read_b128 v[52:55], v14 offset:16384
    v_mfma_f32_16x16x32_bf16 v[24:27], v[176:179], v[72:75], v[24:27]
    ds_read_b128 v[56:59], v14 offset:20480
    v_mfma_f32_16x16x32_bf16 v[24:27], v[180:183], v[80:83], v[24:27]
    ds_read_b128 v[60:63], v14 offset:24576
    v_mfma_f32_16x16x32_bf16 v[20:23], v[180:183], v[76:79], v[20:23]
    ds_read_b128 v[64:67], v14 offset:28672
    s_waitcnt lgkmcnt(4)
    v_mfma_f32_16x16x32_bf16 v[20:23], v[184:187], v[36:39], v[20:23]
    ds_read_b128 v[68:71], v15 offset:16384
    v_mfma_f32_16x16x32_bf16 v[24:27], v[184:187], v[40:43], v[24:27]
    ds_read_b128 v[72:75], v15 offset:20480
    v_mfma_f32_16x16x32_bf16 v[24:27], v[188:191], v[48:51], v[24:27]
    ds_read_b128 v[76:79], v15 offset:24576
    v_mfma_f32_16x16x32_bf16 v[20:23], v[188:191], v[44:47], v[20:23]
    ds_read_b128 v[80:83], v15 offset:28672
    s_waitcnt lgkmcnt(4)
    v_mfma_f32_16x16x32_bf16 v[20:23], v[192:195], v[52:55], v[20:23]
    ds_read_b128 v[36:39], v16 offset:16384
    v_mfma_f32_16x16x32_bf16 v[24:27], v[192:195], v[56:59], v[24:27]
    ds_read_b128 v[40:43], v16 offset:20480
    v_mfma_f32_16x16x32_bf16 v[24:27], v[196:199], v[64:67], v[24:27]
    ds_read_b128 v[44:47], v16 offset:24576
    v_mfma_f32_16x16x32_bf16 v[20:23], v[196:199], v[60:63], v[20:23]
    ds_read_b128 v[48:51], v16 offset:28672
    s_waitcnt lgkmcnt(4)
    v_mfma_f32_16x16x32_bf16 v[20:23], v[200:203], v[68:71], v[20:23]
    ds_read_b128 v[52:55], v17 offset:16384
    v_mfma_f32_16x16x32_bf16 v[24:27], v[200:203], v[72:75], v[24:27]
    ds_read_b128 v[56:59], v17 offset:20480
    v_mfma_f32_16x16x32_bf16 v[24:27], v[204:207], v[80:83], v[24:27]
    ds_read_b128 v[60:63], v17 offset:24576
    v_mfma_f32_16x16x32_bf16 v[20:23], v[204:207], v[76:79], v[20:23]
    ds_read_b128 v[64:67], v17 offset:28672
    s_barrier
    s_waitcnt lgkmcnt(4)
    v_mfma_f32_16x16x32_bf16 v[20:23], v[208:211], v[36:39], v[20:23]
    ds_read_b128 v[68:71], v14 offset:32768
    v_mfma_f32_16x16x32_bf16 v[24:27], v[208:211], v[40:43], v[24:27]
    ds_read_b128 v[72:75], v14 offset:36864
    v_mfma_f32_16x16x32_bf16 v[24:27], v[212:215], v[48:51], v[24:27]
    ds_read_b128 v[76:79], v14 offset:40960
    v_mfma_f32_16x16x32_bf16 v[20:23], v[212:215], v[44:47], v[20:23]
    ds_read_b128 v[80:83], v14 offset:45056
    s_waitcnt lgkmcnt(4)
    v_mfma_f32_16x16x32_bf16 v[20:23], v[216:219], v[52:55], v[20:23]
    ds_read_b128 v[36:39], v15 offset:32768
    v_mfma_f32_16x16x32_bf16 v[24:27], v[216:219], v[56:59], v[24:27]
    ds_read_b128 v[40:43], v15 offset:36864
    v_mfma_f32_16x16x32_bf16 v[24:27], v[220:223], v[64:67], v[24:27]
    ds_read_b128 v[44:47], v15 offset:40960
    v_mfma_f32_16x16x32_bf16 v[20:23], v[220:223], v[60:63], v[20:23]
    ds_read_b128 v[48:51], v15 offset:45056
    s_waitcnt lgkmcnt(4)
    v_mfma_f32_16x16x32_bf16 v[20:23], v[224:227], v[68:71], v[20:23]
    ds_read_b128 v[52:55], v16 offset:32768
    v_mfma_f32_16x16x32_bf16 v[24:27], v[224:227], v[72:75], v[24:27]
    ds_read_b128 v[56:59], v16 offset:36864
    v_mfma_f32_16x16x32_bf16 v[24:27], v[228:231], v[80:83], v[24:27]
    ds_read_b128 v[60:63], v16 offset:40960
    v_mfma_f32_16x16x32_bf16 v[20:23], v[228:231], v[76:79], v[20:23]
    ds_read_b128 v[64:67], v16 offset:45056
    s_waitcnt lgkmcnt(4)
    v_mfma_f32_16x16x32_bf16 v[20:23], v[232:235], v[36:39], v[20:23]
    ds_read_b128 v[68:71], v17 offset:32768
    v_mfma_f32_16x16x32_bf16 v[24:27], v[232:235], v[40:43], v[24:27]
    ds_read_b128 v[72:75], v17 offset:36864
    v_mfma_f32_16x16x32_bf16 v[24:27], v[236:239], v[48:51], v[24:27]
    ds_read_b128 v[76:79], v17 offset:40960
    v_mfma_f32_16x16x32_bf16 v[20:23], v[236:239], v[44:47], v[20:23]
    ds_read_b128 v[80:83], v17 offset:45056
    s_barrier
    ds_read_b128 v[88:91], v18 offset:1024
    ds_read_b128 v[92:95], v18 offset:3072
    ds_read_b128 v[96:99], v18 offset:1280
    ds_read_b128 v[100:103], v18 offset:3328
    s_waitcnt vmcnt(0)
    buffer_atomic_add v113, v112, s[56:59], s40 offen offset:2560 sc1
    s_waitcnt lgkmcnt(8)
    v_mfma_f32_16x16x32_bf16 v[20:23], v[240:243], v[52:55], v[20:23]
    ds_read_b128 v[36:39], v10 offset:16384
    v_mfma_f32_16x16x32_bf16 v[24:27], v[240:243], v[56:59], v[24:27]
    ds_read_b128 v[40:43], v10 offset:20480
    v_mfma_f32_16x16x32_bf16 v[24:27], v[244:247], v[64:67], v[24:27]
    ds_read_b128 v[44:47], v10 offset:24576
    v_mfma_f32_16x16x32_bf16 v[20:23], v[244:247], v[60:63], v[20:23]
    ds_read_b128 v[48:51], v10 offset:28672
    s_waitcnt lgkmcnt(8)
    v_mfma_f32_16x16x32_bf16 v[20:23], v[248:251], v[68:71], v[20:23]
    ds_read_b128 v[52:55], v11 offset:16384
    v_mfma_f32_16x16x32_bf16 v[24:27], v[248:251], v[72:75], v[24:27]
    ds_read_b128 v[56:59], v11 offset:20480
    v_mfma_f32_16x16x32_bf16 v[24:27], v[252:255], v[80:83], v[24:27]
    ds_read_b128 v[60:63], v11 offset:24576
    v_mfma_f32_16x16x32_bf16 v[20:23], v[252:255], v[76:79], v[20:23]
    ds_read_b128 v[64:67], v11 offset:28672
    s_waitcnt lgkmcnt(4)
    v_mfma_f32_16x16x32_bf16 v[28:31], v[128:131], v[36:39], 0
    ds_read_b128 v[68:71], v12 offset:16384
    v_mfma_f32_16x16x32_bf16 v[32:35], v[128:131], v[40:43], 0
    ds_read_b128 v[72:75], v12 offset:20480
    v_mfma_f32_16x16x32_bf16 v[32:35], v[132:135], v[48:51], v[32:35]
    ds_read_b128 v[76:79], v12 offset:24576
    v_mfma_f32_16x16x32_bf16 v[28:31], v[132:135], v[44:47], v[28:31]
    ds_read_b128 v[80:83], v12 offset:28672
    v_pk_fma_f32 v[20:21], v[88:89], v[84:85], v[20:21]
    v_pk_fma_f32 v[22:23], v[88:89], v[86:87], v[22:23]
    v_pk_fma_f32 v[24:25], v[96:97], v[84:85], v[24:25]
    v_pk_fma_f32 v[26:27], v[96:97], v[86:87], v[26:27]
    v_pk_mul_f32 v[104:105], v[20:21], v[20:21]
    v_pk_mul_f32 v[106:107], v[22:23], v[22:23]
    v_pk_mul_f32 v[108:109], v[24:25], v[24:25]
    v_pk_mul_f32 v[110:111], v[26:27], v[26:27]
    v_pk_fma_f32 v[104:105], v[104:105], v[92:93], v[90:91]
    v_pk_fma_f32 v[106:107], v[106:107], v[92:93], v[90:91]
    v_pk_fma_f32 v[108:109], v[108:109], v[100:101], v[98:99]
    v_pk_fma_f32 v[110:111], v[110:111], v[100:101], v[98:99]
    v_pk_mul_f32 v[104:105], v[104:105], v[20:21]
    v_pk_mul_f32 v[106:107], v[106:107], v[22:23]
    v_pk_mul_f32 v[108:109], v[108:109], v[24:25]
    v_pk_mul_f32 v[110:111], v[110:111], v[26:27]
    v_exp_f32 v104, v104
    v_exp_f32 v105, v105
    v_exp_f32 v106, v106
    v_exp_f32 v107, v107
    v_exp_f32 v108, v108
    v_exp_f32 v109, v109
    v_exp_f32 v110, v110
    v_exp_f32 v111, v111
    v_pk_fma_f32 v[104:105], v[104:105], v[94:95], v[94:95]
    v_pk_fma_f32 v[106:107], v[106:107], v[94:95], v[94:95]
    v_pk_fma_f32 v[108:109], v[108:109], v[102:103], v[102:103]
    v_pk_fma_f32 v[110:111], v[110:111], v[102:103], v[102:103]
    v_rcp_f32 v104, v104
    v_rcp_f32 v105, v105
    v_rcp_f32 v106, v106
    v_rcp_f32 v107, v107
    v_rcp_f32 v108, v108
    v_rcp_f32 v109, v109
    v_rcp_f32 v110, v110
    v_rcp_f32 v111, v111
    v_pk_mul_f32 v[20:21], v[20:21], v[104:105]
    v_pk_mul_f32 v[22:23], v[22:23], v[106:107]
    v_pk_mul_f32 v[24:25], v[24:25], v[108:109]
    v_pk_mul_f32 v[26:27], v[26:27], v[110:111]
    v_add_u32 v20, 0x10000, v20
    v_add_u32 v22, 0x10000, v22
    v_add_u32 v24, 0x10000, v24
    v_add_u32 v26, 0x10000, v26
    v_and_b32 v20, 0xfffe0000, v20
    v_and_b32 v22, 0xfffe0000, v22
    v_and_b32 v24, 0xfffe0000, v24
    v_and_b32 v26, 0xfffe0000, v26
    v_cvt_pk_bf16_f32 v104, v20, v21
    v_cvt_pk_bf16_f32 v105, v22, v23
    v_cvt_pk_bf16_f32 v106, v24, v25
    v_cvt_pk_bf16_f32 v107, v26, v27
    s_add_u32 s36, s39, 262144
    v_permlane16_swap_b32 v104, v106
    v_permlane16_swap_b32 v105, v107
    buffer_store_dwordx4 v[104:107], v114, s[16:19], s36 offen sc1
    s_waitcnt lgkmcnt(4)
    v_mfma_f32_16x16x32_bf16 v[28:31], v[136:139], v[52:55], v[28:31]
    ds_read_b128 v[36:39], v13 offset:16384
    v_mfma_f32_16x16x32_bf16 v[32:35], v[136:139], v[56:59], v[32:35]
    ds_read_b128 v[40:43], v13 offset:20480
    v_mfma_f32_16x16x32_bf16 v[32:35], v[140:143], v[64:67], v[32:35]
    ds_read_b128 v[44:47], v13 offset:24576
    v_mfma_f32_16x16x32_bf16 v[28:31], v[140:143], v[60:63], v[28:31]
    ds_read_b128 v[48:51], v13 offset:28672
    s_barrier
    s_waitcnt lgkmcnt(4)
    v_mfma_f32_16x16x32_bf16 v[28:31], v[144:147], v[68:71], v[28:31]
    ds_read_b128 v[52:55], v10 offset:32768
    v_mfma_f32_16x16x32_bf16 v[32:35], v[144:147], v[72:75], v[32:35]
    ds_read_b128 v[56:59], v10 offset:36864
    v_mfma_f32_16x16x32_bf16 v[32:35], v[148:151], v[80:83], v[32:35]
    ds_read_b128 v[60:63], v10 offset:40960
    v_mfma_f32_16x16x32_bf16 v[28:31], v[148:151], v[76:79], v[28:31]
    ds_read_b128 v[64:67], v10 offset:45056
    s_waitcnt lgkmcnt(4)
    v_mfma_f32_16x16x32_bf16 v[28:31], v[152:155], v[36:39], v[28:31]
    ds_read_b128 v[68:71], v11 offset:32768
    v_mfma_f32_16x16x32_bf16 v[32:35], v[152:155], v[40:43], v[32:35]
    ds_read_b128 v[72:75], v11 offset:36864
    v_mfma_f32_16x16x32_bf16 v[32:35], v[156:159], v[48:51], v[32:35]
    ds_read_b128 v[76:79], v11 offset:40960
    v_mfma_f32_16x16x32_bf16 v[28:31], v[156:159], v[44:47], v[28:31]
    ds_read_b128 v[80:83], v11 offset:45056
    s_waitcnt lgkmcnt(4)
    v_mfma_f32_16x16x32_bf16 v[28:31], v[160:163], v[52:55], v[28:31]
    ds_read_b128 v[36:39], v12 offset:32768
    v_mfma_f32_16x16x32_bf16 v[32:35], v[160:163], v[56:59], v[32:35]
    ds_read_b128 v[40:43], v12 offset:36864
    v_mfma_f32_16x16x32_bf16 v[32:35], v[164:167], v[64:67], v[32:35]
    ds_read_b128 v[44:47], v12 offset:40960
    v_mfma_f32_16x16x32_bf16 v[28:31], v[164:167], v[60:63], v[28:31]
    ds_read_b128 v[48:51], v12 offset:45056
    s_waitcnt lgkmcnt(4)
    v_mfma_f32_16x16x32_bf16 v[28:31], v[168:171], v[68:71], v[28:31]
    ds_read_b128 v[52:55], v13 offset:32768
    v_mfma_f32_16x16x32_bf16 v[32:35], v[168:171], v[72:75], v[32:35]
    ds_read_b128 v[56:59], v13 offset:36864
    v_mfma_f32_16x16x32_bf16 v[32:35], v[172:175], v[80:83], v[32:35]
    ds_read_b128 v[60:63], v13 offset:40960
    v_mfma_f32_16x16x32_bf16 v[28:31], v[172:175], v[76:79], v[28:31]
    ds_read_b128 v[64:67], v13 offset:45056
    s_barrier
    s_waitcnt lgkmcnt(4)
    v_mfma_f32_16x16x32_bf16 v[28:31], v[176:179], v[36:39], v[28:31]
    ds_read_b128 v[68:71], v14 offset:0
    v_mfma_f32_16x16x32_bf16 v[32:35], v[176:179], v[40:43], v[32:35]
    ds_read_b128 v[72:75], v14 offset:4096
    v_mfma_f32_16x16x32_bf16 v[32:35], v[180:183], v[48:51], v[32:35]
    ds_read_b128 v[76:79], v14 offset:8192
    v_mfma_f32_16x16x32_bf16 v[28:31], v[180:183], v[44:47], v[28:31]
    ds_read_b128 v[80:83], v14 offset:12288
    s_waitcnt lgkmcnt(4)
    v_mfma_f32_16x16x32_bf16 v[28:31], v[184:187], v[52:55], v[28:31]
    ds_read_b128 v[36:39], v15 offset:0
    v_mfma_f32_16x16x32_bf16 v[32:35], v[184:187], v[56:59], v[32:35]
    ds_read_b128 v[40:43], v15 offset:4096
    v_mfma_f32_16x16x32_bf16 v[32:35], v[188:191], v[64:67], v[32:35]
    ds_read_b128 v[44:47], v15 offset:8192
    v_mfma_f32_16x16x32_bf16 v[28:31], v[188:191], v[60:63], v[28:31]
    ds_read_b128 v[48:51], v15 offset:12288
    s_waitcnt lgkmcnt(4)
    v_mfma_f32_16x16x32_bf16 v[28:31], v[192:195], v[68:71], v[28:31]
    ds_read_b128 v[52:55], v16 offset:0
    v_mfma_f32_16x16x32_bf16 v[32:35], v[192:195], v[72:75], v[32:35]
    ds_read_b128 v[56:59], v16 offset:4096
    v_mfma_f32_16x16x32_bf16 v[32:35], v[196:199], v[80:83], v[32:35]
    ds_read_b128 v[60:63], v16 offset:8192
    v_mfma_f32_16x16x32_bf16 v[28:31], v[196:199], v[76:79], v[28:31]
    ds_read_b128 v[64:67], v16 offset:12288
    s_waitcnt lgkmcnt(4)
    v_mfma_f32_16x16x32_bf16 v[28:31], v[200:203], v[36:39], v[28:31]
    ds_read_b128 v[68:71], v17 offset:0
    v_mfma_f32_16x16x32_bf16 v[32:35], v[200:203], v[40:43], v[32:35]
    ds_read_b128 v[72:75], v17 offset:4096
    v_mfma_f32_16x16x32_bf16 v[32:35], v[204:207], v[48:51], v[32:35]
    ds_read_b128 v[76:79], v17 offset:8192
    v_mfma_f32_16x16x32_bf16 v[28:31], v[204:207], v[44:47], v[28:31]
    ds_read_b128 v[80:83], v17 offset:12288
    s_barrier
    s_waitcnt lgkmcnt(4)
    v_mfma_f32_16x16x32_bf16 v[28:31], v[208:211], v[52:55], v[28:31]
    ds_read_b128 v[36:39], v14 offset:16384
    v_mfma_f32_16x16x32_bf16 v[32:35], v[208:211], v[56:59], v[32:35]
    ds_read_b128 v[40:43], v14 offset:20480
    v_mfma_f32_16x16x32_bf16 v[32:35], v[212:215], v[64:67], v[32:35]
    ds_read_b128 v[44:47], v14 offset:24576
    v_mfma_f32_16x16x32_bf16 v[28:31], v[212:215], v[60:63], v[28:31]
    ds_read_b128 v[48:51], v14 offset:28672
    s_waitcnt lgkmcnt(4)
    v_mfma_f32_16x16x32_bf16 v[28:31], v[216:219], v[68:71], v[28:31]
    ds_read_b128 v[52:55], v15 offset:16384
    v_mfma_f32_16x16x32_bf16 v[32:35], v[216:219], v[72:75], v[32:35]
    ds_read_b128 v[56:59], v15 offset:20480
    v_mfma_f32_16x16x32_bf16 v[32:35], v[220:223], v[80:83], v[32:35]
    ds_read_b128 v[60:63], v15 offset:24576
    v_mfma_f32_16x16x32_bf16 v[28:31], v[220:223], v[76:79], v[28:31]
    ds_read_b128 v[64:67], v15 offset:28672
    s_waitcnt vmcnt(0)
    buffer_atomic_add v113, v112, s[56:59], s40 offen offset:3072 sc1
    s_waitcnt lgkmcnt(4)
    v_mfma_f32_16x16x32_bf16 v[28:31], v[224:227], v[36:39], v[28:31]
    ds_read_b128 v[68:71], v16 offset:16384
    v_mfma_f32_16x16x32_bf16 v[32:35], v[224:227], v[40:43], v[32:35]
    ds_read_b128 v[72:75], v16 offset:20480
    v_mfma_f32_16x16x32_bf16 v[32:35], v[228:231], v[48:51], v[32:35]
    ds_read_b128 v[76:79], v16 offset:24576
    v_mfma_f32_16x16x32_bf16 v[28:31], v[228:231], v[44:47], v[28:31]
    ds_read_b128 v[80:83], v16 offset:28672
    s_waitcnt lgkmcnt(4)
    v_mfma_f32_16x16x32_bf16 v[28:31], v[232:235], v[52:55], v[28:31]
    ds_read_b128 v[36:39], v17 offset:16384
    v_mfma_f32_16x16x32_bf16 v[32:35], v[232:235], v[56:59], v[32:35]
    ds_read_b128 v[40:43], v17 offset:20480
    v_mfma_f32_16x16x32_bf16 v[32:35], v[236:239], v[64:67], v[32:35]
    ds_read_b128 v[44:47], v17 offset:24576
    v_mfma_f32_16x16x32_bf16 v[28:31], v[236:239], v[60:63], v[28:31]
    ds_read_b128 v[48:51], v17 offset:28672
    s_barrier
    ds_read_b128 v[88:91], v18 offset:1536
    ds_read_b128 v[92:95], v18 offset:3584
    ds_read_b128 v[96:99], v18 offset:1792
    ds_read_b128 v[100:103], v18 offset:3840
    s_waitcnt lgkmcnt(8)
    v_mfma_f32_16x16x32_bf16 v[28:31], v[240:243], v[68:71], v[28:31]
    v_mfma_f32_16x16x32_bf16 v[32:35], v[240:243], v[72:75], v[32:35]
    v_mfma_f32_16x16x32_bf16 v[32:35], v[244:247], v[80:83], v[32:35]
    v_mfma_f32_16x16x32_bf16 v[28:31], v[244:247], v[76:79], v[28:31]
    s_waitcnt lgkmcnt(4)
    v_mfma_f32_16x16x32_bf16 v[28:31], v[248:251], v[36:39], v[28:31]
    v_mfma_f32_16x16x32_bf16 v[32:35], v[248:251], v[40:43], v[32:35]
    v_mfma_f32_16x16x32_bf16 v[32:35], v[252:255], v[48:51], v[32:35]
    v_mfma_f32_16x16x32_bf16 v[28:31], v[252:255], v[44:47], v[28:31]
    s_setprio 1
    s_waitcnt lgkmcnt(0)
    s_load_dword s32, s[4:5], s20 offset:2560
    s_load_dword s3, s[4:5], s20 offset:2688
    s_add_u32 m0, s12, 106496
    s_add_u32 s49, s8, 20480
    buffer_load_dwordx4 v2, s[16:19], s49 offen offset:0 sc1 lds
    buffer_load_dwordx4 v2, s[16:19], s49 offen offset:1024 sc1 lds
    buffer_load_dwordx4 v2, s[16:19], s49 offen offset:2048 sc1 lds
    buffer_load_dwordx4 v2, s[16:19], s49 offen offset:3072 sc1 lds
    v_pk_fma_f32 v[28:29], v[88:89], v[84:85], v[28:29]
    v_pk_fma_f32 v[30:31], v[88:89], v[86:87], v[30:31]
    v_pk_fma_f32 v[32:33], v[96:97], v[84:85], v[32:33]
    v_pk_fma_f32 v[34:35], v[96:97], v[86:87], v[34:35]
    v_pk_mul_f32 v[104:105], v[28:29], v[28:29]
    v_pk_mul_f32 v[106:107], v[30:31], v[30:31]
    v_pk_mul_f32 v[108:109], v[32:33], v[32:33]
    v_pk_mul_f32 v[110:111], v[34:35], v[34:35]
    v_pk_fma_f32 v[104:105], v[104:105], v[92:93], v[90:91]
    v_pk_fma_f32 v[106:107], v[106:107], v[92:93], v[90:91]
    v_pk_fma_f32 v[108:109], v[108:109], v[100:101], v[98:99]
    v_pk_fma_f32 v[110:111], v[110:111], v[100:101], v[98:99]
    v_pk_mul_f32 v[104:105], v[104:105], v[28:29]
    v_pk_mul_f32 v[106:107], v[106:107], v[30:31]
    v_pk_mul_f32 v[108:109], v[108:109], v[32:33]
    v_pk_mul_f32 v[110:111], v[110:111], v[34:35]
    v_exp_f32 v104, v104
    v_exp_f32 v105, v105
    v_exp_f32 v106, v106
    v_exp_f32 v107, v107
    v_exp_f32 v108, v108
    v_exp_f32 v109, v109
    v_exp_f32 v110, v110
    v_exp_f32 v111, v111
    v_pk_fma_f32 v[104:105], v[104:105], v[94:95], v[94:95]
    v_pk_fma_f32 v[106:107], v[106:107], v[94:95], v[94:95]
    v_pk_fma_f32 v[108:109], v[108:109], v[102:103], v[102:103]
    v_pk_fma_f32 v[110:111], v[110:111], v[102:103], v[102:103]
    v_rcp_f32 v104, v104
    v_rcp_f32 v105, v105
    v_rcp_f32 v106, v106
    v_rcp_f32 v107, v107
    v_rcp_f32 v108, v108
    v_rcp_f32 v109, v109
    v_rcp_f32 v110, v110
    v_rcp_f32 v111, v111
    v_pk_mul_f32 v[28:29], v[28:29], v[104:105]
    v_pk_mul_f32 v[30:31], v[30:31], v[106:107]
    v_pk_mul_f32 v[32:33], v[32:33], v[108:109]
    v_pk_mul_f32 v[34:35], v[34:35], v[110:111]
    v_add_u32 v28, 0x10000, v28
    v_add_u32 v30, 0x10000, v30
    v_add_u32 v32, 0x10000, v32
    v_add_u32 v34, 0x10000, v34
    v_and_b32 v28, 0xfffe0000, v28
    v_and_b32 v30, 0xfffe0000, v30
    v_and_b32 v32, 0xfffe0000, v32
    v_and_b32 v34, 0xfffe0000, v34
    v_cvt_pk_bf16_f32 v104, v28, v29
    v_cvt_pk_bf16_f32 v105, v30, v31
    v_cvt_pk_bf16_f32 v106, v32, v33
    v_cvt_pk_bf16_f32 v107, v34, v35
    s_add_u32 s36, s39, 393216
    v_permlane16_swap_b32 v104, v106
    v_permlane16_swap_b32 v105, v107
    buffer_store_dwordx4 v[104:107], v114, s[16:19], s36 offen sc1
    s_add_u32 m0, s12, 122880
    s_add_u32 s49, s8, 131072
    s_barrier
    s_waitcnt lgkmcnt(0)
    s_cmp_eq_u32 s32, s21
    s_cselect_b32 s32, s3, 0
    s_cmp_eq_u32 s32, s21
    s_cbranch_scc1 hok_11
    s_add_u32 s53, s20, 2560
    v_lshlrev_b32 v85, 7, v1
    v_add_u32 v85, s53, v85
    s_mov_b32 s53, 0
    s_add_u32 s54, s52, 16
    s_bfm_b64 exec, 2, 0
poll_12:
    buffer_load_dword v84, v85, s[56:59], 0 offen sc1
    s_waitcnt vmcnt(0)
    v_cmp_eq_u32 vcc, s54, v84
    s_nop 0
    s_cmp_eq_u64 vcc, exec
    s_cbranch_scc1 pok_13
    s_sleep 8
    s_add_u32 s53, s53, 1
    s_cmp_lt_u32 s53, s61
    s_cbranch_scc1 poll_12
    s_mov_b32 s61, 0
pok_13:
    s_mov_b64 exec, -1
hok_11:
    buffer_load_dwordx4 v2, s[16:19], s49 offen offset:0 sc1 lds
    buffer_load_dwordx4 v2, s[16:19], s49 offen offset:1024 sc1 lds
    buffer_load_dwordx4 v2, s[16:19], s49 offen offset:2048 sc1 lds
    buffer_load_dwordx4 v2, s[16:19], s49 offen offset:3072 sc1 lds
    s_add_u32 m0, s12, 139264
    s_add_u32 s49, s8, 135168
    s_barrier
    buffer_load_dwordx4 v2, s[16:19], s49 offen offset:0 sc1 lds
    buffer_load_dwordx4 v2, s[16:19], s49 offen offset:1024 sc1 lds
    buffer_load_dwordx4 v2, s[16:19], s49 offen offset:2048 sc1 lds
    buffer_load_dwordx4 v2, s[16:19], s49 offen offset:3072 sc1 lds
    s_add_u32 m0, s12, 16384
    s_add_u32 s49, s8, 147456
    s_waitcnt vmcnt(9)
    s_barrier
    s_waitcnt vmcnt(8)
    buffer_atomic_add v113, v112, s[56:59], s40 offen offset:3584 sc1
    buffer_load_dwordx4 v2, s[16:19], s49 offen offset:0 sc1 lds
    buffer_load_dwordx4 v2, s[16:19], s49 offen offset:1024 sc1 lds
    buffer_load_dwordx4 v2, s[16:19], s49 offen offset:2048 sc1 lds
    buffer_load_dwordx4 v2, s[16:19], s49 offen offset:3072 sc1 lds
    s_add_u32 m0, s12, 32768
    s_add_u32 s49, s8, 151552
    s_waitcnt vmcnt(9)
    s_barrier
    s_load_dword s32, s[4:5], s20 offset:3072
    s_load_dword s3, s[4:5], s20 offset:3200
    buffer_load_dwordx4 v2, s[16:19], s49 offen offset:0 sc1 lds
    buffer_load_dwordx4 v2, s[16:19], s49 offen offset:1024 sc1 lds
    buffer_load_dwordx4 v2, s[16:19], s49 offen offset:2048 sc1 lds
    buffer_load_dwordx4 v2, s[16:19], s49 offen offset:3072 sc1 lds
    s_add_u32 m0, s12, 106496
    s_add_u32 s49, s8, 262144
    s_waitcnt vmcnt(9)
    s_barrier
    s_waitcnt lgkmcnt(0)
    s_cmp_eq_u32 s32, s21
    s_cselect_b32 s32, s3, 0
    s_cmp_eq_u32 s32, s21
    s_cbranch_scc1 hok_14
    s_add_u32 s53, s20, 3072
    v_lshlrev_b32 v85, 7, v1
    v_add_u32 v85, s53, v85
    s_mov_b32 s53, 0
    s_add_u32 s54, s52, 16
    s_bfm_b64 exec, 2, 0
poll_15:
    buffer_load_dword v84, v85, s[56:59], 0 offen sc1
    s_waitcnt vmcnt(0)
    v_cmp_eq_u32 vcc, s54, v84
    s_nop 0
    s_cmp_eq_u64 vcc, exec
    s_cbranch_scc1 pok_16
    s_sleep 8
    s_add_u32 s53, s53, 1
    s_cmp_lt_u32 s53, s61
    s_cbranch_scc1 poll_15
    s_mov_b32 s61, 0
pok_16:
    s_mov_b64 exec, -1
hok_14:
    buffer_load_dwordx4 v2, s[16:19], s49 offen offset:0 sc1 lds
    buffer_load_dwordx4 v2, s[16:19], s49 offen offset:1024 sc1 lds
    buffer_load_dwordx4 v2, s[16:19], s49 offen offset:2048 sc1 lds
    buffer_load_dwordx4 v2, s[16:19], s49 offen offset:3072 sc1 lds
    s_add_u32 m0, s12, 122880
    s_add_u32 s49, s8, 266240
    s_waitcnt vmcnt(8)
    s_barrier
    buffer_load_dwordx4 v2, s[16:19], s49 offen offset:0 sc1 lds
    buffer_load_dwordx4 v2, s[16:19], s49 offen offset:1024 sc1 lds
    buffer_load_dwordx4 v2, s[16:19], s49 offen offset:2048 sc1 lds
    buffer_load_dwordx4 v2, s[16:19], s49 offen offset:3072 sc1 lds
    s_add_u32 m0, s12, 139264
    s_add_u32 s49, s8, 278528
    s_waitcnt vmcnt(8)
    s_barrier
    buffer_load_dwordx4 v2, s[16:19], s49 offen offset:0 sc1 lds
    buffer_load_dwordx4 v2, s[16:19], s49 offen offset:1024 sc1 lds
    buffer_load_dwordx4 v2, s[16:19], s49 offen offset:2048 sc1 lds
    buffer_load_dwordx4 v2, s[16:19], s49 offen offset:3072 sc1 lds
    s_add_u32 m0, s12, 16384
    s_add_u32 s49, s8, 282624
    s_waitcnt vmcnt(8)
    s_barrier
    s_load_dword s32, s[4:5], s20 offset:3584
    s_load_dword s3, s[4:5], s20 offset:3712
    buffer_load_dwordx4 v2, s[16:19], s49 offen offset:0 sc1 lds
    buffer_load_dwordx4 v2, s[16:19], s49 offen offset:1024 sc1 lds
    buffer_load_dwordx4 v2, s[16:19], s49 offen offset:2048 sc1 lds
    buffer_load_dwordx4 v2, s[16:19], s49 offen offset:3072 sc1 lds
    s_add_u32 m0, s12, 32768
    s_add_u32 s49, s8, 393216
    s_waitcnt vmcnt(8)
    s_barrier
    s_waitcnt lgkmcnt(0)
    s_cmp_eq_u32 s32, s21
    s_cselect_b32 s32, s3, 0
    s_cmp_eq_u32 s32, s21
    s_cbranch_scc1 hok_17
    s_add_u32 s53, s20, 3584
    v_lshlrev_b32 v85, 7, v1
    v_add_u32 v85, s53, v85
    s_mov_b32 s53, 0
    s_add_u32 s54, s52, 16
    s_bfm_b64 exec, 2, 0
poll_18:
    buffer_load_dword v84, v85, s[56:59], 0 offen sc1
    s_waitcnt vmcnt(0)
    v_cmp_eq_u32 vcc, s54, v84
    s_nop 0
    s_cmp_eq_u64 vcc, exec
    s_cbranch_scc1 pok_19
    s_sleep 8
    s_add_u32 s53, s53, 1
    s_cmp_lt_u32 s53, s61
    s_cbranch_scc1 poll_18
    s_mov_b32 s61, 0
pok_19:
    s_mov_b64 exec, -1
hok_17:
    buffer_load_dwordx4 v2, s[16:19], s49 offen offset:0 sc1 lds
    buffer_load_dwordx4 v2, s[16:19], s49 offen offset:1024 sc1 lds
    buffer_load_dwordx4 v2, s[16:19], s49 offen offset:2048 sc1 lds
    buffer_load_dwordx4 v2, s[16:19], s49 offen offset:3072 sc1 lds
    s_add_u32 m0, s12, 106496
    s_add_u32 s49, s8, 397312
    s_waitcnt vmcnt(8)
    s_barrier
    buffer_load_dwordx4 v2, s[16:19], s49 offen offset:0 sc1 lds
    buffer_load_dwordx4 v2, s[16:19], s49 offen offset:1024 sc1 lds
    buffer_load_dwordx4 v2, s[16:19], s49 offen offset:2048 sc1 lds
    buffer_load_dwordx4 v2, s[16:19], s49 offen offset:3072 sc1 lds
    s_add_u32 m0, s12, 122880
    s_add_u32 s49, s8, 409600
    s_waitcnt vmcnt(8)
    s_barrier
    buffer_load_dwordx4 v2, s[16:19], s49 offen offset:0 sc1 lds
    buffer_load_dwordx4 v2, s[16:19], s49 offen offset:1024 sc1 lds
    buffer_load_dwordx4 v2, s[16:19], s49 offen offset:2048 sc1 lds
    buffer_load_dwordx4 v2, s[16:19], s49 offen offset:3072 sc1 lds
    s_add_u32 m0, s12, 139264
    s_add_u32 s49, s8, 413696
    s_waitcnt vmcnt(8)
    s_barrier
    buffer_load_dwordx4 v2, s[16:19], s49 offen offset:0 sc1 lds
    buffer_load_dwordx4 v2, s[16:19], s49 offen offset:1024 sc1 lds
    buffer_load_dwordx4 v2, s[16:19], s49 offen offset:2048 sc1 lds
    buffer_load_dwordx4 v2, s[16:19], s49 offen offset:3072 sc1 lds
    s_waitcnt vmcnt(8)
    s_barrier
    s_lshr_b32 s34, s30, 1
    s_and_b32 s35, s30, 1
    v_and_b32 v22, 15, v1
    v_lshrrev_b32 v23, 4, v1
    s_mul_i32 s37, s34, 4
    s_mul_i32 s36, s34, 8192
    v_add_u32 v12, s36, v2
    v_lshrrev_b32 v18, 2, v1
    v_mul_u32_u24 v13, 448, v18
    v_and_b32 v19, 3, v1
    v_lshl_add_u32 v13, v19, 3, v13
    v_add_u32 v13, 49152, v13
    v_mul_u32_u24 v15, 448, v18
    v_and_b32 v19, 2, v1
    v_lshl_add_u32 v15, v19, 2, v15
    v_bfe_u32 v18, v1, 4, 1
    v_and_b32 v19, 1, v1
    v_xor_b32 v19, v19, v18
    v_lshl_add_u32 v15, v19, 5, v15
    s_lshl_b32 s36, s35, 4
    s_add_u32 s36, s36, 49344
    v_add_u32 v15, s36, v15
    s_lshl_b32 s36, s35, 8
    v_add_u32 v13, s36, v13
    v_lshlrev_b32 v18, 5, v18
    v_sub_u32 v14, v13, v18
    v_add_u32 v13, v13, v18
    s_mov_b32 s42, 0
    s_mov_b32 s43, 0
    s_mov_b32 s48, 0
    v_mov_b32 v17, v12
    v_mov_b32 v18, v13
    v_mov_b32 v19, v14
    v_mov_b32 v20, v15
    s_waitcnt vmcnt(4)
    s_barrier
    s_waitcnt vmcnt(0)
    s_barrier
    s_setprio 0
    s_waitcnt lgkmcnt(0)
    s_barrier
    ds_read_b128 v[136:139], v17 offset:0
    ds_read_b128 v[140:143], v17 offset:2048
    ds_read_b128 v[144:147], v17 offset:4096
    ds_read_b128 v[148:151], v17 offset:6144
    ds_read_b64_tr_b16 v[152:153], v18 offset:0
    ds_read_b64_tr_b16 v[154:155], v18 offset:7168
    ds_read_b64_tr_b16 v[156:157], v19 offset:32
    ds_read_b64_tr_b16 v[158:159], v19 offset:7200
    ds_read_b64_tr_b16 v[160:161], v18 offset:64
    ds_read_b64_tr_b16 v[162:163], v18 offset:7232
    ds_read_b64_tr_b16 v[164:165], v19 offset:96
    ds_read_b64_tr_b16 v[166:167], v19 offset:7264
    ds_read_b64_tr_b16 v[168:169], v18 offset:128
    ds_read_b64_tr_b16 v[170:171], v18 offset:7296
    ds_read_b64_tr_b16 v[172:173], v19 offset:160
    ds_read_b64_tr_b16 v[174:175], v19 offset:7328
    ds_read_b64_tr_b16 v[176:177], v20 offset:0
    ds_read_b64_tr_b16 v[178:179], v20 offset:7168
    s_waitcnt lgkmcnt(0)
    v_mfma_f32_16x16x32_bf16 v[24:27], v[152:155], v[136:139], 0
    ds_read_b128 v[180:183], v17 offset:1024
    v_mfma_f32_16x16x32_bf16 v[52:55], v[152:155], v[140:143], 0
    ds_read_b128 v[184:187], v17 offset:3072
    v_mfma_f32_16x16x32_bf16 v[80:83], v[152:155], v[144:147], 0
    ds_read_b128 v[188:191], v17 offset:5120
    v_mfma_f32_16x16x32_bf16 v[108:111], v[152:155], v[148:151], 0
    ds_read_b128 v[192:195], v17 offset:7168
    v_mfma_f32_16x16x32_bf16 v[112:115], v[156:159], v[148:151], 0
    ds_read_b64_tr_b16 v[196:197], v18 offset:14336
    v_mfma_f32_16x16x32_bf16 v[84:87], v[156:159], v[144:147], 0
    ds_read_b64_tr_b16 v[198:199], v18 offset:21504
    v_mfma_f32_16x16x32_bf16 v[56:59], v[156:159], v[140:143], 0
    v_mfma_f32_16x16x32_bf16 v[28:31], v[156:159], v[136:139], 0
    ds_read_b64_tr_b16 v[200:201], v19 offset:14368
    v_mfma_f32_16x16x32_bf16 v[32:35], v[160:163], v[136:139], 0
    ds_read_b64_tr_b16 v[202:203], v19 offset:21536
    v_mfma_f32_16x16x32_bf16 v[60:63], v[160:163], v[140:143], 0
    ds_read_b64_tr_b16 v[204:205], v18 offset:14400
    v_mfma_f32_16x16x32_bf16 v[88:91], v[160:163], v[144:147], 0
    ds_read_b64_tr_b16 v[206:207], v18 offset:21568
    v_mfma_f32_16x16x32_bf16 v[116:119], v[160:163], v[148:151], 0
    ds_read_b64_tr_b16 v[208:209], v19 offset:14432
    v_mfma_f32_16x16x32_bf16 v[120:123], v[164:167], v[148:151], 0
    ds_read_b64_tr_b16 v[210:211], v19 offset:21600
    v_mfma_f32_16x16x32_bf16 v[92:95], v[164:167], v[144:147], 0
    v_mfma_f32_16x16x32_bf16 v[64:67], v[164:167], v[140:143], 0
    ds_read_b64_tr_b16 v[212:213], v18 offset:14464
    v_mfma_f32_16x16x32_bf16 v[36:39], v[164:167], v[136:139], 0
    ds_read_b64_tr_b16 v[214:215], v18 offset:21632
    v_mfma_f32_16x16x32_bf16 v[40:43], v[168:171], v[136:139], 0
    ds_read_b64_tr_b16 v[216:217], v19 offset:14496
    v_mfma_f32_16x16x32_bf16 v[68:71], v[168:171], v[140:143], 0
    ds_read_b64_tr_b16 v[218:219], v19 offset:21664
    v_mfma_f32_16x16x32_bf16 v[96:99], v[168:171], v[144:147], 0
    ds_read_b64_tr_b16 v[220:221], v20 offset:14336
    v_mfma_f32_16x16x32_bf16 v[124:127], v[168:171], v[148:151], 0
    ds_read_b64_tr_b16 v[222:223], v20 offset:21504
    v_mfma_f32_16x16x32_bf16 v[128:131], v[172:175], v[148:151], 0
    s_add_u32 s42, s42, 16384
    s_cmp_eq_u32 s42, 49152
    v_mfma_f32_16x16x32_bf16 v[100:103], v[172:175], v[144:147], 0
    s_cselect_b32 s42, 0, s42
    s_add_u32 s48, s48, 28672
    v_mfma_f32_16x16x32_bf16 v[72:75], v[172:175], v[140:143], 0
    s_cmp_eq_u32 s48, 86016
    s_cselect_b32 s48, 0, s48
    v_mfma_f32_16x16x32_bf16 v[44:47], v[172:175], v[136:139], 0
    v_add_u32 v17, s42, v12
    v_add_u32 v18, s48, v13
    v_mfma_f32_16x16x32_bf16 v[48:51], v[176:179], v[136:139], 0
    v_add_u32 v19, s48, v14
    v_add_u32 v20, s48, v15
    v_mfma_f32_16x16x32_bf16 v[76:79], v[176:179], v[140:143], 0
    v_mfma_f32_16x16x32_bf16 v[104:107], v[176:179], v[144:147], 0
    v_mfma_f32_16x16x32_bf16 v[132:135], v[176:179], v[148:151], 0
    s_waitcnt lgkmcnt(0)
    v_mfma_f32_16x16x32_bf16 v[24:27], v[196:199], v[180:183], v[24:27]
    v_mfma_f32_16x16x32_bf16 v[52:55], v[196:199], v[184:187], v[52:55]
    v_mfma_f32_16x16x32_bf16 v[80:83], v[196:199], v[188:191], v[80:83]
    v_mfma_f32_16x16x32_bf16 v[108:111], v[196:199], v[192:195], v[108:111]
    v_mfma_f32_16x16x32_bf16 v[112:115], v[200:203], v[192:195], v[112:115]
    v_mfma_f32_16x16x32_bf16 v[84:87], v[200:203], v[188:191], v[84:87]
    v_mfma_f32_16x16x32_bf16 v[56:59], v[200:203], v[184:187], v[56:59]
    v_mfma_f32_16x16x32_bf16 v[28:31], v[200:203], v[180:183], v[28:31]
    v_mfma_f32_16x16x32_bf16 v[32:35], v[204:207], v[180:183], v[32:35]
    v_mfma_f32_16x16x32_bf16 v[60:63], v[204:207], v[184:187], v[60:63]
    v_mfma_f32_16x16x32_bf16 v[88:91], v[204:207], v[188:191], v[88:91]
    v_mfma_f32_16x16x32_bf16 v[116:119], v[204:207], v[192:195], v[116:119]
    v_mfma_f32_16x16x32_bf16 v[120:123], v[208:211], v[192:195], v[120:123]
    v_mfma_f32_16x16x32_bf16 v[92:95], v[208:211], v[188:191], v[92:95]
    v_mfma_f32_16x16x32_bf16 v[64:67], v[208:211], v[184:187], v[64:67]
    v_mfma_f32_16x16x32_bf16 v[36:39], v[208:211], v[180:183], v[36:39]
    v_mfma_f32_16x16x32_bf16 v[40:43], v[212:215], v[180:183], v[40:43]
    v_mfma_f32_16x16x32_bf16 v[68:71], v[212:215], v[184:187], v[68:71]
    v_mfma_f32_16x16x32_bf16 v[96:99], v[212:215], v[188:191], v[96:99]
    v_mfma_f32_16x16x32_bf16 v[124:127], v[212:215], v[192:195], v[124:127]
    v_mfma_f32_16x16x32_bf16 v[128:131], v[216:219], v[192:195], v[128:131]
    s_add_u32 s43, s43, 1
    v_mfma_f32_16x16x32_bf16 v[100:103], v[216:219], v[188:191], v[100:103]
    v_mfma_f32_16x16x32_bf16 v[72:75], v[216:219], v[184:187], v[72:75]
    v_mfma_f32_16x16x32_bf16 v[44:47], v[216:219], v[180:183], v[44:47]
    v_mfma_f32_16x16x32_bf16 v[48:51], v[220:223], v[180:183], v[48:51]
    v_mfma_f32_16x16x32_bf16 v[76:79], v[220:223], v[184:187], v[76:79]
    v_mfma_f32_16x16x32_bf16 v[104:107], v[220:223], v[188:191], v[104:107]
    v_mfma_f32_16x16x32_bf16 v[132:135], v[220:223], v[192:195], v[132:135]
    s_load_dwordx2 s[6:7], s[0:1], 88
    s_mov_b32 s16, s62
    s_mov_b32 s17, s63
    s_mov_b32 s18, 0x1be000
    s_mov_b32 s19, 0x20000
    s_mul_i32 s39, s37, 229376
    s_mul_i32 s40, s29, 7
    s_lshl2_add_u32 s41, s35, s40
    s_add_u32 s36, s41, 0
    s_lshr_b32 s53, s36, 3
    s_lshl_b32 s53, s53, 14
    s_and_b32 s44, s36, 7
    s_lshl_b32 s44, s44, 10
    s_add_u32 s44, s44, s53
    s_add_u32 s44, s44, s39
    s_add_u32 s36, s41, 1
    s_lshr_b32 s53, s36, 3
    s_lshl_b32 s53, s53, 14
    s_and_b32 s45, s36, 7
    s_lshl_b32 s45, s45, 10
    s_add_u32 s45, s45, s53
    s_add_u32 s45, s45, s39
    s_add_u32 s36, s41, 2
    s_lshr_b32 s53, s36, 3
    s_lshl_b32 s53, s53, 14
    s_and_b32 s46, s36, 7
    s_lshl_b32 s46, s46, 10
    s_add_u32 s46, s46, s53
    s_add_u32 s46, s46, s39
    s_add_u32 s36, s40, 3
    s_lshr_b32 s53, s36, 3
    s_lshl_b32 s53, s53, 14
    s_and_b32 s47, s36, 7
    s_lshl_b32 s47, s47, 10
    s_add_u32 s47, s47, s53
    s_add_u32 s47, s47, s39
    s_lshl_b32 s36, s35, 9
    s_add_u32 s47, s47, s36
    s_lshl1_add_u32 s49, s31, s34
    s_lshl_b32 s49, s49, 7
    s_add_u32 s49, s49, s55
    s_add_u32 s49, s49, 0x1000
    s_lshl_b32 s86, s60, 24
    s_lshl_b32 s87, s94, 13
    s_add_u32 s86, s86, s87
    s_add_u32 s86, s86, 167772160
    s_add_u32 s84, s4, s86
    s_addc_u32 s85, s5, 0
    s_mov_b32 s86, 8380416
    s_mov_b32 s87, 0x20000
    s_add_u32 s88, s62, 0x480000
    s_addc_u32 s89, s63, 0
    s_mov_b32 s90, 0x7e000
    s_mov_b32 s91, 0x20000
    s_add_u32 s24, s62, 0x400000
    s_addc_u32 s25, s63, 0
    s_mov_b32 s26, 0x7e000
    s_mov_b32 s27, 0x20000
    s_lshl1_add_u32 s39, s33, s35
    s_lshl_b32 s36, s39, 1
    s_lshr_b32 s53, s36, 3
    s_lshl_b32 s53, s53, 14
    s_and_b32 s40, s36, 7
    s_lshl_b32 s40, s40, 10
    s_add_u32 s40, s40, s53
    s_lshl1_add_u32 s38, s31, s37
    s_lshl_b32 s36, s38, 16
    s_add_u32 s40, s40, s36
    s_add_u32 s12, s40, 65536
    s_xor_b32 s41, s40, 0x20000
    s_lshl3_add_u32 s38, s28, s38
    s_lshl_b32 s39, s39, 7
    s_lshl_b32 s13, s38, 16
    s_add_u32 s13, s13, s39
    s_add_u32 s14, s13, 65536
    s_lshl_b32 s38, s38, 15
    s_add_u32 s38, s38, s39
    s_add_u32 s39, s38, 32768
    s_mov_b32 s15, 0xffff0000
    s_waitcnt lgkmcnt(0)
    s_mov_b32 s20, s6
    s_mov_b32 s21, s7
    s_mov_b32 s22, 0x400000
    s_mov_b32 s23, 0x20000
    v_lshrrev_b32 v254, 1, v23
    v_lshlrev_b32 v254, 8, v254
    v_lshl_add_u32 v254, v22, 4, v254
    v_and_b32 v6, 1, v23
    v_lshl_add_u32 v254, v6, 3, v254
    v_lshrrev_b32 v6, 2, v22
    v_cmp_eq_u32 vcc, v6, v23
    v_and_b32 v6, 1, v22
    v_lshlrev_b32 v6, 4, v6
    v_mov_b32 v224, 0x3f80
    v_lshlrev_b32 v6, v6, v224
    v_cndmask_b32 v6, 0, v6, vcc
    v_and_b32 v224, 2, v22
    v_cmp_eq_u32 vcc, 0, v224
    v_mov_b32 v224, 0
    v_mov_b32 v225, 0
    v_mov_b32 v228, 0
    v_mov_b32 v229, 0
    v_cndmask_b32 v226, 0, v6, vcc
    v_cndmask_b32 v227, v6, v224, vcc
    v_and_b32 v6, 3, v22
    v_lshrrev_b32 v255, 2, v22
    v_lshlrev_b32 v255, 14, v255
    v_lshl_add_u32 v255, v6, 11, v255
    v_lshl_add_u32 v255, v23, 4, v255
    v_mov_b32 v8, 1
    v_mov_b32 v9, 0x7f000000
    v_writelane_b32 v9, 0, 0
    v_and_b32 v11, 1, v23
    v_lshlrev_b32 v10, 11, v22
    v_lshl_add_u32 v10, v11, 5, v10
    v_lshrrev_b32 v11, 1, v23
    v_lshl_add_u32 v10, v11, 4, v10
    v_cmp_gt_u32 s[50:51], 8, v22
    v_lshrrev_b32 v11, 3, v22
    v_mul_u32_u24 v11, 16320, v11
    v_sub_u32 v10, v10, v11
    v_add_u32 v11, 16384, v10
    s_mul_i32 s36, s35, 448
    s_add_u32 s36, s36, 159744
    v_lshlrev_b32 v6, 4, v23
    v_add_u32 v6, s36, v6
    s_lshl_b32 s36, s34, 10
    s_add_u32 s36, s36, 160768
    v_lshlrev_b32 v7, 4, v22
    v_add_u32 v7, s36, v7
    s_lshl1_add_u32 s36, s37, s35
    s_lshl2_add_u32 s36, s31, s36
    s_lshl_b32 s36, s36, 10
    v_add_u32 v22, s36, v2
    v_xor_b32 v23, 4096, v22
    s_barrier
    ds_read_b128 v[136:139], v17 offset:0
    ds_read_b128 v[140:143], v17 offset:2048
    ds_read_b128 v[144:147], v17 offset:4096
    ds_read_b128 v[148:151], v17 offset:6144
    ds_read_b64_tr_b16 v[152:153], v18 offset:0
    ds_read_b64_tr_b16 v[154:155], v18 offset:7168
    ds_read_b64_tr_b16 v[156:157], v19 offset:32
    ds_read_b64_tr_b16 v[158:159], v19 offset:7200
    ds_read_b64_tr_b16 v[160:161], v18 offset:64
    ds_read_b64_tr_b16 v[162:163], v18 offset:7232
    ds_read_b64_tr_b16 v[164:165], v19 offset:96
    ds_read_b64_tr_b16 v[166:167], v19 offset:7264
    ds_read_b64_tr_b16 v[168:169], v18 offset:128
    ds_read_b64_tr_b16 v[170:171], v18 offset:7296
    ds_read_b64_tr_b16 v[172:173], v19 offset:160
    ds_read_b64_tr_b16 v[174:175], v19 offset:7328
    ds_read_b64_tr_b16 v[176:177], v20 offset:0
    ds_read_b64_tr_b16 v[178:179], v20 offset:7168
mm_20:
    s_waitcnt lgkmcnt(0)
    v_mfma_f32_16x16x32_bf16 v[24:27], v[152:155], v[136:139], v[24:27]
    ds_read_b128 v[180:183], v17 offset:1024
    v_mfma_f32_16x16x32_bf16 v[52:55], v[152:155], v[140:143], v[52:55]
    ds_read_b128 v[184:187], v17 offset:3072
    v_mfma_f32_16x16x32_bf16 v[80:83], v[152:155], v[144:147], v[80:83]
    ds_read_b128 v[188:191], v17 offset:5120
    v_mfma_f32_16x16x32_bf16 v[108:111], v[152:155], v[148:151], v[108:111]
    ds_read_b128 v[192:195], v17 offset:7168
    v_mfma_f32_16x16x32_bf16 v[112:115], v[156:159], v[148:151], v[112:115]
    ds_read_b64_tr_b16 v[196:197], v18 offset:14336
    v_mfma_f32_16x16x32_bf16 v[84:87], v[156:159], v[144:147], v[84:87]
    ds_read_b64_tr_b16 v[198:199], v18 offset:21504
    v_mfma_f32_16x16x32_bf16 v[56:59], v[156:159], v[140:143], v[56:59]
    v_mfma_f32_16x16x32_bf16 v[28:31], v[156:159], v[136:139], v[28:31]
    ds_read_b64_tr_b16 v[200:201], v19 offset:14368
    v_mfma_f32_16x16x32_bf16 v[32:35], v[160:163], v[136:139], v[32:35]
    ds_read_b64_tr_b16 v[202:203], v19 offset:21536
    v_mfma_f32_16x16x32_bf16 v[60:63], v[160:163], v[140:143], v[60:63]
    ds_read_b64_tr_b16 v[204:205], v18 offset:14400
    v_mfma_f32_16x16x32_bf16 v[88:91], v[160:163], v[144:147], v[88:91]
    ds_read_b64_tr_b16 v[206:207], v18 offset:21568
    v_mfma_f32_16x16x32_bf16 v[116:119], v[160:163], v[148:151], v[116:119]
    ds_read_b64_tr_b16 v[208:209], v19 offset:14432
    v_mfma_f32_16x16x32_bf16 v[120:123], v[164:167], v[148:151], v[120:123]
    ds_read_b64_tr_b16 v[210:211], v19 offset:21600
    v_mfma_f32_16x16x32_bf16 v[92:95], v[164:167], v[144:147], v[92:95]
    v_mfma_f32_16x16x32_bf16 v[64:67], v[164:167], v[140:143], v[64:67]
    ds_read_b64_tr_b16 v[212:213], v18 offset:14464
    v_mfma_f32_16x16x32_bf16 v[36:39], v[164:167], v[136:139], v[36:39]
    ds_read_b64_tr_b16 v[214:215], v18 offset:21632
    v_mfma_f32_16x16x32_bf16 v[40:43], v[168:171], v[136:139], v[40:43]
    ds_read_b64_tr_b16 v[216:217], v19 offset:14496
    v_mfma_f32_16x16x32_bf16 v[68:71], v[168:171], v[140:143], v[68:71]
    ds_read_b64_tr_b16 v[218:219], v19 offset:21664
    v_mfma_f32_16x16x32_bf16 v[96:99], v[168:171], v[144:147], v[96:99]
    ds_read_b64_tr_b16 v[220:221], v20 offset:14336
    v_mfma_f32_16x16x32_bf16 v[124:127], v[168:171], v[148:151], v[124:127]
    ds_read_b64_tr_b16 v[222:223], v20 offset:21504
    v_mfma_f32_16x16x32_bf16 v[128:131], v[172:175], v[148:151], v[128:131]
    s_add_u32 s42, s42, 16384
    s_cmp_eq_u32 s42, 49152
    v_mfma_f32_16x16x32_bf16 v[100:103], v[172:175], v[144:147], v[100:103]
    s_cselect_b32 s42, 0, s42
    s_add_u32 s48, s48, 28672
    v_mfma_f32_16x16x32_bf16 v[72:75], v[172:175], v[140:143], v[72:75]
    s_cmp_eq_u32 s48, 86016
    s_cselect_b32 s48, 0, s48
    v_mfma_f32_16x16x32_bf16 v[44:47], v[172:175], v[136:139], v[44:47]
    v_add_u32 v17, s42, v12
    v_add_u32 v18, s48, v13
    v_mfma_f32_16x16x32_bf16 v[48:51], v[176:179], v[136:139], v[48:51]
    v_add_u32 v19, s48, v14
    v_add_u32 v20, s48, v15
    v_mfma_f32_16x16x32_bf16 v[76:79], v[176:179], v[140:143], v[76:79]
    v_mfma_f32_16x16x32_bf16 v[104:107], v[176:179], v[144:147], v[104:107]
    v_mfma_f32_16x16x32_bf16 v[132:135], v[176:179], v[148:151], v[132:135]
    s_waitcnt lgkmcnt(0)
    s_barrier
    v_mfma_f32_16x16x32_bf16 v[24:27], v[196:199], v[180:183], v[24:27]
    ds_read_b128 v[136:139], v17 offset:0
    v_mfma_f32_16x16x32_bf16 v[52:55], v[196:199], v[184:187], v[52:55]
    ds_read_b128 v[140:143], v17 offset:2048
    v_mfma_f32_16x16x32_bf16 v[80:83], v[196:199], v[188:191], v[80:83]
    ds_read_b128 v[144:147], v17 offset:4096
    v_mfma_f32_16x16x32_bf16 v[108:111], v[196:199], v[192:195], v[108:111]
    ds_read_b128 v[148:151], v17 offset:6144
    v_mfma_f32_16x16x32_bf16 v[112:115], v[200:203], v[192:195], v[112:115]
    ds_read_b64_tr_b16 v[152:153], v18 offset:0
    v_mfma_f32_16x16x32_bf16 v[84:87], v[200:203], v[188:191], v[84:87]
    ds_read_b64_tr_b16 v[154:155], v18 offset:7168
    v_mfma_f32_16x16x32_bf16 v[56:59], v[200:203], v[184:187], v[56:59]
    v_mfma_f32_16x16x32_bf16 v[28:31], v[200:203], v[180:183], v[28:31]
    ds_read_b64_tr_b16 v[156:157], v19 offset:32
    v_mfma_f32_16x16x32_bf16 v[32:35], v[204:207], v[180:183], v[32:35]
    ds_read_b64_tr_b16 v[158:159], v19 offset:7200
    v_mfma_f32_16x16x32_bf16 v[60:63], v[204:207], v[184:187], v[60:63]
    ds_read_b64_tr_b16 v[160:161], v18 offset:64
    v_mfma_f32_16x16x32_bf16 v[88:91], v[204:207], v[188:191], v[88:91]
    ds_read_b64_tr_b16 v[162:163], v18 offset:7232
    v_mfma_f32_16x16x32_bf16 v[116:119], v[204:207], v[192:195], v[116:119]
    ds_read_b64_tr_b16 v[164:165], v19 offset:96
    v_mfma_f32_16x16x32_bf16 v[120:123], v[208:211], v[192:195], v[120:123]
    ds_read_b64_tr_b16 v[166:167], v19 offset:7264
    v_mfma_f32_16x16x32_bf16 v[92:95], v[208:211], v[188:191], v[92:95]
    v_mfma_f32_16x16x32_bf16 v[64:67], v[208:211], v[184:187], v[64:67]
    ds_read_b64_tr_b16 v[168:169], v18 offset:128
    v_mfma_f32_16x16x32_bf16 v[36:39], v[208:211], v[180:183], v[36:39]
    ds_read_b64_tr_b16 v[170:171], v18 offset:7296
    v_mfma_f32_16x16x32_bf16 v[40:43], v[212:215], v[180:183], v[40:43]
    ds_read_b64_tr_b16 v[172:173], v19 offset:160
    v_mfma_f32_16x16x32_bf16 v[68:71], v[212:215], v[184:187], v[68:71]
    ds_read_b64_tr_b16 v[174:175], v19 offset:7328
    v_mfma_f32_16x16x32_bf16 v[96:99], v[212:215], v[188:191], v[96:99]
    ds_read_b64_tr_b16 v[176:177], v20 offset:0
    v_mfma_f32_16x16x32_bf16 v[124:127], v[212:215], v[192:195], v[124:127]
    ds_read_b64_tr_b16 v[178:179], v20 offset:7168
    v_mfma_f32_16x16x32_bf16 v[128:131], v[216:219], v[192:195], v[128:131]
    s_add_u32 s43, s43, 1
    v_mfma_f32_16x16x32_bf16 v[100:103], v[216:219], v[188:191], v[100:103]
    s_cmp_lt_u32 s43, 15
    v_mfma_f32_16x16x32_bf16 v[72:75], v[216:219], v[184:187], v[72:75]
    v_mfma_f32_16x16x32_bf16 v[44:47], v[216:219], v[180:183], v[44:47]
    v_mfma_f32_16x16x32_bf16 v[48:51], v[220:223], v[180:183], v[48:51]
    v_mfma_f32_16x16x32_bf16 v[76:79], v[220:223], v[184:187], v[76:79]
    v_mfma_f32_16x16x32_bf16 v[104:107], v[220:223], v[188:191], v[104:107]
    v_mfma_f32_16x16x32_bf16 v[132:135], v[220:223], v[192:195], v[132:135]
    s_cbranch_scc1 mm_20
    s_waitcnt lgkmcnt(0)
    v_mfma_f32_16x16x32_bf16 v[24:27], v[152:155], v[136:139], v[24:27]
    ds_read_b128 v[180:183], v17 offset:1024
    v_mfma_f32_16x16x32_bf16 v[52:55], v[152:155], v[140:143], v[52:55]
    ds_read_b128 v[184:187], v17 offset:3072
    v_mfma_f32_16x16x32_bf16 v[80:83], v[152:155], v[144:147], v[80:83]
    ds_read_b128 v[188:191], v17 offset:5120
    v_mfma_f32_16x16x32_bf16 v[108:111], v[152:155], v[148:151], v[108:111]
    ds_read_b128 v[192:195], v17 offset:7168
    v_mfma_f32_16x16x32_bf16 v[112:115], v[156:159], v[148:151], v[112:115]
    ds_read_b64_tr_b16 v[196:197], v18 offset:14336
    v_mfma_f32_16x16x32_bf16 v[84:87], v[156:159], v[144:147], v[84:87]
    ds_read_b64_tr_b16 v[198:199], v18 offset:21504
    v_mfma_f32_16x16x32_bf16 v[56:59], v[156:159], v[140:143], v[56:59]
    v_mfma_f32_16x16x32_bf16 v[28:31], v[156:159], v[136:139], v[28:31]
    ds_read_b64_tr_b16 v[200:201], v19 offset:14368
    v_mfma_f32_16x16x32_bf16 v[32:35], v[160:163], v[136:139], v[32:35]
    ds_read_b64_tr_b16 v[202:203], v19 offset:21536
    v_mfma_f32_16x16x32_bf16 v[60:63], v[160:163], v[140:143], v[60:63]
    ds_read_b64_tr_b16 v[204:205], v18 offset:14400
    v_mfma_f32_16x16x32_bf16 v[88:91], v[160:163], v[144:147], v[88:91]
    ds_read_b64_tr_b16 v[206:207], v18 offset:21568
    v_mfma_f32_16x16x32_bf16 v[116:119], v[160:163], v[148:151], v[116:119]
    ds_read_b64_tr_b16 v[208:209], v19 offset:14432
    v_mfma_f32_16x16x32_bf16 v[120:123], v[164:167], v[148:151], v[120:123]
    ds_read_b64_tr_b16 v[210:211], v19 offset:21600
    v_mfma_f32_16x16x32_bf16 v[92:95], v[164:167], v[144:147], v[92:95]
    v_mfma_f32_16x16x32_bf16 v[64:67], v[164:167], v[140:143], v[64:67]
    ds_read_b64_tr_b16 v[212:213], v18 offset:14464
    v_mfma_f32_16x16x32_bf16 v[36:39], v[164:167], v[136:139], v[36:39]
    ds_read_b64_tr_b16 v[214:215], v18 offset:21632
    v_mfma_f32_16x16x32_bf16 v[40:43], v[168:171], v[136:139], v[40:43]
    ds_read_b64_tr_b16 v[216:217], v19 offset:14496
    v_mfma_f32_16x16x32_bf16 v[68:71], v[168:171], v[140:143], v[68:71]
    ds_read_b64_tr_b16 v[218:219], v19 offset:21664
    v_mfma_f32_16x16x32_bf16 v[96:99], v[168:171], v[144:147], v[96:99]
    ds_read_b64_tr_b16 v[220:221], v20 offset:14336
    v_mfma_f32_16x16x32_bf16 v[124:127], v[168:171], v[148:151], v[124:127]
    ds_read_b64_tr_b16 v[222:223], v20 offset:21504
    v_mfma_f32_16x16x32_bf16 v[128:131], v[172:175], v[148:151], v[128:131]
    v_mfma_f32_16x16x32_bf16 v[100:103], v[172:175], v[144:147], v[100:103]
    v_mfma_f32_16x16x32_bf16 v[72:75], v[172:175], v[140:143], v[72:75]
    v_mfma_f32_16x16x32_bf16 v[44:47], v[172:175], v[136:139], v[44:47]
    v_mfma_f32_16x16x32_bf16 v[48:51], v[176:179], v[136:139], v[48:51]
    v_mfma_f32_16x16x32_bf16 v[76:79], v[176:179], v[140:143], v[76:79]
    v_mfma_f32_16x16x32_bf16 v[104:107], v[176:179], v[144:147], v[104:107]
    v_mfma_f32_16x16x32_bf16 v[132:135], v[176:179], v[148:151], v[132:135]
    s_waitcnt lgkmcnt(0)
    s_barrier
    v_mfma_f32_16x16x32_bf16 v[24:27], v[196:199], v[180:183], v[24:27]
    ds_read_b128 v[136:139], v6 offset:0
    v_mfma_f32_16x16x32_bf16 v[52:55], v[196:199], v[184:187], v[52:55]
    ds_read_b128 v[140:143], v6 offset:64
    v_mfma_f32_16x16x32_bf16 v[80:83], v[196:199], v[188:191], v[80:83]
    v_mfma_f32_16x16x32_bf16 v[108:111], v[196:199], v[192:195], v[108:111]
    ds_read_b128 v[144:147], v6 offset:128
    v_mfma_f32_16x16x32_bf16 v[112:115], v[200:203], v[192:195], v[112:115]
    v_mfma_f32_16x16x32_bf16 v[84:87], v[200:203], v[188:191], v[84:87]
    ds_read_b128 v[148:151], v6 offset:192
    v_mfma_f32_16x16x32_bf16 v[56:59], v[200:203], v[184:187], v[56:59]
    v_mfma_f32_16x16x32_bf16 v[28:31], v[200:203], v[180:183], v[28:31]
    ds_read_b128 v[152:155], v6 offset:256
    v_mfma_f32_16x16x32_bf16 v[32:35], v[204:207], v[180:183], v[32:35]
    v_mfma_f32_16x16x32_bf16 v[60:63], v[204:207], v[184:187], v[60:63]
    ds_read_b128 v[156:159], v6 offset:320
    v_mfma_f32_16x16x32_bf16 v[88:91], v[204:207], v[188:191], v[88:91]
    v_mfma_f32_16x16x32_bf16 v[116:119], v[204:207], v[192:195], v[116:119]
    ds_read_b128 v[160:163], v6 offset:384
    v_mfma_f32_16x16x32_bf16 v[120:123], v[208:211], v[192:195], v[120:123]
    v_mfma_f32_16x16x32_bf16 v[92:95], v[208:211], v[188:191], v[92:95]
    ds_read_b128 v[164:167], v7 offset:0
    v_mfma_f32_16x16x32_bf16 v[64:67], v[208:211], v[184:187], v[64:67]
    v_mfma_f32_16x16x32_bf16 v[36:39], v[208:211], v[180:183], v[36:39]
    ds_read_b128 v[168:171], v7 offset:256
    v_mfma_f32_16x16x32_bf16 v[40:43], v[212:215], v[180:183], v[40:43]
    v_mfma_f32_16x16x32_bf16 v[68:71], v[212:215], v[184:187], v[68:71]
    ds_read_b128 v[172:175], v7 offset:512
    v_mfma_f32_16x16x32_bf16 v[96:99], v[212:215], v[188:191], v[96:99]
    v_mfma_f32_16x16x32_bf16 v[124:127], v[212:215], v[192:195], v[124:127]
    ds_read_b128 v[176:179], v7 offset:768
    v_mfma_f32_16x16x32_bf16 v[128:131], v[216:219], v[192:195], v[128:131]
    v_mfma_f32_16x16x32_bf16 v[100:103], v[216:219], v[188:191], v[100:103]
    v_mfma_f32_16x16x32_bf16 v[72:75], v[216:219], v[184:187], v[72:75]
    v_mfma_f32_16x16x32_bf16 v[44:47], v[216:219], v[180:183], v[44:47]
    v_mfma_f32_16x16x32_bf16 v[48:51], v[220:223], v[180:183], v[48:51]
    v_mfma_f32_16x16x32_bf16 v[76:79], v[220:223], v[184:187], v[76:79]
    v_mfma_f32_16x16x32_bf16 v[104:107], v[220:223], v[188:191], v[104:107]
    v_mfma_f32_16x16x32_bf16 v[132:135], v[220:223], v[192:195], v[132:135]
    s_waitcnt lgkmcnt(0)
    s_nop 7
    v_pk_fma_f32 v[24:25], v[164:165], v[136:137], v[24:25] op_sel_hi:[0,1,1] neg_lo:[1,0,0] neg_hi:[1,0,0]
    v_pk_fma_f32 v[26:27], v[164:165], v[138:139], v[26:27] op_sel_hi:[0,1,1] neg_lo:[1,0,0] neg_hi:[1,0,0]
    v_pk_fma_f32 v[28:29], v[164:165], v[140:141], v[28:29] op_sel_hi:[0,1,1] neg_lo:[1,0,0] neg_hi:[1,0,0]
    v_pk_fma_f32 v[30:31], v[164:165], v[142:143], v[30:31] op_sel_hi:[0,1,1] neg_lo:[1,0,0] neg_hi:[1,0,0]
    v_pk_mul_f32 v[192:193], v[24:25], v[24:25]
    v_pk_mul_f32 v[194:195], v[26:27], v[26:27]
    v_pk_mul_f32 v[196:197], v[28:29], v[28:29]
    v_pk_mul_f32 v[198:199], v[30:31], v[30:31]
    v_pk_fma_f32 v[192:193], v[192:193], v[166:167], v[166:167] op_sel:[0,1,0] op_sel_hi:[1,1,0]
    v_pk_fma_f32 v[194:195], v[194:195], v[166:167], v[166:167] op_sel:[0,1,0] op_sel_hi:[1,1,0]
    v_pk_fma_f32 v[196:197], v[196:197], v[166:167], v[166:167] op_sel:[0,1,0] op_sel_hi:[1,1,0]
    v_pk_fma_f32 v[198:199], v[198:199], v[166:167], v[166:167] op_sel:[0,1,0] op_sel_hi:[1,1,0]
    v_pk_mul_f32 v[192:193], v[192:193], v[24:25]
    v_pk_mul_f32 v[194:195], v[194:195], v[26:27]
    v_pk_mul_f32 v[196:197], v[196:197], v[28:29]
    v_pk_mul_f32 v[198:199], v[198:199], v[30:31]
    v_exp_f32 v192, v192
    v_exp_f32 v193, v193
    v_exp_f32 v194, v194
    v_exp_f32 v195, v195
    v_exp_f32 v196, v196
    v_exp_f32 v197, v197
    v_exp_f32 v198, v198
    v_exp_f32 v199, v199
    v_pk_fma_f32 v[192:193], v[192:193], v[164:165], v[164:165] op_sel:[0,1,1] op_sel_hi:[1,1,1]
    v_pk_fma_f32 v[194:195], v[194:195], v[164:165], v[164:165] op_sel:[0,1,1] op_sel_hi:[1,1,1]
    v_pk_fma_f32 v[196:197], v[196:197], v[164:165], v[164:165] op_sel:[0,1,1] op_sel_hi:[1,1,1]
    v_pk_fma_f32 v[198:199], v[198:199], v[164:165], v[164:165] op_sel:[0,1,1] op_sel_hi:[1,1,1]
    v_rcp_f32 v192, v192
    v_rcp_f32 v193, v193
    v_rcp_f32 v194, v194
    v_rcp_f32 v195, v195
    v_rcp_f32 v196, v196
    v_rcp_f32 v197, v197
    v_rcp_f32 v198, v198
    v_rcp_f32 v199, v199
    v_pk_mul_f32 v[24:25], v[24:25], v[192:193]
    v_pk_mul_f32 v[26:27], v[26:27], v[194:195]
    v_pk_mul_f32 v[28:29], v[28:29], v[196:197]
    v_pk_mul_f32 v[30:31], v[30:31], v[198:199]
    v_cvt_pk_bf16_f32 v24, v24, v25
    v_cvt_pk_bf16_f32 v25, v26, v27
    v_cvt_pk_bf16_f32 v26, v28, v29
    v_cvt_pk_bf16_f32 v27, v30, v31
    ds_write_b128 v22, v[24:27] offset:0
    s_add_u32 s36, s44, 0
    buffer_store_dwordx4 v[24:27], v2, s[16:19], s36 offen sc1
    v_pk_fma_f32 v[52:53], v[168:169], v[136:137], v[52:53] op_sel_hi:[0,1,1] neg_lo:[1,0,0] neg_hi:[1,0,0]
    v_pk_fma_f32 v[54:55], v[168:169], v[138:139], v[54:55] op_sel_hi:[0,1,1] neg_lo:[1,0,0] neg_hi:[1,0,0]
    v_pk_fma_f32 v[56:57], v[168:169], v[140:141], v[56:57] op_sel_hi:[0,1,1] neg_lo:[1,0,0] neg_hi:[1,0,0]
    v_pk_fma_f32 v[58:59], v[168:169], v[142:143], v[58:59] op_sel_hi:[0,1,1] neg_lo:[1,0,0] neg_hi:[1,0,0]
    v_pk_mul_f32 v[192:193], v[52:53], v[52:53]
    v_pk_mul_f32 v[194:195], v[54:55], v[54:55]
    v_pk_mul_f32 v[196:197], v[56:57], v[56:57]
    v_pk_mul_f32 v[198:199], v[58:59], v[58:59]
    v_pk_fma_f32 v[192:193], v[192:193], v[170:171], v[170:171] op_sel:[0,1,0] op_sel_hi:[1,1,0]
    v_pk_fma_f32 v[194:195], v[194:195], v[170:171], v[170:171] op_sel:[0,1,0] op_sel_hi:[1,1,0]
    v_pk_fma_f32 v[196:197], v[196:197], v[170:171], v[170:171] op_sel:[0,1,0] op_sel_hi:[1,1,0]
    v_pk_fma_f32 v[198:199], v[198:199], v[170:171], v[170:171] op_sel:[0,1,0] op_sel_hi:[1,1,0]
    v_pk_mul_f32 v[192:193], v[192:193], v[52:53]
    v_pk_mul_f32 v[194:195], v[194:195], v[54:55]
    v_pk_mul_f32 v[196:197], v[196:197], v[56:57]
    v_pk_mul_f32 v[198:199], v[198:199], v[58:59]
    v_exp_f32 v192, v192
    v_exp_f32 v193, v193
    v_exp_f32 v194, v194
    v_exp_f32 v195, v195
    v_exp_f32 v196, v196
    v_exp_f32 v197, v197
    v_exp_f32 v198, v198
    v_exp_f32 v199, v199
    v_pk_fma_f32 v[192:193], v[192:193], v[168:169], v[168:169] op_sel:[0,1,1] op_sel_hi:[1,1,1]
    v_pk_fma_f32 v[194:195], v[194:195], v[168:169], v[168:169] op_sel:[0,1,1] op_sel_hi:[1,1,1]
    v_pk_fma_f32 v[196:197], v[196:197], v[168:169], v[168:169] op_sel:[0,1,1] op_sel_hi:[1,1,1]
    v_pk_fma_f32 v[198:199], v[198:199], v[168:169], v[168:169] op_sel:[0,1,1] op_sel_hi:[1,1,1]
    v_rcp_f32 v192, v192
    v_rcp_f32 v193, v193
    v_rcp_f32 v194, v194
    v_rcp_f32 v195, v195
    v_rcp_f32 v196, v196
    v_rcp_f32 v197, v197
    v_rcp_f32 v198, v198
    v_rcp_f32 v199, v199
    v_pk_mul_f32 v[52:53], v[52:53], v[192:193]
    v_pk_mul_f32 v[54:55], v[54:55], v[194:195]
    v_pk_mul_f32 v[56:57], v[56:57], v[196:197]
    v_pk_mul_f32 v[58:59], v[58:59], v[198:199]
    v_cvt_pk_bf16_f32 v52, v52, v53
    v_cvt_pk_bf16_f32 v53, v54, v55
    v_cvt_pk_bf16_f32 v54, v56, v57
    v_cvt_pk_bf16_f32 v55, v58, v59
    ds_write_b128 v22, v[52:55] offset:2048
    s_add_u32 s36, s44, 229376
    buffer_store_dwordx4 v[52:55], v2, s[16:19], s36 offen sc1
    v_pk_fma_f32 v[80:81], v[172:173], v[136:137], v[80:81] op_sel_hi:[0,1,1] neg_lo:[1,0,0] neg_hi:[1,0,0]
    v_pk_fma_f32 v[82:83], v[172:173], v[138:139], v[82:83] op_sel_hi:[0,1,1] neg_lo:[1,0,0] neg_hi:[1,0,0]
    v_pk_fma_f32 v[84:85], v[172:173], v[140:141], v[84:85] op_sel_hi:[0,1,1] neg_lo:[1,0,0] neg_hi:[1,0,0]
    v_pk_fma_f32 v[86:87], v[172:173], v[142:143], v[86:87] op_sel_hi:[0,1,1] neg_lo:[1,0,0] neg_hi:[1,0,0]
    v_pk_mul_f32 v[192:193], v[80:81], v[80:81]
    v_pk_mul_f32 v[194:195], v[82:83], v[82:83]
    v_pk_mul_f32 v[196:197], v[84:85], v[84:85]
    v_pk_mul_f32 v[198:199], v[86:87], v[86:87]
    v_pk_fma_f32 v[192:193], v[192:193], v[174:175], v[174:175] op_sel:[0,1,0] op_sel_hi:[1,1,0]
    v_pk_fma_f32 v[194:195], v[194:195], v[174:175], v[174:175] op_sel:[0,1,0] op_sel_hi:[1,1,0]
    v_pk_fma_f32 v[196:197], v[196:197], v[174:175], v[174:175] op_sel:[0,1,0] op_sel_hi:[1,1,0]
    v_pk_fma_f32 v[198:199], v[198:199], v[174:175], v[174:175] op_sel:[0,1,0] op_sel_hi:[1,1,0]
    v_pk_mul_f32 v[192:193], v[192:193], v[80:81]
    v_pk_mul_f32 v[194:195], v[194:195], v[82:83]
    v_pk_mul_f32 v[196:197], v[196:197], v[84:85]
    v_pk_mul_f32 v[198:199], v[198:199], v[86:87]
    v_exp_f32 v192, v192
    v_exp_f32 v193, v193
    v_exp_f32 v194, v194
    v_exp_f32 v195, v195
    v_exp_f32 v196, v196
    v_exp_f32 v197, v197
    v_exp_f32 v198, v198
    v_exp_f32 v199, v199
    v_pk_fma_f32 v[192:193], v[192:193], v[172:173], v[172:173] op_sel:[0,1,1] op_sel_hi:[1,1,1]
    v_pk_fma_f32 v[194:195], v[194:195], v[172:173], v[172:173] op_sel:[0,1,1] op_sel_hi:[1,1,1]
    v_pk_fma_f32 v[196:197], v[196:197], v[172:173], v[172:173] op_sel:[0,1,1] op_sel_hi:[1,1,1]
    v_pk_fma_f32 v[198:199], v[198:199], v[172:173], v[172:173] op_sel:[0,1,1] op_sel_hi:[1,1,1]
    v_rcp_f32 v192, v192
    v_rcp_f32 v193, v193
    v_rcp_f32 v194, v194
    v_rcp_f32 v195, v195
    v_rcp_f32 v196, v196
    v_rcp_f32 v197, v197
    v_rcp_f32 v198, v198
    v_rcp_f32 v199, v199
    v_pk_mul_f32 v[80:81], v[80:81], v[192:193]
    v_pk_mul_f32 v[82:83], v[82:83], v[194:195]
    v_pk_mul_f32 v[84:85], v[84:85], v[196:197]
    v_pk_mul_f32 v[86:87], v[86:87], v[198:199]
    v_cvt_pk_bf16_f32 v80, v80, v81
    v_cvt_pk_bf16_f32 v81, v82, v83
    v_cvt_pk_bf16_f32 v82, v84, v85
    v_cvt_pk_bf16_f32 v83, v86, v87
    ds_write_b128 v23, v[80:83] offset:0
    s_add_u32 s36, s44, 458752
    buffer_store_dwordx4 v[80:83], v2, s[16:19], s36 offen sc1
    v_pk_fma_f32 v[108:109], v[176:177], v[136:137], v[108:109] op_sel_hi:[0,1,1] neg_lo:[1,0,0] neg_hi:[1,0,0]
    v_pk_fma_f32 v[110:111], v[176:177], v[138:139], v[110:111] op_sel_hi:[0,1,1] neg_lo:[1,0,0] neg_hi:[1,0,0]
    v_pk_fma_f32 v[112:113], v[176:177], v[140:141], v[112:113] op_sel_hi:[0,1,1] neg_lo:[1,0,0] neg_hi:[1,0,0]
    v_pk_fma_f32 v[114:115], v[176:177], v[142:143], v[114:115] op_sel_hi:[0,1,1] neg_lo:[1,0,0] neg_hi:[1,0,0]
    v_pk_mul_f32 v[192:193], v[108:109], v[108:109]
    v_pk_mul_f32 v[194:195], v[110:111], v[110:111]
    v_pk_mul_f32 v[196:197], v[112:113], v[112:113]
    v_pk_mul_f32 v[198:199], v[114:115], v[114:115]
    v_pk_fma_f32 v[192:193], v[192:193], v[178:179], v[178:179] op_sel:[0,1,0] op_sel_hi:[1,1,0]
    v_pk_fma_f32 v[194:195], v[194:195], v[178:179], v[178:179] op_sel:[0,1,0] op_sel_hi:[1,1,0]
    v_pk_fma_f32 v[196:197], v[196:197], v[178:179], v[178:179] op_sel:[0,1,0] op_sel_hi:[1,1,0]
    v_pk_fma_f32 v[198:199], v[198:199], v[178:179], v[178:179] op_sel:[0,1,0] op_sel_hi:[1,1,0]
    v_pk_mul_f32 v[192:193], v[192:193], v[108:109]
    v_pk_mul_f32 v[194:195], v[194:195], v[110:111]
    v_pk_mul_f32 v[196:197], v[196:197], v[112:113]
    v_pk_mul_f32 v[198:199], v[198:199], v[114:115]
    v_exp_f32 v192, v192
    v_exp_f32 v193, v193
    v_exp_f32 v194, v194
    v_exp_f32 v195, v195
    v_exp_f32 v196, v196
    v_exp_f32 v197, v197
    v_exp_f32 v198, v198
    v_exp_f32 v199, v199
    v_pk_fma_f32 v[192:193], v[192:193], v[176:177], v[176:177] op_sel:[0,1,1] op_sel_hi:[1,1,1]
    v_pk_fma_f32 v[194:195], v[194:195], v[176:177], v[176:177] op_sel:[0,1,1] op_sel_hi:[1,1,1]
    v_pk_fma_f32 v[196:197], v[196:197], v[176:177], v[176:177] op_sel:[0,1,1] op_sel_hi:[1,1,1]
    v_pk_fma_f32 v[198:199], v[198:199], v[176:177], v[176:177] op_sel:[0,1,1] op_sel_hi:[1,1,1]
    v_rcp_f32 v192, v192
    v_rcp_f32 v193, v193
    v_rcp_f32 v194, v194
    v_rcp_f32 v195, v195
    v_rcp_f32 v196, v196
    v_rcp_f32 v197, v197
    v_rcp_f32 v198, v198
    v_rcp_f32 v199, v199
    v_pk_mul_f32 v[108:109], v[108:109], v[192:193]
    v_pk_mul_f32 v[110:111], v[110:111], v[194:195]
    v_pk_mul_f32 v[112:113], v[112:113], v[196:197]
    v_pk_mul_f32 v[114:115], v[114:115], v[198:199]
    v_cvt_pk_bf16_f32 v108, v108, v109
    v_cvt_pk_bf16_f32 v109, v110, v111
    v_cvt_pk_bf16_f32 v110, v112, v113
    v_cvt_pk_bf16_f32 v111, v114, v115
    ds_write_b128 v23, v[108:111] offset:2048
    s_add_u32 s36, s44, 688128
    buffer_store_dwordx4 v[108:111], v2, s[16:19], s36 offen sc1
    v_pk_fma_f32 v[32:33], v[164:165], v[144:145], v[32:33] op_sel_hi:[0,1,1] neg_lo:[1,0,0] neg_hi:[1,0,0]
    v_pk_fma_f32 v[34:35], v[164:165], v[146:147], v[34:35] op_sel_hi:[0,1,1] neg_lo:[1,0,0] neg_hi:[1,0,0]
    v_pk_fma_f32 v[36:37], v[164:165], v[148:149], v[36:37] op_sel_hi:[0,1,1] neg_lo:[1,0,0] neg_hi:[1,0,0]
    v_pk_fma_f32 v[38:39], v[164:165], v[150:151], v[38:39] op_sel_hi:[0,1,1] neg_lo:[1,0,0] neg_hi:[1,0,0]
    v_pk_mul_f32 v[192:193], v[32:33], v[32:33]
    v_pk_mul_f32 v[194:195], v[34:35], v[34:35]
    v_pk_mul_f32 v[196:197], v[36:37], v[36:37]
    v_pk_mul_f32 v[198:199], v[38:39], v[38:39]
    v_pk_fma_f32 v[192:193], v[192:193], v[166:167], v[166:167] op_sel:[0,1,0] op_sel_hi:[1,1,0]
    v_pk_fma_f32 v[194:195], v[194:195], v[166:167], v[166:167] op_sel:[0,1,0] op_sel_hi:[1,1,0]
    v_pk_fma_f32 v[196:197], v[196:197], v[166:167], v[166:167] op_sel:[0,1,0] op_sel_hi:[1,1,0]
    v_pk_fma_f32 v[198:199], v[198:199], v[166:167], v[166:167] op_sel:[0,1,0] op_sel_hi:[1,1,0]
    v_pk_mul_f32 v[192:193], v[192:193], v[32:33]
    v_pk_mul_f32 v[194:195], v[194:195], v[34:35]
    v_pk_mul_f32 v[196:197], v[196:197], v[36:37]
    v_pk_mul_f32 v[198:199], v[198:199], v[38:39]
    v_exp_f32 v192, v192
    v_exp_f32 v193, v193
    v_exp_f32 v194, v194
    v_exp_f32 v195, v195
    v_exp_f32 v196, v196
    v_exp_f32 v197, v197
    v_exp_f32 v198, v198
    v_exp_f32 v199, v199
    v_pk_fma_f32 v[192:193], v[192:193], v[164:165], v[164:165] op_sel:[0,1,1] op_sel_hi:[1,1,1]
    v_pk_fma_f32 v[194:195], v[194:195], v[164:165], v[164:165] op_sel:[0,1,1] op_sel_hi:[1,1,1]
    v_pk_fma_f32 v[196:197], v[196:197], v[164:165], v[164:165] op_sel:[0,1,1] op_sel_hi:[1,1,1]
    v_pk_fma_f32 v[198:199], v[198:199], v[164:165], v[164:165] op_sel:[0,1,1] op_sel_hi:[1,1,1]
    v_rcp_f32 v192, v192
    v_rcp_f32 v193, v193
    v_rcp_f32 v194, v194
    v_rcp_f32 v195, v195
    v_rcp_f32 v196, v196
    v_rcp_f32 v197, v197
    v_rcp_f32 v198, v198
    v_rcp_f32 v199, v199
    v_pk_mul_f32 v[32:33], v[32:33], v[192:193]
    v_pk_mul_f32 v[34:35], v[34:35], v[194:195]
    v_pk_mul_f32 v[36:37], v[36:37], v[196:197]
    v_pk_mul_f32 v[38:39], v[38:39], v[198:199]
    v_cvt_pk_bf16_f32 v32, v32, v33
    v_cvt_pk_bf16_f32 v33, v34, v35
    v_cvt_pk_bf16_f32 v34, v36, v37
    v_cvt_pk_bf16_f32 v35, v38, v39
    ds_write_b128 v22, v[32:35] offset:16384
    v_pk_fma_f32 v[60:61], v[168:169], v[144:145], v[60:61] op_sel_hi:[0,1,1] neg_lo:[1,0,0] neg_hi:[1,0,0]
    v_pk_fma_f32 v[62:63], v[168:169], v[146:147], v[62:63] op_sel_hi:[0,1,1] neg_lo:[1,0,0] neg_hi:[1,0,0]
    v_pk_fma_f32 v[64:65], v[168:169], v[148:149], v[64:65] op_sel_hi:[0,1,1] neg_lo:[1,0,0] neg_hi:[1,0,0]
    v_pk_fma_f32 v[66:67], v[168:169], v[150:151], v[66:67] op_sel_hi:[0,1,1] neg_lo:[1,0,0] neg_hi:[1,0,0]
    v_pk_mul_f32 v[192:193], v[60:61], v[60:61]
    v_pk_mul_f32 v[194:195], v[62:63], v[62:63]
    v_pk_mul_f32 v[196:197], v[64:65], v[64:65]
    v_pk_mul_f32 v[198:199], v[66:67], v[66:67]
    v_pk_fma_f32 v[192:193], v[192:193], v[170:171], v[170:171] op_sel:[0,1,0] op_sel_hi:[1,1,0]
    v_pk_fma_f32 v[194:195], v[194:195], v[170:171], v[170:171] op_sel:[0,1,0] op_sel_hi:[1,1,0]
    v_pk_fma_f32 v[196:197], v[196:197], v[170:171], v[170:171] op_sel:[0,1,0] op_sel_hi:[1,1,0]
    v_pk_fma_f32 v[198:199], v[198:199], v[170:171], v[170:171] op_sel:[0,1,0] op_sel_hi:[1,1,0]
    v_pk_mul_f32 v[192:193], v[192:193], v[60:61]
    v_pk_mul_f32 v[194:195], v[194:195], v[62:63]
    v_pk_mul_f32 v[196:197], v[196:197], v[64:65]
    v_pk_mul_f32 v[198:199], v[198:199], v[66:67]
    v_exp_f32 v192, v192
    v_exp_f32 v193, v193
    v_exp_f32 v194, v194
    v_exp_f32 v195, v195
    v_exp_f32 v196, v196
    v_exp_f32 v197, v197
    v_exp_f32 v198, v198
    v_exp_f32 v199, v199
    v_pk_fma_f32 v[192:193], v[192:193], v[168:169], v[168:169] op_sel:[0,1,1] op_sel_hi:[1,1,1]
    v_pk_fma_f32 v[194:195], v[194:195], v[168:169], v[168:169] op_sel:[0,1,1] op_sel_hi:[1,1,1]
    v_pk_fma_f32 v[196:197], v[196:197], v[168:169], v[168:169] op_sel:[0,1,1] op_sel_hi:[1,1,1]
    v_pk_fma_f32 v[198:199], v[198:199], v[168:169], v[168:169] op_sel:[0,1,1] op_sel_hi:[1,1,1]
    v_rcp_f32 v192, v192
    v_rcp_f32 v193, v193
    v_rcp_f32 v194, v194
    v_rcp_f32 v195, v195
    v_rcp_f32 v196, v196
    v_rcp_f32 v197, v197
    v_rcp_f32 v198, v198
    v_rcp_f32 v199, v199
    v_pk_mul_f32 v[60:61], v[60:61], v[192:193]
    v_pk_mul_f32 v[62:63], v[62:63], v[194:195]
    v_pk_mul_f32 v[64:65], v[64:65], v[196:197]
    v_pk_mul_f32 v[66:67], v[66:67], v[198:199]
    v_cvt_pk_bf16_f32 v60, v60, v61
    v_cvt_pk_bf16_f32 v61, v62, v63
    v_cvt_pk_bf16_f32 v62, v64, v65
    v_cvt_pk_bf16_f32 v63, v66, v67
    ds_write_b128 v22, v[60:63] offset:18432
    v_pk_fma_f32 v[88:89], v[172:173], v[144:145], v[88:89] op_sel_hi:[0,1,1] neg_lo:[1,0,0] neg_hi:[1,0,0]
    v_pk_fma_f32 v[90:91], v[172:173], v[146:147], v[90:91] op_sel_hi:[0,1,1] neg_lo:[1,0,0] neg_hi:[1,0,0]
    v_pk_fma_f32 v[92:93], v[172:173], v[148:149], v[92:93] op_sel_hi:[0,1,1] neg_lo:[1,0,0] neg_hi:[1,0,0]
    v_pk_fma_f32 v[94:95], v[172:173], v[150:151], v[94:95] op_sel_hi:[0,1,1] neg_lo:[1,0,0] neg_hi:[1,0,0]
    v_pk_mul_f32 v[192:193], v[88:89], v[88:89]
    v_pk_mul_f32 v[194:195], v[90:91], v[90:91]
    v_pk_mul_f32 v[196:197], v[92:93], v[92:93]
    v_pk_mul_f32 v[198:199], v[94:95], v[94:95]
    v_pk_fma_f32 v[192:193], v[192:193], v[174:175], v[174:175] op_sel:[0,1,0] op_sel_hi:[1,1,0]
    v_pk_fma_f32 v[194:195], v[194:195], v[174:175], v[174:175] op_sel:[0,1,0] op_sel_hi:[1,1,0]
    v_pk_fma_f32 v[196:197], v[196:197], v[174:175], v[174:175] op_sel:[0,1,0] op_sel_hi:[1,1,0]
    v_pk_fma_f32 v[198:199], v[198:199], v[174:175], v[174:175] op_sel:[0,1,0] op_sel_hi:[1,1,0]
    v_pk_mul_f32 v[192:193], v[192:193], v[88:89]
    v_pk_mul_f32 v[194:195], v[194:195], v[90:91]
    v_pk_mul_f32 v[196:197], v[196:197], v[92:93]
    v_pk_mul_f32 v[198:199], v[198:199], v[94:95]
    v_exp_f32 v192, v192
    v_exp_f32 v193, v193
    v_exp_f32 v194, v194
    v_exp_f32 v195, v195
    v_exp_f32 v196, v196
    v_exp_f32 v197, v197
    v_exp_f32 v198, v198
    v_exp_f32 v199, v199
    v_pk_fma_f32 v[192:193], v[192:193], v[172:173], v[172:173] op_sel:[0,1,1] op_sel_hi:[1,1,1]
    v_pk_fma_f32 v[194:195], v[194:195], v[172:173], v[172:173] op_sel:[0,1,1] op_sel_hi:[1,1,1]
    v_pk_fma_f32 v[196:197], v[196:197], v[172:173], v[172:173] op_sel:[0,1,1] op_sel_hi:[1,1,1]
    v_pk_fma_f32 v[198:199], v[198:199], v[172:173], v[172:173] op_sel:[0,1,1] op_sel_hi:[1,1,1]
    v_rcp_f32 v192, v192
    v_rcp_f32 v193, v193
    v_rcp_f32 v194, v194
    v_rcp_f32 v195, v195
    v_rcp_f32 v196, v196
    v_rcp_f32 v197, v197
    v_rcp_f32 v198, v198
    v_rcp_f32 v199, v199
    v_pk_mul_f32 v[88:89], v[88:89], v[192:193]
    v_pk_mul_f32 v[90:91], v[90:91], v[194:195]
    v_pk_mul_f32 v[92:93], v[92:93], v[196:197]
    v_pk_mul_f32 v[94:95], v[94:95], v[198:199]
    v_cvt_pk_bf16_f32 v88, v88, v89
    v_cvt_pk_bf16_f32 v89, v90, v91
    v_cvt_pk_bf16_f32 v90, v92, v93
    v_cvt_pk_bf16_f32 v91, v94, v95
    ds_write_b128 v23, v[88:91] offset:16384
    s_waitcnt vmcnt(0)
    buffer_atomic_add v8, v9, s[56:59], s49 offen offset:0 sc1
    buffer_load_dwordx4 v[180:183], v255, s[84:87], s13 offen offset:0 sc1
    buffer_load_dwordx4 v[184:187], v2, s[88:91], s40 offen offset:0 sc1
    v_pk_fma_f32 v[116:117], v[176:177], v[144:145], v[116:117] op_sel_hi:[0,1,1] neg_lo:[1,0,0] neg_hi:[1,0,0]
    v_pk_fma_f32 v[118:119], v[176:177], v[146:147], v[118:119] op_sel_hi:[0,1,1] neg_lo:[1,0,0] neg_hi:[1,0,0]
    v_pk_fma_f32 v[120:121], v[176:177], v[148:149], v[120:121] op_sel_hi:[0,1,1] neg_lo:[1,0,0] neg_hi:[1,0,0]
    v_pk_fma_f32 v[122:123], v[176:177], v[150:151], v[122:123] op_sel_hi:[0,1,1] neg_lo:[1,0,0] neg_hi:[1,0,0]
    v_pk_mul_f32 v[192:193], v[116:117], v[116:117]
    v_pk_mul_f32 v[194:195], v[118:119], v[118:119]
    v_pk_mul_f32 v[196:197], v[120:121], v[120:121]
    v_pk_mul_f32 v[198:199], v[122:123], v[122:123]
    v_pk_fma_f32 v[192:193], v[192:193], v[178:179], v[178:179] op_sel:[0,1,0] op_sel_hi:[1,1,0]
    v_pk_fma_f32 v[194:195], v[194:195], v[178:179], v[178:179] op_sel:[0,1,0] op_sel_hi:[1,1,0]
    v_pk_fma_f32 v[196:197], v[196:197], v[178:179], v[178:179] op_sel:[0,1,0] op_sel_hi:[1,1,0]
    v_pk_fma_f32 v[198:199], v[198:199], v[178:179], v[178:179] op_sel:[0,1,0] op_sel_hi:[1,1,0]
    v_pk_mul_f32 v[192:193], v[192:193], v[116:117]
    v_pk_mul_f32 v[194:195], v[194:195], v[118:119]
    v_pk_mul_f32 v[196:197], v[196:197], v[120:121]
    v_pk_mul_f32 v[198:199], v[198:199], v[122:123]
    v_exp_f32 v192, v192
    v_exp_f32 v193, v193
    v_exp_f32 v194, v194
    v_exp_f32 v195, v195
    v_exp_f32 v196, v196
    v_exp_f32 v197, v197
    v_exp_f32 v198, v198
    v_exp_f32 v199, v199
    v_pk_fma_f32 v[192:193], v[192:193], v[176:177], v[176:177] op_sel:[0,1,1] op_sel_hi:[1,1,1]
    v_pk_fma_f32 v[194:195], v[194:195], v[176:177], v[176:177] op_sel:[0,1,1] op_sel_hi:[1,1,1]
    v_pk_fma_f32 v[196:197], v[196:197], v[176:177], v[176:177] op_sel:[0,1,1] op_sel_hi:[1,1,1]
    v_pk_fma_f32 v[198:199], v[198:199], v[176:177], v[176:177] op_sel:[0,1,1] op_sel_hi:[1,1,1]
    v_rcp_f32 v192, v192
    v_rcp_f32 v193, v193
    v_rcp_f32 v194, v194
    v_rcp_f32 v195, v195
    v_rcp_f32 v196, v196
    v_rcp_f32 v197, v197
    v_rcp_f32 v198, v198
    v_rcp_f32 v199, v199
    v_pk_mul_f32 v[116:117], v[116:117], v[192:193]
    v_pk_mul_f32 v[118:119], v[118:119], v[194:195]
    v_pk_mul_f32 v[120:121], v[120:121], v[196:197]
    v_pk_mul_f32 v[122:123], v[122:123], v[198:199]
    v_cvt_pk_bf16_f32 v116, v116, v117
    v_cvt_pk_bf16_f32 v117, v118, v119
    v_cvt_pk_bf16_f32 v118, v120, v121
    v_cvt_pk_bf16_f32 v119, v122, v123
    ds_write_b128 v23, v[116:119] offset:18432
    buffer_load_dwordx4 v[200:203], v255, s[84:87], s13 offen offset:64 sc1
    buffer_load_dwordx4 v[204:207], v2, s[88:91], s40 offen offset:1024 sc1
    v_pk_fma_f32 v[40:41], v[164:165], v[152:153], v[40:41] op_sel_hi:[0,1,1] neg_lo:[1,0,0] neg_hi:[1,0,0]
    v_pk_fma_f32 v[42:43], v[164:165], v[154:155], v[42:43] op_sel_hi:[0,1,1] neg_lo:[1,0,0] neg_hi:[1,0,0]
    v_pk_fma_f32 v[44:45], v[164:165], v[156:157], v[44:45] op_sel_hi:[0,1,1] neg_lo:[1,0,0] neg_hi:[1,0,0]
    v_pk_fma_f32 v[46:47], v[164:165], v[158:159], v[46:47] op_sel_hi:[0,1,1] neg_lo:[1,0,0] neg_hi:[1,0,0]
    v_pk_mul_f32 v[192:193], v[40:41], v[40:41]
    v_pk_mul_f32 v[194:195], v[42:43], v[42:43]
    v_pk_mul_f32 v[196:197], v[44:45], v[44:45]
    v_pk_mul_f32 v[198:199], v[46:47], v[46:47]
    v_pk_fma_f32 v[192:193], v[192:193], v[166:167], v[166:167] op_sel:[0,1,0] op_sel_hi:[1,1,0]
    v_pk_fma_f32 v[194:195], v[194:195], v[166:167], v[166:167] op_sel:[0,1,0] op_sel_hi:[1,1,0]
    v_pk_fma_f32 v[196:197], v[196:197], v[166:167], v[166:167] op_sel:[0,1,0] op_sel_hi:[1,1,0]
    v_pk_fma_f32 v[198:199], v[198:199], v[166:167], v[166:167] op_sel:[0,1,0] op_sel_hi:[1,1,0]
    v_pk_mul_f32 v[192:193], v[192:193], v[40:41]
    v_pk_mul_f32 v[194:195], v[194:195], v[42:43]
    v_pk_mul_f32 v[196:197], v[196:197], v[44:45]
    v_pk_mul_f32 v[198:199], v[198:199], v[46:47]
    v_exp_f32 v192, v192
    v_exp_f32 v193, v193
    v_exp_f32 v194, v194
    v_exp_f32 v195, v195
    v_exp_f32 v196, v196
    v_exp_f32 v197, v197
    v_exp_f32 v198, v198
    v_exp_f32 v199, v199
    v_pk_fma_f32 v[192:193], v[192:193], v[164:165], v[164:165] op_sel:[0,1,1] op_sel_hi:[1,1,1]
    v_pk_fma_f32 v[194:195], v[194:195], v[164:165], v[164:165] op_sel:[0,1,1] op_sel_hi:[1,1,1]
    v_pk_fma_f32 v[196:197], v[196:197], v[164:165], v[164:165] op_sel:[0,1,1] op_sel_hi:[1,1,1]
    v_pk_fma_f32 v[198:199], v[198:199], v[164:165], v[164:165] op_sel:[0,1,1] op_sel_hi:[1,1,1]
    v_rcp_f32 v192, v192
    v_rcp_f32 v193, v193
    v_rcp_f32 v194, v194
    v_rcp_f32 v195, v195
    v_rcp_f32 v196, v196
    v_rcp_f32 v197, v197
    v_rcp_f32 v198, v198
    v_rcp_f32 v199, v199
    v_pk_mul_f32 v[40:41], v[40:41], v[192:193]
    v_pk_mul_f32 v[42:43], v[42:43], v[194:195]
    v_pk_mul_f32 v[44:45], v[44:45], v[196:197]
    v_pk_mul_f32 v[46:47], v[46:47], v[198:199]
    v_cvt_pk_bf16_f32 v230, v40, v41
    v_cvt_pk_bf16_f32 v231, v42, v43
    v_cvt_pk_bf16_f32 v232, v44, v45
    v_cvt_pk_bf16_f32 v233, v46, v47
    ds_write_b128 v22, v[230:233] offset:32768
    buffer_load_dwordx4 v[208:211], v255, s[84:87], s14 offen offset:0 sc1
    buffer_load_dwordx4 v[212:215], v2, s[88:91], s12 offen offset:0 sc1
    v_pk_fma_f32 v[68:69], v[168:169], v[152:153], v[68:69] op_sel_hi:[0,1,1] neg_lo:[1,0,0] neg_hi:[1,0,0]
    v_pk_fma_f32 v[70:71], v[168:169], v[154:155], v[70:71] op_sel_hi:[0,1,1] neg_lo:[1,0,0] neg_hi:[1,0,0]
    v_pk_fma_f32 v[72:73], v[168:169], v[156:157], v[72:73] op_sel_hi:[0,1,1] neg_lo:[1,0,0] neg_hi:[1,0,0]
    v_pk_fma_f32 v[74:75], v[168:169], v[158:159], v[74:75] op_sel_hi:[0,1,1] neg_lo:[1,0,0] neg_hi:[1,0,0]
    v_pk_mul_f32 v[192:193], v[68:69], v[68:69]
    v_pk_mul_f32 v[194:195], v[70:71], v[70:71]
    v_pk_mul_f32 v[196:197], v[72:73], v[72:73]
    v_pk_mul_f32 v[198:199], v[74:75], v[74:75]
    v_pk_fma_f32 v[192:193], v[192:193], v[170:171], v[170:171] op_sel:[0,1,0] op_sel_hi:[1,1,0]
    v_pk_fma_f32 v[194:195], v[194:195], v[170:171], v[170:171] op_sel:[0,1,0] op_sel_hi:[1,1,0]
    v_pk_fma_f32 v[196:197], v[196:197], v[170:171], v[170:171] op_sel:[0,1,0] op_sel_hi:[1,1,0]
    v_pk_fma_f32 v[198:199], v[198:199], v[170:171], v[170:171] op_sel:[0,1,0] op_sel_hi:[1,1,0]
    v_pk_mul_f32 v[192:193], v[192:193], v[68:69]
    v_pk_mul_f32 v[194:195], v[194:195], v[70:71]
    v_pk_mul_f32 v[196:197], v[196:197], v[72:73]
    v_pk_mul_f32 v[198:199], v[198:199], v[74:75]
    v_exp_f32 v192, v192
    v_exp_f32 v193, v193
    v_exp_f32 v194, v194
    v_exp_f32 v195, v195
    v_exp_f32 v196, v196
    v_exp_f32 v197, v197
    v_exp_f32 v198, v198
    v_exp_f32 v199, v199
    v_pk_fma_f32 v[192:193], v[192:193], v[168:169], v[168:169] op_sel:[0,1,1] op_sel_hi:[1,1,1]
    v_pk_fma_f32 v[194:195], v[194:195], v[168:169], v[168:169] op_sel:[0,1,1] op_sel_hi:[1,1,1]
    v_pk_fma_f32 v[196:197], v[196:197], v[168:169], v[168:169] op_sel:[0,1,1] op_sel_hi:[1,1,1]
    v_pk_fma_f32 v[198:199], v[198:199], v[168:169], v[168:169] op_sel:[0,1,1] op_sel_hi:[1,1,1]
    v_rcp_f32 v192, v192
    v_rcp_f32 v193, v193
    v_rcp_f32 v194, v194
    v_rcp_f32 v195, v195
    v_rcp_f32 v196, v196
    v_rcp_f32 v197, v197
    v_rcp_f32 v198, v198
    v_rcp_f32 v199, v199
    v_pk_mul_f32 v[68:69], v[68:69], v[192:193]
    v_pk_mul_f32 v[70:71], v[70:71], v[194:195]
    v_pk_mul_f32 v[72:73], v[72:73], v[196:197]
    v_pk_mul_f32 v[74:75], v[74:75], v[198:199]
    v_cvt_pk_bf16_f32 v234, v68, v69
    v_cvt_pk_bf16_f32 v235, v70, v71
    v_cvt_pk_bf16_f32 v236, v72, v73
    v_cvt_pk_bf16_f32 v237, v74, v75
    ds_write_b128 v22, v[234:237] offset:34816
    buffer_load_dwordx4 v[216:219], v255, s[84:87], s14 offen offset:64 sc1
    buffer_load_dwordx4 v[220:223], v2, s[88:91], s12 offen offset:1024 sc1
    v_pk_fma_f32 v[96:97], v[172:173], v[152:153], v[96:97] op_sel_hi:[0,1,1] neg_lo:[1,0,0] neg_hi:[1,0,0]
    v_pk_fma_f32 v[98:99], v[172:173], v[154:155], v[98:99] op_sel_hi:[0,1,1] neg_lo:[1,0,0] neg_hi:[1,0,0]
    v_pk_fma_f32 v[100:101], v[172:173], v[156:157], v[100:101] op_sel_hi:[0,1,1] neg_lo:[1,0,0] neg_hi:[1,0,0]
    v_pk_fma_f32 v[102:103], v[172:173], v[158:159], v[102:103] op_sel_hi:[0,1,1] neg_lo:[1,0,0] neg_hi:[1,0,0]
    v_pk_mul_f32 v[192:193], v[96:97], v[96:97]
    v_pk_mul_f32 v[194:195], v[98:99], v[98:99]
    v_pk_mul_f32 v[196:197], v[100:101], v[100:101]
    v_pk_mul_f32 v[198:199], v[102:103], v[102:103]
    v_pk_fma_f32 v[192:193], v[192:193], v[174:175], v[174:175] op_sel:[0,1,0] op_sel_hi:[1,1,0]
    v_pk_fma_f32 v[194:195], v[194:195], v[174:175], v[174:175] op_sel:[0,1,0] op_sel_hi:[1,1,0]
    v_pk_fma_f32 v[196:197], v[196:197], v[174:175], v[174:175] op_sel:[0,1,0] op_sel_hi:[1,1,0]
    v_pk_fma_f32 v[198:199], v[198:199], v[174:175], v[174:175] op_sel:[0,1,0] op_sel_hi:[1,1,0]
    v_pk_mul_f32 v[192:193], v[192:193], v[96:97]
    v_pk_mul_f32 v[194:195], v[194:195], v[98:99]
    v_pk_mul_f32 v[196:197], v[196:197], v[100:101]
    v_pk_mul_f32 v[198:199], v[198:199], v[102:103]
    v_exp_f32 v192, v192
    v_exp_f32 v193, v193
    v_exp_f32 v194, v194
    v_exp_f32 v195, v195
    v_exp_f32 v196, v196
    v_exp_f32 v197, v197
    v_exp_f32 v198, v198
    v_exp_f32 v199, v199
    v_pk_fma_f32 v[192:193], v[192:193], v[172:173], v[172:173] op_sel:[0,1,1] op_sel_hi:[1,1,1]
    v_pk_fma_f32 v[194:195], v[194:195], v[172:173], v[172:173] op_sel:[0,1,1] op_sel_hi:[1,1,1]
    v_pk_fma_f32 v[196:197], v[196:197], v[172:173], v[172:173] op_sel:[0,1,1] op_sel_hi:[1,1,1]
    v_pk_fma_f32 v[198:199], v[198:199], v[172:173], v[172:173] op_sel:[0,1,1] op_sel_hi:[1,1,1]
    v_rcp_f32 v192, v192
    v_rcp_f32 v193, v193
    v_rcp_f32 v194, v194
    v_rcp_f32 v195, v195
    v_rcp_f32 v196, v196
    v_rcp_f32 v197, v197
    v_rcp_f32 v198, v198
    v_rcp_f32 v199, v199
    v_pk_mul_f32 v[96:97], v[96:97], v[192:193]
    v_pk_mul_f32 v[98:99], v[98:99], v[194:195]
    v_pk_mul_f32 v[100:101], v[100:101], v[196:197]
    v_pk_mul_f32 v[102:103], v[102:103], v[198:199]
    v_cvt_pk_bf16_f32 v238, v96, v97
    v_cvt_pk_bf16_f32 v239, v98, v99
    v_cvt_pk_bf16_f32 v240, v100, v101
    v_cvt_pk_bf16_f32 v241, v102, v103
    ds_write_b128 v23, v[238:241] offset:32768
    v_pk_fma_f32 v[124:125], v[176:177], v[152:153], v[124:125] op_sel_hi:[0,1,1] neg_lo:[1,0,0] neg_hi:[1,0,0]
    v_pk_fma_f32 v[126:127], v[176:177], v[154:155], v[126:127] op_sel_hi:[0,1,1] neg_lo:[1,0,0] neg_hi:[1,0,0]
    v_pk_fma_f32 v[128:129], v[176:177], v[156:157], v[128:129] op_sel_hi:[0,1,1] neg_lo:[1,0,0] neg_hi:[1,0,0]
    v_pk_fma_f32 v[130:131], v[176:177], v[158:159], v[130:131] op_sel_hi:[0,1,1] neg_lo:[1,0,0] neg_hi:[1,0,0]
    v_pk_mul_f32 v[192:193], v[124:125], v[124:125]
    v_pk_mul_f32 v[194:195], v[126:127], v[126:127]
    v_pk_mul_f32 v[196:197], v[128:129], v[128:129]
    v_pk_mul_f32 v[198:199], v[130:131], v[130:131]
    v_pk_fma_f32 v[192:193], v[192:193], v[178:179], v[178:179] op_sel:[0,1,0] op_sel_hi:[1,1,0]
    v_pk_fma_f32 v[194:195], v[194:195], v[178:179], v[178:179] op_sel:[0,1,0] op_sel_hi:[1,1,0]
    v_pk_fma_f32 v[196:197], v[196:197], v[178:179], v[178:179] op_sel:[0,1,0] op_sel_hi:[1,1,0]
    v_pk_fma_f32 v[198:199], v[198:199], v[178:179], v[178:179] op_sel:[0,1,0] op_sel_hi:[1,1,0]
    v_pk_mul_f32 v[192:193], v[192:193], v[124:125]
    v_pk_mul_f32 v[194:195], v[194:195], v[126:127]
    v_pk_mul_f32 v[196:197], v[196:197], v[128:129]
    v_pk_mul_f32 v[198:199], v[198:199], v[130:131]
    v_exp_f32 v192, v192
    v_exp_f32 v193, v193
    v_exp_f32 v194, v194
    v_exp_f32 v195, v195
    v_exp_f32 v196, v196
    v_exp_f32 v197, v197
    v_exp_f32 v198, v198
    v_exp_f32 v199, v199
    v_pk_fma_f32 v[192:193], v[192:193], v[176:177], v[176:177] op_sel:[0,1,1] op_sel_hi:[1,1,1]
    v_pk_fma_f32 v[194:195], v[194:195], v[176:177], v[176:177] op_sel:[0,1,1] op_sel_hi:[1,1,1]
    v_pk_fma_f32 v[196:197], v[196:197], v[176:177], v[176:177] op_sel:[0,1,1] op_sel_hi:[1,1,1]
    v_pk_fma_f32 v[198:199], v[198:199], v[176:177], v[176:177] op_sel:[0,1,1] op_sel_hi:[1,1,1]
    v_rcp_f32 v192, v192
    v_rcp_f32 v193, v193
    v_rcp_f32 v194, v194
    v_rcp_f32 v195, v195
    v_rcp_f32 v196, v196
    v_rcp_f32 v197, v197
    v_rcp_f32 v198, v198
    v_rcp_f32 v199, v199
    v_pk_mul_f32 v[124:125], v[124:125], v[192:193]
    v_pk_mul_f32 v[126:127], v[126:127], v[194:195]
    v_pk_mul_f32 v[128:129], v[128:129], v[196:197]
    v_pk_mul_f32 v[130:131], v[130:131], v[198:199]
    v_cvt_pk_bf16_f32 v242, v124, v125
    v_cvt_pk_bf16_f32 v243, v126, v127
    v_cvt_pk_bf16_f32 v244, v128, v129
    v_cvt_pk_bf16_f32 v245, v130, v131
    ds_write_b128 v23, v[242:245] offset:34816
    v_pk_fma_f32 v[48:49], v[164:165], v[160:161], v[48:49] op_sel_hi:[0,1,1] neg_lo:[1,0,0] neg_hi:[1,0,0]
    v_pk_fma_f32 v[50:51], v[164:165], v[162:163], v[50:51] op_sel_hi:[0,1,1] neg_lo:[1,0,0] neg_hi:[1,0,0]
    v_pk_fma_f32 v[76:77], v[168:169], v[160:161], v[76:77] op_sel_hi:[0,1,1] neg_lo:[1,0,0] neg_hi:[1,0,0]
    v_pk_fma_f32 v[78:79], v[168:169], v[162:163], v[78:79] op_sel_hi:[0,1,1] neg_lo:[1,0,0] neg_hi:[1,0,0]
    v_pk_mul_f32 v[192:193], v[48:49], v[48:49]
    v_pk_mul_f32 v[194:195], v[50:51], v[50:51]
    v_pk_mul_f32 v[196:197], v[76:77], v[76:77]
    v_pk_mul_f32 v[198:199], v[78:79], v[78:79]
    v_pk_fma_f32 v[192:193], v[192:193], v[166:167], v[166:167] op_sel:[0,1,0] op_sel_hi:[1,1,0]
    v_pk_fma_f32 v[194:195], v[194:195], v[166:167], v[166:167] op_sel:[0,1,0] op_sel_hi:[1,1,0]
    v_pk_fma_f32 v[196:197], v[196:197], v[170:171], v[170:171] op_sel:[0,1,0] op_sel_hi:[1,1,0]
    v_pk_fma_f32 v[198:199], v[198:199], v[170:171], v[170:171] op_sel:[0,1,0] op_sel_hi:[1,1,0]
    v_pk_mul_f32 v[192:193], v[192:193], v[48:49]
    v_pk_mul_f32 v[194:195], v[194:195], v[50:51]
    v_pk_mul_f32 v[196:197], v[196:197], v[76:77]
    v_pk_mul_f32 v[198:199], v[198:199], v[78:79]
    v_exp_f32 v192, v192
    v_exp_f32 v193, v193
    v_exp_f32 v194, v194
    v_exp_f32 v195, v195
    v_exp_f32 v196, v196
    v_exp_f32 v197, v197
    v_exp_f32 v198, v198
    v_exp_f32 v199, v199
    v_pk_fma_f32 v[192:193], v[192:193], v[164:165], v[164:165] op_sel:[0,1,1] op_sel_hi:[1,1,1]
    v_pk_fma_f32 v[194:195], v[194:195], v[164:165], v[164:165] op_sel:[0,1,1] op_sel_hi:[1,1,1]
    v_pk_fma_f32 v[196:197], v[196:197], v[168:169], v[168:169] op_sel:[0,1,1] op_sel_hi:[1,1,1]
    v_pk_fma_f32 v[198:199], v[198:199], v[168:169], v[168:169] op_sel:[0,1,1] op_sel_hi:[1,1,1]
    v_rcp_f32 v192, v192
    v_rcp_f32 v193, v193
    v_rcp_f32 v194, v194
    v_rcp_f32 v195, v195
    v_rcp_f32 v196, v196
    v_rcp_f32 v197, v197
    v_rcp_f32 v198, v198
    v_rcp_f32 v199, v199
    v_pk_mul_f32 v[48:49], v[48:49], v[192:193]
    v_pk_mul_f32 v[50:51], v[50:51], v[194:195]
    v_pk_mul_f32 v[76:77], v[76:77], v[196:197]
    v_pk_mul_f32 v[78:79], v[78:79], v[198:199]
    v_cvt_pk_bf16_f32 v246, v48, v49
    v_cvt_pk_bf16_f32 v247, v50, v51
    s_add_u32 s36, s45, 0
    buffer_store_dwordx4 v[32:35], v2, s[16:19], s36 offen sc1
    v_cvt_pk_bf16_f32 v248, v76, v77
    v_cvt_pk_bf16_f32 v249, v78, v79
    s_add_u32 s36, s45, 229376
    buffer_store_dwordx4 v[60:63], v2, s[16:19], s36 offen sc1
    v_pk_fma_f32 v[104:105], v[172:173], v[160:161], v[104:105] op_sel_hi:[0,1,1] neg_lo:[1,0,0] neg_hi:[1,0,0]
    v_pk_fma_f32 v[106:107], v[172:173], v[162:163], v[106:107] op_sel_hi:[0,1,1] neg_lo:[1,0,0] neg_hi:[1,0,0]
    v_pk_fma_f32 v[132:133], v[176:177], v[160:161], v[132:133] op_sel_hi:[0,1,1] neg_lo:[1,0,0] neg_hi:[1,0,0]
    v_pk_fma_f32 v[134:135], v[176:177], v[162:163], v[134:135] op_sel_hi:[0,1,1] neg_lo:[1,0,0] neg_hi:[1,0,0]
    v_pk_mul_f32 v[192:193], v[104:105], v[104:105]
    v_pk_mul_f32 v[194:195], v[106:107], v[106:107]
    v_pk_mul_f32 v[196:197], v[132:133], v[132:133]
    v_pk_mul_f32 v[198:199], v[134:135], v[134:135]
    v_pk_fma_f32 v[192:193], v[192:193], v[174:175], v[174:175] op_sel:[0,1,0] op_sel_hi:[1,1,0]
    v_pk_fma_f32 v[194:195], v[194:195], v[174:175], v[174:175] op_sel:[0,1,0] op_sel_hi:[1,1,0]
    v_pk_fma_f32 v[196:197], v[196:197], v[178:179], v[178:179] op_sel:[0,1,0] op_sel_hi:[1,1,0]
    v_pk_fma_f32 v[198:199], v[198:199], v[178:179], v[178:179] op_sel:[0,1,0] op_sel_hi:[1,1,0]
    v_pk_mul_f32 v[192:193], v[192:193], v[104:105]
    v_pk_mul_f32 v[194:195], v[194:195], v[106:107]
    v_pk_mul_f32 v[196:197], v[196:197], v[132:133]
    v_pk_mul_f32 v[198:199], v[198:199], v[134:135]
    v_exp_f32 v192, v192
    v_exp_f32 v193, v193
    v_exp_f32 v194, v194
    v_exp_f32 v195, v195
    v_exp_f32 v196, v196
    v_exp_f32 v197, v197
    v_exp_f32 v198, v198
    v_exp_f32 v199, v199
    v_pk_fma_f32 v[192:193], v[192:193], v[172:173], v[172:173] op_sel:[0,1,1] op_sel_hi:[1,1,1]
    v_pk_fma_f32 v[194:195], v[194:195], v[172:173], v[172:173] op_sel:[0,1,1] op_sel_hi:[1,1,1]
    v_pk_fma_f32 v[196:197], v[196:197], v[176:177], v[176:177] op_sel:[0,1,1] op_sel_hi:[1,1,1]
    v_pk_fma_f32 v[198:199], v[198:199], v[176:177], v[176:177] op_sel:[0,1,1] op_sel_hi:[1,1,1]
    v_rcp_f32 v192, v192
    v_rcp_f32 v193, v193
    v_rcp_f32 v194, v194
    v_rcp_f32 v195, v195
    v_rcp_f32 v196, v196
    v_rcp_f32 v197, v197
    v_rcp_f32 v198, v198
    v_rcp_f32 v199, v199
    v_pk_mul_f32 v[104:105], v[104:105], v[192:193]
    v_pk_mul_f32 v[106:107], v[106:107], v[194:195]
    v_pk_mul_f32 v[132:133], v[132:133], v[196:197]
    v_pk_mul_f32 v[134:135], v[134:135], v[198:199]
    v_cvt_pk_bf16_f32 v250, v104, v105
    v_cvt_pk_bf16_f32 v251, v106, v107
    s_add_u32 s36, s45, 458752
    buffer_store_dwordx4 v[88:91], v2, s[16:19], s36 offen sc1
    v_cvt_pk_bf16_f32 v252, v132, v133
    v_cvt_pk_bf16_f32 v253, v134, v135
    s_add_u32 s36, s45, 688128
    buffer_store_dwordx4 v[116:119], v2, s[16:19], s36 offen sc1
    s_waitcnt vmcnt(4) lgkmcnt(0)
    v_lshrrev_b32 v18, 2, v1
    v_mul_u32_u24 v13, 256, v18
    v_and_b32 v19, 3, v1
    v_lshl_add_u32 v13, v19, 3, v13
    v_add_u32 v13, 49152, v13
    v_and_b32 v18, 7, v18
    s_mul_i32 s36, s35, 4
    s_add_u32 s36, s36, 3
    v_xor_b32 v19, s36, v18
    v_lshl_add_u32 v16, v19, 5, v13
    s_mul_i32 s36, s35, 4
    s_add_u32 s36, s36, 2
    v_xor_b32 v19, s36, v18
    v_lshl_add_u32 v15, v19, 5, v13
    s_mul_i32 s36, s35, 4
    s_add_u32 s36, s36, 1
    v_xor_b32 v19, s36, v18
    v_lshl_add_u32 v14, v19, 5, v13
    s_mul_i32 s36, s35, 4
    s_add_u32 s36, s36, 0
    v_xor_b32 v19, s36, v18
    v_lshl_add_u32 v13, v19, 5, v13
    s_mov_b32 s42, 0
    s_mov_b32 s43, 0
    s_mov_b32 s48, 0
    v_mov_b32 v17, v12
    v_mov_b32 v18, v13
    v_mov_b32 v19, v14
    v_mov_b32 v20, v15
    v_mov_b32 v21, v16
    v_mov_b32 v56, 0x10000
    s_waitcnt lgkmcnt(0)
    s_barrier
    ds_read_b128 v[24:27], v17 offset:0
    ds_read_b128 v[28:31], v17 offset:2048
    ds_read_b128 v[32:35], v17 offset:4096
    ds_read_b128 v[36:39], v17 offset:6144
    ds_read_b64_tr_b16 v[40:41], v18 offset:0
    ds_read_b64_tr_b16 v[42:43], v18 offset:4096
    ds_read_b64_tr_b16 v[44:45], v19 offset:0
    ds_read_b64_tr_b16 v[46:47], v19 offset:4096
    ds_read_b64_tr_b16 v[48:49], v20 offset:0
    ds_read_b64_tr_b16 v[50:51], v20 offset:4096
    ds_read_b64_tr_b16 v[52:53], v21 offset:0
    ds_read_b64_tr_b16 v[54:55], v21 offset:4096
    v_mfma_f32_16x16x32_bf16 v[120:123], v[226:229], v[180:183], 0
    v_mfma_f32_16x16x32_bf16 v[124:127], v[224:227], v[180:183], 0
    v_mfma_f32_16x16x32_bf16 v[128:131], v[226:229], v[200:203], 0
    v_mfma_f32_16x16x32_bf16 v[132:135], v[224:227], v[200:203], 0
    v_mfma_f32_16x16x32_bf16 v[136:139], v[226:229], v[208:211], 0
    v_mfma_f32_16x16x32_bf16 v[140:143], v[224:227], v[208:211], 0
    v_mfma_f32_16x16x32_bf16 v[144:147], v[226:229], v[216:219], 0
    v_mfma_f32_16x16x32_bf16 v[148:151], v[224:227], v[216:219], 0
    v_mfma_f32_16x16x32_bf16 v[120:123], v[226:229], v[184:187], v[120:123]
    v_mfma_f32_16x16x32_bf16 v[124:127], v[224:227], v[184:187], v[124:127]
    v_mfma_f32_16x16x32_bf16 v[128:131], v[226:229], v[204:207], v[128:131]
    v_mfma_f32_16x16x32_bf16 v[132:135], v[224:227], v[204:207], v[132:135]
    v_mfma_f32_16x16x32_bf16 v[136:139], v[226:229], v[212:215], v[136:139]
    v_mfma_f32_16x16x32_bf16 v[140:143], v[224:227], v[212:215], v[140:143]
    v_mfma_f32_16x16x32_bf16 v[144:147], v[226:229], v[220:223], v[144:147]
    v_mfma_f32_16x16x32_bf16 v[148:151], v[224:227], v[220:223], v[148:151]
    s_waitcnt lgkmcnt(0)
    v_mfma_f32_16x16x32_bf16 v[120:123], v[40:43], v[24:27], v[120:123]
    ds_read_b128 v[184:187], v17 offset:1024
    ds_read_b128 v[188:191], v17 offset:3072
    v_mfma_f32_16x16x32_bf16 v[136:139], v[40:43], v[28:31], v[136:139]
    ds_read_b128 v[192:195], v17 offset:5120
    v_mfma_f32_16x16x32_bf16 v[152:155], v[40:43], v[32:35], 0
    ds_read_b128 v[196:199], v17 offset:7168
    v_mfma_f32_16x16x32_bf16 v[168:171], v[40:43], v[36:39], 0
    s_add_u32 s36, s46, 0
    buffer_store_dwordx4 v[230:233], v2, s[16:19], s36 offen sc1
    v_mfma_f32_16x16x32_bf16 v[172:175], v[44:47], v[36:39], 0
    ds_read_b64_tr_b16 v[200:201], v18 offset:8192
    v_mfma_f32_16x16x32_bf16 v[156:159], v[44:47], v[32:35], 0
    ds_read_b64_tr_b16 v[202:203], v18 offset:12288
    v_mfma_f32_16x16x32_bf16 v[140:143], v[44:47], v[28:31], v[140:143]
    ds_read_b64_tr_b16 v[204:205], v19 offset:8192
    s_add_u32 s36, s47, 0
    buffer_store_dwordx2 v[246:247], v254, s[16:19], s36 offen sc1
    v_mfma_f32_16x16x32_bf16 v[124:127], v[44:47], v[24:27], v[124:127]
    ds_read_b64_tr_b16 v[206:207], v19 offset:12288
    v_mfma_f32_16x16x32_bf16 v[128:131], v[48:51], v[24:27], v[128:131]
    ds_read_b64_tr_b16 v[208:209], v20 offset:8192
    v_mfma_f32_16x16x32_bf16 v[144:147], v[48:51], v[28:31], v[144:147]
    ds_read_b64_tr_b16 v[210:211], v20 offset:12288
    v_mfma_f32_16x16x32_bf16 v[160:163], v[48:51], v[32:35], 0
    ds_read_b64_tr_b16 v[212:213], v21 offset:8192
    v_mfma_f32_16x16x32_bf16 v[176:179], v[48:51], v[36:39], 0
    ds_read_b64_tr_b16 v[214:215], v21 offset:12288
    s_add_u32 s42, s42, 16384
    s_cmp_eq_u32 s42, 49152
    s_cselect_b32 s42, 0, s42
    v_mfma_f32_16x16x32_bf16 v[180:183], v[52:55], v[36:39], 0
    s_add_u32 s48, s48, 16384
    s_cmp_eq_u32 s48, 98304
    s_cselect_b32 s48, 0, s48
    v_mfma_f32_16x16x32_bf16 v[164:167], v[52:55], v[32:35], 0
    v_add_u32 v17, s42, v12
    v_add_u32 v18, s48, v13
    v_add_u32 v19, s48, v14
    v_mfma_f32_16x16x32_bf16 v[148:151], v[52:55], v[28:31], v[148:151]
    v_add_u32 v20, s48, v15
    v_add_u32 v21, s48, v16
    v_mfma_f32_16x16x32_bf16 v[132:135], v[52:55], v[24:27], v[132:135]
    s_waitcnt lgkmcnt(0)
    s_barrier
    v_mfma_f32_16x16x32_bf16 v[120:123], v[200:203], v[184:187], v[120:123]
    ds_read_b128 v[24:27], v17 offset:0
    ds_read_b128 v[28:31], v17 offset:2048
    v_mfma_f32_16x16x32_bf16 v[136:139], v[200:203], v[188:191], v[136:139]
    ds_read_b128 v[32:35], v17 offset:4096
    v_mfma_f32_16x16x32_bf16 v[152:155], v[200:203], v[192:195], v[152:155]
    ds_read_b128 v[36:39], v17 offset:6144
    v_mfma_f32_16x16x32_bf16 v[168:171], v[200:203], v[196:199], v[168:171]
    s_add_u32 s36, s46, 229376
    buffer_store_dwordx4 v[234:237], v2, s[16:19], s36 offen sc1
    v_mfma_f32_16x16x32_bf16 v[172:175], v[204:207], v[196:199], v[172:175]
    ds_read_b64_tr_b16 v[40:41], v18 offset:0
    v_mfma_f32_16x16x32_bf16 v[156:159], v[204:207], v[192:195], v[156:159]
    ds_read_b64_tr_b16 v[42:43], v18 offset:4096
    v_mfma_f32_16x16x32_bf16 v[140:143], v[204:207], v[188:191], v[140:143]
    ds_read_b64_tr_b16 v[44:45], v19 offset:0
    s_add_u32 s36, s47, 229376
    buffer_store_dwordx2 v[248:249], v254, s[16:19], s36 offen sc1
    v_mfma_f32_16x16x32_bf16 v[124:127], v[204:207], v[184:187], v[124:127]
    ds_read_b64_tr_b16 v[46:47], v19 offset:4096
    v_mfma_f32_16x16x32_bf16 v[128:131], v[208:211], v[184:187], v[128:131]
    ds_read_b64_tr_b16 v[48:49], v20 offset:0
    v_mfma_f32_16x16x32_bf16 v[144:147], v[208:211], v[188:191], v[144:147]
    ds_read_b64_tr_b16 v[50:51], v20 offset:4096
    v_mfma_f32_16x16x32_bf16 v[160:163], v[208:211], v[192:195], v[160:163]
    ds_read_b64_tr_b16 v[52:53], v21 offset:0
    v_mfma_f32_16x16x32_bf16 v[176:179], v[208:211], v[196:199], v[176:179]
    ds_read_b64_tr_b16 v[54:55], v21 offset:4096
    s_add_u32 s43, s43, 1
    v_mfma_f32_16x16x32_bf16 v[180:183], v[212:215], v[196:199], v[180:183]
    s_cmp_lt_u32 s43, 27
    v_mfma_f32_16x16x32_bf16 v[164:167], v[212:215], v[192:195], v[164:167]
    v_mfma_f32_16x16x32_bf16 v[148:151], v[212:215], v[188:191], v[148:151]
    v_mfma_f32_16x16x32_bf16 v[132:135], v[212:215], v[184:187], v[132:135]
    s_waitcnt lgkmcnt(0)
    v_mfma_f32_16x16x32_bf16 v[120:123], v[40:43], v[24:27], v[120:123]
    ds_read_b128 v[184:187], v17 offset:1024
    ds_read_b128 v[188:191], v17 offset:3072
    v_mfma_f32_16x16x32_bf16 v[136:139], v[40:43], v[28:31], v[136:139]
    ds_read_b128 v[192:195], v17 offset:5120
    v_mfma_f32_16x16x32_bf16 v[152:155], v[40:43], v[32:35], v[152:155]
    ds_read_b128 v[196:199], v17 offset:7168
    v_mfma_f32_16x16x32_bf16 v[168:171], v[40:43], v[36:39], v[168:171]
    s_add_u32 s36, s46, 458752
    buffer_store_dwordx4 v[238:241], v2, s[16:19], s36 offen sc1
    v_mfma_f32_16x16x32_bf16 v[172:175], v[44:47], v[36:39], v[172:175]
    ds_read_b64_tr_b16 v[200:201], v18 offset:8192
    v_mfma_f32_16x16x32_bf16 v[156:159], v[44:47], v[32:35], v[156:159]
    ds_read_b64_tr_b16 v[202:203], v18 offset:12288
    v_mfma_f32_16x16x32_bf16 v[140:143], v[44:47], v[28:31], v[140:143]
    ds_read_b64_tr_b16 v[204:205], v19 offset:8192
    s_add_u32 s36, s47, 458752
    buffer_store_dwordx2 v[250:251], v254, s[16:19], s36 offen sc1
    v_mfma_f32_16x16x32_bf16 v[124:127], v[44:47], v[24:27], v[124:127]
    ds_read_b64_tr_b16 v[206:207], v19 offset:12288
    v_mfma_f32_16x16x32_bf16 v[128:131], v[48:51], v[24:27], v[128:131]
    ds_read_b64_tr_b16 v[208:209], v20 offset:8192
    v_mfma_f32_16x16x32_bf16 v[144:147], v[48:51], v[28:31], v[144:147]
    ds_read_b64_tr_b16 v[210:211], v20 offset:12288
    v_mfma_f32_16x16x32_bf16 v[160:163], v[48:51], v[32:35], v[160:163]
    ds_read_b64_tr_b16 v[212:213], v21 offset:8192
    v_mfma_f32_16x16x32_bf16 v[176:179], v[48:51], v[36:39], v[176:179]
    ds_read_b64_tr_b16 v[214:215], v21 offset:12288
    s_add_u32 s42, s42, 16384
    s_cmp_eq_u32 s42, 49152
    s_cselect_b32 s42, 0, s42
    v_mfma_f32_16x16x32_bf16 v[180:183], v[52:55], v[36:39], v[180:183]
    s_add_u32 s48, s48, 16384
    s_cmp_eq_u32 s48, 98304
    s_cselect_b32 s48, 0, s48
    v_mfma_f32_16x16x32_bf16 v[164:167], v[52:55], v[32:35], v[164:167]
    v_add_u32 v17, s42, v12
    v_add_u32 v18, s48, v13
    v_add_u32 v19, s48, v14
    v_mfma_f32_16x16x32_bf16 v[148:151], v[52:55], v[28:31], v[148:151]
    v_add_u32 v20, s48, v15
    v_add_u32 v21, s48, v16
    v_mfma_f32_16x16x32_bf16 v[132:135], v[52:55], v[24:27], v[132:135]
    s_waitcnt lgkmcnt(0)
    s_barrier
    v_mfma_f32_16x16x32_bf16 v[120:123], v[200:203], v[184:187], v[120:123]
    ds_read_b128 v[24:27], v17 offset:0
    ds_read_b128 v[28:31], v17 offset:2048
    v_mfma_f32_16x16x32_bf16 v[136:139], v[200:203], v[188:191], v[136:139]
    ds_read_b128 v[32:35], v17 offset:4096
    v_mfma_f32_16x16x32_bf16 v[152:155], v[200:203], v[192:195], v[152:155]
    ds_read_b128 v[36:39], v17 offset:6144
    v_mfma_f32_16x16x32_bf16 v[168:171], v[200:203], v[196:199], v[168:171]
    s_add_u32 s36, s46, 688128
    buffer_store_dwordx4 v[242:245], v2, s[16:19], s36 offen sc1
    v_mfma_f32_16x16x32_bf16 v[172:175], v[204:207], v[196:199], v[172:175]
    ds_read_b64_tr_b16 v[40:41], v18 offset:0
    v_mfma_f32_16x16x32_bf16 v[156:159], v[204:207], v[192:195], v[156:159]
    ds_read_b64_tr_b16 v[42:43], v18 offset:4096
    v_mfma_f32_16x16x32_bf16 v[140:143], v[204:207], v[188:191], v[140:143]
    ds_read_b64_tr_b16 v[44:45], v19 offset:0
    s_add_u32 s36, s47, 688128
    buffer_store_dwordx2 v[252:253], v254, s[16:19], s36 offen sc1
    v_mfma_f32_16x16x32_bf16 v[124:127], v[204:207], v[184:187], v[124:127]
    ds_read_b64_tr_b16 v[46:47], v19 offset:4096
    v_mfma_f32_16x16x32_bf16 v[128:131], v[208:211], v[184:187], v[128:131]
    ds_read_b64_tr_b16 v[48:49], v20 offset:0
    v_mfma_f32_16x16x32_bf16 v[144:147], v[208:211], v[188:191], v[144:147]
    ds_read_b64_tr_b16 v[50:51], v20 offset:4096
    v_mfma_f32_16x16x32_bf16 v[160:163], v[208:211], v[192:195], v[160:163]
    ds_read_b64_tr_b16 v[52:53], v21 offset:0
    v_mfma_f32_16x16x32_bf16 v[176:179], v[208:211], v[196:199], v[176:179]
    ds_read_b64_tr_b16 v[54:55], v21 offset:4096
    s_add_u32 s43, s43, 1
    v_mfma_f32_16x16x32_bf16 v[180:183], v[212:215], v[196:199], v[180:183]
    s_cmp_lt_u32 s43, 27
    v_mfma_f32_16x16x32_bf16 v[164:167], v[212:215], v[192:195], v[164:167]
    v_mfma_f32_16x16x32_bf16 v[148:151], v[212:215], v[188:191], v[148:151]
    v_mfma_f32_16x16x32_bf16 v[132:135], v[212:215], v[184:187], v[132:135]
    s_waitcnt vmcnt(8)
    buffer_atomic_add v8, v9, s[56:59], s49 offen offset:512 sc1
mm_21:
    s_waitcnt lgkmcnt(0)
    v_mfma_f32_16x16x32_bf16 v[120:123], v[40:43], v[24:27], v[120:123]
    ds_read_b128 v[184:187], v17 offset:1024
    v_mfma_f32_16x16x32_bf16 v[136:139], v[40:43], v[28:31], v[136:139]
    ds_read_b128 v[188:191], v17 offset:3072
    v_mfma_f32_16x16x32_bf16 v[152:155], v[40:43], v[32:35], v[152:155]
    ds_read_b128 v[192:195], v17 offset:5120
    v_mfma_f32_16x16x32_bf16 v[168:171], v[40:43], v[36:39], v[168:171]
    ds_read_b128 v[196:199], v17 offset:7168
    v_mfma_f32_16x16x32_bf16 v[172:175], v[44:47], v[36:39], v[172:175]
    ds_read_b64_tr_b16 v[200:201], v18 offset:8192
    v_mfma_f32_16x16x32_bf16 v[156:159], v[44:47], v[32:35], v[156:159]
    ds_read_b64_tr_b16 v[202:203], v18 offset:12288
    v_mfma_f32_16x16x32_bf16 v[140:143], v[44:47], v[28:31], v[140:143]
    ds_read_b64_tr_b16 v[204:205], v19 offset:8192
    v_mfma_f32_16x16x32_bf16 v[124:127], v[44:47], v[24:27], v[124:127]
    ds_read_b64_tr_b16 v[206:207], v19 offset:12288
    v_mfma_f32_16x16x32_bf16 v[128:131], v[48:51], v[24:27], v[128:131]
    ds_read_b64_tr_b16 v[208:209], v20 offset:8192
    v_mfma_f32_16x16x32_bf16 v[144:147], v[48:51], v[28:31], v[144:147]
    ds_read_b64_tr_b16 v[210:211], v20 offset:12288
    v_mfma_f32_16x16x32_bf16 v[160:163], v[48:51], v[32:35], v[160:163]
    ds_read_b64_tr_b16 v[212:213], v21 offset:8192
    v_mfma_f32_16x16x32_bf16 v[176:179], v[48:51], v[36:39], v[176:179]
    ds_read_b64_tr_b16 v[214:215], v21 offset:12288
    s_add_u32 s42, s42, 16384
    s_cmp_eq_u32 s42, 49152
    s_cselect_b32 s42, 0, s42
    v_mfma_f32_16x16x32_bf16 v[180:183], v[52:55], v[36:39], v[180:183]
    s_add_u32 s48, s48, 16384
    s_cmp_eq_u32 s48, 98304
    s_cselect_b32 s48, 0, s48
    v_mfma_f32_16x16x32_bf16 v[164:167], v[52:55], v[32:35], v[164:167]
    v_add_u32 v17, s42, v12
    v_add_u32 v18, s48, v13
    v_add_u32 v19, s48, v14
    v_mfma_f32_16x16x32_bf16 v[148:151], v[52:55], v[28:31], v[148:151]
    v_add_u32 v20, s48, v15
    v_add_u32 v21, s48, v16
    v_mfma_f32_16x16x32_bf16 v[132:135], v[52:55], v[24:27], v[132:135]
    s_waitcnt lgkmcnt(0)
    s_barrier
    v_mfma_f32_16x16x32_bf16 v[120:123], v[200:203], v[184:187], v[120:123]
    ds_read_b128 v[24:27], v17 offset:0
    v_mfma_f32_16x16x32_bf16 v[136:139], v[200:203], v[188:191], v[136:139]
    ds_read_b128 v[28:31], v17 offset:2048
    v_mfma_f32_16x16x32_bf16 v[152:155], v[200:203], v[192:195], v[152:155]
    ds_read_b128 v[32:35], v17 offset:4096
    v_mfma_f32_16x16x32_bf16 v[168:171], v[200:203], v[196:199], v[168:171]
    ds_read_b128 v[36:39], v17 offset:6144
    v_mfma_f32_16x16x32_bf16 v[172:175], v[204:207], v[196:199], v[172:175]
    ds_read_b64_tr_b16 v[40:41], v18 offset:0
    v_mfma_f32_16x16x32_bf16 v[156:159], v[204:207], v[192:195], v[156:159]
    ds_read_b64_tr_b16 v[42:43], v18 offset:4096
    v_mfma_f32_16x16x32_bf16 v[140:143], v[204:207], v[188:191], v[140:143]
    ds_read_b64_tr_b16 v[44:45], v19 offset:0
    v_mfma_f32_16x16x32_bf16 v[124:127], v[204:207], v[184:187], v[124:127]
    ds_read_b64_tr_b16 v[46:47], v19 offset:4096
    v_mfma_f32_16x16x32_bf16 v[128:131], v[208:211], v[184:187], v[128:131]
    ds_read_b64_tr_b16 v[48:49], v20 offset:0
    v_mfma_f32_16x16x32_bf16 v[144:147], v[208:211], v[188:191], v[144:147]
    ds_read_b64_tr_b16 v[50:51], v20 offset:4096
    v_mfma_f32_16x16x32_bf16 v[160:163], v[208:211], v[192:195], v[160:163]
    ds_read_b64_tr_b16 v[52:53], v21 offset:0
    v_mfma_f32_16x16x32_bf16 v[176:179], v[208:211], v[196:199], v[176:179]
    ds_read_b64_tr_b16 v[54:55], v21 offset:4096
    s_add_u32 s43, s43, 1
    v_mfma_f32_16x16x32_bf16 v[180:183], v[212:215], v[196:199], v[180:183]
    s_cmp_lt_u32 s43, 4
    v_mfma_f32_16x16x32_bf16 v[164:167], v[212:215], v[192:195], v[164:167]
    v_mfma_f32_16x16x32_bf16 v[148:151], v[212:215], v[188:191], v[148:151]
    v_mfma_f32_16x16x32_bf16 v[132:135], v[212:215], v[184:187], v[132:135]
    s_cbranch_scc1 mm_21
    s_waitcnt vmcnt(0)
    buffer_atomic_add v8, v9, s[56:59], s49 offen offset:1024 sc1
mm_22:
    s_waitcnt lgkmcnt(0)
    v_mfma_f32_16x16x32_bf16 v[120:123], v[40:43], v[24:27], v[120:123]
    ds_read_b128 v[184:187], v17 offset:1024
    v_mfma_f32_16x16x32_bf16 v[136:139], v[40:43], v[28:31], v[136:139]
    ds_read_b128 v[188:191], v17 offset:3072
    v_mfma_f32_16x16x32_bf16 v[152:155], v[40:43], v[32:35], v[152:155]
    ds_read_b128 v[192:195], v17 offset:5120
    v_mfma_f32_16x16x32_bf16 v[168:171], v[40:43], v[36:39], v[168:171]
    ds_read_b128 v[196:199], v17 offset:7168
    v_mfma_f32_16x16x32_bf16 v[172:175], v[44:47], v[36:39], v[172:175]
    ds_read_b64_tr_b16 v[200:201], v18 offset:8192
    v_mfma_f32_16x16x32_bf16 v[156:159], v[44:47], v[32:35], v[156:159]
    ds_read_b64_tr_b16 v[202:203], v18 offset:12288
    v_mfma_f32_16x16x32_bf16 v[140:143], v[44:47], v[28:31], v[140:143]
    ds_read_b64_tr_b16 v[204:205], v19 offset:8192
    v_mfma_f32_16x16x32_bf16 v[124:127], v[44:47], v[24:27], v[124:127]
    ds_read_b64_tr_b16 v[206:207], v19 offset:12288
    v_mfma_f32_16x16x32_bf16 v[128:131], v[48:51], v[24:27], v[128:131]
    ds_read_b64_tr_b16 v[208:209], v20 offset:8192
    v_mfma_f32_16x16x32_bf16 v[144:147], v[48:51], v[28:31], v[144:147]
    ds_read_b64_tr_b16 v[210:211], v20 offset:12288
    v_mfma_f32_16x16x32_bf16 v[160:163], v[48:51], v[32:35], v[160:163]
    ds_read_b64_tr_b16 v[212:213], v21 offset:8192
    v_mfma_f32_16x16x32_bf16 v[176:179], v[48:51], v[36:39], v[176:179]
    ds_read_b64_tr_b16 v[214:215], v21 offset:12288
    s_add_u32 s42, s42, 16384
    s_cmp_eq_u32 s42, 49152
    s_cselect_b32 s42, 0, s42
    v_mfma_f32_16x16x32_bf16 v[180:183], v[52:55], v[36:39], v[180:183]
    s_add_u32 s48, s48, 16384
    s_cmp_eq_u32 s48, 98304
    s_cselect_b32 s48, 0, s48
    v_mfma_f32_16x16x32_bf16 v[164:167], v[52:55], v[32:35], v[164:167]
    v_add_u32 v17, s42, v12
    v_add_u32 v18, s48, v13
    v_add_u32 v19, s48, v14
    v_mfma_f32_16x16x32_bf16 v[148:151], v[52:55], v[28:31], v[148:151]
    v_add_u32 v20, s48, v15
    v_add_u32 v21, s48, v16
    v_mfma_f32_16x16x32_bf16 v[132:135], v[52:55], v[24:27], v[132:135]
    s_waitcnt lgkmcnt(0)
    s_barrier
    v_mfma_f32_16x16x32_bf16 v[120:123], v[200:203], v[184:187], v[120:123]
    ds_read_b128 v[24:27], v17 offset:0
    v_mfma_f32_16x16x32_bf16 v[136:139], v[200:203], v[188:191], v[136:139]
    ds_read_b128 v[28:31], v17 offset:2048
    v_mfma_f32_16x16x32_bf16 v[152:155], v[200:203], v[192:195], v[152:155]
    ds_read_b128 v[32:35], v17 offset:4096
    v_mfma_f32_16x16x32_bf16 v[168:171], v[200:203], v[196:199], v[168:171]
    ds_read_b128 v[36:39], v17 offset:6144
    v_mfma_f32_16x16x32_bf16 v[172:175], v[204:207], v[196:199], v[172:175]
    ds_read_b64_tr_b16 v[40:41], v18 offset:0
    v_mfma_f32_16x16x32_bf16 v[156:159], v[204:207], v[192:195], v[156:159]
    ds_read_b64_tr_b16 v[42:43], v18 offset:4096
    v_mfma_f32_16x16x32_bf16 v[140:143], v[204:207], v[188:191], v[140:143]
    ds_read_b64_tr_b16 v[44:45], v19 offset:0
    v_mfma_f32_16x16x32_bf16 v[124:127], v[204:207], v[184:187], v[124:127]
    ds_read_b64_tr_b16 v[46:47], v19 offset:4096
    v_mfma_f32_16x16x32_bf16 v[128:131], v[208:211], v[184:187], v[128:131]
    ds_read_b64_tr_b16 v[48:49], v20 offset:0
    v_mfma_f32_16x16x32_bf16 v[144:147], v[208:211], v[188:191], v[144:147]
    ds_read_b64_tr_b16 v[50:51], v20 offset:4096
    v_mfma_f32_16x16x32_bf16 v[160:163], v[208:211], v[192:195], v[160:163]
    ds_read_b64_tr_b16 v[52:53], v21 offset:0
    v_mfma_f32_16x16x32_bf16 v[176:179], v[208:211], v[196:199], v[176:179]
    ds_read_b64_tr_b16 v[54:55], v21 offset:4096
    s_add_u32 s43, s43, 1
    v_mfma_f32_16x16x32_bf16 v[180:183], v[212:215], v[196:199], v[180:183]
    s_cmp_lt_u32 s43, 21
    v_mfma_f32_16x16x32_bf16 v[164:167], v[212:215], v[192:195], v[164:167]
    v_mfma_f32_16x16x32_bf16 v[148:151], v[212:215], v[188:191], v[148:151]
    v_mfma_f32_16x16x32_bf16 v[132:135], v[212:215], v[184:187], v[132:135]
    s_cbranch_scc1 mm_22
    s_waitcnt lgkmcnt(0)
    v_mfma_f32_16x16x32_bf16 v[120:123], v[40:43], v[24:27], v[120:123]
    ds_read_b128 v[184:187], v17 offset:1024
    v_mfma_f32_16x16x32_bf16 v[136:139], v[40:43], v[28:31], v[136:139]
    ds_read_b128 v[188:191], v17 offset:3072
    v_mfma_f32_16x16x32_bf16 v[152:155], v[40:43], v[32:35], v[152:155]
    ds_read_b128 v[192:195], v17 offset:5120
    v_mfma_f32_16x16x32_bf16 v[168:171], v[40:43], v[36:39], v[168:171]
    ds_read_b128 v[196:199], v17 offset:7168
    v_mfma_f32_16x16x32_bf16 v[172:175], v[44:47], v[36:39], v[172:175]
    ds_read_b64_tr_b16 v[200:201], v18 offset:8192
    v_mfma_f32_16x16x32_bf16 v[156:159], v[44:47], v[32:35], v[156:159]
    ds_read_b64_tr_b16 v[202:203], v18 offset:12288
    v_mfma_f32_16x16x32_bf16 v[140:143], v[44:47], v[28:31], v[140:143]
    ds_read_b64_tr_b16 v[204:205], v19 offset:8192
    v_mfma_f32_16x16x32_bf16 v[124:127], v[44:47], v[24:27], v[124:127]
    ds_read_b64_tr_b16 v[206:207], v19 offset:12288
    v_mfma_f32_16x16x32_bf16 v[128:131], v[48:51], v[24:27], v[128:131]
    ds_read_b64_tr_b16 v[208:209], v20 offset:8192
    v_mfma_f32_16x16x32_bf16 v[144:147], v[48:51], v[28:31], v[144:147]
    ds_read_b64_tr_b16 v[210:211], v20 offset:12288
    v_mfma_f32_16x16x32_bf16 v[160:163], v[48:51], v[32:35], v[160:163]
    ds_read_b64_tr_b16 v[212:213], v21 offset:8192
    v_mfma_f32_16x16x32_bf16 v[176:179], v[48:51], v[36:39], v[176:179]
    ds_read_b64_tr_b16 v[214:215], v21 offset:12288
    v_add_u32 v18, 49152, v13
    v_mfma_f32_16x16x32_bf16 v[180:183], v[52:55], v[36:39], v[180:183]
    v_add_u32 v19, 49152, v14
    v_mfma_f32_16x16x32_bf16 v[164:167], v[52:55], v[32:35], v[164:167]
    v_add_u32 v20, 49152, v15
    v_mfma_f32_16x16x32_bf16 v[148:151], v[52:55], v[28:31], v[148:151]
    v_add_u32 v21, 49152, v16
    v_mfma_f32_16x16x32_bf16 v[132:135], v[52:55], v[24:27], v[132:135]
    s_waitcnt lgkmcnt(0)
    s_barrier
    v_mfma_f32_16x16x32_bf16 v[120:123], v[200:203], v[184:187], v[120:123]
    ds_read_b128 v[232:235], v12 offset:16384
    ds_read_b128 v[236:239], v12 offset:18432
    v_mfma_f32_16x16x32_bf16 v[136:139], v[200:203], v[188:191], v[136:139]
    ds_read_b128 v[240:243], v12 offset:17408
    ds_read_b128 v[244:247], v12 offset:19456
    v_mfma_f32_16x16x32_bf16 v[152:155], v[200:203], v[192:195], v[152:155]
    ds_read_b64_tr_b16 v[24:25], v18 offset:16384
    v_mfma_f32_16x16x32_bf16 v[168:171], v[200:203], v[196:199], v[168:171]
    ds_read_b64_tr_b16 v[26:27], v18 offset:20480
    ds_read_b64_tr_b16 v[28:29], v19 offset:16384
    v_mfma_f32_16x16x32_bf16 v[172:175], v[204:207], v[196:199], v[172:175]
    ds_read_b64_tr_b16 v[30:31], v19 offset:20480
    ds_read_b64_tr_b16 v[32:33], v20 offset:16384
    v_mfma_f32_16x16x32_bf16 v[156:159], v[204:207], v[192:195], v[156:159]
    ds_read_b64_tr_b16 v[34:35], v20 offset:20480
    v_mfma_f32_16x16x32_bf16 v[140:143], v[204:207], v[188:191], v[140:143]
    ds_read_b64_tr_b16 v[36:37], v21 offset:16384
    ds_read_b64_tr_b16 v[38:39], v21 offset:20480
    v_mfma_f32_16x16x32_bf16 v[124:127], v[204:207], v[184:187], v[124:127]
    ds_read_b64_tr_b16 v[40:41], v18 offset:24576
    ds_read_b64_tr_b16 v[42:43], v18 offset:28672
    v_mfma_f32_16x16x32_bf16 v[128:131], v[208:211], v[184:187], v[128:131]
    ds_read_b64_tr_b16 v[44:45], v19 offset:24576
    v_mfma_f32_16x16x32_bf16 v[144:147], v[208:211], v[188:191], v[144:147]
    ds_read_b64_tr_b16 v[46:47], v19 offset:28672
    ds_read_b64_tr_b16 v[48:49], v20 offset:24576
    v_mfma_f32_16x16x32_bf16 v[160:163], v[208:211], v[192:195], v[160:163]
    ds_read_b64_tr_b16 v[50:51], v20 offset:28672
    ds_read_b64_tr_b16 v[52:53], v21 offset:24576
    v_mfma_f32_16x16x32_bf16 v[176:179], v[208:211], v[196:199], v[176:179]
    ds_read_b64_tr_b16 v[54:55], v21 offset:28672
    v_mfma_f32_16x16x32_bf16 v[180:183], v[212:215], v[196:199], v[180:183]
    v_mfma_f32_16x16x32_bf16 v[164:167], v[212:215], v[192:195], v[164:167]
    v_mfma_f32_16x16x32_bf16 v[148:151], v[212:215], v[188:191], v[148:151]
    v_mfma_f32_16x16x32_bf16 v[132:135], v[212:215], v[184:187], v[132:135]
    s_waitcnt lgkmcnt(8)
    v_mfma_f32_16x16x32_bf16 v[152:155], v[24:27], v[232:235], v[152:155]
    ds_read_b128 v[88:91], v12 offset:20480
    ds_read_b128 v[92:95], v12 offset:22528
    v_mfma_f32_16x16x32_bf16 v[168:171], v[24:27], v[236:239], v[168:171]
    ds_read_b128 v[96:99], v12 offset:21504
    v_mfma_f32_16x16x32_bf16 v[172:175], v[28:31], v[236:239], v[172:175]
    ds_read_b128 v[100:103], v12 offset:23552
    v_mfma_f32_16x16x32_bf16 v[156:159], v[28:31], v[232:235], v[156:159]
    ds_read_b64_tr_b16 v[184:185], v18 offset:32768
    v_mfma_f32_16x16x32_bf16 v[160:163], v[32:35], v[232:235], v[160:163]
    ds_read_b64_tr_b16 v[186:187], v18 offset:36864
    ds_read_b64_tr_b16 v[188:189], v19 offset:32768
    v_mfma_f32_16x16x32_bf16 v[176:179], v[32:35], v[236:239], v[176:179]
    ds_read_b64_tr_b16 v[190:191], v19 offset:36864
    v_mfma_f32_16x16x32_bf16 v[180:183], v[36:39], v[236:239], v[180:183]
    ds_read_b64_tr_b16 v[192:193], v20 offset:32768
    v_mfma_f32_16x16x32_bf16 v[164:167], v[36:39], v[232:235], v[164:167]
    ds_read_b64_tr_b16 v[194:195], v20 offset:36864
    s_waitcnt lgkmcnt(10)
    v_mfma_f32_16x16x32_bf16 v[152:155], v[40:43], v[240:243], v[152:155]
    ds_read_b64_tr_b16 v[196:197], v21 offset:32768
    ds_read_b64_tr_b16 v[198:199], v21 offset:36864
    v_mfma_f32_16x16x32_bf16 v[168:171], v[40:43], v[244:247], v[168:171]
    ds_read_b64_tr_b16 v[200:201], v18 offset:40960
    v_mfma_f32_16x16x32_bf16 v[172:175], v[44:47], v[244:247], v[172:175]
    ds_read_b64_tr_b16 v[202:203], v18 offset:45056
    v_mfma_f32_16x16x32_bf16 v[156:159], v[44:47], v[240:243], v[156:159]
    ds_read_b64_tr_b16 v[204:205], v19 offset:40960
    v_mfma_f32_16x16x32_bf16 v[160:163], v[48:51], v[240:243], v[160:163]
    ds_read_b64_tr_b16 v[206:207], v19 offset:45056
    ds_read_b64_tr_b16 v[208:209], v20 offset:40960
    v_mfma_f32_16x16x32_bf16 v[176:179], v[48:51], v[244:247], v[176:179]
    ds_read_b64_tr_b16 v[210:211], v20 offset:45056
    v_mfma_f32_16x16x32_bf16 v[180:183], v[52:55], v[244:247], v[180:183]
    ds_read_b64_tr_b16 v[212:213], v21 offset:40960
    v_mfma_f32_16x16x32_bf16 v[164:167], v[52:55], v[240:243], v[164:167]
    ds_read_b64_tr_b16 v[214:215], v21 offset:45056
    s_waitcnt lgkmcnt(8)
    s_barrier
    v_mfma_f32_16x16x32_bf16 v[152:155], v[184:187], v[88:91], v[152:155]
    ds_read_b128 v[232:235], v12 offset:32768
    ds_read_b128 v[236:239], v12 offset:34816
    v_mfma_f32_16x16x32_bf16 v[168:171], v[184:187], v[92:95], v[168:171]
    ds_read_b128 v[240:243], v12 offset:33792
    v_mfma_f32_16x16x32_bf16 v[172:175], v[188:191], v[92:95], v[172:175]
    ds_read_b128 v[244:247], v12 offset:35840
    v_mfma_f32_16x16x32_bf16 v[156:159], v[188:191], v[88:91], v[156:159]
    ds_read_b64_tr_b16 v[24:25], v13 offset:0
    v_mfma_f32_16x16x32_bf16 v[160:163], v[192:195], v[88:91], v[160:163]
    ds_read_b64_tr_b16 v[26:27], v13 offset:4096
    ds_read_b64_tr_b16 v[28:29], v14 offset:0
    v_mfma_f32_16x16x32_bf16 v[176:179], v[192:195], v[92:95], v[176:179]
    ds_read_b64_tr_b16 v[30:31], v14 offset:4096
    v_mfma_f32_16x16x32_bf16 v[180:183], v[196:199], v[92:95], v[180:183]
    ds_read_b64_tr_b16 v[32:33], v15 offset:0
    v_mfma_f32_16x16x32_bf16 v[164:167], v[196:199], v[88:91], v[164:167]
    ds_read_b64_tr_b16 v[34:35], v15 offset:4096
    s_waitcnt lgkmcnt(10)
    v_mfma_f32_16x16x32_bf16 v[152:155], v[200:203], v[96:99], v[152:155]
    ds_read_b64_tr_b16 v[36:37], v16 offset:0
    ds_read_b64_tr_b16 v[38:39], v16 offset:4096
    v_mfma_f32_16x16x32_bf16 v[168:171], v[200:203], v[100:103], v[168:171]
    ds_read_b64_tr_b16 v[40:41], v13 offset:8192
    v_mfma_f32_16x16x32_bf16 v[172:175], v[204:207], v[100:103], v[172:175]
    ds_read_b64_tr_b16 v[42:43], v13 offset:12288
    v_mfma_f32_16x16x32_bf16 v[156:159], v[204:207], v[96:99], v[156:159]
    ds_read_b64_tr_b16 v[44:45], v14 offset:8192
    v_mfma_f32_16x16x32_bf16 v[160:163], v[208:211], v[96:99], v[160:163]
    ds_read_b64_tr_b16 v[46:47], v14 offset:12288
    ds_read_b64_tr_b16 v[48:49], v15 offset:8192
    v_mfma_f32_16x16x32_bf16 v[176:179], v[208:211], v[100:103], v[176:179]
    ds_read_b64_tr_b16 v[50:51], v15 offset:12288
    v_mfma_f32_16x16x32_bf16 v[180:183], v[212:215], v[100:103], v[180:183]
    ds_read_b64_tr_b16 v[52:53], v16 offset:8192
    v_mfma_f32_16x16x32_bf16 v[164:167], v[212:215], v[96:99], v[164:167]
    ds_read_b64_tr_b16 v[54:55], v16 offset:12288
    s_waitcnt lgkmcnt(8)
    v_mfma_f32_16x16x32_bf16 v[152:155], v[24:27], v[232:235], v[152:155]
    ds_read_b128 v[88:91], v12 offset:36864
    ds_read_b128 v[92:95], v12 offset:38912
    v_mfma_f32_16x16x32_bf16 v[168:171], v[24:27], v[236:239], v[168:171]
    ds_read_b128 v[96:99], v12 offset:37888
    v_mfma_f32_16x16x32_bf16 v[172:175], v[28:31], v[236:239], v[172:175]
    ds_read_b128 v[100:103], v12 offset:39936
    v_mfma_f32_16x16x32_bf16 v[156:159], v[28:31], v[232:235], v[156:159]
    ds_read_b64_tr_b16 v[184:185], v13 offset:16384
    v_mfma_f32_16x16x32_bf16 v[160:163], v[32:35], v[232:235], v[160:163]
    ds_read_b64_tr_b16 v[186:187], v13 offset:20480
    ds_read_b64_tr_b16 v[188:189], v14 offset:16384
    v_mfma_f32_16x16x32_bf16 v[176:179], v[32:35], v[236:239], v[176:179]
    ds_read_b64_tr_b16 v[190:191], v14 offset:20480
    v_mfma_f32_16x16x32_bf16 v[180:183], v[36:39], v[236:239], v[180:183]
    ds_read_b64_tr_b16 v[192:193], v15 offset:16384
    v_mfma_f32_16x16x32_bf16 v[164:167], v[36:39], v[232:235], v[164:167]
    ds_read_b64_tr_b16 v[194:195], v15 offset:20480
    s_waitcnt lgkmcnt(10)
    v_mfma_f32_16x16x32_bf16 v[152:155], v[40:43], v[240:243], v[152:155]
    ds_read_b64_tr_b16 v[196:197], v16 offset:16384
    ds_read_b64_tr_b16 v[198:199], v16 offset:20480
    v_mfma_f32_16x16x32_bf16 v[168:171], v[40:43], v[244:247], v[168:171]
    ds_read_b64_tr_b16 v[200:201], v13 offset:24576
    v_mfma_f32_16x16x32_bf16 v[172:175], v[44:47], v[244:247], v[172:175]
    ds_read_b64_tr_b16 v[202:203], v13 offset:28672
    v_mfma_f32_16x16x32_bf16 v[156:159], v[44:47], v[240:243], v[156:159]
    ds_read_b64_tr_b16 v[204:205], v14 offset:24576
    v_mfma_f32_16x16x32_bf16 v[160:163], v[48:51], v[240:243], v[160:163]
    ds_read_b64_tr_b16 v[206:207], v14 offset:28672
    ds_read_b64_tr_b16 v[208:209], v15 offset:24576
    v_mfma_f32_16x16x32_bf16 v[176:179], v[48:51], v[244:247], v[176:179]
    ds_read_b64_tr_b16 v[210:211], v15 offset:28672
    v_mfma_f32_16x16x32_bf16 v[180:183], v[52:55], v[244:247], v[180:183]
    ds_read_b64_tr_b16 v[212:213], v16 offset:24576
    v_mfma_f32_16x16x32_bf16 v[164:167], v[52:55], v[240:243], v[164:167]
    ds_read_b64_tr_b16 v[214:215], v16 offset:28672
    s_waitcnt lgkmcnt(8)
    s_barrier
    v_mfma_f32_16x16x32_bf16 v[152:155], v[184:187], v[88:91], v[152:155]
    ds_read_b128 v[232:235], v12 offset:0
    ds_read_b128 v[236:239], v12 offset:2048
    v_mfma_f32_16x16x32_bf16 v[168:171], v[184:187], v[92:95], v[168:171]
    ds_read_b128 v[240:243], v12 offset:1024
    v_mfma_f32_16x16x32_bf16 v[172:175], v[188:191], v[92:95], v[172:175]
    ds_read_b128 v[244:247], v12 offset:3072
    v_mfma_f32_16x16x32_bf16 v[156:159], v[188:191], v[88:91], v[156:159]
    ds_read_b64_tr_b16 v[24:25], v13 offset:32768
    v_mfma_f32_16x16x32_bf16 v[160:163], v[192:195], v[88:91], v[160:163]
    ds_read_b64_tr_b16 v[26:27], v13 offset:36864
    ds_read_b64_tr_b16 v[28:29], v14 offset:32768
    v_mfma_f32_16x16x32_bf16 v[176:179], v[192:195], v[92:95], v[176:179]
    ds_read_b64_tr_b16 v[30:31], v14 offset:36864
    v_mfma_f32_16x16x32_bf16 v[180:183], v[196:199], v[92:95], v[180:183]
    ds_read_b64_tr_b16 v[32:33], v15 offset:32768
    v_mfma_f32_16x16x32_bf16 v[164:167], v[196:199], v[88:91], v[164:167]
    ds_read_b64_tr_b16 v[34:35], v15 offset:36864
    s_waitcnt lgkmcnt(10)
    v_mfma_f32_16x16x32_bf16 v[152:155], v[200:203], v[96:99], v[152:155]
    ds_read_b64_tr_b16 v[36:37], v16 offset:32768
    ds_read_b64_tr_b16 v[38:39], v16 offset:36864
    v_mfma_f32_16x16x32_bf16 v[168:171], v[200:203], v[100:103], v[168:171]
    ds_read_b64_tr_b16 v[40:41], v13 offset:40960
    v_mfma_f32_16x16x32_bf16 v[172:175], v[204:207], v[100:103], v[172:175]
    ds_read_b64_tr_b16 v[42:43], v13 offset:45056
    v_mfma_f32_16x16x32_bf16 v[156:159], v[204:207], v[96:99], v[156:159]
    ds_read_b64_tr_b16 v[44:45], v14 offset:40960
    v_mfma_f32_16x16x32_bf16 v[160:163], v[208:211], v[96:99], v[160:163]
    ds_read_b64_tr_b16 v[46:47], v14 offset:45056
    ds_read_b64_tr_b16 v[48:49], v15 offset:40960
    v_mfma_f32_16x16x32_bf16 v[176:179], v[208:211], v[100:103], v[176:179]
    ds_read_b64_tr_b16 v[50:51], v15 offset:45056
    v_mfma_f32_16x16x32_bf16 v[180:183], v[212:215], v[100:103], v[180:183]
    ds_read_b64_tr_b16 v[52:53], v16 offset:40960
    v_mfma_f32_16x16x32_bf16 v[164:167], v[212:215], v[96:99], v[164:167]
    ds_read_b64_tr_b16 v[54:55], v16 offset:45056
    s_waitcnt lgkmcnt(8)
    v_mfma_f32_16x16x32_bf16 v[152:155], v[24:27], v[232:235], v[152:155]
    ds_read_b128 v[88:91], v12 offset:4096
    ds_read_b128 v[92:95], v12 offset:6144
    v_mfma_f32_16x16x32_bf16 v[168:171], v[24:27], v[236:239], v[168:171]
    ds_read_b128 v[96:99], v12 offset:5120
    v_mfma_f32_16x16x32_bf16 v[172:175], v[28:31], v[236:239], v[172:175]
    ds_read_b128 v[100:103], v12 offset:7168
    v_mfma_f32_16x16x32_bf16 v[156:159], v[28:31], v[232:235], v[156:159]
    ds_read_b64_tr_b16 v[184:185], v18 offset:0
    v_mfma_f32_16x16x32_bf16 v[160:163], v[32:35], v[232:235], v[160:163]
    ds_read_b64_tr_b16 v[186:187], v18 offset:4096
    ds_read_b64_tr_b16 v[188:189], v19 offset:0
    v_mfma_f32_16x16x32_bf16 v[176:179], v[32:35], v[236:239], v[176:179]
    ds_read_b64_tr_b16 v[190:191], v19 offset:4096
    v_mfma_f32_16x16x32_bf16 v[180:183], v[36:39], v[236:239], v[180:183]
    ds_read_b64_tr_b16 v[192:193], v20 offset:0
    v_mfma_f32_16x16x32_bf16 v[164:167], v[36:39], v[232:235], v[164:167]
    ds_read_b64_tr_b16 v[194:195], v20 offset:4096
    s_waitcnt lgkmcnt(10)
    v_mfma_f32_16x16x32_bf16 v[152:155], v[40:43], v[240:243], v[152:155]
    ds_read_b64_tr_b16 v[196:197], v21 offset:0
    ds_read_b64_tr_b16 v[198:199], v21 offset:4096
    v_mfma_f32_16x16x32_bf16 v[168:171], v[40:43], v[244:247], v[168:171]
    ds_read_b64_tr_b16 v[200:201], v18 offset:8192
    v_mfma_f32_16x16x32_bf16 v[172:175], v[44:47], v[244:247], v[172:175]
    ds_read_b64_tr_b16 v[202:203], v18 offset:12288
    v_mfma_f32_16x16x32_bf16 v[156:159], v[44:47], v[240:243], v[156:159]
    ds_read_b64_tr_b16 v[204:205], v19 offset:8192
    v_mfma_f32_16x16x32_bf16 v[160:163], v[48:51], v[240:243], v[160:163]
    ds_read_b64_tr_b16 v[206:207], v19 offset:12288
    ds_read_b64_tr_b16 v[208:209], v20 offset:8192
    v_mfma_f32_16x16x32_bf16 v[176:179], v[48:51], v[244:247], v[176:179]
    ds_read_b64_tr_b16 v[210:211], v20 offset:12288
    v_mfma_f32_16x16x32_bf16 v[180:183], v[52:55], v[244:247], v[180:183]
    ds_read_b64_tr_b16 v[212:213], v21 offset:8192
    v_mfma_f32_16x16x32_bf16 v[164:167], v[52:55], v[240:243], v[164:167]
    ds_read_b64_tr_b16 v[214:215], v21 offset:12288
    s_waitcnt lgkmcnt(8)
    s_barrier
    v_mfma_f32_16x16x32_bf16 v[152:155], v[184:187], v[88:91], v[152:155]
    ds_read_b128 v[232:235], v12 offset:16384
    ds_read_b128 v[236:239], v12 offset:18432
    v_mfma_f32_16x16x32_bf16 v[168:171], v[184:187], v[92:95], v[168:171]
    ds_read_b128 v[240:243], v12 offset:17408
    v_mfma_f32_16x16x32_bf16 v[172:175], v[188:191], v[92:95], v[172:175]
    ds_read_b128 v[244:247], v12 offset:19456
    v_mfma_f32_16x16x32_bf16 v[156:159], v[188:191], v[88:91], v[156:159]
    ds_read_b64_tr_b16 v[24:25], v18 offset:16384
    v_mfma_f32_16x16x32_bf16 v[160:163], v[192:195], v[88:91], v[160:163]
    ds_read_b64_tr_b16 v[26:27], v18 offset:20480
    ds_read_b64_tr_b16 v[28:29], v19 offset:16384
    v_mfma_f32_16x16x32_bf16 v[176:179], v[192:195], v[92:95], v[176:179]
    ds_read_b64_tr_b16 v[30:31], v19 offset:20480
    v_mfma_f32_16x16x32_bf16 v[180:183], v[196:199], v[92:95], v[180:183]
    ds_read_b64_tr_b16 v[32:33], v20 offset:16384
    v_mfma_f32_16x16x32_bf16 v[164:167], v[196:199], v[88:91], v[164:167]
    ds_read_b64_tr_b16 v[34:35], v20 offset:20480
    s_waitcnt lgkmcnt(10)
    v_mfma_f32_16x16x32_bf16 v[152:155], v[200:203], v[96:99], v[152:155]
    ds_read_b64_tr_b16 v[36:37], v21 offset:16384
    ds_read_b64_tr_b16 v[38:39], v21 offset:20480
    v_mfma_f32_16x16x32_bf16 v[168:171], v[200:203], v[100:103], v[168:171]
    ds_read_b64_tr_b16 v[40:41], v18 offset:24576
    v_mfma_f32_16x16x32_bf16 v[172:175], v[204:207], v[100:103], v[172:175]
    ds_read_b64_tr_b16 v[42:43], v18 offset:28672
    v_mfma_f32_16x16x32_bf16 v[156:159], v[204:207], v[96:99], v[156:159]
    ds_read_b64_tr_b16 v[44:45], v19 offset:24576
    v_mfma_f32_16x16x32_bf16 v[160:163], v[208:211], v[96:99], v[160:163]
    ds_read_b64_tr_b16 v[46:47], v19 offset:28672
    ds_read_b64_tr_b16 v[48:49], v20 offset:24576
    v_mfma_f32_16x16x32_bf16 v[176:179], v[208:211], v[100:103], v[176:179]
    ds_read_b64_tr_b16 v[50:51], v20 offset:28672
    v_mfma_f32_16x16x32_bf16 v[180:183], v[212:215], v[100:103], v[180:183]
    ds_read_b64_tr_b16 v[52:53], v21 offset:24576
    v_mfma_f32_16x16x32_bf16 v[164:167], v[212:215], v[96:99], v[164:167]
    ds_read_b64_tr_b16 v[54:55], v21 offset:28672
    s_waitcnt lgkmcnt(8)
    v_mfma_f32_16x16x32_bf16 v[120:123], v[24:27], v[232:235], v[120:123]
    ds_read_b128 v[88:91], v12 offset:20480
    ds_read_b128 v[92:95], v12 offset:22528
    v_mfma_f32_16x16x32_bf16 v[136:139], v[24:27], v[236:239], v[136:139]
    ds_read_b128 v[96:99], v12 offset:21504
    v_mfma_f32_16x16x32_bf16 v[140:143], v[28:31], v[236:239], v[140:143]
    ds_read_b128 v[100:103], v12 offset:23552
    v_mfma_f32_16x16x32_bf16 v[124:127], v[28:31], v[232:235], v[124:127]
    ds_read_b64_tr_b16 v[184:185], v18 offset:32768
    v_and_or_b32 v152, v152, s15, v56
    v_and_or_b32 v154, v154, s15, v56
    v_and_or_b32 v156, v156, s15, v56
    v_and_or_b32 v158, v158, s15, v56
    v_cvt_pk_bf16_f32 v152, v152, v153
    v_cvt_pk_bf16_f32 v153, v154, v155
    v_cvt_pk_bf16_f32 v154, v156, v157
    v_cvt_pk_bf16_f32 v155, v158, v159
    buffer_store_dwordx4 v[152:155], v2, s[24:27], s41 offen offset:0 sc1
    v_and_or_b32 v160, v160, s15, v56
    v_and_or_b32 v162, v162, s15, v56
    v_and_or_b32 v164, v164, s15, v56
    v_and_or_b32 v166, v166, s15, v56
    v_cvt_pk_bf16_f32 v160, v160, v161
    v_cvt_pk_bf16_f32 v161, v162, v163
    v_cvt_pk_bf16_f32 v162, v164, v165
    v_cvt_pk_bf16_f32 v163, v166, v167
    buffer_store_dwordx4 v[160:163], v2, s[24:27], s41 offen offset:1024 sc1
    s_add_u32 s36, s41, 65536
    v_and_or_b32 v168, v168, s15, v56
    v_and_or_b32 v170, v170, s15, v56
    v_and_or_b32 v172, v172, s15, v56
    v_and_or_b32 v174, v174, s15, v56
    v_cvt_pk_bf16_f32 v168, v168, v169
    v_cvt_pk_bf16_f32 v169, v170, v171
    v_cvt_pk_bf16_f32 v170, v172, v173
    v_cvt_pk_bf16_f32 v171, v174, v175
    buffer_store_dwordx4 v[168:171], v2, s[24:27], s36 offen offset:0 sc1
    v_and_or_b32 v176, v176, s15, v56
    v_and_or_b32 v178, v178, s15, v56
    v_and_or_b32 v180, v180, s15, v56
    v_and_or_b32 v182, v182, s15, v56
    v_cvt_pk_bf16_f32 v176, v176, v177
    v_cvt_pk_bf16_f32 v177, v178, v179
    v_cvt_pk_bf16_f32 v178, v180, v181
    v_cvt_pk_bf16_f32 v179, v182, v183
    buffer_store_dwordx4 v[176:179], v2, s[24:27], s36 offen offset:1024 sc1
    v_mfma_f32_16x16x32_bf16 v[128:131], v[32:35], v[232:235], v[128:131]
    ds_read_b64_tr_b16 v[186:187], v18 offset:36864
    ds_read_b64_tr_b16 v[188:189], v19 offset:32768
    v_mfma_f32_16x16x32_bf16 v[144:147], v[32:35], v[236:239], v[144:147]
    ds_read_b64_tr_b16 v[190:191], v19 offset:36864
    v_mfma_f32_16x16x32_bf16 v[148:151], v[36:39], v[236:239], v[148:151]
    ds_read_b64_tr_b16 v[192:193], v20 offset:32768
    v_mfma_f32_16x16x32_bf16 v[132:135], v[36:39], v[232:235], v[132:135]
    ds_read_b64_tr_b16 v[194:195], v20 offset:36864
    s_waitcnt lgkmcnt(10)
    v_mfma_f32_16x16x32_bf16 v[120:123], v[40:43], v[240:243], v[120:123]
    ds_read_b64_tr_b16 v[196:197], v21 offset:32768
    ds_read_b64_tr_b16 v[198:199], v21 offset:36864
    v_mfma_f32_16x16x32_bf16 v[136:139], v[40:43], v[244:247], v[136:139]
    ds_read_b64_tr_b16 v[200:201], v18 offset:40960
    v_mfma_f32_16x16x32_bf16 v[140:143], v[44:47], v[244:247], v[140:143]
    ds_read_b64_tr_b16 v[202:203], v18 offset:45056
    v_mfma_f32_16x16x32_bf16 v[124:127], v[44:47], v[240:243], v[124:127]
    ds_read_b64_tr_b16 v[204:205], v19 offset:40960
    v_mfma_f32_16x16x32_bf16 v[128:131], v[48:51], v[240:243], v[128:131]
    ds_read_b64_tr_b16 v[206:207], v19 offset:45056
    ds_read_b64_tr_b16 v[208:209], v20 offset:40960
    v_mfma_f32_16x16x32_bf16 v[144:147], v[48:51], v[244:247], v[144:147]
    ds_read_b64_tr_b16 v[210:211], v20 offset:45056
    v_mfma_f32_16x16x32_bf16 v[148:151], v[52:55], v[244:247], v[148:151]
    ds_read_b64_tr_b16 v[212:213], v21 offset:40960
    v_mfma_f32_16x16x32_bf16 v[132:135], v[52:55], v[240:243], v[132:135]
    ds_read_b64_tr_b16 v[214:215], v21 offset:45056
    s_waitcnt lgkmcnt(8)
    s_barrier
    v_mfma_f32_16x16x32_bf16 v[120:123], v[184:187], v[88:91], v[120:123]
    ds_read_b128 v[232:235], v12 offset:32768
    ds_read_b128 v[236:239], v12 offset:34816
    v_mfma_f32_16x16x32_bf16 v[136:139], v[184:187], v[92:95], v[136:139]
    ds_read_b128 v[240:243], v12 offset:33792
    v_mfma_f32_16x16x32_bf16 v[140:143], v[188:191], v[92:95], v[140:143]
    ds_read_b128 v[244:247], v12 offset:35840
    v_mfma_f32_16x16x32_bf16 v[124:127], v[188:191], v[88:91], v[124:127]
    ds_read_b64_tr_b16 v[24:25], v13 offset:0
    v_mfma_f32_16x16x32_bf16 v[128:131], v[192:195], v[88:91], v[128:131]
    ds_read_b64_tr_b16 v[26:27], v13 offset:4096
    ds_read_b64_tr_b16 v[28:29], v14 offset:0
    v_mfma_f32_16x16x32_bf16 v[144:147], v[192:195], v[92:95], v[144:147]
    ds_read_b64_tr_b16 v[30:31], v14 offset:4096
    v_mfma_f32_16x16x32_bf16 v[148:151], v[196:199], v[92:95], v[148:151]
    ds_read_b64_tr_b16 v[32:33], v15 offset:0
    v_mfma_f32_16x16x32_bf16 v[132:135], v[196:199], v[88:91], v[132:135]
    ds_read_b64_tr_b16 v[34:35], v15 offset:4096
    s_waitcnt lgkmcnt(10)
    v_mfma_f32_16x16x32_bf16 v[120:123], v[200:203], v[96:99], v[120:123]
    ds_read_b64_tr_b16 v[36:37], v16 offset:0
    ds_read_b64_tr_b16 v[38:39], v16 offset:4096
    v_mfma_f32_16x16x32_bf16 v[136:139], v[200:203], v[100:103], v[136:139]
    ds_read_b64_tr_b16 v[40:41], v13 offset:8192
    v_mfma_f32_16x16x32_bf16 v[140:143], v[204:207], v[100:103], v[140:143]
    ds_read_b64_tr_b16 v[42:43], v13 offset:12288
    v_mfma_f32_16x16x32_bf16 v[124:127], v[204:207], v[96:99], v[124:127]
    ds_read_b64_tr_b16 v[44:45], v14 offset:8192
    v_mfma_f32_16x16x32_bf16 v[128:131], v[208:211], v[96:99], v[128:131]
    ds_read_b64_tr_b16 v[46:47], v14 offset:12288
    ds_read_b64_tr_b16 v[48:49], v15 offset:8192
    v_mfma_f32_16x16x32_bf16 v[144:147], v[208:211], v[100:103], v[144:147]
    ds_read_b64_tr_b16 v[50:51], v15 offset:12288
    v_mfma_f32_16x16x32_bf16 v[148:151], v[212:215], v[100:103], v[148:151]
    ds_read_b64_tr_b16 v[52:53], v16 offset:8192
    v_mfma_f32_16x16x32_bf16 v[132:135], v[212:215], v[96:99], v[132:135]
    ds_read_b64_tr_b16 v[54:55], v16 offset:12288
    s_waitcnt lgkmcnt(8)
    v_mfma_f32_16x16x32_bf16 v[120:123], v[24:27], v[232:235], v[120:123]
    ds_read_b128 v[88:91], v12 offset:36864
    ds_read_b128 v[92:95], v12 offset:38912
    v_mfma_f32_16x16x32_bf16 v[136:139], v[24:27], v[236:239], v[136:139]
    ds_read_b128 v[96:99], v12 offset:37888
    v_mfma_f32_16x16x32_bf16 v[140:143], v[28:31], v[236:239], v[140:143]
    ds_read_b128 v[100:103], v12 offset:39936
    v_mfma_f32_16x16x32_bf16 v[124:127], v[28:31], v[232:235], v[124:127]
    ds_read_b64_tr_b16 v[184:185], v13 offset:16384
    v_mfma_f32_16x16x32_bf16 v[128:131], v[32:35], v[232:235], v[128:131]
    ds_read_b64_tr_b16 v[186:187], v13 offset:20480
    ds_read_b64_tr_b16 v[188:189], v14 offset:16384
    v_mfma_f32_16x16x32_bf16 v[144:147], v[32:35], v[236:239], v[144:147]
    ds_read_b64_tr_b16 v[190:191], v14 offset:20480
    v_mfma_f32_16x16x32_bf16 v[148:151], v[36:39], v[236:239], v[148:151]
    ds_read_b64_tr_b16 v[192:193], v15 offset:16384
    v_mfma_f32_16x16x32_bf16 v[132:135], v[36:39], v[232:235], v[132:135]
    ds_read_b64_tr_b16 v[194:195], v15 offset:20480
    s_waitcnt lgkmcnt(10)
    v_mfma_f32_16x16x32_bf16 v[120:123], v[40:43], v[240:243], v[120:123]
    ds_read_b64_tr_b16 v[196:197], v16 offset:16384
    ds_read_b64_tr_b16 v[198:199], v16 offset:20480
    v_mfma_f32_16x16x32_bf16 v[136:139], v[40:43], v[244:247], v[136:139]
    ds_read_b64_tr_b16 v[200:201], v13 offset:24576
    v_mfma_f32_16x16x32_bf16 v[140:143], v[44:47], v[244:247], v[140:143]
    ds_read_b64_tr_b16 v[202:203], v13 offset:28672
    v_mfma_f32_16x16x32_bf16 v[124:127], v[44:47], v[240:243], v[124:127]
    ds_read_b64_tr_b16 v[204:205], v14 offset:24576
    v_mfma_f32_16x16x32_bf16 v[128:131], v[48:51], v[240:243], v[128:131]
    ds_read_b64_tr_b16 v[206:207], v14 offset:28672
    ds_read_b64_tr_b16 v[208:209], v15 offset:24576
    v_mfma_f32_16x16x32_bf16 v[144:147], v[48:51], v[244:247], v[144:147]
    ds_read_b64_tr_b16 v[210:211], v15 offset:28672
    v_mfma_f32_16x16x32_bf16 v[148:151], v[52:55], v[244:247], v[148:151]
    ds_read_b64_tr_b16 v[212:213], v16 offset:24576
    v_mfma_f32_16x16x32_bf16 v[132:135], v[52:55], v[240:243], v[132:135]
    ds_read_b64_tr_b16 v[214:215], v16 offset:28672
    s_waitcnt lgkmcnt(8)
    s_barrier
    v_mfma_f32_16x16x32_bf16 v[120:123], v[184:187], v[88:91], v[120:123]
    ds_read_b128 v[232:235], v12 offset:0
    ds_read_b128 v[236:239], v12 offset:2048
    v_mfma_f32_16x16x32_bf16 v[136:139], v[184:187], v[92:95], v[136:139]
    ds_read_b128 v[240:243], v12 offset:1024
    v_mfma_f32_16x16x32_bf16 v[140:143], v[188:191], v[92:95], v[140:143]
    ds_read_b128 v[244:247], v12 offset:3072
    v_mfma_f32_16x16x32_bf16 v[124:127], v[188:191], v[88:91], v[124:127]
    ds_read_b64_tr_b16 v[24:25], v13 offset:32768
    v_mfma_f32_16x16x32_bf16 v[128:131], v[192:195], v[88:91], v[128:131]
    ds_read_b64_tr_b16 v[26:27], v13 offset:36864
    ds_read_b64_tr_b16 v[28:29], v14 offset:32768
    v_mfma_f32_16x16x32_bf16 v[144:147], v[192:195], v[92:95], v[144:147]
    ds_read_b64_tr_b16 v[30:31], v14 offset:36864
    v_mfma_f32_16x16x32_bf16 v[148:151], v[196:199], v[92:95], v[148:151]
    ds_read_b64_tr_b16 v[32:33], v15 offset:32768
    v_mfma_f32_16x16x32_bf16 v[132:135], v[196:199], v[88:91], v[132:135]
    ds_read_b64_tr_b16 v[34:35], v15 offset:36864
    s_waitcnt lgkmcnt(10)
    v_mfma_f32_16x16x32_bf16 v[120:123], v[200:203], v[96:99], v[120:123]
    ds_read_b64_tr_b16 v[36:37], v16 offset:32768
    ds_read_b64_tr_b16 v[38:39], v16 offset:36864
    v_mfma_f32_16x16x32_bf16 v[136:139], v[200:203], v[100:103], v[136:139]
    ds_read_b64_tr_b16 v[40:41], v13 offset:40960
    v_mfma_f32_16x16x32_bf16 v[140:143], v[204:207], v[100:103], v[140:143]
    ds_read_b64_tr_b16 v[42:43], v13 offset:45056
    v_mfma_f32_16x16x32_bf16 v[124:127], v[204:207], v[96:99], v[124:127]
    ds_read_b64_tr_b16 v[44:45], v14 offset:40960
    v_mfma_f32_16x16x32_bf16 v[128:131], v[208:211], v[96:99], v[128:131]
    ds_read_b64_tr_b16 v[46:47], v14 offset:45056
    ds_read_b64_tr_b16 v[48:49], v15 offset:40960
    v_mfma_f32_16x16x32_bf16 v[144:147], v[208:211], v[100:103], v[144:147]
    ds_read_b64_tr_b16 v[50:51], v15 offset:45056
    v_mfma_f32_16x16x32_bf16 v[148:151], v[212:215], v[100:103], v[148:151]
    ds_read_b64_tr_b16 v[52:53], v16 offset:40960
    v_mfma_f32_16x16x32_bf16 v[132:135], v[212:215], v[96:99], v[132:135]
    ds_read_b64_tr_b16 v[54:55], v16 offset:45056
    s_waitcnt lgkmcnt(8)
    v_mfma_f32_16x16x32_bf16 v[120:123], v[24:27], v[232:235], v[120:123]
    ds_read_b128 v[88:91], v12 offset:4096
    ds_read_b128 v[92:95], v12 offset:6144
    v_mfma_f32_16x16x32_bf16 v[136:139], v[24:27], v[236:239], v[136:139]
    ds_read_b128 v[96:99], v12 offset:5120
    v_mfma_f32_16x16x32_bf16 v[140:143], v[28:31], v[236:239], v[140:143]
    ds_read_b128 v[100:103], v12 offset:7168
    v_mfma_f32_16x16x32_bf16 v[124:127], v[28:31], v[232:235], v[124:127]
    ds_read_b64_tr_b16 v[184:185], v18 offset:0
    buffer_load_dwordx4 v[152:155], v2, s[24:27], s40 offen offset:0 sc1
    buffer_load_dwordx4 v[156:159], v2, s[24:27], s40 offen offset:1024 sc1
    buffer_load_dwordx4 v[160:163], v2, s[24:27], s12 offen offset:0 sc1
    buffer_load_dwordx4 v[164:167], v2, s[24:27], s12 offen offset:1024 sc1
    v_mfma_f32_16x16x32_bf16 v[128:131], v[32:35], v[232:235], v[128:131]
    ds_read_b64_tr_b16 v[186:187], v18 offset:4096
    ds_read_b64_tr_b16 v[188:189], v19 offset:0
    v_mfma_f32_16x16x32_bf16 v[144:147], v[32:35], v[236:239], v[144:147]
    ds_read_b64_tr_b16 v[190:191], v19 offset:4096
    v_mfma_f32_16x16x32_bf16 v[148:151], v[36:39], v[236:239], v[148:151]
    ds_read_b64_tr_b16 v[192:193], v20 offset:0
    v_mfma_f32_16x16x32_bf16 v[132:135], v[36:39], v[232:235], v[132:135]
    ds_read_b64_tr_b16 v[194:195], v20 offset:4096
    s_waitcnt lgkmcnt(10)
    v_mfma_f32_16x16x32_bf16 v[120:123], v[40:43], v[240:243], v[120:123]
    ds_read_b64_tr_b16 v[196:197], v21 offset:0
    ds_read_b64_tr_b16 v[198:199], v21 offset:4096
    v_mfma_f32_16x16x32_bf16 v[136:139], v[40:43], v[244:247], v[136:139]
    ds_read_b64_tr_b16 v[200:201], v18 offset:8192
    v_mfma_f32_16x16x32_bf16 v[140:143], v[44:47], v[244:247], v[140:143]
    ds_read_b64_tr_b16 v[202:203], v18 offset:12288
    v_mfma_f32_16x16x32_bf16 v[124:127], v[44:47], v[240:243], v[124:127]
    ds_read_b64_tr_b16 v[204:205], v19 offset:8192
    v_mfma_f32_16x16x32_bf16 v[128:131], v[48:51], v[240:243], v[128:131]
    ds_read_b64_tr_b16 v[206:207], v19 offset:12288
    ds_read_b64_tr_b16 v[208:209], v20 offset:8192
    v_mfma_f32_16x16x32_bf16 v[144:147], v[48:51], v[244:247], v[144:147]
    ds_read_b64_tr_b16 v[210:211], v20 offset:12288
    v_mfma_f32_16x16x32_bf16 v[148:151], v[52:55], v[244:247], v[148:151]
    ds_read_b64_tr_b16 v[212:213], v21 offset:8192
    v_mfma_f32_16x16x32_bf16 v[132:135], v[52:55], v[240:243], v[132:135]
    ds_read_b64_tr_b16 v[214:215], v21 offset:12288
    s_waitcnt lgkmcnt(8)
    v_mfma_f32_16x16x32_bf16 v[120:123], v[184:187], v[88:91], v[120:123]
    v_mfma_f32_16x16x32_bf16 v[136:139], v[184:187], v[92:95], v[136:139]
    v_mfma_f32_16x16x32_bf16 v[140:143], v[188:191], v[92:95], v[140:143]
    v_mfma_f32_16x16x32_bf16 v[124:127], v[188:191], v[88:91], v[124:127]
    v_mfma_f32_16x16x32_bf16 v[128:131], v[192:195], v[88:91], v[128:131]
    v_mfma_f32_16x16x32_bf16 v[144:147], v[192:195], v[92:95], v[144:147]
    v_mfma_f32_16x16x32_bf16 v[148:151], v[196:199], v[92:95], v[148:151]
    v_mfma_f32_16x16x32_bf16 v[132:135], v[196:199], v[88:91], v[132:135]
    s_waitcnt lgkmcnt(0)
    s_barrier
    v_mfma_f32_16x16x32_bf16 v[120:123], v[200:203], v[96:99], v[120:123]
    v_mfma_f32_16x16x32_bf16 v[136:139], v[200:203], v[100:103], v[136:139]
    v_mfma_f32_16x16x32_bf16 v[140:143], v[204:207], v[100:103], v[140:143]
    v_mfma_f32_16x16x32_bf16 v[124:127], v[204:207], v[96:99], v[124:127]
    v_mfma_f32_16x16x32_bf16 v[128:131], v[208:211], v[96:99], v[128:131]
    v_mfma_f32_16x16x32_bf16 v[144:147], v[208:211], v[100:103], v[144:147]
    v_mfma_f32_16x16x32_bf16 v[148:151], v[212:215], v[100:103], v[148:151]
    v_mfma_f32_16x16x32_bf16 v[132:135], v[212:215], v[96:99], v[132:135]
    s_mov_b32 s53, 0
dw_23:
    s_waitcnt vmcnt(0)
    v_and_b32 v6, v152, v153
    v_and_b32 v7, v160, v161
    v_bitop3_b32 v6, v154, v155, v6 bitop3:0x80
    v_bitop3_b32 v7, v162, v163, v7 bitop3:0x80
    v_bitop3_b32 v6, v156, v157, v6 bitop3:0x80
    v_bitop3_b32 v7, v164, v165, v7 bitop3:0x80
    v_bitop3_b32 v6, v158, v159, v6 bitop3:0x80
    v_bitop3_b32 v7, v166, v167, v7 bitop3:0x80
    v_bitop3_b32 v6, v6, v7, 1 bitop3:0x80
    v_cmp_eq_u32 vcc, 0, v6
    s_nop 0
    s_cmp_eq_u64 vcc, 0
    s_cbranch_scc1 dok_24
    s_mov_b64 exec, vcc
    s_sleep 1
    buffer_load_dwordx4 v[152:155], v2, s[24:27], s40 offen offset:0 sc1
    buffer_load_dwordx4 v[156:159], v2, s[24:27], s40 offen offset:1024 sc1
    buffer_load_dwordx4 v[160:163], v2, s[24:27], s12 offen offset:0 sc1
    buffer_load_dwordx4 v[164:167], v2, s[24:27], s12 offen offset:1024 sc1
    s_add_u32 s53, s53, 1
    s_cmp_lt_u32 s53, s61
    s_cbranch_scc1 dw_23
    s_mov_b32 s61, 0
    s_waitcnt vmcnt(0)
dok_24:
    s_mov_b64 exec, -1
    v_mfma_f32_16x16x32_bf16 v[120:123], v[226:229], v[152:155], v[120:123]
    v_mfma_f32_16x16x32_bf16 v[124:127], v[224:227], v[152:155], v[124:127]
    v_mfma_f32_16x16x32_bf16 v[128:131], v[226:229], v[156:159], v[128:131]
    v_mfma_f32_16x16x32_bf16 v[132:135], v[224:227], v[156:159], v[132:135]
    v_mfma_f32_16x16x32_bf16 v[136:139], v[226:229], v[160:163], v[136:139]
    v_mfma_f32_16x16x32_bf16 v[140:143], v[224:227], v[160:163], v[140:143]
    v_mfma_f32_16x16x32_bf16 v[144:147], v[226:229], v[164:167], v[144:147]
    v_mfma_f32_16x16x32_bf16 v[148:151], v[224:227], v[164:167], v[148:151]
    s_cmp_eq_u32 s60, 1
    s_cbranch_scc1 G4_last
    v_and_or_b32 v120, v120, s15, v56
    v_and_or_b32 v122, v122, s15, v56
    v_and_or_b32 v124, v124, s15, v56
    v_and_or_b32 v126, v126, s15, v56
    v_cvt_pk_bf16_f32 v120, v120, v121
    v_cvt_pk_bf16_f32 v121, v122, v123
    v_cvt_pk_bf16_f32 v122, v124, v125
    v_cvt_pk_bf16_f32 v123, v126, v127
    buffer_store_dwordx4 v[120:123], v2, s[88:91], s40 offen offset:0 sc1
    v_and_or_b32 v128, v128, s15, v56
    v_and_or_b32 v130, v130, s15, v56
    v_and_or_b32 v132, v132, s15, v56
    v_and_or_b32 v134, v134, s15, v56
    v_cvt_pk_bf16_f32 v128, v128, v129
    v_cvt_pk_bf16_f32 v129, v130, v131
    v_cvt_pk_bf16_f32 v130, v132, v133
    v_cvt_pk_bf16_f32 v131, v134, v135
    buffer_store_dwordx4 v[128:131], v2, s[88:91], s40 offen offset:1024 sc1
    s_add_u32 s36, s40, 65536
    v_and_or_b32 v136, v136, s15, v56
    v_and_or_b32 v138, v138, s15, v56
    v_and_or_b32 v140, v140, s15, v56
    v_and_or_b32 v142, v142, s15, v56
    v_cvt_pk_bf16_f32 v136, v136, v137
    v_cvt_pk_bf16_f32 v137, v138, v139
    v_cvt_pk_bf16_f32 v138, v140, v141
    v_cvt_pk_bf16_f32 v139, v142, v143
    buffer_store_dwordx4 v[136:139], v2, s[88:91], s36 offen offset:0 sc1
    v_and_or_b32 v144, v144, s15, v56
    v_and_or_b32 v146, v146, s15, v56
    v_and_or_b32 v148, v148, s15, v56
    v_and_or_b32 v150, v150, s15, v56
    v_cvt_pk_bf16_f32 v144, v144, v145
    v_cvt_pk_bf16_f32 v145, v146, v147
    v_cvt_pk_bf16_f32 v146, v148, v149
    v_cvt_pk_bf16_f32 v147, v150, v151
    buffer_store_dwordx4 v[144:147], v2, s[88:91], s36 offen offset:1024 sc1
    v_and_b32 v81, 7, v0
    v_lshrrev_b32 v84, 6, v0
    v_lshlrev_b32 v84, 4, v84
    v_bfe_u32 v85, v0, 3, 3
    v_add_u32 v84, v84, v85
    s_lshr_b32 s78, s29, 1
    s_lshl_b32 s78, s78, 16
    s_and_b32 s79, s29, 1
    s_lshl_b32 s79, s79, 7
    s_add_u32 s78, s78, s79
    s_lshr_b32 s79, s30, 1
    s_lshl_b32 s79, s79, 13
    s_add_u32 s78, s78, s79
    v_lshlrev_b32 v78, 8, v84
    v_lshl_add_u32 v78, v81, 4, v78
    v_add_u32 v78, s78, v78
    s_lshl_b32 s78, s28, 7
    s_lshl_b32 s79, s29, 3
    s_add_u32 s78, s78, s79
    v_add_u32 v79, s78, v81
    v_lshlrev_b32 v80, 11, v79
    v_and_b32 v85, 3, v79
    v_lshrrev_b32 v82, 2, v79
    v_lshlrev_b32 v82, 14, v82
    v_lshl_add_u32 v82, v85, 11, v82
    v_lshl_add_u32 v82, v84, 4, v82
    v_lshrrev_b32 v85, 2, v84
    v_lshlrev_b32 v85, 3, v85
    v_and_b32 v84, 3, v84
    v_add_u32 v84, v84, v85
    v_lshl_add_u32 v80, v84, 3, v80
    v_lshlrev_b32 v79, 3, v79
    v_lshl_add_u32 v79, v84, 14, v79
    s_add_u32 s80, s4, 0x1800000
    s_addc_u32 s81, s5, 0
    s_mov_b32 s82, 0x400000
    s_mov_b32 s83, 0x20000
    s_mov_b32 s78, 0
    buffer_load_dwordx2 v[110:111], v79, s[80:83], s78 offen sc1
    s_mov_b32 s78, 65536
    buffer_load_dwordx2 v[112:113], v79, s[80:83], s78 offen sc1
    s_mov_b32 s78, 262144
    buffer_load_dwordx2 v[114:115], v79, s[80:83], s78 offen sc1
    s_mov_b32 s78, 327680
    buffer_load_dwordx2 v[116:117], v79, s[80:83], s78 offen sc1
    s_branch NEXT
G4_last:
    v_cvt_pk_bf16_f32 v120, v120, v121
    v_cvt_pk_bf16_f32 v121, v122, v123
    v_cvt_pk_bf16_f32 v122, v124, v125
    v_cvt_pk_bf16_f32 v123, v126, v127
    s_nop 0
    v_permlane16_swap_b32 v120, v122
    v_permlane16_swap_b32 v121, v123
    v_cvt_pk_bf16_f32 v128, v128, v129
    v_cvt_pk_bf16_f32 v129, v130, v131
    v_cvt_pk_bf16_f32 v130, v132, v133
    v_cvt_pk_bf16_f32 v131, v134, v135
    s_nop 0
    v_permlane16_swap_b32 v128, v130
    v_permlane16_swap_b32 v129, v131
    v_cndmask_b32 v132, v120, v128, s[50:51]
    v_cndmask_b32 v133, v121, v129, s[50:51]
    v_cndmask_b32 v134, v122, v130, s[50:51]
    v_cndmask_b32 v135, v123, v131, s[50:51]
    v_mov_b32_dpp v124, v132 row_ror:8 row_mask:0xf bank_mask:0xf
    v_mov_b32_dpp v125, v133 row_ror:8 row_mask:0xf bank_mask:0xf
    v_mov_b32_dpp v126, v134 row_ror:8 row_mask:0xf bank_mask:0xf
    v_mov_b32_dpp v127, v135 row_ror:8 row_mask:0xf bank_mask:0xf
    v_cndmask_b32 v120, v124, v120, s[50:51]
    v_cndmask_b32 v128, v128, v124, s[50:51]
    v_cndmask_b32 v121, v125, v121, s[50:51]
    v_cndmask_b32 v129, v129, v125, s[50:51]
    v_cndmask_b32 v122, v126, v122, s[50:51]
    v_cndmask_b32 v130, v130, v126, s[50:51]
    v_cndmask_b32 v123, v127, v123, s[50:51]
    v_cndmask_b32 v131, v131, v127, s[50:51]
    buffer_store_dwordx4 v[120:123], v10, s[20:23], s38 offen sc1
    buffer_store_dwordx4 v[128:131], v11, s[20:23], s38 offen sc1
    v_cvt_pk_bf16_f32 v136, v136, v137
    v_cvt_pk_bf16_f32 v137, v138, v139
    v_cvt_pk_bf16_f32 v138, v140, v141
    v_cvt_pk_bf16_f32 v139, v142, v143
    s_nop 0
    v_permlane16_swap_b32 v136, v138
    v_permlane16_swap_b32 v137, v139
    v_cvt_pk_bf16_f32 v144, v144, v145
    v_cvt_pk_bf16_f32 v145, v146, v147
    v_cvt_pk_bf16_f32 v146, v148, v149
    v_cvt_pk_bf16_f32 v147, v150, v151
    s_nop 0
    v_permlane16_swap_b32 v144, v146
    v_permlane16_swap_b32 v145, v147
    v_cndmask_b32 v148, v136, v144, s[50:51]
    v_cndmask_b32 v149, v137, v145, s[50:51]
    v_cndmask_b32 v150, v138, v146, s[50:51]
    v_cndmask_b32 v151, v139, v147, s[50:51]
    v_mov_b32_dpp v140, v148 row_ror:8 row_mask:0xf bank_mask:0xf
    v_mov_b32_dpp v141, v149 row_ror:8 row_mask:0xf bank_mask:0xf
    v_mov_b32_dpp v142, v150 row_ror:8 row_mask:0xf bank_mask:0xf
    v_mov_b32_dpp v143, v151 row_ror:8 row_mask:0xf bank_mask:0xf
    v_cndmask_b32 v136, v140, v136, s[50:51]
    v_cndmask_b32 v144, v144, v140, s[50:51]
    v_cndmask_b32 v137, v141, v137, s[50:51]
    v_cndmask_b32 v145, v145, v141, s[50:51]
    v_cndmask_b32 v138, v142, v138, s[50:51]
    v_cndmask_b32 v146, v146, v142, s[50:51]
    v_cndmask_b32 v139, v143, v139, s[50:51]
    v_cndmask_b32 v147, v147, v143, s[50:51]
    buffer_store_dwordx4 v[136:139], v10, s[20:23], s39 offen sc1
    buffer_store_dwordx4 v[144:147], v11, s[20:23], s39 offen sc1
    s_branch K_fin
LOADERS:
    s_mov_b64 s[80:81], s[68:69]
    s_mov_b32 s82, 2097152
    s_mov_b32 s83, 0x20000
    s_cmp_lg_u32 s60, 0
    s_cbranch_scc1 WY_1
    ds_read_b64_tr_b16 v[128:129], v74 offset:0
    ds_read_b64_tr_b16 v[130:131], v74 offset:2048
    ds_read_b64_tr_b16 v[136:137], v74 offset:4096
    ds_read_b64_tr_b16 v[138:139], v74 offset:6144
    ds_read_b64_tr_b16 v[144:145], v74 offset:8192
    ds_read_b64_tr_b16 v[146:147], v74 offset:10240
    ds_read_b64_tr_b16 v[152:153], v74 offset:12288
    ds_read_b64_tr_b16 v[154:155], v74 offset:14336
    ds_read_b64_tr_b16 v[160:161], v74 offset:16384
    ds_read_b64_tr_b16 v[162:163], v74 offset:18432
    ds_read_b64_tr_b16 v[168:169], v74 offset:20480
    ds_read_b64_tr_b16 v[170:171], v74 offset:22528
    ds_read_b64_tr_b16 v[176:177], v75 offset:16384
    ds_read_b64_tr_b16 v[178:179], v75 offset:18432
    ds_read_b64_tr_b16 v[184:185], v75 offset:20480
    ds_read_b64_tr_b16 v[186:187], v75 offset:22528
    ds_read_b64_tr_b16 v[192:193], v75 offset:24576
    ds_read_b64_tr_b16 v[194:195], v75 offset:26624
    ds_read_b64_tr_b16 v[200:201], v75 offset:28672
    ds_read_b64_tr_b16 v[202:203], v75 offset:30720
    ds_read_b64_tr_b16 v[208:209], v74 offset:32768
    ds_read_b64_tr_b16 v[210:211], v74 offset:34816
    ds_read_b64_tr_b16 v[216:217], v74 offset:36864
    ds_read_b64_tr_b16 v[218:219], v74 offset:38912
    ds_read_b64_tr_b16 v[224:225], v74 offset:40960
    ds_read_b64_tr_b16 v[226:227], v74 offset:43008
    ds_read_b64_tr_b16 v[232:233], v74 offset:45056
    ds_read_b64_tr_b16 v[234:235], v74 offset:47104
    ds_read_b64_tr_b16 v[240:241], v75 offset:32768
    ds_read_b64_tr_b16 v[242:243], v75 offset:34816
    ds_read_b64_tr_b16 v[248:249], v75 offset:36864
    ds_read_b64_tr_b16 v[250:251], v75 offset:38912
    s_branch WY_2
WY_1:
    s_and_b32 s49, s30, 3
    s_lshl_b32 s36, s49, 14
    s_lshl_b32 s48, s29, 7
    s_add_u32 s48, s48, s36
    s_lshl_b32 s49, s49, 10
    s_xor_b32 s48, s48, 128
    s_add_u32 s36, s48, 917504
    s_add_u32 m0, s49, 81920
    s_nop 0
    buffer_load_dwordx4 v118, s[80:83], s36 offen lds
    s_add_u32 s36, s36, 65536
    s_add_u32 m0, s49, 86016
    s_nop 0
    buffer_load_dwordx4 v118, s[80:83], s36 offen lds
    s_add_u32 s36, s48, 1048576
    s_add_u32 m0, s49, 90112
    s_nop 0
    buffer_load_dwordx4 v118, s[80:83], s36 offen lds
    s_add_u32 s36, s36, 65536
    s_add_u32 m0, s49, 94208
    s_nop 0
    buffer_load_dwordx4 v118, s[80:83], s36 offen lds
WY_2:
    v_and_b32 v8, 15, v1
    v_lshrrev_b32 v9, 4, v1
    s_and_b32 s34, s30, 1
    s_and_b32 s37, s30, 3
    s_lshr_b32 s38, s29, 3
    s_add_u32 s38, s38, 1
    s_sub_u32 s39, 0, s38
    s_bitcmp1_b32 s29, 2
    s_cselect_b32 s38, s38, s39
    s_lshl_b32 s35, s28, 7
    s_cmp_lt_u32 s37, 2
    s_cselect_b32 s36, s38, 0
    s_add_u32 s36, s36, s35
    s_lshl_b32 s45, s34, 6
    s_add_u32 s36, s36, s45
    v_add_u32 v72, s36, v1
    s_movk_i32 s45, 2048
    v_cmp_gt_u32 s[46:47], s45, v72
    v_lshlrev_b32 v72, 4, v72
    s_lshl_b32 s22, s60, 15
    s_add_u32 s22, s22, 23199744
    s_add_u32 s20, s4, s22
    s_addc_u32 s21, s5, 0
    s_mov_b32 s22, 32768
    s_mov_b32 s23, 0x20000
    s_lshl_b32 s36, s37, 2
    v_add_u32 v6, s36, v9
    v_xor_b32 v10, v6, v8
    s_add_u32 s36, s35, s38
    s_add_u32 s36, s36, 16
    v_add_u32 v6, s36, v6
    v_and_b32 v7, 3, v6
    v_lshrrev_b32 v11, 2, v6
    v_lshlrev_b32 v11, 14, v11
    v_lshl_add_u32 v11, v7, 11, v11
    v_lshl_add_u32 v11, v10, 4, v11
    v_subrev_u32 v10, 65536, v11
    s_lshl_b32 s44, s37, 10
    s_lshl_b32 s14, s60, 24
    s_lshl_b32 s15, s94, 13
    s_add_u32 s14, s14, s15
    s_add_u32 s14, s14, 167772160
    s_add_u32 s12, s4, s14
    s_addc_u32 s13, s5, 0
    s_mov_b32 s14, 8380416
    s_mov_b32 s15, 0x20000
    s_cmp_lg_u32 s60, 0
    s_waitcnt vmcnt(4)
    s_cbranch_scc1 WY_6
    s_waitcnt vmcnt(0) lgkmcnt(0)
    s_barrier
    s_and_b32 s49, s30, 3
    s_lshl_b32 s36, s49, 14
    s_lshl_b32 s48, s29, 7
    s_add_u32 s48, s48, s36
    s_lshl_b32 s49, s49, 10
    s_xor_b32 s48, s48, 128
    s_add_u32 s36, s48, 917504
    s_add_u32 m0, s49, 81920
    s_nop 0
    buffer_load_dwordx4 v118, s[80:83], s36 offen lds
    s_add_u32 s36, s36, 65536
    s_add_u32 m0, s49, 86016
    s_nop 0
    buffer_load_dwordx4 v118, s[80:83], s36 offen lds
    s_add_u32 s36, s48, 1048576
    s_add_u32 m0, s49, 90112
    s_nop 0
    buffer_load_dwordx4 v118, s[80:83], s36 offen lds
    s_add_u32 s36, s36, 65536
    s_add_u32 m0, s49, 94208
    s_nop 0
    buffer_load_dwordx4 v118, s[80:83], s36 offen lds
    s_branch WY_7
WY_6:
    s_barrier
WY_7:
    s_add_u32 s36, s48, 131072
    s_add_u32 m0, s49, 32768
    s_nop 0
    buffer_load_dwordx4 v118, s[80:83], s36 offen lds
    s_add_u32 s36, s36, 65536
    s_add_u32 m0, s49, 36864
    s_nop 0
    buffer_load_dwordx4 v118, s[80:83], s36 offen lds
    s_add_u32 s36, s48, 262144
    s_add_u32 m0, s49, 40960
    s_nop 0
    buffer_load_dwordx4 v118, s[80:83], s36 offen lds
    s_add_u32 s36, s36, 65536
    s_add_u32 m0, s49, 45056
    s_nop 0
    buffer_load_dwordx4 v118, s[80:83], s36 offen lds
    s_add_u32 s36, s48, 1179648
    s_add_u32 m0, s49, 98304
    s_nop 0
    buffer_load_dwordx4 v118, s[80:83], s36 offen lds
    s_add_u32 s36, s36, 65536
    s_add_u32 m0, s49, 102400
    s_nop 0
    buffer_load_dwordx4 v118, s[80:83], s36 offen lds
    s_add_u32 s36, s48, 1310720
    s_add_u32 m0, s49, 106496
    s_nop 0
    buffer_load_dwordx4 v118, s[80:83], s36 offen lds
    s_add_u32 s36, s36, 65536
    s_add_u32 m0, s49, 110592
    s_nop 0
    buffer_load_dwordx4 v118, s[80:83], s36 offen lds
    v_lshrrev_b32 v6, 3, v1
    v_and_b32 v17, 7, v1
    v_xor_b32 v17, v17, v6
    s_lshl_b32 s36, s37, 3
    s_add_u32 s36, s36, s35
    v_add_u32 v6, s36, v6
    v_and_b32 v7, 3, v6
    v_lshrrev_b32 v12, 2, v6
    v_lshlrev_b32 v12, 14, v12
    v_lshl_add_u32 v12, v7, 11, v12
    s_lshl_b32 s36, s29, 7
    v_lshl_add_u32 v12, v17, 4, v12
    v_add_u32 v12, s36, v12
    v_lshrrev_b32 v6, 1, v9
    s_lshl_b32 s36, s37, 1
    v_add_u32 v6, s36, v6
    v_and_b32 v7, 7, v8
    v_xor_b32 v6, v6, v7
    v_lshlrev_b32 v17, 7, v8
    v_lshl_add_u32 v17, v6, 4, v17
    v_and_b32 v6, 1, v9
    v_lshl_add_u32 v17, v6, 3, v17
    v_and_b32 v6, 1, v9
    v_lshlrev_b32 v13, 16, v6
    v_lshrrev_b32 v6, 1, v9
    v_lshl_add_u32 v13, v6, 8, v13
    v_lshl_add_u32 v13, v8, 4, v13
    s_bfe_u32 s36, s30, 0x10001
    s_lshl1_add_u32 s36, s29, s36
    s_lshr_b32 s53, s36, 3
    s_lshl_b32 s53, s53, 14
    s_and_b32 s39, s36, 7
    s_lshl_b32 s39, s39, 10
    s_add_u32 s39, s39, s53
    s_and_b32 s36, s30, 1
    s_lshl_b32 s36, s36, 9
    s_add_u32 s39, s39, s36
    v_mov_b32 v14, v2
    v_add_u32 v15, 106496, v2
    v_lshrrev_b32 v6, 5, v13
    v_and_b32 v6, 2048, v6
    v_and_b32 v16, 511, v13
    v_add_u32 v16, v16, v6
    s_lshl_b32 s36, s37, 9
    v_add_u32 v16, s36, v16
    s_add_u32 s16, s62, 0x400000
    s_addc_u32 s17, s63, 0
    s_mov_b32 s18, 0x7e000
    s_mov_b32 s19, 0x20000
    s_add_u32 s24, s62, 0x480000
    s_addc_u32 s25, s63, 0
    s_mov_b32 s26, 0x7e000
    s_mov_b32 s27, 0x20000
    s_and_b32 s78, s30, 3
    s_lshl_b32 s78, s78, 15
    s_and_b32 s53, s30, 2
    s_lshl_b32 s53, s53, 11
    s_and_b32 s82, s30, 1
    s_lshl_b32 s82, s82, 13
    s_add_u32 s82, s82, s53
    s_and_b32 s84, s30, 1
    s_lshl_b32 s84, s84, 8
    s_add_u32 s84, s84, s55
    s_add_u32 s85, s52, 16
    s_mov_b64 s[8:9], s[72:73]
    s_mov_b32 s10, 7340032
    s_mov_b32 s11, 0x20000
    s_add_u32 s89, s29, 1
    s_and_b32 s89, s89, 15
    s_cmp_lg_u32 s28, s29
    s_cselect_b32 s89, s28, s89
    s_and_b32 s90, s30, 3
    s_mul_i32 s36, s29, 448
    s_lshl2_add_u32 s88, s29, s90
    s_mul_i32 s88, s88, 114688
    s_add_u32 s88, s88, s36
    s_lshl2_add_u32 s89, s89, s90
    s_mul_i32 s89, s89, 114688
    s_add_u32 s89, s89, s36
    s_mul_i32 s90, s90, 7168
    s_waitcnt vmcnt(0) lgkmcnt(0)
    s_setprio 1
    s_add_u32 m0, s44, 122880
    s_mov_b32 s49, 0
    s_barrier
    buffer_load_dwordx4 v[52:55], v72, s[20:23], 0 offen sc1
    buffer_load_dwordx4 v10, s[12:15], s49 offen offset:0 sc1 lds
    s_add_u32 m0, s44, 130048
    s_nop 0
    buffer_load_dwordx4 v10, s[12:15], s49 offen offset:1024 sc1 lds
    s_add_u32 m0, s44, 126976
    s_nop 0
    buffer_load_dwordx4 v11, s[12:15], s49 offen offset:0 sc1 lds
    s_add_u32 m0, s44, 134144
    s_nop 0
    buffer_load_dwordx4 v11, s[12:15], s49 offen offset:1024 sc1 lds
    s_add_u32 m0, s44, 139264
    s_mov_b32 s49, 256
    buffer_load_dwordx4 v10, s[12:15], s49 offen offset:0 sc1 lds
    s_add_u32 m0, s44, 146432
    s_nop 0
    buffer_load_dwordx4 v10, s[12:15], s49 offen offset:1024 sc1 lds
    s_add_u32 m0, s44, 143360
    s_nop 0
    buffer_load_dwordx4 v11, s[12:15], s49 offen offset:0 sc1 lds
    s_add_u32 m0, s44, 150528
    s_nop 0
    buffer_load_dwordx4 v11, s[12:15], s49 offen offset:1024 sc1 lds
    s_waitcnt vmcnt(8)
    s_mov_b32 s53, 0
lns_25:
    v_cmp_eq_u32 vcc, s52, v53
    v_cmp_eq_u32 s[50:51], s52, v55
    s_nop 0
    s_and_b64 vcc, vcc, s[50:51]
    s_orn2_b64 vcc, vcc, s[46:47]
    s_cmp_eq_u64 vcc, -1
    s_cbranch_scc1 lnk_26
    buffer_load_dwordx4 v[52:55], v72, s[20:23], 0 offen sc1
    s_waitcnt vmcnt(0)
    s_add_u32 s53, s53, 1
    s_cmp_lt_u32 s53, s61
    s_cbranch_scc1 lns_25
    s_mov_b32 s61, 0
lnk_26:
    v_lshlrev_b32 v56, 16, v52
    v_and_b32 v57, 0xffff0000, v52
    v_lshlrev_b32 v58, 16, v54
    v_and_b32 v59, 0xffff0000, v54
    v_cndmask_b32 v57, 1.0, v57, s[46:47]
    v_cndmask_b32 v59, 1.0, v59, s[46:47]
    s_lshl_b32 s36, s34, 10
    s_add_u32 s36, s36, 155648
    v_add_u32 v6, s36, v2
    s_cmp_ge_u32 s37, 2
    s_cbranch_scc1 lnx_27
    v_mul_f32 v66, v57, v59
    v_fma_f32 v60, -v58, v57, -v56
    v_rcp_f32 v7, v66
    v_mov_b32 v67, v66
    v_mov_b32 v61, v60
    v_mul_f32 v62, 0xc0135761, v7
    v_mul_f32 v7, v7, v7
    v_mov_b32 v63, v62
    v_mul_f32 v7, 0x3d372713, v7
    v_mul_f32 v64, v7, v62
    v_mov_b32 v65, v64
    ds_write_b128 v6, v[60:63] offset:0
    ds_write_b128 v6, v[64:67] offset:2048
    s_branch lnd_28
lnx_27:
    v_rcp_f32 v60, v57
    s_nop 0
    v_mul_f32 v62, -v56, v60
    v_mov_b32 v61, v60
    v_mov_b32 v63, v62
    ds_write_b128 v6, v[60:63] offset:5120
lnd_28:
    v_lshlrev_b32 v7, 4, v8
    v_add_u32 v7, 160768, v7
    s_add_u32 m0, s44, 16384
    s_mov_b32 s49, 512
    buffer_load_dwordx4 v10, s[12:15], s49 offen offset:0 sc1 lds
    s_add_u32 m0, s44, 23552
    s_nop 0
    buffer_load_dwordx4 v10, s[12:15], s49 offen offset:1024 sc1 lds
    s_add_u32 m0, s44, 20480
    s_nop 0
    buffer_load_dwordx4 v11, s[12:15], s49 offen offset:0 sc1 lds
    s_add_u32 m0, s44, 27648
    s_nop 0
    buffer_load_dwordx4 v11, s[12:15], s49 offen offset:1024 sc1 lds
    s_add_u32 m0, s44, 32768
    s_mov_b32 s49, 768
    s_waitcnt vmcnt(8)
    s_barrier
    buffer_load_dwordx4 v10, s[12:15], s49 offen offset:0 sc1 lds
    s_add_u32 m0, s44, 39936
    s_nop 0
    buffer_load_dwordx4 v10, s[12:15], s49 offen offset:1024 sc1 lds
    s_add_u32 m0, s44, 36864
    s_nop 0
    buffer_load_dwordx4 v11, s[12:15], s49 offen offset:0 sc1 lds
    s_add_u32 m0, s44, 44032
    s_nop 0
    buffer_load_dwordx4 v11, s[12:15], s49 offen offset:1024 sc1 lds
    v_mov_b32 v10, v11
    v_add_u32 v11, 65536, v11
    s_add_u32 m0, s44, 106496
    s_mov_b32 s49, 65536
    s_waitcnt vmcnt(8)
    s_barrier
    buffer_load_dwordx4 v10, s[12:15], s49 offen offset:0 sc1 lds
    s_add_u32 m0, s44, 113664
    s_nop 0
    buffer_load_dwordx4 v10, s[12:15], s49 offen offset:1024 sc1 lds
    s_add_u32 m0, s44, 110592
    s_nop 0
    buffer_load_dwordx4 v11, s[12:15], s49 offen offset:0 sc1 lds
    s_add_u32 m0, s44, 117760
    s_nop 0
    buffer_load_dwordx4 v11, s[12:15], s49 offen offset:1024 sc1 lds
    s_add_u32 m0, s44, 122880
    s_mov_b32 s49, 65792
    s_waitcnt vmcnt(8)
    s_barrier
    buffer_load_dwordx4 v10, s[12:15], s49 offen offset:0 sc1 lds
    s_add_u32 m0, s44, 130048
    s_nop 0
    buffer_load_dwordx4 v10, s[12:15], s49 offen offset:1024 sc1 lds
    s_add_u32 m0, s44, 126976
    s_nop 0
    buffer_load_dwordx4 v11, s[12:15], s49 offen offset:0 sc1 lds
    s_add_u32 m0, s44, 134144
    s_nop 0
    buffer_load_dwordx4 v11, s[12:15], s49 offen offset:1024 sc1 lds
    s_add_u32 m0, s44, 139264
    s_mov_b32 s49, 66048
    s_waitcnt vmcnt(8)
    s_barrier
    buffer_load_dwordx4 v10, s[12:15], s49 offen offset:0 sc1 lds
    s_add_u32 m0, s44, 146432
    s_nop 0
    buffer_load_dwordx4 v10, s[12:15], s49 offen offset:1024 sc1 lds
    s_add_u32 m0, s44, 143360
    s_nop 0
    buffer_load_dwordx4 v11, s[12:15], s49 offen offset:0 sc1 lds
    s_add_u32 m0, s44, 150528
    s_nop 0
    buffer_load_dwordx4 v11, s[12:15], s49 offen offset:1024 sc1 lds
    s_waitcnt lgkmcnt(0)
    s_add_u32 m0, s44, 16384
    s_mov_b32 s49, 66304
    s_waitcnt vmcnt(8)
    s_barrier
    buffer_load_dwordx4 v10, s[12:15], s49 offen offset:0 sc1 lds
    s_add_u32 m0, s44, 23552
    s_nop 0
    buffer_load_dwordx4 v10, s[12:15], s49 offen offset:1024 sc1 lds
    s_add_u32 m0, s44, 20480
    s_nop 0
    buffer_load_dwordx4 v11, s[12:15], s49 offen offset:0 sc1 lds
    s_add_u32 m0, s44, 27648
    s_nop 0
    buffer_load_dwordx4 v11, s[12:15], s49 offen offset:1024 sc1 lds
    s_add_u32 m0, s44, 0
    s_mov_b32 s36, 0
    buffer_load_dwordx4 v12, s[12:15], s36 offen sc1 lds
    s_add_u32 m0, s44, 4096
    s_mov_b32 s36, 131072
    buffer_load_dwordx4 v12, s[12:15], s36 offen sc1 lds
    s_add_u32 m0, s44, 8192
    s_mov_b32 s36, 262144
    buffer_load_dwordx4 v12, s[12:15], s36 offen sc1 lds
    s_add_u32 m0, s44, 12288
    s_mov_b32 s36, 393216
    buffer_load_dwordx4 v12, s[12:15], s36 offen sc1 lds
    s_add_u32 m0, s90, 77824
    s_nop 0
    buffer_load_dwordx4 v121, s[8:11], s89 offen lds
    s_add_u32 m0, s90, 78848
    s_nop 0
    buffer_load_dwordx4 v122, s[8:11], s89 offen lds
    s_add_u32 m0, s44, 32768
    s_mov_b32 s49, 196608
    s_waitcnt vmcnt(14)
    s_barrier
    buffer_load_dwordx4 v10, s[12:15], s49 offen offset:0 sc1 lds
    s_add_u32 m0, s44, 39936
    s_nop 0
    buffer_load_dwordx4 v10, s[12:15], s49 offen offset:1024 sc1 lds
    s_add_u32 m0, s44, 36864
    s_nop 0
    buffer_load_dwordx4 v11, s[12:15], s49 offen offset:0 sc1 lds
    s_add_u32 m0, s44, 44032
    s_nop 0
    buffer_load_dwordx4 v11, s[12:15], s49 offen offset:1024 sc1 lds
    s_add_u32 m0, s44, 106496
    s_mov_b32 s49, 196864
    s_waitcnt vmcnt(14)
    s_barrier
    buffer_load_dwordx4 v10, s[12:15], s49 offen offset:0 sc1 lds
    s_add_u32 m0, s44, 113664
    s_nop 0
    buffer_load_dwordx4 v10, s[12:15], s49 offen offset:1024 sc1 lds
    s_add_u32 m0, s44, 110592
    s_nop 0
    buffer_load_dwordx4 v11, s[12:15], s49 offen offset:0 sc1 lds
    s_add_u32 m0, s44, 117760
    s_nop 0
    buffer_load_dwordx4 v11, s[12:15], s49 offen offset:1024 sc1 lds
    s_add_u32 m0, s44, 122880
    s_mov_b32 s49, 197120
    s_waitcnt vmcnt(10)
    s_barrier
    buffer_load_dwordx4 v10, s[12:15], s49 offen offset:0 sc1 lds
    s_add_u32 m0, s44, 130048
    s_nop 0
    buffer_load_dwordx4 v10, s[12:15], s49 offen offset:1024 sc1 lds
    s_add_u32 m0, s44, 126976
    s_nop 0
    buffer_load_dwordx4 v11, s[12:15], s49 offen offset:0 sc1 lds
    s_add_u32 m0, s44, 134144
    s_nop 0
    buffer_load_dwordx4 v11, s[12:15], s49 offen offset:1024 sc1 lds
    ds_read_b64 v[22:23], v17 offset:0
    ds_read_b128 v[60:63], v7 offset:0
    ds_read_b64 v[26:27], v17 offset:2048
    ds_read_b128 v[64:67], v7 offset:256
    s_add_u32 m0, s44, 139264
    s_mov_b32 s49, 197376
    s_waitcnt vmcnt(8)
    s_barrier
    buffer_load_dwordx4 v10, s[12:15], s49 offen offset:0 sc1 lds
    s_waitcnt lgkmcnt(0)
    v_lshlrev_b32 v20, 16, v22
    v_and_b32 v21, 0xffff0000, v22
    v_lshlrev_b32 v22, 16, v23
    v_and_b32 v23, 0xffff0000, v23
    s_add_u32 m0, s44, 146432
    s_nop 0
    buffer_load_dwordx4 v10, s[12:15], s49 offen offset:1024 sc1 lds
    v_pk_fma_f32 v[20:21], v[20:21], v[60:61], v[62:63]
    v_pk_fma_f32 v[22:23], v[22:23], v[60:61], v[62:63]
    v_lshlrev_b32 v24, 16, v26
    v_and_b32 v25, 0xffff0000, v26
    v_lshlrev_b32 v26, 16, v27
    s_add_u32 m0, s44, 143360
    s_nop 0
    buffer_load_dwordx4 v11, s[12:15], s49 offen offset:0 sc1 lds
    v_and_b32 v27, 0xffff0000, v27
    v_pk_fma_f32 v[24:25], v[24:25], v[64:65], v[66:67]
    v_pk_fma_f32 v[26:27], v[26:27], v[64:65], v[66:67]
    s_add_u32 m0, s44, 150528
    s_nop 0
    buffer_load_dwordx4 v11, s[12:15], s49 offen offset:1024 sc1 lds
    ds_read_b64 v[30:31], v17 offset:4096
    ds_read_b128 v[60:63], v7 offset:512
    ds_read_b64 v[34:35], v17 offset:6144
    ds_read_b128 v[64:67], v7 offset:768
    s_add_u32 m0, s90, 79872
    s_nop 0
    buffer_load_dwordx4 v123, s[8:11], s89 offen lds
    s_add_u32 m0, s90, 80896
    s_nop 0
    buffer_load_dwordx4 v124, s[8:11], s89 offen lds
    s_add_u32 m0, s90, 81920
    s_nop 0
    buffer_load_dwordx4 v125, s[8:11], s89 offen lds
    s_add_u32 m0, s90, 82944
    s_nop 0
    buffer_load_dwordx4 v126, s[8:11], s89 offen lds
    s_add_u32 m0, s90, 83968
    s_nop 0
    buffer_load_dwordx4 v127, s[8:11], s89 offen lds
    s_add_u32 m0, s90, 49152
    s_nop 0
    buffer_load_dwordx4 v121, s[8:11], s88 offen lds
    s_add_u32 m0, s44, 16384
    s_mov_b32 s49, 327680
    s_waitcnt vmcnt(14)
    s_barrier
    buffer_load_dwordx4 v10, s[12:15], s49 offen offset:0 sc1 lds
    s_waitcnt lgkmcnt(0)
    v_lshlrev_b32 v28, 16, v30
    v_and_b32 v29, 0xffff0000, v30
    v_lshlrev_b32 v30, 16, v31
    v_and_b32 v31, 0xffff0000, v31
    s_add_u32 m0, s44, 23552
    s_nop 0
    buffer_load_dwordx4 v10, s[12:15], s49 offen offset:1024 sc1 lds
    v_pk_fma_f32 v[28:29], v[28:29], v[60:61], v[62:63]
    v_pk_fma_f32 v[30:31], v[30:31], v[60:61], v[62:63]
    v_lshlrev_b32 v32, 16, v34
    v_and_b32 v33, 0xffff0000, v34
    v_lshlrev_b32 v34, 16, v35
    s_add_u32 m0, s44, 20480
    s_nop 0
    buffer_load_dwordx4 v11, s[12:15], s49 offen offset:0 sc1 lds
    v_and_b32 v35, 0xffff0000, v35
    v_pk_fma_f32 v[32:33], v[32:33], v[64:65], v[66:67]
    v_pk_fma_f32 v[34:35], v[34:35], v[64:65], v[66:67]
    s_add_u32 m0, s44, 27648
    s_nop 0
    buffer_load_dwordx4 v11, s[12:15], s49 offen offset:1024 sc1 lds
    ds_read_b64 v[38:39], v17 offset:8192
    ds_read_b128 v[60:63], v7 offset:1024
    ds_read_b64 v[42:43], v17 offset:10240
    ds_read_b128 v[64:67], v7 offset:1280
    s_add_u32 m0, s44, 32768
    s_mov_b32 s49, 327936
    s_waitcnt vmcnt(14)
    s_barrier
    buffer_load_dwordx4 v10, s[12:15], s49 offen offset:0 sc1 lds
    s_waitcnt lgkmcnt(0)
    v_lshlrev_b32 v36, 16, v38
    v_and_b32 v37, 0xffff0000, v38
    v_lshlrev_b32 v38, 16, v39
    v_and_b32 v39, 0xffff0000, v39
    s_add_u32 m0, s44, 39936
    s_nop 0
    buffer_load_dwordx4 v10, s[12:15], s49 offen offset:1024 sc1 lds
    v_pk_fma_f32 v[36:37], v[36:37], v[60:61], v[62:63]
    v_pk_fma_f32 v[38:39], v[38:39], v[60:61], v[62:63]
    v_lshlrev_b32 v40, 16, v42
    v_and_b32 v41, 0xffff0000, v42
    v_lshlrev_b32 v42, 16, v43
    s_add_u32 m0, s44, 36864
    s_nop 0
    buffer_load_dwordx4 v11, s[12:15], s49 offen offset:0 sc1 lds
    v_and_b32 v43, 0xffff0000, v43
    v_pk_fma_f32 v[40:41], v[40:41], v[64:65], v[66:67]
    v_pk_fma_f32 v[42:43], v[42:43], v[64:65], v[66:67]
    s_add_u32 m0, s44, 44032
    s_nop 0
    buffer_load_dwordx4 v11, s[12:15], s49 offen offset:1024 sc1 lds
    ds_read_b64 v[46:47], v17 offset:12288
    ds_read_b128 v[60:63], v7 offset:1536
    ds_read_b64 v[50:51], v17 offset:14336
    ds_read_b128 v[64:67], v7 offset:1792
    s_add_u32 m0, s44, 106496
    s_mov_b32 s49, 328192
    s_waitcnt vmcnt(14)
    s_barrier
    buffer_load_dwordx4 v10, s[12:15], s49 offen offset:0 sc1 lds
    s_waitcnt lgkmcnt(0)
    v_lshlrev_b32 v44, 16, v46
    v_and_b32 v45, 0xffff0000, v46
    v_lshlrev_b32 v46, 16, v47
    v_and_b32 v47, 0xffff0000, v47
    s_add_u32 m0, s44, 113664
    s_nop 0
    buffer_load_dwordx4 v10, s[12:15], s49 offen offset:1024 sc1 lds
    v_pk_fma_f32 v[44:45], v[44:45], v[60:61], v[62:63]
    v_pk_fma_f32 v[46:47], v[46:47], v[60:61], v[62:63]
    v_lshlrev_b32 v48, 16, v50
    v_and_b32 v49, 0xffff0000, v50
    v_lshlrev_b32 v50, 16, v51
    s_add_u32 m0, s44, 110592
    s_nop 0
    buffer_load_dwordx4 v11, s[12:15], s49 offen offset:0 sc1 lds
    v_and_b32 v51, 0xffff0000, v51
    v_pk_fma_f32 v[48:49], v[48:49], v[64:65], v[66:67]
    v_pk_fma_f32 v[50:51], v[50:51], v[64:65], v[66:67]
    s_add_u32 m0, s44, 117760
    s_nop 0
    buffer_load_dwordx4 v11, s[12:15], s49 offen offset:1024 sc1 lds
    s_add_u32 m0, s44, 122880
    s_mov_b32 s49, 328448
    s_waitcnt vmcnt(8)
    s_barrier
    s_load_dword s32, s[4:5], s84 offset:2048
    s_load_dword s3, s[4:5], s84 offset:2176
    buffer_load_dwordx4 v10, s[12:15], s49 offen offset:0 sc1 lds
    s_add_u32 m0, s44, 130048
    s_nop 0
    buffer_load_dwordx4 v10, s[12:15], s49 offen offset:1024 sc1 lds
    s_add_u32 m0, s44, 126976
    s_nop 0
    buffer_load_dwordx4 v11, s[12:15], s49 offen offset:0 sc1 lds
    s_add_u32 m0, s44, 134144
    s_nop 0
    buffer_load_dwordx4 v11, s[12:15], s49 offen offset:1024 sc1 lds
    s_add_u32 m0, s90, 50176
    s_nop 0
    buffer_load_dwordx4 v122, s[8:11], s88 offen lds
    s_add_u32 m0, s90, 51200
    s_nop 0
    buffer_load_dwordx4 v123, s[8:11], s88 offen lds
    s_add_u32 m0, s90, 52224
    s_nop 0
    buffer_load_dwordx4 v124, s[8:11], s88 offen lds
    s_add_u32 m0, s90, 53248
    s_nop 0
    buffer_load_dwordx4 v125, s[8:11], s88 offen lds
    s_add_u32 m0, s90, 54272
    s_nop 0
    buffer_load_dwordx4 v126, s[8:11], s88 offen lds
    s_add_u32 m0, s90, 55296
    s_nop 0
    buffer_load_dwordx4 v127, s[8:11], s88 offen lds
    s_add_u32 m0, s82, 139264
    s_add_u32 s49, s78, 0
    s_waitcnt vmcnt(14)
    s_barrier
    s_waitcnt lgkmcnt(0)
    s_cmp_eq_u32 s32, s85
    s_cselect_b32 s32, s3, 0
    s_cmp_eq_u32 s32, s85
    s_cbranch_scc1 hok_29
    s_add_u32 s53, s84, 2048
    v_lshlrev_b32 v109, 7, v1
    v_add_u32 v109, s53, v109
    s_mov_b32 s53, 0
    s_add_u32 s54, s52, 16
    s_bfm_b64 exec, 2, 0
poll_30:
    buffer_load_dword v108, v109, s[56:59], 0 offen sc1
    s_waitcnt vmcnt(0)
    v_cmp_eq_u32 vcc, s54, v108
    s_nop 0
    s_cmp_eq_u64 vcc, exec
    s_cbranch_scc1 pok_31
    s_sleep 8
    s_add_u32 s53, s53, 1
    s_cmp_lt_u32 s53, s61
    s_cbranch_scc1 poll_30
    s_mov_b32 s61, 0
pok_31:
    s_mov_b64 exec, -1
hok_29:
    buffer_load_dwordx4 v2, s[16:19], s49 offen offset:0 sc1 lds
    buffer_load_dwordx4 v2, s[16:19], s49 offen offset:1024 sc1 lds
    buffer_load_dwordx4 v2, s[16:19], s49 offen offset:2048 sc1 lds
    buffer_load_dwordx4 v2, s[16:19], s49 offen offset:3072 sc1 lds
    s_add_u32 m0, s82, 16384
    s_add_u32 s49, s78, 4096
    s_waitcnt vmcnt(14)
    s_barrier
    buffer_load_dwordx4 v2, s[16:19], s49 offen offset:0 sc1 lds
    buffer_load_dwordx4 v2, s[16:19], s49 offen offset:1024 sc1 lds
    buffer_load_dwordx4 v2, s[16:19], s49 offen offset:2048 sc1 lds
    buffer_load_dwordx4 v2, s[16:19], s49 offen offset:3072 sc1 lds
    s_add_u32 m0, s82, 32768
    s_add_u32 s49, s78, 16384
    s_waitcnt vmcnt(14)
    s_barrier
    buffer_load_dwordx4 v2, s[16:19], s49 offen offset:0 sc1 lds
    buffer_load_dwordx4 v2, s[16:19], s49 offen offset:1024 sc1 lds
    buffer_load_dwordx4 v2, s[16:19], s49 offen offset:2048 sc1 lds
    buffer_load_dwordx4 v2, s[16:19], s49 offen offset:3072 sc1 lds
    s_setprio 0
    s_waitcnt vmcnt(8)
    s_barrier
    ds_read_b128 v[52:55], v15 offset:32768
    ds_read_b128 v[56:59], v15 offset:36864
    ds_read_b128 v[60:63], v15 offset:40960
    ds_read_b128 v[64:67], v15 offset:45056
    ds_read_b128 v[68:71], v15 offset:33792
    ds_read_b128 v[72:75], v15 offset:37888
    ds_read_b128 v[76:79], v15 offset:41984
    ds_read_b128 v[80:83], v15 offset:46080
    s_waitcnt lgkmcnt(4)
    v_mfma_f32_16x16x32_bf16 v[20:23], v[128:131], v[52:55], v[20:23]
    ds_read_b128 v[84:87], v15 offset:34816
    v_mfma_f32_16x16x32_bf16 v[24:27], v[128:131], v[56:59], v[24:27]
    ds_read_b128 v[88:91], v15 offset:38912
    v_mfma_f32_16x16x32_bf16 v[24:27], v[132:135], v[64:67], v[24:27]
    ds_read_b128 v[92:95], v15 offset:43008
    v_mfma_f32_16x16x32_bf16 v[20:23], v[132:135], v[60:63], v[20:23]
    ds_read_b128 v[96:99], v15 offset:47104
    s_waitcnt lgkmcnt(4)
    v_mfma_f32_16x16x32_bf16 v[20:23], v[136:139], v[68:71], v[20:23]
    ds_read_b128 v[52:55], v15 offset:35840
    v_mfma_f32_16x16x32_bf16 v[24:27], v[136:139], v[72:75], v[24:27]
    ds_read_b128 v[56:59], v15 offset:39936
    v_mfma_f32_16x16x32_bf16 v[24:27], v[140:143], v[80:83], v[24:27]
    ds_read_b128 v[60:63], v15 offset:44032
    v_mfma_f32_16x16x32_bf16 v[20:23], v[140:143], v[76:79], v[20:23]
    ds_read_b128 v[64:67], v15 offset:48128
    s_waitcnt vmcnt(4)
    s_barrier
    s_waitcnt lgkmcnt(4)
    v_mfma_f32_16x16x32_bf16 v[20:23], v[144:147], v[84:87], v[20:23]
    ds_read_b128 v[68:71], v14 offset:16384
    v_mfma_f32_16x16x32_bf16 v[24:27], v[144:147], v[88:91], v[24:27]
    ds_read_b128 v[72:75], v14 offset:20480
    v_mfma_f32_16x16x32_bf16 v[24:27], v[148:151], v[96:99], v[24:27]
    ds_read_b128 v[76:79], v14 offset:24576
    v_mfma_f32_16x16x32_bf16 v[20:23], v[148:151], v[92:95], v[20:23]
    ds_read_b128 v[80:83], v14 offset:28672
    s_waitcnt lgkmcnt(4)
    v_mfma_f32_16x16x32_bf16 v[20:23], v[152:155], v[52:55], v[20:23]
    ds_read_b128 v[84:87], v14 offset:17408
    v_mfma_f32_16x16x32_bf16 v[24:27], v[152:155], v[56:59], v[24:27]
    ds_read_b128 v[88:91], v14 offset:21504
    v_mfma_f32_16x16x32_bf16 v[24:27], v[156:159], v[64:67], v[24:27]
    ds_read_b128 v[92:95], v14 offset:25600
    v_mfma_f32_16x16x32_bf16 v[20:23], v[156:159], v[60:63], v[20:23]
    ds_read_b128 v[96:99], v14 offset:29696
    s_waitcnt lgkmcnt(4)
    v_mfma_f32_16x16x32_bf16 v[20:23], v[160:163], v[68:71], v[20:23]
    ds_read_b128 v[52:55], v14 offset:18432
    v_mfma_f32_16x16x32_bf16 v[24:27], v[160:163], v[72:75], v[24:27]
    ds_read_b128 v[56:59], v14 offset:22528
    v_mfma_f32_16x16x32_bf16 v[24:27], v[164:167], v[80:83], v[24:27]
    ds_read_b128 v[60:63], v14 offset:26624
    v_mfma_f32_16x16x32_bf16 v[20:23], v[164:167], v[76:79], v[20:23]
    ds_read_b128 v[64:67], v14 offset:30720
    s_waitcnt lgkmcnt(4)
    v_mfma_f32_16x16x32_bf16 v[20:23], v[168:171], v[84:87], v[20:23]
    ds_read_b128 v[68:71], v14 offset:19456
    v_mfma_f32_16x16x32_bf16 v[24:27], v[168:171], v[88:91], v[24:27]
    ds_read_b128 v[72:75], v14 offset:23552
    v_mfma_f32_16x16x32_bf16 v[24:27], v[172:175], v[96:99], v[24:27]
    ds_read_b128 v[76:79], v14 offset:27648
    v_mfma_f32_16x16x32_bf16 v[20:23], v[172:175], v[92:95], v[20:23]
    ds_read_b128 v[80:83], v14 offset:31744
    s_waitcnt vmcnt(0)
    s_barrier
    s_waitcnt lgkmcnt(4)
    v_mfma_f32_16x16x32_bf16 v[20:23], v[176:179], v[52:55], v[20:23]
    ds_read_b128 v[84:87], v14 offset:32768
    v_mfma_f32_16x16x32_bf16 v[24:27], v[176:179], v[56:59], v[24:27]
    ds_read_b128 v[88:91], v14 offset:36864
    v_mfma_f32_16x16x32_bf16 v[24:27], v[180:183], v[64:67], v[24:27]
    ds_read_b128 v[92:95], v14 offset:40960
    v_mfma_f32_16x16x32_bf16 v[20:23], v[180:183], v[60:63], v[20:23]
    ds_read_b128 v[96:99], v14 offset:45056
    s_waitcnt lgkmcnt(4)
    v_mfma_f32_16x16x32_bf16 v[20:23], v[184:187], v[68:71], v[20:23]
    ds_read_b128 v[52:55], v14 offset:33792
    v_mfma_f32_16x16x32_bf16 v[24:27], v[184:187], v[72:75], v[24:27]
    ds_read_b128 v[56:59], v14 offset:37888
    v_mfma_f32_16x16x32_bf16 v[24:27], v[188:191], v[80:83], v[24:27]
    ds_read_b128 v[60:63], v14 offset:41984
    v_mfma_f32_16x16x32_bf16 v[20:23], v[188:191], v[76:79], v[20:23]
    ds_read_b128 v[64:67], v14 offset:46080
    s_waitcnt lgkmcnt(4)
    v_mfma_f32_16x16x32_bf16 v[20:23], v[192:195], v[84:87], v[20:23]
    ds_read_b128 v[68:71], v14 offset:34816
    v_mfma_f32_16x16x32_bf16 v[24:27], v[192:195], v[88:91], v[24:27]
    ds_read_b128 v[72:75], v14 offset:38912
    v_mfma_f32_16x16x32_bf16 v[24:27], v[196:199], v[96:99], v[24:27]
    ds_read_b128 v[76:79], v14 offset:43008
    v_mfma_f32_16x16x32_bf16 v[20:23], v[196:199], v[92:95], v[20:23]
    ds_read_b128 v[80:83], v14 offset:47104
    s_waitcnt lgkmcnt(4)
    v_mfma_f32_16x16x32_bf16 v[20:23], v[200:203], v[52:55], v[20:23]
    ds_read_b128 v[84:87], v14 offset:35840
    v_mfma_f32_16x16x32_bf16 v[24:27], v[200:203], v[56:59], v[24:27]
    ds_read_b128 v[88:91], v14 offset:39936
    v_mfma_f32_16x16x32_bf16 v[24:27], v[204:207], v[64:67], v[24:27]
    ds_read_b128 v[92:95], v14 offset:44032
    v_mfma_f32_16x16x32_bf16 v[20:23], v[204:207], v[60:63], v[20:23]
    ds_read_b128 v[96:99], v14 offset:48128
    s_barrier
    s_waitcnt lgkmcnt(4)
    v_mfma_f32_16x16x32_bf16 v[20:23], v[208:211], v[68:71], v[20:23]
    ds_read_b128 v[52:55], v15 offset:0
    v_mfma_f32_16x16x32_bf16 v[24:27], v[208:211], v[72:75], v[24:27]
    ds_read_b128 v[56:59], v15 offset:4096
    v_mfma_f32_16x16x32_bf16 v[24:27], v[212:215], v[80:83], v[24:27]
    ds_read_b128 v[60:63], v15 offset:8192
    v_mfma_f32_16x16x32_bf16 v[20:23], v[212:215], v[76:79], v[20:23]
    ds_read_b128 v[64:67], v15 offset:12288
    s_waitcnt lgkmcnt(4)
    v_mfma_f32_16x16x32_bf16 v[20:23], v[216:219], v[84:87], v[20:23]
    ds_read_b128 v[68:71], v15 offset:1024
    v_mfma_f32_16x16x32_bf16 v[24:27], v[216:219], v[88:91], v[24:27]
    ds_read_b128 v[72:75], v15 offset:5120
    v_mfma_f32_16x16x32_bf16 v[24:27], v[220:223], v[96:99], v[24:27]
    ds_read_b128 v[76:79], v15 offset:9216
    v_mfma_f32_16x16x32_bf16 v[20:23], v[220:223], v[92:95], v[20:23]
    ds_read_b128 v[80:83], v15 offset:13312
    s_waitcnt lgkmcnt(4)
    v_mfma_f32_16x16x32_bf16 v[20:23], v[224:227], v[52:55], v[20:23]
    ds_read_b128 v[84:87], v15 offset:2048
    v_mfma_f32_16x16x32_bf16 v[24:27], v[224:227], v[56:59], v[24:27]
    ds_read_b128 v[88:91], v15 offset:6144
    v_mfma_f32_16x16x32_bf16 v[24:27], v[228:231], v[64:67], v[24:27]
    ds_read_b128 v[92:95], v15 offset:10240
    v_mfma_f32_16x16x32_bf16 v[20:23], v[228:231], v[60:63], v[20:23]
    ds_read_b128 v[96:99], v15 offset:14336
    s_waitcnt lgkmcnt(4)
    v_mfma_f32_16x16x32_bf16 v[20:23], v[232:235], v[68:71], v[20:23]
    ds_read_b128 v[52:55], v15 offset:3072
    v_mfma_f32_16x16x32_bf16 v[24:27], v[232:235], v[72:75], v[24:27]
    ds_read_b128 v[56:59], v15 offset:7168
    v_mfma_f32_16x16x32_bf16 v[24:27], v[236:239], v[80:83], v[24:27]
    ds_read_b128 v[60:63], v15 offset:11264
    v_mfma_f32_16x16x32_bf16 v[20:23], v[236:239], v[76:79], v[20:23]
    ds_read_b128 v[64:67], v15 offset:15360
    s_barrier
    s_waitcnt lgkmcnt(4)
    v_mfma_f32_16x16x32_bf16 v[20:23], v[240:243], v[84:87], v[20:23]
    ds_read_b128 v[68:71], v15 offset:16384
    v_mfma_f32_16x16x32_bf16 v[24:27], v[240:243], v[88:91], v[24:27]
    ds_read_b128 v[72:75], v15 offset:20480
    v_mfma_f32_16x16x32_bf16 v[24:27], v[244:247], v[96:99], v[24:27]
    ds_read_b128 v[76:79], v15 offset:24576
    v_mfma_f32_16x16x32_bf16 v[20:23], v[244:247], v[92:95], v[20:23]
    ds_read_b128 v[80:83], v15 offset:28672
    s_waitcnt lgkmcnt(4)
    v_mfma_f32_16x16x32_bf16 v[20:23], v[248:251], v[52:55], v[20:23]
    ds_read_b128 v[84:87], v15 offset:17408
    v_mfma_f32_16x16x32_bf16 v[24:27], v[248:251], v[56:59], v[24:27]
    ds_read_b128 v[88:91], v15 offset:21504
    v_mfma_f32_16x16x32_bf16 v[24:27], v[252:255], v[64:67], v[24:27]
    ds_read_b128 v[92:95], v15 offset:25600
    v_mfma_f32_16x16x32_bf16 v[20:23], v[252:255], v[60:63], v[20:23]
    ds_read_b128 v[96:99], v15 offset:29696
    s_waitcnt lgkmcnt(4)
    v_mfma_f32_16x16x32_bf16 v[28:31], v[128:131], v[68:71], v[28:31]
    ds_read_b128 v[52:55], v15 offset:18432
    v_mfma_f32_16x16x32_bf16 v[32:35], v[128:131], v[72:75], v[32:35]
    ds_read_b128 v[56:59], v15 offset:22528
    v_mfma_f32_16x16x32_bf16 v[32:35], v[132:135], v[80:83], v[32:35]
    ds_read_b128 v[60:63], v15 offset:26624
    v_mfma_f32_16x16x32_bf16 v[28:31], v[132:135], v[76:79], v[28:31]
    ds_read_b128 v[64:67], v15 offset:30720
    v_add_u32 v20, 0x10000, v20
    v_add_u32 v22, 0x10000, v22
    v_add_u32 v24, 0x10000, v24
    v_add_u32 v26, 0x10000, v26
    v_and_b32 v20, 0xfffe0000, v20
    v_and_b32 v22, 0xfffe0000, v22
    v_and_b32 v24, 0xfffe0000, v24
    v_and_b32 v26, 0xfffe0000, v26
    v_cvt_pk_bf16_f32 v20, v20, v21
    v_cvt_pk_bf16_f32 v21, v22, v23
    v_cvt_pk_bf16_f32 v22, v24, v25
    v_cvt_pk_bf16_f32 v23, v26, v27
    s_add_u32 s36, s39, 0
    v_permlane16_swap_b32 v20, v22
    v_permlane16_swap_b32 v21, v23
    s_waitcnt lgkmcnt(4)
    v_mfma_f32_16x16x32_bf16 v[28:31], v[136:139], v[84:87], v[28:31]
    ds_read_b128 v[68:71], v15 offset:19456
    v_mfma_f32_16x16x32_bf16 v[32:35], v[136:139], v[88:91], v[32:35]
    ds_read_b128 v[72:75], v15 offset:23552
    v_mfma_f32_16x16x32_bf16 v[32:35], v[140:143], v[96:99], v[32:35]
    ds_read_b128 v[76:79], v15 offset:27648
    v_mfma_f32_16x16x32_bf16 v[28:31], v[140:143], v[92:95], v[28:31]
    ds_read_b128 v[80:83], v15 offset:31744
    s_barrier
    s_waitcnt lgkmcnt(4)
    v_mfma_f32_16x16x32_bf16 v[28:31], v[144:147], v[52:55], v[28:31]
    ds_read_b128 v[84:87], v15 offset:32768
    v_mfma_f32_16x16x32_bf16 v[32:35], v[144:147], v[56:59], v[32:35]
    ds_read_b128 v[88:91], v15 offset:36864
    v_mfma_f32_16x16x32_bf16 v[32:35], v[148:151], v[64:67], v[32:35]
    ds_read_b128 v[92:95], v15 offset:40960
    v_mfma_f32_16x16x32_bf16 v[28:31], v[148:151], v[60:63], v[28:31]
    ds_read_b128 v[96:99], v15 offset:45056
    s_waitcnt lgkmcnt(4)
    v_mfma_f32_16x16x32_bf16 v[28:31], v[152:155], v[68:71], v[28:31]
    ds_read_b128 v[52:55], v15 offset:33792
    v_mfma_f32_16x16x32_bf16 v[32:35], v[152:155], v[72:75], v[32:35]
    ds_read_b128 v[56:59], v15 offset:37888
    v_mfma_f32_16x16x32_bf16 v[32:35], v[156:159], v[80:83], v[32:35]
    ds_read_b128 v[60:63], v15 offset:41984
    v_mfma_f32_16x16x32_bf16 v[28:31], v[156:159], v[76:79], v[28:31]
    ds_read_b128 v[64:67], v15 offset:46080
    s_waitcnt lgkmcnt(4)
    v_mfma_f32_16x16x32_bf16 v[28:31], v[160:163], v[84:87], v[28:31]
    ds_read_b128 v[68:71], v15 offset:34816
    v_mfma_f32_16x16x32_bf16 v[32:35], v[160:163], v[88:91], v[32:35]
    ds_read_b128 v[72:75], v15 offset:38912
    v_mfma_f32_16x16x32_bf16 v[32:35], v[164:167], v[96:99], v[32:35]
    ds_read_b128 v[76:79], v15 offset:43008
    v_mfma_f32_16x16x32_bf16 v[28:31], v[164:167], v[92:95], v[28:31]
    ds_read_b128 v[80:83], v15 offset:47104
    s_waitcnt lgkmcnt(4)
    v_mfma_f32_16x16x32_bf16 v[28:31], v[168:171], v[52:55], v[28:31]
    ds_read_b128 v[84:87], v15 offset:35840
    v_mfma_f32_16x16x32_bf16 v[32:35], v[168:171], v[56:59], v[32:35]
    ds_read_b128 v[88:91], v15 offset:39936
    v_mfma_f32_16x16x32_bf16 v[32:35], v[172:175], v[64:67], v[32:35]
    ds_read_b128 v[92:95], v15 offset:44032
    v_mfma_f32_16x16x32_bf16 v[28:31], v[172:175], v[60:63], v[28:31]
    ds_read_b128 v[96:99], v15 offset:48128
    s_barrier
    s_waitcnt lgkmcnt(4)
    v_mfma_f32_16x16x32_bf16 v[28:31], v[176:179], v[68:71], v[28:31]
    ds_read_b128 v[52:55], v14 offset:16384
    v_mfma_f32_16x16x32_bf16 v[32:35], v[176:179], v[72:75], v[32:35]
    ds_read_b128 v[56:59], v14 offset:20480
    v_mfma_f32_16x16x32_bf16 v[32:35], v[180:183], v[80:83], v[32:35]
    ds_read_b128 v[60:63], v14 offset:24576
    v_mfma_f32_16x16x32_bf16 v[28:31], v[180:183], v[76:79], v[28:31]
    ds_read_b128 v[64:67], v14 offset:28672
    s_waitcnt lgkmcnt(4)
    v_mfma_f32_16x16x32_bf16 v[28:31], v[184:187], v[84:87], v[28:31]
    ds_read_b128 v[68:71], v14 offset:17408
    v_mfma_f32_16x16x32_bf16 v[32:35], v[184:187], v[88:91], v[32:35]
    ds_read_b128 v[72:75], v14 offset:21504
    v_mfma_f32_16x16x32_bf16 v[32:35], v[188:191], v[96:99], v[32:35]
    ds_read_b128 v[76:79], v14 offset:25600
    v_mfma_f32_16x16x32_bf16 v[28:31], v[188:191], v[92:95], v[28:31]
    ds_read_b128 v[80:83], v14 offset:29696
    s_waitcnt lgkmcnt(4)
    v_mfma_f32_16x16x32_bf16 v[28:31], v[192:195], v[52:55], v[28:31]
    ds_read_b128 v[84:87], v14 offset:18432
    v_mfma_f32_16x16x32_bf16 v[32:35], v[192:195], v[56:59], v[32:35]
    ds_read_b128 v[88:91], v14 offset:22528
    v_mfma_f32_16x16x32_bf16 v[32:35], v[196:199], v[64:67], v[32:35]
    ds_read_b128 v[92:95], v14 offset:26624
    v_mfma_f32_16x16x32_bf16 v[28:31], v[196:199], v[60:63], v[28:31]
    ds_read_b128 v[96:99], v14 offset:30720
    s_waitcnt lgkmcnt(4)
    v_mfma_f32_16x16x32_bf16 v[28:31], v[200:203], v[68:71], v[28:31]
    ds_read_b128 v[52:55], v14 offset:19456
    v_mfma_f32_16x16x32_bf16 v[32:35], v[200:203], v[72:75], v[32:35]
    ds_read_b128 v[56:59], v14 offset:23552
    v_mfma_f32_16x16x32_bf16 v[32:35], v[204:207], v[80:83], v[32:35]
    ds_read_b128 v[60:63], v14 offset:27648
    v_mfma_f32_16x16x32_bf16 v[28:31], v[204:207], v[76:79], v[28:31]
    ds_read_b128 v[64:67], v14 offset:31744
    s_barrier
    s_waitcnt lgkmcnt(4)
    v_mfma_f32_16x16x32_bf16 v[28:31], v[208:211], v[84:87], v[28:31]
    ds_read_b128 v[68:71], v14 offset:32768
    v_mfma_f32_16x16x32_bf16 v[32:35], v[208:211], v[88:91], v[32:35]
    ds_read_b128 v[72:75], v14 offset:36864
    v_mfma_f32_16x16x32_bf16 v[32:35], v[212:215], v[96:99], v[32:35]
    ds_read_b128 v[76:79], v14 offset:40960
    v_mfma_f32_16x16x32_bf16 v[28:31], v[212:215], v[92:95], v[28:31]
    ds_read_b128 v[80:83], v14 offset:45056
    s_waitcnt lgkmcnt(4)
    v_mfma_f32_16x16x32_bf16 v[28:31], v[216:219], v[52:55], v[28:31]
    ds_read_b128 v[84:87], v14 offset:33792
    v_mfma_f32_16x16x32_bf16 v[32:35], v[216:219], v[56:59], v[32:35]
    ds_read_b128 v[88:91], v14 offset:37888
    v_mfma_f32_16x16x32_bf16 v[32:35], v[220:223], v[64:67], v[32:35]
    ds_read_b128 v[92:95], v14 offset:41984
    v_mfma_f32_16x16x32_bf16 v[28:31], v[220:223], v[60:63], v[28:31]
    ds_read_b128 v[96:99], v14 offset:46080
    s_waitcnt lgkmcnt(4)
    v_mfma_f32_16x16x32_bf16 v[28:31], v[224:227], v[68:71], v[28:31]
    ds_read_b128 v[52:55], v14 offset:34816
    v_mfma_f32_16x16x32_bf16 v[32:35], v[224:227], v[72:75], v[32:35]
    ds_read_b128 v[56:59], v14 offset:38912
    v_mfma_f32_16x16x32_bf16 v[32:35], v[228:231], v[80:83], v[32:35]
    ds_read_b128 v[60:63], v14 offset:43008
    v_mfma_f32_16x16x32_bf16 v[28:31], v[228:231], v[76:79], v[28:31]
    ds_read_b128 v[64:67], v14 offset:47104
    s_waitcnt lgkmcnt(4)
    v_mfma_f32_16x16x32_bf16 v[28:31], v[232:235], v[84:87], v[28:31]
    ds_read_b128 v[68:71], v14 offset:35840
    v_mfma_f32_16x16x32_bf16 v[32:35], v[232:235], v[88:91], v[32:35]
    ds_read_b128 v[72:75], v14 offset:39936
    v_mfma_f32_16x16x32_bf16 v[32:35], v[236:239], v[96:99], v[32:35]
    ds_read_b128 v[76:79], v14 offset:44032
    v_mfma_f32_16x16x32_bf16 v[28:31], v[236:239], v[92:95], v[28:31]
    ds_read_b128 v[80:83], v14 offset:48128
    s_barrier
    s_waitcnt lgkmcnt(4)
    v_mfma_f32_16x16x32_bf16 v[28:31], v[240:243], v[52:55], v[28:31]
    ds_read_b128 v[84:87], v15 offset:0
    v_mfma_f32_16x16x32_bf16 v[32:35], v[240:243], v[56:59], v[32:35]
    ds_read_b128 v[88:91], v15 offset:4096
    v_mfma_f32_16x16x32_bf16 v[32:35], v[244:247], v[64:67], v[32:35]
    ds_read_b128 v[92:95], v15 offset:8192
    v_mfma_f32_16x16x32_bf16 v[28:31], v[244:247], v[60:63], v[28:31]
    ds_read_b128 v[96:99], v15 offset:12288
    s_waitcnt lgkmcnt(4)
    v_mfma_f32_16x16x32_bf16 v[28:31], v[248:251], v[68:71], v[28:31]
    ds_read_b128 v[52:55], v15 offset:1024
    v_mfma_f32_16x16x32_bf16 v[32:35], v[248:251], v[72:75], v[32:35]
    ds_read_b128 v[56:59], v15 offset:5120
    v_mfma_f32_16x16x32_bf16 v[32:35], v[252:255], v[80:83], v[32:35]
    ds_read_b128 v[60:63], v15 offset:9216
    v_mfma_f32_16x16x32_bf16 v[28:31], v[252:255], v[76:79], v[28:31]
    ds_read_b128 v[64:67], v15 offset:13312
    s_waitcnt lgkmcnt(4)
    v_mfma_f32_16x16x32_bf16 v[36:39], v[128:131], v[84:87], v[36:39]
    ds_read_b128 v[68:71], v15 offset:2048
    v_mfma_f32_16x16x32_bf16 v[40:43], v[128:131], v[88:91], v[40:43]
    ds_read_b128 v[72:75], v15 offset:6144
    v_mfma_f32_16x16x32_bf16 v[40:43], v[132:135], v[96:99], v[40:43]
    ds_read_b128 v[76:79], v15 offset:10240
    v_mfma_f32_16x16x32_bf16 v[36:39], v[132:135], v[92:95], v[36:39]
    ds_read_b128 v[80:83], v15 offset:14336
    v_add_u32 v28, 0x10000, v28
    v_add_u32 v30, 0x10000, v30
    v_add_u32 v32, 0x10000, v32
    v_add_u32 v34, 0x10000, v34
    v_and_b32 v28, 0xfffe0000, v28
    v_and_b32 v30, 0xfffe0000, v30
    v_and_b32 v32, 0xfffe0000, v32
    v_and_b32 v34, 0xfffe0000, v34
    v_cvt_pk_bf16_f32 v28, v28, v29
    v_cvt_pk_bf16_f32 v29, v30, v31
    v_cvt_pk_bf16_f32 v30, v32, v33
    v_cvt_pk_bf16_f32 v31, v34, v35
    s_add_u32 s36, s39, 131072
    v_permlane16_swap_b32 v28, v30
    v_permlane16_swap_b32 v29, v31
    s_waitcnt lgkmcnt(4)
    v_mfma_f32_16x16x32_bf16 v[36:39], v[136:139], v[52:55], v[36:39]
    ds_read_b128 v[84:87], v15 offset:3072
    v_mfma_f32_16x16x32_bf16 v[40:43], v[136:139], v[56:59], v[40:43]
    ds_read_b128 v[88:91], v15 offset:7168
    v_mfma_f32_16x16x32_bf16 v[40:43], v[140:143], v[64:67], v[40:43]
    ds_read_b128 v[92:95], v15 offset:11264
    v_mfma_f32_16x16x32_bf16 v[36:39], v[140:143], v[60:63], v[36:39]
    ds_read_b128 v[96:99], v15 offset:15360
    s_barrier
    s_waitcnt lgkmcnt(4)
    v_mfma_f32_16x16x32_bf16 v[36:39], v[144:147], v[68:71], v[36:39]
    ds_read_b128 v[52:55], v15 offset:16384
    v_mfma_f32_16x16x32_bf16 v[40:43], v[144:147], v[72:75], v[40:43]
    ds_read_b128 v[56:59], v15 offset:20480
    v_mfma_f32_16x16x32_bf16 v[40:43], v[148:151], v[80:83], v[40:43]
    ds_read_b128 v[60:63], v15 offset:24576
    v_mfma_f32_16x16x32_bf16 v[36:39], v[148:151], v[76:79], v[36:39]
    ds_read_b128 v[64:67], v15 offset:28672
    s_waitcnt lgkmcnt(4)
    v_mfma_f32_16x16x32_bf16 v[36:39], v[152:155], v[84:87], v[36:39]
    ds_read_b128 v[68:71], v15 offset:17408
    v_mfma_f32_16x16x32_bf16 v[40:43], v[152:155], v[88:91], v[40:43]
    ds_read_b128 v[72:75], v15 offset:21504
    v_mfma_f32_16x16x32_bf16 v[40:43], v[156:159], v[96:99], v[40:43]
    ds_read_b128 v[76:79], v15 offset:25600
    v_mfma_f32_16x16x32_bf16 v[36:39], v[156:159], v[92:95], v[36:39]
    ds_read_b128 v[80:83], v15 offset:29696
    s_waitcnt lgkmcnt(4)
    v_mfma_f32_16x16x32_bf16 v[36:39], v[160:163], v[52:55], v[36:39]
    ds_read_b128 v[84:87], v15 offset:18432
    v_mfma_f32_16x16x32_bf16 v[40:43], v[160:163], v[56:59], v[40:43]
    ds_read_b128 v[88:91], v15 offset:22528
    v_mfma_f32_16x16x32_bf16 v[40:43], v[164:167], v[64:67], v[40:43]
    ds_read_b128 v[92:95], v15 offset:26624
    v_mfma_f32_16x16x32_bf16 v[36:39], v[164:167], v[60:63], v[36:39]
    ds_read_b128 v[96:99], v15 offset:30720
    s_waitcnt lgkmcnt(4)
    v_mfma_f32_16x16x32_bf16 v[36:39], v[168:171], v[68:71], v[36:39]
    ds_read_b128 v[52:55], v15 offset:19456
    v_mfma_f32_16x16x32_bf16 v[40:43], v[168:171], v[72:75], v[40:43]
    ds_read_b128 v[56:59], v15 offset:23552
    v_mfma_f32_16x16x32_bf16 v[40:43], v[172:175], v[80:83], v[40:43]
    ds_read_b128 v[60:63], v15 offset:27648
    v_mfma_f32_16x16x32_bf16 v[36:39], v[172:175], v[76:79], v[36:39]
    ds_read_b128 v[64:67], v15 offset:31744
    s_barrier
    s_waitcnt lgkmcnt(4)
    v_mfma_f32_16x16x32_bf16 v[36:39], v[176:179], v[84:87], v[36:39]
    ds_read_b128 v[68:71], v15 offset:32768
    v_mfma_f32_16x16x32_bf16 v[40:43], v[176:179], v[88:91], v[40:43]
    ds_read_b128 v[72:75], v15 offset:36864
    v_mfma_f32_16x16x32_bf16 v[40:43], v[180:183], v[96:99], v[40:43]
    ds_read_b128 v[76:79], v15 offset:40960
    v_mfma_f32_16x16x32_bf16 v[36:39], v[180:183], v[92:95], v[36:39]
    ds_read_b128 v[80:83], v15 offset:45056
    s_waitcnt lgkmcnt(4)
    v_mfma_f32_16x16x32_bf16 v[36:39], v[184:187], v[52:55], v[36:39]
    ds_read_b128 v[84:87], v15 offset:33792
    v_mfma_f32_16x16x32_bf16 v[40:43], v[184:187], v[56:59], v[40:43]
    ds_read_b128 v[88:91], v15 offset:37888
    v_mfma_f32_16x16x32_bf16 v[40:43], v[188:191], v[64:67], v[40:43]
    ds_read_b128 v[92:95], v15 offset:41984
    v_mfma_f32_16x16x32_bf16 v[36:39], v[188:191], v[60:63], v[36:39]
    ds_read_b128 v[96:99], v15 offset:46080
    s_waitcnt lgkmcnt(4)
    v_mfma_f32_16x16x32_bf16 v[36:39], v[192:195], v[68:71], v[36:39]
    ds_read_b128 v[52:55], v15 offset:34816
    v_mfma_f32_16x16x32_bf16 v[40:43], v[192:195], v[72:75], v[40:43]
    ds_read_b128 v[56:59], v15 offset:38912
    v_mfma_f32_16x16x32_bf16 v[40:43], v[196:199], v[80:83], v[40:43]
    ds_read_b128 v[60:63], v15 offset:43008
    v_mfma_f32_16x16x32_bf16 v[36:39], v[196:199], v[76:79], v[36:39]
    ds_read_b128 v[64:67], v15 offset:47104
    s_waitcnt lgkmcnt(4)
    v_mfma_f32_16x16x32_bf16 v[36:39], v[200:203], v[84:87], v[36:39]
    ds_read_b128 v[68:71], v15 offset:35840
    v_mfma_f32_16x16x32_bf16 v[40:43], v[200:203], v[88:91], v[40:43]
    ds_read_b128 v[72:75], v15 offset:39936
    v_mfma_f32_16x16x32_bf16 v[40:43], v[204:207], v[96:99], v[40:43]
    ds_read_b128 v[76:79], v15 offset:44032
    v_mfma_f32_16x16x32_bf16 v[36:39], v[204:207], v[92:95], v[36:39]
    ds_read_b128 v[80:83], v15 offset:48128
    s_barrier
    s_waitcnt lgkmcnt(4)
    v_mfma_f32_16x16x32_bf16 v[36:39], v[208:211], v[52:55], v[36:39]
    ds_read_b128 v[84:87], v14 offset:16384
    v_mfma_f32_16x16x32_bf16 v[40:43], v[208:211], v[56:59], v[40:43]
    ds_read_b128 v[88:91], v14 offset:20480
    v_mfma_f32_16x16x32_bf16 v[40:43], v[212:215], v[64:67], v[40:43]
    ds_read_b128 v[92:95], v14 offset:24576
    v_mfma_f32_16x16x32_bf16 v[36:39], v[212:215], v[60:63], v[36:39]
    ds_read_b128 v[96:99], v14 offset:28672
    s_waitcnt lgkmcnt(4)
    v_mfma_f32_16x16x32_bf16 v[36:39], v[216:219], v[68:71], v[36:39]
    ds_read_b128 v[52:55], v14 offset:17408
    v_mfma_f32_16x16x32_bf16 v[40:43], v[216:219], v[72:75], v[40:43]
    ds_read_b128 v[56:59], v14 offset:21504
    v_mfma_f32_16x16x32_bf16 v[40:43], v[220:223], v[80:83], v[40:43]
    ds_read_b128 v[60:63], v14 offset:25600
    v_mfma_f32_16x16x32_bf16 v[36:39], v[220:223], v[76:79], v[36:39]
    ds_read_b128 v[64:67], v14 offset:29696
    s_waitcnt lgkmcnt(4)
    v_mfma_f32_16x16x32_bf16 v[36:39], v[224:227], v[84:87], v[36:39]
    ds_read_b128 v[68:71], v14 offset:18432
    v_mfma_f32_16x16x32_bf16 v[40:43], v[224:227], v[88:91], v[40:43]
    ds_read_b128 v[72:75], v14 offset:22528
    v_mfma_f32_16x16x32_bf16 v[40:43], v[228:231], v[96:99], v[40:43]
    ds_read_b128 v[76:79], v14 offset:26624
    v_mfma_f32_16x16x32_bf16 v[36:39], v[228:231], v[92:95], v[36:39]
    ds_read_b128 v[80:83], v14 offset:30720
    s_waitcnt lgkmcnt(4)
    v_mfma_f32_16x16x32_bf16 v[36:39], v[232:235], v[52:55], v[36:39]
    ds_read_b128 v[84:87], v14 offset:19456
    v_mfma_f32_16x16x32_bf16 v[40:43], v[232:235], v[56:59], v[40:43]
    ds_read_b128 v[88:91], v14 offset:23552
    v_mfma_f32_16x16x32_bf16 v[40:43], v[236:239], v[64:67], v[40:43]
    ds_read_b128 v[92:95], v14 offset:27648
    v_mfma_f32_16x16x32_bf16 v[36:39], v[236:239], v[60:63], v[36:39]
    ds_read_b128 v[96:99], v14 offset:31744
    s_barrier
    s_waitcnt lgkmcnt(4)
    v_mfma_f32_16x16x32_bf16 v[36:39], v[240:243], v[68:71], v[36:39]
    ds_read_b128 v[52:55], v14 offset:32768
    v_mfma_f32_16x16x32_bf16 v[40:43], v[240:243], v[72:75], v[40:43]
    ds_read_b128 v[56:59], v14 offset:36864
    v_mfma_f32_16x16x32_bf16 v[40:43], v[244:247], v[80:83], v[40:43]
    ds_read_b128 v[60:63], v14 offset:40960
    v_mfma_f32_16x16x32_bf16 v[36:39], v[244:247], v[76:79], v[36:39]
    ds_read_b128 v[64:67], v14 offset:45056
    s_waitcnt lgkmcnt(4)
    v_mfma_f32_16x16x32_bf16 v[36:39], v[248:251], v[84:87], v[36:39]
    ds_read_b128 v[68:71], v14 offset:33792
    v_mfma_f32_16x16x32_bf16 v[40:43], v[248:251], v[88:91], v[40:43]
    ds_read_b128 v[72:75], v14 offset:37888
    v_mfma_f32_16x16x32_bf16 v[40:43], v[252:255], v[96:99], v[40:43]
    ds_read_b128 v[76:79], v14 offset:41984
    v_mfma_f32_16x16x32_bf16 v[36:39], v[252:255], v[92:95], v[36:39]
    ds_read_b128 v[80:83], v14 offset:46080
    s_waitcnt lgkmcnt(4)
    v_mfma_f32_16x16x32_bf16 v[44:47], v[128:131], v[52:55], v[44:47]
    ds_read_b128 v[84:87], v14 offset:34816
    v_mfma_f32_16x16x32_bf16 v[48:51], v[128:131], v[56:59], v[48:51]
    ds_read_b128 v[88:91], v14 offset:38912
    v_mfma_f32_16x16x32_bf16 v[48:51], v[132:135], v[64:67], v[48:51]
    ds_read_b128 v[92:95], v14 offset:43008
    v_mfma_f32_16x16x32_bf16 v[44:47], v[132:135], v[60:63], v[44:47]
    ds_read_b128 v[96:99], v14 offset:47104
    v_add_u32 v36, 0x10000, v36
    v_add_u32 v38, 0x10000, v38
    v_add_u32 v40, 0x10000, v40
    v_add_u32 v42, 0x10000, v42
    v_and_b32 v36, 0xfffe0000, v36
    v_and_b32 v38, 0xfffe0000, v38
    v_and_b32 v40, 0xfffe0000, v40
    v_and_b32 v42, 0xfffe0000, v42
    v_cvt_pk_bf16_f32 v36, v36, v37
    v_cvt_pk_bf16_f32 v37, v38, v39
    v_cvt_pk_bf16_f32 v38, v40, v41
    v_cvt_pk_bf16_f32 v39, v42, v43
    s_add_u32 s36, s39, 262144
    v_permlane16_swap_b32 v36, v38
    v_permlane16_swap_b32 v37, v39
    s_waitcnt lgkmcnt(4)
    v_mfma_f32_16x16x32_bf16 v[44:47], v[136:139], v[68:71], v[44:47]
    ds_read_b128 v[52:55], v14 offset:35840
    v_mfma_f32_16x16x32_bf16 v[48:51], v[136:139], v[72:75], v[48:51]
    ds_read_b128 v[56:59], v14 offset:39936
    v_mfma_f32_16x16x32_bf16 v[48:51], v[140:143], v[80:83], v[48:51]
    ds_read_b128 v[60:63], v14 offset:44032
    v_mfma_f32_16x16x32_bf16 v[44:47], v[140:143], v[76:79], v[44:47]
    ds_read_b128 v[64:67], v14 offset:48128
    s_barrier
    s_waitcnt lgkmcnt(4)
    v_mfma_f32_16x16x32_bf16 v[44:47], v[144:147], v[84:87], v[44:47]
    ds_read_b128 v[68:71], v15 offset:0
    v_mfma_f32_16x16x32_bf16 v[48:51], v[144:147], v[88:91], v[48:51]
    ds_read_b128 v[72:75], v15 offset:4096
    v_mfma_f32_16x16x32_bf16 v[48:51], v[148:151], v[96:99], v[48:51]
    ds_read_b128 v[76:79], v15 offset:8192
    v_mfma_f32_16x16x32_bf16 v[44:47], v[148:151], v[92:95], v[44:47]
    ds_read_b128 v[80:83], v15 offset:12288
    s_add_u32 s36, s39, 0
    buffer_store_dwordx4 v[20:23], v13, s[24:27], s36 offen sc1
    s_waitcnt lgkmcnt(4)
    v_mfma_f32_16x16x32_bf16 v[44:47], v[152:155], v[52:55], v[44:47]
    ds_read_b128 v[84:87], v15 offset:1024
    v_mfma_f32_16x16x32_bf16 v[48:51], v[152:155], v[56:59], v[48:51]
    ds_read_b128 v[88:91], v15 offset:5120
    v_mfma_f32_16x16x32_bf16 v[48:51], v[156:159], v[64:67], v[48:51]
    ds_read_b128 v[92:95], v15 offset:9216
    v_mfma_f32_16x16x32_bf16 v[44:47], v[156:159], v[60:63], v[44:47]
    ds_read_b128 v[96:99], v15 offset:13312
    s_add_u32 s36, s39, 131072
    buffer_store_dwordx4 v[28:31], v13, s[24:27], s36 offen sc1
    s_waitcnt lgkmcnt(4)
    v_mfma_f32_16x16x32_bf16 v[44:47], v[160:163], v[68:71], v[44:47]
    ds_read_b128 v[52:55], v15 offset:2048
    v_mfma_f32_16x16x32_bf16 v[48:51], v[160:163], v[72:75], v[48:51]
    ds_read_b128 v[56:59], v15 offset:6144
    v_mfma_f32_16x16x32_bf16 v[48:51], v[164:167], v[80:83], v[48:51]
    ds_read_b128 v[60:63], v15 offset:10240
    v_mfma_f32_16x16x32_bf16 v[44:47], v[164:167], v[76:79], v[44:47]
    ds_read_b128 v[64:67], v15 offset:14336
    s_add_u32 s36, s39, 262144
    buffer_store_dwordx4 v[36:39], v13, s[24:27], s36 offen sc1
    s_waitcnt lgkmcnt(4)
    v_mfma_f32_16x16x32_bf16 v[44:47], v[168:171], v[84:87], v[44:47]
    ds_read_b128 v[68:71], v15 offset:3072
    v_mfma_f32_16x16x32_bf16 v[48:51], v[168:171], v[88:91], v[48:51]
    ds_read_b128 v[72:75], v15 offset:7168
    v_mfma_f32_16x16x32_bf16 v[48:51], v[172:175], v[96:99], v[48:51]
    ds_read_b128 v[76:79], v15 offset:11264
    v_mfma_f32_16x16x32_bf16 v[44:47], v[172:175], v[92:95], v[44:47]
    ds_read_b128 v[80:83], v15 offset:15360
    s_barrier
    s_waitcnt lgkmcnt(4)
    v_mfma_f32_16x16x32_bf16 v[44:47], v[176:179], v[52:55], v[44:47]
    ds_read_b128 v[84:87], v15 offset:16384
    v_mfma_f32_16x16x32_bf16 v[48:51], v[176:179], v[56:59], v[48:51]
    ds_read_b128 v[88:91], v15 offset:20480
    v_mfma_f32_16x16x32_bf16 v[48:51], v[180:183], v[64:67], v[48:51]
    ds_read_b128 v[92:95], v15 offset:24576
    v_mfma_f32_16x16x32_bf16 v[44:47], v[180:183], v[60:63], v[44:47]
    ds_read_b128 v[96:99], v15 offset:28672
    s_waitcnt lgkmcnt(4)
    v_mfma_f32_16x16x32_bf16 v[44:47], v[184:187], v[68:71], v[44:47]
    ds_read_b128 v[52:55], v15 offset:17408
    v_mfma_f32_16x16x32_bf16 v[48:51], v[184:187], v[72:75], v[48:51]
    ds_read_b128 v[56:59], v15 offset:21504
    v_mfma_f32_16x16x32_bf16 v[48:51], v[188:191], v[80:83], v[48:51]
    ds_read_b128 v[60:63], v15 offset:25600
    v_mfma_f32_16x16x32_bf16 v[44:47], v[188:191], v[76:79], v[44:47]
    ds_read_b128 v[64:67], v15 offset:29696
    s_waitcnt lgkmcnt(4)
    v_mfma_f32_16x16x32_bf16 v[44:47], v[192:195], v[84:87], v[44:47]
    ds_read_b128 v[68:71], v15 offset:18432
    v_mfma_f32_16x16x32_bf16 v[48:51], v[192:195], v[88:91], v[48:51]
    ds_read_b128 v[72:75], v15 offset:22528
    v_mfma_f32_16x16x32_bf16 v[48:51], v[196:199], v[96:99], v[48:51]
    ds_read_b128 v[76:79], v15 offset:26624
    v_mfma_f32_16x16x32_bf16 v[44:47], v[196:199], v[92:95], v[44:47]
    ds_read_b128 v[80:83], v15 offset:30720
    s_waitcnt lgkmcnt(4)
    v_mfma_f32_16x16x32_bf16 v[44:47], v[200:203], v[52:55], v[44:47]
    ds_read_b128 v[84:87], v15 offset:19456
    v_mfma_f32_16x16x32_bf16 v[48:51], v[200:203], v[56:59], v[48:51]
    ds_read_b128 v[88:91], v15 offset:23552
    v_mfma_f32_16x16x32_bf16 v[48:51], v[204:207], v[64:67], v[48:51]
    ds_read_b128 v[92:95], v15 offset:27648
    v_mfma_f32_16x16x32_bf16 v[44:47], v[204:207], v[60:63], v[44:47]
    ds_read_b128 v[96:99], v15 offset:31744
    s_barrier
    s_waitcnt lgkmcnt(4)
    v_mfma_f32_16x16x32_bf16 v[44:47], v[208:211], v[68:71], v[44:47]
    ds_read_b128 v[52:55], v15 offset:32768
    v_mfma_f32_16x16x32_bf16 v[48:51], v[208:211], v[72:75], v[48:51]
    ds_read_b128 v[56:59], v15 offset:36864
    v_mfma_f32_16x16x32_bf16 v[48:51], v[212:215], v[80:83], v[48:51]
    ds_read_b128 v[60:63], v15 offset:40960
    v_mfma_f32_16x16x32_bf16 v[44:47], v[212:215], v[76:79], v[44:47]
    ds_read_b128 v[64:67], v15 offset:45056
    s_waitcnt lgkmcnt(4)
    v_mfma_f32_16x16x32_bf16 v[44:47], v[216:219], v[84:87], v[44:47]
    ds_read_b128 v[68:71], v15 offset:33792
    v_mfma_f32_16x16x32_bf16 v[48:51], v[216:219], v[88:91], v[48:51]
    ds_read_b128 v[72:75], v15 offset:37888
    v_mfma_f32_16x16x32_bf16 v[48:51], v[220:223], v[96:99], v[48:51]
    ds_read_b128 v[76:79], v15 offset:41984
    v_mfma_f32_16x16x32_bf16 v[44:47], v[220:223], v[92:95], v[44:47]
    ds_read_b128 v[80:83], v15 offset:46080
    s_waitcnt lgkmcnt(4)
    v_mfma_f32_16x16x32_bf16 v[44:47], v[224:227], v[52:55], v[44:47]
    ds_read_b128 v[84:87], v15 offset:34816
    v_mfma_f32_16x16x32_bf16 v[48:51], v[224:227], v[56:59], v[48:51]
    ds_read_b128 v[88:91], v15 offset:38912
    v_mfma_f32_16x16x32_bf16 v[48:51], v[228:231], v[64:67], v[48:51]
    ds_read_b128 v[92:95], v15 offset:43008
    v_mfma_f32_16x16x32_bf16 v[44:47], v[228:231], v[60:63], v[44:47]
    ds_read_b128 v[96:99], v15 offset:47104
    s_waitcnt lgkmcnt(4)
    v_mfma_f32_16x16x32_bf16 v[44:47], v[232:235], v[68:71], v[44:47]
    ds_read_b128 v[52:55], v15 offset:35840
    v_mfma_f32_16x16x32_bf16 v[48:51], v[232:235], v[72:75], v[48:51]
    ds_read_b128 v[56:59], v15 offset:39936
    v_mfma_f32_16x16x32_bf16 v[48:51], v[236:239], v[80:83], v[48:51]
    ds_read_b128 v[60:63], v15 offset:44032
    v_mfma_f32_16x16x32_bf16 v[44:47], v[236:239], v[76:79], v[44:47]
    ds_read_b128 v[64:67], v15 offset:48128
    ds_write_b128 v16, v[20:23] offset:0
    ds_write_b128 v16, v[28:31] offset:4096
    ds_write_b128 v16, v[36:39] offset:8192
    s_waitcnt lgkmcnt(7)
    v_mfma_f32_16x16x32_bf16 v[44:47], v[240:243], v[84:87], v[44:47]
    v_mfma_f32_16x16x32_bf16 v[48:51], v[240:243], v[88:91], v[48:51]
    v_mfma_f32_16x16x32_bf16 v[48:51], v[244:247], v[96:99], v[48:51]
    v_mfma_f32_16x16x32_bf16 v[44:47], v[244:247], v[92:95], v[44:47]
    s_waitcnt lgkmcnt(3)
    v_mfma_f32_16x16x32_bf16 v[44:47], v[248:251], v[52:55], v[44:47]
    v_mfma_f32_16x16x32_bf16 v[48:51], v[248:251], v[56:59], v[48:51]
    v_mfma_f32_16x16x32_bf16 v[48:51], v[252:255], v[64:67], v[48:51]
    v_mfma_f32_16x16x32_bf16 v[44:47], v[252:255], v[60:63], v[44:47]
    s_setprio 0
    s_nop 6
    v_add_u32 v44, 0x10000, v44
    v_add_u32 v46, 0x10000, v46
    v_add_u32 v48, 0x10000, v48
    v_add_u32 v50, 0x10000, v50
    v_and_b32 v44, 0xfffe0000, v44
    v_and_b32 v46, 0xfffe0000, v46
    v_and_b32 v48, 0xfffe0000, v48
    v_and_b32 v50, 0xfffe0000, v50
    v_cvt_pk_bf16_f32 v44, v44, v45
    v_cvt_pk_bf16_f32 v45, v46, v47
    v_cvt_pk_bf16_f32 v46, v48, v49
    v_cvt_pk_bf16_f32 v47, v50, v51
    s_add_u32 s36, s39, 393216
    v_permlane16_swap_b32 v44, v46
    v_permlane16_swap_b32 v45, v47
    s_add_u32 s36, s39, 393216
    buffer_store_dwordx4 v[44:47], v13, s[24:27], s36 offen sc1
    ds_write_b128 v16, v[44:47] offset:12288
    s_waitcnt lgkmcnt(0)
    s_barrier
    s_cmp_ge_u32 s30, 6
    s_cbranch_scc1 WLOAD
    s_and_b32 s35, s30, 1
    s_add_u32 s12, s62, 0x480000
    s_addc_u32 s13, s63, 0
    s_mov_b32 s14, 0x7e000
    s_mov_b32 s15, 0x20000
    s_mul_i32 s38, s35, 262144
    s_lshl_b32 s41, s35, 13
    s_mov_b32 s42, 0
    s_mov_b32 s44, s29
    s_add_u32 s54, s55, 1024
    v_mov_b32 v9, s54
    v_lshl_add_u32 v9, v1, 7, v9
    s_add_u32 s44, s44, 1
    s_and_b32 s44, s44, 15
    s_add_u32 s46, s29, 1
    s_and_b32 s46, s46, 15
    s_cmp_eq_u32 s28, s29
    s_cselect_b32 s47, s46, s28
    s_mov_b32 s42, 16384
    s_and_b32 s35, s30, 1
    s_lshl_b32 s35, s35, 7
    s_add_u32 s35, s35, s55
    s_add_u32 s35, s35, 0x1600
    s_and_b32 s40, s30, 1
    s_lshl_b32 s40, s40, 13
    s_lshl_b32 s53, s29, 7
    s_add_u32 s40, s40, s53
    s_add_u32 s40, s40, 23068672
    v_lshlrev_b32 v10, 3, v1
    s_add_u32 s20, s62, 0x1c8000
    s_addc_u32 s21, s63, 0
    s_mov_b32 s22, 0x6000
    s_mov_b32 s23, 0x20000
    s_and_b32 s34, s30, 1
    s_lshl_b32 s34, s34, 9
    s_call_b64 s[76:77], PREP_a_issue_3
    s_mov_b32 m0, s19
    s_mov_b32 s39, s16
    s_and_b32 s53, s30, 3
    s_lshl_b32 s53, s53, 7
    s_add_u32 s53, s53, s55
    s_add_u32 s53, s53, 0x400
    v_mov_b32 v14, 1
    v_mov_b32 v15, 0
    s_mov_b64 exec, 1
    s_waitcnt vmcnt(0)
    buffer_atomic_add v14, v15, s[56:59], s53 offen sc1
    s_mov_b64 exec, -1
    s_call_b64 s[76:77], SUB_rest_2
    s_waitcnt lgkmcnt(0)
    s_mov_b32 s53, 0
    s_add_u32 s54, s52, 16
    s_bfm_b64 exec, 4, 0
poll_32:
    buffer_load_dword v8, v9, s[56:59], 0 offen sc1
    s_waitcnt vmcnt(0)
    v_cmp_eq_u32 vcc, s54, v8
    s_nop 0
    s_cmp_eq_u64 vcc, exec
    s_cbranch_scc1 pok_33
    s_sleep 5
    s_add_u32 s53, s53, 1
    s_cmp_lt_u32 s53, s61
    s_cbranch_scc1 poll_32
    s_mov_b32 s61, 0
pok_33:
    s_mov_b64 exec, -1
    buffer_load_dwordx4 v2, s[12:15], s39 offen sc1 lds
    buffer_load_dwordx4 v2, s[12:15], s39 offen offset:1024 sc1 lds
    s_call_b64 s[76:77], PREP_a_issue_3
    s_add_u32 m0, m0, 2048
    s_add_u32 s39, s39, 65536
    buffer_load_dwordx4 v2, s[12:15], s39 offen sc1 lds
    buffer_load_dwordx4 v2, s[12:15], s39 offen offset:1024 sc1 lds
    s_add_u32 m0, m0, 2048
    s_add_u32 s39, s39, 65536
    buffer_load_dwordx4 v2, s[12:15], s39 offen sc1 lds
    buffer_load_dwordx4 v2, s[12:15], s39 offen offset:1024 sc1 lds
    s_add_u32 m0, m0, 2048
    s_add_u32 s39, s39, 65536
    buffer_load_dwordx4 v2, s[12:15], s39 offen sc1 lds
    buffer_load_dwordx4 v2, s[12:15], s39 offen offset:1024 sc1 lds
    s_mov_b32 m0, s19
    s_mov_b32 s39, s16
    buffer_load_dwordx4 v2, s[12:15], s39 offen sc1 lds
    buffer_load_dwordx4 v2, s[12:15], s39 offen offset:1024 sc1 lds
    s_call_b64 s[76:77], PREP_a_issue_3
    s_add_u32 m0, m0, 2048
    s_add_u32 s39, s39, 65536
    buffer_load_dwordx4 v2, s[12:15], s39 offen sc1 lds
    buffer_load_dwordx4 v2, s[12:15], s39 offen offset:1024 sc1 lds
    s_add_u32 m0, m0, 2048
    s_add_u32 s39, s39, 65536
    buffer_load_dwordx4 v2, s[12:15], s39 offen sc1 lds
    buffer_load_dwordx4 v2, s[12:15], s39 offen offset:1024 sc1 lds
    s_add_u32 m0, m0, 2048
    s_add_u32 s39, s39, 65536
    buffer_load_dwordx4 v2, s[12:15], s39 offen sc1 lds
    buffer_load_dwordx4 v2, s[12:15], s39 offen offset:1024 sc1 lds
    s_mov_b32 m0, s19
    s_mov_b32 s39, s16
    s_waitcnt vmcnt(8)
    s_barrier
    buffer_load_dwordx4 v2, s[12:15], s39 offen sc1 lds
    buffer_load_dwordx4 v2, s[12:15], s39 offen offset:1024 sc1 lds
    s_call_b64 s[76:77], PREP_a_issue_3
    s_add_u32 m0, m0, 2048
    s_add_u32 s39, s39, 65536
    buffer_load_dwordx4 v2, s[12:15], s39 offen sc1 lds
    buffer_load_dwordx4 v2, s[12:15], s39 offen offset:1024 sc1 lds
    s_add_u32 m0, m0, 2048
    s_add_u32 s39, s39, 65536
    buffer_load_dwordx4 v2, s[12:15], s39 offen sc1 lds
    buffer_load_dwordx4 v2, s[12:15], s39 offen offset:1024 sc1 lds
    s_add_u32 m0, m0, 2048
    s_add_u32 s39, s39, 65536
    buffer_load_dwordx4 v2, s[12:15], s39 offen sc1 lds
    buffer_load_dwordx4 v2, s[12:15], s39 offen offset:1024 sc1 lds
    s_mov_b32 m0, s19
    s_mov_b32 s39, s16
    s_add_u32 s36, s34, 155648
    v_add_u32 v51, s36, v10
    ds_read_b64 v[18:19], v51 offset:0
    ds_read_b64 v[20:21], v51 offset:1024
    ds_read_b64 v[22:23], v51 offset:2048
    ds_read_b64 v[24:25], v51 offset:3072
    s_lshr_b32 s53, s29, 3
    s_lshl_b32 s53, s53, 14
    s_and_b32 s36, s29, 7
    s_lshl_b32 s36, s36, 10
    s_add_u32 s36, s36, s53
    s_add_u32 s36, s36, s34
    s_waitcnt lgkmcnt(0)
    v_pk_add_f32 v[18:19], v[18:19], v[20:21]
    v_pk_add_f32 v[18:19], v[18:19], v[22:23]
    v_pk_add_f32 v[18:19], v[18:19], v[24:25]
    buffer_store_dwordx2 v[18:19], v10, s[20:23], s36 offen sc1
    s_waitcnt vmcnt(9)
    s_barrier
    buffer_load_dwordx4 v2, s[12:15], s39 offen sc1 lds
    buffer_load_dwordx4 v2, s[12:15], s39 offen offset:1024 sc1 lds
    s_call_b64 s[76:77], PREP_a_issue_3
    s_add_u32 m0, m0, 2048
    s_add_u32 s39, s39, 65536
    buffer_load_dwordx4 v2, s[12:15], s39 offen sc1 lds
    buffer_load_dwordx4 v2, s[12:15], s39 offen offset:1024 sc1 lds
    s_add_u32 m0, m0, 2048
    s_add_u32 s39, s39, 65536
    buffer_load_dwordx4 v2, s[12:15], s39 offen sc1 lds
    buffer_load_dwordx4 v2, s[12:15], s39 offen offset:1024 sc1 lds
    s_add_u32 m0, m0, 2048
    s_add_u32 s39, s39, 65536
    buffer_load_dwordx4 v2, s[12:15], s39 offen sc1 lds
    buffer_load_dwordx4 v2, s[12:15], s39 offen offset:1024 sc1 lds
    s_mov_b32 m0, s19
    s_mov_b32 s39, s16
    s_waitcnt vmcnt(9)
    s_barrier
    buffer_load_dwordx4 v2, s[12:15], s39 offen sc1 lds
    buffer_load_dwordx4 v2, s[12:15], s39 offen offset:1024 sc1 lds
    s_call_b64 s[76:77], PREP_a_issue_3
    s_add_u32 m0, m0, 2048
    s_add_u32 s39, s39, 65536
    buffer_load_dwordx4 v2, s[12:15], s39 offen sc1 lds
    buffer_load_dwordx4 v2, s[12:15], s39 offen offset:1024 sc1 lds
    s_add_u32 m0, m0, 2048
    s_add_u32 s39, s39, 65536
    buffer_load_dwordx4 v2, s[12:15], s39 offen sc1 lds
    buffer_load_dwordx4 v2, s[12:15], s39 offen offset:1024 sc1 lds
    s_add_u32 m0, m0, 2048
    s_add_u32 s39, s39, 65536
    buffer_load_dwordx4 v2, s[12:15], s39 offen sc1 lds
    buffer_load_dwordx4 v2, s[12:15], s39 offen offset:1024 sc1 lds
    s_mov_b32 m0, s19
    s_mov_b32 s39, s16
    s_waitcnt vmcnt(16)
    s_and_b32 s53, s30, 1
    s_lshl_b32 s53, s53, 7
    s_add_u32 s53, s53, s55
    s_add_u32 s53, s53, 0x1600
    v_mov_b32 v14, 1
    v_mov_b32 v15, 0
    s_mov_b64 exec, 1
    buffer_atomic_add v14, v15, s[56:59], s53 offen sc1
    s_mov_b64 exec, -1
    s_waitcnt vmcnt(9)
    s_barrier
    buffer_load_dwordx4 v2, s[12:15], s39 offen sc1 lds
    buffer_load_dwordx4 v2, s[12:15], s39 offen offset:1024 sc1 lds
    s_call_b64 s[76:77], PREP_a_issue_3
    s_add_u32 m0, m0, 2048
    s_add_u32 s39, s39, 65536
    buffer_load_dwordx4 v2, s[12:15], s39 offen sc1 lds
    buffer_load_dwordx4 v2, s[12:15], s39 offen offset:1024 sc1 lds
    s_add_u32 m0, m0, 2048
    s_add_u32 s39, s39, 65536
    buffer_load_dwordx4 v2, s[12:15], s39 offen sc1 lds
    buffer_load_dwordx4 v2, s[12:15], s39 offen offset:1024 sc1 lds
    s_add_u32 m0, m0, 2048
    s_add_u32 s39, s39, 65536
    buffer_load_dwordx4 v2, s[12:15], s39 offen sc1 lds
    buffer_load_dwordx4 v2, s[12:15], s39 offen offset:1024 sc1 lds
    s_mov_b32 m0, s19
    s_mov_b32 s39, s16
    s_waitcnt vmcnt(9)
    s_barrier
    buffer_load_dwordx4 v2, s[12:15], s39 offen sc1 lds
    buffer_load_dwordx4 v2, s[12:15], s39 offen offset:1024 sc1 lds
    s_call_b64 s[76:77], PREP_a_issue_3
    s_add_u32 m0, m0, 2048
    s_add_u32 s39, s39, 65536
    buffer_load_dwordx4 v2, s[12:15], s39 offen sc1 lds
    buffer_load_dwordx4 v2, s[12:15], s39 offen offset:1024 sc1 lds
    s_add_u32 m0, m0, 2048
    s_add_u32 s39, s39, 65536
    buffer_load_dwordx4 v2, s[12:15], s39 offen sc1 lds
    buffer_load_dwordx4 v2, s[12:15], s39 offen offset:1024 sc1 lds
    s_add_u32 m0, m0, 2048
    s_add_u32 s39, s39, 65536
    buffer_load_dwordx4 v2, s[12:15], s39 offen sc1 lds
    buffer_load_dwordx4 v2, s[12:15], s39 offen offset:1024 sc1 lds
    s_mov_b32 m0, s19
    s_mov_b32 s39, s16
    s_waitcnt vmcnt(8)
    s_barrier
    buffer_load_dwordx4 v2, s[12:15], s39 offen sc1 lds
    buffer_load_dwordx4 v2, s[12:15], s39 offen offset:1024 sc1 lds
    s_call_b64 s[76:77], PREP_a_issue_3
    s_add_u32 m0, m0, 2048
    s_add_u32 s39, s39, 65536
    buffer_load_dwordx4 v2, s[12:15], s39 offen sc1 lds
    buffer_load_dwordx4 v2, s[12:15], s39 offen offset:1024 sc1 lds
    s_add_u32 m0, m0, 2048
    s_add_u32 s39, s39, 65536
    buffer_load_dwordx4 v2, s[12:15], s39 offen sc1 lds
    buffer_load_dwordx4 v2, s[12:15], s39 offen offset:1024 sc1 lds
    s_add_u32 m0, m0, 2048
    s_add_u32 s39, s39, 65536
    buffer_load_dwordx4 v2, s[12:15], s39 offen sc1 lds
    buffer_load_dwordx4 v2, s[12:15], s39 offen offset:1024 sc1 lds
    s_mov_b32 m0, s19
    s_mov_b32 s39, s16
    s_waitcnt vmcnt(8)
    s_barrier
    buffer_load_dwordx4 v2, s[12:15], s39 offen sc1 lds
    buffer_load_dwordx4 v2, s[12:15], s39 offen offset:1024 sc1 lds
    s_call_b64 s[76:77], PREP_a_issue_3
    s_add_u32 m0, m0, 2048
    s_add_u32 s39, s39, 65536
    buffer_load_dwordx4 v2, s[12:15], s39 offen sc1 lds
    buffer_load_dwordx4 v2, s[12:15], s39 offen offset:1024 sc1 lds
    s_add_u32 m0, m0, 2048
    s_add_u32 s39, s39, 65536
    buffer_load_dwordx4 v2, s[12:15], s39 offen sc1 lds
    buffer_load_dwordx4 v2, s[12:15], s39 offen offset:1024 sc1 lds
    s_add_u32 m0, m0, 2048
    s_add_u32 s39, s39, 65536
    buffer_load_dwordx4 v2, s[12:15], s39 offen sc1 lds
    buffer_load_dwordx4 v2, s[12:15], s39 offen offset:1024 sc1 lds
    s_mov_b32 m0, s19
    s_mov_b32 s39, s16
    s_load_dword s32, s[4:5], s35
    s_load_dword s3, s[4:5], s40
    s_waitcnt vmcnt(8)
    s_barrier
    buffer_load_dwordx4 v2, s[12:15], s39 offen sc1 lds
    buffer_load_dwordx4 v2, s[12:15], s39 offen offset:1024 sc1 lds
    s_call_b64 s[76:77], PREP_a_issue_3
    s_add_u32 m0, m0, 2048
    s_add_u32 s39, s39, 65536
    buffer_load_dwordx4 v2, s[12:15], s39 offen sc1 lds
    buffer_load_dwordx4 v2, s[12:15], s39 offen offset:1024 sc1 lds
    s_add_u32 m0, m0, 2048
    s_add_u32 s39, s39, 65536
    buffer_load_dwordx4 v2, s[12:15], s39 offen sc1 lds
    buffer_load_dwordx4 v2, s[12:15], s39 offen offset:1024 sc1 lds
    s_add_u32 m0, m0, 2048
    s_add_u32 s39, s39, 65536
    buffer_load_dwordx4 v2, s[12:15], s39 offen sc1 lds
    buffer_load_dwordx4 v2, s[12:15], s39 offen offset:1024 sc1 lds
    s_mov_b32 m0, s19
    s_mov_b32 s39, s16
    s_add_u32 s54, s52, 16
    s_waitcnt lgkmcnt(0)
    s_cmp_eq_u32 s32, s54
    s_cbranch_scc1 fok_34
    v_mov_b32 v15, s35
    s_mov_b32 s53, 0
    s_add_u32 s54, s52, 16
    s_bfm_b64 exec, 1, 0
poll_35:
    buffer_load_dword v14, v15, s[56:59], 0 offen sc1
    s_waitcnt vmcnt(0)
    v_cmp_eq_u32 vcc, s54, v14
    s_nop 0
    s_cmp_eq_u64 vcc, exec
    s_cbranch_scc1 pok_36
    s_sleep 5
    s_add_u32 s53, s53, 1
    s_cmp_lt_u32 s53, s61
    s_cbranch_scc1 poll_35
    s_mov_b32 s61, 0
pok_36:
    s_mov_b64 exec, -1
fok_34:
    s_add_u32 s36, s34, 0
    buffer_load_dwordx2 v[18:19], v10, s[20:23], s36 offen offset:0 sc1
    buffer_load_dwordx2 v[20:21], v10, s[20:23], s36 offen offset:1024 sc1
    buffer_load_dwordx2 v[22:23], v10, s[20:23], s36 offen offset:2048 sc1
    buffer_load_dwordx2 v[24:25], v10, s[20:23], s36 offen offset:3072 sc1
    s_add_u32 s36, s36, 4096
    buffer_load_dwordx2 v[26:27], v10, s[20:23], s36 offen offset:0 sc1
    buffer_load_dwordx2 v[28:29], v10, s[20:23], s36 offen offset:1024 sc1
    buffer_load_dwordx2 v[30:31], v10, s[20:23], s36 offen offset:2048 sc1
    buffer_load_dwordx2 v[32:33], v10, s[20:23], s36 offen offset:3072 sc1
    s_waitcnt vmcnt(16)
    s_barrier
    buffer_load_dwordx4 v2, s[12:15], s39 offen sc1 lds
    buffer_load_dwordx4 v2, s[12:15], s39 offen offset:1024 sc1 lds
    s_call_b64 s[76:77], PREP_a_issue_3
    s_add_u32 m0, m0, 2048
    s_add_u32 s39, s39, 65536
    buffer_load_dwordx4 v2, s[12:15], s39 offen sc1 lds
    buffer_load_dwordx4 v2, s[12:15], s39 offen offset:1024 sc1 lds
    s_add_u32 m0, m0, 2048
    s_add_u32 s39, s39, 65536
    buffer_load_dwordx4 v2, s[12:15], s39 offen sc1 lds
    buffer_load_dwordx4 v2, s[12:15], s39 offen offset:1024 sc1 lds
    s_add_u32 m0, m0, 2048
    s_add_u32 s39, s39, 65536
    buffer_load_dwordx4 v2, s[12:15], s39 offen sc1 lds
    buffer_load_dwordx4 v2, s[12:15], s39 offen offset:1024 sc1 lds
    s_mov_b32 m0, s19
    s_mov_b32 s39, s16
    s_add_u32 s36, s34, 16384
    buffer_load_dwordx2 v[34:35], v10, s[20:23], s36 offen offset:0 sc1
    buffer_load_dwordx2 v[36:37], v10, s[20:23], s36 offen offset:1024 sc1
    buffer_load_dwordx2 v[38:39], v10, s[20:23], s36 offen offset:2048 sc1
    buffer_load_dwordx2 v[40:41], v10, s[20:23], s36 offen offset:3072 sc1
    s_add_u32 s36, s36, 4096
    buffer_load_dwordx2 v[42:43], v10, s[20:23], s36 offen offset:0 sc1
    buffer_load_dwordx2 v[44:45], v10, s[20:23], s36 offen offset:1024 sc1
    buffer_load_dwordx2 v[46:47], v10, s[20:23], s36 offen offset:2048 sc1
    buffer_load_dwordx2 v[48:49], v10, s[20:23], s36 offen offset:3072 sc1
    s_waitcnt vmcnt(24)
    s_barrier
    buffer_load_dwordx4 v2, s[12:15], s39 offen sc1 lds
    buffer_load_dwordx4 v2, s[12:15], s39 offen offset:1024 sc1 lds
    s_call_b64 s[76:77], PREP_a_issue_3
    s_add_u32 m0, m0, 2048
    s_add_u32 s39, s39, 65536
    buffer_load_dwordx4 v2, s[12:15], s39 offen sc1 lds
    buffer_load_dwordx4 v2, s[12:15], s39 offen offset:1024 sc1 lds
    s_add_u32 m0, m0, 2048
    s_add_u32 s39, s39, 65536
    buffer_load_dwordx4 v2, s[12:15], s39 offen sc1 lds
    buffer_load_dwordx4 v2, s[12:15], s39 offen offset:1024 sc1 lds
    s_add_u32 m0, m0, 2048
    s_add_u32 s39, s39, 65536
    buffer_load_dwordx4 v2, s[12:15], s39 offen sc1 lds
    buffer_load_dwordx4 v2, s[12:15], s39 offen offset:1024 sc1 lds
    s_mov_b32 m0, s19
    s_mov_b32 s39, s16
    s_add_u32 s54, s52, 16
    s_waitcnt lgkmcnt(0)
    s_cmp_eq_u32 s3, s54
    s_cbranch_scc1 fok_37
    v_mov_b32 v15, s40
    s_mov_b32 s53, 0
    s_add_u32 s54, s52, 16
    s_bfm_b64 exec, 1, 0
poll_38:
    buffer_load_dword v14, v15, s[56:59], 0 offen sc1
    s_waitcnt vmcnt(0)
    v_cmp_eq_u32 vcc, s54, v14
    s_nop 0
    s_cmp_eq_u64 vcc, exec
    s_cbranch_scc1 pok_39
    s_sleep 5
    s_add_u32 s53, s53, 1
    s_cmp_lt_u32 s53, s61
    s_cbranch_scc1 poll_38
    s_mov_b32 s61, 0
pok_39:
    s_mov_b64 exec, -1
fok_37:
    s_add_u32 s24, s4, 0x1420000
    s_addc_u32 s25, s5, 0
    s_mov_b32 s26, 0x38000
    s_mov_b32 s27, 0x20000
    s_cmp_eq_u32 s60, 0
    s_cselect_b32 s26, s26, 0
    s_and_b32 s36, s30, 1
    s_mul_i32 s36, s36, 448
    s_mul_i32 s37, s29, 896
    s_add_u32 s37, s36, s37
    v_lshrrev_b32 v13, 5, v1
    v_mul_u32_u24 v13, 14336, v13
    v_and_b32 v6, 496, v2
    v_add_u32 v13, v13, v6
    buffer_load_dwordx4 v[54:57], v13, s[24:27], s37 offen sc1
    s_add_u32 s37, s37, 28672
    buffer_load_dwordx4 v[58:61], v13, s[24:27], s37 offen sc1
    s_add_u32 s37, s37, 28672
    buffer_load_dwordx4 v[62:65], v13, s[24:27], s37 offen sc1
    s_add_u32 s37, s37, 28672
    buffer_load_dwordx4 v[66:69], v13, s[24:27], s37 offen sc1
    s_add_u32 s37, s37, 28672
    buffer_load_dwordx4 v[70:73], v13, s[24:27], s37 offen sc1
    s_add_u32 s37, s37, 28672
    buffer_load_dwordx4 v[74:77], v13, s[24:27], s37 offen sc1
    s_add_u32 s37, s37, 28672
    buffer_load_dwordx4 v[78:81], v13, s[24:27], s37 offen sc1
    s_add_u32 s37, s37, 28672
    buffer_load_dwordx4 v[82:85], v13, s[24:27], s37 offen sc1
    s_add_u32 s37, s37, 28672
    s_waitcnt vmcnt(24)
    s_barrier
    buffer_load_dwordx4 v2, s[12:15], s39 offen sc1 lds
    buffer_load_dwordx4 v2, s[12:15], s39 offen offset:1024 sc1 lds
    s_call_b64 s[76:77], PREP_a_issue_3
    s_add_u32 m0, m0, 2048
    s_add_u32 s39, s39, 65536
    buffer_load_dwordx4 v2, s[12:15], s39 offen sc1 lds
    buffer_load_dwordx4 v2, s[12:15], s39 offen offset:1024 sc1 lds
    s_add_u32 m0, m0, 2048
    s_add_u32 s39, s39, 65536
    buffer_load_dwordx4 v2, s[12:15], s39 offen sc1 lds
    buffer_load_dwordx4 v2, s[12:15], s39 offen offset:1024 sc1 lds
    s_add_u32 m0, m0, 2048
    s_add_u32 s39, s39, 65536
    buffer_load_dwordx4 v2, s[12:15], s39 offen sc1 lds
    buffer_load_dwordx4 v2, s[12:15], s39 offen offset:1024 sc1 lds
    s_mov_b32 m0, s19
    s_mov_b32 s39, s16
    s_waitcnt vmcnt(24)
    v_pk_add_f32 v[18:19], v[18:19], v[34:35]
    v_pk_add_f32 v[20:21], v[20:21], v[36:37]
    v_pk_add_f32 v[22:23], v[22:23], v[38:39]
    v_pk_add_f32 v[24:25], v[24:25], v[40:41]
    v_pk_add_f32 v[26:27], v[26:27], v[42:43]
    v_pk_add_f32 v[28:29], v[28:29], v[44:45]
    v_pk_add_f32 v[30:31], v[30:31], v[46:47]
    v_pk_add_f32 v[32:33], v[32:33], v[48:49]
    v_pk_add_f32 v[18:19], v[18:19], v[26:27]
    v_pk_add_f32 v[20:21], v[20:21], v[28:29]
    v_pk_add_f32 v[22:23], v[22:23], v[30:31]
    v_pk_add_f32 v[24:25], v[24:25], v[32:33]
    v_pk_add_f32 v[18:19], v[18:19], v[22:23]
    v_pk_add_f32 v[20:21], v[20:21], v[24:25]
    s_waitcnt vmcnt(16)
    s_barrier
    buffer_load_dwordx4 v2, s[12:15], s39 offen sc1 lds
    buffer_load_dwordx4 v2, s[12:15], s39 offen offset:1024 sc1 lds
    s_call_b64 s[76:77], PREP_a_issue_3
    s_add_u32 m0, m0, 2048
    s_add_u32 s39, s39, 65536
    buffer_load_dwordx4 v2, s[12:15], s39 offen sc1 lds
    buffer_load_dwordx4 v2, s[12:15], s39 offen offset:1024 sc1 lds
    s_add_u32 m0, m0, 2048
    s_add_u32 s39, s39, 65536
    buffer_load_dwordx4 v2, s[12:15], s39 offen sc1 lds
    buffer_load_dwordx4 v2, s[12:15], s39 offen offset:1024 sc1 lds
    s_add_u32 m0, m0, 2048
    s_add_u32 s39, s39, 65536
    buffer_load_dwordx4 v2, s[12:15], s39 offen sc1 lds
    buffer_load_dwordx4 v2, s[12:15], s39 offen offset:1024 sc1 lds
    s_mov_b32 m0, s19
    s_mov_b32 s39, s16
    v_pk_add_f32 v[18:19], v[18:19], v[20:21]
    v_mul_f32 v52, 0x3a800000, v18
    v_mul_f32 v50, 0x3a800000, v19
    v_fma_f32 v50, -v52, v52, v50
    v_max_f32 v50, 0, v50
    v_cvt_pk_bf16_f32 v52, v52, v52
    v_lshlrev_b32 v52, 16, v52
    v_cvt_pk_bf16_f32 v50, v50, v50
    v_lshlrev_b32 v50, 16, v50
    v_add_f32 v50, 0x3727c5ac, v50
    v_cvt_pk_bf16_f32 v50, v50, v50
    v_lshlrev_b32 v50, 16, v50
    v_sqrt_f32 v50, v50
    s_nop 0
    v_cvt_pk_bf16_f32 v50, v50, v50
    s_waitcnt vmcnt(8)
    s_barrier
    buffer_load_dwordx4 v2, s[12:15], s39 offen sc1 lds
    buffer_load_dwordx4 v2, s[12:15], s39 offen offset:1024 sc1 lds
    s_add_u32 m0, m0, 2048
    s_add_u32 s39, s39, 65536
    buffer_load_dwordx4 v2, s[12:15], s39 offen sc1 lds
    buffer_load_dwordx4 v2, s[12:15], s39 offen offset:1024 sc1 lds
    s_add_u32 m0, m0, 2048
    s_add_u32 s39, s39, 65536
    buffer_load_dwordx4 v2, s[12:15], s39 offen sc1 lds
    buffer_load_dwordx4 v2, s[12:15], s39 offen offset:1024 sc1 lds
    s_add_u32 m0, m0, 2048
    s_add_u32 s39, s39, 65536
    buffer_load_dwordx4 v2, s[12:15], s39 offen sc1 lds
    buffer_load_dwordx4 v2, s[12:15], s39 offen offset:1024 sc1 lds
    s_waitcnt vmcnt(24)
    v_lshlrev_b32 v50, 16, v50
    v_rcp_f32 v53, v50
    v_mov_b32 v18, v52
    v_mov_b32 v19, v50
    v_mul_f32 v20, 0xc0135761, v53
    v_mul_f32 v53, v53, v53
    v_mul_f32 v53, 0x3d372713, v53
    v_mul_f32 v21, v53, v20
    s_lshl1_add_u32 s36, s34, 160768
    v_add_u32 v51, s36, v2
    ds_write_b128 v51, v[18:21]
    s_cmp_lg_u32 s60, 0
    s_cbranch_scc1 pc_43
    v_pk_add_f32 v[54:55], v[54:55], v[58:59]
    v_pk_add_f32 v[56:57], v[56:57], v[60:61]
    v_pk_add_f32 v[54:55], v[54:55], v[62:63]
    v_pk_add_f32 v[56:57], v[56:57], v[64:65]
    v_pk_add_f32 v[54:55], v[54:55], v[66:67]
    v_pk_add_f32 v[56:57], v[56:57], v[68:69]
    v_pk_add_f32 v[54:55], v[54:55], v[70:71]
    v_pk_add_f32 v[56:57], v[56:57], v[72:73]
pc_43:
    s_waitcnt vmcnt(8)
    s_barrier
    s_cmp_lg_u32 s60, 0
    s_cbranch_scc1 pc_44
    v_pk_add_f32 v[54:55], v[54:55], v[74:75]
    v_pk_add_f32 v[56:57], v[56:57], v[76:77]
    v_pk_add_f32 v[54:55], v[54:55], v[78:79]
    v_pk_add_f32 v[56:57], v[56:57], v[80:81]
    v_pk_add_f32 v[54:55], v[54:55], v[82:83]
    v_pk_add_f32 v[56:57], v[56:57], v[84:85]
    v_mov_b32 v58, v54
    v_mov_b32 v59, v55
    v_mov_b32 v60, v56
    v_mov_b32 v61, v57
    v_permlane32_swap_b32 v54, v58
    v_permlane32_swap_b32 v55, v59
    v_permlane32_swap_b32 v56, v60
    v_permlane32_swap_b32 v57, v61
    v_pk_add_f32 v[54:55], v[54:55], v[58:59]
    v_pk_add_f32 v[56:57], v[56:57], v[60:61]
    s_and_b32 s36, s30, 1
    s_mul_i32 s36, s36, 448
    s_add_u32 s36, s36, 159744
    v_add_u32 v6, s36, v2
    s_bfm_b64 exec, 28, 0
    ds_write_b128 v6, v[54:57]
    s_mov_b64 exec, -1
    s_waitcnt lgkmcnt(0)
pc_44:
    s_waitcnt lgkmcnt(0)
    s_waitcnt vmcnt(0)
    s_barrier
    s_cmp_lg_u32 s60, 0
    s_cbranch_scc1 tw4_46
    s_mov_b64 s[48:49], s[74:75]
    s_lshl_b32 s45, s2, 1
    s_and_b32 s50, s30, 1
    s_add_u32 s45, s45, s50
    s_mul_i32 s45, s45, 14336
    s_mov_b32 s50, 7340032
    s_mov_b32 s51, 0x20000
    buffer_load_dwordx4 v[90:93], v2, s[48:51], s45 offen offset:0
    buffer_load_dwordx4 v[90:93], v2, s[48:51], s45 offen offset:1024
    buffer_load_dwordx4 v[90:93], v2, s[48:51], s45 offen offset:2048
    buffer_load_dwordx4 v[90:93], v2, s[48:51], s45 offen offset:3072
    s_add_u32 s45, s45, 4096
    buffer_load_dwordx4 v[90:93], v2, s[48:51], s45 offen offset:0
    buffer_load_dwordx4 v[90:93], v2, s[48:51], s45 offen offset:1024
    buffer_load_dwordx4 v[90:93], v2, s[48:51], s45 offen offset:2048
    buffer_load_dwordx4 v[90:93], v2, s[48:51], s45 offen offset:3072
    s_add_u32 s45, s45, 4096
    buffer_load_dwordx4 v[90:93], v2, s[48:51], s45 offen offset:0
    buffer_load_dwordx4 v[90:93], v2, s[48:51], s45 offen offset:1024
    buffer_load_dwordx4 v[90:93], v2, s[48:51], s45 offen offset:2048
    buffer_load_dwordx4 v[90:93], v2, s[48:51], s45 offen offset:3072
    s_add_u32 s45, s45, 4096
    buffer_load_dwordx4 v[90:93], v2, s[48:51], s45 offen offset:0
    buffer_load_dwordx4 v[90:93], v2, s[48:51], s45 offen offset:1024
tw4_46:
    s_barrier
    s_and_b32 s35, s30, 1
    s_mov_b32 s12, s62
    s_mov_b32 s13, s63
    s_mov_b32 s14, 0x1be000
    s_mov_b32 s15, 0x20000
    s_mul_i32 s38, s35, 917504
    s_mul_i32 s36, s31, 573440
    s_add_u32 s38, s38, s36
    s_mul_i32 s37, s31, 917504
    s_sub_u32 s37, 229376, s37
    s_lshl_b32 s41, s35, 13
    s_mov_b32 s42, 0
    s_mov_b32 s44, 0
    s_and_b32 s34, s30, 1
    s_lshl1_add_u32 s34, s31, s34
    s_lshl_b32 s34, s34, 7
    s_add_u32 s34, s34, s55
    s_add_u32 s34, s34, 0x1200
    s_and_b32 s35, s30, 1
    s_lshl1_add_u32 s35, s31, s35
    s_lshl_b32 s35, s35, 7
    s_add_u32 s35, s35, s55
    s_add_u32 s35, s35, 0x1400
    s_sub_u32 s48, s34, 512
    s_mov_b32 s44, 3
    s_add_u32 s36, s33, 4
    s_and_b32 s36, s36, 7
    s_mul_i32 s36, s36, 7
    s_add_u32 s36, s36, 2
    s_lshr_b32 s53, s36, 3
    s_lshl_b32 s53, s53, 14
    s_and_b32 s78, s36, 7
    s_lshl_b32 s78, s78, 10
    s_add_u32 s78, s78, s53
    s_add_u32 s36, s33, 4
    s_and_b32 s36, s36, 7
    s_mul_i32 s36, s36, 7
    s_add_u32 s36, s36, 6
    s_lshr_b32 s53, s36, 3
    s_lshl_b32 s53, s53, 14
    s_and_b32 s79, s36, 7
    s_lshl_b32 s79, s79, 10
    s_add_u32 s79, s79, s53
    s_add_u32 s36, s33, 4
    s_and_b32 s36, s36, 7
    s_mul_i32 s36, s36, 7
    s_add_u32 s36, s36, 3
    s_lshr_b32 s53, s36, 3
    s_lshl_b32 s53, s53, 14
    s_and_b32 s80, s36, 7
    s_lshl_b32 s80, s80, 10
    s_add_u32 s80, s80, s53
    s_add_u32 s36, s33, 5
    s_and_b32 s36, s36, 7
    s_mul_i32 s36, s36, 7
    s_add_u32 s36, s36, 2
    s_lshr_b32 s53, s36, 3
    s_lshl_b32 s53, s53, 14
    s_and_b32 s81, s36, 7
    s_lshl_b32 s81, s81, 10
    s_add_u32 s81, s81, s53
    s_add_u32 s36, s33, 5
    s_and_b32 s36, s36, 7
    s_mul_i32 s36, s36, 7
    s_add_u32 s36, s36, 6
    s_lshr_b32 s53, s36, 3
    s_lshl_b32 s53, s53, 14
    s_and_b32 s82, s36, 7
    s_lshl_b32 s82, s82, 10
    s_add_u32 s82, s82, s53
    s_add_u32 s36, s33, 5
    s_and_b32 s36, s36, 7
    s_mul_i32 s36, s36, 7
    s_add_u32 s36, s36, 3
    s_lshr_b32 s53, s36, 3
    s_lshl_b32 s53, s53, 14
    s_and_b32 s83, s36, 7
    s_lshl_b32 s83, s83, 10
    s_add_u32 s83, s83, s53
    s_add_u32 s36, s33, 6
    s_and_b32 s36, s36, 7
    s_mul_i32 s36, s36, 7
    s_add_u32 s36, s36, 2
    s_lshr_b32 s53, s36, 3
    s_lshl_b32 s53, s53, 14
    s_and_b32 s84, s36, 7
    s_lshl_b32 s84, s84, 10
    s_add_u32 s84, s84, s53
    s_add_u32 s36, s33, 6
    s_and_b32 s36, s36, 7
    s_mul_i32 s36, s36, 7
    s_add_u32 s36, s36, 6
    s_lshr_b32 s53, s36, 3
    s_lshl_b32 s53, s53, 14
    s_and_b32 s85, s36, 7
    s_lshl_b32 s85, s85, 10
    s_add_u32 s85, s85, s53
    s_add_u32 s36, s33, 6
    s_and_b32 s36, s36, 7
    s_mul_i32 s36, s36, 7
    s_add_u32 s36, s36, 3
    s_lshr_b32 s53, s36, 3
    s_lshl_b32 s53, s53, 14
    s_and_b32 s86, s36, 7
    s_lshl_b32 s86, s86, 10
    s_add_u32 s86, s86, s53
    s_add_u32 s36, s33, 7
    s_and_b32 s36, s36, 7
    s_mul_i32 s36, s36, 7
    s_add_u32 s36, s36, 2
    s_lshr_b32 s53, s36, 3
    s_lshl_b32 s53, s53, 14
    s_and_b32 s87, s36, 7
    s_lshl_b32 s87, s87, 10
    s_add_u32 s87, s87, s53
    s_add_u32 s36, s33, 7
    s_and_b32 s36, s36, 7
    s_mul_i32 s36, s36, 7
    s_add_u32 s36, s36, 6
    s_lshr_b32 s53, s36, 3
    s_lshl_b32 s53, s53, 14
    s_and_b32 s88, s36, 7
    s_lshl_b32 s88, s88, 10
    s_add_u32 s88, s88, s53
    s_add_u32 s36, s33, 7
    s_and_b32 s36, s36, 7
    s_mul_i32 s36, s36, 7
    s_add_u32 s36, s36, 3
    s_lshr_b32 s53, s36, 3
    s_lshl_b32 s53, s53, 14
    s_and_b32 s89, s36, 7
    s_lshl_b32 s89, s89, 10
    s_add_u32 s89, s89, s53
    s_mov_b64 s[8:9], s[68:69]
    s_mov_b32 s10, 2097152
    s_mov_b32 s11, 0x20000
    s_and_b32 s3, s30, 3
    s_lshl_b32 s36, s3, 14
    s_lshl_b32 s90, s29, 7
    s_add_u32 s90, s90, s36
    s_xor_b32 s90, s90, 128
    s_lshl_b32 s3, s3, 10
    s_call_b64 s[76:77], PREP_a_issue_4
    s_mov_b32 m0, s19
    s_mov_b32 s39, s16
    s_mov_b32 s40, s17
    s_waitcnt vmcnt(16)
    s_barrier
    s_load_dword s32, s[4:5], s48
    s_waitcnt vmcnt(8)
    s_barrier
    s_add_u32 s54, s52, 16
    s_waitcnt lgkmcnt(0)
    s_cmp_eq_u32 s32, s54
    s_cbranch_scc1 fok_47
    v_mov_b32 v9, s48
    s_mov_b32 s53, 0
    s_add_u32 s54, s52, 16
    s_bfm_b64 exec, 1, 0
poll_48:
    buffer_load_dword v8, v9, s[56:59], 0 offen sc1
    s_waitcnt vmcnt(0)
    v_cmp_eq_u32 vcc, s54, v8
    s_nop 0
    s_cmp_eq_u64 vcc, exec
    s_cbranch_scc1 pok_49
    s_sleep 5
    s_add_u32 s53, s53, 1
    s_cmp_lt_u32 s53, s61
    s_cbranch_scc1 poll_48
    s_mov_b32 s61, 0
pok_49:
    s_mov_b64 exec, -1
fok_47:
    buffer_load_dwordx4 v2, s[12:15], s39 offen sc1 lds
    s_add_u32 m0, m0, 1024
    s_nop 0
    buffer_load_dwordx4 v2, s[12:15], s40 offen sc1 lds
    s_call_b64 s[76:77], PREP_a_issue_4
    s_add_u32 m0, m0, 1024
    s_add_u32 s39, s39, 229376
    buffer_load_dwordx4 v2, s[12:15], s39 offen sc1 lds
    s_add_u32 m0, m0, 1024
    s_add_u32 s40, s40, 229376
    buffer_load_dwordx4 v2, s[12:15], s40 offen sc1 lds
    s_add_u32 m0, m0, 1024
    s_add_u32 s39, s39, s37
    buffer_load_dwordx4 v2, s[12:15], s39 offen sc1 lds
    s_add_u32 m0, m0, 1024
    s_add_u32 s40, s40, s37
    buffer_load_dwordx4 v2, s[12:15], s40 offen sc1 lds
    s_add_u32 m0, m0, 1024
    s_add_u32 s39, s39, 229376
    buffer_load_dwordx4 v2, s[12:15], s39 offen sc1 lds
    s_add_u32 m0, m0, 1024
    s_add_u32 s40, s40, 229376
    buffer_load_dwordx4 v2, s[12:15], s40 offen sc1 lds
    s_mov_b32 m0, s19
    s_mov_b32 s39, s16
    s_mov_b32 s40, s17
    s_waitcnt vmcnt(8)
    s_barrier
    buffer_load_dwordx4 v2, s[12:15], s39 offen sc1 lds
    s_add_u32 m0, m0, 1024
    s_nop 0
    buffer_load_dwordx4 v2, s[12:15], s40 offen sc1 lds
    s_mov_b32 s43, 1
ld_50:
    s_add_u32 s19, s41, s42
    s_lshl_b32 s45, s44, 1
    s_add_u32 s45, s45, 0
    s_sub_u32 s45, s45, 32
    s_mul_i32 s46, s45, 86
    s_lshr_b32 s46, s46, 8
    s_mul_i32 s47, s46, 3
    s_sub_u32 s47, s45, s47
    s_lshl_b32 s47, s47, 2
    s_lshr_b32 s47, 0x362, s47
    s_and_b32 s47, s47, 7
    s_cmp_ge_u32 s44, 10
    s_cselect_b32 s45, 9, 2
    s_cselect_b32 s51, 1, 0
    s_sub_u32 s45, s44, s45
    s_cmp_lt_u32 s44, 3
    s_cselect_b32 s45, 0, s45
    s_cselect_b32 s51, s44, s51
    s_lshl2_add_u32 s51, 0, s51
    s_cmp_lt_u32 s44, 17
    s_cselect_b32 s47, s51, s47
    s_cselect_b32 s46, s45, s46
    s_add_u32 s46, s46, s33
    s_and_b32 s46, s46, 7
    s_mul_i32 s46, s46, 7
    s_add_u32 s16, s46, s47
    s_lshr_b32 s53, s16, 3
    s_lshl_b32 s53, s53, 14
    s_and_b32 s16, s16, 7
    s_lshl_b32 s16, s16, 10
    s_add_u32 s16, s16, s53
    s_add_u32 s16, s16, s38
    s_lshl_b32 s45, s44, 1
    s_add_u32 s45, s45, 1
    s_sub_u32 s45, s45, 32
    s_mul_i32 s46, s45, 86
    s_lshr_b32 s46, s46, 8
    s_mul_i32 s47, s46, 3
    s_sub_u32 s47, s45, s47
    s_lshl_b32 s47, s47, 2
    s_lshr_b32 s47, 0x362, s47
    s_and_b32 s47, s47, 7
    s_cmp_ge_u32 s44, 10
    s_cselect_b32 s45, 9, 2
    s_cselect_b32 s51, 1, 0
    s_sub_u32 s45, s44, s45
    s_cmp_lt_u32 s44, 3
    s_cselect_b32 s45, 0, s45
    s_cselect_b32 s51, s44, s51
    s_lshl2_add_u32 s51, 1, s51
    s_cmp_lt_u32 s44, 17
    s_cselect_b32 s47, s51, s47
    s_cselect_b32 s46, s45, s46
    s_add_u32 s46, s46, s33
    s_and_b32 s46, s46, 7
    s_mul_i32 s46, s46, 7
    s_add_u32 s17, s46, s47
    s_lshr_b32 s53, s17, 3
    s_lshl_b32 s53, s53, 14
    s_and_b32 s17, s17, 7
    s_lshl_b32 s17, s17, 10
    s_add_u32 s17, s17, s53
    s_add_u32 s17, s17, s38
    s_add_u32 s44, s44, 1
    s_add_u32 s42, s42, 16384
    s_cmp_eq_u32 s42, 49152
    s_cselect_b32 s42, 0, s42
    s_add_u32 m0, m0, 1024
    s_add_u32 s39, s39, 229376
    buffer_load_dwordx4 v2, s[12:15], s39 offen sc1 lds
    s_add_u32 m0, m0, 1024
    s_add_u32 s40, s40, 229376
    buffer_load_dwordx4 v2, s[12:15], s40 offen sc1 lds
    s_add_u32 m0, m0, 1024
    s_add_u32 s39, s39, s37
    buffer_load_dwordx4 v2, s[12:15], s39 offen sc1 lds
    s_add_u32 m0, m0, 1024
    s_add_u32 s40, s40, s37
    buffer_load_dwordx4 v2, s[12:15], s40 offen sc1 lds
    s_add_u32 m0, m0, 1024
    s_add_u32 s39, s39, 229376
    buffer_load_dwordx4 v2, s[12:15], s39 offen sc1 lds
    s_add_u32 m0, m0, 1024
    s_add_u32 s40, s40, 229376
    buffer_load_dwordx4 v2, s[12:15], s40 offen sc1 lds
    s_mov_b32 m0, s19
    s_mov_b32 s39, s16
    s_mov_b32 s40, s17
    s_waitcnt vmcnt(8)
    s_barrier
    buffer_load_dwordx4 v2, s[12:15], s39 offen sc1 lds
    s_add_u32 m0, m0, 1024
    s_nop 0
    buffer_load_dwordx4 v2, s[12:15], s40 offen sc1 lds
    s_add_u32 s43, s43, 1
    s_cmp_lt_u32 s43, 4
    s_cbranch_scc1 ld_50
    s_call_b64 s[76:77], PREP_a_issue_4
    s_add_u32 m0, m0, 1024
    s_add_u32 s39, s39, 229376
    buffer_load_dwordx4 v2, s[12:15], s39 offen sc1 lds
    s_add_u32 m0, m0, 1024
    s_add_u32 s40, s40, 229376
    buffer_load_dwordx4 v2, s[12:15], s40 offen sc1 lds
    s_add_u32 m0, m0, 1024
    s_add_u32 s39, s39, s37
    buffer_load_dwordx4 v2, s[12:15], s39 offen sc1 lds
    s_add_u32 m0, m0, 1024
    s_add_u32 s40, s40, s37
    buffer_load_dwordx4 v2, s[12:15], s40 offen sc1 lds
    s_add_u32 m0, m0, 1024
    s_add_u32 s39, s39, 229376
    buffer_load_dwordx4 v2, s[12:15], s39 offen sc1 lds
    s_add_u32 m0, m0, 1024
    s_add_u32 s40, s40, 229376
    buffer_load_dwordx4 v2, s[12:15], s40 offen sc1 lds
    s_mov_b32 m0, s19
    s_mov_b32 s39, s16
    s_mov_b32 s40, s17
    s_waitcnt vmcnt(8)
    s_barrier
    buffer_load_dwordx4 v2, s[12:15], s39 offen sc1 lds
    s_add_u32 m0, m0, 1024
    s_nop 0
    buffer_load_dwordx4 v2, s[12:15], s40 offen sc1 lds
    s_load_dword s32, s[4:5], s34
    s_call_b64 s[76:77], PREP_a_issue_4
    s_add_u32 m0, m0, 1024
    s_add_u32 s39, s39, 229376
    buffer_load_dwordx4 v2, s[12:15], s39 offen sc1 lds
    s_add_u32 m0, m0, 1024
    s_add_u32 s40, s40, 229376
    buffer_load_dwordx4 v2, s[12:15], s40 offen sc1 lds
    s_add_u32 m0, m0, 1024
    s_add_u32 s39, s39, s37
    buffer_load_dwordx4 v2, s[12:15], s39 offen sc1 lds
    s_add_u32 m0, m0, 1024
    s_add_u32 s40, s40, s37
    buffer_load_dwordx4 v2, s[12:15], s40 offen sc1 lds
    s_add_u32 m0, m0, 1024
    s_add_u32 s39, s39, 229376
    buffer_load_dwordx4 v2, s[12:15], s39 offen sc1 lds
    s_add_u32 m0, m0, 1024
    s_add_u32 s40, s40, 229376
    buffer_load_dwordx4 v2, s[12:15], s40 offen sc1 lds
    s_mov_b32 m0, s19
    s_mov_b32 s39, s16
    s_mov_b32 s40, s17
    s_waitcnt vmcnt(8)
    s_barrier
    buffer_load_dwordx4 v2, s[12:15], s39 offen sc1 lds
    s_add_u32 m0, m0, 1024
    s_nop 0
    buffer_load_dwordx4 v2, s[12:15], s40 offen sc1 lds
    s_add_u32 s54, s52, 16
    s_waitcnt lgkmcnt(0)
    s_cmp_eq_u32 s32, s54
    s_cbranch_scc1 fok_51
    v_mov_b32 v9, s34
    s_mov_b32 s53, 0
    s_add_u32 s54, s52, 16
    s_bfm_b64 exec, 1, 0
poll_52:
    buffer_load_dword v8, v9, s[56:59], 0 offen sc1
    s_waitcnt vmcnt(0)
    v_cmp_eq_u32 vcc, s54, v8
    s_nop 0
    s_cmp_eq_u64 vcc, exec
    s_cbranch_scc1 pok_53
    s_sleep 5
    s_add_u32 s53, s53, 1
    s_cmp_lt_u32 s53, s61
    s_cbranch_scc1 poll_52
    s_mov_b32 s61, 0
pok_53:
    s_mov_b64 exec, -1
fok_51:
    s_call_b64 s[76:77], PREP_a_issue_4
    s_add_u32 m0, m0, 1024
    s_add_u32 s39, s39, 229376
    buffer_load_dwordx4 v2, s[12:15], s39 offen sc1 lds
    s_add_u32 m0, m0, 1024
    s_add_u32 s40, s40, 229376
    buffer_load_dwordx4 v2, s[12:15], s40 offen sc1 lds
    s_add_u32 m0, m0, 1024
    s_add_u32 s39, s39, s37
    buffer_load_dwordx4 v2, s[12:15], s39 offen sc1 lds
    s_add_u32 m0, m0, 1024
    s_add_u32 s40, s40, s37
    buffer_load_dwordx4 v2, s[12:15], s40 offen sc1 lds
    s_add_u32 m0, m0, 1024
    s_add_u32 s39, s39, 229376
    buffer_load_dwordx4 v2, s[12:15], s39 offen sc1 lds
    s_add_u32 m0, m0, 1024
    s_add_u32 s40, s40, 229376
    buffer_load_dwordx4 v2, s[12:15], s40 offen sc1 lds
    s_mov_b32 m0, s19
    s_mov_b32 s39, s16
    s_mov_b32 s40, s17
    s_waitcnt vmcnt(8)
    s_barrier
    buffer_load_dwordx4 v2, s[12:15], s39 offen sc1 lds
    s_add_u32 m0, m0, 1024
    s_nop 0
    buffer_load_dwordx4 v2, s[12:15], s40 offen sc1 lds
    s_mov_b32 s43, 1
ld_54:
    s_add_u32 s19, s41, s42
    s_lshl_b32 s45, s44, 1
    s_add_u32 s45, s45, 0
    s_sub_u32 s45, s45, 32
    s_mul_i32 s46, s45, 86
    s_lshr_b32 s46, s46, 8
    s_mul_i32 s47, s46, 3
    s_sub_u32 s47, s45, s47
    s_lshl_b32 s47, s47, 2
    s_lshr_b32 s47, 0x362, s47
    s_and_b32 s47, s47, 7
    s_cmp_ge_u32 s44, 10
    s_cselect_b32 s45, 9, 2
    s_cselect_b32 s51, 1, 0
    s_sub_u32 s45, s44, s45
    s_cmp_lt_u32 s44, 3
    s_cselect_b32 s45, 0, s45
    s_cselect_b32 s51, s44, s51
    s_lshl2_add_u32 s51, 0, s51
    s_cmp_lt_u32 s44, 17
    s_cselect_b32 s47, s51, s47
    s_cselect_b32 s46, s45, s46
    s_add_u32 s46, s46, s33
    s_and_b32 s46, s46, 7
    s_mul_i32 s46, s46, 7
    s_add_u32 s16, s46, s47
    s_lshr_b32 s53, s16, 3
    s_lshl_b32 s53, s53, 14
    s_and_b32 s16, s16, 7
    s_lshl_b32 s16, s16, 10
    s_add_u32 s16, s16, s53
    s_add_u32 s16, s16, s38
    s_lshl_b32 s45, s44, 1
    s_add_u32 s45, s45, 1
    s_sub_u32 s45, s45, 32
    s_mul_i32 s46, s45, 86
    s_lshr_b32 s46, s46, 8
    s_mul_i32 s47, s46, 3
    s_sub_u32 s47, s45, s47
    s_lshl_b32 s47, s47, 2
    s_lshr_b32 s47, 0x362, s47
    s_and_b32 s47, s47, 7
    s_cmp_ge_u32 s44, 10
    s_cselect_b32 s45, 9, 2
    s_cselect_b32 s51, 1, 0
    s_sub_u32 s45, s44, s45
    s_cmp_lt_u32 s44, 3
    s_cselect_b32 s45, 0, s45
    s_cselect_b32 s51, s44, s51
    s_lshl2_add_u32 s51, 1, s51
    s_cmp_lt_u32 s44, 17
    s_cselect_b32 s47, s51, s47
    s_cselect_b32 s46, s45, s46
    s_add_u32 s46, s46, s33
    s_and_b32 s46, s46, 7
    s_mul_i32 s46, s46, 7
    s_add_u32 s17, s46, s47
    s_lshr_b32 s53, s17, 3
    s_lshl_b32 s53, s53, 14
    s_and_b32 s17, s17, 7
    s_lshl_b32 s17, s17, 10
    s_add_u32 s17, s17, s53
    s_add_u32 s17, s17, s38
    s_add_u32 s44, s44, 1
    s_add_u32 s42, s42, 16384
    s_cmp_eq_u32 s42, 49152
    s_cselect_b32 s42, 0, s42
    s_add_u32 m0, m0, 1024
    s_add_u32 s39, s39, 229376
    buffer_load_dwordx4 v2, s[12:15], s39 offen sc1 lds
    s_add_u32 m0, m0, 1024
    s_add_u32 s40, s40, 229376
    buffer_load_dwordx4 v2, s[12:15], s40 offen sc1 lds
    s_add_u32 m0, m0, 1024
    s_add_u32 s39, s39, s37
    buffer_load_dwordx4 v2, s[12:15], s39 offen sc1 lds
    s_add_u32 m0, m0, 1024
    s_add_u32 s40, s40, s37
    buffer_load_dwordx4 v2, s[12:15], s40 offen sc1 lds
    s_add_u32 m0, m0, 1024
    s_add_u32 s39, s39, 229376
    buffer_load_dwordx4 v2, s[12:15], s39 offen sc1 lds
    s_add_u32 m0, m0, 1024
    s_add_u32 s40, s40, 229376
    buffer_load_dwordx4 v2, s[12:15], s40 offen sc1 lds
    s_mov_b32 m0, s19
    s_mov_b32 s39, s16
    s_mov_b32 s40, s17
    s_waitcnt vmcnt(8)
    s_barrier
    buffer_load_dwordx4 v2, s[12:15], s39 offen sc1 lds
    s_add_u32 m0, m0, 1024
    s_nop 0
    buffer_load_dwordx4 v2, s[12:15], s40 offen sc1 lds
    s_add_u32 s43, s43, 1
    s_cmp_lt_u32 s43, 5
    s_cbranch_scc1 ld_54
    s_call_b64 s[76:77], PREP_a_issue_4
    s_add_u32 m0, m0, 1024
    s_add_u32 s39, s39, 229376
    buffer_load_dwordx4 v2, s[12:15], s39 offen sc1 lds
    s_add_u32 m0, m0, 1024
    s_add_u32 s40, s40, 229376
    buffer_load_dwordx4 v2, s[12:15], s40 offen sc1 lds
    s_add_u32 m0, m0, 1024
    s_add_u32 s39, s39, s37
    buffer_load_dwordx4 v2, s[12:15], s39 offen sc1 lds
    s_add_u32 m0, m0, 1024
    s_add_u32 s40, s40, s37
    buffer_load_dwordx4 v2, s[12:15], s40 offen sc1 lds
    s_add_u32 m0, m0, 1024
    s_add_u32 s39, s39, 229376
    buffer_load_dwordx4 v2, s[12:15], s39 offen sc1 lds
    s_add_u32 m0, m0, 1024
    s_add_u32 s40, s40, 229376
    buffer_load_dwordx4 v2, s[12:15], s40 offen sc1 lds
    s_mov_b32 m0, s19
    s_mov_b32 s39, s16
    s_mov_b32 s40, s17
    s_waitcnt vmcnt(8)
    s_barrier
    buffer_load_dwordx4 v2, s[12:15], s39 offen sc1 lds
    s_add_u32 m0, m0, 1024
    s_nop 0
    buffer_load_dwordx4 v2, s[12:15], s40 offen sc1 lds
    s_load_dword s32, s[4:5], s35
    s_call_b64 s[76:77], PREP_a_issue_4
    s_add_u32 m0, m0, 1024
    s_add_u32 s39, s39, 229376
    buffer_load_dwordx4 v2, s[12:15], s39 offen sc1 lds
    s_add_u32 m0, m0, 1024
    s_add_u32 s40, s40, 229376
    buffer_load_dwordx4 v2, s[12:15], s40 offen sc1 lds
    s_add_u32 m0, m0, 1024
    s_add_u32 s39, s39, s37
    buffer_load_dwordx4 v2, s[12:15], s39 offen sc1 lds
    s_add_u32 m0, m0, 1024
    s_add_u32 s40, s40, s37
    buffer_load_dwordx4 v2, s[12:15], s40 offen sc1 lds
    s_add_u32 m0, m0, 1024
    s_add_u32 s39, s39, 229376
    buffer_load_dwordx4 v2, s[12:15], s39 offen sc1 lds
    s_add_u32 m0, m0, 1024
    s_add_u32 s40, s40, 229376
    buffer_load_dwordx4 v2, s[12:15], s40 offen sc1 lds
    s_mov_b32 m0, s19
    s_mov_b32 s39, s16
    s_mov_b32 s40, s17
    s_waitcnt vmcnt(8)
    s_barrier
    buffer_load_dwordx4 v2, s[12:15], s39 offen sc1 lds
    s_add_u32 m0, m0, 1024
    s_nop 0
    buffer_load_dwordx4 v2, s[12:15], s40 offen sc1 lds
    s_add_u32 s54, s52, 16
    s_waitcnt lgkmcnt(0)
    s_cmp_eq_u32 s32, s54
    s_cbranch_scc1 fok_55
    v_mov_b32 v9, s35
    s_mov_b32 s53, 0
    s_add_u32 s54, s52, 16
    s_bfm_b64 exec, 1, 0
poll_56:
    buffer_load_dword v8, v9, s[56:59], 0 offen sc1
    s_waitcnt vmcnt(0)
    v_cmp_eq_u32 vcc, s54, v8
    s_nop 0
    s_cmp_eq_u64 vcc, exec
    s_cbranch_scc1 pok_57
    s_sleep 5
    s_add_u32 s53, s53, 1
    s_cmp_lt_u32 s53, s61
    s_cbranch_scc1 poll_56
    s_mov_b32 s61, 0
pok_57:
    s_mov_b64 exec, -1
fok_55:
    s_call_b64 s[76:77], PREP_a_issue_4
    s_add_u32 m0, m0, 1024
    s_add_u32 s39, s39, 229376
    buffer_load_dwordx4 v2, s[12:15], s39 offen sc1 lds
    s_add_u32 m0, m0, 1024
    s_add_u32 s40, s40, 229376
    buffer_load_dwordx4 v2, s[12:15], s40 offen sc1 lds
    s_add_u32 m0, m0, 1024
    s_add_u32 s39, s39, s37
    buffer_load_dwordx4 v2, s[12:15], s39 offen sc1 lds
    s_add_u32 m0, m0, 1024
    s_add_u32 s40, s40, s37
    buffer_load_dwordx4 v2, s[12:15], s40 offen sc1 lds
    s_add_u32 m0, m0, 1024
    s_add_u32 s39, s39, 229376
    buffer_load_dwordx4 v2, s[12:15], s39 offen sc1 lds
    s_add_u32 m0, m0, 1024
    s_add_u32 s40, s40, 229376
    buffer_load_dwordx4 v2, s[12:15], s40 offen sc1 lds
    s_mov_b32 m0, s19
    s_mov_b32 s39, s16
    s_mov_b32 s40, s17
    s_waitcnt vmcnt(8)
    s_barrier
    buffer_load_dwordx4 v2, s[12:15], s39 offen sc1 lds
    s_add_u32 m0, m0, 1024
    s_nop 0
    buffer_load_dwordx4 v2, s[12:15], s40 offen sc1 lds
    s_mov_b32 s43, 1
ld_58:
    s_add_u32 s19, s41, s42
    s_lshl_b32 s45, s44, 1
    s_add_u32 s45, s45, 0
    s_sub_u32 s45, s45, 32
    s_mul_i32 s46, s45, 86
    s_lshr_b32 s46, s46, 8
    s_mul_i32 s47, s46, 3
    s_sub_u32 s47, s45, s47
    s_lshl_b32 s47, s47, 2
    s_lshr_b32 s47, 0x362, s47
    s_and_b32 s47, s47, 7
    s_cmp_ge_u32 s44, 10
    s_cselect_b32 s45, 9, 2
    s_cselect_b32 s51, 1, 0
    s_sub_u32 s45, s44, s45
    s_cmp_lt_u32 s44, 3
    s_cselect_b32 s45, 0, s45
    s_cselect_b32 s51, s44, s51
    s_lshl2_add_u32 s51, 0, s51
    s_cmp_lt_u32 s44, 17
    s_cselect_b32 s47, s51, s47
    s_cselect_b32 s46, s45, s46
    s_add_u32 s46, s46, s33
    s_and_b32 s46, s46, 7
    s_mul_i32 s46, s46, 7
    s_add_u32 s16, s46, s47
    s_lshr_b32 s53, s16, 3
    s_lshl_b32 s53, s53, 14
    s_and_b32 s16, s16, 7
    s_lshl_b32 s16, s16, 10
    s_add_u32 s16, s16, s53
    s_add_u32 s16, s16, s38
    s_lshl_b32 s45, s44, 1
    s_add_u32 s45, s45, 1
    s_sub_u32 s45, s45, 32
    s_mul_i32 s46, s45, 86
    s_lshr_b32 s46, s46, 8
    s_mul_i32 s47, s46, 3
    s_sub_u32 s47, s45, s47
    s_lshl_b32 s47, s47, 2
    s_lshr_b32 s47, 0x362, s47
    s_and_b32 s47, s47, 7
    s_cmp_ge_u32 s44, 10
    s_cselect_b32 s45, 9, 2
    s_cselect_b32 s51, 1, 0
    s_sub_u32 s45, s44, s45
    s_cmp_lt_u32 s44, 3
    s_cselect_b32 s45, 0, s45
    s_cselect_b32 s51, s44, s51
    s_lshl2_add_u32 s51, 1, s51
    s_cmp_lt_u32 s44, 17
    s_cselect_b32 s47, s51, s47
    s_cselect_b32 s46, s45, s46
    s_add_u32 s46, s46, s33
    s_and_b32 s46, s46, 7
    s_mul_i32 s46, s46, 7
    s_add_u32 s17, s46, s47
    s_lshr_b32 s53, s17, 3
    s_lshl_b32 s53, s53, 14
    s_and_b32 s17, s17, 7
    s_lshl_b32 s17, s17, 10
    s_add_u32 s17, s17, s53
    s_add_u32 s17, s17, s38
    s_add_u32 s44, s44, 1
    s_add_u32 s42, s42, 16384
    s_cmp_eq_u32 s42, 49152
    s_cselect_b32 s42, 0, s42
    s_add_u32 m0, m0, 1024
    s_add_u32 s39, s39, 229376
    buffer_load_dwordx4 v2, s[12:15], s39 offen sc1 lds
    s_add_u32 m0, m0, 1024
    s_add_u32 s40, s40, 229376
    buffer_load_dwordx4 v2, s[12:15], s40 offen sc1 lds
    s_add_u32 m0, m0, 1024
    s_add_u32 s39, s39, s37
    buffer_load_dwordx4 v2, s[12:15], s39 offen sc1 lds
    s_add_u32 m0, m0, 1024
    s_add_u32 s40, s40, s37
    buffer_load_dwordx4 v2, s[12:15], s40 offen sc1 lds
    s_add_u32 m0, m0, 1024
    s_add_u32 s39, s39, 229376
    buffer_load_dwordx4 v2, s[12:15], s39 offen sc1 lds
    s_add_u32 m0, m0, 1024
    s_add_u32 s40, s40, 229376
    buffer_load_dwordx4 v2, s[12:15], s40 offen sc1 lds
    s_mov_b32 m0, s19
    s_mov_b32 s39, s16
    s_mov_b32 s40, s17
    s_waitcnt vmcnt(8)
    s_barrier
    buffer_load_dwordx4 v2, s[12:15], s39 offen sc1 lds
    s_add_u32 m0, m0, 1024
    s_nop 0
    buffer_load_dwordx4 v2, s[12:15], s40 offen sc1 lds
    s_add_u32 s43, s43, 1
    s_cmp_lt_u32 s43, 5
    s_cbranch_scc1 ld_58
    s_call_b64 s[76:77], PREP_a_issue_4
    s_add_u32 m0, m0, 1024
    s_add_u32 s39, s39, 229376
    buffer_load_dwordx4 v2, s[12:15], s39 offen sc1 lds
    s_add_u32 m0, m0, 1024
    s_add_u32 s40, s40, 229376
    buffer_load_dwordx4 v2, s[12:15], s40 offen sc1 lds
    s_add_u32 m0, m0, 1024
    s_add_u32 s39, s39, s37
    buffer_load_dwordx4 v2, s[12:15], s39 offen sc1 lds
    s_add_u32 m0, m0, 1024
    s_add_u32 s40, s40, s37
    buffer_load_dwordx4 v2, s[12:15], s40 offen sc1 lds
    s_add_u32 m0, m0, 1024
    s_add_u32 s39, s39, 229376
    buffer_load_dwordx4 v2, s[12:15], s39 offen sc1 lds
    s_add_u32 m0, m0, 1024
    s_add_u32 s40, s40, 229376
    buffer_load_dwordx4 v2, s[12:15], s40 offen sc1 lds
    s_mov_b32 m0, s19
    s_mov_b32 s39, s16
    s_mov_b32 s40, s17
    s_waitcnt vmcnt(8)
    s_barrier
    s_add_u32 s39, s38, s37
    s_add_u32 s39, s39, 229376
    s_add_u32 m0, s41, 16384
    s_add_u32 s16, s39, s78
    s_add_u32 s17, s39, s79
    buffer_load_dwordx4 v2, s[12:15], s16 offen sc1 lds
    s_add_u32 m0, m0, 1024
    s_nop 0
    buffer_load_dwordx4 v2, s[12:15], s17 offen sc1 lds
    s_add_u32 m0, m0, 1024
    s_add_u32 s16, s16, 229376
    buffer_load_dwordx4 v2, s[12:15], s16 offen sc1 lds
    s_add_u32 m0, m0, 1024
    s_add_u32 s17, s17, 229376
    buffer_load_dwordx4 v2, s[12:15], s17 offen sc1 lds
    s_add_u32 m0, m0, 1024
    s_add_u32 s16, s39, s80
    s_add_u32 s17, s39, s81
    buffer_load_dwordx4 v2, s[12:15], s16 offen sc1 lds
    s_add_u32 m0, m0, 1024
    s_nop 0
    buffer_load_dwordx4 v2, s[12:15], s17 offen sc1 lds
    s_add_u32 m0, m0, 1024
    s_add_u32 s16, s16, 229376
    buffer_load_dwordx4 v2, s[12:15], s16 offen sc1 lds
    s_add_u32 m0, m0, 1024
    s_add_u32 s17, s17, 229376
    buffer_load_dwordx4 v2, s[12:15], s17 offen sc1 lds
    s_waitcnt vmcnt(8)
    s_barrier
    s_add_u32 m0, s41, 32768
    s_add_u32 s16, s39, s82
    s_add_u32 s17, s39, s83
    buffer_load_dwordx4 v2, s[12:15], s16 offen sc1 lds
    s_add_u32 m0, m0, 1024
    s_nop 0
    buffer_load_dwordx4 v2, s[12:15], s17 offen sc1 lds
    s_add_u32 m0, m0, 1024
    s_add_u32 s16, s16, 229376
    buffer_load_dwordx4 v2, s[12:15], s16 offen sc1 lds
    s_add_u32 m0, m0, 1024
    s_add_u32 s17, s17, 229376
    buffer_load_dwordx4 v2, s[12:15], s17 offen sc1 lds
    s_add_u32 m0, m0, 1024
    s_add_u32 s16, s39, s84
    s_add_u32 s17, s39, s85
    buffer_load_dwordx4 v2, s[12:15], s16 offen sc1 lds
    s_add_u32 m0, m0, 1024
    s_nop 0
    buffer_load_dwordx4 v2, s[12:15], s17 offen sc1 lds
    s_add_u32 m0, m0, 1024
    s_add_u32 s16, s16, 229376
    buffer_load_dwordx4 v2, s[12:15], s16 offen sc1 lds
    s_add_u32 m0, m0, 1024
    s_add_u32 s17, s17, 229376
    buffer_load_dwordx4 v2, s[12:15], s17 offen sc1 lds
    s_waitcnt vmcnt(8)
    s_barrier
    s_add_u32 m0, s41, 0
    s_add_u32 s16, s39, s86
    s_add_u32 s17, s39, s87
    buffer_load_dwordx4 v2, s[12:15], s16 offen sc1 lds
    s_add_u32 m0, m0, 1024
    s_nop 0
    buffer_load_dwordx4 v2, s[12:15], s17 offen sc1 lds
    s_add_u32 m0, m0, 1024
    s_add_u32 s16, s16, 229376
    buffer_load_dwordx4 v2, s[12:15], s16 offen sc1 lds
    s_add_u32 m0, m0, 1024
    s_add_u32 s17, s17, 229376
    buffer_load_dwordx4 v2, s[12:15], s17 offen sc1 lds
    s_add_u32 m0, m0, 1024
    s_add_u32 s16, s39, s88
    s_add_u32 s17, s39, s89
    buffer_load_dwordx4 v2, s[12:15], s16 offen sc1 lds
    s_add_u32 m0, m0, 1024
    s_nop 0
    buffer_load_dwordx4 v2, s[12:15], s17 offen sc1 lds
    s_add_u32 m0, m0, 1024
    s_add_u32 s16, s16, 229376
    buffer_load_dwordx4 v2, s[12:15], s16 offen sc1 lds
    s_add_u32 m0, m0, 1024
    s_add_u32 s17, s17, 229376
    buffer_load_dwordx4 v2, s[12:15], s17 offen sc1 lds
    s_cmp_lg_u32 s60, 0
    s_cbranch_scc1 tl_59
    s_call_b64 s[76:77], SUB_w1_piece_23
    s_waitcnt vmcnt(10)
    s_branch tz_60
tl_59:
    s_waitcnt vmcnt(8)
tz_60:
    s_barrier
    s_mov_b32 s39, s38
    s_add_u32 m0, s41, 16384
    s_add_u32 s16, s39, s78
    s_add_u32 s17, s39, s79
    buffer_load_dwordx4 v2, s[12:15], s16 offen sc1 lds
    s_add_u32 m0, m0, 1024
    s_nop 0
    buffer_load_dwordx4 v2, s[12:15], s17 offen sc1 lds
    s_add_u32 m0, m0, 1024
    s_add_u32 s16, s16, 229376
    buffer_load_dwordx4 v2, s[12:15], s16 offen sc1 lds
    s_add_u32 m0, m0, 1024
    s_add_u32 s17, s17, 229376
    buffer_load_dwordx4 v2, s[12:15], s17 offen sc1 lds
    s_add_u32 m0, m0, 1024
    s_add_u32 s16, s39, s80
    s_add_u32 s17, s39, s81
    buffer_load_dwordx4 v2, s[12:15], s16 offen sc1 lds
    s_add_u32 m0, m0, 1024
    s_nop 0
    buffer_load_dwordx4 v2, s[12:15], s17 offen sc1 lds
    s_add_u32 m0, m0, 1024
    s_add_u32 s16, s16, 229376
    buffer_load_dwordx4 v2, s[12:15], s16 offen sc1 lds
    s_add_u32 m0, m0, 1024
    s_add_u32 s17, s17, 229376
    buffer_load_dwordx4 v2, s[12:15], s17 offen sc1 lds
    s_cmp_lg_u32 s60, 0
    s_cbranch_scc1 tl_61
    s_call_b64 s[76:77], SUB_w1_piece_24
    s_waitcnt vmcnt(14)
    s_branch tz_62
tl_61:
    s_waitcnt vmcnt(8)
tz_62:
    s_barrier
    s_add_u32 m0, s41, 32768
    s_add_u32 s16, s39, s82
    s_add_u32 s17, s39, s83
    buffer_load_dwordx4 v2, s[12:15], s16 offen sc1 lds
    s_add_u32 m0, m0, 1024
    s_nop 0
    buffer_load_dwordx4 v2, s[12:15], s17 offen sc1 lds
    s_add_u32 m0, m0, 1024
    s_add_u32 s16, s16, 229376
    buffer_load_dwordx4 v2, s[12:15], s16 offen sc1 lds
    s_add_u32 m0, m0, 1024
    s_add_u32 s17, s17, 229376
    buffer_load_dwordx4 v2, s[12:15], s17 offen sc1 lds
    s_add_u32 m0, m0, 1024
    s_add_u32 s16, s39, s84
    s_add_u32 s17, s39, s85
    buffer_load_dwordx4 v2, s[12:15], s16 offen sc1 lds
    s_add_u32 m0, m0, 1024
    s_nop 0
    buffer_load_dwordx4 v2, s[12:15], s17 offen sc1 lds
    s_add_u32 m0, m0, 1024
    s_add_u32 s16, s16, 229376
    buffer_load_dwordx4 v2, s[12:15], s16 offen sc1 lds
    s_add_u32 m0, m0, 1024
    s_add_u32 s17, s17, 229376
    buffer_load_dwordx4 v2, s[12:15], s17 offen sc1 lds
    s_cmp_lg_u32 s60, 0
    s_cbranch_scc1 tl_63
    s_call_b64 s[76:77], SUB_w1_piece_25
    s_waitcnt vmcnt(16)
    s_branch tz_64
tl_63:
    s_waitcnt vmcnt(8)
tz_64:
    s_barrier
    s_add_u32 m0, s41, 0
    s_add_u32 s16, s39, s86
    s_add_u32 s17, s39, s87
    buffer_load_dwordx4 v2, s[12:15], s16 offen sc1 lds
    s_add_u32 m0, m0, 1024
    s_nop 0
    buffer_load_dwordx4 v2, s[12:15], s17 offen sc1 lds
    s_add_u32 m0, m0, 1024
    s_add_u32 s16, s16, 229376
    buffer_load_dwordx4 v2, s[12:15], s16 offen sc1 lds
    s_add_u32 m0, m0, 1024
    s_add_u32 s17, s17, 229376
    buffer_load_dwordx4 v2, s[12:15], s17 offen sc1 lds
    s_add_u32 m0, m0, 1024
    s_add_u32 s16, s39, s88
    s_add_u32 s17, s39, s89
    buffer_load_dwordx4 v2, s[12:15], s16 offen sc1 lds
    s_add_u32 m0, m0, 1024
    s_nop 0
    buffer_load_dwordx4 v2, s[12:15], s17 offen sc1 lds
    s_add_u32 m0, m0, 1024
    s_add_u32 s16, s16, 229376
    buffer_load_dwordx4 v2, s[12:15], s16 offen sc1 lds
    s_add_u32 m0, m0, 1024
    s_add_u32 s17, s17, 229376
    buffer_load_dwordx4 v2, s[12:15], s17 offen sc1 lds
    s_cmp_lg_u32 s60, 0
    s_cbranch_scc1 tl_65
    s_call_b64 s[76:77], SUB_w1_piece_26
    s_waitcnt vmcnt(18)
    s_branch tz_66
tl_65:
    s_waitcnt vmcnt(8)
tz_66:
    s_barrier
    s_cmp_lg_u32 s60, 0
    s_cbranch_scc1 tl_67
    s_call_b64 s[76:77], SUB_w1_piece_27
    s_waitcnt vmcnt(10)
    s_branch tz_68
tl_67:
    s_waitcnt vmcnt(0)
tz_68:
    s_barrier
    s_cmp_eq_u32 s60, 1
    s_cbranch_scc1 K_fin
    s_branch Y_END
WLOAD:
    s_mov_b64 s[12:13], s[72:73]
    s_mov_b32 s14, 7340032
    s_mov_b32 s15, 0x20000
    s_and_b32 s35, s30, 1
    s_mul_i32 s38, s29, 448
    s_mul_i32 s41, s35, 229376
    s_add_u32 s38, s38, s41
    s_mul_i32 s41, s35, 14336
    s_add_u32 s41, s41, 49152
    s_mov_b32 s42, 0
    s_mov_b32 s44, s29
    s_add_u32 s44, s44, 1
    s_and_b32 s44, s44, 15
    s_add_u32 s44, s44, 1
    s_and_b32 s44, s44, 15
    s_add_u32 s46, s29, 1
    s_and_b32 s46, s46, 15
    s_cmp_eq_u32 s28, s29
    s_cselect_b32 s47, s46, s28
    s_mov_b32 s42, 57344
    s_call_b64 s[76:77], PREP_w_issue_3
    s_mov_b32 m0, s19
    s_mov_b32 s39, s16
    s_waitcnt vmcnt(0)
    s_and_b32 s53, s30, 3
    s_lshl_b32 s53, s53, 7
    s_add_u32 s53, s53, s55
    s_add_u32 s53, s53, 0x400
    v_mov_b32 v14, 1
    v_mov_b32 v15, 0
    s_mov_b64 exec, 1
    buffer_atomic_add v14, v15, s[56:59], s53 offen sc1
    s_mov_b64 exec, -1
    s_call_b64 s[76:77], SUB_rest_2
    s_waitcnt lgkmcnt(0)
    buffer_load_dwordx4 v121, s[12:15], s39 offen  lds
    s_add_u32 m0, m0, 1024
    s_nop 0
    buffer_load_dwordx4 v122, s[12:15], s39 offen  lds
    s_add_u32 m0, m0, 1024
    s_nop 0
    buffer_load_dwordx4 v123, s[12:15], s39 offen  lds
    s_call_b64 s[76:77], PREP_w_issue_3
    s_add_u32 m0, m0, 1024
    s_nop 0
    buffer_load_dwordx4 v124, s[12:15], s39 offen  lds
    s_add_u32 m0, m0, 1024
    s_nop 0
    buffer_load_dwordx4 v125, s[12:15], s39 offen  lds
    s_add_u32 m0, m0, 1024
    s_nop 0
    buffer_load_dwordx4 v126, s[12:15], s39 offen  lds
    s_add_u32 m0, m0, 1024
    s_nop 0
    buffer_load_dwordx4 v127, s[12:15], s39 offen  lds
    s_add_u32 m0, m0, 1024
    s_add_u32 s39, s39, 114688
    buffer_load_dwordx4 v121, s[12:15], s39 offen  lds
    s_add_u32 m0, m0, 1024
    s_nop 0
    buffer_load_dwordx4 v122, s[12:15], s39 offen  lds
    s_add_u32 m0, m0, 1024
    s_nop 0
    buffer_load_dwordx4 v123, s[12:15], s39 offen  lds
    s_add_u32 m0, m0, 1024
    s_nop 0
    buffer_load_dwordx4 v124, s[12:15], s39 offen  lds
    s_add_u32 m0, m0, 1024
    s_nop 0
    buffer_load_dwordx4 v125, s[12:15], s39 offen  lds
    s_add_u32 m0, m0, 1024
    s_nop 0
    buffer_load_dwordx4 v126, s[12:15], s39 offen  lds
    s_add_u32 m0, m0, 1024
    s_nop 0
    buffer_load_dwordx4 v127, s[12:15], s39 offen  lds
    s_mov_b32 m0, s19
    s_mov_b32 s39, s16
    s_cmp_lg_u32 s60, 0
    s_cbranch_scc1 cs_69
    s_and_b32 s35, s30, 1
    v_lshrrev_b32 v112, 2, v1
    v_mul_u32_u24 v104, 448, v112
    v_and_b32 v113, 3, v1
    v_lshl_add_u32 v104, v113, 3, v104
    v_add_u32 v104, 49152, v104
    v_mul_u32_u24 v106, 448, v112
    v_and_b32 v113, 2, v1
    v_lshl_add_u32 v106, v113, 2, v106
    v_bfe_u32 v112, v1, 4, 1
    v_and_b32 v113, 1, v1
    v_xor_b32 v113, v113, v112
    v_lshl_add_u32 v106, v113, 5, v106
    s_lshl_b32 s36, s35, 4
    s_add_u32 s36, s36, 49344
    v_add_u32 v106, s36, v106
    s_lshl_b32 s36, s35, 8
    v_add_u32 v104, s36, v104
    v_lshlrev_b32 v112, 5, v112
    v_sub_u32 v105, v104, v112
    v_add_u32 v104, v104, v112
    s_cmp_eq_u32 s28, s29
    s_cselect_b32 s36, 0, 28672
    v_add_u32 v104, s36, v104
    v_add_u32 v105, s36, v105
    v_add_u32 v106, s36, v106
    ds_read_b64_tr_b16 v[48:49], v104 offset:0
    ds_read_b64_tr_b16 v[50:51], v104 offset:7168
    ds_read_b64_tr_b16 v[52:53], v104 offset:14336
    ds_read_b64_tr_b16 v[54:55], v104 offset:21504
    ds_read_b64_tr_b16 v[56:57], v105 offset:32
    ds_read_b64_tr_b16 v[58:59], v105 offset:7200
    ds_read_b64_tr_b16 v[60:61], v105 offset:14368
    ds_read_b64_tr_b16 v[62:63], v105 offset:21536
    ds_read_b64_tr_b16 v[64:65], v104 offset:64
    ds_read_b64_tr_b16 v[66:67], v104 offset:7232
    ds_read_b64_tr_b16 v[68:69], v104 offset:14400
    ds_read_b64_tr_b16 v[70:71], v104 offset:21568
    ds_read_b64_tr_b16 v[72:73], v105 offset:96
    ds_read_b64_tr_b16 v[74:75], v105 offset:7264
    ds_read_b64_tr_b16 v[76:77], v105 offset:14432
    ds_read_b64_tr_b16 v[78:79], v105 offset:21600
    ds_read_b64_tr_b16 v[80:81], v104 offset:128
    ds_read_b64_tr_b16 v[82:83], v104 offset:7296
    ds_read_b64_tr_b16 v[84:85], v104 offset:14464
    ds_read_b64_tr_b16 v[86:87], v104 offset:21632
    ds_read_b64_tr_b16 v[88:89], v105 offset:160
    ds_read_b64_tr_b16 v[90:91], v105 offset:7328
    ds_read_b64_tr_b16 v[92:93], v105 offset:14496
    ds_read_b64_tr_b16 v[94:95], v105 offset:21664
    ds_read_b64_tr_b16 v[96:97], v106 offset:0
    ds_read_b64_tr_b16 v[98:99], v106 offset:7168
    ds_read_b64_tr_b16 v[100:101], v106 offset:14336
    ds_read_b64_tr_b16 v[102:103], v106 offset:21504
    v_and_b32 v112, 15, v1
    v_mov_b32 v113, 0x3f803f80
    v_cmp_eq_u32 vcc, 0, v112
    s_nop 1
    v_cndmask_b32 v20, 0, v113, vcc
    v_cndmask_b32 v21, 0, v113, vcc
    v_cndmask_b32 v22, 0, v113, vcc
    v_cndmask_b32 v23, 0, v113, vcc
    v_cmp_eq_u32 vcc, 1, v112
    s_nop 1
    v_cndmask_b32 v24, 0, v113, vcc
    v_cndmask_b32 v25, 0, v113, vcc
    v_cndmask_b32 v26, 0, v113, vcc
    v_cndmask_b32 v27, 0, v113, vcc
    v_cmp_eq_u32 vcc, 2, v112
    s_nop 1
    v_cndmask_b32 v28, 0, v113, vcc
    v_cndmask_b32 v29, 0, v113, vcc
    v_cndmask_b32 v30, 0, v113, vcc
    v_cndmask_b32 v31, 0, v113, vcc
    v_cmp_eq_u32 vcc, 3, v112
    s_nop 1
    v_cndmask_b32 v32, 0, v113, vcc
    v_cndmask_b32 v33, 0, v113, vcc
    v_cndmask_b32 v34, 0, v113, vcc
    v_cndmask_b32 v35, 0, v113, vcc
    v_cmp_eq_u32 vcc, 4, v112
    s_nop 1
    v_cndmask_b32 v36, 0, v113, vcc
    v_cndmask_b32 v37, 0, v113, vcc
    v_cndmask_b32 v38, 0, v113, vcc
    v_cndmask_b32 v39, 0, v113, vcc
    v_cmp_eq_u32 vcc, 5, v112
    s_nop 1
    v_cndmask_b32 v40, 0, v113, vcc
    v_cndmask_b32 v41, 0, v113, vcc
    v_cndmask_b32 v42, 0, v113, vcc
    v_cndmask_b32 v43, 0, v113, vcc
    v_cmp_eq_u32 vcc, 6, v112
    s_nop 1
    v_cndmask_b32 v44, 0, v113, vcc
    v_cndmask_b32 v45, 0, v113, vcc
    v_cndmask_b32 v46, 0, v113, vcc
    v_cndmask_b32 v47, 0, v113, vcc
    v_and_b32 v114, 48, v1
    v_lshl_add_u32 v114, v112, 6, v114
    v_mov_b32 v113, 0x7f000000
    v_cmp_gt_u32 vcc, 7, v112
    s_nop 1
    v_cndmask_b32 v114, v113, v114, vcc
    s_add_u32 s20, s4, 0x1420000
    s_addc_u32 s21, s5, 0
    s_mov_b32 s22, 0x38000
    s_mov_b32 s23, 0x20000
    s_mul_i32 s36, s28, 14336
    s_lshl1_add_u32 s35, s29, s35
    s_mul_i32 s35, s35, 448
    s_add_u32 s35, s35, s36
    s_waitcnt lgkmcnt(0)
    v_mfma_f32_16x16x32_bf16 v[108:111], v[48:51], v[20:23], 0
    v_mfma_f32_16x16x32_bf16 v[108:111], v[52:55], v[20:23], v[108:111]
    v_mfma_f32_16x16x32_bf16 v[108:111], v[56:59], v[24:27], v[108:111]
    v_mfma_f32_16x16x32_bf16 v[108:111], v[60:63], v[24:27], v[108:111]
    v_mfma_f32_16x16x32_bf16 v[108:111], v[64:67], v[28:31], v[108:111]
    v_mfma_f32_16x16x32_bf16 v[108:111], v[68:71], v[28:31], v[108:111]
    v_mfma_f32_16x16x32_bf16 v[108:111], v[72:75], v[32:35], v[108:111]
    v_mfma_f32_16x16x32_bf16 v[108:111], v[76:79], v[32:35], v[108:111]
    v_mfma_f32_16x16x32_bf16 v[108:111], v[80:83], v[36:39], v[108:111]
    v_mfma_f32_16x16x32_bf16 v[108:111], v[84:87], v[36:39], v[108:111]
    v_mfma_f32_16x16x32_bf16 v[108:111], v[88:91], v[40:43], v[108:111]
    v_mfma_f32_16x16x32_bf16 v[108:111], v[92:95], v[40:43], v[108:111]
    v_mfma_f32_16x16x32_bf16 v[108:111], v[96:99], v[44:47], v[108:111]
    v_mfma_f32_16x16x32_bf16 v[108:111], v[100:103], v[44:47], v[108:111]
    s_nop 7
    buffer_store_dwordx4 v[108:111], v114, s[20:23], s35 offen sc1
cs_69:
    s_waitcnt vmcnt(15)
    s_barrier
    buffer_load_dwordx4 v121, s[12:15], s39 offen  lds
    s_add_u32 m0, m0, 1024
    s_nop 0
    buffer_load_dwordx4 v122, s[12:15], s39 offen  lds
    s_add_u32 m0, m0, 1024
    s_nop 0
    buffer_load_dwordx4 v123, s[12:15], s39 offen  lds
    s_call_b64 s[76:77], PREP_w_issue_3
    s_add_u32 m0, m0, 1024
    s_nop 0
    buffer_load_dwordx4 v124, s[12:15], s39 offen  lds
    s_add_u32 m0, m0, 1024
    s_nop 0
    buffer_load_dwordx4 v125, s[12:15], s39 offen  lds
    s_add_u32 m0, m0, 1024
    s_nop 0
    buffer_load_dwordx4 v126, s[12:15], s39 offen  lds
    s_add_u32 m0, m0, 1024
    s_nop 0
    buffer_load_dwordx4 v127, s[12:15], s39 offen  lds
    s_add_u32 m0, m0, 1024
    s_add_u32 s39, s39, 114688
    buffer_load_dwordx4 v121, s[12:15], s39 offen  lds
    s_add_u32 m0, m0, 1024
    s_nop 0
    buffer_load_dwordx4 v122, s[12:15], s39 offen  lds
    s_add_u32 m0, m0, 1024
    s_nop 0
    buffer_load_dwordx4 v123, s[12:15], s39 offen  lds
    s_add_u32 m0, m0, 1024
    s_nop 0
    buffer_load_dwordx4 v124, s[12:15], s39 offen  lds
    s_add_u32 m0, m0, 1024
    s_nop 0
    buffer_load_dwordx4 v125, s[12:15], s39 offen  lds
    s_add_u32 m0, m0, 1024
    s_nop 0
    buffer_load_dwordx4 v126, s[12:15], s39 offen  lds
    s_add_u32 m0, m0, 1024
    s_nop 0
    buffer_load_dwordx4 v127, s[12:15], s39 offen  lds
    s_mov_b32 m0, s19
    s_mov_b32 s39, s16
    s_waitcnt vmcnt(14)
    s_barrier
    buffer_load_dwordx4 v121, s[12:15], s39 offen  lds
    s_add_u32 m0, m0, 1024
    s_nop 0
    buffer_load_dwordx4 v122, s[12:15], s39 offen  lds
    s_add_u32 m0, m0, 1024
    s_nop 0
    buffer_load_dwordx4 v123, s[12:15], s39 offen  lds
    s_call_b64 s[76:77], PREP_w_issue_3
    s_add_u32 m0, m0, 1024
    s_nop 0
    buffer_load_dwordx4 v124, s[12:15], s39 offen  lds
    s_add_u32 m0, m0, 1024
    s_nop 0
    buffer_load_dwordx4 v125, s[12:15], s39 offen  lds
    s_add_u32 m0, m0, 1024
    s_nop 0
    buffer_load_dwordx4 v126, s[12:15], s39 offen  lds
    s_add_u32 m0, m0, 1024
    s_nop 0
    buffer_load_dwordx4 v127, s[12:15], s39 offen  lds
    s_add_u32 m0, m0, 1024
    s_add_u32 s39, s39, 114688
    buffer_load_dwordx4 v121, s[12:15], s39 offen  lds
    s_add_u32 m0, m0, 1024
    s_nop 0
    buffer_load_dwordx4 v122, s[12:15], s39 offen  lds
    s_add_u32 m0, m0, 1024
    s_nop 0
    buffer_load_dwordx4 v123, s[12:15], s39 offen  lds
    s_add_u32 m0, m0, 1024
    s_nop 0
    buffer_load_dwordx4 v124, s[12:15], s39 offen  lds
    s_add_u32 m0, m0, 1024
    s_nop 0
    buffer_load_dwordx4 v125, s[12:15], s39 offen  lds
    s_add_u32 m0, m0, 1024
    s_nop 0
    buffer_load_dwordx4 v126, s[12:15], s39 offen  lds
    s_add_u32 m0, m0, 1024
    s_nop 0
    buffer_load_dwordx4 v127, s[12:15], s39 offen  lds
    s_mov_b32 m0, s19
    s_mov_b32 s39, s16
    s_waitcnt vmcnt(14)
    s_barrier
    buffer_load_dwordx4 v121, s[12:15], s39 offen  lds
    s_add_u32 m0, m0, 1024
    s_nop 0
    buffer_load_dwordx4 v122, s[12:15], s39 offen  lds
    s_add_u32 m0, m0, 1024
    s_nop 0
    buffer_load_dwordx4 v123, s[12:15], s39 offen  lds
    s_call_b64 s[76:77], PREP_w_issue_3
    s_add_u32 m0, m0, 1024
    s_nop 0
    buffer_load_dwordx4 v124, s[12:15], s39 offen  lds
    s_add_u32 m0, m0, 1024
    s_nop 0
    buffer_load_dwordx4 v125, s[12:15], s39 offen  lds
    s_add_u32 m0, m0, 1024
    s_nop 0
    buffer_load_dwordx4 v126, s[12:15], s39 offen  lds
    s_add_u32 m0, m0, 1024
    s_nop 0
    buffer_load_dwordx4 v127, s[12:15], s39 offen  lds
    s_add_u32 m0, m0, 1024
    s_add_u32 s39, s39, 114688
    buffer_load_dwordx4 v121, s[12:15], s39 offen  lds
    s_add_u32 m0, m0, 1024
    s_nop 0
    buffer_load_dwordx4 v122, s[12:15], s39 offen  lds
    s_add_u32 m0, m0, 1024
    s_nop 0
    buffer_load_dwordx4 v123, s[12:15], s39 offen  lds
    s_add_u32 m0, m0, 1024
    s_nop 0
    buffer_load_dwordx4 v124, s[12:15], s39 offen  lds
    s_add_u32 m0, m0, 1024
    s_nop 0
    buffer_load_dwordx4 v125, s[12:15], s39 offen  lds
    s_add_u32 m0, m0, 1024
    s_nop 0
    buffer_load_dwordx4 v126, s[12:15], s39 offen  lds
    s_add_u32 m0, m0, 1024
    s_nop 0
    buffer_load_dwordx4 v127, s[12:15], s39 offen  lds
    s_mov_b32 m0, s19
    s_mov_b32 s39, s16
    s_waitcnt vmcnt(28)
    s_cmp_lg_u32 s60, 0
    s_cbranch_scc1 cs_70
    s_and_b32 s36, s30, 1
    s_lshl_b32 s36, s36, 13
    s_lshl_b32 s53, s29, 7
    s_add_u32 s36, s36, s53
    s_add_u32 s36, s36, 23068672
    v_mov_b32 v14, 1
    v_mov_b32 v15, 0
    s_mov_b64 exec, 1
    buffer_atomic_add v14, v15, s[56:59], s36 offen sc1
    s_mov_b64 exec, -1
cs_70:
    s_waitcnt vmcnt(14)
    s_barrier
    buffer_load_dwordx4 v121, s[12:15], s39 offen  lds
    s_add_u32 m0, m0, 1024
    s_nop 0
    buffer_load_dwordx4 v122, s[12:15], s39 offen  lds
    s_add_u32 m0, m0, 1024
    s_nop 0
    buffer_load_dwordx4 v123, s[12:15], s39 offen  lds
    s_mov_b32 s43, 1
ld_71:
    s_add_u32 s19, s41, s42
    s_cmp_eq_u32 s44, s47
    s_cselect_b32 s16, s46, s44
    s_mul_i32 s16, s16, 458752
    s_add_u32 s16, s16, s38
    s_add_u32 s44, s44, 1
    s_and_b32 s44, s44, 15
    s_add_u32 s42, s42, 28672
    s_cmp_eq_u32 s42, 86016
    s_cselect_b32 s42, 0, s42
    s_add_u32 m0, m0, 1024
    s_nop 0
    buffer_load_dwordx4 v124, s[12:15], s39 offen  lds
    s_add_u32 m0, m0, 1024
    s_nop 0
    buffer_load_dwordx4 v125, s[12:15], s39 offen  lds
    s_add_u32 m0, m0, 1024
    s_nop 0
    buffer_load_dwordx4 v126, s[12:15], s39 offen  lds
    s_add_u32 m0, m0, 1024
    s_nop 0
    buffer_load_dwordx4 v127, s[12:15], s39 offen  lds
    s_add_u32 m0, m0, 1024
    s_add_u32 s39, s39, 114688
    buffer_load_dwordx4 v121, s[12:15], s39 offen  lds
    s_add_u32 m0, m0, 1024
    s_nop 0
    buffer_load_dwordx4 v122, s[12:15], s39 offen  lds
    s_add_u32 m0, m0, 1024
    s_nop 0
    buffer_load_dwordx4 v123, s[12:15], s39 offen  lds
    s_add_u32 m0, m0, 1024
    s_nop 0
    buffer_load_dwordx4 v124, s[12:15], s39 offen  lds
    s_add_u32 m0, m0, 1024
    s_nop 0
    buffer_load_dwordx4 v125, s[12:15], s39 offen  lds
    s_add_u32 m0, m0, 1024
    s_nop 0
    buffer_load_dwordx4 v126, s[12:15], s39 offen  lds
    s_add_u32 m0, m0, 1024
    s_nop 0
    buffer_load_dwordx4 v127, s[12:15], s39 offen  lds
    s_mov_b32 m0, s19
    s_mov_b32 s39, s16
    s_waitcnt vmcnt(14)
    s_barrier
    buffer_load_dwordx4 v121, s[12:15], s39 offen  lds
    s_add_u32 m0, m0, 1024
    s_nop 0
    buffer_load_dwordx4 v122, s[12:15], s39 offen  lds
    s_add_u32 m0, m0, 1024
    s_nop 0
    buffer_load_dwordx4 v123, s[12:15], s39 offen  lds
    s_add_u32 s43, s43, 1
    s_cmp_lt_u32 s43, 9
    s_cbranch_scc1 ld_71
    s_call_b64 s[76:77], PREP_w_issue_3
    s_add_u32 m0, m0, 1024
    s_nop 0
    buffer_load_dwordx4 v124, s[12:15], s39 offen  lds
    s_add_u32 m0, m0, 1024
    s_nop 0
    buffer_load_dwordx4 v125, s[12:15], s39 offen  lds
    s_add_u32 m0, m0, 1024
    s_nop 0
    buffer_load_dwordx4 v126, s[12:15], s39 offen  lds
    s_add_u32 m0, m0, 1024
    s_nop 0
    buffer_load_dwordx4 v127, s[12:15], s39 offen  lds
    s_add_u32 m0, m0, 1024
    s_add_u32 s39, s39, 114688
    buffer_load_dwordx4 v121, s[12:15], s39 offen  lds
    s_add_u32 m0, m0, 1024
    s_nop 0
    buffer_load_dwordx4 v122, s[12:15], s39 offen  lds
    s_add_u32 m0, m0, 1024
    s_nop 0
    buffer_load_dwordx4 v123, s[12:15], s39 offen  lds
    s_add_u32 m0, m0, 1024
    s_nop 0
    buffer_load_dwordx4 v124, s[12:15], s39 offen  lds
    s_add_u32 m0, m0, 1024
    s_nop 0
    buffer_load_dwordx4 v125, s[12:15], s39 offen  lds
    s_add_u32 m0, m0, 1024
    s_nop 0
    buffer_load_dwordx4 v126, s[12:15], s39 offen  lds
    s_add_u32 m0, m0, 1024
    s_nop 0
    buffer_load_dwordx4 v127, s[12:15], s39 offen  lds
    s_mov_b32 m0, s19
    s_mov_b32 s39, s16
    s_waitcnt vmcnt(14)
    s_barrier
    buffer_load_dwordx4 v121, s[12:15], s39 offen  lds
    s_add_u32 m0, m0, 1024
    s_nop 0
    buffer_load_dwordx4 v122, s[12:15], s39 offen  lds
    s_add_u32 m0, m0, 1024
    s_nop 0
    buffer_load_dwordx4 v123, s[12:15], s39 offen  lds
    s_add_u32 m0, m0, 1024
    s_nop 0
    buffer_load_dwordx4 v124, s[12:15], s39 offen  lds
    s_add_u32 m0, m0, 1024
    s_nop 0
    buffer_load_dwordx4 v125, s[12:15], s39 offen  lds
    s_add_u32 m0, m0, 1024
    s_nop 0
    buffer_load_dwordx4 v126, s[12:15], s39 offen  lds
    s_add_u32 m0, m0, 1024
    s_nop 0
    buffer_load_dwordx4 v127, s[12:15], s39 offen  lds
    s_add_u32 m0, m0, 1024
    s_add_u32 s39, s39, 114688
    buffer_load_dwordx4 v121, s[12:15], s39 offen  lds
    s_add_u32 m0, m0, 1024
    s_nop 0
    buffer_load_dwordx4 v122, s[12:15], s39 offen  lds
    s_add_u32 m0, m0, 1024
    s_nop 0
    buffer_load_dwordx4 v123, s[12:15], s39 offen  lds
    s_add_u32 m0, m0, 1024
    s_nop 0
    buffer_load_dwordx4 v124, s[12:15], s39 offen  lds
    s_add_u32 m0, m0, 1024
    s_nop 0
    buffer_load_dwordx4 v125, s[12:15], s39 offen  lds
    s_add_u32 m0, m0, 1024
    s_nop 0
    buffer_load_dwordx4 v126, s[12:15], s39 offen  lds
    s_add_u32 m0, m0, 1024
    s_nop 0
    buffer_load_dwordx4 v127, s[12:15], s39 offen  lds
    s_waitcnt vmcnt(14)
    s_barrier
    s_waitcnt vmcnt(0)
    s_barrier
    s_barrier
    s_mov_b64 s[12:13], s[74:75]
    s_mov_b32 s14, 7340032
    s_mov_b32 s15, 0x20000
    s_and_b32 s35, s30, 1
    s_mul_i32 s38, s33, 256
    s_mul_i32 s41, s31, 3670016
    s_add_u32 s38, s38, s41
    s_mul_i32 s41, s35, 8192
    s_add_u32 s41, s41, 49152
    s_mov_b32 s42, 0
    s_mov_b32 s44, 0
    s_mov_b32 s49, s44
    s_and_b32 s43, s28, 0
    s_mul_i32 s43, s43, 6
    s_lshr_b32 s43, s43, 2
    s_mov_b32 s50, 0
wpre_72:
    s_mul_i32 s42, s43, 16384
    s_add_u32 s44, s49, s43
    s_add_u32 s19, s41, s42
    s_and_b32 s40, s30, 1
    s_lshl_b32 s45, s44, 1
    s_add_u32 s45, s45, s40
    s_sub_u32 s45, s45, 32
    s_mul_i32 s46, s45, 86
    s_lshr_b32 s46, s46, 8
    s_mul_i32 s47, s46, 3
    s_sub_u32 s47, s45, s47
    s_lshl_b32 s47, s47, 2
    s_lshr_b32 s47, 0x362, s47
    s_and_b32 s47, s47, 7
    s_cmp_ge_u32 s44, 10
    s_cselect_b32 s45, 9, 2
    s_cselect_b32 s51, 1, 0
    s_sub_u32 s45, s44, s45
    s_cmp_lt_u32 s44, 3
    s_cselect_b32 s45, 0, s45
    s_cselect_b32 s51, s44, s51
    s_lshl2_add_u32 s51, s40, s51
    s_cmp_lt_u32 s44, 17
    s_cselect_b32 s47, s51, s47
    s_cselect_b32 s46, s45, s46
    s_add_u32 s46, s46, s33
    s_and_b32 s46, s46, 7
    s_mul_i32 s46, s46, 7
    s_add_u32 s16, s46, s47
    s_mul_i32 s16, s16, 65536
    s_add_u32 s16, s16, s38
    s_add_u32 s44, s44, 1
    s_add_u32 s42, s42, 16384
    s_cmp_eq_u32 s42, 98304
    s_cselect_b32 s42, 0, s42
    s_mov_b32 m0, s19
    s_mov_b32 s39, s16
    buffer_load_dwordx4 v119, s[12:15], s39 offen  lds
    s_add_u32 m0, m0, 1024
    s_add_u32 s39, s39, 8192
    buffer_load_dwordx4 v120, s[12:15], s39 offen  lds
    s_add_u32 m0, m0, 1024
    s_add_u32 s39, s39, 8192
    buffer_load_dwordx4 v119, s[12:15], s39 offen  lds
    s_add_u32 m0, m0, 1024
    s_add_u32 s39, s39, 8192
    buffer_load_dwordx4 v120, s[12:15], s39 offen  lds
    s_waitcnt vmcnt(8)
    s_add_u32 m0, m0, 1024
    s_add_u32 s39, s39, 8192
    buffer_load_dwordx4 v119, s[12:15], s39 offen  lds
    s_add_u32 m0, m0, 1024
    s_add_u32 s39, s39, 8192
    buffer_load_dwordx4 v120, s[12:15], s39 offen  lds
    s_add_u32 m0, m0, 1024
    s_add_u32 s39, s39, 8192
    buffer_load_dwordx4 v119, s[12:15], s39 offen  lds
    s_add_u32 m0, m0, 1024
    s_add_u32 s39, s39, 8192
    buffer_load_dwordx4 v120, s[12:15], s39 offen  lds
    s_waitcnt vmcnt(8)
    s_add_u32 s43, s43, 1
    s_cmp_eq_u32 s43, 6
    s_cselect_b32 s43, 0, s43
    s_add_u32 s50, s50, 1
    s_cmp_lt_u32 s50, 6
    s_cbranch_scc1 wpre_72
    s_mov_b32 s42, 0
    s_add_u32 s44, s49, 6
    s_mov_b64 s[8:9], s[68:69]
    s_mov_b32 s10, 2097152
    s_mov_b32 s11, 0x20000
    s_and_b32 s3, s30, 3
    s_lshl_b32 s36, s3, 14
    s_lshl_b32 s90, s29, 7
    s_add_u32 s90, s90, s36
    s_xor_b32 s90, s90, 128
    s_lshl_b32 s3, s3, 10
    s_call_b64 s[76:77], PREP_w_issue_4
    s_mov_b32 m0, s19
    s_mov_b32 s39, s16
    s_waitcnt vmcnt(40)
    s_barrier
    s_waitcnt vmcnt(32)
    s_barrier
    buffer_load_dwordx4 v119, s[12:15], s39 offen  lds
    s_add_u32 m0, m0, 1024
    s_add_u32 s39, s39, 8192
    buffer_load_dwordx4 v120, s[12:15], s39 offen  lds
    s_mov_b32 s43, 1
ld_73:
    s_add_u32 s19, s41, s42
    s_and_b32 s40, s30, 1
    s_lshl_b32 s45, s44, 1
    s_add_u32 s45, s45, s40
    s_sub_u32 s45, s45, 32
    s_mul_i32 s46, s45, 86
    s_lshr_b32 s46, s46, 8
    s_mul_i32 s47, s46, 3
    s_sub_u32 s47, s45, s47
    s_lshl_b32 s47, s47, 2
    s_lshr_b32 s47, 0x362, s47
    s_and_b32 s47, s47, 7
    s_cmp_ge_u32 s44, 10
    s_cselect_b32 s45, 9, 2
    s_cselect_b32 s51, 1, 0
    s_sub_u32 s45, s44, s45
    s_cmp_lt_u32 s44, 3
    s_cselect_b32 s45, 0, s45
    s_cselect_b32 s51, s44, s51
    s_lshl2_add_u32 s51, s40, s51
    s_cmp_lt_u32 s44, 17
    s_cselect_b32 s47, s51, s47
    s_cselect_b32 s46, s45, s46
    s_add_u32 s46, s46, s33
    s_and_b32 s46, s46, 7
    s_mul_i32 s46, s46, 7
    s_add_u32 s16, s46, s47
    s_mul_i32 s16, s16, 65536
    s_add_u32 s16, s16, s38
    s_add_u32 s44, s44, 1
    s_add_u32 s42, s42, 16384
    s_cmp_eq_u32 s42, 98304
    s_cselect_b32 s42, 0, s42
    s_add_u32 m0, m0, 1024
    s_add_u32 s39, s39, 8192
    buffer_load_dwordx4 v119, s[12:15], s39 offen  lds
    s_add_u32 m0, m0, 1024
    s_add_u32 s39, s39, 8192
    buffer_load_dwordx4 v120, s[12:15], s39 offen  lds
    s_add_u32 m0, m0, 1024
    s_add_u32 s39, s39, 8192
    buffer_load_dwordx4 v119, s[12:15], s39 offen  lds
    s_add_u32 m0, m0, 1024
    s_add_u32 s39, s39, 8192
    buffer_load_dwordx4 v120, s[12:15], s39 offen  lds
    s_add_u32 m0, m0, 1024
    s_add_u32 s39, s39, 8192
    buffer_load_dwordx4 v119, s[12:15], s39 offen  lds
    s_add_u32 m0, m0, 1024
    s_add_u32 s39, s39, 8192
    buffer_load_dwordx4 v120, s[12:15], s39 offen  lds
    s_mov_b32 m0, s19
    s_mov_b32 s39, s16
    s_waitcnt vmcnt(32)
    s_barrier
    buffer_load_dwordx4 v119, s[12:15], s39 offen  lds
    s_add_u32 m0, m0, 1024
    s_add_u32 s39, s39, 8192
    buffer_load_dwordx4 v120, s[12:15], s39 offen  lds
    s_add_u32 s43, s43, 1
    s_cmp_lt_u32 s43, 20
    s_cbranch_scc1 ld_73
    s_call_b64 s[76:77], PREP_w_issue_4
    s_add_u32 m0, m0, 1024
    s_add_u32 s39, s39, 8192
    buffer_load_dwordx4 v119, s[12:15], s39 offen  lds
    s_add_u32 m0, m0, 1024
    s_add_u32 s39, s39, 8192
    buffer_load_dwordx4 v120, s[12:15], s39 offen  lds
    s_add_u32 m0, m0, 1024
    s_add_u32 s39, s39, 8192
    buffer_load_dwordx4 v119, s[12:15], s39 offen  lds
    s_add_u32 m0, m0, 1024
    s_add_u32 s39, s39, 8192
    buffer_load_dwordx4 v120, s[12:15], s39 offen  lds
    s_add_u32 m0, m0, 1024
    s_add_u32 s39, s39, 8192
    buffer_load_dwordx4 v119, s[12:15], s39 offen  lds
    s_add_u32 m0, m0, 1024
    s_add_u32 s39, s39, 8192
    buffer_load_dwordx4 v120, s[12:15], s39 offen  lds
    s_mov_b32 m0, s19
    s_mov_b32 s39, s16
    s_waitcnt vmcnt(32)
    s_barrier
    buffer_load_dwordx4 v119, s[12:15], s39 offen  lds
    s_add_u32 m0, m0, 1024
    s_add_u32 s39, s39, 8192
    buffer_load_dwordx4 v120, s[12:15], s39 offen  lds
    s_add_u32 m0, m0, 1024
    s_add_u32 s39, s39, 8192
    buffer_load_dwordx4 v119, s[12:15], s39 offen  lds
    s_add_u32 m0, m0, 1024
    s_add_u32 s39, s39, 8192
    buffer_load_dwordx4 v120, s[12:15], s39 offen  lds
    s_add_u32 m0, m0, 1024
    s_add_u32 s39, s39, 8192
    buffer_load_dwordx4 v119, s[12:15], s39 offen  lds
    s_add_u32 m0, m0, 1024
    s_add_u32 s39, s39, 8192
    buffer_load_dwordx4 v120, s[12:15], s39 offen  lds
    s_add_u32 m0, m0, 1024
    s_add_u32 s39, s39, 8192
    buffer_load_dwordx4 v119, s[12:15], s39 offen  lds
    s_add_u32 m0, m0, 1024
    s_add_u32 s39, s39, 8192
    buffer_load_dwordx4 v120, s[12:15], s39 offen  lds
    s_call_b64 s[76:77], PREP_w_issue_4
    s_mov_b32 m0, s19
    s_mov_b32 s39, s16
    s_waitcnt vmcnt(24)
    s_barrier
    buffer_load_dwordx4 v119, s[12:15], s39 offen  lds
    s_add_u32 m0, m0, 1024
    s_add_u32 s39, s39, 8192
    buffer_load_dwordx4 v120, s[12:15], s39 offen  lds
    s_add_u32 m0, m0, 1024
    s_add_u32 s39, s39, 8192
    buffer_load_dwordx4 v119, s[12:15], s39 offen  lds
    s_add_u32 m0, m0, 1024
    s_add_u32 s39, s39, 8192
    buffer_load_dwordx4 v120, s[12:15], s39 offen  lds
    s_add_u32 m0, m0, 1024
    s_add_u32 s39, s39, 8192
    buffer_load_dwordx4 v119, s[12:15], s39 offen  lds
    s_add_u32 m0, m0, 1024
    s_add_u32 s39, s39, 8192
    buffer_load_dwordx4 v120, s[12:15], s39 offen  lds
    s_add_u32 m0, m0, 1024
    s_add_u32 s39, s39, 8192
    buffer_load_dwordx4 v119, s[12:15], s39 offen  lds
    s_add_u32 m0, m0, 1024
    s_add_u32 s39, s39, 8192
    buffer_load_dwordx4 v120, s[12:15], s39 offen  lds
    s_cmp_lg_u32 s60, 0
    s_cbranch_scc1 tl_74
    s_call_b64 s[76:77], SUB_w1_piece_23
    s_waitcnt vmcnt(18)
    s_branch tz_75
tl_74:
    s_waitcnt vmcnt(16)
tz_75:
    s_barrier
    s_cmp_lg_u32 s60, 0
    s_cbranch_scc1 tl_76
    s_call_b64 s[76:77], SUB_w1_piece_24
    s_waitcnt vmcnt(6)
    s_branch tz_77
tl_76:
    s_waitcnt vmcnt(0)
tz_77:
    s_barrier
    s_cmp_lg_u32 s60, 0
    s_cbranch_scc1 tl_78
    s_call_b64 s[76:77], SUB_w1_piece_25
tl_78:
tz_79:
    s_barrier
    s_cmp_lg_u32 s60, 0
    s_cbranch_scc1 tl_80
    s_call_b64 s[76:77], SUB_w1_piece_26
tl_80:
tz_81:
    s_barrier
    s_cmp_lg_u32 s60, 0
    s_cbranch_scc1 tl_82
    s_call_b64 s[76:77], SUB_w1_piece_27
tl_82:
tz_83:
    s_barrier
    s_cmp_eq_u32 s60, 1
    s_cbranch_scc1 K_fin
    s_branch Y_END
Y_END:
    v_and_b32 v81, 7, v0
    v_lshrrev_b32 v84, 6, v0
    v_lshlrev_b32 v84, 4, v84
    v_bfe_u32 v85, v0, 3, 3
    v_add_u32 v84, v84, v85
    s_lshr_b32 s78, s29, 1
    s_lshl_b32 s78, s78, 16
    s_and_b32 s79, s29, 1
    s_lshl_b32 s79, s79, 7
    s_add_u32 s78, s78, s79
    s_lshr_b32 s79, s30, 1
    s_lshl_b32 s79, s79, 13
    s_add_u32 s78, s78, s79
    v_lshlrev_b32 v78, 8, v84
    v_lshl_add_u32 v78, v81, 4, v78
    v_add_u32 v78, s78, v78
    s_lshl_b32 s78, s28, 7
    s_lshl_b32 s79, s29, 3
    s_add_u32 s78, s78, s79
    v_add_u32 v79, s78, v81
    v_lshlrev_b32 v80, 11, v79
    v_and_b32 v85, 3, v79
    v_lshrrev_b32 v82, 2, v79
    v_lshlrev_b32 v82, 14, v82
    v_lshl_add_u32 v82, v85, 11, v82
    v_lshl_add_u32 v82, v84, 4, v82
    v_lshrrev_b32 v85, 2, v84
    v_lshlrev_b32 v85, 3, v85
    v_and_b32 v84, 3, v84
    v_add_u32 v84, v84, v85
    v_lshl_add_u32 v80, v84, 3, v80
    v_lshlrev_b32 v79, 3, v79
    v_lshl_add_u32 v79, v84, 14, v79
    s_add_u32 s80, s4, 0x1800000
    s_addc_u32 s81, s5, 0
    s_mov_b32 s82, 0x400000
    s_mov_b32 s83, 0x20000
    s_mov_b32 s78, 0
    buffer_load_dwordx2 v[110:111], v79, s[80:83], s78 offen sc1
    s_mov_b32 s78, 65536
    buffer_load_dwordx2 v[112:113], v79, s[80:83], s78 offen sc1
    s_mov_b32 s78, 262144
    buffer_load_dwordx2 v[114:115], v79, s[80:83], s78 offen sc1
    s_mov_b32 s78, 327680
    buffer_load_dwordx2 v[116:117], v79, s[80:83], s78 offen sc1
    s_waitcnt vmcnt(10)
    s_barrier
    s_and_b32 s36, s30, 3
    s_lshl_b32 s36, s36, 10
    v_add_u32 v8, s36, v2
    v_add_u32 v9, 65536, v8
    v_add_u32 v10, 131072, v8
    ds_write_b128 v8, v[12:15] offset:49152
    ds_write_b128 v8, v[16:19] offset:53248
    ds_write_b128 v8, v[20:23] offset:57344
    ds_write_b128 v8, v[24:27] offset:61440
    ds_write_b128 v9, v[28:31] offset:0
    ds_write_b128 v9, v[32:35] offset:4096
    ds_write_b128 v9, v[36:39] offset:8192
    ds_write_b128 v9, v[40:43] offset:12288
    ds_write_b128 v10, v[44:47] offset:0
    ds_write_b128 v10, v[48:51] offset:4096
    ds_write_b128 v10, v[52:55] offset:8192
    ds_write_b128 v10, v[56:59] offset:12288
    ds_write_b128 v8, v[60:63] offset:24576
    ds_write_b128 v8, v[64:67] offset:28672
    s_waitcnt lgkmcnt(0)
NEXT:
    s_setprio 0
    s_add_u32 s60, s60, 1
    s_add_u32 s55, s55, 67108864
    s_add_u32 s62, s62, 67108864
    s_addc_u32 s63, s63, 0
    s_branch LAYER
K_fin:
    s_endpgm
PREP_a_issue_3:
    s_add_u32 s19, s41, s42
    s_cmp_eq_u32 s44, s47
    s_cselect_b32 s16, s46, s44
    s_cmp_eq_u32 s44, s46
    s_cselect_b32 s16, s47, s16
    s_lshr_b32 s45, s16, 2
    s_lshl_b32 s45, s45, 14
    s_and_b32 s16, s16, 3
    s_lshl_b32 s16, s16, 11
    s_add_u32 s16, s16, s45
    s_add_u32 s16, s16, s38
    s_add_u32 s44, s44, 1
    s_and_b32 s44, s44, 15
    s_add_u32 s42, s42, 16384
    s_cmp_eq_u32 s42, 49152
    s_cselect_b32 s42, 0, s42
    s_setpc_b64 s[76:77]
SUB_rest_2:
    v_lshlrev_b32 v108, 16, v20
    v_and_b32 v109, 0xffff0000, v20
    v_lshlrev_b32 v110, 16, v21
    v_and_b32 v111, 0xffff0000, v21
    v_lshlrev_b32 v112, 16, v22
    v_and_b32 v113, 0xffff0000, v22
    v_lshlrev_b32 v114, 16, v23
    v_and_b32 v115, 0xffff0000, v23
    v_pk_add_f32 v[24:25], v[108:109], v[110:111]
    v_pk_mul_f32 v[26:27], v[108:109], v[108:109]
    v_pk_fma_f32 v[26:27], v[110:111], v[110:111], v[26:27]
    v_pk_add_f32 v[24:25], v[24:25], v[112:113]
    v_pk_fma_f32 v[26:27], v[112:113], v[112:113], v[26:27]
    v_pk_add_f32 v[24:25], v[24:25], v[114:115]
    v_pk_fma_f32 v[26:27], v[114:115], v[114:115], v[26:27]
    v_add_f32 v100, v24, v25
    v_add_f32 v101, v26, v27
    v_lshlrev_b32 v108, 16, v28
    v_and_b32 v109, 0xffff0000, v28
    v_lshlrev_b32 v110, 16, v29
    v_and_b32 v111, 0xffff0000, v29
    v_lshlrev_b32 v112, 16, v30
    v_and_b32 v113, 0xffff0000, v30
    v_lshlrev_b32 v114, 16, v31
    v_and_b32 v115, 0xffff0000, v31
    v_pk_add_f32 v[32:33], v[108:109], v[110:111]
    v_pk_mul_f32 v[34:35], v[108:109], v[108:109]
    v_pk_fma_f32 v[34:35], v[110:111], v[110:111], v[34:35]
    v_pk_add_f32 v[32:33], v[32:33], v[112:113]
    v_pk_fma_f32 v[34:35], v[112:113], v[112:113], v[34:35]
    v_pk_add_f32 v[32:33], v[32:33], v[114:115]
    v_pk_fma_f32 v[34:35], v[114:115], v[114:115], v[34:35]
    v_add_f32 v102, v32, v33
    v_add_f32 v103, v34, v35
    v_lshlrev_b32 v108, 16, v36
    v_and_b32 v109, 0xffff0000, v36
    v_lshlrev_b32 v110, 16, v37
    v_and_b32 v111, 0xffff0000, v37
    v_lshlrev_b32 v112, 16, v38
    v_and_b32 v113, 0xffff0000, v38
    v_lshlrev_b32 v114, 16, v39
    v_and_b32 v115, 0xffff0000, v39
    v_pk_add_f32 v[40:41], v[108:109], v[110:111]
    v_pk_mul_f32 v[42:43], v[108:109], v[108:109]
    v_pk_fma_f32 v[42:43], v[110:111], v[110:111], v[42:43]
    v_pk_add_f32 v[40:41], v[40:41], v[112:113]
    v_pk_fma_f32 v[42:43], v[112:113], v[112:113], v[42:43]
    v_pk_add_f32 v[40:41], v[40:41], v[114:115]
    v_pk_fma_f32 v[42:43], v[114:115], v[114:115], v[42:43]
    v_add_f32 v104, v40, v41
    v_add_f32 v105, v42, v43
    v_lshlrev_b32 v108, 16, v44
    v_and_b32 v109, 0xffff0000, v44
    v_lshlrev_b32 v110, 16, v45
    v_and_b32 v111, 0xffff0000, v45
    v_lshlrev_b32 v112, 16, v46
    v_and_b32 v113, 0xffff0000, v46
    v_lshlrev_b32 v114, 16, v47
    v_and_b32 v115, 0xffff0000, v47
    v_pk_add_f32 v[48:49], v[108:109], v[110:111]
    v_pk_mul_f32 v[50:51], v[108:109], v[108:109]
    v_pk_fma_f32 v[50:51], v[110:111], v[110:111], v[50:51]
    v_pk_add_f32 v[48:49], v[48:49], v[112:113]
    v_pk_fma_f32 v[50:51], v[112:113], v[112:113], v[50:51]
    v_pk_add_f32 v[48:49], v[48:49], v[114:115]
    v_pk_fma_f32 v[50:51], v[114:115], v[114:115], v[50:51]
    v_add_f32 v106, v48, v49
    v_add_f32 v107, v50, v51
    s_and_b32 s36, s30, 3
    s_lshl_b32 s36, s36, 10
    s_add_u32 s36, s36, 155648
    v_lshlrev_b32 v6, 3, v1
    v_add_u32 v6, s36, v6
    v_permlane32_swap_b32 v100, v102
    v_permlane32_swap_b32 v104, v106
    v_permlane32_swap_b32 v101, v103
    v_permlane32_swap_b32 v105, v107
    v_pk_add_f32 v[100:101], v[100:101], v[102:103]
    v_pk_add_f32 v[104:105], v[104:105], v[106:107]
    ds_write_b64 v6, v[100:101] offset:0
    ds_write_b64 v6, v[104:105] offset:512
    s_setpc_b64 s[76:77]
PREP_a_issue_4:
    s_add_u32 s19, s41, s42
    s_lshl_b32 s45, s44, 1
    s_add_u32 s45, s45, 0
    s_sub_u32 s45, s45, 32
    s_mul_i32 s46, s45, 86
    s_lshr_b32 s46, s46, 8
    s_mul_i32 s47, s46, 3
    s_sub_u32 s47, s45, s47
    s_lshl_b32 s47, s47, 2
    s_lshr_b32 s47, 0x362, s47
    s_and_b32 s47, s47, 7
    s_cmp_ge_u32 s44, 10
    s_cselect_b32 s45, 9, 2
    s_cselect_b32 s51, 1, 0
    s_sub_u32 s45, s44, s45
    s_cmp_lt_u32 s44, 3
    s_cselect_b32 s45, 0, s45
    s_cselect_b32 s51, s44, s51
    s_lshl2_add_u32 s51, 0, s51
    s_cmp_lt_u32 s44, 17
    s_cselect_b32 s47, s51, s47
    s_cselect_b32 s46, s45, s46
    s_add_u32 s46, s46, s33
    s_and_b32 s46, s46, 7
    s_mul_i32 s46, s46, 7
    s_add_u32 s16, s46, s47
    s_lshr_b32 s53, s16, 3
    s_lshl_b32 s53, s53, 14
    s_and_b32 s16, s16, 7
    s_lshl_b32 s16, s16, 10
    s_add_u32 s16, s16, s53
    s_add_u32 s16, s16, s38
    s_lshl_b32 s45, s44, 1
    s_add_u32 s45, s45, 1
    s_sub_u32 s45, s45, 32
    s_mul_i32 s46, s45, 86
    s_lshr_b32 s46, s46, 8
    s_mul_i32 s47, s46, 3
    s_sub_u32 s47, s45, s47
    s_lshl_b32 s47, s47, 2
    s_lshr_b32 s47, 0x362, s47
    s_and_b32 s47, s47, 7
    s_cmp_ge_u32 s44, 10
    s_cselect_b32 s45, 9, 2
    s_cselect_b32 s51, 1, 0
    s_sub_u32 s45, s44, s45
    s_cmp_lt_u32 s44, 3
    s_cselect_b32 s45, 0, s45
    s_cselect_b32 s51, s44, s51
    s_lshl2_add_u32 s51, 1, s51
    s_cmp_lt_u32 s44, 17
    s_cselect_b32 s47, s51, s47
    s_cselect_b32 s46, s45, s46
    s_add_u32 s46, s46, s33
    s_and_b32 s46, s46, 7
    s_mul_i32 s46, s46, 7
    s_add_u32 s17, s46, s47
    s_lshr_b32 s53, s17, 3
    s_lshl_b32 s53, s53, 14
    s_and_b32 s17, s17, 7
    s_lshl_b32 s17, s17, 10
    s_add_u32 s17, s17, s53
    s_add_u32 s17, s17, s38
    s_add_u32 s44, s44, 1
    s_add_u32 s42, s42, 16384
    s_cmp_eq_u32 s42, 49152
    s_cselect_b32 s42, 0, s42
    s_setpc_b64 s[76:77]
SUB_w1_piece_23:
    s_add_u32 s36, s90, 393216
    buffer_load_dwordx4 v[12:15], v118, s[8:11], s36 offen
    s_add_u32 s36, s36, 65536
    buffer_load_dwordx4 v[16:19], v118, s[8:11], s36 offen
    s_setpc_b64 s[76:77]
SUB_w1_piece_24:
    s_add_u32 s36, s90, 524288
    buffer_load_dwordx4 v[20:23], v118, s[8:11], s36 offen
    s_add_u32 s36, s36, 65536
    buffer_load_dwordx4 v[24:27], v118, s[8:11], s36 offen
    s_add_u32 s36, s90, 655360
    buffer_load_dwordx4 v[28:31], v118, s[8:11], s36 offen
    s_add_u32 s36, s36, 65536
    buffer_load_dwordx4 v[32:35], v118, s[8:11], s36 offen
    s_setpc_b64 s[76:77]
SUB_w1_piece_25:
    s_add_u32 s36, s90, 786432
    buffer_load_dwordx4 v[36:39], v118, s[8:11], s36 offen
    s_add_u32 s36, s36, 65536
    buffer_load_dwordx4 v[40:43], v118, s[8:11], s36 offen
    s_add_u32 s36, s90, 1703936
    buffer_load_dwordx4 v[44:47], v118, s[8:11], s36 offen
    s_add_u32 s36, s36, 65536
    buffer_load_dwordx4 v[48:51], v118, s[8:11], s36 offen
    s_setpc_b64 s[76:77]
SUB_w1_piece_26:
    s_add_u32 s36, s90, 1835008
    buffer_load_dwordx4 v[52:55], v118, s[8:11], s36 offen
    s_add_u32 s36, s36, 65536
    buffer_load_dwordx4 v[56:59], v118, s[8:11], s36 offen
    s_add_u32 s36, s90, 0
    buffer_load_dwordx4 v[60:63], v118, s[8:11], s36 offen
    s_add_u32 s36, s36, 65536
    buffer_load_dwordx4 v[64:67], v118, s[8:11], s36 offen
    s_add_u32 s36, s90, 1966080
    s_add_u32 m0, s3, 147456
    s_nop 0
    buffer_load_dwordx4 v118, s[8:11], s36 offen lds
    s_add_u32 s36, s36, 65536
    s_add_u32 m0, s3, 151552
    s_nop 0
    buffer_load_dwordx4 v118, s[8:11], s36 offen lds
    s_setpc_b64 s[76:77]
SUB_w1_piece_27:
    s_add_u32 s36, s90, 1441792
    s_add_u32 m0, s3, 114688
    s_nop 0
    buffer_load_dwordx4 v118, s[8:11], s36 offen lds
    s_add_u32 s36, s36, 65536
    s_add_u32 m0, s3, 118784
    s_nop 0
    buffer_load_dwordx4 v118, s[8:11], s36 offen lds
    s_add_u32 s36, s90, 1572864
    s_add_u32 m0, s3, 122880
    s_nop 0
    buffer_load_dwordx4 v118, s[8:11], s36 offen lds
    s_add_u32 s36, s36, 65536
    s_add_u32 m0, s3, 126976
    s_nop 0
    buffer_load_dwordx4 v118, s[8:11], s36 offen lds
    s_setpc_b64 s[76:77]
PREP_w_issue_3:
    s_add_u32 s19, s41, s42
    s_cmp_eq_u32 s44, s47
    s_cselect_b32 s16, s46, s44
    s_mul_i32 s16, s16, 458752
    s_add_u32 s16, s16, s38
    s_add_u32 s44, s44, 1
    s_and_b32 s44, s44, 15
    s_add_u32 s42, s42, 28672
    s_cmp_eq_u32 s42, 86016
    s_cselect_b32 s42, 0, s42
    s_setpc_b64 s[76:77]
PREP_w_issue_4:
    s_add_u32 s19, s41, s42
    s_and_b32 s40, s30, 1
    s_lshl_b32 s45, s44, 1
    s_add_u32 s45, s45, s40
    s_sub_u32 s45, s45, 32
    s_mul_i32 s46, s45, 86
    s_lshr_b32 s46, s46, 8
    s_mul_i32 s47, s46, 3
    s_sub_u32 s47, s45, s47
    s_lshl_b32 s47, s47, 2
    s_lshr_b32 s47, 0x362, s47
    s_and_b32 s47, s47, 7
    s_cmp_ge_u32 s44, 10
    s_cselect_b32 s45, 9, 2
    s_cselect_b32 s51, 1, 0
    s_sub_u32 s45, s44, s45
    s_cmp_lt_u32 s44, 3
    s_cselect_b32 s45, 0, s45
    s_cselect_b32 s51, s44, s51
    s_lshl2_add_u32 s51, s40, s51
    s_cmp_lt_u32 s44, 17
    s_cselect_b32 s47, s51, s47
    s_cselect_b32 s46, s45, s46
    s_add_u32 s46, s46, s33
    s_and_b32 s46, s46, 7
    s_mul_i32 s46, s46, 7
    s_add_u32 s16, s46, s47
    s_mul_i32 s16, s16, 65536
    s_add_u32 s16, s16, s38
    s_add_u32 s44, s44, 1
    s_add_u32 s42, s42, 16384
    s_cmp_eq_u32 s42, 98304
    s_cselect_b32 s42, 0, s42
    s_setpc_b64 s[76:77]
K_end:
    s_endpgm
.section .rodata,"a"
.p2align 6
.amdhsa_kernel interleave_layers__ssm_conv_h3__mixer_s_mlp__prompt_kernel
  .amdhsa_next_free_vgpr 256
  .amdhsa_next_free_sgpr 102
  .amdhsa_accum_offset 256
  .amdhsa_group_segment_fixed_size 0
  .amdhsa_kernarg_size 112
  .amdhsa_user_sgpr_count 2
  .amdhsa_user_sgpr_kernarg_segment_ptr 1
  .amdhsa_system_sgpr_workgroup_id_x 1
  .amdhsa_float_denorm_mode_32 3
.end_amdhsa_kernel
```

```asm
; @launch grid=(256,1,1) block=(512,1,1) lds=163840
.amdgcn_target "amdgcn-amd-amdhsa--gfx950"
.text
.globl interleave_layers__ssm_conv_h3__mixer_s_mlp__prompt_kernel
.p2align 8
.type interleave_layers__ssm_conv_h3__mixer_s_mlp__prompt_kernel,@function
interleave_layers__ssm_conv_h3__mixer_s_mlp__prompt_kernel:
    s_cmp_ge_u32 s2, 256
    s_cbranch_scc1 K_end
    s_load_dwordx8 s[8:15], s[0:1], 8
    s_load_dwordx2 s[6:7], s[0:1], 0
    s_load_dwordx8 s[68:75], s[0:1], 56
    s_load_dwordx2 s[4:5], s[0:1], 104
    s_load_dwordx2 s[84:85], s[0:1], 96
    s_memrealtime s[46:47]
    s_load_dwordx2 s[76:77], s[0:1], 40
    v_lshrrev_b32 v1, 6, v0
    s_nop 0
    v_readfirstlane_b32 s30, v1
    s_getpc_b64 s[48:49]
K_pc:
    s_lshr_b32 s36, s2, 3
    s_lshl_b32 s36, s36, 12
    v_lshlrev_b32 v252, 3, v0
    v_add_u32 v252, s36, v252
    v_cmp_gt_u32 vcc, K_end-K_pc-8, v252
    s_nop 0
    s_and_saveexec_b64 s[36:37], vcc
    s_cbranch_execz K_3
    v_mov_b32 v253, s49
    v_add_co_u32 v252, vcc, s48, v252
    s_nop 1
    v_addc_co_u32 v253, vcc, 0, v253, vcc
    global_load_dword v250, v[252:253], off
K_3:
    s_mov_b64 exec, -1
    v_bfe_u32 v8, v0, 4, 2
    v_and_b32 v9, 15, v0
    v_lshlrev_b32 v6, 11, v8
    v_lshlrev_b32 v8, 1, v8
    v_xor_b32 v8, v8, v9
    v_lshl_add_u32 v8, v8, 4, v6
    s_and_b32 s34, s2, 7
    s_lshr_b32 s35, s2, 3
    s_lshl_b32 s36, s35, 17
    s_lshl_b32 s37, s34, 8
    s_add_u32 s36, s36, s37
    s_lshl_b32 s37, s30, 6
    s_and_b32 s38, s37, 128
    s_add_u32 s37, s37, 64
    s_and_b32 s37, s37, 128
    v_xor_b32 v6, s38, v8
    v_xor_b32 v7, s37, v8
    s_lshl_b32 s37, s30, 14
    s_add_u32 s37, s37, s36
    s_add_u32 s38, s37, 8192
    s_lshl_b32 s39, s30, 11
    s_mov_b32 s18, 4194304
    s_mov_b32 s19, 0x20000
    s_mov_b32 s22, s18
    s_mov_b32 s23, s19
    s_add_u32 m0, s39, 99328
    s_waitcnt lgkmcnt(0)
    s_mov_b64 s[16:17], s[8:9]
    s_mov_b64 s[20:21], s[10:11]
    buffer_load_dwordx4 v6, s[16:19], s37 offen nt lds
    s_add_u32 m0, m0, 1024
    s_nop 0
    buffer_load_dwordx4 v7, s[16:19], s38 offen nt lds
    s_add_u32 m0, s39, 115712
    s_nop 0
    buffer_load_dwordx4 v6, s[20:23], s37 offen nt lds
    s_add_u32 m0, m0, 1024
    s_nop 0
    buffer_load_dwordx4 v6, s[20:23], s38 offen nt lds
    s_mov_b32 s86, 256
    s_mov_b32 s87, 0x20000
    v_mov_b32 v10, 0
    s_cmp_lg_u32 s30, 0
    s_cbranch_scc1 KV_t0
    s_sub_u32 s36, s36, 8192
    v_add_u32 v8, s36, v8
    s_mov_b32 m0, 98304
    s_nop 0
    buffer_load_dwordx4 v8, s[16:19], 0 offen nt lds
    s_cmp_lg_u32 s2, 0
    s_cbranch_scc1 KV_t0
    s_lshl_b32 s44, s46, 6
    s_or_b32 s44, s44, 1
    v_mov_b32 v9, s44
    s_mov_b64 exec, 1
    buffer_store_dword v9, v10, s[84:87], 0 offen sc1
    s_mov_b64 exec, -1
KV_t0:
    s_lshl_b32 s37, s34, 10
    s_lshl_b32 s38, s30, 7
    s_add_u32 s37, s37, s38
    v_and_b32 v9, 15, v0
    v_lshlrev_b32 v9, 3, v9
    s_mov_b32 s24, s12
    s_mov_b32 s25, s13
    s_mov_b32 s26, 0x2000
    s_mov_b32 s27, 0x20000
    buffer_load_dwordx2 v[12:13], v9, s[24:27], s37 offen
    v_and_b32 v1, 63, v0
    v_lshlrev_b32 v2, 4, v1
    v_lshlrev_b32 v3, 2, v1
    s_and_b32 s32, s2, 7
    s_lshr_b32 s33, s2, 3
    s_and_b32 s28, s32, 2
    s_lshr_b32 s34, s32, 2
    s_or_b32 s28, s28, s34
    s_lshl_b32 s28, s28, 2
    s_and_b32 s34, s33, 3
    s_add_u32 s28, s28, s34
    s_and_b32 s31, s32, 1
    s_lshr_b32 s33, s33, 2
    s_lshl_b32 s29, s31, 3
    s_add_u32 s29, s29, s33
    s_mov_b32 s60, 0
    s_mov_b32 s61, 40000
    s_mov_b32 s52, 0
    s_mov_b32 s55, 0
    s_mov_b32 s92, 0
    s_mov_b32 s93, 0
    s_mov_b32 s94, 0
    s_mov_b32 s56, s4
    s_mov_b32 s57, s5
    s_mov_b32 s58, 0xa000000
    s_mov_b32 s59, 0x20000
    s_add_u32 s62, s4, 33554432
    s_addc_u32 s63, s5, 0
    s_cmp_lg_u32 s30, 4
    s_cbranch_scc1 HB_1
    v_add_u32 v14, 162816, v3
    ds_write_b32 v14, v10
HB_1:
    s_mov_b64 s[88:89], s[70:71]
    s_mov_b32 s90, 2097152
    s_mov_b32 s91, 0x20000
    s_lshl3_add_u32 s36, s2, s30
    s_lshl_b32 s36, s36, 10
    s_mov_b64 s[80:81], s[68:69]
    s_mov_b32 s82, 2097152
    s_mov_b32 s83, 0x20000
    s_mov_b32 s50, s36
    v_lshrrev_b32 v14, 3, v1
    v_lshlrev_b32 v118, 11, v14
    v_and_b32 v14, 6, v14
    v_and_b32 v15, 7, v1
    v_xor_b32 v14, v14, v15
    v_lshl_add_u32 v118, v14, 4, v118
    v_mov_b32 v119, 0
    v_mov_b32 v120, 0
    v_mov_b32 v121, 0
    v_mov_b32 v122, 0
    v_mov_b32 v123, 0
    v_mov_b32 v124, 0
    v_mov_b32 v125, 0
    v_mov_b32 v126, 0
    v_mov_b32 v127, 0
    s_lshl_b32 s48, s29, 7
    s_lshl_b32 s36, s30, 14
    s_add_u32 s48, s48, s36
    s_lshl_b32 s49, s30, 10
    s_add_u32 s48, s48, 1048576
    s_and_b32 s41, s30, 3
    s_and_b32 s38, s2, 7
    s_lshl_b32 s38, s38, 5
    s_lshr_b32 s39, s2, 3
    s_add_u32 s38, s38, s39
    s_lshl_b32 s39, s38, 2
    s_add_u32 s39, s39, s41
    s_mul_i32 s40, s41, 21504
    s_lshl_b32 s36, s39, 12
    s_add_u32 s12, s14, s36
    s_addc_u32 s13, s15, 0
    s_mov_b32 s14, 4096
    s_mov_b32 s15, 0x20000
    s_lshr_b32 s45, s30, 2
    s_lshl_b32 s45, s45, 11
    s_add_u32 s36, s45, 0xffffffc0
    v_add_u32 v22, s36, v2
    v_add_u32 v23, 16, v22
    s_add_u32 s36, s45, 0x3c0
    v_add_u32 v24, s36, v2
    v_add_u32 v25, 16, v24
    s_mov_b32 s36, 4032
    v_add_u32 v26, s36, v2
    v_add_u32 v27, 16, v26
    v_add_u32 v19, s40, v2
    v_add_u32 v20, s45, v19
    s_lshl_b32 s36, s38, 14
    s_add_u32 s36, s36, 25165824
    s_add_u32 s20, s4, s36
    s_addc_u32 s21, s5, 0
    s_mov_b32 s22, 16384
    s_mov_b32 s23, 0x20000
    s_lshl_b32 s36, s30, 6
    v_lshrrev_b32 v94, 2, v1
    v_and_b32 v97, 48, v2
    v_lshl_add_u32 v97, v94, 8, v97
    v_add_u32 v97, s36, v97
    s_lshr_b32 s36, s39, 1
    s_lshl_b32 s36, s36, 2
    s_load_dword s41, s[76:77], s36
    v_and_b32 v100, 15, v1
    v_lshrrev_b32 v101, 4, v1
    v_and_b32 v94, 3, v100
    v_mul_u32_u24 v98, 4160, v94
    v_lshl_add_u32 v98, v101, 4, v98
    v_lshrrev_b32 v94, 2, v100
    v_lshl_add_u32 v98, v94, 3, v98
    v_add_u32 v98, s40, v98
    v_sub_u32 v94, 15, v100
    v_lshlrev_b32 v99, 5, v94
    v_add_u32 v99, s40, v99
    v_lshl_add_u32 v99, v101, 4, v99
    s_lshr_b32 s36, s38, 2
    s_lshl_b32 s36, s36, 12
    s_add_u32 s36, s36, 23330816
    v_lshlrev_b32 v102, 7, v1
    v_add_u32 v102, s36, v102
    v_and_b32 v81, 7, v0
    v_lshrrev_b32 v84, 6, v0
    v_lshlrev_b32 v84, 4, v84
    v_bfe_u32 v85, v0, 3, 3
    v_add_u32 v84, v84, v85
    s_lshr_b32 s78, s29, 1
    s_lshl_b32 s78, s78, 16
    s_and_b32 s79, s29, 1
    s_lshl_b32 s79, s79, 7
    s_add_u32 s78, s78, s79
    s_lshr_b32 s79, s30, 1
    s_lshl_b32 s79, s79, 13
    s_add_u32 s78, s78, s79
    v_lshlrev_b32 v78, 8, v84
    v_lshl_add_u32 v78, v81, 4, v78
    v_add_u32 v78, s78, v78
    s_lshl_b32 s78, s28, 7
    s_lshl_b32 s79, s29, 3
    s_add_u32 s78, s78, s79
    v_add_u32 v79, s78, v81
    v_lshlrev_b32 v80, 11, v79
    v_and_b32 v85, 3, v79
    v_lshrrev_b32 v82, 2, v79
    v_lshlrev_b32 v82, 14, v82
    v_lshl_add_u32 v82, v85, 11, v82
    v_lshl_add_u32 v82, v84, 4, v82
    v_lshrrev_b32 v85, 2, v84
    v_lshlrev_b32 v85, 3, v85
    v_and_b32 v84, 3, v84
    v_add_u32 v84, v84, v85
    v_lshl_add_u32 v80, v84, 3, v80
    v_lshlrev_b32 v79, 3, v79
    v_lshl_add_u32 v79, v84, 14, v79
    s_mov_b32 s8, s6
    s_mov_b32 s9, s7
    s_mov_b32 s10, 0x400000
    s_mov_b32 s11, 0x20000
    v_mov_b32 v60, 0
    v_mov_b32 v61, 0
    v_mov_b32 v62, 0
    v_mov_b32 v63, 0
    s_bfm_b64 exec, 40, 0
    ds_write_b128 v19, v[60:63] offset:20736
    s_mov_b64 exec, -1
    s_and_b32 s34, s2, 7
    s_lshr_b32 s35, s2, 3
    v_bfe_u32 v14, v1, 2, 3
    v_xor_b32 v14, s30, v14
    v_lshlrev_b32 v16, 5, v14
    v_and_b32 v14, 3, v1
    v_lshl_add_u32 v16, v14, 3, v16
    v_bfe_u32 v14, v1, 2, 2
    v_lshl_add_u32 v16, v14, 8, v16
    v_lshrrev_b32 v14, 4, v1
    v_lshl_add_u32 v16, v14, 12, v16
    v_add_u32 v16, 98304, v16
    v_xor_b32 v17, 128, v16
    s_add_u32 s16, s4, 0x1800000
    s_addc_u32 s17, s5, 0
    s_mov_b32 s18, 0x400000
    s_mov_b32 s19, 0x20000
    v_bfe_u32 v18, v1, 2, 2
    v_lshlrev_b32 v18, 14, v18
    v_and_b32 v14, 3, v1
    v_lshl_add_u32 v18, v14, 6, v18
    v_bfe_u32 v14, v1, 4, 1
    v_lshrrev_b32 v15, 5, v1
    v_lshl_add_u32 v14, v14, 1, v15
    v_xor_b32 v14, 3, v14
    v_lshl_add_u32 v18, v14, 4, v18
    s_lshl3_add_u32 s42, s34, s30
    s_lshl_b32 s43, s42, 16
    s_sub_u32 s37, 31, s35
    s_lshl_b32 s37, s37, 9
    s_add_u32 s43, s43, s37
    s_lshl_b32 s44, s42, 5
    s_add_u32 s44, s44, s35
    s_lshl_b32 s44, s44, 7
    s_add_u32 s44, s44, 23330816
    s_cmp_lt_u32 s30, 4
    s_cbranch_scc1 HB_4
    v_lshrrev_b32 v14, 4, v1
    v_lshlrev_b32 v119, 11, v14
    v_add_u32 v14, 0, v14
    v_lshlrev_b32 v14, 1, v14
    v_and_b32 v15, 15, v1
    v_xor_b32 v14, v14, v15
    v_lshl_add_u32 v119, v14, 4, v119
    v_lshrrev_b32 v14, 4, v1
    v_lshlrev_b32 v120, 11, v14
    v_add_u32 v14, 4, v14
    v_lshlrev_b32 v14, 1, v14
    v_and_b32 v15, 15, v1
    v_xor_b32 v14, v14, v15
    v_lshl_add_u32 v120, v14, 4, v120
    v_add_u32 v15, 0, v1
    v_mul_u32_u24 v14, 2341, v15
    v_lshrrev_b32 v14, 16, v14
    v_mul_u32_u24 v121, 28, v14
    v_sub_u32 v15, v15, v121
    v_mul_u32_u24 v121, 7168, v14
    v_lshrrev_b32 v14, 1, v14
    v_and_b32 v14, 2, v14
    v_xor_b32 v15, v15, v14
    v_lshl_add_u32 v121, v15, 4, v121
    v_add_u32 v15, 64, v1
    v_mul_u32_u24 v14, 2341, v15
    v_lshrrev_b32 v14, 16, v14
    v_mul_u32_u24 v122, 28, v14
    v_sub_u32 v15, v15, v122
    v_mul_u32_u24 v122, 7168, v14
    v_lshrrev_b32 v14, 1, v14
    v_and_b32 v14, 2, v14
    v_xor_b32 v15, v15, v14
    v_lshl_add_u32 v122, v15, 4, v122
    v_add_u32 v15, 128, v1
    v_mul_u32_u24 v14, 2341, v15
    v_lshrrev_b32 v14, 16, v14
    v_mul_u32_u24 v123, 28, v14
    v_sub_u32 v15, v15, v123
    v_mul_u32_u24 v123, 7168, v14
    v_lshrrev_b32 v14, 1, v14
    v_and_b32 v14, 2, v14
    v_xor_b32 v15, v15, v14
    v_lshl_add_u32 v123, v15, 4, v123
    v_add_u32 v15, 192, v1
    v_mul_u32_u24 v14, 2341, v15
    v_lshrrev_b32 v14, 16, v14
    v_mul_u32_u24 v124, 28, v14
    v_sub_u32 v15, v15, v124
    v_mul_u32_u24 v124, 7168, v14
    v_lshrrev_b32 v14, 1, v14
    v_and_b32 v14, 2, v14
    v_xor_b32 v15, v15, v14
    v_lshl_add_u32 v124, v15, 4, v124
    v_add_u32 v15, 256, v1
    v_mul_u32_u24 v14, 2341, v15
    v_lshrrev_b32 v14, 16, v14
    v_mul_u32_u24 v125, 28, v14
    v_sub_u32 v15, v15, v125
    v_mul_u32_u24 v125, 7168, v14
    v_lshrrev_b32 v14, 1, v14
    v_and_b32 v14, 2, v14
    v_xor_b32 v15, v15, v14
    v_lshl_add_u32 v125, v15, 4, v125
    v_add_u32 v15, 320, v1
    v_mul_u32_u24 v14, 2341, v15
    v_lshrrev_b32 v14, 16, v14
    v_mul_u32_u24 v126, 28, v14
    v_sub_u32 v15, v15, v126
    v_mul_u32_u24 v126, 7168, v14
    v_lshrrev_b32 v14, 1, v14
    v_and_b32 v14, 2, v14
    v_xor_b32 v15, v15, v14
    v_lshl_add_u32 v126, v15, 4, v126
    v_add_u32 v15, 384, v1
    v_mul_u32_u24 v14, 2341, v15
    v_lshrrev_b32 v14, 16, v14
    v_mul_u32_u24 v127, 28, v14
    v_sub_u32 v15, v15, v127
    v_mul_u32_u24 v127, 7168, v14
    v_lshrrev_b32 v14, 1, v14
    v_and_b32 v14, 2, v14
    v_xor_b32 v15, v15, v14
    v_lshl_add_u32 v127, v15, 4, v127
HB_4:
    buffer_load_dwordx4 v[28:31], v22, s[12:15], 0 offen nt
    buffer_load_dwordx2 v[32:33], v23, s[12:15], 0 offen nt
    buffer_load_dwordx4 v[34:37], v24, s[12:15], 0 offen nt
    buffer_load_dwordx2 v[38:39], v25, s[12:15], 0 offen nt
    buffer_load_dwordx4 v[40:43], v26, s[12:15], 0 offen nt
    buffer_load_dwordx2 v[44:45], v27, s[12:15], 0 offen nt
    buffer_load_dwordx4 v[240:243], v2, s[88:91], s50 offen
    s_cmp_ge_u32 s30, 4
    s_cbranch_scc1 HB_3
    s_mul_i32 s36, s30, 21568
    v_lshrrev_b32 v94, 1, v100
    v_mul_u32_u24 v108, 72, v94
    v_and_b32 v94, 1, v100
    v_lshl_add_u32 v108, v94, 4, v108
    v_lshl_add_u32 v108, v101, 2, v108
    v_add_u32 v108, s36, v108
    v_add_u32 v109, 1152, v108
    v_add_u32 v110, 2304, v108
    v_add_u32 v111, 3456, v108
    v_bfe_u32 v94, v1, 2, 2
    v_mul_u32_u24 v103, 21568, v94
    v_mul_u32_u24 v94, 72, v101
    v_add_u32 v103, v103, v94
    v_and_b32 v94, 3, v1
    v_lshl_add_u32 v103, v94, 3, v103
    s_mul_i32 s36, s30, 1152
    v_add_u32 v103, s36, v103
    s_waitcnt lgkmcnt(0)
    s_bitcmp1_b32 s39, 0
    s_cselect_b32 s36, 0, 16
    s_lshl_b32 s41, s41, s36
    s_and_b32 s41, s41, 0xffff0000
    s_lshr_b32 s36, s41, 16
    v_lshl_add_u32 v94, v101, 3, v100
    v_sub_u32 v94, 15, v94
    v_and_b32 v95, 1, v94
    v_cmp_eq_u32 vcc, 1, v95
    v_mov_b32 v95, s36
    v_mov_b32 v96, s41
    v_cndmask_b32 v95, v95, v96, vcc
    v_ashrrev_i32 v94, 1, v94
    v_cmp_eq_u32 vcc, 0, v94
    s_nop 1
    v_cndmask_b32 v104, 0, v95, vcc
    v_cmp_eq_u32 vcc, 1, v94
    s_nop 1
    v_cndmask_b32 v105, 0, v95, vcc
    v_cmp_eq_u32 vcc, 2, v94
    s_nop 1
    v_cndmask_b32 v106, 0, v95, vcc
    v_cmp_eq_u32 vcc, 3, v94
    s_nop 1
    v_cndmask_b32 v107, 0, v95, vcc
HB_3:
    s_waitcnt vmcnt(7) lgkmcnt(0)
    s_barrier
    ds_read_b64_tr_b16 v[128:129], v16 offset:0
    ds_read_b64_tr_b16 v[130:131], v16 offset:1024
    ds_read_b64_tr_b16 v[132:133], v16 offset:2048
    ds_read_b64_tr_b16 v[134:135], v16 offset:3072
    ds_read_b64_tr_b16 v[136:137], v17 offset:4096
    ds_read_b64_tr_b16 v[138:139], v16 offset:17408
    ds_read_b64_tr_b16 v[140:141], v16 offset:18432
    ds_read_b64_tr_b16 v[142:143], v16 offset:19456
    ds_read_b64_tr_b16 v[144:145], v16 offset:20480
    s_load_dword s52, s[84:85], 0
    v_lshlrev_b32 v46, 16, v12
    v_and_b32 v47, 0xffff0000, v12
    v_lshlrev_b32 v48, 16, v13
    v_and_b32 v49, 0xffff0000, v13
    s_waitcnt lgkmcnt(0)
    v_lshlrev_b32 v146, 16, v128
    v_and_b32 v147, 0xffff0000, v128
    v_lshlrev_b32 v148, 16, v129
    v_and_b32 v149, 0xffff0000, v129
    v_lshlrev_b32 v150, 16, v130
    v_and_b32 v151, 0xffff0000, v130
    v_lshlrev_b32 v152, 16, v131
    v_and_b32 v153, 0xffff0000, v131
    v_lshlrev_b32 v154, 16, v132
    v_and_b32 v155, 0xffff0000, v132
    v_lshlrev_b32 v156, 16, v133
    v_and_b32 v157, 0xffff0000, v133
    v_lshlrev_b32 v158, 16, v134
    v_and_b32 v159, 0xffff0000, v134
    v_lshlrev_b32 v160, 16, v135
    v_and_b32 v161, 0xffff0000, v135
    v_lshlrev_b32 v162, 16, v136
    v_and_b32 v163, 0xffff0000, v136
    v_lshlrev_b32 v164, 16, v137
    v_and_b32 v165, 0xffff0000, v137
    v_mul_f32 v166, v147, v49
    v_mul_f32 v167, v148, v49
    v_mul_f32 v168, v149, v49
    v_mul_f32 v169, v150, v49
    v_mul_f32 v170, v151, v49
    v_mul_f32 v171, v152, v49
    v_mul_f32 v172, v153, v49
    v_mul_f32 v173, v154, v49
    v_mul_f32 v174, v155, v49
    v_mul_f32 v175, v156, v49
    v_mul_f32 v176, v157, v49
    v_mul_f32 v177, v158, v49
    v_mul_f32 v178, v159, v49
    v_mul_f32 v179, v160, v49
    v_mul_f32 v180, v161, v49
    v_mul_f32 v181, v162, v49
    v_fmac_f32 v166, v148, v48
    v_fmac_f32 v167, v149, v48
    v_fmac_f32 v168, v150, v48
    v_fmac_f32 v169, v151, v48
    v_fmac_f32 v170, v152, v48
    v_fmac_f32 v171, v153, v48
    v_fmac_f32 v172, v154, v48
    v_fmac_f32 v173, v155, v48
    v_fmac_f32 v174, v156, v48
    v_fmac_f32 v175, v157, v48
    v_fmac_f32 v176, v158, v48
    v_fmac_f32 v177, v159, v48
    v_fmac_f32 v178, v160, v48
    v_fmac_f32 v179, v161, v48
    v_fmac_f32 v180, v162, v48
    v_fmac_f32 v181, v163, v48
    v_fmac_f32 v166, v149, v47
    v_fmac_f32 v167, v150, v47
    v_fmac_f32 v168, v151, v47
    v_fmac_f32 v169, v152, v47
    v_fmac_f32 v170, v153, v47
    v_fmac_f32 v171, v154, v47
    v_fmac_f32 v172, v155, v47
    v_fmac_f32 v173, v156, v47
    v_fmac_f32 v174, v157, v47
    v_fmac_f32 v175, v158, v47
    v_fmac_f32 v176, v159, v47
    v_fmac_f32 v177, v160, v47
    v_fmac_f32 v178, v161, v47
    v_fmac_f32 v179, v162, v47
    v_fmac_f32 v180, v163, v47
    v_fmac_f32 v181, v164, v47
    v_fmac_f32 v166, v150, v46
    v_fmac_f32 v167, v151, v46
    v_fmac_f32 v168, v152, v46
    v_fmac_f32 v169, v153, v46
    v_fmac_f32 v170, v154, v46
    v_fmac_f32 v171, v155, v46
    v_fmac_f32 v172, v156, v46
    v_fmac_f32 v173, v157, v46
    v_fmac_f32 v174, v158, v46
    v_fmac_f32 v175, v159, v46
    v_fmac_f32 v176, v160, v46
    v_fmac_f32 v177, v161, v46
    v_fmac_f32 v178, v162, v46
    v_fmac_f32 v179, v163, v46
    v_fmac_f32 v180, v164, v46
    v_fmac_f32 v181, v165, v46
    v_lshlrev_b32 v146, 16, v138
    v_and_b32 v147, 0xffff0000, v138
    v_lshlrev_b32 v148, 16, v139
    v_and_b32 v149, 0xffff0000, v139
    v_lshlrev_b32 v150, 16, v140
    v_and_b32 v151, 0xffff0000, v140
    v_lshlrev_b32 v152, 16, v141
    v_and_b32 v153, 0xffff0000, v141
    v_lshlrev_b32 v154, 16, v142
    v_and_b32 v155, 0xffff0000, v142
    v_lshlrev_b32 v156, 16, v143
    v_and_b32 v157, 0xffff0000, v143
    v_lshlrev_b32 v158, 16, v144
    v_and_b32 v159, 0xffff0000, v144
    v_lshlrev_b32 v160, 16, v145
    v_and_b32 v161, 0xffff0000, v145
    v_mul_f32 v166, v166, v146
    v_mul_f32 v167, v167, v147
    v_mul_f32 v168, v168, v148
    v_mul_f32 v169, v169, v149
    v_mul_f32 v170, v170, v150
    v_mul_f32 v171, v171, v151
    v_mul_f32 v172, v172, v152
    v_mul_f32 v173, v173, v153
    v_mul_f32 v174, v174, v154
    v_mul_f32 v175, v175, v155
    v_mul_f32 v176, v176, v156
    v_mul_f32 v177, v177, v157
    v_mul_f32 v178, v178, v158
    v_mul_f32 v179, v179, v159
    v_mul_f32 v180, v180, v160
    v_mul_f32 v181, v181, v161
    v_add_u32 v167, 0x10000, v167
    v_and_b32 v167, 0xfffe0000, v167
    v_add_u32 v169, 0x10000, v169
    v_and_b32 v169, 0xfffe0000, v169
    v_add_u32 v171, 0x10000, v171
    v_and_b32 v171, 0xfffe0000, v171
    v_add_u32 v173, 0x10000, v173
    v_and_b32 v173, 0xfffe0000, v173
    v_add_u32 v175, 0x10000, v175
    v_and_b32 v175, 0xfffe0000, v175
    v_add_u32 v177, 0x10000, v177
    v_and_b32 v177, 0xfffe0000, v177
    v_add_u32 v179, 0x10000, v179
    v_and_b32 v179, 0xfffe0000, v179
    v_add_u32 v181, 0x10000, v181
    v_and_b32 v181, 0xfffe0000, v181
    v_cvt_pk_bf16_f32 v52, v173, v172
    v_cvt_pk_bf16_f32 v53, v171, v170
    v_cvt_pk_bf16_f32 v54, v169, v168
    v_cvt_pk_bf16_f32 v55, v167, v166
    v_cvt_pk_bf16_f32 v56, v181, v180
    v_cvt_pk_bf16_f32 v57, v179, v178
    v_cvt_pk_bf16_f32 v58, v177, v176
    v_cvt_pk_bf16_f32 v59, v175, v174
    s_cmp_lg_u32 s52, 0
    s_cbranch_scc1 HB_q
    s_mov_b32 s53, 0
HB_p:
    buffer_load_dword v14, v10, s[84:87], 0 offen sc1
    s_waitcnt vmcnt(0)
    v_readfirstlane_b32 s52, v14
    s_nop 0
    s_cmp_lg_u32 s52, 0
    s_cbranch_scc1 HB_q
    s_add_u32 s53, s53, 1
    s_cmp_lt_u32 s53, s61
    s_cbranch_scc1 HB_p
    s_mov_b32 s52, 1
    s_mov_b32 s61, 0
HB_q:
    v_permlane32_swap_b32 v52, v56
    v_permlane32_swap_b32 v53, v57
    v_permlane32_swap_b32 v54, v58
    v_permlane32_swap_b32 v55, v59
    v_mov_b32 v14, s52
    buffer_store_dwordx4 v[52:55], v18, s[16:19], s43 offen offset:256 sc1
    buffer_store_dwordx4 v[56:59], v18, s[16:19], s43 offen offset:0 sc1
    s_waitcnt vmcnt(3)
    v_alignbit_b32 v128, v29, v28, 16
    v_mov_b32 v132, v29
    v_alignbit_b32 v136, v30, v29, 16
    v_alignbit_b32 v129, v30, v29, 16
    v_mov_b32 v133, v30
    v_alignbit_b32 v137, v31, v30, 16
    v_alignbit_b32 v130, v31, v30, 16
    v_mov_b32 v134, v31
    v_alignbit_b32 v138, v32, v31, 16
    v_alignbit_b32 v131, v32, v31, 16
    v_mov_b32 v135, v32
    v_alignbit_b32 v139, v33, v32, 16
    ds_write_b128 v20, v[128:131] offset:0
    ds_write_b128 v20, v[132:135] offset:4160
    ds_write_b128 v20, v[136:139] offset:8320
    ds_write_b128 v20, v[30:33] offset:12480
    v_alignbit_b32 v140, v35, v34, 16
    v_mov_b32 v144, v35
    v_alignbit_b32 v148, v36, v35, 16
    v_alignbit_b32 v141, v36, v35, 16
    v_mov_b32 v145, v36
    v_alignbit_b32 v149, v37, v36, 16
    v_alignbit_b32 v142, v37, v36, 16
    v_mov_b32 v146, v37
    v_alignbit_b32 v150, v38, v37, 16
    v_alignbit_b32 v143, v38, v37, 16
    v_mov_b32 v147, v38
    v_alignbit_b32 v151, v39, v38, 16
    ds_write_b128 v20, v[140:143] offset:1024
    ds_write_b128 v20, v[144:147] offset:5184
    ds_write_b128 v20, v[148:151] offset:9344
    ds_write_b128 v20, v[36:39] offset:13504
    s_waitcnt vmcnt(0)
    s_mov_b64 exec, 1
    buffer_store_dword v14, v10, s[56:59], s44 offen sc1
    s_mov_b64 exec, -1
    s_cmp_lg_u32 s30, 5
    s_cbranch_scc1 KV_n3
    s_lshl_b32 s36, s2, 14
    s_add_u32 s36, s36, 29360128
    v_lshrrev_b32 v15, 3, v1
    v_mul_u32_u24 v15, 8064, v15
    v_add_u32 v15, v15, v2
    s_mov_b64 exec, 0xffff
    buffer_store_dwordx4 v[60:63], v15, s[56:59], s36 offen sc1
    s_mov_b64 exec, -1
KV_n3:
    v_alignbit_b32 v152, v41, v40, 16
    v_mov_b32 v156, v41
    v_alignbit_b32 v160, v42, v41, 16
    v_alignbit_b32 v153, v42, v41, 16
    v_mov_b32 v157, v42
    v_alignbit_b32 v161, v43, v42, 16
    v_alignbit_b32 v154, v43, v42, 16
    v_mov_b32 v158, v43
    v_alignbit_b32 v162, v44, v43, 16
    v_alignbit_b32 v155, v44, v43, 16
    v_mov_b32 v159, v44
    v_alignbit_b32 v163, v45, v44, 16
    s_mov_b64 exec, 0xf
    ds_write_b128 v19, v[152:155] offset:4096
    ds_write_b128 v19, v[156:159] offset:8256
    ds_write_b128 v19, v[160:163] offset:12416
    ds_write_b128 v19, v[42:45] offset:16576
    s_mov_b64 exec, -1
    s_waitcnt lgkmcnt(0)
    s_barrier
    s_add_u32 s36, s48, 0
    s_add_u32 m0, s49, 90112
    s_nop 0
    buffer_load_dwordx4 v118, s[88:91], s36 offen lds
    s_add_u32 s36, s48, 131072
    s_add_u32 m0, s49, 98304
    s_nop 0
    buffer_load_dwordx4 v118, s[88:91], s36 offen lds
    s_add_u32 s36, s48, 262144
    s_add_u32 m0, s49, 106496
    s_nop 0
    buffer_load_dwordx4 v118, s[88:91], s36 offen lds
    s_add_u32 s36, s48, 393216
    s_add_u32 m0, s49, 114688
    s_nop 0
    buffer_load_dwordx4 v118, s[88:91], s36 offen lds
    s_add_u32 s36, s48, 524288
    s_add_u32 m0, s49, 122880
    s_nop 0
    buffer_load_dwordx4 v118, s[88:91], s36 offen lds
    s_add_u32 s36, s48, 655360
    s_add_u32 m0, s49, 131072
    s_nop 0
    buffer_load_dwordx4 v118, s[88:91], s36 offen lds
    s_add_u32 s36, s48, 786432
    s_add_u32 m0, s49, 139264
    s_nop 0
    buffer_load_dwordx4 v118, s[88:91], s36 offen lds
    s_add_u32 s36, s48, 917504
    s_add_u32 m0, s49, 147456
    s_nop 0
    buffer_load_dwordx4 v118, s[88:91], s36 offen lds
    s_cmp_ge_u32 s30, 4
    s_cbranch_scc1 FR_b
    s_lshl_b32 s44, s30, 12
    s_mov_b32 s45, 0x07060302
    s_cmp_lg_u32 s30, 0
    s_cbranch_scc1 CV_w
    s_mov_b32 s53, 0
    s_add_u32 s54, s52, 0
    s_bfm_b64 exec, 32, 0
poll_1:
    buffer_load_dword v8, v102, s[56:59], 0 offen sc1
    s_waitcnt vmcnt(0)
    v_cmp_eq_u32 vcc, s54, v8
    s_nop 0
    s_cmp_eq_u64 vcc, exec
    s_cbranch_scc1 pok_2
    s_sleep 5
    s_add_u32 s53, s53, 1
    s_cmp_lt_u32 s53, s61
    s_cbranch_scc1 poll_1
    s_mov_b32 s61, 0
pok_2:
    s_mov_b64 exec, -1
CV_w:
    s_add_u32 m0, s40, 16640
    s_mov_b32 s36, 0
    s_waitcnt vmcnt(0)
    s_barrier
    buffer_load_dwordx4 v97, s[20:23], s36 offen offset:0 sc1 lds
    s_add_u32 s36, s36, 3072
    buffer_load_dwordx4 v97, s[20:23], s36 offen offset:1024 sc1 lds
    s_add_u32 s36, s36, 3072
    buffer_load_dwordx4 v97, s[20:23], s36 offen offset:2048 sc1 lds
    s_add_u32 s36, s36, 3072
    buffer_load_dwordx4 v97, s[20:23], s36 offen offset:3072 sc1 lds
    s_barrier
    buffer_load_dwordx2 v[86:87], v80, s[8:11], 0 offen offset:0 nt
    buffer_load_dwordx2 v[88:89], v80, s[8:11], 0 offen offset:32 nt
    buffer_load_dwordx2 v[90:91], v80, s[8:11], 0 offen offset:128 nt
    buffer_load_dwordx2 v[92:93], v80, s[8:11], 0 offen offset:160 nt
    ds_read_b64 v[120:121], v98 offset:32
    ds_read_b64 v[122:123], v98 offset:40
    ds_read_b64 v[124:125], v98 offset:544
    ds_read_b64 v[126:127], v98 offset:552
    ds_read_b64 v[128:129], v98 offset:1056
    ds_read_b64 v[130:131], v98 offset:1064
    ds_read_b64 v[132:133], v98 offset:1568
    ds_read_b64 v[134:135], v98 offset:1576
    ds_read_b64 v[136:137], v98 offset:2080
    ds_read_b64 v[138:139], v98 offset:2088
    ds_read_b64 v[140:141], v98 offset:2592
    ds_read_b64 v[142:143], v98 offset:2600
    ds_read_b64 v[144:145], v98 offset:3104
    ds_read_b64 v[146:147], v98 offset:3112
    ds_read_b64 v[148:149], v98 offset:3616
    ds_read_b64 v[150:151], v98 offset:3624
    s_waitcnt vmcnt(4)
    ds_read_b128 v[184:187], v99 offset:20224
    ds_read_b128 v[188:191], v99 offset:19712
    ds_read_b128 v[192:195], v99 offset:19200
    ds_read_b128 v[196:199], v99 offset:18688
    ds_read_b128 v[200:203], v99 offset:18176
    ds_read_b128 v[204:207], v99 offset:17664
    ds_read_b128 v[208:211], v99 offset:17152
    ds_read_b128 v[212:215], v99 offset:16640
    s_waitcnt lgkmcnt(0)
    v_mfma_f32_16x16x32_bf16 v[12:15], v[104:107], v[184:187], 0
    v_mfma_f32_16x16x32_bf16 v[16:19], v[104:107], v[188:191], 0
    v_mfma_f32_16x16x32_bf16 v[20:23], v[104:107], v[192:195], 0
    v_mfma_f32_16x16x32_bf16 v[24:27], v[104:107], v[196:199], 0
    v_mfma_f32_16x16x32_bf16 v[28:31], v[104:107], v[200:203], 0
    v_mfma_f32_16x16x32_bf16 v[32:35], v[104:107], v[204:207], 0
    v_mfma_f32_16x16x32_bf16 v[36:39], v[104:107], v[208:211], 0
    v_mfma_f32_16x16x32_bf16 v[40:43], v[104:107], v[212:215], 0
    s_mov_b32 s43, 0
CV_r:
    s_waitcnt lgkmcnt(0)
    v_mfma_f32_16x16x32_bf16 v[12:15], v[120:123], v[184:187], v[12:15]
    ds_read_b128 v[216:219], v99 offset:20288
    v_mfma_f32_16x16x32_bf16 v[16:19], v[120:123], v[188:191], v[16:19]
    ds_read_b128 v[220:223], v99 offset:19776
    v_mfma_f32_16x16x32_bf16 v[20:23], v[120:123], v[192:195], v[20:23]
    ds_read_b128 v[224:227], v99 offset:19264
    v_mfma_f32_16x16x32_bf16 v[24:27], v[120:123], v[196:199], v[24:27]
    ds_read_b128 v[228:231], v99 offset:18752
    v_mfma_f32_16x16x32_bf16 v[28:31], v[120:123], v[200:203], v[28:31]
    ds_read_b128 v[232:235], v99 offset:18240
    v_mfma_f32_16x16x32_bf16 v[32:35], v[120:123], v[204:207], v[32:35]
    ds_read_b128 v[236:239], v99 offset:17728
    v_mfma_f32_16x16x32_bf16 v[36:39], v[120:123], v[208:211], v[36:39]
    ds_read_b128 v[240:243], v99 offset:17216
    v_mfma_f32_16x16x32_bf16 v[40:43], v[120:123], v[212:215], v[40:43]
    ds_read_b128 v[244:247], v99 offset:16704
    v_mfma_f32_16x16x32_bf16 v[16:19], v[124:127], v[184:187], v[16:19]
    ds_read_b64 v[152:153], v98 offset:96
    v_mfma_f32_16x16x32_bf16 v[20:23], v[124:127], v[188:191], v[20:23]
    ds_read_b64 v[154:155], v98 offset:104
    v_mfma_f32_16x16x32_bf16 v[24:27], v[124:127], v[192:195], v[24:27]
    ds_read_b64 v[156:157], v98 offset:608
    v_mfma_f32_16x16x32_bf16 v[28:31], v[124:127], v[196:199], v[28:31]
    ds_read_b64 v[158:159], v98 offset:616
    v_mfma_f32_16x16x32_bf16 v[32:35], v[124:127], v[200:203], v[32:35]
    ds_read_b64 v[160:161], v98 offset:1120
    v_mfma_f32_16x16x32_bf16 v[36:39], v[124:127], v[204:207], v[36:39]
    ds_read_b64 v[162:163], v98 offset:1128
    v_mfma_f32_16x16x32_bf16 v[40:43], v[124:127], v[208:211], v[40:43]
    v_mfma_f32_16x16x32_bf16 v[20:23], v[128:131], v[184:187], v[20:23]
    v_mfma_f32_16x16x32_bf16 v[24:27], v[128:131], v[188:191], v[24:27]
    v_mfma_f32_16x16x32_bf16 v[28:31], v[128:131], v[192:195], v[28:31]
    v_mfma_f32_16x16x32_bf16 v[32:35], v[128:131], v[196:199], v[32:35]
    v_mfma_f32_16x16x32_bf16 v[36:39], v[128:131], v[200:203], v[36:39]
    v_mfma_f32_16x16x32_bf16 v[40:43], v[128:131], v[204:207], v[40:43]
    v_mfma_f32_16x16x32_bf16 v[24:27], v[132:135], v[184:187], v[24:27]
    v_mfma_f32_16x16x32_bf16 v[28:31], v[132:135], v[188:191], v[28:31]
    v_mfma_f32_16x16x32_bf16 v[32:35], v[132:135], v[192:195], v[32:35]
    v_mfma_f32_16x16x32_bf16 v[36:39], v[132:135], v[196:199], v[36:39]
    v_mfma_f32_16x16x32_bf16 v[40:43], v[132:135], v[200:203], v[40:43]
    v_mfma_f32_16x16x32_bf16 v[28:31], v[136:139], v[184:187], v[28:31]
    v_mfma_f32_16x16x32_bf16 v[32:35], v[136:139], v[188:191], v[32:35]
    v_mfma_f32_16x16x32_bf16 v[36:39], v[136:139], v[192:195], v[36:39]
    v_mfma_f32_16x16x32_bf16 v[40:43], v[136:139], v[196:199], v[40:43]
    v_mfma_f32_16x16x32_bf16 v[32:35], v[140:143], v[184:187], v[32:35]
    v_mfma_f32_16x16x32_bf16 v[36:39], v[140:143], v[188:191], v[36:39]
    v_mfma_f32_16x16x32_bf16 v[40:43], v[140:143], v[192:195], v[40:43]
    v_mfma_f32_16x16x32_bf16 v[36:39], v[144:147], v[184:187], v[36:39]
    v_mfma_f32_16x16x32_bf16 v[40:43], v[144:147], v[188:191], v[40:43]
    v_mfma_f32_16x16x32_bf16 v[40:43], v[148:151], v[184:187], v[40:43]
    ds_read_b64 v[164:165], v98 offset:1632
    ds_read_b64 v[166:167], v98 offset:1640
    ds_read_b64 v[168:169], v98 offset:2144
    ds_read_b64 v[170:171], v98 offset:2152
    ds_read_b64 v[172:173], v98 offset:2656
    ds_read_b64 v[174:175], v98 offset:2664
    ds_read_b64 v[176:177], v98 offset:3168
    ds_read_b64 v[178:179], v98 offset:3176
    ds_read_b64 v[180:181], v98 offset:3680
    ds_read_b64 v[182:183], v98 offset:3688
    s_waitcnt lgkmcnt(0)
    v_mfma_f32_16x16x32_bf16 v[12:15], v[152:155], v[216:219], v[12:15]
    ds_read_b128 v[184:187], v99 offset:20352
    v_mfma_f32_16x16x32_bf16 v[16:19], v[152:155], v[220:223], v[16:19]
    ds_read_b128 v[188:191], v99 offset:19840
    v_mfma_f32_16x16x32_bf16 v[20:23], v[152:155], v[224:227], v[20:23]
    ds_read_b128 v[192:195], v99 offset:19328
    v_mfma_f32_16x16x32_bf16 v[24:27], v[152:155], v[228:231], v[24:27]
    ds_read_b128 v[196:199], v99 offset:18816
    v_mfma_f32_16x16x32_bf16 v[28:31], v[152:155], v[232:235], v[28:31]
    ds_read_b128 v[200:203], v99 offset:18304
    v_mfma_f32_16x16x32_bf16 v[32:35], v[152:155], v[236:239], v[32:35]
    ds_read_b128 v[204:207], v99 offset:17792
    v_mfma_f32_16x16x32_bf16 v[36:39], v[152:155], v[240:243], v[36:39]
    ds_read_b128 v[208:211], v99 offset:17280
    v_mfma_f32_16x16x32_bf16 v[40:43], v[152:155], v[244:247], v[40:43]
    ds_read_b128 v[212:215], v99 offset:16768
    v_mfma_f32_16x16x32_bf16 v[16:19], v[156:159], v[216:219], v[16:19]
    ds_read_b64 v[120:121], v98 offset:160
    v_mfma_f32_16x16x32_bf16 v[20:23], v[156:159], v[220:223], v[20:23]
    ds_read_b64 v[122:123], v98 offset:168
    v_mfma_f32_16x16x32_bf16 v[24:27], v[156:159], v[224:227], v[24:27]
    ds_read_b64 v[124:125], v98 offset:672
    v_mfma_f32_16x16x32_bf16 v[28:31], v[156:159], v[228:231], v[28:31]
    ds_read_b64 v[126:127], v98 offset:680
    v_mfma_f32_16x16x32_bf16 v[32:35], v[156:159], v[232:235], v[32:35]
    ds_read_b64 v[128:129], v98 offset:1184
    v_mfma_f32_16x16x32_bf16 v[36:39], v[156:159], v[236:239], v[36:39]
    ds_read_b64 v[130:131], v98 offset:1192
    v_mfma_f32_16x16x32_bf16 v[40:43], v[156:159], v[240:243], v[40:43]
    v_mfma_f32_16x16x32_bf16 v[20:23], v[160:163], v[216:219], v[20:23]
    v_mfma_f32_16x16x32_bf16 v[24:27], v[160:163], v[220:223], v[24:27]
    v_mfma_f32_16x16x32_bf16 v[28:31], v[160:163], v[224:227], v[28:31]
    v_mfma_f32_16x16x32_bf16 v[32:35], v[160:163], v[228:231], v[32:35]
    v_mfma_f32_16x16x32_bf16 v[36:39], v[160:163], v[232:235], v[36:39]
    v_mfma_f32_16x16x32_bf16 v[40:43], v[160:163], v[236:239], v[40:43]
    v_mfma_f32_16x16x32_bf16 v[24:27], v[164:167], v[216:219], v[24:27]
    v_mfma_f32_16x16x32_bf16 v[28:31], v[164:167], v[220:223], v[28:31]
    v_mfma_f32_16x16x32_bf16 v[32:35], v[164:167], v[224:227], v[32:35]
    v_mfma_f32_16x16x32_bf16 v[36:39], v[164:167], v[228:231], v[36:39]
    v_mfma_f32_16x16x32_bf16 v[40:43], v[164:167], v[232:235], v[40:43]
    v_mfma_f32_16x16x32_bf16 v[28:31], v[168:171], v[216:219], v[28:31]
    v_mfma_f32_16x16x32_bf16 v[32:35], v[168:171], v[220:223], v[32:35]
    v_mfma_f32_16x16x32_bf16 v[36:39], v[168:171], v[224:227], v[36:39]
    v_mfma_f32_16x16x32_bf16 v[40:43], v[168:171], v[228:231], v[40:43]
    v_mfma_f32_16x16x32_bf16 v[32:35], v[172:175], v[216:219], v[32:35]
    v_mfma_f32_16x16x32_bf16 v[36:39], v[172:175], v[220:223], v[36:39]
    v_mfma_f32_16x16x32_bf16 v[40:43], v[172:175], v[224:227], v[40:43]
    v_mfma_f32_16x16x32_bf16 v[36:39], v[176:179], v[216:219], v[36:39]
    v_mfma_f32_16x16x32_bf16 v[40:43], v[176:179], v[220:223], v[40:43]
    v_mfma_f32_16x16x32_bf16 v[40:43], v[180:183], v[216:219], v[40:43]
    ds_read_b64 v[132:133], v98 offset:1696
    ds_read_b64 v[134:135], v98 offset:1704
    ds_read_b64 v[136:137], v98 offset:2208
    ds_read_b64 v[138:139], v98 offset:2216
    ds_read_b64 v[140:141], v98 offset:2720
    ds_read_b64 v[142:143], v98 offset:2728
    ds_read_b64 v[144:145], v98 offset:3232
    ds_read_b64 v[146:147], v98 offset:3240
    ds_read_b64 v[148:149], v98 offset:3744
    ds_read_b64 v[150:151], v98 offset:3752
    v_add_u32 v98, 128, v98
    v_add_u32 v99, 128, v99
    s_add_u32 s43, s43, 1
    s_cmp_lt_u32 s43, 3
    s_cbranch_scc1 CV_r
CV_l:
    s_waitcnt lgkmcnt(0)
    v_mfma_f32_16x16x32_bf16 v[12:15], v[120:123], v[184:187], v[12:15]
    ds_read_b128 v[216:219], v99 offset:20288
    v_mfma_f32_16x16x32_bf16 v[16:19], v[120:123], v[188:191], v[16:19]
    ds_read_b128 v[220:223], v99 offset:19776
    v_mfma_f32_16x16x32_bf16 v[20:23], v[120:123], v[192:195], v[20:23]
    ds_read_b128 v[224:227], v99 offset:19264
    v_mfma_f32_16x16x32_bf16 v[24:27], v[120:123], v[196:199], v[24:27]
    ds_read_b128 v[228:231], v99 offset:18752
    v_mfma_f32_16x16x32_bf16 v[28:31], v[120:123], v[200:203], v[28:31]
    ds_read_b128 v[232:235], v99 offset:18240
    v_mfma_f32_16x16x32_bf16 v[32:35], v[120:123], v[204:207], v[32:35]
    ds_read_b128 v[236:239], v99 offset:17728
    v_mfma_f32_16x16x32_bf16 v[36:39], v[120:123], v[208:211], v[36:39]
    ds_read_b128 v[240:243], v99 offset:17216
    v_mfma_f32_16x16x32_bf16 v[40:43], v[120:123], v[212:215], v[40:43]
    ds_read_b128 v[244:247], v99 offset:16704
    v_mfma_f32_16x16x32_bf16 v[16:19], v[124:127], v[184:187], v[16:19]
    ds_read_b64 v[152:153], v98 offset:96
    v_mfma_f32_16x16x32_bf16 v[20:23], v[124:127], v[188:191], v[20:23]
    ds_read_b64 v[154:155], v98 offset:104
    v_mfma_f32_16x16x32_bf16 v[24:27], v[124:127], v[192:195], v[24:27]
    ds_read_b64 v[156:157], v98 offset:608
    v_mfma_f32_16x16x32_bf16 v[28:31], v[124:127], v[196:199], v[28:31]
    ds_read_b64 v[158:159], v98 offset:616
    v_mfma_f32_16x16x32_bf16 v[32:35], v[124:127], v[200:203], v[32:35]
    ds_read_b64 v[160:161], v98 offset:1120
    v_mfma_f32_16x16x32_bf16 v[36:39], v[124:127], v[204:207], v[36:39]
    ds_read_b64 v[162:163], v98 offset:1128
    v_mfma_f32_16x16x32_bf16 v[40:43], v[124:127], v[208:211], v[40:43]
    ds_read_b64 v[164:165], v98 offset:1632
    v_mfma_f32_16x16x32_bf16 v[20:23], v[128:131], v[184:187], v[20:23]
    ds_read_b64 v[166:167], v98 offset:1640
    v_mfma_f32_16x16x32_bf16 v[24:27], v[128:131], v[188:191], v[24:27]
    ds_read_b64 v[168:169], v98 offset:2144
    v_mfma_f32_16x16x32_bf16 v[28:31], v[128:131], v[192:195], v[28:31]
    ds_read_b64 v[170:171], v98 offset:2152
    v_mfma_f32_16x16x32_bf16 v[32:35], v[128:131], v[196:199], v[32:35]
    ds_read_b64 v[172:173], v98 offset:2656
    v_mfma_f32_16x16x32_bf16 v[36:39], v[128:131], v[200:203], v[36:39]
    ds_read_b64 v[174:175], v98 offset:2664
    v_mfma_f32_16x16x32_bf16 v[40:43], v[128:131], v[204:207], v[40:43]
    ds_read_b64 v[176:177], v98 offset:3168
    v_mfma_f32_16x16x32_bf16 v[24:27], v[132:135], v[184:187], v[24:27]
    ds_read_b64 v[178:179], v98 offset:3176
    v_mfma_f32_16x16x32_bf16 v[28:31], v[132:135], v[188:191], v[28:31]
    ds_read_b64 v[180:181], v98 offset:3680
    v_mfma_f32_16x16x32_bf16 v[32:35], v[132:135], v[192:195], v[32:35]
    ds_read_b64 v[182:183], v98 offset:3688
    v_mfma_f32_16x16x32_bf16 v[36:39], v[132:135], v[196:199], v[36:39]
    v_mfma_f32_16x16x32_bf16 v[40:43], v[132:135], v[200:203], v[40:43]
    v_mfma_f32_16x16x32_bf16 v[28:31], v[136:139], v[184:187], v[28:31]
    v_mfma_f32_16x16x32_bf16 v[32:35], v[136:139], v[188:191], v[32:35]
    v_mfma_f32_16x16x32_bf16 v[36:39], v[136:139], v[192:195], v[36:39]
    v_mfma_f32_16x16x32_bf16 v[40:43], v[136:139], v[196:199], v[40:43]
    v_mfma_f32_16x16x32_bf16 v[32:35], v[140:143], v[184:187], v[32:35]
    v_mfma_f32_16x16x32_bf16 v[36:39], v[140:143], v[188:191], v[36:39]
    v_mfma_f32_16x16x32_bf16 v[40:43], v[140:143], v[192:195], v[40:43]
    v_mfma_f32_16x16x32_bf16 v[36:39], v[144:147], v[184:187], v[36:39]
    v_mfma_f32_16x16x32_bf16 v[40:43], v[144:147], v[188:191], v[40:43]
    v_mfma_f32_16x16x32_bf16 v[40:43], v[148:151], v[184:187], v[40:43]
    s_waitcnt lgkmcnt(0)
    v_mfma_f32_16x16x32_bf16 v[12:15], v[152:155], v[216:219], v[12:15]
    ds_read_b128 v[184:187], v99 offset:20352
    v_mfma_f32_16x16x32_bf16 v[16:19], v[152:155], v[220:223], v[16:19]
    ds_read_b128 v[188:191], v99 offset:19840
    v_mfma_f32_16x16x32_bf16 v[20:23], v[152:155], v[224:227], v[20:23]
    ds_read_b128 v[192:195], v99 offset:19328
    v_mfma_f32_16x16x32_bf16 v[24:27], v[152:155], v[228:231], v[24:27]
    ds_read_b128 v[196:199], v99 offset:18816
    v_mfma_f32_16x16x32_bf16 v[28:31], v[152:155], v[232:235], v[28:31]
    ds_read_b128 v[200:203], v99 offset:18304
    v_mfma_f32_16x16x32_bf16 v[32:35], v[152:155], v[236:239], v[32:35]
    ds_read_b128 v[204:207], v99 offset:17792
    v_mfma_f32_16x16x32_bf16 v[36:39], v[152:155], v[240:243], v[36:39]
    ds_read_b128 v[208:211], v99 offset:17280
    v_mfma_f32_16x16x32_bf16 v[40:43], v[152:155], v[244:247], v[40:43]
    ds_read_b128 v[212:215], v99 offset:16768
    v_mfma_f32_16x16x32_bf16 v[16:19], v[156:159], v[216:219], v[16:19]
    ds_read_b64 v[120:121], v98 offset:160
    v_mfma_f32_16x16x32_bf16 v[20:23], v[156:159], v[220:223], v[20:23]
    ds_read_b64 v[122:123], v98 offset:168
    v_mfma_f32_16x16x32_bf16 v[24:27], v[156:159], v[224:227], v[24:27]
    ds_read_b64 v[124:125], v98 offset:672
    v_mfma_f32_16x16x32_bf16 v[28:31], v[156:159], v[228:231], v[28:31]
    ds_read_b64 v[126:127], v98 offset:680
    v_mfma_f32_16x16x32_bf16 v[32:35], v[156:159], v[232:235], v[32:35]
    ds_read_b64 v[128:129], v98 offset:1184
    v_mfma_f32_16x16x32_bf16 v[36:39], v[156:159], v[236:239], v[36:39]
    ds_read_b64 v[130:131], v98 offset:1192
    v_mfma_f32_16x16x32_bf16 v[40:43], v[156:159], v[240:243], v[40:43]
    ds_read_b64 v[132:133], v98 offset:1696
    v_mfma_f32_16x16x32_bf16 v[20:23], v[160:163], v[216:219], v[20:23]
    ds_read_b64 v[134:135], v98 offset:1704
    v_mfma_f32_16x16x32_bf16 v[24:27], v[160:163], v[220:223], v[24:27]
    ds_read_b64 v[136:137], v98 offset:2208
    v_mfma_f32_16x16x32_bf16 v[28:31], v[160:163], v[224:227], v[28:31]
    ds_read_b64 v[138:139], v98 offset:2216
    v_mfma_f32_16x16x32_bf16 v[32:35], v[160:163], v[228:231], v[32:35]
    ds_read_b64 v[140:141], v98 offset:2720
    v_mfma_f32_16x16x32_bf16 v[36:39], v[160:163], v[232:235], v[36:39]
    ds_read_b64 v[142:143], v98 offset:2728
    v_mfma_f32_16x16x32_bf16 v[40:43], v[160:163], v[236:239], v[40:43]
    ds_read_b64 v[144:145], v98 offset:3232
    v_mfma_f32_16x16x32_bf16 v[24:27], v[164:167], v[216:219], v[24:27]
    ds_read_b64 v[146:147], v98 offset:3240
    v_mfma_f32_16x16x32_bf16 v[28:31], v[164:167], v[220:223], v[28:31]
    ds_read_b64 v[148:149], v98 offset:3744
    v_mfma_f32_16x16x32_bf16 v[32:35], v[164:167], v[224:227], v[32:35]
    ds_read_b64 v[150:151], v98 offset:3752
    v_mfma_f32_16x16x32_bf16 v[36:39], v[164:167], v[228:231], v[36:39]
    v_add_u32 v98, 128, v98
    v_mfma_f32_16x16x32_bf16 v[40:43], v[164:167], v[232:235], v[40:43]
    v_add_u32 v99, 128, v99
    v_mfma_f32_16x16x32_bf16 v[28:31], v[168:171], v[216:219], v[28:31]
    s_add_u32 s43, s43, 1
    v_mfma_f32_16x16x32_bf16 v[32:35], v[168:171], v[220:223], v[32:35]
    s_cmp_lt_u32 s43, 4
    v_mfma_f32_16x16x32_bf16 v[36:39], v[168:171], v[224:227], v[36:39]
    v_mfma_f32_16x16x32_bf16 v[40:43], v[168:171], v[228:231], v[40:43]
    v_mfma_f32_16x16x32_bf16 v[32:35], v[172:175], v[216:219], v[32:35]
    v_mfma_f32_16x16x32_bf16 v[36:39], v[172:175], v[220:223], v[36:39]
    v_mfma_f32_16x16x32_bf16 v[40:43], v[172:175], v[224:227], v[40:43]
    v_mfma_f32_16x16x32_bf16 v[36:39], v[176:179], v[216:219], v[36:39]
    v_mfma_f32_16x16x32_bf16 v[40:43], v[176:179], v[220:223], v[40:43]
    v_mfma_f32_16x16x32_bf16 v[40:43], v[180:183], v[216:219], v[40:43]
    s_cbranch_scc1 CV_l
    s_bitcmp1_b32 s30, 0
    s_waitcnt lgkmcnt(0)
    s_cbranch_scc1 CV_o
    v_perm_b32 v12, v14, v12, s45
    v_perm_b32 v13, v15, v13, s45
    v_or_b32 v12, 0x10001, v12
    v_or_b32 v13, 0x10001, v13
    ds_write2_b32 v108, v12, v13 offset0:0 offset1:8
    v_perm_b32 v16, v18, v16, s45
    v_perm_b32 v17, v19, v17, s45
    v_or_b32 v16, 0x10001, v16
    v_or_b32 v17, 0x10001, v17
    ds_write2_b32 v108, v16, v17 offset0:144 offset1:152
    v_perm_b32 v20, v22, v20, s45
    v_perm_b32 v21, v23, v21, s45
    v_or_b32 v20, 0x10001, v20
    v_or_b32 v21, 0x10001, v21
    ds_write2_b32 v109, v20, v21 offset0:0 offset1:8
    v_perm_b32 v24, v26, v24, s45
    v_perm_b32 v25, v27, v25, s45
    v_or_b32 v24, 0x10001, v24
    v_or_b32 v25, 0x10001, v25
    ds_write2_b32 v109, v24, v25 offset0:144 offset1:152
    v_perm_b32 v28, v30, v28, s45
    v_perm_b32 v29, v31, v29, s45
    v_or_b32 v28, 0x10001, v28
    v_or_b32 v29, 0x10001, v29
    ds_write2_b32 v110, v28, v29 offset0:0 offset1:8
    v_perm_b32 v32, v34, v32, s45
    v_perm_b32 v33, v35, v33, s45
    v_or_b32 v32, 0x10001, v32
    v_or_b32 v33, 0x10001, v33
    ds_write2_b32 v110, v32, v33 offset0:144 offset1:152
    v_perm_b32 v36, v38, v36, s45
    v_perm_b32 v37, v39, v37, s45
    v_or_b32 v36, 0x10001, v36
    v_or_b32 v37, 0x10001, v37
    ds_write2_b32 v111, v36, v37 offset0:0 offset1:8
    v_perm_b32 v40, v42, v40, s45
    v_perm_b32 v41, v43, v41, s45
    v_or_b32 v40, 0x10001, v40
    v_or_b32 v41, 0x10001, v41
    ds_write2_b32 v111, v40, v41 offset0:144 offset1:152
    s_branch CV_e
CV_o:
    v_cvt_pk_bf16_f32 v12, v12, v14
    v_cvt_pk_bf16_f32 v13, v13, v15
    ds_write2_b32 v108, v12, v13 offset0:0 offset1:8
    v_cvt_pk_bf16_f32 v16, v16, v18
    v_cvt_pk_bf16_f32 v17, v17, v19
    ds_write2_b32 v108, v16, v17 offset0:144 offset1:152
    v_cvt_pk_bf16_f32 v20, v20, v22
    v_cvt_pk_bf16_f32 v21, v21, v23
    ds_write2_b32 v109, v20, v21 offset0:0 offset1:8
    v_cvt_pk_bf16_f32 v24, v24, v26
    v_cvt_pk_bf16_f32 v25, v25, v27
    ds_write2_b32 v109, v24, v25 offset0:144 offset1:152
    v_cvt_pk_bf16_f32 v28, v28, v30
    v_cvt_pk_bf16_f32 v29, v29, v31
    ds_write2_b32 v110, v28, v29 offset0:0 offset1:8
    v_cvt_pk_bf16_f32 v32, v32, v34
    v_cvt_pk_bf16_f32 v33, v33, v35
    ds_write2_b32 v110, v32, v33 offset0:144 offset1:152
    v_cvt_pk_bf16_f32 v36, v36, v38
    v_cvt_pk_bf16_f32 v37, v37, v39
    ds_write2_b32 v111, v36, v37 offset0:0 offset1:8
    v_cvt_pk_bf16_f32 v40, v40, v42
    v_cvt_pk_bf16_f32 v41, v41, v43
    ds_write2_b32 v111, v40, v41 offset0:144 offset1:152
CV_e:
    v_mov_b32 v8, 162824
    v_mov_b32 v9, 1
    s_waitcnt lgkmcnt(0)
    s_mov_b64 exec, 1
    ds_add_u32 v8, v9
    s_mov_b64 exec, -1
    v_mov_b32 v8, 162824
spin_3:
    ds_read_b32 v9, v8
    s_waitcnt lgkmcnt(0)
    v_readfirstlane_b32 s53, v9
    s_nop 0
    s_cmp_ge_u32 s53, 8
    s_cbranch_scc0 spin_3
    ds_read_b64_tr_b16 v[120:121], v103 offset:0
    ds_read_b64_tr_b16 v[122:123], v103 offset:32
    ds_read_b64_tr_b16 v[124:125], v103 offset:288
    ds_read_b64_tr_b16 v[126:127], v103 offset:320
    ds_read_b64_tr_b16 v[128:129], v103 offset:576
    ds_read_b64_tr_b16 v[130:131], v103 offset:608
    ds_read_b64_tr_b16 v[132:133], v103 offset:864
    ds_read_b64_tr_b16 v[134:135], v103 offset:896
    s_waitcnt lgkmcnt(6)
    buffer_store_dwordx4 v[120:123], v2, s[20:23], s44 offen offset:0 sc1
    s_waitcnt lgkmcnt(4)
    buffer_store_dwordx4 v[124:127], v2, s[20:23], s44 offen offset:1024 sc1
    s_waitcnt lgkmcnt(2)
    buffer_store_dwordx4 v[128:131], v2, s[20:23], s44 offen offset:2048 sc1
    s_waitcnt lgkmcnt(0)
    buffer_store_dwordx4 v[132:135], v2, s[20:23], s44 offen offset:3072 sc1
    s_waitcnt vmcnt(4)
    s_branch FR_end
FR_b:
    v_lshrrev_b32 v10, 2, v1
    v_lshlrev_b32 v74, 7, v10
    v_bfe_u32 v10, v10, 1, 2
    s_and_b32 s35, s30, 2
    v_and_b32 v11, 1, v1
    v_or_b32 v11, s35, v11
    v_xor_b32 v10, v10, v11
    v_lshl_add_u32 v74, v10, 5, v74
    v_and_b32 v10, 2, v1
    v_lshl_add_u32 v74, v10, 2, v74
    s_and_b32 s35, s30, 1
    s_lshl_b32 s35, s35, 4
    v_add_u32 v74, s35, v74
    v_add_u32 v75, 65536, v74
    v_add_u32 v76, 131072, v74
    s_and_b32 s36, s30, 3
    s_lshl_b32 s36, s36, 14
    s_lshl_b32 s48, s29, 7
    s_add_u32 s48, s48, s36
    s_cmp_lg_u32 s30, 5
    s_cbranch_scc1 FB_np
    s_waitcnt vmcnt(8)
    s_lshl_b32 s42, s2, 14
    s_add_u32 s42, s42, 29360128
    s_memtime s[34:35]
    s_waitcnt lgkmcnt(0)
    s_load_dword s32, s[4:5], s42 offset:0 glc
    s_waitcnt lgkmcnt(0)
    s_memtime s[40:41]
    s_waitcnt lgkmcnt(0)
    s_sub_u32 s46, s40, s34
    s_memtime s[34:35]
    s_waitcnt lgkmcnt(0)
    s_load_dword s32, s[4:5], s42 offset:8192 glc
    s_waitcnt lgkmcnt(0)
    s_memtime s[40:41]
    s_waitcnt lgkmcnt(0)
    s_sub_u32 s47, s40, s34
    s_cmp_lt_u32 s47, s46
    s_cselect_b32 s45, 1, 0
    s_lshr_b32 s46, s28, 2
    s_xor_b32 s45, s45, s46
    s_lshr_b32 s46, s2, 7
    s_xor_b32 s45, s45, s46
    s_and_b32 s45, s45, 1
    s_lshl_b32 s45, s45, 1
FB_np:
    s_lshr_b32 s53, s28, 3
    s_lshl_b32 s53, s53, 2
    s_and_b32 s54, s28, 3
    s_add_u32 s53, s53, s54
    s_lshl_b32 s53, s53, 23
    s_lshr_b32 s54, s28, 2
    s_xor_b32 s54, s54, s94
    s_and_b32 s54, s54, 1
    s_lshl_b32 s54, s54, 13
    s_add_u32 s37, s53, s54
    s_add_u32 s37, s37, 33554432
    s_andn2_b32 s37, s37, 0x2000
    s_lshl_b32 s43, s29, 7
    s_add_u32 s37, s37, s43
    s_add_u32 s37, s37, 1835008
    s_add_u32 s43, s43, 23068672
    v_mov_b32 v102, s52
    v_and_b32 v103, 1, v1
    v_lshlrev_b32 v103, 13, v103
    v_bfe_u32 v104, v1, 1, 1
    v_lshl_add_u32 v103, v104, 26, v103
    v_lshrrev_b32 v104, 2, v1
    v_lshl_add_u32 v103, v104, 11, v103
    s_waitcnt vmcnt(0) lgkmcnt(0)
    s_barrier
    ds_read_b64_tr_b16 v[132:133], v75 offset:24576
    ds_read_b64_tr_b16 v[134:135], v75 offset:26624
    ds_read_b64_tr_b16 v[140:141], v75 offset:28672
    ds_read_b64_tr_b16 v[142:143], v75 offset:30720
    ds_read_b64_tr_b16 v[148:149], v75 offset:32768
    ds_read_b64_tr_b16 v[150:151], v75 offset:34816
    ds_read_b64_tr_b16 v[156:157], v75 offset:36864
    ds_read_b64_tr_b16 v[158:159], v75 offset:38912
    ds_read_b64_tr_b16 v[164:165], v75 offset:40960
    ds_read_b64_tr_b16 v[166:167], v75 offset:43008
    ds_read_b64_tr_b16 v[172:173], v75 offset:45056
    ds_read_b64_tr_b16 v[174:175], v75 offset:47104
    ds_read_b64_tr_b16 v[180:181], v75 offset:49152
    ds_read_b64_tr_b16 v[182:183], v75 offset:51200
    ds_read_b64_tr_b16 v[188:189], v75 offset:53248
    ds_read_b64_tr_b16 v[190:191], v75 offset:55296
    ds_read_b64_tr_b16 v[196:197], v75 offset:57344
    ds_read_b64_tr_b16 v[198:199], v75 offset:59392
    ds_read_b64_tr_b16 v[204:205], v75 offset:61440
    ds_read_b64_tr_b16 v[206:207], v75 offset:63488
    ds_read_b64_tr_b16 v[212:213], v76 offset:0
    ds_read_b64_tr_b16 v[214:215], v76 offset:2048
    ds_read_b64_tr_b16 v[220:221], v76 offset:4096
    ds_read_b64_tr_b16 v[222:223], v76 offset:6144
    ds_read_b64_tr_b16 v[228:229], v76 offset:8192
    ds_read_b64_tr_b16 v[230:231], v76 offset:10240
    ds_read_b64_tr_b16 v[236:237], v76 offset:12288
    ds_read_b64_tr_b16 v[238:239], v76 offset:14336
    ds_read_b64_tr_b16 v[244:245], v76 offset:16384
    ds_read_b64_tr_b16 v[246:247], v76 offset:18432
    ds_read_b64_tr_b16 v[252:253], v76 offset:20480
    ds_read_b64_tr_b16 v[254:255], v76 offset:22528
    s_waitcnt lgkmcnt(0)
    s_barrier
    s_cmp_lg_u32 s30, 5
    s_cbranch_scc1 FB_na
    s_lshl_b32 s36, s2, 7
    s_add_u32 s36, s36, 23592960
    s_add_u32 s45, s45, s52
    v_mov_b32 v8, s45
    s_mov_b64 exec, 1
    buffer_store_dword v8, v2, s[56:59], s36 offen sc1
    s_mov_b64 exec, -1
FB_na:
    buffer_load_dwordx4 v[12:15], v2, s[80:83], s50 offen
    s_sub_u32 s50, s50, 4096
    buffer_load_dwordx4 v[12:15], v2, s[80:83], s50 offen
    s_sub_u32 s50, s50, 4096
    buffer_load_dwordx2 v[86:87], v80, s[8:11], 0 offen offset:0 nt
    buffer_load_dwordx2 v[88:89], v80, s[8:11], 0 offen offset:32 nt
    buffer_load_dwordx2 v[90:91], v80, s[8:11], 0 offen offset:128 nt
    buffer_load_dwordx2 v[92:93], v80, s[8:11], 0 offen offset:160 nt
    s_setprio 0
    s_cmp_lg_u32 s30, 4
    s_cbranch_scc1 FB_ni
    s_mov_b64 exec, 0xfff
    buffer_store_dword v102, v103, s[56:59], s37 offen sc1
    s_cmp_lg_u32 s28, 0
    s_cbranch_scc1 FB_n2
    s_mov_b64 exec, 3
    buffer_store_dword v102, v103, s[56:59], s43 offen sc1
FB_n2:
    s_mov_b64 exec, -1
FB_ni:
    s_add_u32 s36, s48, 0
    buffer_load_dwordx4 v[128:131], v118, s[88:91], s36 offen
    s_add_u32 s36, s36, 65536
    buffer_load_dwordx4 v[136:139], v118, s[88:91], s36 offen
    s_add_u32 s36, s48, 131072
    buffer_load_dwordx4 v[144:147], v118, s[88:91], s36 offen
    s_add_u32 s36, s36, 65536
    buffer_load_dwordx4 v[152:155], v118, s[88:91], s36 offen
    s_and_b32 s49, s30, 3
    s_lshl_b32 s36, s49, 14
    s_lshl_b32 s48, s29, 7
    s_add_u32 s48, s48, s36
    s_lshl_b32 s49, s49, 10
    s_xor_b32 s48, s48, 128
    s_add_u32 s36, s48, 1441792
    s_add_u32 m0, s49, 114688
    s_nop 0
    buffer_load_dwordx4 v118, s[80:83], s36 offen lds
    s_add_u32 s36, s36, 65536
    s_add_u32 m0, s49, 118784
    s_nop 0
    buffer_load_dwordx4 v118, s[80:83], s36 offen lds
    s_add_u32 s36, s48, 1572864
    s_add_u32 m0, s49, 122880
    s_nop 0
    buffer_load_dwordx4 v118, s[80:83], s36 offen lds
    s_add_u32 s36, s36, 65536
    s_add_u32 m0, s49, 126976
    s_nop 0
    buffer_load_dwordx4 v118, s[80:83], s36 offen lds
    s_add_u32 s36, s48, 1966080
    s_add_u32 m0, s49, 147456
    s_nop 0
    buffer_load_dwordx4 v118, s[80:83], s36 offen lds
    s_add_u32 s36, s36, 65536
    s_add_u32 m0, s49, 151552
    s_nop 0
    buffer_load_dwordx4 v118, s[80:83], s36 offen lds
    s_add_u32 s36, s48, 1703936
    s_add_u32 m0, s49, 131072
    s_nop 0
    buffer_load_dwordx4 v118, s[80:83], s36 offen lds
    s_add_u32 s36, s36, 65536
    s_add_u32 m0, s49, 135168
    s_nop 0
    buffer_load_dwordx4 v118, s[80:83], s36 offen lds
    s_add_u32 s36, s48, 1835008
    s_add_u32 m0, s49, 139264
    s_nop 0
    buffer_load_dwordx4 v118, s[80:83], s36 offen lds
    s_add_u32 s36, s36, 65536
    s_add_u32 m0, s49, 143360
    s_nop 0
    buffer_load_dwordx4 v118, s[80:83], s36 offen lds
    s_waitcnt vmcnt(14)
    v_mov_b32 v6, 162824
    v_mov_b32 v7, 1
    s_waitcnt lgkmcnt(0)
    s_mov_b64 exec, 1
    ds_add_u32 v6, v7
    s_mov_b64 exec, -1
    s_add_u32 s36, s48, 393216
    buffer_load_dwordx4 v[28:31], v118, s[80:83], s36 offen
    s_add_u32 s36, s36, 65536
    buffer_load_dwordx4 v[32:35], v118, s[80:83], s36 offen
    s_add_u32 s36, s48, 524288
    buffer_load_dwordx4 v[36:39], v118, s[80:83], s36 offen
    s_add_u32 s36, s36, 65536
    buffer_load_dwordx4 v[40:43], v118, s[80:83], s36 offen
    s_add_u32 s36, s48, 655360
    buffer_load_dwordx4 v[52:55], v118, s[80:83], s36 offen
    s_add_u32 s36, s36, 65536
    buffer_load_dwordx4 v[56:59], v118, s[80:83], s36 offen
    s_add_u32 s36, s48, 786432
    buffer_load_dwordx4 v[60:63], v118, s[80:83], s36 offen
    s_add_u32 s36, s36, 65536
    buffer_load_dwordx4 v[64:67], v118, s[80:83], s36 offen
    s_add_u32 s36, s48, 0
    buffer_load_dwordx4 v[94:97], v118, s[80:83], s36 offen
    s_add_u32 s36, s36, 65536
    buffer_load_dwordx4 v[98:101], v118, s[80:83], s36 offen
    s_xor_b32 s48, s48, 128
    s_add_u32 s36, s48, 262144
    buffer_load_dwordx4 v[160:163], v118, s[88:91], s36 offen
    s_add_u32 s36, s36, 65536
    buffer_load_dwordx4 v[168:171], v118, s[88:91], s36 offen
    s_add_u32 s36, s48, 393216
    buffer_load_dwordx4 v[176:179], v118, s[88:91], s36 offen
    s_add_u32 s36, s36, 65536
    buffer_load_dwordx4 v[184:187], v118, s[88:91], s36 offen
    s_add_u32 s36, s48, 524288
    buffer_load_dwordx4 v[192:195], v118, s[88:91], s36 offen
    s_add_u32 s36, s36, 65536
    buffer_load_dwordx4 v[200:203], v118, s[88:91], s36 offen
    s_and_b32 s42, s30, 3
    s_lshl_b32 s42, s42, 13
    s_add_u32 s42, s42, 23592960
    v_lshlrev_b32 v8, 7, v1
    buffer_load_dword v10, v8, s[56:59], s42 offen sc1
    s_add_u32 s36, s48, 655360
    buffer_load_dwordx4 v[208:211], v118, s[88:91], s36 offen
    s_add_u32 s36, s36, 65536
    buffer_load_dwordx4 v[216:219], v118, s[88:91], s36 offen
    s_add_u32 s36, s48, 786432
    buffer_load_dwordx4 v[224:227], v118, s[88:91], s36 offen
    s_add_u32 s36, s36, 65536
    buffer_load_dwordx4 v[232:235], v118, s[88:91], s36 offen
    s_add_u32 s36, s48, 917504
    buffer_load_dwordx4 v[240:243], v118, s[88:91], s36 offen
    s_add_u32 s36, s36, 65536
    buffer_load_dwordx4 v[248:251], v118, s[88:91], s36 offen
    s_setprio 0
    s_mov_b32 s53, 0
    s_waitcnt vmcnt(6)
R_fp:
    v_and_b32 v11, -3, v10
    v_cmp_eq_u32 vcc, s52, v11
    s_nop 0
    s_cmp_eq_u64 vcc, exec
    s_cbranch_scc1 R_fq
    s_sleep 3
    buffer_load_dword v10, v8, s[56:59], s42 offen sc1
    s_waitcnt vmcnt(0)
    s_add_u32 s53, s53, 1
    s_cmp_lt_u32 s53, s61
    s_cbranch_scc1 R_fp
    s_mov_b32 s61, 0
R_fq:
    v_cmp_ne_u32 vcc, s52, v10
    s_nop 0
    s_bcnt1_i32_b64 s36, vcc
    v_mov_b32 v10, s36
    v_mov_b32 v11, 162844
    s_mov_b64 exec, 1
    ds_add_u32 v11, v10
    s_mov_b64 exec, -1
FR_end:
    v_and_b32 v81, 7, v0
    v_lshlrev_b32 v72, 6, v81
    v_add_u32 v72, 161792, v72
    s_lshl_b32 s35, s30, 3
    v_add_u32 v71, s35, v72
    v_lshlrev_b32 v12, 16, v86
    v_and_b32 v13, 0xffff0000, v86
    v_lshlrev_b32 v14, 16, v87
    v_and_b32 v15, 0xffff0000, v87
    v_lshlrev_b32 v16, 16, v88
    v_and_b32 v17, 0xffff0000, v88
    v_lshlrev_b32 v18, 16, v89
    v_and_b32 v19, 0xffff0000, v89
    v_lshlrev_b32 v20, 16, v90
    v_and_b32 v21, 0xffff0000, v90
    v_lshlrev_b32 v22, 16, v91
    v_and_b32 v23, 0xffff0000, v91
    v_lshlrev_b32 v24, 16, v92
    v_and_b32 v25, 0xffff0000, v92
    v_lshlrev_b32 v26, 16, v93
    v_and_b32 v27, 0xffff0000, v93
    v_pk_add_f32 v[48:49], v[12:13], v[14:15]
    v_pk_mul_f32 v[50:51], v[12:13], v[12:13]
    v_pk_fma_f32 v[50:51], v[14:15], v[14:15], v[50:51]
    v_pk_add_f32 v[48:49], v[48:49], v[16:17]
    v_pk_fma_f32 v[50:51], v[16:17], v[16:17], v[50:51]
    v_pk_add_f32 v[48:49], v[48:49], v[18:19]
    v_pk_fma_f32 v[50:51], v[18:19], v[18:19], v[50:51]
    v_pk_add_f32 v[48:49], v[48:49], v[20:21]
    v_pk_fma_f32 v[50:51], v[20:21], v[20:21], v[50:51]
    v_pk_add_f32 v[48:49], v[48:49], v[22:23]
    v_pk_fma_f32 v[50:51], v[22:23], v[22:23], v[50:51]
    v_pk_add_f32 v[48:49], v[48:49], v[24:25]
    v_pk_fma_f32 v[50:51], v[24:25], v[24:25], v[50:51]
    v_pk_add_f32 v[48:49], v[48:49], v[26:27]
    v_pk_fma_f32 v[50:51], v[26:27], v[26:27], v[50:51]
    v_add_f32 v46, v48, v49
    v_add_f32 v47, v50, v51
    s_nop 0
    v_add_f32_dpp v46, v46, v46 row_ror:8 row_mask:0xf bank_mask:0xf
    v_add_f32_dpp v47, v47, v47 row_ror:8 row_mask:0xf bank_mask:0xf
    v_mov_b32 v48, v46
    v_mov_b32 v49, v47
    s_nop 0
    v_permlane16_swap_b32 v46, v48
    v_permlane16_swap_b32 v47, v49
    v_pk_add_f32 v[46:47], v[46:47], v[48:49]
    v_mov_b32 v48, v46
    v_mov_b32 v49, v47
    s_nop 0
    v_permlane32_swap_b32 v46, v48
    v_permlane32_swap_b32 v47, v49
    v_pk_add_f32 v[46:47], v[46:47], v[48:49]
    ds_write_b64 v71, v[46:47] offset:0
    s_waitcnt lgkmcnt(0)
    s_barrier
LAYER:
    v_and_b32 v81, 7, v0
    v_lshlrev_b32 v72, 6, v81
    v_add_u32 v72, 161792, v72
    s_lshl_b32 s35, s30, 3
    v_add_u32 v71, s35, v72
    v_lshrrev_b32 v6, 2, v1
    v_lshlrev_b32 v74, 7, v6
    v_bfe_u32 v6, v6, 1, 2
    s_and_b32 s35, s30, 2
    v_and_b32 v7, 1, v1
    v_or_b32 v7, s35, v7
    v_xor_b32 v6, v6, v7
    v_lshl_add_u32 v74, v6, 5, v74
    v_and_b32 v6, 2, v1
    v_lshl_add_u32 v74, v6, 2, v74
    s_and_b32 s35, s30, 1
    s_lshl_b32 s35, s35, 4
    v_add_u32 v74, s35, v74
    v_add_u32 v75, 65536, v74
    v_add_u32 v76, 131072, v74
    s_cmp_eq_u32 s60, 0
    s_cbranch_scc1 R_l0
    s_sub_u32 s12, s62, 0x3b80000
    s_subb_u32 s13, s63, 0
    s_mov_b32 s14, 0x7e000
    s_mov_b32 s15, 0x20000
    s_lshl_b32 s22, s60, 24
    s_lshl_b32 s23, s94, 13
    s_add_u32 s22, s22, s23
    s_add_u32 s22, s22, 167772160
    s_add_u32 s20, s4, s22
    s_addc_u32 s21, s5, 0
    s_mov_b32 s22, 8380416
    s_mov_b32 s23, 0x20000
    buffer_load_dwordx4 v[86:89], v78, s[12:15], 0 offen offset:0 sc1
    buffer_load_dwordx4 v[90:93], v78, s[12:15], 0 offen offset:2048 sc1
    s_waitcnt vmcnt(2)
    v_lshlrev_b32 v102, 16, v110
    v_and_b32 v103, 0xffff0000, v110
    v_lshlrev_b32 v104, 16, v111
    v_and_b32 v105, 0xffff0000, v111
    v_lshlrev_b32 v106, 16, v112
    v_and_b32 v107, 0xffff0000, v112
    v_lshlrev_b32 v108, 16, v113
    v_and_b32 v109, 0xffff0000, v113
    v_lshlrev_b32 v110, 16, v114
    v_and_b32 v111, 0xffff0000, v114
    v_lshlrev_b32 v112, 16, v115
    v_and_b32 v113, 0xffff0000, v115
    v_lshlrev_b32 v114, 16, v116
    v_and_b32 v115, 0xffff0000, v116
    v_lshlrev_b32 v116, 16, v117
    v_and_b32 v117, 0xffff0000, v117
    s_mov_b32 s53, 0
dw_4:
    s_waitcnt vmcnt(0)
    v_and_b32 v6, v86, v87
    v_and_b32 v7, v90, v91
    v_bitop3_b32 v6, v88, v89, v6 bitop3:0x80
    v_bitop3_b32 v7, v92, v93, v7 bitop3:0x80
    v_bitop3_b32 v6, v6, v7, 1 bitop3:0x80
    v_cmp_eq_u32 vcc, 0, v6
    s_nop 0
    s_cmp_eq_u64 vcc, 0
    s_cbranch_scc1 dok_5
    s_mov_b64 exec, vcc
    s_sleep 2
    buffer_load_dwordx4 v[86:89], v78, s[12:15], 0 offen offset:0 sc1
    buffer_load_dwordx4 v[90:93], v78, s[12:15], 0 offen offset:2048 sc1
    s_add_u32 s53, s53, 1
    s_cmp_lt_u32 s53, s61
    s_cbranch_scc1 dw_4
    s_mov_b32 s61, 0
    s_waitcnt vmcnt(0)
dok_5:
    s_mov_b64 exec, -1
    s_mov_b32 s36, 0x3f803f80
    v_dot2_f32_bf16 v48, v86, s36, 0
    v_dot2_f32_bf16 v50, v86, v86, 0
    v_dot2_f32_bf16 v49, v87, s36, 0
    v_dot2_f32_bf16 v51, v87, v87, 0
    v_dot2_f32_bf16 v48, v88, s36, v48
    v_dot2_f32_bf16 v50, v88, v88, v50
    v_dot2_f32_bf16 v49, v89, s36, v49
    v_dot2_f32_bf16 v51, v89, v89, v51
    v_dot2_f32_bf16 v48, v90, s36, v48
    v_dot2_f32_bf16 v50, v90, v90, v50
    v_dot2_f32_bf16 v49, v91, s36, v49
    v_dot2_f32_bf16 v51, v91, v91, v51
    v_dot2_f32_bf16 v48, v92, s36, v48
    v_dot2_f32_bf16 v50, v92, v92, v50
    v_dot2_f32_bf16 v49, v93, s36, v49
    v_dot2_f32_bf16 v51, v93, v93, v51
    s_nop 2
    v_add_f32 v46, v48, v49
    v_add_f32 v47, v50, v51
    s_nop 0
    v_add_f32_dpp v46, v46, v46 row_ror:8 row_mask:0xf bank_mask:0xf
    v_add_f32_dpp v47, v47, v47 row_ror:8 row_mask:0xf bank_mask:0xf
    v_mov_b32 v48, v46
    v_mov_b32 v49, v47
    s_nop 0
    v_permlane16_swap_b32 v46, v48
    v_permlane16_swap_b32 v47, v49
    v_pk_add_f32 v[46:47], v[46:47], v[48:49]
    v_mov_b32 v48, v46
    v_mov_b32 v49, v47
    s_nop 0
    v_permlane32_swap_b32 v46, v48
    v_permlane32_swap_b32 v47, v49
    v_pk_add_f32 v[46:47], v[46:47], v[48:49]
    ds_write_b64 v71, v[46:47] offset:0
    v_lshlrev_b32 v12, 16, v86
    v_and_b32 v13, 0xffff0000, v86
    v_lshlrev_b32 v14, 16, v87
    v_and_b32 v15, 0xffff0000, v87
    v_lshlrev_b32 v16, 16, v88
    v_and_b32 v17, 0xffff0000, v88
    v_lshlrev_b32 v18, 16, v89
    v_and_b32 v19, 0xffff0000, v89
    v_lshlrev_b32 v20, 16, v90
    v_and_b32 v21, 0xffff0000, v90
    v_lshlrev_b32 v22, 16, v91
    v_and_b32 v23, 0xffff0000, v91
    v_lshlrev_b32 v24, 16, v92
    v_and_b32 v25, 0xffff0000, v92
    v_lshlrev_b32 v26, 16, v93
    v_and_b32 v27, 0xffff0000, v93
    s_waitcnt lgkmcnt(0)
    s_barrier
    ds_read_b128 v[52:55], v72 offset:0
    ds_read_b128 v[56:59], v72 offset:16
    ds_read_b128 v[60:63], v72 offset:32
    ds_read_b128 v[64:67], v72 offset:48
    s_waitcnt lgkmcnt(0)
    v_pk_add_f32 v[52:53], v[52:53], v[54:55]
    v_pk_add_f32 v[56:57], v[56:57], v[58:59]
    v_pk_add_f32 v[60:61], v[60:61], v[62:63]
    v_pk_add_f32 v[64:65], v[64:65], v[66:67]
    v_pk_add_f32 v[52:53], v[52:53], v[56:57]
    v_pk_add_f32 v[60:61], v[60:61], v[64:65]
    v_pk_add_f32 v[52:53], v[52:53], v[60:61]
    v_mul_f32 v68, 0x3a800000, v52
    v_mul_f32 v70, 0x3a800000, v53
    v_fma_f32 v70, -v68, v68, v70
    v_max_f32 v70, 0, v70
    v_add_f32 v70, 0x3727c5ac, v70
    v_rsq_f32 v69, v70
    s_nop 0
    v_mul_f32 v68, -v68, v69
    v_pk_fma_f32 v[28:29], v[12:13], v[68:69], v[68:69] op_sel:[0,1,0] op_sel_hi:[1,1,0]
    v_pk_fma_f32 v[30:31], v[14:15], v[68:69], v[68:69] op_sel:[0,1,0] op_sel_hi:[1,1,0]
    v_pk_fma_f32 v[32:33], v[16:17], v[68:69], v[68:69] op_sel:[0,1,0] op_sel_hi:[1,1,0]
    v_pk_fma_f32 v[34:35], v[18:19], v[68:69], v[68:69] op_sel:[0,1,0] op_sel_hi:[1,1,0]
    v_pk_fma_f32 v[36:37], v[20:21], v[68:69], v[68:69] op_sel:[0,1,0] op_sel_hi:[1,1,0]
    v_pk_fma_f32 v[38:39], v[22:23], v[68:69], v[68:69] op_sel:[0,1,0] op_sel_hi:[1,1,0]
    v_pk_fma_f32 v[40:41], v[24:25], v[68:69], v[68:69] op_sel:[0,1,0] op_sel_hi:[1,1,0]
    v_pk_fma_f32 v[42:43], v[26:27], v[68:69], v[68:69] op_sel:[0,1,0] op_sel_hi:[1,1,0]
    s_branch R_s2
R_l0:
    s_cmp_lt_u32 s30, 4
    s_cbranch_scc1 R_f2
    s_and_b32 s36, s30, 3
    s_lshl_b32 s36, s36, 10
    v_add_u32 v8, s36, v2
    v_add_u32 v9, 65536, v8
    ds_write_b128 v8, v[28:31] offset:49152
    ds_write_b128 v8, v[32:35] offset:53248
    ds_write_b128 v8, v[36:39] offset:57344
    ds_write_b128 v8, v[40:43] offset:61440
    ds_write_b128 v9, v[52:55] offset:0
    ds_write_b128 v9, v[56:59] offset:4096
    ds_write_b128 v9, v[60:63] offset:8192
    ds_write_b128 v9, v[64:67] offset:12288
    ds_write_b128 v8, v[94:97] offset:24576
    ds_write_b128 v8, v[98:101] offset:28672
R_f2:
    v_mov_b32 v6, 162844
    ds_read_b32 v7, v6
    ds_read_b128 v[52:55], v72 offset:0
    ds_read_b128 v[56:59], v72 offset:16
    ds_read_b128 v[60:63], v72 offset:32
    ds_read_b128 v[64:67], v72 offset:48
    s_waitcnt lgkmcnt(0)
    v_pk_add_f32 v[52:53], v[52:53], v[54:55]
    v_pk_add_f32 v[56:57], v[56:57], v[58:59]
    v_pk_add_f32 v[60:61], v[60:61], v[62:63]
    v_pk_add_f32 v[64:65], v[64:65], v[66:67]
    v_pk_add_f32 v[52:53], v[52:53], v[56:57]
    v_pk_add_f32 v[60:61], v[60:61], v[64:65]
    v_pk_add_f32 v[52:53], v[52:53], v[60:61]
    v_mul_f32 v68, 0x3a800000, v52
    v_mul_f32 v70, 0x3a800000, v53
    v_fma_f32 v70, -v68, v68, v70
    v_max_f32 v70, 0, v70
    v_add_f32 v70, 0x3727c5ac, v70
    v_rsq_f32 v69, v70
    s_nop 0
    v_mul_f32 v68, -v68, v69
    v_pk_fma_f32 v[28:29], v[12:13], v[68:69], v[68:69] op_sel:[0,1,0] op_sel_hi:[1,1,0]
    v_pk_fma_f32 v[30:31], v[14:15], v[68:69], v[68:69] op_sel:[0,1,0] op_sel_hi:[1,1,0]
    v_pk_fma_f32 v[32:33], v[16:17], v[68:69], v[68:69] op_sel:[0,1,0] op_sel_hi:[1,1,0]
    v_pk_fma_f32 v[34:35], v[18:19], v[68:69], v[68:69] op_sel:[0,1,0] op_sel_hi:[1,1,0]
    v_pk_fma_f32 v[36:37], v[20:21], v[68:69], v[68:69] op_sel:[0,1,0] op_sel_hi:[1,1,0]
    v_pk_fma_f32 v[38:39], v[22:23], v[68:69], v[68:69] op_sel:[0,1,0] op_sel_hi:[1,1,0]
    v_pk_fma_f32 v[40:41], v[24:25], v[68:69], v[68:69] op_sel:[0,1,0] op_sel_hi:[1,1,0]
    v_pk_fma_f32 v[42:43], v[26:27], v[68:69], v[68:69] op_sel:[0,1,0] op_sel_hi:[1,1,0]
    v_readfirstlane_b32 s94, v7
    s_nop 0
    s_cmp_gt_u32 s94, 127
    s_cselect_b32 s94, 1, 0
    s_lshr_b32 s53, s28, 3
    s_lshl_b32 s53, s53, 2
    s_and_b32 s54, s28, 3
    s_add_u32 s53, s53, s54
    s_lshl_b32 s53, s53, 23
    s_lshr_b32 s54, s28, 2
    s_xor_b32 s54, s54, s94
    s_and_b32 s54, s54, 1
    s_lshl_b32 s54, s54, 13
    s_add_u32 s55, s53, s54
    s_add_u32 s55, s55, 33554432
    s_add_u32 s62, s4, s55
    s_addc_u32 s63, s5, 0
    s_sub_u32 s36, s28, 1
    s_max_i32 s36, s36, 0
    s_lshr_b32 s53, s36, 3
    s_lshl_b32 s53, s53, 2
    s_and_b32 s54, s36, 3
    s_add_u32 s53, s53, s54
    s_lshl_b32 s53, s53, 23
    s_lshr_b32 s54, s36, 2
    s_xor_b32 s54, s54, s94
    s_and_b32 s54, s54, 1
    s_lshl_b32 s54, s54, 13
    s_add_u32 s92, s53, s54
    s_add_u32 s92, s92, 33554432
    s_sub_u32 s92, s92, s55
    s_add_u32 s36, s28, 1
    s_min_u32 s36, s36, 15
    s_lshr_b32 s53, s36, 3
    s_lshl_b32 s53, s53, 2
    s_and_b32 s54, s36, 3
    s_add_u32 s53, s53, s54
    s_lshl_b32 s53, s53, 23
    s_lshr_b32 s54, s36, 2
    s_xor_b32 s54, s54, s94
    s_and_b32 s54, s54, 1
    s_lshl_b32 s54, s54, 13
    s_add_u32 s93, s53, s54
    s_add_u32 s93, s93, 33554432
    s_sub_u32 s93, s93, s55
    s_add_u32 s55, s55, 1835008
    s_lshl_b32 s22, s60, 24
    s_lshl_b32 s23, s94, 13
    s_add_u32 s22, s22, s23
    s_add_u32 s22, s22, 167772160
    s_add_u32 s20, s4, s22
    s_addc_u32 s21, s5, 0
    s_mov_b32 s22, 8380416
    s_mov_b32 s23, 0x20000
    s_add_u32 s80, s4, 0x1800000
    s_addc_u32 s81, s5, 0
    s_mov_b32 s82, 0x400000
    s_mov_b32 s83, 0x20000
    s_mov_b32 s78, 0
    buffer_load_dwordx2 v[110:111], v79, s[80:83], s78 offen sc1
    s_mov_b32 s78, 65536
    buffer_load_dwordx2 v[112:113], v79, s[80:83], s78 offen sc1
    s_mov_b32 s78, 262144
    buffer_load_dwordx2 v[114:115], v79, s[80:83], s78 offen sc1
    s_mov_b32 s78, 327680
    buffer_load_dwordx2 v[116:117], v79, s[80:83], s78 offen sc1
    s_cmp_lt_u32 s30, 4
    s_cbranch_scc1 R_f3
    s_waitcnt vmcnt(4)
    s_and_b32 s36, s30, 3
    s_lshl_b32 s36, s36, 10
    v_add_u32 v8, s36, v2
    v_add_u32 v9, 65536, v8
    ds_write_b128 v8, v[128:131] offset:0
    ds_write_b128 v8, v[136:139] offset:4096
    ds_write_b128 v8, v[144:147] offset:8192
    ds_write_b128 v8, v[152:155] offset:12288
    ds_write_b128 v8, v[160:163] offset:16384
    ds_write_b128 v8, v[168:171] offset:20480
    ds_write_b128 v9, v[176:179] offset:16384
    ds_write_b128 v9, v[184:187] offset:20480
    ds_write_b128 v9, v[192:195] offset:24576
    ds_write_b128 v9, v[200:203] offset:28672
    ds_write_b128 v8, v[208:211] offset:32768
    ds_write_b128 v8, v[216:219] offset:36864
    ds_write_b128 v8, v[224:227] offset:40960
    ds_write_b128 v8, v[232:235] offset:45056
    ds_write_b128 v9, v[240:243] offset:32768
    ds_write_b128 v9, v[248:251] offset:36864
R_f3:
    s_mov_b32 s53, 0
dw_6:
    s_waitcnt vmcnt(0)
    v_and_b32 v6, v110, v111
    v_and_b32 v7, v114, v115
    v_bitop3_b32 v6, v112, v113, v6 bitop3:0x80
    v_bitop3_b32 v7, v116, v117, v7 bitop3:0x80
    v_bitop3_b32 v6, v6, v7, 1 bitop3:0x80
    v_cmp_eq_u32 vcc, 0, v6
    s_nop 0
    s_cmp_eq_u64 vcc, 0
    s_cbranch_scc1 dok_7
    s_mov_b64 exec, vcc
    s_sleep 4
    s_mov_b32 s78, 0
    buffer_load_dwordx2 v[110:111], v79, s[80:83], s78 offen sc1
    s_mov_b32 s78, 65536
    buffer_load_dwordx2 v[112:113], v79, s[80:83], s78 offen sc1
    s_mov_b32 s78, 262144
    buffer_load_dwordx2 v[114:115], v79, s[80:83], s78 offen sc1
    s_mov_b32 s78, 327680
    buffer_load_dwordx2 v[116:117], v79, s[80:83], s78 offen sc1
    s_add_u32 s53, s53, 1
    s_cmp_lt_u32 s53, s61
    s_cbranch_scc1 dw_6
    s_mov_b32 s61, 0
    s_waitcnt vmcnt(0)
dok_7:
    s_mov_b64 exec, -1
    v_lshlrev_b32 v102, 16, v110
    v_and_b32 v103, 0xffff0000, v110
    v_lshlrev_b32 v104, 16, v111
    v_and_b32 v105, 0xffff0000, v111
    v_lshlrev_b32 v106, 16, v112
    v_and_b32 v107, 0xffff0000, v112
    v_lshlrev_b32 v108, 16, v113
    v_and_b32 v109, 0xffff0000, v113
    v_lshlrev_b32 v110, 16, v114
    v_and_b32 v111, 0xffff0000, v114
    v_lshlrev_b32 v112, 16, v115
    v_and_b32 v113, 0xffff0000, v115
    v_lshlrev_b32 v114, 16, v116
    v_and_b32 v115, 0xffff0000, v116
    v_lshlrev_b32 v116, 16, v117
    v_and_b32 v117, 0xffff0000, v117
R_s2:
    v_pk_fma_f32 v[12:13], v[28:29], v[102:103], v[12:13]
    v_pk_fma_f32 v[14:15], v[30:31], v[104:105], v[14:15]
    v_pk_fma_f32 v[16:17], v[32:33], v[106:107], v[16:17]
    v_pk_fma_f32 v[18:19], v[34:35], v[108:109], v[18:19]
    v_cvt_pk_bf16_f32 v86, v12, v13
    v_cvt_pk_bf16_f32 v87, v14, v15
    v_cvt_pk_bf16_f32 v88, v16, v17
    v_cvt_pk_bf16_f32 v89, v18, v19
    buffer_store_dwordx4 v[86:89], v82, s[20:23], 0 offen offset:0 sc1
    v_pk_fma_f32 v[20:21], v[36:37], v[110:111], v[20:21]
    v_pk_fma_f32 v[22:23], v[38:39], v[112:113], v[22:23]
    v_pk_fma_f32 v[24:25], v[40:41], v[114:115], v[24:25]
    v_pk_fma_f32 v[26:27], v[42:43], v[116:117], v[26:27]
    v_cvt_pk_bf16_f32 v90, v20, v21
    v_cvt_pk_bf16_f32 v91, v22, v23
    v_cvt_pk_bf16_f32 v92, v24, v25
    v_cvt_pk_bf16_f32 v93, v26, v27
    buffer_store_dwordx4 v[90:93], v82, s[20:23], 0 offen offset:128 sc1
    v_pk_add_f32 v[48:49], v[12:13], v[14:15]
    v_pk_mul_f32 v[50:51], v[12:13], v[12:13]
    v_pk_fma_f32 v[50:51], v[14:15], v[14:15], v[50:51]
    v_pk_add_f32 v[48:49], v[48:49], v[16:17]
    v_pk_fma_f32 v[50:51], v[16:17], v[16:17], v[50:51]
    v_pk_add_f32 v[48:49], v[48:49], v[18:19]
    v_pk_fma_f32 v[50:51], v[18:19], v[18:19], v[50:51]
    v_pk_add_f32 v[48:49], v[48:49], v[20:21]
    v_pk_fma_f32 v[50:51], v[20:21], v[20:21], v[50:51]
    v_pk_add_f32 v[48:49], v[48:49], v[22:23]
    v_pk_fma_f32 v[50:51], v[22:23], v[22:23], v[50:51]
    v_pk_add_f32 v[48:49], v[48:49], v[24:25]
    v_pk_fma_f32 v[50:51], v[24:25], v[24:25], v[50:51]
    v_pk_add_f32 v[48:49], v[48:49], v[26:27]
    v_pk_fma_f32 v[50:51], v[26:27], v[26:27], v[50:51]
    v_add_f32 v46, v48, v49
    v_add_f32 v47, v50, v51
    s_nop 0
    v_add_f32_dpp v46, v46, v46 row_ror:8 row_mask:0xf bank_mask:0xf
    v_add_f32_dpp v47, v47, v47 row_ror:8 row_mask:0xf bank_mask:0xf
    v_mov_b32 v48, v46
    v_mov_b32 v49, v47
    s_nop 0
    v_permlane16_swap_b32 v46, v48
    v_permlane16_swap_b32 v47, v49
    v_pk_add_f32 v[46:47], v[46:47], v[48:49]
    v_mov_b32 v48, v46
    v_mov_b32 v49, v47
    s_nop 0
    v_permlane32_swap_b32 v46, v48
    v_permlane32_swap_b32 v47, v49
    v_pk_add_f32 v[46:47], v[46:47], v[48:49]
    ds_write_b64 v71, v[46:47] offset:1536
    s_waitcnt lgkmcnt(0)
    s_barrier
    s_cmp_ge_u32 s30, 4
    s_cbranch_scc1 LOADERS
    s_cmp_lg_u32 s30, 3
    s_cbranch_scc1 R_nl
    ds_read_b128 v[52:55], v72 offset:1536
    ds_read_b128 v[56:59], v72 offset:1552
    ds_read_b128 v[60:63], v72 offset:1568
    ds_read_b128 v[64:67], v72 offset:1584
    s_waitcnt lgkmcnt(0)
    v_pk_add_f32 v[52:53], v[52:53], v[54:55]
    v_pk_add_f32 v[56:57], v[56:57], v[58:59]
    v_pk_add_f32 v[60:61], v[60:61], v[62:63]
    v_pk_add_f32 v[64:65], v[64:65], v[66:67]
    v_pk_add_f32 v[52:53], v[52:53], v[56:57]
    v_pk_add_f32 v[60:61], v[60:61], v[64:65]
    v_pk_add_f32 v[52:53], v[52:53], v[60:61]
    v_mul_f32 v68, 0x3a800000, v52
    v_mul_f32 v70, 0x3a800000, v53
    v_fma_f32 v70, -v68, v68, v70
    v_max_f32 v70, 0, v70
    v_mov_b32 v32, v68
    v_mov_b32 v33, v70
    v_cvt_pk_bf16_f32 v68, v68, v68
    v_lshlrev_b32 v68, 16, v68
    v_cvt_pk_bf16_f32 v70, v70, v70
    v_lshlrev_b32 v70, 16, v70
    v_add_f32 v70, 0x3727c5ac, v70
    v_cvt_pk_bf16_f32 v70, v70, v70
    v_lshlrev_b32 v70, 16, v70
    v_sqrt_f32 v70, v70
    s_nop 0
    v_cvt_pk_bf16_f32 v70, v70, v70
    v_lshlrev_b32 v70, 16, v70
    v_rcp_f32 v69, v70
    v_sub_f32 v32, v32, v68
    v_mul_f32 v32, v32, v69
    v_mul_f32 v33, v33, v69
    v_mul_f32 v33, v33, v69
    v_cvt_pk_bf16_f32 v32, v32, v32
    v_lshlrev_b32 v32, 16, v32
    v_cvt_pk_bf16_f32 v33, v33, v33
    v_lshlrev_b32 v33, 16, v33
    v_add_f32 v33, 0x3727c5ac, v33
    v_cvt_pk_bf16_f32 v33, v33, v33
    v_lshlrev_b32 v33, 16, v33
    v_sqrt_f32 v33, v33
    s_nop 0
    v_cvt_pk_bf16_f32 v33, v33, v33
    v_lshlrev_b32 v33, 16, v33
    v_cvt_pk_bf16_f32 v28, v68, v70
    v_cvt_pk_bf16_f32 v30, v32, v33
    v_mov_b32 v29, s52
    v_mov_b32 v31, s52
    s_lshl_b32 s26, s60, 15
    s_add_u32 s26, s26, 23199744
    s_add_u32 s24, s4, s26
    s_addc_u32 s25, s5, 0
    s_mov_b32 s26, 32768
    s_mov_b32 s27, 0x20000
    s_lshl_b32 s36, s28, 4
    s_add_u32 s36, s36, s29
    s_lshl_b32 s36, s36, 7
    s_mov_b64 exec, 0xff
    buffer_store_dwordx4 v[28:31], v2, s[24:27], s36 offen sc1
    s_mov_b64 exec, -1
R_nl:
    v_mov_b32 v6, 1
    v_mov_b32 v7, 0
    s_cmp_eq_u32 s30, 3
    s_waitcnt vmcnt(1)
    s_cbranch_scc1 R_n2
    s_waitcnt vmcnt(0)
R_n2:
    s_barrier
    s_cmp_lg_u32 s30, 0
    s_cbranch_scc1 R_n3
    s_mov_b64 exec, 1
    buffer_atomic_add v6, v7, s[56:59], s55 offen sc1
    s_mov_b64 exec, -1
R_n3:
    ds_read_b64_tr_b16 v[180:181], v75 offset:49152
    ds_read_b64_tr_b16 v[182:183], v75 offset:51200
    ds_read_b64_tr_b16 v[188:189], v75 offset:53248
    ds_read_b64_tr_b16 v[190:191], v75 offset:55296
    ds_read_b64_tr_b16 v[196:197], v75 offset:57344
    ds_read_b64_tr_b16 v[198:199], v75 offset:59392
    ds_read_b64_tr_b16 v[204:205], v75 offset:61440
    ds_read_b64_tr_b16 v[206:207], v75 offset:63488
    ds_read_b64_tr_b16 v[244:245], v76 offset:16384
    ds_read_b64_tr_b16 v[246:247], v76 offset:18432
    ds_read_b64_tr_b16 v[252:253], v76 offset:20480
    ds_read_b64_tr_b16 v[254:255], v76 offset:22528
    ds_read_b64_tr_b16 v[212:213], v76 offset:0
    ds_read_b64_tr_b16 v[214:215], v76 offset:2048
    ds_read_b64_tr_b16 v[220:221], v76 offset:4096
    ds_read_b64_tr_b16 v[222:223], v76 offset:6144
    ds_read_b64_tr_b16 v[228:229], v76 offset:8192
    ds_read_b64_tr_b16 v[230:231], v76 offset:10240
    ds_read_b64_tr_b16 v[236:237], v76 offset:12288
    ds_read_b64_tr_b16 v[238:239], v76 offset:14336
    ds_read_b64_tr_b16 v[176:177], v74 offset:49152
    ds_read_b64_tr_b16 v[178:179], v74 offset:51200
    ds_read_b64_tr_b16 v[184:185], v74 offset:53248
    ds_read_b64_tr_b16 v[186:187], v74 offset:55296
    ds_read_b64_tr_b16 v[192:193], v74 offset:57344
    ds_read_b64_tr_b16 v[194:195], v74 offset:59392
    ds_read_b64_tr_b16 v[200:201], v74 offset:61440
    ds_read_b64_tr_b16 v[202:203], v74 offset:63488
    ds_read_b64_tr_b16 v[208:209], v75 offset:0
    ds_read_b64_tr_b16 v[210:211], v75 offset:2048
    ds_read_b64_tr_b16 v[216:217], v75 offset:4096
    ds_read_b64_tr_b16 v[218:219], v75 offset:6144
    ds_read_b64_tr_b16 v[224:225], v75 offset:8192
    ds_read_b64_tr_b16 v[226:227], v75 offset:10240
    ds_read_b64_tr_b16 v[232:233], v75 offset:12288
    ds_read_b64_tr_b16 v[234:235], v75 offset:14336
    ds_read_b64_tr_b16 v[128:129], v74 offset:24576
    ds_read_b64_tr_b16 v[130:131], v74 offset:26624
    ds_read_b64_tr_b16 v[136:137], v74 offset:28672
    ds_read_b64_tr_b16 v[138:139], v74 offset:30720
    v_and_b32 v8, 15, v1
    v_lshrrev_b32 v9, 4, v1
    v_xor_b32 v6, v9, v8
    v_lshlrev_b32 v7, 8, v8
    v_xor_b32 v10, 0, v6
    v_lshl_add_u32 v10, v10, 4, v7
    v_add_u32 v14, 106496, v10
    v_xor_b32 v11, 4, v6
    v_lshl_add_u32 v11, v11, 4, v7
    v_add_u32 v15, 106496, v11
    v_xor_b32 v12, 8, v6
    v_lshl_add_u32 v12, v12, 4, v7
    v_add_u32 v16, 106496, v12
    v_xor_b32 v13, 12, v6
    v_lshl_add_u32 v13, v13, 4, v7
    v_add_u32 v17, 106496, v13
    v_lshlrev_b32 v18, 4, v8
    v_add_u32 v18, 155648, v18
    s_add_u32 s16, s62, 0x400000
    s_addc_u32 s17, s63, 0
    s_mov_b32 s18, 0x7e000
    s_mov_b32 s19, 0x20000
    v_and_b32 v6, 1, v9
    v_lshlrev_b32 v114, 16, v6
    v_lshrrev_b32 v6, 1, v9
    v_lshl_add_u32 v114, v6, 8, v114
    v_lshl_add_u32 v114, v8, 4, v114
    s_bfe_u32 s36, s30, 0x10001
    s_lshl1_add_u32 s36, s29, s36
    s_xor_b32 s36, s36, 2
    s_lshr_b32 s53, s36, 3
    s_lshl_b32 s53, s53, 14
    s_and_b32 s39, s36, 7
    s_lshl_b32 s39, s39, 10
    s_add_u32 s39, s39, s53
    s_and_b32 s36, s30, 1
    s_lshl_b32 s36, s36, 9
    s_add_u32 s39, s39, s36
    s_and_b32 s8, s30, 3
    s_lshl_b32 s8, s8, 15
    s_and_b32 s53, s30, 2
    s_lshl_b32 s53, s53, 11
    s_and_b32 s12, s30, 1
    s_lshl_b32 s12, s12, 13
    s_add_u32 s12, s12, s53
    s_and_b32 s20, s30, 1
    s_lshl_b32 s20, s20, 8
    s_add_u32 s20, s20, s55
    s_add_u32 s21, s52, 16
    v_mov_b32 v112, 0x7f000000
    v_writelane_b32 v112, 0, 0
    v_mov_b32 v113, 1
    s_and_b32 s40, s30, 1
    s_lshl1_add_u32 s40, s31, s40
    s_lshl_b32 s40, s40, 7
    s_add_u32 s40, s40, s55
    v_mov_b32 v88, 0x3f803f80
    v_mov_b32 v89, 0x3f803f80
    v_mov_b32 v90, 0x3f803f80
    v_mov_b32 v91, 0x3f803f80
    s_waitcnt lgkmcnt(0)
    s_nop 0
    v_mfma_f32_16x16x32_bf16 v[84:87], v[180:183], v[88:91], 0
    v_mfma_f32_16x16x32_bf16 v[84:87], v[188:191], v[88:91], v[84:87]
    v_mfma_f32_16x16x32_bf16 v[84:87], v[196:199], v[88:91], v[84:87]
    v_mfma_f32_16x16x32_bf16 v[84:87], v[204:207], v[88:91], v[84:87]
    v_mfma_f32_16x16x32_bf16 v[84:87], v[244:247], v[88:91], v[84:87]
    v_mfma_f32_16x16x32_bf16 v[84:87], v[252:255], v[88:91], v[84:87]
    v_mfma_f32_16x16x32_bf16 v[84:87], v[212:215], v[88:91], v[84:87]
    v_mfma_f32_16x16x32_bf16 v[84:87], v[220:223], v[88:91], v[84:87]
    v_mfma_f32_16x16x32_bf16 v[84:87], v[228:231], v[88:91], v[84:87]
    v_mfma_f32_16x16x32_bf16 v[84:87], v[236:239], v[88:91], v[84:87]
    v_mfma_f32_16x16x32_bf16 v[84:87], v[176:179], v[88:91], v[84:87]
    v_mfma_f32_16x16x32_bf16 v[84:87], v[184:187], v[88:91], v[84:87]
    v_mfma_f32_16x16x32_bf16 v[84:87], v[192:195], v[88:91], v[84:87]
    v_mfma_f32_16x16x32_bf16 v[84:87], v[200:203], v[88:91], v[84:87]
    v_mfma_f32_16x16x32_bf16 v[84:87], v[208:211], v[88:91], v[84:87]
    v_mfma_f32_16x16x32_bf16 v[84:87], v[216:219], v[88:91], v[84:87]
    v_mfma_f32_16x16x32_bf16 v[84:87], v[224:227], v[88:91], v[84:87]
    v_mfma_f32_16x16x32_bf16 v[84:87], v[232:235], v[88:91], v[84:87]
    v_mfma_f32_16x16x32_bf16 v[84:87], v[128:131], v[88:91], v[84:87]
    v_mfma_f32_16x16x32_bf16 v[84:87], v[136:139], v[88:91], v[84:87]
    s_cmp_lg_u32 s30, 0
    s_cbranch_scc1 pdone_8
    s_add_u32 s54, s55, 0
    s_bitcmp1_b32 s29, 2
    s_cselect_b32 s53, s93, s92
    s_add_u32 s53, s53, s54
    v_mov_b32 v105, s54
    v_writelane_b32 v105, s53, 1
    s_mov_b32 s53, 0
    s_add_u32 s54, s52, 16
    s_bfm_b64 exec, 2, 0
poll_9:
    buffer_load_dword v104, v105, s[56:59], 0 offen sc1
    s_waitcnt vmcnt(0)
    v_cmp_eq_u32 vcc, s54, v104
    s_nop 0
    s_cmp_eq_u64 vcc, exec
    s_cbranch_scc1 pok_10
    s_sleep 3
    s_add_u32 s53, s53, 1
    s_cmp_lt_u32 s53, s61
    s_cbranch_scc1 poll_9
    s_mov_b32 s61, 0
pok_10:
    s_mov_b64 exec, -1
pdone_8:
    s_waitcnt lgkmcnt(0)
    s_barrier
    ds_read_b64_tr_b16 v[240:241], v75 offset:16384
    ds_read_b64_tr_b16 v[242:243], v75 offset:18432
    ds_read_b64_tr_b16 v[248:249], v75 offset:20480
    ds_read_b64_tr_b16 v[250:251], v75 offset:22528
    ds_read_b64_tr_b16 v[132:133], v75 offset:24576
    ds_read_b64_tr_b16 v[134:135], v75 offset:26624
    ds_read_b64_tr_b16 v[140:141], v75 offset:28672
    ds_read_b64_tr_b16 v[142:143], v75 offset:30720
    ds_read_b64_tr_b16 v[144:145], v74 offset:32768
    ds_read_b64_tr_b16 v[146:147], v74 offset:34816
    ds_read_b64_tr_b16 v[152:153], v74 offset:36864
    ds_read_b64_tr_b16 v[154:155], v74 offset:38912
    ds_read_b64_tr_b16 v[160:161], v74 offset:40960
    ds_read_b64_tr_b16 v[162:163], v74 offset:43008
    ds_read_b64_tr_b16 v[168:169], v74 offset:45056
    ds_read_b64_tr_b16 v[170:171], v74 offset:47104
    ds_read_b64_tr_b16 v[148:149], v75 offset:32768
    ds_read_b64_tr_b16 v[150:151], v75 offset:34816
    ds_read_b64_tr_b16 v[156:157], v75 offset:36864
    ds_read_b64_tr_b16 v[158:159], v75 offset:38912
    ds_read_b64_tr_b16 v[164:165], v75 offset:40960
    ds_read_b64_tr_b16 v[166:167], v75 offset:43008
    ds_read_b64_tr_b16 v[172:173], v75 offset:45056
    ds_read_b64_tr_b16 v[174:175], v75 offset:47104
    s_waitcnt lgkmcnt(12)
    v_mfma_f32_16x16x32_bf16 v[84:87], v[240:243], v[88:91], v[84:87]
    v_mfma_f32_16x16x32_bf16 v[84:87], v[248:251], v[88:91], v[84:87]
    v_mfma_f32_16x16x32_bf16 v[84:87], v[132:135], v[88:91], v[84:87]
    v_mfma_f32_16x16x32_bf16 v[84:87], v[140:143], v[88:91], v[84:87]
    v_mfma_f32_16x16x32_bf16 v[84:87], v[144:147], v[88:91], v[84:87]
    v_mfma_f32_16x16x32_bf16 v[84:87], v[152:155], v[88:91], v[84:87]
    s_waitcnt lgkmcnt(0)
    v_mfma_f32_16x16x32_bf16 v[84:87], v[160:163], v[88:91], v[84:87]
    v_mfma_f32_16x16x32_bf16 v[84:87], v[168:171], v[88:91], v[84:87]
    v_mfma_f32_16x16x32_bf16 v[84:87], v[148:151], v[88:91], v[84:87]
    v_mfma_f32_16x16x32_bf16 v[84:87], v[156:159], v[88:91], v[84:87]
    v_mfma_f32_16x16x32_bf16 v[84:87], v[164:167], v[88:91], v[84:87]
    v_mfma_f32_16x16x32_bf16 v[84:87], v[172:175], v[88:91], v[84:87]
    s_barrier
    ds_read_b128 v[36:39], v14 offset:16384
    ds_read_b128 v[40:43], v14 offset:20480
    ds_read_b128 v[44:47], v14 offset:24576
    ds_read_b128 v[48:51], v14 offset:28672
    ds_read_b128 v[52:55], v15 offset:16384
    ds_read_b128 v[56:59], v15 offset:20480
    ds_read_b128 v[60:63], v15 offset:24576
    ds_read_b128 v[64:67], v15 offset:28672
    s_waitcnt lgkmcnt(4)
    v_mfma_f32_16x16x32_bf16 v[20:23], v[128:131], v[36:39], 0
    ds_read_b128 v[68:71], v16 offset:16384
    v_mfma_f32_16x16x32_bf16 v[24:27], v[128:131], v[40:43], 0
    ds_read_b128 v[72:75], v16 offset:20480
    v_mfma_f32_16x16x32_bf16 v[24:27], v[132:135], v[48:51], v[24:27]
    ds_read_b128 v[76:79], v16 offset:24576
    v_mfma_f32_16x16x32_bf16 v[20:23], v[132:135], v[44:47], v[20:23]
    ds_read_b128 v[80:83], v16 offset:28672
    s_waitcnt lgkmcnt(4)
    v_mfma_f32_16x16x32_bf16 v[20:23], v[136:139], v[52:55], v[20:23]
    ds_read_b128 v[36:39], v17 offset:16384
    v_mfma_f32_16x16x32_bf16 v[24:27], v[136:139], v[56:59], v[24:27]
    ds_read_b128 v[40:43], v17 offset:20480
    v_mfma_f32_16x16x32_bf16 v[24:27], v[140:143], v[64:67], v[24:27]
    ds_read_b128 v[44:47], v17 offset:24576
    v_mfma_f32_16x16x32_bf16 v[20:23], v[140:143], v[60:63], v[20:23]
    ds_read_b128 v[48:51], v17 offset:28672
    s_barrier
    s_waitcnt lgkmcnt(4)
    v_mfma_f32_16x16x32_bf16 v[20:23], v[144:147], v[68:71], v[20:23]
    ds_read_b128 v[52:55], v14 offset:32768
    v_mfma_f32_16x16x32_bf16 v[24:27], v[144:147], v[72:75], v[24:27]
    ds_read_b128 v[56:59], v14 offset:36864
    v_mfma_f32_16x16x32_bf16 v[24:27], v[148:151], v[80:83], v[24:27]
    ds_read_b128 v[60:63], v14 offset:40960
    v_mfma_f32_16x16x32_bf16 v[20:23], v[148:151], v[76:79], v[20:23]
    ds_read_b128 v[64:67], v14 offset:45056
    s_waitcnt lgkmcnt(4)
    v_mfma_f32_16x16x32_bf16 v[20:23], v[152:155], v[36:39], v[20:23]
    ds_read_b128 v[68:71], v15 offset:32768
    v_mfma_f32_16x16x32_bf16 v[24:27], v[152:155], v[40:43], v[24:27]
    ds_read_b128 v[72:75], v15 offset:36864
    v_mfma_f32_16x16x32_bf16 v[24:27], v[156:159], v[48:51], v[24:27]
    ds_read_b128 v[76:79], v15 offset:40960
    v_mfma_f32_16x16x32_bf16 v[20:23], v[156:159], v[44:47], v[20:23]
    ds_read_b128 v[80:83], v15 offset:45056
    s_waitcnt lgkmcnt(4)
    v_mfma_f32_16x16x32_bf16 v[20:23], v[160:163], v[52:55], v[20:23]
    ds_read_b128 v[36:39], v16 offset:32768
    v_mfma_f32_16x16x32_bf16 v[24:27], v[160:163], v[56:59], v[24:27]
    ds_read_b128 v[40:43], v16 offset:36864
    v_mfma_f32_16x16x32_bf16 v[24:27], v[164:167], v[64:67], v[24:27]
    ds_read_b128 v[44:47], v16 offset:40960
    v_mfma_f32_16x16x32_bf16 v[20:23], v[164:167], v[60:63], v[20:23]
    ds_read_b128 v[48:51], v16 offset:45056
    s_waitcnt lgkmcnt(4)
    v_mfma_f32_16x16x32_bf16 v[20:23], v[168:171], v[68:71], v[20:23]
    ds_read_b128 v[52:55], v17 offset:32768
    v_mfma_f32_16x16x32_bf16 v[24:27], v[168:171], v[72:75], v[24:27]
    ds_read_b128 v[56:59], v17 offset:36864
    v_mfma_f32_16x16x32_bf16 v[24:27], v[172:175], v[80:83], v[24:27]
    ds_read_b128 v[60:63], v17 offset:40960
    v_mfma_f32_16x16x32_bf16 v[20:23], v[172:175], v[76:79], v[20:23]
    ds_read_b128 v[64:67], v17 offset:45056
    s_barrier
    s_waitcnt lgkmcnt(4)
    v_mfma_f32_16x16x32_bf16 v[20:23], v[176:179], v[36:39], v[20:23]
    ds_read_b128 v[68:71], v10 offset:16384
    v_mfma_f32_16x16x32_bf16 v[24:27], v[176:179], v[40:43], v[24:27]
    ds_read_b128 v[72:75], v10 offset:20480
    v_mfma_f32_16x16x32_bf16 v[24:27], v[180:183], v[48:51], v[24:27]
    ds_read_b128 v[76:79], v10 offset:24576
    v_mfma_f32_16x16x32_bf16 v[20:23], v[180:183], v[44:47], v[20:23]
    ds_read_b128 v[80:83], v10 offset:28672
    s_waitcnt lgkmcnt(4)
    v_mfma_f32_16x16x32_bf16 v[20:23], v[184:187], v[52:55], v[20:23]
    ds_read_b128 v[36:39], v11 offset:16384
    v_mfma_f32_16x16x32_bf16 v[24:27], v[184:187], v[56:59], v[24:27]
    ds_read_b128 v[40:43], v11 offset:20480
    v_mfma_f32_16x16x32_bf16 v[24:27], v[188:191], v[64:67], v[24:27]
    ds_read_b128 v[44:47], v11 offset:24576
    v_mfma_f32_16x16x32_bf16 v[20:23], v[188:191], v[60:63], v[20:23]
    ds_read_b128 v[48:51], v11 offset:28672
    s_waitcnt lgkmcnt(4)
    v_mfma_f32_16x16x32_bf16 v[20:23], v[192:195], v[68:71], v[20:23]
    ds_read_b128 v[52:55], v12 offset:16384
    v_mfma_f32_16x16x32_bf16 v[24:27], v[192:195], v[72:75], v[24:27]
    ds_read_b128 v[56:59], v12 offset:20480
    v_mfma_f32_16x16x32_bf16 v[24:27], v[196:199], v[80:83], v[24:27]
    ds_read_b128 v[60:63], v12 offset:24576
    v_mfma_f32_16x16x32_bf16 v[20:23], v[196:199], v[76:79], v[20:23]
    ds_read_b128 v[64:67], v12 offset:28672
    s_waitcnt lgkmcnt(4)
    v_mfma_f32_16x16x32_bf16 v[20:23], v[200:203], v[36:39], v[20:23]
    ds_read_b128 v[68:71], v13 offset:16384
    v_mfma_f32_16x16x32_bf16 v[24:27], v[200:203], v[40:43], v[24:27]
    ds_read_b128 v[72:75], v13 offset:20480
    v_mfma_f32_16x16x32_bf16 v[24:27], v[204:207], v[48:51], v[24:27]
    ds_read_b128 v[76:79], v13 offset:24576
    v_mfma_f32_16x16x32_bf16 v[20:23], v[204:207], v[44:47], v[20:23]
    ds_read_b128 v[80:83], v13 offset:28672
    s_barrier
    s_waitcnt lgkmcnt(4)
    v_mfma_f32_16x16x32_bf16 v[20:23], v[208:211], v[52:55], v[20:23]
    ds_read_b128 v[36:39], v10 offset:32768
    v_mfma_f32_16x16x32_bf16 v[24:27], v[208:211], v[56:59], v[24:27]
    ds_read_b128 v[40:43], v10 offset:36864
    v_mfma_f32_16x16x32_bf16 v[24:27], v[212:215], v[64:67], v[24:27]
    ds_read_b128 v[44:47], v10 offset:40960
    v_mfma_f32_16x16x32_bf16 v[20:23], v[212:215], v[60:63], v[20:23]
    ds_read_b128 v[48:51], v10 offset:45056
    s_waitcnt lgkmcnt(4)
    v_mfma_f32_16x16x32_bf16 v[20:23], v[216:219], v[68:71], v[20:23]
    ds_read_b128 v[52:55], v11 offset:32768
    v_mfma_f32_16x16x32_bf16 v[24:27], v[216:219], v[72:75], v[24:27]
    ds_read_b128 v[56:59], v11 offset:36864
    v_mfma_f32_16x16x32_bf16 v[24:27], v[220:223], v[80:83], v[24:27]
    ds_read_b128 v[60:63], v11 offset:40960
    v_mfma_f32_16x16x32_bf16 v[20:23], v[220:223], v[76:79], v[20:23]
    ds_read_b128 v[64:67], v11 offset:45056
    s_waitcnt lgkmcnt(4)
    v_mfma_f32_16x16x32_bf16 v[20:23], v[224:227], v[36:39], v[20:23]
    ds_read_b128 v[68:71], v12 offset:32768
    v_mfma_f32_16x16x32_bf16 v[24:27], v[224:227], v[40:43], v[24:27]
    ds_read_b128 v[72:75], v12 offset:36864
    v_mfma_f32_16x16x32_bf16 v[24:27], v[228:231], v[48:51], v[24:27]
    ds_read_b128 v[76:79], v12 offset:40960
    v_mfma_f32_16x16x32_bf16 v[20:23], v[228:231], v[44:47], v[20:23]
    ds_read_b128 v[80:83], v12 offset:45056
    s_waitcnt lgkmcnt(4)
    v_mfma_f32_16x16x32_bf16 v[20:23], v[232:235], v[52:55], v[20:23]
    ds_read_b128 v[36:39], v13 offset:32768
    v_mfma_f32_16x16x32_bf16 v[24:27], v[232:235], v[56:59], v[24:27]
    ds_read_b128 v[40:43], v13 offset:36864
    v_mfma_f32_16x16x32_bf16 v[24:27], v[236:239], v[64:67], v[24:27]
    ds_read_b128 v[44:47], v13 offset:40960
    v_mfma_f32_16x16x32_bf16 v[20:23], v[236:239], v[60:63], v[20:23]
    ds_read_b128 v[48:51], v13 offset:45056
    s_barrier
    ds_read_b128 v[88:91], v18 offset:0
    ds_read_b128 v[92:95], v18 offset:2048
    ds_read_b128 v[96:99], v18 offset:256
    ds_read_b128 v[100:103], v18 offset:2304
    s_waitcnt lgkmcnt(8)
    v_mfma_f32_16x16x32_bf16 v[20:23], v[240:243], v[68:71], v[20:23]
    ds_read_b128 v[52:55], v14 offset:0
    v_mfma_f32_16x16x32_bf16 v[24:27], v[240:243], v[72:75], v[24:27]
    ds_read_b128 v[56:59], v14 offset:4096
    v_mfma_f32_16x16x32_bf16 v[24:27], v[244:247], v[80:83], v[24:27]
    ds_read_b128 v[60:63], v14 offset:8192
    v_mfma_f32_16x16x32_bf16 v[20:23], v[244:247], v[76:79], v[20:23]
    ds_read_b128 v[64:67], v14 offset:12288
    s_waitcnt lgkmcnt(8)
    v_mfma_f32_16x16x32_bf16 v[20:23], v[248:251], v[36:39], v[20:23]
    ds_read_b128 v[68:71], v15 offset:0
    v_mfma_f32_16x16x32_bf16 v[24:27], v[248:251], v[40:43], v[24:27]
    ds_read_b128 v[72:75], v15 offset:4096
    v_mfma_f32_16x16x32_bf16 v[24:27], v[252:255], v[48:51], v[24:27]
    ds_read_b128 v[76:79], v15 offset:8192
    v_mfma_f32_16x16x32_bf16 v[20:23], v[252:255], v[44:47], v[20:23]
    ds_read_b128 v[80:83], v15 offset:12288
    s_waitcnt lgkmcnt(4)
    v_mfma_f32_16x16x32_bf16 v[28:31], v[128:131], v[52:55], 0
    ds_read_b128 v[36:39], v16 offset:0
    v_mfma_f32_16x16x32_bf16 v[32:35], v[128:131], v[56:59], 0
    ds_read_b128 v[40:43], v16 offset:4096
    v_mfma_f32_16x16x32_bf16 v[32:35], v[132:135], v[64:67], v[32:35]
    ds_read_b128 v[44:47], v16 offset:8192
    v_mfma_f32_16x16x32_bf16 v[28:31], v[132:135], v[60:63], v[28:31]
    ds_read_b128 v[48:51], v16 offset:12288
    v_pk_fma_f32 v[20:21], v[88:89], v[84:85], v[20:21]
    v_pk_fma_f32 v[22:23], v[88:89], v[86:87], v[22:23]
    v_pk_fma_f32 v[24:25], v[96:97], v[84:85], v[24:25]
    v_pk_fma_f32 v[26:27], v[96:97], v[86:87], v[26:27]
    v_pk_mul_f32 v[104:105], v[20:21], v[20:21]
    v_pk_mul_f32 v[106:107], v[22:23], v[22:23]
    v_pk_mul_f32 v[108:109], v[24:25], v[24:25]
    v_pk_mul_f32 v[110:111], v[26:27], v[26:27]
    v_pk_fma_f32 v[104:105], v[104:105], v[92:93], v[90:91]
    v_pk_fma_f32 v[106:107], v[106:107], v[92:93], v[90:91]
    v_pk_fma_f32 v[108:109], v[108:109], v[100:101], v[98:99]
    v_pk_fma_f32 v[110:111], v[110:111], v[100:101], v[98:99]
    v_pk_mul_f32 v[104:105], v[104:105], v[20:21]
    v_pk_mul_f32 v[106:107], v[106:107], v[22:23]
    v_pk_mul_f32 v[108:109], v[108:109], v[24:25]
    v_pk_mul_f32 v[110:111], v[110:111], v[26:27]
    v_exp_f32 v104, v104
    v_exp_f32 v105, v105
    v_exp_f32 v106, v106
    v_exp_f32 v107, v107
    v_exp_f32 v108, v108
    v_exp_f32 v109, v109
    v_exp_f32 v110, v110
    v_exp_f32 v111, v111
    v_pk_fma_f32 v[104:105], v[104:105], v[94:95], v[94:95]
    v_pk_fma_f32 v[106:107], v[106:107], v[94:95], v[94:95]
    v_pk_fma_f32 v[108:109], v[108:109], v[102:103], v[102:103]
    v_pk_fma_f32 v[110:111], v[110:111], v[102:103], v[102:103]
    v_rcp_f32 v104, v104
    v_rcp_f32 v105, v105
    v_rcp_f32 v106, v106
    v_rcp_f32 v107, v107
    v_rcp_f32 v108, v108
    v_rcp_f32 v109, v109
    v_rcp_f32 v110, v110
    v_rcp_f32 v111, v111
    v_pk_mul_f32 v[20:21], v[20:21], v[104:105]
    v_pk_mul_f32 v[22:23], v[22:23], v[106:107]
    v_pk_mul_f32 v[24:25], v[24:25], v[108:109]
    v_pk_mul_f32 v[26:27], v[26:27], v[110:111]
    v_add_u32 v20, 0x10000, v20
    v_add_u32 v22, 0x10000, v22
    v_add_u32 v24, 0x10000, v24
    v_add_u32 v26, 0x10000, v26
    v_and_b32 v20, 0xfffe0000, v20
    v_and_b32 v22, 0xfffe0000, v22
    v_and_b32 v24, 0xfffe0000, v24
    v_and_b32 v26, 0xfffe0000, v26
    v_cvt_pk_bf16_f32 v104, v20, v21
    v_cvt_pk_bf16_f32 v105, v22, v23
    v_cvt_pk_bf16_f32 v106, v24, v25
    v_cvt_pk_bf16_f32 v107, v26, v27
    s_add_u32 s36, s39, 0
    v_permlane16_swap_b32 v104, v106
    v_permlane16_swap_b32 v105, v107
    buffer_store_dwordx4 v[104:107], v114, s[16:19], s36 offen sc1
    s_waitcnt lgkmcnt(4)
    v_mfma_f32_16x16x32_bf16 v[28:31], v[136:139], v[68:71], v[28:31]
    ds_read_b128 v[52:55], v17 offset:0
    v_mfma_f32_16x16x32_bf16 v[32:35], v[136:139], v[72:75], v[32:35]
    ds_read_b128 v[56:59], v17 offset:4096
    v_mfma_f32_16x16x32_bf16 v[32:35], v[140:143], v[80:83], v[32:35]
    ds_read_b128 v[60:63], v17 offset:8192
    v_mfma_f32_16x16x32_bf16 v[28:31], v[140:143], v[76:79], v[28:31]
    ds_read_b128 v[64:67], v17 offset:12288
    s_barrier
    s_waitcnt lgkmcnt(4)
    v_mfma_f32_16x16x32_bf16 v[28:31], v[144:147], v[36:39], v[28:31]
    ds_read_b128 v[68:71], v14 offset:16384
    v_mfma_f32_16x16x32_bf16 v[32:35], v[144:147], v[40:43], v[32:35]
    ds_read_b128 v[72:75], v14 offset:20480
    v_mfma_f32_16x16x32_bf16 v[32:35], v[148:151], v[48:51], v[32:35]
    ds_read_b128 v[76:79], v14 offset:24576
    v_mfma_f32_16x16x32_bf16 v[28:31], v[148:151], v[44:47], v[28:31]
    ds_read_b128 v[80:83], v14 offset:28672
    s_waitcnt lgkmcnt(4)
    v_mfma_f32_16x16x32_bf16 v[28:31], v[152:155], v[52:55], v[28:31]
    ds_read_b128 v[36:39], v15 offset:16384
    v_mfma_f32_16x16x32_bf16 v[32:35], v[152:155], v[56:59], v[32:35]
    ds_read_b128 v[40:43], v15 offset:20480
    v_mfma_f32_16x16x32_bf16 v[32:35], v[156:159], v[64:67], v[32:35]
    ds_read_b128 v[44:47], v15 offset:24576
    v_mfma_f32_16x16x32_bf16 v[28:31], v[156:159], v[60:63], v[28:31]
    ds_read_b128 v[48:51], v15 offset:28672
    s_waitcnt lgkmcnt(4)
    v_mfma_f32_16x16x32_bf16 v[28:31], v[160:163], v[68:71], v[28:31]
    ds_read_b128 v[52:55], v16 offset:16384
    v_mfma_f32_16x16x32_bf16 v[32:35], v[160:163], v[72:75], v[32:35]
    ds_read_b128 v[56:59], v16 offset:20480
    v_mfma_f32_16x16x32_bf16 v[32:35], v[164:167], v[80:83], v[32:35]
    ds_read_b128 v[60:63], v16 offset:24576
    v_mfma_f32_16x16x32_bf16 v[28:31], v[164:167], v[76:79], v[28:31]
    ds_read_b128 v[64:67], v16 offset:28672
    s_waitcnt lgkmcnt(4)
    v_mfma_f32_16x16x32_bf16 v[28:31], v[168:171], v[36:39], v[28:31]
    ds_read_b128 v[68:71], v17 offset:16384
    v_mfma_f32_16x16x32_bf16 v[32:35], v[168:171], v[40:43], v[32:35]
    ds_read_b128 v[72:75], v17 offset:20480
    v_mfma_f32_16x16x32_bf16 v[32:35], v[172:175], v[48:51], v[32:35]
    ds_read_b128 v[76:79], v17 offset:24576
    v_mfma_f32_16x16x32_bf16 v[28:31], v[172:175], v[44:47], v[28:31]
    ds_read_b128 v[80:83], v17 offset:28672
    s_barrier
    s_waitcnt lgkmcnt(4)
    v_mfma_f32_16x16x32_bf16 v[28:31], v[176:179], v[52:55], v[28:31]
    ds_read_b128 v[36:39], v14 offset:32768
    v_mfma_f32_16x16x32_bf16 v[32:35], v[176:179], v[56:59], v[32:35]
    ds_read_b128 v[40:43], v14 offset:36864
    v_mfma_f32_16x16x32_bf16 v[32:35], v[180:183], v[64:67], v[32:35]
    ds_read_b128 v[44:47], v14 offset:40960
    v_mfma_f32_16x16x32_bf16 v[28:31], v[180:183], v[60:63], v[28:31]
    ds_read_b128 v[48:51], v14 offset:45056
    s_waitcnt lgkmcnt(4)
    v_mfma_f32_16x16x32_bf16 v[28:31], v[184:187], v[68:71], v[28:31]
    ds_read_b128 v[52:55], v15 offset:32768
    v_mfma_f32_16x16x32_bf16 v[32:35], v[184:187], v[72:75], v[32:35]
    ds_read_b128 v[56:59], v15 offset:36864
    v_mfma_f32_16x16x32_bf16 v[32:35], v[188:191], v[80:83], v[32:35]
    ds_read_b128 v[60:63], v15 offset:40960
    v_mfma_f32_16x16x32_bf16 v[28:31], v[188:191], v[76:79], v[28:31]
    ds_read_b128 v[64:67], v15 offset:45056
    s_waitcnt lgkmcnt(4)
    v_mfma_f32_16x16x32_bf16 v[28:31], v[192:195], v[36:39], v[28:31]
    ds_read_b128 v[68:71], v16 offset:32768
    v_mfma_f32_16x16x32_bf16 v[32:35], v[192:195], v[40:43], v[32:35]
    ds_read_b128 v[72:75], v16 offset:36864
    v_mfma_f32_16x16x32_bf16 v[32:35], v[196:199], v[48:51], v[32:35]
    ds_read_b128 v[76:79], v16 offset:40960
    v_mfma_f32_16x16x32_bf16 v[28:31], v[196:199], v[44:47], v[28:31]
    ds_read_b128 v[80:83], v16 offset:45056
    s_waitcnt lgkmcnt(4)
    v_mfma_f32_16x16x32_bf16 v[28:31], v[200:203], v[52:55], v[28:31]
    ds_read_b128 v[36:39], v17 offset:32768
    v_mfma_f32_16x16x32_bf16 v[32:35], v[200:203], v[56:59], v[32:35]
    ds_read_b128 v[40:43], v17 offset:36864
    v_mfma_f32_16x16x32_bf16 v[32:35], v[204:207], v[64:67], v[32:35]
    ds_read_b128 v[44:47], v17 offset:40960
    v_mfma_f32_16x16x32_bf16 v[28:31], v[204:207], v[60:63], v[28:31]
    ds_read_b128 v[48:51], v17 offset:45056
    s_barrier
    s_waitcnt lgkmcnt(4)
    v_mfma_f32_16x16x32_bf16 v[28:31], v[208:211], v[68:71], v[28:31]
    ds_read_b128 v[52:55], v10 offset:16384
    v_mfma_f32_16x16x32_bf16 v[32:35], v[208:211], v[72:75], v[32:35]
    ds_read_b128 v[56:59], v10 offset:20480
    v_mfma_f32_16x16x32_bf16 v[32:35], v[212:215], v[80:83], v[32:35]
    ds_read_b128 v[60:63], v10 offset:24576
    v_mfma_f32_16x16x32_bf16 v[28:31], v[212:215], v[76:79], v[28:31]
    ds_read_b128 v[64:67], v10 offset:28672
    s_waitcnt lgkmcnt(4)
    v_mfma_f32_16x16x32_bf16 v[28:31], v[216:219], v[36:39], v[28:31]
    ds_read_b128 v[68:71], v11 offset:16384
    v_mfma_f32_16x16x32_bf16 v[32:35], v[216:219], v[40:43], v[32:35]
    ds_read_b128 v[72:75], v11 offset:20480
    v_mfma_f32_16x16x32_bf16 v[32:35], v[220:223], v[48:51], v[32:35]
    ds_read_b128 v[76:79], v11 offset:24576
    v_mfma_f32_16x16x32_bf16 v[28:31], v[220:223], v[44:47], v[28:31]
    ds_read_b128 v[80:83], v11 offset:28672
    s_waitcnt lgkmcnt(4)
    v_mfma_f32_16x16x32_bf16 v[28:31], v[224:227], v[52:55], v[28:31]
    ds_read_b128 v[36:39], v12 offset:16384
    v_mfma_f32_16x16x32_bf16 v[32:35], v[224:227], v[56:59], v[32:35]
    ds_read_b128 v[40:43], v12 offset:20480
    v_mfma_f32_16x16x32_bf16 v[32:35], v[228:231], v[64:67], v[32:35]
    ds_read_b128 v[44:47], v12 offset:24576
    v_mfma_f32_16x16x32_bf16 v[28:31], v[228:231], v[60:63], v[28:31]
    ds_read_b128 v[48:51], v12 offset:28672
    s_waitcnt lgkmcnt(4)
    v_mfma_f32_16x16x32_bf16 v[28:31], v[232:235], v[68:71], v[28:31]
    ds_read_b128 v[52:55], v13 offset:16384
    v_mfma_f32_16x16x32_bf16 v[32:35], v[232:235], v[72:75], v[32:35]
    ds_read_b128 v[56:59], v13 offset:20480
    v_mfma_f32_16x16x32_bf16 v[32:35], v[236:239], v[80:83], v[32:35]
    ds_read_b128 v[60:63], v13 offset:24576
    v_mfma_f32_16x16x32_bf16 v[28:31], v[236:239], v[76:79], v[28:31]
    ds_read_b128 v[64:67], v13 offset:28672
    s_barrier
    ds_read_b128 v[88:91], v18 offset:512
    ds_read_b128 v[92:95], v18 offset:2560
    ds_read_b128 v[96:99], v18 offset:768
    ds_read_b128 v[100:103], v18 offset:2816
    s_waitcnt vmcnt(0)
    buffer_atomic_add v113, v112, s[56:59], s40 offen offset:2048 sc1
    s_waitcnt lgkmcnt(8)
    v_mfma_f32_16x16x32_bf16 v[28:31], v[240:243], v[36:39], v[28:31]
    ds_read_b128 v[68:71], v10 offset:32768
    v_mfma_f32_16x16x32_bf16 v[32:35], v[240:243], v[40:43], v[32:35]
    ds_read_b128 v[72:75], v10 offset:36864
    v_mfma_f32_16x16x32_bf16 v[32:35], v[244:247], v[48:51], v[32:35]
    ds_read_b128 v[76:79], v10 offset:40960
    v_mfma_f32_16x16x32_bf16 v[28:31], v[244:247], v[44:47], v[28:31]
    ds_read_b128 v[80:83], v10 offset:45056
    s_waitcnt lgkmcnt(8)
    v_mfma_f32_16x16x32_bf16 v[28:31], v[248:251], v[52:55], v[28:31]
    ds_read_b128 v[36:39], v11 offset:32768
    v_mfma_f32_16x16x32_bf16 v[32:35], v[248:251], v[56:59], v[32:35]
    ds_read_b128 v[40:43], v11 offset:36864
    v_mfma_f32_16x16x32_bf16 v[32:35], v[252:255], v[64:67], v[32:35]
    ds_read_b128 v[44:47], v11 offset:40960
    v_mfma_f32_16x16x32_bf16 v[28:31], v[252:255], v[60:63], v[28:31]
    ds_read_b128 v[48:51], v11 offset:45056
    s_waitcnt lgkmcnt(4)
    v_mfma_f32_16x16x32_bf16 v[20:23], v[128:131], v[68:71], 0
    ds_read_b128 v[52:55], v12 offset:32768
    v_mfma_f32_16x16x32_bf16 v[24:27], v[128:131], v[72:75], 0
    ds_read_b128 v[56:59], v12 offset:36864
    v_mfma_f32_16x16x32_bf16 v[24:27], v[132:135], v[80:83], v[24:27]
    ds_read_b128 v[60:63], v12 offset:40960
    v_mfma_f32_16x16x32_bf16 v[20:23], v[132:135], v[76:79], v[20:23]
    ds_read_b128 v[64:67], v12 offset:45056
    v_pk_fma_f32 v[28:29], v[88:89], v[84:85], v[28:29]
    v_pk_fma_f32 v[30:31], v[88:89], v[86:87], v[30:31]
    v_pk_fma_f32 v[32:33], v[96:97], v[84:85], v[32:33]
    v_pk_fma_f32 v[34:35], v[96:97], v[86:87], v[34:35]
    v_pk_mul_f32 v[104:105], v[28:29], v[28:29]
    v_pk_mul_f32 v[106:107], v[30:31], v[30:31]
    v_pk_mul_f32 v[108:109], v[32:33], v[32:33]
    v_pk_mul_f32 v[110:111], v[34:35], v[34:35]
    v_pk_fma_f32 v[104:105], v[104:105], v[92:93], v[90:91]
    v_pk_fma_f32 v[106:107], v[106:107], v[92:93], v[90:91]
    v_pk_fma_f32 v[108:109], v[108:109], v[100:101], v[98:99]
    v_pk_fma_f32 v[110:111], v[110:111], v[100:101], v[98:99]
    v_pk_mul_f32 v[104:105], v[104:105], v[28:29]
    v_pk_mul_f32 v[106:107], v[106:107], v[30:31]
    v_pk_mul_f32 v[108:109], v[108:109], v[32:33]
    v_pk_mul_f32 v[110:111], v[110:111], v[34:35]
    v_exp_f32 v104, v104
    v_exp_f32 v105, v105
    v_exp_f32 v106, v106
    v_exp_f32 v107, v107
    v_exp_f32 v108, v108
    v_exp_f32 v109, v109
    v_exp_f32 v110, v110
    v_exp_f32 v111, v111
    v_pk_fma_f32 v[104:105], v[104:105], v[94:95], v[94:95]
    v_pk_fma_f32 v[106:107], v[106:107], v[94:95], v[94:95]
    v_pk_fma_f32 v[108:109], v[108:109], v[102:103], v[102:103]
    v_pk_fma_f32 v[110:111], v[110:111], v[102:103], v[102:103]
    v_rcp_f32 v104, v104
    v_rcp_f32 v105, v105
    v_rcp_f32 v106, v106
    v_rcp_f32 v107, v107
    v_rcp_f32 v108, v108
    v_rcp_f32 v109, v109
    v_rcp_f32 v110, v110
    v_rcp_f32 v111, v111
    v_pk_mul_f32 v[28:29], v[28:29], v[104:105]
    v_pk_mul_f32 v[30:31], v[30:31], v[106:107]
    v_pk_mul_f32 v[32:33], v[32:33], v[108:109]
    v_pk_mul_f32 v[34:35], v[34:35], v[110:111]
    v_add_u32 v28, 0x10000, v28
    v_add_u32 v30, 0x10000, v30
    v_add_u32 v32, 0x10000, v32
    v_add_u32 v34, 0x10000, v34
    v_and_b32 v28, 0xfffe0000, v28
    v_and_b32 v30, 0xfffe0000, v30
    v_and_b32 v32, 0xfffe0000, v32
    v_and_b32 v34, 0xfffe0000, v34
    v_cvt_pk_bf16_f32 v104, v28, v29
    v_cvt_pk_bf16_f32 v105, v30, v31
    v_cvt_pk_bf16_f32 v106, v32, v33
    v_cvt_pk_bf16_f32 v107, v34, v35
    s_add_u32 s36, s39, 131072
    v_permlane16_swap_b32 v104, v106
    v_permlane16_swap_b32 v105, v107
    buffer_store_dwordx4 v[104:107], v114, s[16:19], s36 offen sc1
    s_waitcnt lgkmcnt(4)
    v_mfma_f32_16x16x32_bf16 v[20:23], v[136:139], v[36:39], v[20:23]
    ds_read_b128 v[68:71], v13 offset:32768
    v_mfma_f32_16x16x32_bf16 v[24:27], v[136:139], v[40:43], v[24:27]
    ds_read_b128 v[72:75], v13 offset:36864
    v_mfma_f32_16x16x32_bf16 v[24:27], v[140:143], v[48:51], v[24:27]
    ds_read_b128 v[76:79], v13 offset:40960
    v_mfma_f32_16x16x32_bf16 v[20:23], v[140:143], v[44:47], v[20:23]
    ds_read_b128 v[80:83], v13 offset:45056
    s_barrier
    s_waitcnt lgkmcnt(4)
    v_mfma_f32_16x16x32_bf16 v[20:23], v[144:147], v[52:55], v[20:23]
    ds_read_b128 v[36:39], v14 offset:0
    v_mfma_f32_16x16x32_bf16 v[24:27], v[144:147], v[56:59], v[24:27]
    ds_read_b128 v[40:43], v14 offset:4096
    v_mfma_f32_16x16x32_bf16 v[24:27], v[148:151], v[64:67], v[24:27]
    ds_read_b128 v[44:47], v14 offset:8192
    v_mfma_f32_16x16x32_bf16 v[20:23], v[148:151], v[60:63], v[20:23]
    ds_read_b128 v[48:51], v14 offset:12288
    s_waitcnt lgkmcnt(4)
    v_mfma_f32_16x16x32_bf16 v[20:23], v[152:155], v[68:71], v[20:23]
    ds_read_b128 v[52:55], v15 offset:0
    v_mfma_f32_16x16x32_bf16 v[24:27], v[152:155], v[72:75], v[24:27]
    ds_read_b128 v[56:59], v15 offset:4096
    v_mfma_f32_16x16x32_bf16 v[24:27], v[156:159], v[80:83], v[24:27]
    ds_read_b128 v[60:63], v15 offset:8192
    v_mfma_f32_16x16x32_bf16 v[20:23], v[156:159], v[76:79], v[20:23]
    ds_read_b128 v[64:67], v15 offset:12288
    s_waitcnt lgkmcnt(4)
    v_mfma_f32_16x16x32_bf16 v[20:23], v[160:163], v[36:39], v[20:23]
    ds_read_b128 v[68:71], v16 offset:0
    v_mfma_f32_16x16x32_bf16 v[24:27], v[160:163], v[40:43], v[24:27]
    ds_read_b128 v[72:75], v16 offset:4096
    v_mfma_f32_16x16x32_bf16 v[24:27], v[164:167], v[48:51], v[24:27]
    ds_read_b128 v[76:79], v16 offset:8192
    v_mfma_f32_16x16x32_bf16 v[20:23], v[164:167], v[44:47], v[20:23]
    ds_read_b128 v[80:83], v16 offset:12288
    s_waitcnt lgkmcnt(4)
    v_mfma_f32_16x16x32_bf16 v[20:23], v[168:171], v[52:55], v[20:23]
    ds_read_b128 v[36:39], v17 offset:0
    v_mfma_f32_16x16x32_bf16 v[24:27], v[168:171], v[56:59], v[24:27]
    ds_read_b128 v[40:43], v17 offset:4096
    v_mfma_f32_16x16x32_bf16 v[24:27], v[172:175], v[64:67], v[24:27]
    ds_read_b128 v[44:47], v17 offset:8192
    v_mfma_f32_16x16x32_bf16 v[20:23], v[172:175], v[60:63], v[20:23]
    ds_read_b128 v[48:51], v17 offset:12288
    s_barrier
    s_waitcnt lgkmcnt(4)
    v_mfma_f32_16x16x32_bf16 v[20:23], v[176:179], v[68:71], v[20:23]
    ds_read_b128 v[52:55], v14 offset:16384
    v_mfma_f32_16x16x32_bf16 v[24:27], v[176:179], v[72:75], v[24:27]
    ds_read_b128 v[56:59], v14 offset:20480
    v_mfma_f32_16x16x32_bf16 v[24:27], v[180:183], v[80:83], v[24:27]
    ds_read_b128 v[60:63], v14 offset:24576
    v_mfma_f32_16x16x32_bf16 v[20:23], v[180:183], v[76:79], v[20:23]
    ds_read_b128 v[64:67], v14 offset:28672
    s_waitcnt lgkmcnt(4)
    v_mfma_f32_16x16x32_bf16 v[20:23], v[184:187], v[36:39], v[20:23]
    ds_read_b128 v[68:71], v15 offset:16384
    v_mfma_f32_16x16x32_bf16 v[24:27], v[184:187], v[40:43], v[24:27]
    ds_read_b128 v[72:75], v15 offset:20480
    v_mfma_f32_16x16x32_bf16 v[24:27], v[188:191], v[48:51], v[24:27]
    ds_read_b128 v[76:79], v15 offset:24576
    v_mfma_f32_16x16x32_bf16 v[20:23], v[188:191], v[44:47], v[20:23]
    ds_read_b128 v[80:83], v15 offset:28672
    s_waitcnt lgkmcnt(4)
    v_mfma_f32_16x16x32_bf16 v[20:23], v[192:195], v[52:55], v[20:23]
    ds_read_b128 v[36:39], v16 offset:16384
    v_mfma_f32_16x16x32_bf16 v[24:27], v[192:195], v[56:59], v[24:27]
    ds_read_b128 v[40:43], v16 offset:20480
    v_mfma_f32_16x16x32_bf16 v[24:27], v[196:199], v[64:67], v[24:27]
    ds_read_b128 v[44:47], v16 offset:24576
    v_mfma_f32_16x16x32_bf16 v[20:23], v[196:199], v[60:63], v[20:23]
    ds_read_b128 v[48:51], v16 offset:28672
    s_waitcnt lgkmcnt(4)
    v_mfma_f32_16x16x32_bf16 v[20:23], v[200:203], v[68:71], v[20:23]
    ds_read_b128 v[52:55], v17 offset:16384
    v_mfma_f32_16x16x32_bf16 v[24:27], v[200:203], v[72:75], v[24:27]
    ds_read_b128 v[56:59], v17 offset:20480
    v_mfma_f32_16x16x32_bf16 v[24:27], v[204:207], v[80:83], v[24:27]
    ds_read_b128 v[60:63], v17 offset:24576
    v_mfma_f32_16x16x32_bf16 v[20:23], v[204:207], v[76:79], v[20:23]
    ds_read_b128 v[64:67], v17 offset:28672
    s_barrier
    s_waitcnt lgkmcnt(4)
    v_mfma_f32_16x16x32_bf16 v[20:23], v[208:211], v[36:39], v[20:23]
    ds_read_b128 v[68:71], v14 offset:32768
    v_mfma_f32_16x16x32_bf16 v[24:27], v[208:211], v[40:43], v[24:27]
    ds_read_b128 v[72:75], v14 offset:36864
    v_mfma_f32_16x16x32_bf16 v[24:27], v[212:215], v[48:51], v[24:27]
    ds_read_b128 v[76:79], v14 offset:40960
    v_mfma_f32_16x16x32_bf16 v[20:23], v[212:215], v[44:47], v[20:23]
    ds_read_b128 v[80:83], v14 offset:45056
    s_waitcnt lgkmcnt(4)
    v_mfma_f32_16x16x32_bf16 v[20:23], v[216:219], v[52:55], v[20:23]
    ds_read_b128 v[36:39], v15 offset:32768
    v_mfma_f32_16x16x32_bf16 v[24:27], v[216:219], v[56:59], v[24:27]
    ds_read_b128 v[40:43], v15 offset:36864
    v_mfma_f32_16x16x32_bf16 v[24:27], v[220:223], v[64:67], v[24:27]
    ds_read_b128 v[44:47], v15 offset:40960
    v_mfma_f32_16x16x32_bf16 v[20:23], v[220:223], v[60:63], v[20:23]
    ds_read_b128 v[48:51], v15 offset:45056
    s_waitcnt lgkmcnt(4)
    v_mfma_f32_16x16x32_bf16 v[20:23], v[224:227], v[68:71], v[20:23]
    ds_read_b128 v[52:55], v16 offset:32768
    v_mfma_f32_16x16x32_bf16 v[24:27], v[224:227], v[72:75], v[24:27]
    ds_read_b128 v[56:59], v16 offset:36864
    v_mfma_f32_16x16x32_bf16 v[24:27], v[228:231], v[80:83], v[24:27]
    ds_read_b128 v[60:63], v16 offset:40960
    v_mfma_f32_16x16x32_bf16 v[20:23], v[228:231], v[76:79], v[20:23]
    ds_read_b128 v[64:67], v16 offset:45056
    s_waitcnt lgkmcnt(4)
    v_mfma_f32_16x16x32_bf16 v[20:23], v[232:235], v[36:39], v[20:23]
    ds_read_b128 v[68:71], v17 offset:32768
    v_mfma_f32_16x16x32_bf16 v[24:27], v[232:235], v[40:43], v[24:27]
    ds_read_b128 v[72:75], v17 offset:36864
    v_mfma_f32_16x16x32_bf16 v[24:27], v[236:239], v[48:51], v[24:27]
    ds_read_b128 v[76:79], v17 offset:40960
    v_mfma_f32_16x16x32_bf16 v[20:23], v[236:239], v[44:47], v[20:23]
    ds_read_b128 v[80:83], v17 offset:45056
    s_barrier
    ds_read_b128 v[88:91], v18 offset:1024
    ds_read_b128 v[92:95], v18 offset:3072
    ds_read_b128 v[96:99], v18 offset:1280
    ds_read_b128 v[100:103], v18 offset:3328
    s_waitcnt vmcnt(0)
    buffer_atomic_add v113, v112, s[56:59], s40 offen offset:2560 sc1
    s_waitcnt lgkmcnt(8)
    v_mfma_f32_16x16x32_bf16 v[20:23], v[240:243], v[52:55], v[20:23]
    ds_read_b128 v[36:39], v10 offset:16384
    v_mfma_f32_16x16x32_bf16 v[24:27], v[240:243], v[56:59], v[24:27]
    ds_read_b128 v[40:43], v10 offset:20480
    v_mfma_f32_16x16x32_bf16 v[24:27], v[244:247], v[64:67], v[24:27]
    ds_read_b128 v[44:47], v10 offset:24576
    v_mfma_f32_16x16x32_bf16 v[20:23], v[244:247], v[60:63], v[20:23]
    ds_read_b128 v[48:51], v10 offset:28672
    s_waitcnt lgkmcnt(8)
    v_mfma_f32_16x16x32_bf16 v[20:23], v[248:251], v[68:71], v[20:23]
    ds_read_b128 v[52:55], v11 offset:16384
    v_mfma_f32_16x16x32_bf16 v[24:27], v[248:251], v[72:75], v[24:27]
    ds_read_b128 v[56:59], v11 offset:20480
    v_mfma_f32_16x16x32_bf16 v[24:27], v[252:255], v[80:83], v[24:27]
    ds_read_b128 v[60:63], v11 offset:24576
    v_mfma_f32_16x16x32_bf16 v[20:23], v[252:255], v[76:79], v[20:23]
    ds_read_b128 v[64:67], v11 offset:28672
    s_waitcnt lgkmcnt(4)
    v_mfma_f32_16x16x32_bf16 v[28:31], v[128:131], v[36:39], 0
    ds_read_b128 v[68:71], v12 offset:16384
    v_mfma_f32_16x16x32_bf16 v[32:35], v[128:131], v[40:43], 0
    ds_read_b128 v[72:75], v12 offset:20480
    v_mfma_f32_16x16x32_bf16 v[32:35], v[132:135], v[48:51], v[32:35]
    ds_read_b128 v[76:79], v12 offset:24576
    v_mfma_f32_16x16x32_bf16 v[28:31], v[132:135], v[44:47], v[28:31]
    ds_read_b128 v[80:83], v12 offset:28672
    v_pk_fma_f32 v[20:21], v[88:89], v[84:85], v[20:21]
    v_pk_fma_f32 v[22:23], v[88:89], v[86:87], v[22:23]
    v_pk_fma_f32 v[24:25], v[96:97], v[84:85], v[24:25]
    v_pk_fma_f32 v[26:27], v[96:97], v[86:87], v[26:27]
    v_pk_mul_f32 v[104:105], v[20:21], v[20:21]
    v_pk_mul_f32 v[106:107], v[22:23], v[22:23]
    v_pk_mul_f32 v[108:109], v[24:25], v[24:25]
    v_pk_mul_f32 v[110:111], v[26:27], v[26:27]
    v_pk_fma_f32 v[104:105], v[104:105], v[92:93], v[90:91]
    v_pk_fma_f32 v[106:107], v[106:107], v[92:93], v[90:91]
    v_pk_fma_f32 v[108:109], v[108:109], v[100:101], v[98:99]
    v_pk_fma_f32 v[110:111], v[110:111], v[100:101], v[98:99]
    v_pk_mul_f32 v[104:105], v[104:105], v[20:21]
    v_pk_mul_f32 v[106:107], v[106:107], v[22:23]
    v_pk_mul_f32 v[108:109], v[108:109], v[24:25]
    v_pk_mul_f32 v[110:111], v[110:111], v[26:27]
    v_exp_f32 v104, v104
    v_exp_f32 v105, v105
    v_exp_f32 v106, v106
    v_exp_f32 v107, v107
    v_exp_f32 v108, v108
    v_exp_f32 v109, v109
    v_exp_f32 v110, v110
    v_exp_f32 v111, v111
    v_pk_fma_f32 v[104:105], v[104:105], v[94:95], v[94:95]
    v_pk_fma_f32 v[106:107], v[106:107], v[94:95], v[94:95]
    v_pk_fma_f32 v[108:109], v[108:109], v[102:103], v[102:103]
    v_pk_fma_f32 v[110:111], v[110:111], v[102:103], v[102:103]
    v_rcp_f32 v104, v104
    v_rcp_f32 v105, v105
    v_rcp_f32 v106, v106
    v_rcp_f32 v107, v107
    v_rcp_f32 v108, v108
    v_rcp_f32 v109, v109
    v_rcp_f32 v110, v110
    v_rcp_f32 v111, v111
    v_pk_mul_f32 v[20:21], v[20:21], v[104:105]
    v_pk_mul_f32 v[22:23], v[22:23], v[106:107]
    v_pk_mul_f32 v[24:25], v[24:25], v[108:109]
    v_pk_mul_f32 v[26:27], v[26:27], v[110:111]
    v_add_u32 v20, 0x10000, v20
    v_add_u32 v22, 0x10000, v22
    v_add_u32 v24, 0x10000, v24
    v_add_u32 v26, 0x10000, v26
    v_and_b32 v20, 0xfffe0000, v20
    v_and_b32 v22, 0xfffe0000, v22
    v_and_b32 v24, 0xfffe0000, v24
    v_and_b32 v26, 0xfffe0000, v26
    v_cvt_pk_bf16_f32 v104, v20, v21
    v_cvt_pk_bf16_f32 v105, v22, v23
    v_cvt_pk_bf16_f32 v106, v24, v25
    v_cvt_pk_bf16_f32 v107, v26, v27
    s_add_u32 s36, s39, 262144
    v_permlane16_swap_b32 v104, v106
    v_permlane16_swap_b32 v105, v107
    buffer_store_dwordx4 v[104:107], v114, s[16:19], s36 offen sc1
    s_waitcnt lgkmcnt(4)
    v_mfma_f32_16x16x32_bf16 v[28:31], v[136:139], v[52:55], v[28:31]
    ds_read_b128 v[36:39], v13 offset:16384
    v_mfma_f32_16x16x32_bf16 v[32:35], v[136:139], v[56:59], v[32:35]
    ds_read_b128 v[40:43], v13 offset:20480
    v_mfma_f32_16x16x32_bf16 v[32:35], v[140:143], v[64:67], v[32:35]
    ds_read_b128 v[44:47], v13 offset:24576
    v_mfma_f32_16x16x32_bf16 v[28:31], v[140:143], v[60:63], v[28:31]
    ds_read_b128 v[48:51], v13 offset:28672
    s_barrier
    s_waitcnt lgkmcnt(4)
    v_mfma_f32_16x16x32_bf16 v[28:31], v[144:147], v[68:71], v[28:31]
    ds_read_b128 v[52:55], v10 offset:32768
    v_mfma_f32_16x16x32_bf16 v[32:35], v[144:147], v[72:75], v[32:35]
    ds_read_b128 v[56:59], v10 offset:36864
    v_mfma_f32_16x16x32_bf16 v[32:35], v[148:151], v[80:83], v[32:35]
    ds_read_b128 v[60:63], v10 offset:40960
    v_mfma_f32_16x16x32_bf16 v[28:31], v[148:151], v[76:79], v[28:31]
    ds_read_b128 v[64:67], v10 offset:45056
    s_waitcnt lgkmcnt(4)
    v_mfma_f32_16x16x32_bf16 v[28:31], v[152:155], v[36:39], v[28:31]
    ds_read_b128 v[68:71], v11 offset:32768
    v_mfma_f32_16x16x32_bf16 v[32:35], v[152:155], v[40:43], v[32:35]
    ds_read_b128 v[72:75], v11 offset:36864
    v_mfma_f32_16x16x32_bf16 v[32:35], v[156:159], v[48:51], v[32:35]
    ds_read_b128 v[76:79], v11 offset:40960
    v_mfma_f32_16x16x32_bf16 v[28:31], v[156:159], v[44:47], v[28:31]
    ds_read_b128 v[80:83], v11 offset:45056
    s_waitcnt lgkmcnt(4)
    v_mfma_f32_16x16x32_bf16 v[28:31], v[160:163], v[52:55], v[28:31]
    ds_read_b128 v[36:39], v12 offset:32768
    v_mfma_f32_16x16x32_bf16 v[32:35], v[160:163], v[56:59], v[32:35]
    ds_read_b128 v[40:43], v12 offset:36864
    v_mfma_f32_16x16x32_bf16 v[32:35], v[164:167], v[64:67], v[32:35]
    ds_read_b128 v[44:47], v12 offset:40960
    v_mfma_f32_16x16x32_bf16 v[28:31], v[164:167], v[60:63], v[28:31]
    ds_read_b128 v[48:51], v12 offset:45056
    s_waitcnt lgkmcnt(4)
    v_mfma_f32_16x16x32_bf16 v[28:31], v[168:171], v[68:71], v[28:31]
    ds_read_b128 v[52:55], v13 offset:32768
    v_mfma_f32_16x16x32_bf16 v[32:35], v[168:171], v[72:75], v[32:35]
    ds_read_b128 v[56:59], v13 offset:36864
    v_mfma_f32_16x16x32_bf16 v[32:35], v[172:175], v[80:83], v[32:35]
    ds_read_b128 v[60:63], v13 offset:40960
    v_mfma_f32_16x16x32_bf16 v[28:31], v[172:175], v[76:79], v[28:31]
    ds_read_b128 v[64:67], v13 offset:45056
    s_barrier
    s_waitcnt lgkmcnt(4)
    v_mfma_f32_16x16x32_bf16 v[28:31], v[176:179], v[36:39], v[28:31]
    ds_read_b128 v[68:71], v14 offset:0
    v_mfma_f32_16x16x32_bf16 v[32:35], v[176:179], v[40:43], v[32:35]
    ds_read_b128 v[72:75], v14 offset:4096
    v_mfma_f32_16x16x32_bf16 v[32:35], v[180:183], v[48:51], v[32:35]
    ds_read_b128 v[76:79], v14 offset:8192
    v_mfma_f32_16x16x32_bf16 v[28:31], v[180:183], v[44:47], v[28:31]
    ds_read_b128 v[80:83], v14 offset:12288
    s_waitcnt lgkmcnt(4)
    v_mfma_f32_16x16x32_bf16 v[28:31], v[184:187], v[52:55], v[28:31]
    ds_read_b128 v[36:39], v15 offset:0
    v_mfma_f32_16x16x32_bf16 v[32:35], v[184:187], v[56:59], v[32:35]
    ds_read_b128 v[40:43], v15 offset:4096
    v_mfma_f32_16x16x32_bf16 v[32:35], v[188:191], v[64:67], v[32:35]
    ds_read_b128 v[44:47], v15 offset:8192
    v_mfma_f32_16x16x32_bf16 v[28:31], v[188:191], v[60:63], v[28:31]
    ds_read_b128 v[48:51], v15 offset:12288
    s_waitcnt lgkmcnt(4)
    v_mfma_f32_16x16x32_bf16 v[28:31], v[192:195], v[68:71], v[28:31]
    ds_read_b128 v[52:55], v16 offset:0
    v_mfma_f32_16x16x32_bf16 v[32:35], v[192:195], v[72:75], v[32:35]
    ds_read_b128 v[56:59], v16 offset:4096
    v_mfma_f32_16x16x32_bf16 v[32:35], v[196:199], v[80:83], v[32:35]
    ds_read_b128 v[60:63], v16 offset:8192
    v_mfma_f32_16x16x32_bf16 v[28:31], v[196:199], v[76:79], v[28:31]
    ds_read_b128 v[64:67], v16 offset:12288
    s_waitcnt lgkmcnt(4)
    v_mfma_f32_16x16x32_bf16 v[28:31], v[200:203], v[36:39], v[28:31]
    ds_read_b128 v[68:71], v17 offset:0
    v_mfma_f32_16x16x32_bf16 v[32:35], v[200:203], v[40:43], v[32:35]
    ds_read_b128 v[72:75], v17 offset:4096
    v_mfma_f32_16x16x32_bf16 v[32:35], v[204:207], v[48:51], v[32:35]
    ds_read_b128 v[76:79], v17 offset:8192
    v_mfma_f32_16x16x32_bf16 v[28:31], v[204:207], v[44:47], v[28:31]
    ds_read_b128 v[80:83], v17 offset:12288
    s_barrier
    s_waitcnt lgkmcnt(4)
    v_mfma_f32_16x16x32_bf16 v[28:31], v[208:211], v[52:55], v[28:31]
    ds_read_b128 v[36:39], v14 offset:16384
    v_mfma_f32_16x16x32_bf16 v[32:35], v[208:211], v[56:59], v[32:35]
    ds_read_b128 v[40:43], v14 offset:20480
    v_mfma_f32_16x16x32_bf16 v[32:35], v[212:215], v[64:67], v[32:35]
    ds_read_b128 v[44:47], v14 offset:24576
    v_mfma_f32_16x16x32_bf16 v[28:31], v[212:215], v[60:63], v[28:31]
    ds_read_b128 v[48:51], v14 offset:28672
    s_waitcnt lgkmcnt(4)
    v_mfma_f32_16x16x32_bf16 v[28:31], v[216:219], v[68:71], v[28:31]
    ds_read_b128 v[52:55], v15 offset:16384
    v_mfma_f32_16x16x32_bf16 v[32:35], v[216:219], v[72:75], v[32:35]
    ds_read_b128 v[56:59], v15 offset:20480
    v_mfma_f32_16x16x32_bf16 v[32:35], v[220:223], v[80:83], v[32:35]
    ds_read_b128 v[60:63], v15 offset:24576
    v_mfma_f32_16x16x32_bf16 v[28:31], v[220:223], v[76:79], v[28:31]
    ds_read_b128 v[64:67], v15 offset:28672
    s_waitcnt vmcnt(0)
    buffer_atomic_add v113, v112, s[56:59], s40 offen offset:3072 sc1
    s_waitcnt lgkmcnt(4)
    v_mfma_f32_16x16x32_bf16 v[28:31], v[224:227], v[36:39], v[28:31]
    ds_read_b128 v[68:71], v16 offset:16384
    v_mfma_f32_16x16x32_bf16 v[32:35], v[224:227], v[40:43], v[32:35]
    ds_read_b128 v[72:75], v16 offset:20480
    v_mfma_f32_16x16x32_bf16 v[32:35], v[228:231], v[48:51], v[32:35]
    ds_read_b128 v[76:79], v16 offset:24576
    v_mfma_f32_16x16x32_bf16 v[28:31], v[228:231], v[44:47], v[28:31]
    ds_read_b128 v[80:83], v16 offset:28672
    s_waitcnt lgkmcnt(4)
    v_mfma_f32_16x16x32_bf16 v[28:31], v[232:235], v[52:55], v[28:31]
    ds_read_b128 v[36:39], v17 offset:16384
    v_mfma_f32_16x16x32_bf16 v[32:35], v[232:235], v[56:59], v[32:35]
    ds_read_b128 v[40:43], v17 offset:20480
    v_mfma_f32_16x16x32_bf16 v[32:35], v[236:239], v[64:67], v[32:35]
    ds_read_b128 v[44:47], v17 offset:24576
    v_mfma_f32_16x16x32_bf16 v[28:31], v[236:239], v[60:63], v[28:31]
    ds_read_b128 v[48:51], v17 offset:28672
    s_barrier
    ds_read_b128 v[88:91], v18 offset:1536
    ds_read_b128 v[92:95], v18 offset:3584
    ds_read_b128 v[96:99], v18 offset:1792
    ds_read_b128 v[100:103], v18 offset:3840
    s_waitcnt lgkmcnt(8)
    v_mfma_f32_16x16x32_bf16 v[28:31], v[240:243], v[68:71], v[28:31]
    v_mfma_f32_16x16x32_bf16 v[32:35], v[240:243], v[72:75], v[32:35]
    v_mfma_f32_16x16x32_bf16 v[32:35], v[244:247], v[80:83], v[32:35]
    v_mfma_f32_16x16x32_bf16 v[28:31], v[244:247], v[76:79], v[28:31]
    s_waitcnt lgkmcnt(4)
    v_mfma_f32_16x16x32_bf16 v[28:31], v[248:251], v[36:39], v[28:31]
    v_mfma_f32_16x16x32_bf16 v[32:35], v[248:251], v[40:43], v[32:35]
    v_mfma_f32_16x16x32_bf16 v[32:35], v[252:255], v[48:51], v[32:35]
    v_mfma_f32_16x16x32_bf16 v[28:31], v[252:255], v[44:47], v[28:31]
    s_setprio 1
    s_waitcnt lgkmcnt(0)
    s_load_dword s32, s[4:5], s20 offset:2560
    s_load_dword s3, s[4:5], s20 offset:2688
    s_add_u32 m0, s12, 106496
    s_add_u32 s49, s8, 20480
    buffer_load_dwordx4 v2, s[16:19], s49 offen offset:0 sc1 lds
    buffer_load_dwordx4 v2, s[16:19], s49 offen offset:1024 sc1 lds
    buffer_load_dwordx4 v2, s[16:19], s49 offen offset:2048 sc1 lds
    buffer_load_dwordx4 v2, s[16:19], s49 offen offset:3072 sc1 lds
    v_pk_fma_f32 v[28:29], v[88:89], v[84:85], v[28:29]
    v_pk_fma_f32 v[30:31], v[88:89], v[86:87], v[30:31]
    v_pk_fma_f32 v[32:33], v[96:97], v[84:85], v[32:33]
    v_pk_fma_f32 v[34:35], v[96:97], v[86:87], v[34:35]
    v_pk_mul_f32 v[104:105], v[28:29], v[28:29]
    v_pk_mul_f32 v[106:107], v[30:31], v[30:31]
    v_pk_mul_f32 v[108:109], v[32:33], v[32:33]
    v_pk_mul_f32 v[110:111], v[34:35], v[34:35]
    v_pk_fma_f32 v[104:105], v[104:105], v[92:93], v[90:91]
    v_pk_fma_f32 v[106:107], v[106:107], v[92:93], v[90:91]
    v_pk_fma_f32 v[108:109], v[108:109], v[100:101], v[98:99]
    v_pk_fma_f32 v[110:111], v[110:111], v[100:101], v[98:99]
    v_pk_mul_f32 v[104:105], v[104:105], v[28:29]
    v_pk_mul_f32 v[106:107], v[106:107], v[30:31]
    v_pk_mul_f32 v[108:109], v[108:109], v[32:33]
    v_pk_mul_f32 v[110:111], v[110:111], v[34:35]
    v_exp_f32 v104, v104
    v_exp_f32 v105, v105
    v_exp_f32 v106, v106
    v_exp_f32 v107, v107
    v_exp_f32 v108, v108
    v_exp_f32 v109, v109
    v_exp_f32 v110, v110
    v_exp_f32 v111, v111
    v_pk_fma_f32 v[104:105], v[104:105], v[94:95], v[94:95]
    v_pk_fma_f32 v[106:107], v[106:107], v[94:95], v[94:95]
    v_pk_fma_f32 v[108:109], v[108:109], v[102:103], v[102:103]
    v_pk_fma_f32 v[110:111], v[110:111], v[102:103], v[102:103]
    v_rcp_f32 v104, v104
    v_rcp_f32 v105, v105
    v_rcp_f32 v106, v106
    v_rcp_f32 v107, v107
    v_rcp_f32 v108, v108
    v_rcp_f32 v109, v109
    v_rcp_f32 v110, v110
    v_rcp_f32 v111, v111
    v_pk_mul_f32 v[28:29], v[28:29], v[104:105]
    v_pk_mul_f32 v[30:31], v[30:31], v[106:107]
    v_pk_mul_f32 v[32:33], v[32:33], v[108:109]
    v_pk_mul_f32 v[34:35], v[34:35], v[110:111]
    v_add_u32 v28, 0x10000, v28
    v_add_u32 v30, 0x10000, v30
    v_add_u32 v32, 0x10000, v32
    v_add_u32 v34, 0x10000, v34
    v_and_b32 v28, 0xfffe0000, v28
    v_and_b32 v30, 0xfffe0000, v30
    v_and_b32 v32, 0xfffe0000, v32
    v_and_b32 v34, 0xfffe0000, v34
    v_cvt_pk_bf16_f32 v104, v28, v29
    v_cvt_pk_bf16_f32 v105, v30, v31
    v_cvt_pk_bf16_f32 v106, v32, v33
    v_cvt_pk_bf16_f32 v107, v34, v35
    s_add_u32 s36, s39, 393216
    v_permlane16_swap_b32 v104, v106
    v_permlane16_swap_b32 v105, v107
    buffer_store_dwordx4 v[104:107], v114, s[16:19], s36 offen sc1
    s_add_u32 m0, s12, 122880
    s_add_u32 s49, s8, 131072
    s_barrier
    s_waitcnt lgkmcnt(0)
    s_cmp_eq_u32 s32, s21
    s_cselect_b32 s32, s3, 0
    s_cmp_eq_u32 s32, s21
    s_cbranch_scc1 hok_11
    s_add_u32 s53, s20, 2560
    v_lshlrev_b32 v85, 7, v1
    v_add_u32 v85, s53, v85
    s_mov_b32 s53, 0
    s_add_u32 s54, s52, 16
    s_bfm_b64 exec, 2, 0
poll_12:
    buffer_load_dword v84, v85, s[56:59], 0 offen sc1
    s_waitcnt vmcnt(0)
    v_cmp_eq_u32 vcc, s54, v84
    s_nop 0
    s_cmp_eq_u64 vcc, exec
    s_cbranch_scc1 pok_13
    s_sleep 8
    s_add_u32 s53, s53, 1
    s_cmp_lt_u32 s53, s61
    s_cbranch_scc1 poll_12
    s_mov_b32 s61, 0
pok_13:
    s_mov_b64 exec, -1
hok_11:
    buffer_load_dwordx4 v2, s[16:19], s49 offen offset:0 sc1 lds
    buffer_load_dwordx4 v2, s[16:19], s49 offen offset:1024 sc1 lds
    buffer_load_dwordx4 v2, s[16:19], s49 offen offset:2048 sc1 lds
    buffer_load_dwordx4 v2, s[16:19], s49 offen offset:3072 sc1 lds
    s_add_u32 m0, s12, 139264
    s_add_u32 s49, s8, 135168
    s_barrier
    buffer_load_dwordx4 v2, s[16:19], s49 offen offset:0 sc1 lds
    buffer_load_dwordx4 v2, s[16:19], s49 offen offset:1024 sc1 lds
    buffer_load_dwordx4 v2, s[16:19], s49 offen offset:2048 sc1 lds
    buffer_load_dwordx4 v2, s[16:19], s49 offen offset:3072 sc1 lds
    s_add_u32 m0, s12, 16384
    s_add_u32 s49, s8, 147456
    s_waitcnt vmcnt(9)
    s_barrier
    s_waitcnt vmcnt(8)
    buffer_atomic_add v113, v112, s[56:59], s40 offen offset:3584 sc1
    buffer_load_dwordx4 v2, s[16:19], s49 offen offset:0 sc1 lds
    buffer_load_dwordx4 v2, s[16:19], s49 offen offset:1024 sc1 lds
    buffer_load_dwordx4 v2, s[16:19], s49 offen offset:2048 sc1 lds
    buffer_load_dwordx4 v2, s[16:19], s49 offen offset:3072 sc1 lds
    s_add_u32 m0, s12, 32768
    s_add_u32 s49, s8, 151552
    s_waitcnt vmcnt(9)
    s_barrier
    s_load_dword s32, s[4:5], s20 offset:3072
    s_load_dword s3, s[4:5], s20 offset:3200
    buffer_load_dwordx4 v2, s[16:19], s49 offen offset:0 sc1 lds
    buffer_load_dwordx4 v2, s[16:19], s49 offen offset:1024 sc1 lds
    buffer_load_dwordx4 v2, s[16:19], s49 offen offset:2048 sc1 lds
    buffer_load_dwordx4 v2, s[16:19], s49 offen offset:3072 sc1 lds
    s_add_u32 m0, s12, 106496
    s_add_u32 s49, s8, 262144
    s_waitcnt vmcnt(9)
    s_barrier
    s_waitcnt lgkmcnt(0)
    s_cmp_eq_u32 s32, s21
    s_cselect_b32 s32, s3, 0
    s_cmp_eq_u32 s32, s21
    s_cbranch_scc1 hok_14
    s_add_u32 s53, s20, 3072
    v_lshlrev_b32 v85, 7, v1
    v_add_u32 v85, s53, v85
    s_mov_b32 s53, 0
    s_add_u32 s54, s52, 16
    s_bfm_b64 exec, 2, 0
poll_15:
    buffer_load_dword v84, v85, s[56:59], 0 offen sc1
    s_waitcnt vmcnt(0)
    v_cmp_eq_u32 vcc, s54, v84
    s_nop 0
    s_cmp_eq_u64 vcc, exec
    s_cbranch_scc1 pok_16
    s_sleep 8
    s_add_u32 s53, s53, 1
    s_cmp_lt_u32 s53, s61
    s_cbranch_scc1 poll_15
    s_mov_b32 s61, 0
pok_16:
    s_mov_b64 exec, -1
hok_14:
    buffer_load_dwordx4 v2, s[16:19], s49 offen offset:0 sc1 lds
    buffer_load_dwordx4 v2, s[16:19], s49 offen offset:1024 sc1 lds
    buffer_load_dwordx4 v2, s[16:19], s49 offen offset:2048 sc1 lds
    buffer_load_dwordx4 v2, s[16:19], s49 offen offset:3072 sc1 lds
    s_add_u32 m0, s12, 122880
    s_add_u32 s49, s8, 266240
    s_waitcnt vmcnt(8)
    s_barrier
    buffer_load_dwordx4 v2, s[16:19], s49 offen offset:0 sc1 lds
    buffer_load_dwordx4 v2, s[16:19], s49 offen offset:1024 sc1 lds
    buffer_load_dwordx4 v2, s[16:19], s49 offen offset:2048 sc1 lds
    buffer_load_dwordx4 v2, s[16:19], s49 offen offset:3072 sc1 lds
    s_add_u32 m0, s12, 139264
    s_add_u32 s49, s8, 278528
    s_waitcnt vmcnt(8)
    s_barrier
    buffer_load_dwordx4 v2, s[16:19], s49 offen offset:0 sc1 lds
    buffer_load_dwordx4 v2, s[16:19], s49 offen offset:1024 sc1 lds
    buffer_load_dwordx4 v2, s[16:19], s49 offen offset:2048 sc1 lds
    buffer_load_dwordx4 v2, s[16:19], s49 offen offset:3072 sc1 lds
    s_add_u32 m0, s12, 16384
    s_add_u32 s49, s8, 282624
    s_waitcnt vmcnt(8)
    s_barrier
    s_load_dword s32, s[4:5], s20 offset:3584
    s_load_dword s3, s[4:5], s20 offset:3712
    buffer_load_dwordx4 v2, s[16:19], s49 offen offset:0 sc1 lds
    buffer_load_dwordx4 v2, s[16:19], s49 offen offset:1024 sc1 lds
    buffer_load_dwordx4 v2, s[16:19], s49 offen offset:2048 sc1 lds
    buffer_load_dwordx4 v2, s[16:19], s49 offen offset:3072 sc1 lds
    s_add_u32 m0, s12, 32768
    s_add_u32 s49, s8, 393216
    s_waitcnt vmcnt(8)
    s_barrier
    s_waitcnt lgkmcnt(0)
    s_cmp_eq_u32 s32, s21
    s_cselect_b32 s32, s3, 0
    s_cmp_eq_u32 s32, s21
    s_cbranch_scc1 hok_17
    s_add_u32 s53, s20, 3584
    v_lshlrev_b32 v85, 7, v1
    v_add_u32 v85, s53, v85
    s_mov_b32 s53, 0
    s_add_u32 s54, s52, 16
    s_bfm_b64 exec, 2, 0
poll_18:
    buffer_load_dword v84, v85, s[56:59], 0 offen sc1
    s_waitcnt vmcnt(0)
    v_cmp_eq_u32 vcc, s54, v84
    s_nop 0
    s_cmp_eq_u64 vcc, exec
    s_cbranch_scc1 pok_19
    s_sleep 8
    s_add_u32 s53, s53, 1
    s_cmp_lt_u32 s53, s61
    s_cbranch_scc1 poll_18
    s_mov_b32 s61, 0
pok_19:
    s_mov_b64 exec, -1
hok_17:
    buffer_load_dwordx4 v2, s[16:19], s49 offen offset:0 sc1 lds
    buffer_load_dwordx4 v2, s[16:19], s49 offen offset:1024 sc1 lds
    buffer_load_dwordx4 v2, s[16:19], s49 offen offset:2048 sc1 lds
    buffer_load_dwordx4 v2, s[16:19], s49 offen offset:3072 sc1 lds
    s_add_u32 m0, s12, 106496
    s_add_u32 s49, s8, 397312
    s_waitcnt vmcnt(8)
    s_barrier
    buffer_load_dwordx4 v2, s[16:19], s49 offen offset:0 sc1 lds
    buffer_load_dwordx4 v2, s[16:19], s49 offen offset:1024 sc1 lds
    buffer_load_dwordx4 v2, s[16:19], s49 offen offset:2048 sc1 lds
    buffer_load_dwordx4 v2, s[16:19], s49 offen offset:3072 sc1 lds
    s_add_u32 m0, s12, 122880
    s_add_u32 s49, s8, 409600
    s_waitcnt vmcnt(8)
    s_barrier
    buffer_load_dwordx4 v2, s[16:19], s49 offen offset:0 sc1 lds
    buffer_load_dwordx4 v2, s[16:19], s49 offen offset:1024 sc1 lds
    buffer_load_dwordx4 v2, s[16:19], s49 offen offset:2048 sc1 lds
    buffer_load_dwordx4 v2, s[16:19], s49 offen offset:3072 sc1 lds
    s_add_u32 m0, s12, 139264
    s_add_u32 s49, s8, 413696
    s_waitcnt vmcnt(8)
    s_barrier
    buffer_load_dwordx4 v2, s[16:19], s49 offen offset:0 sc1 lds
    buffer_load_dwordx4 v2, s[16:19], s49 offen offset:1024 sc1 lds
    buffer_load_dwordx4 v2, s[16:19], s49 offen offset:2048 sc1 lds
    buffer_load_dwordx4 v2, s[16:19], s49 offen offset:3072 sc1 lds
    s_waitcnt vmcnt(8)
    s_barrier
    s_lshr_b32 s34, s30, 1
    s_and_b32 s35, s30, 1
    v_and_b32 v22, 15, v1
    v_lshrrev_b32 v23, 4, v1
    s_mul_i32 s37, s34, 4
    s_mul_i32 s36, s34, 8192
    v_add_u32 v12, s36, v2
    v_lshrrev_b32 v18, 2, v1
    v_mul_u32_u24 v13, 448, v18
    v_and_b32 v19, 3, v1
    v_lshl_add_u32 v13, v19, 3, v13
    v_add_u32 v13, 49152, v13
    v_mul_u32_u24 v15, 448, v18
    v_and_b32 v19, 2, v1
    v_lshl_add_u32 v15, v19, 2, v15
    v_bfe_u32 v18, v1, 4, 1
    v_and_b32 v19, 1, v1
    v_xor_b32 v19, v19, v18
    v_lshl_add_u32 v15, v19, 5, v15
    s_lshl_b32 s36, s35, 4
    s_add_u32 s36, s36, 49344
    v_add_u32 v15, s36, v15
    s_lshl_b32 s36, s35, 8
    v_add_u32 v13, s36, v13
    v_lshlrev_b32 v18, 5, v18
    v_sub_u32 v14, v13, v18
    v_add_u32 v13, v13, v18
    s_mov_b32 s42, 0
    s_mov_b32 s43, 0
    s_mov_b32 s48, 0
    v_mov_b32 v17, v12
    v_mov_b32 v18, v13
    v_mov_b32 v19, v14
    v_mov_b32 v20, v15
    s_waitcnt vmcnt(4)
    s_barrier
    s_waitcnt vmcnt(0)
    s_barrier
    s_setprio 0
    s_waitcnt lgkmcnt(0)
    s_barrier
    ds_read_b128 v[136:139], v17 offset:0
    ds_read_b128 v[140:143], v17 offset:2048
    ds_read_b128 v[144:147], v17 offset:4096
    ds_read_b128 v[148:151], v17 offset:6144
    ds_read_b64_tr_b16 v[152:153], v18 offset:0
    ds_read_b64_tr_b16 v[154:155], v18 offset:7168
    ds_read_b64_tr_b16 v[156:157], v19 offset:32
    ds_read_b64_tr_b16 v[158:159], v19 offset:7200
    ds_read_b64_tr_b16 v[160:161], v18 offset:64
    ds_read_b64_tr_b16 v[162:163], v18 offset:7232
    ds_read_b64_tr_b16 v[164:165], v19 offset:96
    ds_read_b64_tr_b16 v[166:167], v19 offset:7264
    ds_read_b64_tr_b16 v[168:169], v18 offset:128
    ds_read_b64_tr_b16 v[170:171], v18 offset:7296
    ds_read_b64_tr_b16 v[172:173], v19 offset:160
    ds_read_b64_tr_b16 v[174:175], v19 offset:7328
    ds_read_b64_tr_b16 v[176:177], v20 offset:0
    ds_read_b64_tr_b16 v[178:179], v20 offset:7168
    s_waitcnt lgkmcnt(0)
    v_mfma_f32_16x16x32_bf16 v[24:27], v[152:155], v[136:139], 0
    ds_read_b128 v[180:183], v17 offset:1024
    v_mfma_f32_16x16x32_bf16 v[52:55], v[152:155], v[140:143], 0
    ds_read_b128 v[184:187], v17 offset:3072
    v_mfma_f32_16x16x32_bf16 v[80:83], v[152:155], v[144:147], 0
    ds_read_b128 v[188:191], v17 offset:5120
    v_mfma_f32_16x16x32_bf16 v[108:111], v[152:155], v[148:151], 0
    ds_read_b128 v[192:195], v17 offset:7168
    v_mfma_f32_16x16x32_bf16 v[112:115], v[156:159], v[148:151], 0
    ds_read_b64_tr_b16 v[196:197], v18 offset:14336
    v_mfma_f32_16x16x32_bf16 v[84:87], v[156:159], v[144:147], 0
    ds_read_b64_tr_b16 v[198:199], v18 offset:21504
    v_mfma_f32_16x16x32_bf16 v[56:59], v[156:159], v[140:143], 0
    v_mfma_f32_16x16x32_bf16 v[28:31], v[156:159], v[136:139], 0
    ds_read_b64_tr_b16 v[200:201], v19 offset:14368
    v_mfma_f32_16x16x32_bf16 v[32:35], v[160:163], v[136:139], 0
    ds_read_b64_tr_b16 v[202:203], v19 offset:21536
    v_mfma_f32_16x16x32_bf16 v[60:63], v[160:163], v[140:143], 0
    ds_read_b64_tr_b16 v[204:205], v18 offset:14400
    v_mfma_f32_16x16x32_bf16 v[88:91], v[160:163], v[144:147], 0
    ds_read_b64_tr_b16 v[206:207], v18 offset:21568
    v_mfma_f32_16x16x32_bf16 v[116:119], v[160:163], v[148:151], 0
    ds_read_b64_tr_b16 v[208:209], v19 offset:14432
    v_mfma_f32_16x16x32_bf16 v[120:123], v[164:167], v[148:151], 0
    ds_read_b64_tr_b16 v[210:211], v19 offset:21600
    v_mfma_f32_16x16x32_bf16 v[92:95], v[164:167], v[144:147], 0
    v_mfma_f32_16x16x32_bf16 v[64:67], v[164:167], v[140:143], 0
    ds_read_b64_tr_b16 v[212:213], v18 offset:14464
    v_mfma_f32_16x16x32_bf16 v[36:39], v[164:167], v[136:139], 0
    ds_read_b64_tr_b16 v[214:215], v18 offset:21632
    v_mfma_f32_16x16x32_bf16 v[40:43], v[168:171], v[136:139], 0
    ds_read_b64_tr_b16 v[216:217], v19 offset:14496
    v_mfma_f32_16x16x32_bf16 v[68:71], v[168:171], v[140:143], 0
    ds_read_b64_tr_b16 v[218:219], v19 offset:21664
    v_mfma_f32_16x16x32_bf16 v[96:99], v[168:171], v[144:147], 0
    ds_read_b64_tr_b16 v[220:221], v20 offset:14336
    v_mfma_f32_16x16x32_bf16 v[124:127], v[168:171], v[148:151], 0
    ds_read_b64_tr_b16 v[222:223], v20 offset:21504
    v_mfma_f32_16x16x32_bf16 v[128:131], v[172:175], v[148:151], 0
    s_add_u32 s42, s42, 16384
    s_cmp_eq_u32 s42, 49152
    v_mfma_f32_16x16x32_bf16 v[100:103], v[172:175], v[144:147], 0
    s_cselect_b32 s42, 0, s42
    s_add_u32 s48, s48, 28672
    v_mfma_f32_16x16x32_bf16 v[72:75], v[172:175], v[140:143], 0
    s_cmp_eq_u32 s48, 86016
    s_cselect_b32 s48, 0, s48
    v_mfma_f32_16x16x32_bf16 v[44:47], v[172:175], v[136:139], 0
    v_add_u32 v17, s42, v12
    v_add_u32 v18, s48, v13
    v_mfma_f32_16x16x32_bf16 v[48:51], v[176:179], v[136:139], 0
    v_add_u32 v19, s48, v14
    v_add_u32 v20, s48, v15
    v_mfma_f32_16x16x32_bf16 v[76:79], v[176:179], v[140:143], 0
    v_mfma_f32_16x16x32_bf16 v[104:107], v[176:179], v[144:147], 0
    v_mfma_f32_16x16x32_bf16 v[132:135], v[176:179], v[148:151], 0
    s_waitcnt lgkmcnt(0)
    v_mfma_f32_16x16x32_bf16 v[24:27], v[196:199], v[180:183], v[24:27]
    v_mfma_f32_16x16x32_bf16 v[52:55], v[196:199], v[184:187], v[52:55]
    v_mfma_f32_16x16x32_bf16 v[80:83], v[196:199], v[188:191], v[80:83]
    v_mfma_f32_16x16x32_bf16 v[108:111], v[196:199], v[192:195], v[108:111]
    v_mfma_f32_16x16x32_bf16 v[112:115], v[200:203], v[192:195], v[112:115]
    v_mfma_f32_16x16x32_bf16 v[84:87], v[200:203], v[188:191], v[84:87]
    v_mfma_f32_16x16x32_bf16 v[56:59], v[200:203], v[184:187], v[56:59]
    v_mfma_f32_16x16x32_bf16 v[28:31], v[200:203], v[180:183], v[28:31]
    v_mfma_f32_16x16x32_bf16 v[32:35], v[204:207], v[180:183], v[32:35]
    v_mfma_f32_16x16x32_bf16 v[60:63], v[204:207], v[184:187], v[60:63]
    v_mfma_f32_16x16x32_bf16 v[88:91], v[204:207], v[188:191], v[88:91]
    v_mfma_f32_16x16x32_bf16 v[116:119], v[204:207], v[192:195], v[116:119]
    v_mfma_f32_16x16x32_bf16 v[120:123], v[208:211], v[192:195], v[120:123]
    v_mfma_f32_16x16x32_bf16 v[92:95], v[208:211], v[188:191], v[92:95]
    v_mfma_f32_16x16x32_bf16 v[64:67], v[208:211], v[184:187], v[64:67]
    v_mfma_f32_16x16x32_bf16 v[36:39], v[208:211], v[180:183], v[36:39]
    v_mfma_f32_16x16x32_bf16 v[40:43], v[212:215], v[180:183], v[40:43]
    v_mfma_f32_16x16x32_bf16 v[68:71], v[212:215], v[184:187], v[68:71]
    v_mfma_f32_16x16x32_bf16 v[96:99], v[212:215], v[188:191], v[96:99]
    v_mfma_f32_16x16x32_bf16 v[124:127], v[212:215], v[192:195], v[124:127]
    v_mfma_f32_16x16x32_bf16 v[128:131], v[216:219], v[192:195], v[128:131]
    s_add_u32 s43, s43, 1
    v_mfma_f32_16x16x32_bf16 v[100:103], v[216:219], v[188:191], v[100:103]
    v_mfma_f32_16x16x32_bf16 v[72:75], v[216:219], v[184:187], v[72:75]
    v_mfma_f32_16x16x32_bf16 v[44:47], v[216:219], v[180:183], v[44:47]
    v_mfma_f32_16x16x32_bf16 v[48:51], v[220:223], v[180:183], v[48:51]
    v_mfma_f32_16x16x32_bf16 v[76:79], v[220:223], v[184:187], v[76:79]
    v_mfma_f32_16x16x32_bf16 v[104:107], v[220:223], v[188:191], v[104:107]
    v_mfma_f32_16x16x32_bf16 v[132:135], v[220:223], v[192:195], v[132:135]
    s_load_dwordx2 s[6:7], s[0:1], 88
    s_mov_b32 s16, s62
    s_mov_b32 s17, s63
    s_mov_b32 s18, 0x1be000
    s_mov_b32 s19, 0x20000
    s_mul_i32 s39, s37, 229376
    s_mul_i32 s40, s29, 7
    s_lshl2_add_u32 s41, s35, s40
    s_add_u32 s36, s41, 0
    s_lshr_b32 s53, s36, 3
    s_lshl_b32 s53, s53, 14
    s_and_b32 s44, s36, 7
    s_lshl_b32 s44, s44, 10
    s_add_u32 s44, s44, s53
    s_add_u32 s44, s44, s39
    s_add_u32 s36, s41, 1
    s_lshr_b32 s53, s36, 3
    s_lshl_b32 s53, s53, 14
    s_and_b32 s45, s36, 7
    s_lshl_b32 s45, s45, 10
    s_add_u32 s45, s45, s53
    s_add_u32 s45, s45, s39
    s_add_u32 s36, s41, 2
    s_lshr_b32 s53, s36, 3
    s_lshl_b32 s53, s53, 14
    s_and_b32 s46, s36, 7
    s_lshl_b32 s46, s46, 10
    s_add_u32 s46, s46, s53
    s_add_u32 s46, s46, s39
    s_add_u32 s36, s40, 3
    s_lshr_b32 s53, s36, 3
    s_lshl_b32 s53, s53, 14
    s_and_b32 s47, s36, 7
    s_lshl_b32 s47, s47, 10
    s_add_u32 s47, s47, s53
    s_add_u32 s47, s47, s39
    s_lshl_b32 s36, s35, 9
    s_add_u32 s47, s47, s36
    s_lshl1_add_u32 s49, s31, s34
    s_lshl_b32 s49, s49, 7
    s_add_u32 s49, s49, s55
    s_add_u32 s49, s49, 0x1000
    s_lshl_b32 s86, s60, 24
    s_lshl_b32 s87, s94, 13
    s_add_u32 s86, s86, s87
    s_add_u32 s86, s86, 167772160
    s_add_u32 s84, s4, s86
    s_addc_u32 s85, s5, 0
    s_mov_b32 s86, 8380416
    s_mov_b32 s87, 0x20000
    s_add_u32 s88, s62, 0x480000
    s_addc_u32 s89, s63, 0
    s_mov_b32 s90, 0x7e000
    s_mov_b32 s91, 0x20000
    s_add_u32 s24, s62, 0x400000
    s_addc_u32 s25, s63, 0
    s_mov_b32 s26, 0x7e000
    s_mov_b32 s27, 0x20000
    s_lshl1_add_u32 s39, s33, s35
    s_lshl_b32 s36, s39, 1
    s_lshr_b32 s53, s36, 3
    s_lshl_b32 s53, s53, 14
    s_and_b32 s40, s36, 7
    s_lshl_b32 s40, s40, 10
    s_add_u32 s40, s40, s53
    s_lshl1_add_u32 s38, s31, s37
    s_lshl_b32 s36, s38, 16
    s_add_u32 s40, s40, s36
    s_add_u32 s12, s40, 65536
    s_xor_b32 s41, s40, 0x20000
    s_lshl3_add_u32 s38, s28, s38
    s_lshl_b32 s39, s39, 7
    s_lshl_b32 s13, s38, 16
    s_add_u32 s13, s13, s39
    s_add_u32 s14, s13, 65536
    s_lshl_b32 s38, s38, 15
    s_add_u32 s38, s38, s39
    s_add_u32 s39, s38, 32768
    s_mov_b32 s15, 0xffff0000
    s_waitcnt lgkmcnt(0)
    s_mov_b32 s20, s6
    s_mov_b32 s21, s7
    s_mov_b32 s22, 0x400000
    s_mov_b32 s23, 0x20000
    v_lshrrev_b32 v254, 1, v23
    v_lshlrev_b32 v254, 8, v254
    v_lshl_add_u32 v254, v22, 4, v254
    v_and_b32 v6, 1, v23
    v_lshl_add_u32 v254, v6, 3, v254
    v_lshrrev_b32 v6, 2, v22
    v_cmp_eq_u32 vcc, v6, v23
    v_and_b32 v6, 1, v22
    v_lshlrev_b32 v6, 4, v6
    v_mov_b32 v224, 0x3f80
    v_lshlrev_b32 v6, v6, v224
    v_cndmask_b32 v6, 0, v6, vcc
    v_and_b32 v224, 2, v22
    v_cmp_eq_u32 vcc, 0, v224
    v_mov_b32 v224, 0
    v_mov_b32 v225, 0
    v_mov_b32 v228, 0
    v_mov_b32 v229, 0
    v_cndmask_b32 v226, 0, v6, vcc
    v_cndmask_b32 v227, v6, v224, vcc
    v_and_b32 v6, 3, v22
    v_lshrrev_b32 v255, 2, v22
    v_lshlrev_b32 v255, 14, v255
    v_lshl_add_u32 v255, v6, 11, v255
    v_lshl_add_u32 v255, v23, 4, v255
    v_mov_b32 v8, 1
    v_mov_b32 v9, 0x7f000000
    v_writelane_b32 v9, 0, 0
    v_and_b32 v11, 1, v23
    v_lshlrev_b32 v10, 11, v22
    v_lshl_add_u32 v10, v11, 5, v10
    v_lshrrev_b32 v11, 1, v23
    v_lshl_add_u32 v10, v11, 4, v10
    v_lshrrev_b32 v11, 3, v22
    v_mul_u32_u24 v11, 16320, v11
    v_sub_u32 v10, v10, v11
    v_add_u32 v11, 16384, v10
    s_mul_i32 s36, s35, 448
    s_add_u32 s36, s36, 159744
    v_lshlrev_b32 v6, 4, v23
    v_add_u32 v6, s36, v6
    s_lshl_b32 s36, s34, 10
    s_add_u32 s36, s36, 160768
    v_lshlrev_b32 v7, 4, v22
    v_add_u32 v7, s36, v7
    s_lshl1_add_u32 s36, s37, s35
    s_lshl2_add_u32 s36, s31, s36
    s_lshl_b32 s36, s36, 10
    v_add_u32 v22, s36, v2
    v_xor_b32 v23, 4096, v22
    s_barrier
    ds_read_b128 v[136:139], v17 offset:0
    ds_read_b128 v[140:143], v17 offset:2048
    ds_read_b128 v[144:147], v17 offset:4096
    ds_read_b128 v[148:151], v17 offset:6144
    ds_read_b64_tr_b16 v[152:153], v18 offset:0
    ds_read_b64_tr_b16 v[154:155], v18 offset:7168
    ds_read_b64_tr_b16 v[156:157], v19 offset:32
    ds_read_b64_tr_b16 v[158:159], v19 offset:7200
    ds_read_b64_tr_b16 v[160:161], v18 offset:64
    ds_read_b64_tr_b16 v[162:163], v18 offset:7232
    ds_read_b64_tr_b16 v[164:165], v19 offset:96
    ds_read_b64_tr_b16 v[166:167], v19 offset:7264
    ds_read_b64_tr_b16 v[168:169], v18 offset:128
    ds_read_b64_tr_b16 v[170:171], v18 offset:7296
    ds_read_b64_tr_b16 v[172:173], v19 offset:160
    ds_read_b64_tr_b16 v[174:175], v19 offset:7328
    ds_read_b64_tr_b16 v[176:177], v20 offset:0
    ds_read_b64_tr_b16 v[178:179], v20 offset:7168
mm_20:
    s_waitcnt lgkmcnt(0)
    v_mfma_f32_16x16x32_bf16 v[24:27], v[152:155], v[136:139], v[24:27]
    ds_read_b128 v[180:183], v17 offset:1024
    v_mfma_f32_16x16x32_bf16 v[52:55], v[152:155], v[140:143], v[52:55]
    ds_read_b128 v[184:187], v17 offset:3072
    v_mfma_f32_16x16x32_bf16 v[80:83], v[152:155], v[144:147], v[80:83]
    ds_read_b128 v[188:191], v17 offset:5120
    v_mfma_f32_16x16x32_bf16 v[108:111], v[152:155], v[148:151], v[108:111]
    ds_read_b128 v[192:195], v17 offset:7168
    v_mfma_f32_16x16x32_bf16 v[112:115], v[156:159], v[148:151], v[112:115]
    ds_read_b64_tr_b16 v[196:197], v18 offset:14336
    v_mfma_f32_16x16x32_bf16 v[84:87], v[156:159], v[144:147], v[84:87]
    ds_read_b64_tr_b16 v[198:199], v18 offset:21504
    v_mfma_f32_16x16x32_bf16 v[56:59], v[156:159], v[140:143], v[56:59]
    v_mfma_f32_16x16x32_bf16 v[28:31], v[156:159], v[136:139], v[28:31]
    ds_read_b64_tr_b16 v[200:201], v19 offset:14368
    v_mfma_f32_16x16x32_bf16 v[32:35], v[160:163], v[136:139], v[32:35]
    ds_read_b64_tr_b16 v[202:203], v19 offset:21536
    v_mfma_f32_16x16x32_bf16 v[60:63], v[160:163], v[140:143], v[60:63]
    ds_read_b64_tr_b16 v[204:205], v18 offset:14400
    v_mfma_f32_16x16x32_bf16 v[88:91], v[160:163], v[144:147], v[88:91]
    ds_read_b64_tr_b16 v[206:207], v18 offset:21568
    v_mfma_f32_16x16x32_bf16 v[116:119], v[160:163], v[148:151], v[116:119]
    ds_read_b64_tr_b16 v[208:209], v19 offset:14432
    v_mfma_f32_16x16x32_bf16 v[120:123], v[164:167], v[148:151], v[120:123]
    ds_read_b64_tr_b16 v[210:211], v19 offset:21600
    v_mfma_f32_16x16x32_bf16 v[92:95], v[164:167], v[144:147], v[92:95]
    v_mfma_f32_16x16x32_bf16 v[64:67], v[164:167], v[140:143], v[64:67]
    ds_read_b64_tr_b16 v[212:213], v18 offset:14464
    v_mfma_f32_16x16x32_bf16 v[36:39], v[164:167], v[136:139], v[36:39]
    ds_read_b64_tr_b16 v[214:215], v18 offset:21632
    v_mfma_f32_16x16x32_bf16 v[40:43], v[168:171], v[136:139], v[40:43]
    ds_read_b64_tr_b16 v[216:217], v19 offset:14496
    v_mfma_f32_16x16x32_bf16 v[68:71], v[168:171], v[140:143], v[68:71]
    ds_read_b64_tr_b16 v[218:219], v19 offset:21664
    v_mfma_f32_16x16x32_bf16 v[96:99], v[168:171], v[144:147], v[96:99]
    ds_read_b64_tr_b16 v[220:221], v20 offset:14336
    v_mfma_f32_16x16x32_bf16 v[124:127], v[168:171], v[148:151], v[124:127]
    ds_read_b64_tr_b16 v[222:223], v20 offset:21504
    v_mfma_f32_16x16x32_bf16 v[128:131], v[172:175], v[148:151], v[128:131]
    s_add_u32 s42, s42, 16384
    s_cmp_eq_u32 s42, 49152
    v_mfma_f32_16x16x32_bf16 v[100:103], v[172:175], v[144:147], v[100:103]
    s_cselect_b32 s42, 0, s42
    s_add_u32 s48, s48, 28672
    v_mfma_f32_16x16x32_bf16 v[72:75], v[172:175], v[140:143], v[72:75]
    s_cmp_eq_u32 s48, 86016
    s_cselect_b32 s48, 0, s48
    v_mfma_f32_16x16x32_bf16 v[44:47], v[172:175], v[136:139], v[44:47]
    v_add_u32 v17, s42, v12
    v_add_u32 v18, s48, v13
    v_mfma_f32_16x16x32_bf16 v[48:51], v[176:179], v[136:139], v[48:51]
    v_add_u32 v19, s48, v14
    v_add_u32 v20, s48, v15
    v_mfma_f32_16x16x32_bf16 v[76:79], v[176:179], v[140:143], v[76:79]
    v_mfma_f32_16x16x32_bf16 v[104:107], v[176:179], v[144:147], v[104:107]
    v_mfma_f32_16x16x32_bf16 v[132:135], v[176:179], v[148:151], v[132:135]
    s_waitcnt lgkmcnt(0)
    s_barrier
    v_mfma_f32_16x16x32_bf16 v[24:27], v[196:199], v[180:183], v[24:27]
    ds_read_b128 v[136:139], v17 offset:0
    v_mfma_f32_16x16x32_bf16 v[52:55], v[196:199], v[184:187], v[52:55]
    ds_read_b128 v[140:143], v17 offset:2048
    v_mfma_f32_16x16x32_bf16 v[80:83], v[196:199], v[188:191], v[80:83]
    ds_read_b128 v[144:147], v17 offset:4096
    v_mfma_f32_16x16x32_bf16 v[108:111], v[196:199], v[192:195], v[108:111]
    ds_read_b128 v[148:151], v17 offset:6144
    v_mfma_f32_16x16x32_bf16 v[112:115], v[200:203], v[192:195], v[112:115]
    ds_read_b64_tr_b16 v[152:153], v18 offset:0
    v_mfma_f32_16x16x32_bf16 v[84:87], v[200:203], v[188:191], v[84:87]
    ds_read_b64_tr_b16 v[154:155], v18 offset:7168
    v_mfma_f32_16x16x32_bf16 v[56:59], v[200:203], v[184:187], v[56:59]
    v_mfma_f32_16x16x32_bf16 v[28:31], v[200:203], v[180:183], v[28:31]
    ds_read_b64_tr_b16 v[156:157], v19 offset:32
    v_mfma_f32_16x16x32_bf16 v[32:35], v[204:207], v[180:183], v[32:35]
    ds_read_b64_tr_b16 v[158:159], v19 offset:7200
    v_mfma_f32_16x16x32_bf16 v[60:63], v[204:207], v[184:187], v[60:63]
    ds_read_b64_tr_b16 v[160:161], v18 offset:64
    v_mfma_f32_16x16x32_bf16 v[88:91], v[204:207], v[188:191], v[88:91]
    ds_read_b64_tr_b16 v[162:163], v18 offset:7232
    v_mfma_f32_16x16x32_bf16 v[116:119], v[204:207], v[192:195], v[116:119]
    ds_read_b64_tr_b16 v[164:165], v19 offset:96
    v_mfma_f32_16x16x32_bf16 v[120:123], v[208:211], v[192:195], v[120:123]
    ds_read_b64_tr_b16 v[166:167], v19 offset:7264
    v_mfma_f32_16x16x32_bf16 v[92:95], v[208:211], v[188:191], v[92:95]
    v_mfma_f32_16x16x32_bf16 v[64:67], v[208:211], v[184:187], v[64:67]
    ds_read_b64_tr_b16 v[168:169], v18 offset:128
    v_mfma_f32_16x16x32_bf16 v[36:39], v[208:211], v[180:183], v[36:39]
    ds_read_b64_tr_b16 v[170:171], v18 offset:7296
    v_mfma_f32_16x16x32_bf16 v[40:43], v[212:215], v[180:183], v[40:43]
    ds_read_b64_tr_b16 v[172:173], v19 offset:160
    v_mfma_f32_16x16x32_bf16 v[68:71], v[212:215], v[184:187], v[68:71]
    ds_read_b64_tr_b16 v[174:175], v19 offset:7328
    v_mfma_f32_16x16x32_bf16 v[96:99], v[212:215], v[188:191], v[96:99]
    ds_read_b64_tr_b16 v[176:177], v20 offset:0
    v_mfma_f32_16x16x32_bf16 v[124:127], v[212:215], v[192:195], v[124:127]
    ds_read_b64_tr_b16 v[178:179], v20 offset:7168
    v_mfma_f32_16x16x32_bf16 v[128:131], v[216:219], v[192:195], v[128:131]
    s_add_u32 s43, s43, 1
    v_mfma_f32_16x16x32_bf16 v[100:103], v[216:219], v[188:191], v[100:103]
    s_cmp_lt_u32 s43, 15
    v_mfma_f32_16x16x32_bf16 v[72:75], v[216:219], v[184:187], v[72:75]
    v_mfma_f32_16x16x32_bf16 v[44:47], v[216:219], v[180:183], v[44:47]
    v_mfma_f32_16x16x32_bf16 v[48:51], v[220:223], v[180:183], v[48:51]
    v_mfma_f32_16x16x32_bf16 v[76:79], v[220:223], v[184:187], v[76:79]
    v_mfma_f32_16x16x32_bf16 v[104:107], v[220:223], v[188:191], v[104:107]
    v_mfma_f32_16x16x32_bf16 v[132:135], v[220:223], v[192:195], v[132:135]
    s_cbranch_scc1 mm_20
    s_waitcnt lgkmcnt(0)
    v_mfma_f32_16x16x32_bf16 v[24:27], v[152:155], v[136:139], v[24:27]
    ds_read_b128 v[180:183], v17 offset:1024
    v_mfma_f32_16x16x32_bf16 v[52:55], v[152:155], v[140:143], v[52:55]
    ds_read_b128 v[184:187], v17 offset:3072
    v_mfma_f32_16x16x32_bf16 v[80:83], v[152:155], v[144:147], v[80:83]
    ds_read_b128 v[188:191], v17 offset:5120
    v_mfma_f32_16x16x32_bf16 v[108:111], v[152:155], v[148:151], v[108:111]
    ds_read_b128 v[192:195], v17 offset:7168
    v_mfma_f32_16x16x32_bf16 v[112:115], v[156:159], v[148:151], v[112:115]
    ds_read_b64_tr_b16 v[196:197], v18 offset:14336
    v_mfma_f32_16x16x32_bf16 v[84:87], v[156:159], v[144:147], v[84:87]
    ds_read_b64_tr_b16 v[198:199], v18 offset:21504
    v_mfma_f32_16x16x32_bf16 v[56:59], v[156:159], v[140:143], v[56:59]
    v_mfma_f32_16x16x32_bf16 v[28:31], v[156:159], v[136:139], v[28:31]
    ds_read_b64_tr_b16 v[200:201], v19 offset:14368
    v_mfma_f32_16x16x32_bf16 v[32:35], v[160:163], v[136:139], v[32:35]
    ds_read_b64_tr_b16 v[202:203], v19 offset:21536
    v_mfma_f32_16x16x32_bf16 v[60:63], v[160:163], v[140:143], v[60:63]
    ds_read_b64_tr_b16 v[204:205], v18 offset:14400
    v_mfma_f32_16x16x32_bf16 v[88:91], v[160:163], v[144:147], v[88:91]
    ds_read_b64_tr_b16 v[206:207], v18 offset:21568
    v_mfma_f32_16x16x32_bf16 v[116:119], v[160:163], v[148:151], v[116:119]
    ds_read_b64_tr_b16 v[208:209], v19 offset:14432
    v_mfma_f32_16x16x32_bf16 v[120:123], v[164:167], v[148:151], v[120:123]
    ds_read_b64_tr_b16 v[210:211], v19 offset:21600
    v_mfma_f32_16x16x32_bf16 v[92:95], v[164:167], v[144:147], v[92:95]
    v_mfma_f32_16x16x32_bf16 v[64:67], v[164:167], v[140:143], v[64:67]
    ds_read_b64_tr_b16 v[212:213], v18 offset:14464
    v_mfma_f32_16x16x32_bf16 v[36:39], v[164:167], v[136:139], v[36:39]
    ds_read_b64_tr_b16 v[214:215], v18 offset:21632
    v_mfma_f32_16x16x32_bf16 v[40:43], v[168:171], v[136:139], v[40:43]
    ds_read_b64_tr_b16 v[216:217], v19 offset:14496
    v_mfma_f32_16x16x32_bf16 v[68:71], v[168:171], v[140:143], v[68:71]
    ds_read_b64_tr_b16 v[218:219], v19 offset:21664
    v_mfma_f32_16x16x32_bf16 v[96:99], v[168:171], v[144:147], v[96:99]
    ds_read_b64_tr_b16 v[220:221], v20 offset:14336
    v_mfma_f32_16x16x32_bf16 v[124:127], v[168:171], v[148:151], v[124:127]
    ds_read_b64_tr_b16 v[222:223], v20 offset:21504
    v_mfma_f32_16x16x32_bf16 v[128:131], v[172:175], v[148:151], v[128:131]
    v_mfma_f32_16x16x32_bf16 v[100:103], v[172:175], v[144:147], v[100:103]
    v_mfma_f32_16x16x32_bf16 v[72:75], v[172:175], v[140:143], v[72:75]
    v_mfma_f32_16x16x32_bf16 v[44:47], v[172:175], v[136:139], v[44:47]
    v_mfma_f32_16x16x32_bf16 v[48:51], v[176:179], v[136:139], v[48:51]
    v_mfma_f32_16x16x32_bf16 v[76:79], v[176:179], v[140:143], v[76:79]
    v_mfma_f32_16x16x32_bf16 v[104:107], v[176:179], v[144:147], v[104:107]
    v_mfma_f32_16x16x32_bf16 v[132:135], v[176:179], v[148:151], v[132:135]
    s_waitcnt lgkmcnt(0)
    s_barrier
    v_mfma_f32_16x16x32_bf16 v[24:27], v[196:199], v[180:183], v[24:27]
    ds_read_b128 v[136:139], v6 offset:0
    v_mfma_f32_16x16x32_bf16 v[52:55], v[196:199], v[184:187], v[52:55]
    ds_read_b128 v[140:143], v6 offset:64
    v_mfma_f32_16x16x32_bf16 v[80:83], v[196:199], v[188:191], v[80:83]
    v_mfma_f32_16x16x32_bf16 v[108:111], v[196:199], v[192:195], v[108:111]
    ds_read_b128 v[144:147], v6 offset:128
    v_mfma_f32_16x16x32_bf16 v[112:115], v[200:203], v[192:195], v[112:115]
    v_mfma_f32_16x16x32_bf16 v[84:87], v[200:203], v[188:191], v[84:87]
    ds_read_b128 v[148:151], v6 offset:192
    v_mfma_f32_16x16x32_bf16 v[56:59], v[200:203], v[184:187], v[56:59]
    v_mfma_f32_16x16x32_bf16 v[28:31], v[200:203], v[180:183], v[28:31]
    ds_read_b128 v[152:155], v6 offset:256
    v_mfma_f32_16x16x32_bf16 v[32:35], v[204:207], v[180:183], v[32:35]
    v_mfma_f32_16x16x32_bf16 v[60:63], v[204:207], v[184:187], v[60:63]
    ds_read_b128 v[156:159], v6 offset:320
    v_mfma_f32_16x16x32_bf16 v[88:91], v[204:207], v[188:191], v[88:91]
    v_mfma_f32_16x16x32_bf16 v[116:119], v[204:207], v[192:195], v[116:119]
    ds_read_b128 v[160:163], v6 offset:384
    v_mfma_f32_16x16x32_bf16 v[120:123], v[208:211], v[192:195], v[120:123]
    v_mfma_f32_16x16x32_bf16 v[92:95], v[208:211], v[188:191], v[92:95]
    ds_read_b128 v[164:167], v7 offset:0
    v_mfma_f32_16x16x32_bf16 v[64:67], v[208:211], v[184:187], v[64:67]
    v_mfma_f32_16x16x32_bf16 v[36:39], v[208:211], v[180:183], v[36:39]
    ds_read_b128 v[168:171], v7 offset:256
    v_mfma_f32_16x16x32_bf16 v[40:43], v[212:215], v[180:183], v[40:43]
    v_mfma_f32_16x16x32_bf16 v[68:71], v[212:215], v[184:187], v[68:71]
    ds_read_b128 v[172:175], v7 offset:512
    v_mfma_f32_16x16x32_bf16 v[96:99], v[212:215], v[188:191], v[96:99]
    v_mfma_f32_16x16x32_bf16 v[124:127], v[212:215], v[192:195], v[124:127]
    ds_read_b128 v[176:179], v7 offset:768
    v_mfma_f32_16x16x32_bf16 v[128:131], v[216:219], v[192:195], v[128:131]
    v_mfma_f32_16x16x32_bf16 v[100:103], v[216:219], v[188:191], v[100:103]
    v_mfma_f32_16x16x32_bf16 v[72:75], v[216:219], v[184:187], v[72:75]
    v_mfma_f32_16x16x32_bf16 v[44:47], v[216:219], v[180:183], v[44:47]
    v_mfma_f32_16x16x32_bf16 v[48:51], v[220:223], v[180:183], v[48:51]
    v_mfma_f32_16x16x32_bf16 v[76:79], v[220:223], v[184:187], v[76:79]
    v_mfma_f32_16x16x32_bf16 v[104:107], v[220:223], v[188:191], v[104:107]
    v_mfma_f32_16x16x32_bf16 v[132:135], v[220:223], v[192:195], v[132:135]
    s_waitcnt lgkmcnt(0)
    s_nop 7
    v_pk_fma_f32 v[24:25], v[164:165], v[136:137], v[24:25] op_sel_hi:[0,1,1] neg_lo:[1,0,0] neg_hi:[1,0,0]
    v_pk_fma_f32 v[26:27], v[164:165], v[138:139], v[26:27] op_sel_hi:[0,1,1] neg_lo:[1,0,0] neg_hi:[1,0,0]
    v_pk_fma_f32 v[28:29], v[164:165], v[140:141], v[28:29] op_sel_hi:[0,1,1] neg_lo:[1,0,0] neg_hi:[1,0,0]
    v_pk_fma_f32 v[30:31], v[164:165], v[142:143], v[30:31] op_sel_hi:[0,1,1] neg_lo:[1,0,0] neg_hi:[1,0,0]
    v_pk_mul_f32 v[192:193], v[24:25], v[24:25]
    v_pk_mul_f32 v[194:195], v[26:27], v[26:27]
    v_pk_mul_f32 v[196:197], v[28:29], v[28:29]
    v_pk_mul_f32 v[198:199], v[30:31], v[30:31]
    v_pk_fma_f32 v[192:193], v[192:193], v[166:167], v[166:167] op_sel:[0,1,0] op_sel_hi:[1,1,0]
    v_pk_fma_f32 v[194:195], v[194:195], v[166:167], v[166:167] op_sel:[0,1,0] op_sel_hi:[1,1,0]
    v_pk_fma_f32 v[196:197], v[196:197], v[166:167], v[166:167] op_sel:[0,1,0] op_sel_hi:[1,1,0]
    v_pk_fma_f32 v[198:199], v[198:199], v[166:167], v[166:167] op_sel:[0,1,0] op_sel_hi:[1,1,0]
    v_pk_mul_f32 v[192:193], v[192:193], v[24:25]
    v_pk_mul_f32 v[194:195], v[194:195], v[26:27]
    v_pk_mul_f32 v[196:197], v[196:197], v[28:29]
    v_pk_mul_f32 v[198:199], v[198:199], v[30:31]
    v_exp_f32 v192, v192
    v_exp_f32 v193, v193
    v_exp_f32 v194, v194
    v_exp_f32 v195, v195
    v_exp_f32 v196, v196
    v_exp_f32 v197, v197
    v_exp_f32 v198, v198
    v_exp_f32 v199, v199
    v_pk_fma_f32 v[192:193], v[192:193], v[164:165], v[164:165] op_sel:[0,1,1] op_sel_hi:[1,1,1]
    v_pk_fma_f32 v[194:195], v[194:195], v[164:165], v[164:165] op_sel:[0,1,1] op_sel_hi:[1,1,1]
    v_pk_fma_f32 v[196:197], v[196:197], v[164:165], v[164:165] op_sel:[0,1,1] op_sel_hi:[1,1,1]
    v_pk_fma_f32 v[198:199], v[198:199], v[164:165], v[164:165] op_sel:[0,1,1] op_sel_hi:[1,1,1]
    v_rcp_f32 v192, v192
    v_rcp_f32 v193, v193
    v_rcp_f32 v194, v194
    v_rcp_f32 v195, v195
    v_rcp_f32 v196, v196
    v_rcp_f32 v197, v197
    v_rcp_f32 v198, v198
    v_rcp_f32 v199, v199
    v_pk_mul_f32 v[24:25], v[24:25], v[192:193]
    v_pk_mul_f32 v[26:27], v[26:27], v[194:195]
    v_pk_mul_f32 v[28:29], v[28:29], v[196:197]
    v_pk_mul_f32 v[30:31], v[30:31], v[198:199]
    v_cvt_pk_bf16_f32 v24, v24, v25
    v_cvt_pk_bf16_f32 v25, v26, v27
    v_cvt_pk_bf16_f32 v26, v28, v29
    v_cvt_pk_bf16_f32 v27, v30, v31
    ds_write_b128 v22, v[24:27] offset:0
    s_add_u32 s36, s44, 0
    buffer_store_dwordx4 v[24:27], v2, s[16:19], s36 offen sc1
    v_pk_fma_f32 v[52:53], v[168:169], v[136:137], v[52:53] op_sel_hi:[0,1,1] neg_lo:[1,0,0] neg_hi:[1,0,0]
    v_pk_fma_f32 v[54:55], v[168:169], v[138:139], v[54:55] op_sel_hi:[0,1,1] neg_lo:[1,0,0] neg_hi:[1,0,0]
    v_pk_fma_f32 v[56:57], v[168:169], v[140:141], v[56:57] op_sel_hi:[0,1,1] neg_lo:[1,0,0] neg_hi:[1,0,0]
    v_pk_fma_f32 v[58:59], v[168:169], v[142:143], v[58:59] op_sel_hi:[0,1,1] neg_lo:[1,0,0] neg_hi:[1,0,0]
    v_pk_mul_f32 v[192:193], v[52:53], v[52:53]
    v_pk_mul_f32 v[194:195], v[54:55], v[54:55]
    v_pk_mul_f32 v[196:197], v[56:57], v[56:57]
    v_pk_mul_f32 v[198:199], v[58:59], v[58:59]
    v_pk_fma_f32 v[192:193], v[192:193], v[170:171], v[170:171] op_sel:[0,1,0] op_sel_hi:[1,1,0]
    v_pk_fma_f32 v[194:195], v[194:195], v[170:171], v[170:171] op_sel:[0,1,0] op_sel_hi:[1,1,0]
    v_pk_fma_f32 v[196:197], v[196:197], v[170:171], v[170:171] op_sel:[0,1,0] op_sel_hi:[1,1,0]
    v_pk_fma_f32 v[198:199], v[198:199], v[170:171], v[170:171] op_sel:[0,1,0] op_sel_hi:[1,1,0]
    v_pk_mul_f32 v[192:193], v[192:193], v[52:53]
    v_pk_mul_f32 v[194:195], v[194:195], v[54:55]
    v_pk_mul_f32 v[196:197], v[196:197], v[56:57]
    v_pk_mul_f32 v[198:199], v[198:199], v[58:59]
    v_exp_f32 v192, v192
    v_exp_f32 v193, v193
    v_exp_f32 v194, v194
    v_exp_f32 v195, v195
    v_exp_f32 v196, v196
    v_exp_f32 v197, v197
    v_exp_f32 v198, v198
    v_exp_f32 v199, v199
    v_pk_fma_f32 v[192:193], v[192:193], v[168:169], v[168:169] op_sel:[0,1,1] op_sel_hi:[1,1,1]
    v_pk_fma_f32 v[194:195], v[194:195], v[168:169], v[168:169] op_sel:[0,1,1] op_sel_hi:[1,1,1]
    v_pk_fma_f32 v[196:197], v[196:197], v[168:169], v[168:169] op_sel:[0,1,1] op_sel_hi:[1,1,1]
    v_pk_fma_f32 v[198:199], v[198:199], v[168:169], v[168:169] op_sel:[0,1,1] op_sel_hi:[1,1,1]
    v_rcp_f32 v192, v192
    v_rcp_f32 v193, v193
    v_rcp_f32 v194, v194
    v_rcp_f32 v195, v195
    v_rcp_f32 v196, v196
    v_rcp_f32 v197, v197
    v_rcp_f32 v198, v198
    v_rcp_f32 v199, v199
    v_pk_mul_f32 v[52:53], v[52:53], v[192:193]
    v_pk_mul_f32 v[54:55], v[54:55], v[194:195]
    v_pk_mul_f32 v[56:57], v[56:57], v[196:197]
    v_pk_mul_f32 v[58:59], v[58:59], v[198:199]
    v_cvt_pk_bf16_f32 v52, v52, v53
    v_cvt_pk_bf16_f32 v53, v54, v55
    v_cvt_pk_bf16_f32 v54, v56, v57
    v_cvt_pk_bf16_f32 v55, v58, v59
    ds_write_b128 v22, v[52:55] offset:2048
    s_add_u32 s36, s44, 229376
    buffer_store_dwordx4 v[52:55], v2, s[16:19], s36 offen sc1
    v_pk_fma_f32 v[80:81], v[172:173], v[136:137], v[80:81] op_sel_hi:[0,1,1] neg_lo:[1,0,0] neg_hi:[1,0,0]
    v_pk_fma_f32 v[82:83], v[172:173], v[138:139], v[82:83] op_sel_hi:[0,1,1] neg_lo:[1,0,0] neg_hi:[1,0,0]
    v_pk_fma_f32 v[84:85], v[172:173], v[140:141], v[84:85] op_sel_hi:[0,1,1] neg_lo:[1,0,0] neg_hi:[1,0,0]
    v_pk_fma_f32 v[86:87], v[172:173], v[142:143], v[86:87] op_sel_hi:[0,1,1] neg_lo:[1,0,0] neg_hi:[1,0,0]
    v_pk_mul_f32 v[192:193], v[80:81], v[80:81]
    v_pk_mul_f32 v[194:195], v[82:83], v[82:83]
    v_pk_mul_f32 v[196:197], v[84:85], v[84:85]
    v_pk_mul_f32 v[198:199], v[86:87], v[86:87]
    v_pk_fma_f32 v[192:193], v[192:193], v[174:175], v[174:175] op_sel:[0,1,0] op_sel_hi:[1,1,0]
    v_pk_fma_f32 v[194:195], v[194:195], v[174:175], v[174:175] op_sel:[0,1,0] op_sel_hi:[1,1,0]
    v_pk_fma_f32 v[196:197], v[196:197], v[174:175], v[174:175] op_sel:[0,1,0] op_sel_hi:[1,1,0]
    v_pk_fma_f32 v[198:199], v[198:199], v[174:175], v[174:175] op_sel:[0,1,0] op_sel_hi:[1,1,0]
    v_pk_mul_f32 v[192:193], v[192:193], v[80:81]
    v_pk_mul_f32 v[194:195], v[194:195], v[82:83]
    v_pk_mul_f32 v[196:197], v[196:197], v[84:85]
    v_pk_mul_f32 v[198:199], v[198:199], v[86:87]
    v_exp_f32 v192, v192
    v_exp_f32 v193, v193
    v_exp_f32 v194, v194
    v_exp_f32 v195, v195
    v_exp_f32 v196, v196
    v_exp_f32 v197, v197
    v_exp_f32 v198, v198
    v_exp_f32 v199, v199
    v_pk_fma_f32 v[192:193], v[192:193], v[172:173], v[172:173] op_sel:[0,1,1] op_sel_hi:[1,1,1]
    v_pk_fma_f32 v[194:195], v[194:195], v[172:173], v[172:173] op_sel:[0,1,1] op_sel_hi:[1,1,1]
    v_pk_fma_f32 v[196:197], v[196:197], v[172:173], v[172:173] op_sel:[0,1,1] op_sel_hi:[1,1,1]
    v_pk_fma_f32 v[198:199], v[198:199], v[172:173], v[172:173] op_sel:[0,1,1] op_sel_hi:[1,1,1]
    v_rcp_f32 v192, v192
    v_rcp_f32 v193, v193
    v_rcp_f32 v194, v194
    v_rcp_f32 v195, v195
    v_rcp_f32 v196, v196
    v_rcp_f32 v197, v197
    v_rcp_f32 v198, v198
    v_rcp_f32 v199, v199
    v_pk_mul_f32 v[80:81], v[80:81], v[192:193]
    v_pk_mul_f32 v[82:83], v[82:83], v[194:195]
    v_pk_mul_f32 v[84:85], v[84:85], v[196:197]
    v_pk_mul_f32 v[86:87], v[86:87], v[198:199]
    v_cvt_pk_bf16_f32 v80, v80, v81
    v_cvt_pk_bf16_f32 v81, v82, v83
    v_cvt_pk_bf16_f32 v82, v84, v85
    v_cvt_pk_bf16_f32 v83, v86, v87
    ds_write_b128 v23, v[80:83] offset:0
    s_add_u32 s36, s44, 458752
    buffer_store_dwordx4 v[80:83], v2, s[16:19], s36 offen sc1
    v_pk_fma_f32 v[108:109], v[176:177], v[136:137], v[108:109] op_sel_hi:[0,1,1] neg_lo:[1,0,0] neg_hi:[1,0,0]
    v_pk_fma_f32 v[110:111], v[176:177], v[138:139], v[110:111] op_sel_hi:[0,1,1] neg_lo:[1,0,0] neg_hi:[1,0,0]
    v_pk_fma_f32 v[112:113], v[176:177], v[140:141], v[112:113] op_sel_hi:[0,1,1] neg_lo:[1,0,0] neg_hi:[1,0,0]
    v_pk_fma_f32 v[114:115], v[176:177], v[142:143], v[114:115] op_sel_hi:[0,1,1] neg_lo:[1,0,0] neg_hi:[1,0,0]
    v_pk_mul_f32 v[192:193], v[108:109], v[108:109]
    v_pk_mul_f32 v[194:195], v[110:111], v[110:111]
    v_pk_mul_f32 v[196:197], v[112:113], v[112:113]
    v_pk_mul_f32 v[198:199], v[114:115], v[114:115]
    v_pk_fma_f32 v[192:193], v[192:193], v[178:179], v[178:179] op_sel:[0,1,0] op_sel_hi:[1,1,0]
    v_pk_fma_f32 v[194:195], v[194:195], v[178:179], v[178:179] op_sel:[0,1,0] op_sel_hi:[1,1,0]
    v_pk_fma_f32 v[196:197], v[196:197], v[178:179], v[178:179] op_sel:[0,1,0] op_sel_hi:[1,1,0]
    v_pk_fma_f32 v[198:199], v[198:199], v[178:179], v[178:179] op_sel:[0,1,0] op_sel_hi:[1,1,0]
    v_pk_mul_f32 v[192:193], v[192:193], v[108:109]
    v_pk_mul_f32 v[194:195], v[194:195], v[110:111]
    v_pk_mul_f32 v[196:197], v[196:197], v[112:113]
    v_pk_mul_f32 v[198:199], v[198:199], v[114:115]
    v_exp_f32 v192, v192
    v_exp_f32 v193, v193
    v_exp_f32 v194, v194
    v_exp_f32 v195, v195
    v_exp_f32 v196, v196
    v_exp_f32 v197, v197
    v_exp_f32 v198, v198
    v_exp_f32 v199, v199
    v_pk_fma_f32 v[192:193], v[192:193], v[176:177], v[176:177] op_sel:[0,1,1] op_sel_hi:[1,1,1]
    v_pk_fma_f32 v[194:195], v[194:195], v[176:177], v[176:177] op_sel:[0,1,1] op_sel_hi:[1,1,1]
    v_pk_fma_f32 v[196:197], v[196:197], v[176:177], v[176:177] op_sel:[0,1,1] op_sel_hi:[1,1,1]
    v_pk_fma_f32 v[198:199], v[198:199], v[176:177], v[176:177] op_sel:[0,1,1] op_sel_hi:[1,1,1]
    v_rcp_f32 v192, v192
    v_rcp_f32 v193, v193
    v_rcp_f32 v194, v194
    v_rcp_f32 v195, v195
    v_rcp_f32 v196, v196
    v_rcp_f32 v197, v197
    v_rcp_f32 v198, v198
    v_rcp_f32 v199, v199
    v_pk_mul_f32 v[108:109], v[108:109], v[192:193]
    v_pk_mul_f32 v[110:111], v[110:111], v[194:195]
    v_pk_mul_f32 v[112:113], v[112:113], v[196:197]
    v_pk_mul_f32 v[114:115], v[114:115], v[198:199]
    v_cvt_pk_bf16_f32 v108, v108, v109
    v_cvt_pk_bf16_f32 v109, v110, v111
    v_cvt_pk_bf16_f32 v110, v112, v113
    v_cvt_pk_bf16_f32 v111, v114, v115
    ds_write_b128 v23, v[108:111] offset:2048
    s_add_u32 s36, s44, 688128
    buffer_store_dwordx4 v[108:111], v2, s[16:19], s36 offen sc1
    v_pk_fma_f32 v[32:33], v[164:165], v[144:145], v[32:33] op_sel_hi:[0,1,1] neg_lo:[1,0,0] neg_hi:[1,0,0]
    v_pk_fma_f32 v[34:35], v[164:165], v[146:147], v[34:35] op_sel_hi:[0,1,1] neg_lo:[1,0,0] neg_hi:[1,0,0]
    v_pk_fma_f32 v[36:37], v[164:165], v[148:149], v[36:37] op_sel_hi:[0,1,1] neg_lo:[1,0,0] neg_hi:[1,0,0]
    v_pk_fma_f32 v[38:39], v[164:165], v[150:151], v[38:39] op_sel_hi:[0,1,1] neg_lo:[1,0,0] neg_hi:[1,0,0]
    v_pk_mul_f32 v[192:193], v[32:33], v[32:33]
    v_pk_mul_f32 v[194:195], v[34:35], v[34:35]
    v_pk_mul_f32 v[196:197], v[36:37], v[36:37]
    v_pk_mul_f32 v[198:199], v[38:39], v[38:39]
    v_pk_fma_f32 v[192:193], v[192:193], v[166:167], v[166:167] op_sel:[0,1,0] op_sel_hi:[1,1,0]
    v_pk_fma_f32 v[194:195], v[194:195], v[166:167], v[166:167] op_sel:[0,1,0] op_sel_hi:[1,1,0]
    v_pk_fma_f32 v[196:197], v[196:197], v[166:167], v[166:167] op_sel:[0,1,0] op_sel_hi:[1,1,0]
    v_pk_fma_f32 v[198:199], v[198:199], v[166:167], v[166:167] op_sel:[0,1,0] op_sel_hi:[1,1,0]
    v_pk_mul_f32 v[192:193], v[192:193], v[32:33]
    v_pk_mul_f32 v[194:195], v[194:195], v[34:35]
    v_pk_mul_f32 v[196:197], v[196:197], v[36:37]
    v_pk_mul_f32 v[198:199], v[198:199], v[38:39]
    v_exp_f32 v192, v192
    v_exp_f32 v193, v193
    v_exp_f32 v194, v194
    v_exp_f32 v195, v195
    v_exp_f32 v196, v196
    v_exp_f32 v197, v197
    v_exp_f32 v198, v198
    v_exp_f32 v199, v199
    v_pk_fma_f32 v[192:193], v[192:193], v[164:165], v[164:165] op_sel:[0,1,1] op_sel_hi:[1,1,1]
    v_pk_fma_f32 v[194:195], v[194:195], v[164:165], v[164:165] op_sel:[0,1,1] op_sel_hi:[1,1,1]
    v_pk_fma_f32 v[196:197], v[196:197], v[164:165], v[164:165] op_sel:[0,1,1] op_sel_hi:[1,1,1]
    v_pk_fma_f32 v[198:199], v[198:199], v[164:165], v[164:165] op_sel:[0,1,1] op_sel_hi:[1,1,1]
    v_rcp_f32 v192, v192
    v_rcp_f32 v193, v193
    v_rcp_f32 v194, v194
    v_rcp_f32 v195, v195
    v_rcp_f32 v196, v196
    v_rcp_f32 v197, v197
    v_rcp_f32 v198, v198
    v_rcp_f32 v199, v199
    v_pk_mul_f32 v[32:33], v[32:33], v[192:193]
    v_pk_mul_f32 v[34:35], v[34:35], v[194:195]
    v_pk_mul_f32 v[36:37], v[36:37], v[196:197]
    v_pk_mul_f32 v[38:39], v[38:39], v[198:199]
    v_cvt_pk_bf16_f32 v32, v32, v33
    v_cvt_pk_bf16_f32 v33, v34, v35
    v_cvt_pk_bf16_f32 v34, v36, v37
    v_cvt_pk_bf16_f32 v35, v38, v39
    ds_write_b128 v22, v[32:35] offset:16384
    v_pk_fma_f32 v[60:61], v[168:169], v[144:145], v[60:61] op_sel_hi:[0,1,1] neg_lo:[1,0,0] neg_hi:[1,0,0]
    v_pk_fma_f32 v[62:63], v[168:169], v[146:147], v[62:63] op_sel_hi:[0,1,1] neg_lo:[1,0,0] neg_hi:[1,0,0]
    v_pk_fma_f32 v[64:65], v[168:169], v[148:149], v[64:65] op_sel_hi:[0,1,1] neg_lo:[1,0,0] neg_hi:[1,0,0]
    v_pk_fma_f32 v[66:67], v[168:169], v[150:151], v[66:67] op_sel_hi:[0,1,1] neg_lo:[1,0,0] neg_hi:[1,0,0]
    v_pk_mul_f32 v[192:193], v[60:61], v[60:61]
    v_pk_mul_f32 v[194:195], v[62:63], v[62:63]
    v_pk_mul_f32 v[196:197], v[64:65], v[64:65]
    v_pk_mul_f32 v[198:199], v[66:67], v[66:67]
    v_pk_fma_f32 v[192:193], v[192:193], v[170:171], v[170:171] op_sel:[0,1,0] op_sel_hi:[1,1,0]
    v_pk_fma_f32 v[194:195], v[194:195], v[170:171], v[170:171] op_sel:[0,1,0] op_sel_hi:[1,1,0]
    v_pk_fma_f32 v[196:197], v[196:197], v[170:171], v[170:171] op_sel:[0,1,0] op_sel_hi:[1,1,0]
    v_pk_fma_f32 v[198:199], v[198:199], v[170:171], v[170:171] op_sel:[0,1,0] op_sel_hi:[1,1,0]
    v_pk_mul_f32 v[192:193], v[192:193], v[60:61]
    v_pk_mul_f32 v[194:195], v[194:195], v[62:63]
    v_pk_mul_f32 v[196:197], v[196:197], v[64:65]
    v_pk_mul_f32 v[198:199], v[198:199], v[66:67]
    v_exp_f32 v192, v192
    v_exp_f32 v193, v193
    v_exp_f32 v194, v194
    v_exp_f32 v195, v195
    v_exp_f32 v196, v196
    v_exp_f32 v197, v197
    v_exp_f32 v198, v198
    v_exp_f32 v199, v199
    v_pk_fma_f32 v[192:193], v[192:193], v[168:169], v[168:169] op_sel:[0,1,1] op_sel_hi:[1,1,1]
    v_pk_fma_f32 v[194:195], v[194:195], v[168:169], v[168:169] op_sel:[0,1,1] op_sel_hi:[1,1,1]
    v_pk_fma_f32 v[196:197], v[196:197], v[168:169], v[168:169] op_sel:[0,1,1] op_sel_hi:[1,1,1]
    v_pk_fma_f32 v[198:199], v[198:199], v[168:169], v[168:169] op_sel:[0,1,1] op_sel_hi:[1,1,1]
    v_rcp_f32 v192, v192
    v_rcp_f32 v193, v193
    v_rcp_f32 v194, v194
    v_rcp_f32 v195, v195
    v_rcp_f32 v196, v196
    v_rcp_f32 v197, v197
    v_rcp_f32 v198, v198
    v_rcp_f32 v199, v199
    v_pk_mul_f32 v[60:61], v[60:61], v[192:193]
    v_pk_mul_f32 v[62:63], v[62:63], v[194:195]
    v_pk_mul_f32 v[64:65], v[64:65], v[196:197]
    v_pk_mul_f32 v[66:67], v[66:67], v[198:199]
    v_cvt_pk_bf16_f32 v60, v60, v61
    v_cvt_pk_bf16_f32 v61, v62, v63
    v_cvt_pk_bf16_f32 v62, v64, v65
    v_cvt_pk_bf16_f32 v63, v66, v67
    ds_write_b128 v22, v[60:63] offset:18432
    v_pk_fma_f32 v[88:89], v[172:173], v[144:145], v[88:89] op_sel_hi:[0,1,1] neg_lo:[1,0,0] neg_hi:[1,0,0]
    v_pk_fma_f32 v[90:91], v[172:173], v[146:147], v[90:91] op_sel_hi:[0,1,1] neg_lo:[1,0,0] neg_hi:[1,0,0]
    v_pk_fma_f32 v[92:93], v[172:173], v[148:149], v[92:93] op_sel_hi:[0,1,1] neg_lo:[1,0,0] neg_hi:[1,0,0]
    v_pk_fma_f32 v[94:95], v[172:173], v[150:151], v[94:95] op_sel_hi:[0,1,1] neg_lo:[1,0,0] neg_hi:[1,0,0]
    v_pk_mul_f32 v[192:193], v[88:89], v[88:89]
    v_pk_mul_f32 v[194:195], v[90:91], v[90:91]
    v_pk_mul_f32 v[196:197], v[92:93], v[92:93]
    v_pk_mul_f32 v[198:199], v[94:95], v[94:95]
    v_pk_fma_f32 v[192:193], v[192:193], v[174:175], v[174:175] op_sel:[0,1,0] op_sel_hi:[1,1,0]
    v_pk_fma_f32 v[194:195], v[194:195], v[174:175], v[174:175] op_sel:[0,1,0] op_sel_hi:[1,1,0]
    v_pk_fma_f32 v[196:197], v[196:197], v[174:175], v[174:175] op_sel:[0,1,0] op_sel_hi:[1,1,0]
    v_pk_fma_f32 v[198:199], v[198:199], v[174:175], v[174:175] op_sel:[0,1,0] op_sel_hi:[1,1,0]
    v_pk_mul_f32 v[192:193], v[192:193], v[88:89]
    v_pk_mul_f32 v[194:195], v[194:195], v[90:91]
    v_pk_mul_f32 v[196:197], v[196:197], v[92:93]
    v_pk_mul_f32 v[198:199], v[198:199], v[94:95]
    v_exp_f32 v192, v192
    v_exp_f32 v193, v193
    v_exp_f32 v194, v194
    v_exp_f32 v195, v195
    v_exp_f32 v196, v196
    v_exp_f32 v197, v197
    v_exp_f32 v198, v198
    v_exp_f32 v199, v199
    v_pk_fma_f32 v[192:193], v[192:193], v[172:173], v[172:173] op_sel:[0,1,1] op_sel_hi:[1,1,1]
    v_pk_fma_f32 v[194:195], v[194:195], v[172:173], v[172:173] op_sel:[0,1,1] op_sel_hi:[1,1,1]
    v_pk_fma_f32 v[196:197], v[196:197], v[172:173], v[172:173] op_sel:[0,1,1] op_sel_hi:[1,1,1]
    v_pk_fma_f32 v[198:199], v[198:199], v[172:173], v[172:173] op_sel:[0,1,1] op_sel_hi:[1,1,1]
    v_rcp_f32 v192, v192
    v_rcp_f32 v193, v193
    v_rcp_f32 v194, v194
    v_rcp_f32 v195, v195
    v_rcp_f32 v196, v196
    v_rcp_f32 v197, v197
    v_rcp_f32 v198, v198
    v_rcp_f32 v199, v199
    v_pk_mul_f32 v[88:89], v[88:89], v[192:193]
    v_pk_mul_f32 v[90:91], v[90:91], v[194:195]
    v_pk_mul_f32 v[92:93], v[92:93], v[196:197]
    v_pk_mul_f32 v[94:95], v[94:95], v[198:199]
    v_cvt_pk_bf16_f32 v88, v88, v89
    v_cvt_pk_bf16_f32 v89, v90, v91
    v_cvt_pk_bf16_f32 v90, v92, v93
    v_cvt_pk_bf16_f32 v91, v94, v95
    ds_write_b128 v23, v[88:91] offset:16384
    s_waitcnt vmcnt(0)
    buffer_atomic_add v8, v9, s[56:59], s49 offen offset:0 sc1
    buffer_load_dwordx4 v[180:183], v255, s[84:87], s13 offen offset:0 sc1
    buffer_load_dwordx4 v[184:187], v2, s[88:91], s40 offen offset:0 sc1
    v_pk_fma_f32 v[116:117], v[176:177], v[144:145], v[116:117] op_sel_hi:[0,1,1] neg_lo:[1,0,0] neg_hi:[1,0,0]
    v_pk_fma_f32 v[118:119], v[176:177], v[146:147], v[118:119] op_sel_hi:[0,1,1] neg_lo:[1,0,0] neg_hi:[1,0,0]
    v_pk_fma_f32 v[120:121], v[176:177], v[148:149], v[120:121] op_sel_hi:[0,1,1] neg_lo:[1,0,0] neg_hi:[1,0,0]
    v_pk_fma_f32 v[122:123], v[176:177], v[150:151], v[122:123] op_sel_hi:[0,1,1] neg_lo:[1,0,0] neg_hi:[1,0,0]
    v_pk_mul_f32 v[192:193], v[116:117], v[116:117]
    v_pk_mul_f32 v[194:195], v[118:119], v[118:119]
    v_pk_mul_f32 v[196:197], v[120:121], v[120:121]
    v_pk_mul_f32 v[198:199], v[122:123], v[122:123]
    v_pk_fma_f32 v[192:193], v[192:193], v[178:179], v[178:179] op_sel:[0,1,0] op_sel_hi:[1,1,0]
    v_pk_fma_f32 v[194:195], v[194:195], v[178:179], v[178:179] op_sel:[0,1,0] op_sel_hi:[1,1,0]
    v_pk_fma_f32 v[196:197], v[196:197], v[178:179], v[178:179] op_sel:[0,1,0] op_sel_hi:[1,1,0]
    v_pk_fma_f32 v[198:199], v[198:199], v[178:179], v[178:179] op_sel:[0,1,0] op_sel_hi:[1,1,0]
    v_pk_mul_f32 v[192:193], v[192:193], v[116:117]
    v_pk_mul_f32 v[194:195], v[194:195], v[118:119]
    v_pk_mul_f32 v[196:197], v[196:197], v[120:121]
    v_pk_mul_f32 v[198:199], v[198:199], v[122:123]
    v_exp_f32 v192, v192
    v_exp_f32 v193, v193
    v_exp_f32 v194, v194
    v_exp_f32 v195, v195
    v_exp_f32 v196, v196
    v_exp_f32 v197, v197
    v_exp_f32 v198, v198
    v_exp_f32 v199, v199
    v_pk_fma_f32 v[192:193], v[192:193], v[176:177], v[176:177] op_sel:[0,1,1] op_sel_hi:[1,1,1]
    v_pk_fma_f32 v[194:195], v[194:195], v[176:177], v[176:177] op_sel:[0,1,1] op_sel_hi:[1,1,1]
    v_pk_fma_f32 v[196:197], v[196:197], v[176:177], v[176:177] op_sel:[0,1,1] op_sel_hi:[1,1,1]
    v_pk_fma_f32 v[198:199], v[198:199], v[176:177], v[176:177] op_sel:[0,1,1] op_sel_hi:[1,1,1]
    v_rcp_f32 v192, v192
    v_rcp_f32 v193, v193
    v_rcp_f32 v194, v194
    v_rcp_f32 v195, v195
    v_rcp_f32 v196, v196
    v_rcp_f32 v197, v197
    v_rcp_f32 v198, v198
    v_rcp_f32 v199, v199
    v_pk_mul_f32 v[116:117], v[116:117], v[192:193]
    v_pk_mul_f32 v[118:119], v[118:119], v[194:195]
    v_pk_mul_f32 v[120:121], v[120:121], v[196:197]
    v_pk_mul_f32 v[122:123], v[122:123], v[198:199]
    v_cvt_pk_bf16_f32 v116, v116, v117
    v_cvt_pk_bf16_f32 v117, v118, v119
    v_cvt_pk_bf16_f32 v118, v120, v121
    v_cvt_pk_bf16_f32 v119, v122, v123
    ds_write_b128 v23, v[116:119] offset:18432
    buffer_load_dwordx4 v[200:203], v255, s[84:87], s13 offen offset:64 sc1
    buffer_load_dwordx4 v[204:207], v2, s[88:91], s40 offen offset:1024 sc1
    v_pk_fma_f32 v[40:41], v[164:165], v[152:153], v[40:41] op_sel_hi:[0,1,1] neg_lo:[1,0,0] neg_hi:[1,0,0]
    v_pk_fma_f32 v[42:43], v[164:165], v[154:155], v[42:43] op_sel_hi:[0,1,1] neg_lo:[1,0,0] neg_hi:[1,0,0]
    v_pk_fma_f32 v[44:45], v[164:165], v[156:157], v[44:45] op_sel_hi:[0,1,1] neg_lo:[1,0,0] neg_hi:[1,0,0]
    v_pk_fma_f32 v[46:47], v[164:165], v[158:159], v[46:47] op_sel_hi:[0,1,1] neg_lo:[1,0,0] neg_hi:[1,0,0]
    v_pk_mul_f32 v[192:193], v[40:41], v[40:41]
    v_pk_mul_f32 v[194:195], v[42:43], v[42:43]
    v_pk_mul_f32 v[196:197], v[44:45], v[44:45]
    v_pk_mul_f32 v[198:199], v[46:47], v[46:47]
    v_pk_fma_f32 v[192:193], v[192:193], v[166:167], v[166:167] op_sel:[0,1,0] op_sel_hi:[1,1,0]
    v_pk_fma_f32 v[194:195], v[194:195], v[166:167], v[166:167] op_sel:[0,1,0] op_sel_hi:[1,1,0]
    v_pk_fma_f32 v[196:197], v[196:197], v[166:167], v[166:167] op_sel:[0,1,0] op_sel_hi:[1,1,0]
    v_pk_fma_f32 v[198:199], v[198:199], v[166:167], v[166:167] op_sel:[0,1,0] op_sel_hi:[1,1,0]
    v_pk_mul_f32 v[192:193], v[192:193], v[40:41]
    v_pk_mul_f32 v[194:195], v[194:195], v[42:43]
    v_pk_mul_f32 v[196:197], v[196:197], v[44:45]
    v_pk_mul_f32 v[198:199], v[198:199], v[46:47]
    v_exp_f32 v192, v192
    v_exp_f32 v193, v193
    v_exp_f32 v194, v194
    v_exp_f32 v195, v195
    v_exp_f32 v196, v196
    v_exp_f32 v197, v197
    v_exp_f32 v198, v198
    v_exp_f32 v199, v199
    v_pk_fma_f32 v[192:193], v[192:193], v[164:165], v[164:165] op_sel:[0,1,1] op_sel_hi:[1,1,1]
    v_pk_fma_f32 v[194:195], v[194:195], v[164:165], v[164:165] op_sel:[0,1,1] op_sel_hi:[1,1,1]
    v_pk_fma_f32 v[196:197], v[196:197], v[164:165], v[164:165] op_sel:[0,1,1] op_sel_hi:[1,1,1]
    v_pk_fma_f32 v[198:199], v[198:199], v[164:165], v[164:165] op_sel:[0,1,1] op_sel_hi:[1,1,1]
    v_rcp_f32 v192, v192
    v_rcp_f32 v193, v193
    v_rcp_f32 v194, v194
    v_rcp_f32 v195, v195
    v_rcp_f32 v196, v196
    v_rcp_f32 v197, v197
    v_rcp_f32 v198, v198
    v_rcp_f32 v199, v199
    v_pk_mul_f32 v[40:41], v[40:41], v[192:193]
    v_pk_mul_f32 v[42:43], v[42:43], v[194:195]
    v_pk_mul_f32 v[44:45], v[44:45], v[196:197]
    v_pk_mul_f32 v[46:47], v[46:47], v[198:199]
    v_cvt_pk_bf16_f32 v230, v40, v41
    v_cvt_pk_bf16_f32 v231, v42, v43
    v_cvt_pk_bf16_f32 v232, v44, v45
    v_cvt_pk_bf16_f32 v233, v46, v47
    ds_write_b128 v22, v[230:233] offset:32768
    buffer_load_dwordx4 v[208:211], v255, s[84:87], s14 offen offset:0 sc1
    buffer_load_dwordx4 v[212:215], v2, s[88:91], s12 offen offset:0 sc1
    v_pk_fma_f32 v[68:69], v[168:169], v[152:153], v[68:69] op_sel_hi:[0,1,1] neg_lo:[1,0,0] neg_hi:[1,0,0]
    v_pk_fma_f32 v[70:71], v[168:169], v[154:155], v[70:71] op_sel_hi:[0,1,1] neg_lo:[1,0,0] neg_hi:[1,0,0]
    v_pk_fma_f32 v[72:73], v[168:169], v[156:157], v[72:73] op_sel_hi:[0,1,1] neg_lo:[1,0,0] neg_hi:[1,0,0]
    v_pk_fma_f32 v[74:75], v[168:169], v[158:159], v[74:75] op_sel_hi:[0,1,1] neg_lo:[1,0,0] neg_hi:[1,0,0]
    v_pk_mul_f32 v[192:193], v[68:69], v[68:69]
    v_pk_mul_f32 v[194:195], v[70:71], v[70:71]
    v_pk_mul_f32 v[196:197], v[72:73], v[72:73]
    v_pk_mul_f32 v[198:199], v[74:75], v[74:75]
    v_pk_fma_f32 v[192:193], v[192:193], v[170:171], v[170:171] op_sel:[0,1,0] op_sel_hi:[1,1,0]
    v_pk_fma_f32 v[194:195], v[194:195], v[170:171], v[170:171] op_sel:[0,1,0] op_sel_hi:[1,1,0]
    v_pk_fma_f32 v[196:197], v[196:197], v[170:171], v[170:171] op_sel:[0,1,0] op_sel_hi:[1,1,0]
    v_pk_fma_f32 v[198:199], v[198:199], v[170:171], v[170:171] op_sel:[0,1,0] op_sel_hi:[1,1,0]
    v_pk_mul_f32 v[192:193], v[192:193], v[68:69]
    v_pk_mul_f32 v[194:195], v[194:195], v[70:71]
    v_pk_mul_f32 v[196:197], v[196:197], v[72:73]
    v_pk_mul_f32 v[198:199], v[198:199], v[74:75]
    v_exp_f32 v192, v192
    v_exp_f32 v193, v193
    v_exp_f32 v194, v194
    v_exp_f32 v195, v195
    v_exp_f32 v196, v196
    v_exp_f32 v197, v197
    v_exp_f32 v198, v198
    v_exp_f32 v199, v199
    v_pk_fma_f32 v[192:193], v[192:193], v[168:169], v[168:169] op_sel:[0,1,1] op_sel_hi:[1,1,1]
    v_pk_fma_f32 v[194:195], v[194:195], v[168:169], v[168:169] op_sel:[0,1,1] op_sel_hi:[1,1,1]
    v_pk_fma_f32 v[196:197], v[196:197], v[168:169], v[168:169] op_sel:[0,1,1] op_sel_hi:[1,1,1]
    v_pk_fma_f32 v[198:199], v[198:199], v[168:169], v[168:169] op_sel:[0,1,1] op_sel_hi:[1,1,1]
    v_rcp_f32 v192, v192
    v_rcp_f32 v193, v193
    v_rcp_f32 v194, v194
    v_rcp_f32 v195, v195
    v_rcp_f32 v196, v196
    v_rcp_f32 v197, v197
    v_rcp_f32 v198, v198
    v_rcp_f32 v199, v199
    v_pk_mul_f32 v[68:69], v[68:69], v[192:193]
    v_pk_mul_f32 v[70:71], v[70:71], v[194:195]
    v_pk_mul_f32 v[72:73], v[72:73], v[196:197]
    v_pk_mul_f32 v[74:75], v[74:75], v[198:199]
    v_cvt_pk_bf16_f32 v234, v68, v69
    v_cvt_pk_bf16_f32 v235, v70, v71
    v_cvt_pk_bf16_f32 v236, v72, v73
    v_cvt_pk_bf16_f32 v237, v74, v75
    ds_write_b128 v22, v[234:237] offset:34816
    buffer_load_dwordx4 v[216:219], v255, s[84:87], s14 offen offset:64 sc1
    buffer_load_dwordx4 v[220:223], v2, s[88:91], s12 offen offset:1024 sc1
    v_pk_fma_f32 v[96:97], v[172:173], v[152:153], v[96:97] op_sel_hi:[0,1,1] neg_lo:[1,0,0] neg_hi:[1,0,0]
    v_pk_fma_f32 v[98:99], v[172:173], v[154:155], v[98:99] op_sel_hi:[0,1,1] neg_lo:[1,0,0] neg_hi:[1,0,0]
    v_pk_fma_f32 v[100:101], v[172:173], v[156:157], v[100:101] op_sel_hi:[0,1,1] neg_lo:[1,0,0] neg_hi:[1,0,0]
    v_pk_fma_f32 v[102:103], v[172:173], v[158:159], v[102:103] op_sel_hi:[0,1,1] neg_lo:[1,0,0] neg_hi:[1,0,0]
    v_pk_mul_f32 v[192:193], v[96:97], v[96:97]
    v_pk_mul_f32 v[194:195], v[98:99], v[98:99]
    v_pk_mul_f32 v[196:197], v[100:101], v[100:101]
    v_pk_mul_f32 v[198:199], v[102:103], v[102:103]
    v_pk_fma_f32 v[192:193], v[192:193], v[174:175], v[174:175] op_sel:[0,1,0] op_sel_hi:[1,1,0]
    v_pk_fma_f32 v[194:195], v[194:195], v[174:175], v[174:175] op_sel:[0,1,0] op_sel_hi:[1,1,0]
    v_pk_fma_f32 v[196:197], v[196:197], v[174:175], v[174:175] op_sel:[0,1,0] op_sel_hi:[1,1,0]
    v_pk_fma_f32 v[198:199], v[198:199], v[174:175], v[174:175] op_sel:[0,1,0] op_sel_hi:[1,1,0]
    v_pk_mul_f32 v[192:193], v[192:193], v[96:97]
    v_pk_mul_f32 v[194:195], v[194:195], v[98:99]
    v_pk_mul_f32 v[196:197], v[196:197], v[100:101]
    v_pk_mul_f32 v[198:199], v[198:199], v[102:103]
    v_exp_f32 v192, v192
    v_exp_f32 v193, v193
    v_exp_f32 v194, v194
    v_exp_f32 v195, v195
    v_exp_f32 v196, v196
    v_exp_f32 v197, v197
    v_exp_f32 v198, v198
    v_exp_f32 v199, v199
    v_pk_fma_f32 v[192:193], v[192:193], v[172:173], v[172:173] op_sel:[0,1,1] op_sel_hi:[1,1,1]
    v_pk_fma_f32 v[194:195], v[194:195], v[172:173], v[172:173] op_sel:[0,1,1] op_sel_hi:[1,1,1]
    v_pk_fma_f32 v[196:197], v[196:197], v[172:173], v[172:173] op_sel:[0,1,1] op_sel_hi:[1,1,1]
    v_pk_fma_f32 v[198:199], v[198:199], v[172:173], v[172:173] op_sel:[0,1,1] op_sel_hi:[1,1,1]
    v_rcp_f32 v192, v192
    v_rcp_f32 v193, v193
    v_rcp_f32 v194, v194
    v_rcp_f32 v195, v195
    v_rcp_f32 v196, v196
    v_rcp_f32 v197, v197
    v_rcp_f32 v198, v198
    v_rcp_f32 v199, v199
    v_pk_mul_f32 v[96:97], v[96:97], v[192:193]
    v_pk_mul_f32 v[98:99], v[98:99], v[194:195]
    v_pk_mul_f32 v[100:101], v[100:101], v[196:197]
    v_pk_mul_f32 v[102:103], v[102:103], v[198:199]
    v_cvt_pk_bf16_f32 v238, v96, v97
    v_cvt_pk_bf16_f32 v239, v98, v99
    v_cvt_pk_bf16_f32 v240, v100, v101
    v_cvt_pk_bf16_f32 v241, v102, v103
    ds_write_b128 v23, v[238:241] offset:32768
    v_pk_fma_f32 v[124:125], v[176:177], v[152:153], v[124:125] op_sel_hi:[0,1,1] neg_lo:[1,0,0] neg_hi:[1,0,0]
    v_pk_fma_f32 v[126:127], v[176:177], v[154:155], v[126:127] op_sel_hi:[0,1,1] neg_lo:[1,0,0] neg_hi:[1,0,0]
    v_pk_fma_f32 v[128:129], v[176:177], v[156:157], v[128:129] op_sel_hi:[0,1,1] neg_lo:[1,0,0] neg_hi:[1,0,0]
    v_pk_fma_f32 v[130:131], v[176:177], v[158:159], v[130:131] op_sel_hi:[0,1,1] neg_lo:[1,0,0] neg_hi:[1,0,0]
    v_pk_mul_f32 v[192:193], v[124:125], v[124:125]
    v_pk_mul_f32 v[194:195], v[126:127], v[126:127]
    v_pk_mul_f32 v[196:197], v[128:129], v[128:129]
    v_pk_mul_f32 v[198:199], v[130:131], v[130:131]
    v_pk_fma_f32 v[192:193], v[192:193], v[178:179], v[178:179] op_sel:[0,1,0] op_sel_hi:[1,1,0]
    v_pk_fma_f32 v[194:195], v[194:195], v[178:179], v[178:179] op_sel:[0,1,0] op_sel_hi:[1,1,0]
    v_pk_fma_f32 v[196:197], v[196:197], v[178:179], v[178:179] op_sel:[0,1,0] op_sel_hi:[1,1,0]
    v_pk_fma_f32 v[198:199], v[198:199], v[178:179], v[178:179] op_sel:[0,1,0] op_sel_hi:[1,1,0]
    v_pk_mul_f32 v[192:193], v[192:193], v[124:125]
    v_pk_mul_f32 v[194:195], v[194:195], v[126:127]
    v_pk_mul_f32 v[196:197], v[196:197], v[128:129]
    v_pk_mul_f32 v[198:199], v[198:199], v[130:131]
    v_exp_f32 v192, v192
    v_exp_f32 v193, v193
    v_exp_f32 v194, v194
    v_exp_f32 v195, v195
    v_exp_f32 v196, v196
    v_exp_f32 v197, v197
    v_exp_f32 v198, v198
    v_exp_f32 v199, v199
    v_pk_fma_f32 v[192:193], v[192:193], v[176:177], v[176:177] op_sel:[0,1,1] op_sel_hi:[1,1,1]
    v_pk_fma_f32 v[194:195], v[194:195], v[176:177], v[176:177] op_sel:[0,1,1] op_sel_hi:[1,1,1]
    v_pk_fma_f32 v[196:197], v[196:197], v[176:177], v[176:177] op_sel:[0,1,1] op_sel_hi:[1,1,1]
    v_pk_fma_f32 v[198:199], v[198:199], v[176:177], v[176:177] op_sel:[0,1,1] op_sel_hi:[1,1,1]
    v_rcp_f32 v192, v192
    v_rcp_f32 v193, v193
    v_rcp_f32 v194, v194
    v_rcp_f32 v195, v195
    v_rcp_f32 v196, v196
    v_rcp_f32 v197, v197
    v_rcp_f32 v198, v198
    v_rcp_f32 v199, v199
    v_pk_mul_f32 v[124:125], v[124:125], v[192:193]
    v_pk_mul_f32 v[126:127], v[126:127], v[194:195]
    v_pk_mul_f32 v[128:129], v[128:129], v[196:197]
    v_pk_mul_f32 v[130:131], v[130:131], v[198:199]
    v_cvt_pk_bf16_f32 v242, v124, v125
    v_cvt_pk_bf16_f32 v243, v126, v127
    v_cvt_pk_bf16_f32 v244, v128, v129
    v_cvt_pk_bf16_f32 v245, v130, v131
    ds_write_b128 v23, v[242:245] offset:34816
    v_pk_fma_f32 v[48:49], v[164:165], v[160:161], v[48:49] op_sel_hi:[0,1,1] neg_lo:[1,0,0] neg_hi:[1,0,0]
    v_pk_fma_f32 v[50:51], v[164:165], v[162:163], v[50:51] op_sel_hi:[0,1,1] neg_lo:[1,0,0] neg_hi:[1,0,0]
    v_pk_fma_f32 v[76:77], v[168:169], v[160:161], v[76:77] op_sel_hi:[0,1,1] neg_lo:[1,0,0] neg_hi:[1,0,0]
    v_pk_fma_f32 v[78:79], v[168:169], v[162:163], v[78:79] op_sel_hi:[0,1,1] neg_lo:[1,0,0] neg_hi:[1,0,0]
    v_pk_mul_f32 v[192:193], v[48:49], v[48:49]
    v_pk_mul_f32 v[194:195], v[50:51], v[50:51]
    v_pk_mul_f32 v[196:197], v[76:77], v[76:77]
    v_pk_mul_f32 v[198:199], v[78:79], v[78:79]
    v_pk_fma_f32 v[192:193], v[192:193], v[166:167], v[166:167] op_sel:[0,1,0] op_sel_hi:[1,1,0]
    v_pk_fma_f32 v[194:195], v[194:195], v[166:167], v[166:167] op_sel:[0,1,0] op_sel_hi:[1,1,0]
    v_pk_fma_f32 v[196:197], v[196:197], v[170:171], v[170:171] op_sel:[0,1,0] op_sel_hi:[1,1,0]
    v_pk_fma_f32 v[198:199], v[198:199], v[170:171], v[170:171] op_sel:[0,1,0] op_sel_hi:[1,1,0]
    v_pk_mul_f32 v[192:193], v[192:193], v[48:49]
    v_pk_mul_f32 v[194:195], v[194:195], v[50:51]
    v_pk_mul_f32 v[196:197], v[196:197], v[76:77]
    v_pk_mul_f32 v[198:199], v[198:199], v[78:79]
    v_exp_f32 v192, v192
    v_exp_f32 v193, v193
    v_exp_f32 v194, v194
    v_exp_f32 v195, v195
    v_exp_f32 v196, v196
    v_exp_f32 v197, v197
    v_exp_f32 v198, v198
    v_exp_f32 v199, v199
    v_pk_fma_f32 v[192:193], v[192:193], v[164:165], v[164:165] op_sel:[0,1,1] op_sel_hi:[1,1,1]
    v_pk_fma_f32 v[194:195], v[194:195], v[164:165], v[164:165] op_sel:[0,1,1] op_sel_hi:[1,1,1]
    v_pk_fma_f32 v[196:197], v[196:197], v[168:169], v[168:169] op_sel:[0,1,1] op_sel_hi:[1,1,1]
    v_pk_fma_f32 v[198:199], v[198:199], v[168:169], v[168:169] op_sel:[0,1,1] op_sel_hi:[1,1,1]
    v_rcp_f32 v192, v192
    v_rcp_f32 v193, v193
    v_rcp_f32 v194, v194
    v_rcp_f32 v195, v195
    v_rcp_f32 v196, v196
    v_rcp_f32 v197, v197
    v_rcp_f32 v198, v198
    v_rcp_f32 v199, v199
    v_pk_mul_f32 v[48:49], v[48:49], v[192:193]
    v_pk_mul_f32 v[50:51], v[50:51], v[194:195]
    v_pk_mul_f32 v[76:77], v[76:77], v[196:197]
    v_pk_mul_f32 v[78:79], v[78:79], v[198:199]
    v_cvt_pk_bf16_f32 v246, v48, v49
    v_cvt_pk_bf16_f32 v247, v50, v51
    s_add_u32 s36, s45, 0
    buffer_store_dwordx4 v[32:35], v2, s[16:19], s36 offen sc1
    v_cvt_pk_bf16_f32 v248, v76, v77
    v_cvt_pk_bf16_f32 v249, v78, v79
    s_add_u32 s36, s45, 229376
    buffer_store_dwordx4 v[60:63], v2, s[16:19], s36 offen sc1
    v_pk_fma_f32 v[104:105], v[172:173], v[160:161], v[104:105] op_sel_hi:[0,1,1] neg_lo:[1,0,0] neg_hi:[1,0,0]
    v_pk_fma_f32 v[106:107], v[172:173], v[162:163], v[106:107] op_sel_hi:[0,1,1] neg_lo:[1,0,0] neg_hi:[1,0,0]
    v_pk_fma_f32 v[132:133], v[176:177], v[160:161], v[132:133] op_sel_hi:[0,1,1] neg_lo:[1,0,0] neg_hi:[1,0,0]
    v_pk_fma_f32 v[134:135], v[176:177], v[162:163], v[134:135] op_sel_hi:[0,1,1] neg_lo:[1,0,0] neg_hi:[1,0,0]
    v_pk_mul_f32 v[192:193], v[104:105], v[104:105]
    v_pk_mul_f32 v[194:195], v[106:107], v[106:107]
    v_pk_mul_f32 v[196:197], v[132:133], v[132:133]
    v_pk_mul_f32 v[198:199], v[134:135], v[134:135]
    v_pk_fma_f32 v[192:193], v[192:193], v[174:175], v[174:175] op_sel:[0,1,0] op_sel_hi:[1,1,0]
    v_pk_fma_f32 v[194:195], v[194:195], v[174:175], v[174:175] op_sel:[0,1,0] op_sel_hi:[1,1,0]
    v_pk_fma_f32 v[196:197], v[196:197], v[178:179], v[178:179] op_sel:[0,1,0] op_sel_hi:[1,1,0]
    v_pk_fma_f32 v[198:199], v[198:199], v[178:179], v[178:179] op_sel:[0,1,0] op_sel_hi:[1,1,0]
    v_pk_mul_f32 v[192:193], v[192:193], v[104:105]
    v_pk_mul_f32 v[194:195], v[194:195], v[106:107]
    v_pk_mul_f32 v[196:197], v[196:197], v[132:133]
    v_pk_mul_f32 v[198:199], v[198:199], v[134:135]
    v_exp_f32 v192, v192
    v_exp_f32 v193, v193
    v_exp_f32 v194, v194
    v_exp_f32 v195, v195
    v_exp_f32 v196, v196
    v_exp_f32 v197, v197
    v_exp_f32 v198, v198
    v_exp_f32 v199, v199
    v_pk_fma_f32 v[192:193], v[192:193], v[172:173], v[172:173] op_sel:[0,1,1] op_sel_hi:[1,1,1]
    v_pk_fma_f32 v[194:195], v[194:195], v[172:173], v[172:173] op_sel:[0,1,1] op_sel_hi:[1,1,1]
    v_pk_fma_f32 v[196:197], v[196:197], v[176:177], v[176:177] op_sel:[0,1,1] op_sel_hi:[1,1,1]
    v_pk_fma_f32 v[198:199], v[198:199], v[176:177], v[176:177] op_sel:[0,1,1] op_sel_hi:[1,1,1]
    v_rcp_f32 v192, v192
    v_rcp_f32 v193, v193
    v_rcp_f32 v194, v194
    v_rcp_f32 v195, v195
    v_rcp_f32 v196, v196
    v_rcp_f32 v197, v197
    v_rcp_f32 v198, v198
    v_rcp_f32 v199, v199
    v_pk_mul_f32 v[104:105], v[104:105], v[192:193]
    v_pk_mul_f32 v[106:107], v[106:107], v[194:195]
    v_pk_mul_f32 v[132:133], v[132:133], v[196:197]
    v_pk_mul_f32 v[134:135], v[134:135], v[198:199]
    v_cvt_pk_bf16_f32 v250, v104, v105
    v_cvt_pk_bf16_f32 v251, v106, v107
    s_add_u32 s36, s45, 458752
    buffer_store_dwordx4 v[88:91], v2, s[16:19], s36 offen sc1
    v_cvt_pk_bf16_f32 v252, v132, v133
    v_cvt_pk_bf16_f32 v253, v134, v135
    s_add_u32 s36, s45, 688128
    buffer_store_dwordx4 v[116:119], v2, s[16:19], s36 offen sc1
    s_waitcnt vmcnt(4) lgkmcnt(0)
    v_lshrrev_b32 v18, 2, v1
    v_mul_u32_u24 v13, 256, v18
    v_and_b32 v19, 3, v1
    v_lshl_add_u32 v13, v19, 3, v13
    v_add_u32 v13, 49152, v13
    v_and_b32 v18, 7, v18
    s_mul_i32 s36, s35, 4
    s_add_u32 s36, s36, 3
    v_xor_b32 v19, s36, v18
    v_lshl_add_u32 v16, v19, 5, v13
    s_mul_i32 s36, s35, 4
    s_add_u32 s36, s36, 2
    v_xor_b32 v19, s36, v18
    v_lshl_add_u32 v15, v19, 5, v13
    s_mul_i32 s36, s35, 4
    s_add_u32 s36, s36, 1
    v_xor_b32 v19, s36, v18
    v_lshl_add_u32 v14, v19, 5, v13
    s_mul_i32 s36, s35, 4
    s_add_u32 s36, s36, 0
    v_xor_b32 v19, s36, v18
    v_lshl_add_u32 v13, v19, 5, v13
    s_mov_b32 s42, 0
    s_mov_b32 s43, 0
    s_mov_b32 s48, 0
    v_mov_b32 v17, v12
    v_mov_b32 v18, v13
    v_mov_b32 v19, v14
    v_mov_b32 v20, v15
    v_mov_b32 v21, v16
    v_mov_b32 v56, 0x10000
    s_waitcnt lgkmcnt(0)
    s_barrier
    ds_read_b128 v[24:27], v17 offset:0
    ds_read_b128 v[28:31], v17 offset:2048
    ds_read_b128 v[32:35], v17 offset:4096
    ds_read_b128 v[36:39], v17 offset:6144
    ds_read_b64_tr_b16 v[40:41], v18 offset:0
    ds_read_b64_tr_b16 v[42:43], v18 offset:4096
    ds_read_b64_tr_b16 v[44:45], v19 offset:0
    ds_read_b64_tr_b16 v[46:47], v19 offset:4096
    ds_read_b64_tr_b16 v[48:49], v20 offset:0
    ds_read_b64_tr_b16 v[50:51], v20 offset:4096
    ds_read_b64_tr_b16 v[52:53], v21 offset:0
    ds_read_b64_tr_b16 v[54:55], v21 offset:4096
    v_mfma_f32_16x16x32_bf16 v[120:123], v[226:229], v[180:183], 0
    v_mfma_f32_16x16x32_bf16 v[124:127], v[224:227], v[180:183], 0
    v_mfma_f32_16x16x32_bf16 v[128:131], v[226:229], v[200:203], 0
    v_mfma_f32_16x16x32_bf16 v[132:135], v[224:227], v[200:203], 0
    v_mfma_f32_16x16x32_bf16 v[136:139], v[226:229], v[208:211], 0
    v_mfma_f32_16x16x32_bf16 v[140:143], v[224:227], v[208:211], 0
    v_mfma_f32_16x16x32_bf16 v[144:147], v[226:229], v[216:219], 0
    v_mfma_f32_16x16x32_bf16 v[148:151], v[224:227], v[216:219], 0
    v_mfma_f32_16x16x32_bf16 v[120:123], v[226:229], v[184:187], v[120:123]
    v_mfma_f32_16x16x32_bf16 v[124:127], v[224:227], v[184:187], v[124:127]
    v_mfma_f32_16x16x32_bf16 v[128:131], v[226:229], v[204:207], v[128:131]
    v_mfma_f32_16x16x32_bf16 v[132:135], v[224:227], v[204:207], v[132:135]
    v_mfma_f32_16x16x32_bf16 v[136:139], v[226:229], v[212:215], v[136:139]
    v_mfma_f32_16x16x32_bf16 v[140:143], v[224:227], v[212:215], v[140:143]
    v_mfma_f32_16x16x32_bf16 v[144:147], v[226:229], v[220:223], v[144:147]
    v_mfma_f32_16x16x32_bf16 v[148:151], v[224:227], v[220:223], v[148:151]
    s_waitcnt lgkmcnt(0)
    v_mfma_f32_16x16x32_bf16 v[120:123], v[40:43], v[24:27], v[120:123]
    ds_read_b128 v[184:187], v17 offset:1024
    ds_read_b128 v[188:191], v17 offset:3072
    v_mfma_f32_16x16x32_bf16 v[136:139], v[40:43], v[28:31], v[136:139]
    ds_read_b128 v[192:195], v17 offset:5120
    v_mfma_f32_16x16x32_bf16 v[152:155], v[40:43], v[32:35], 0
    ds_read_b128 v[196:199], v17 offset:7168
    v_mfma_f32_16x16x32_bf16 v[168:171], v[40:43], v[36:39], 0
    s_add_u32 s36, s46, 0
    buffer_store_dwordx4 v[230:233], v2, s[16:19], s36 offen sc1
    v_mfma_f32_16x16x32_bf16 v[172:175], v[44:47], v[36:39], 0
    ds_read_b64_tr_b16 v[200:201], v18 offset:8192
    v_mfma_f32_16x16x32_bf16 v[156:159], v[44:47], v[32:35], 0
    ds_read_b64_tr_b16 v[202:203], v18 offset:12288
    v_mfma_f32_16x16x32_bf16 v[140:143], v[44:47], v[28:31], v[140:143]
    ds_read_b64_tr_b16 v[204:205], v19 offset:8192
    s_add_u32 s36, s47, 0
    buffer_store_dwordx2 v[246:247], v254, s[16:19], s36 offen sc1
    v_mfma_f32_16x16x32_bf16 v[124:127], v[44:47], v[24:27], v[124:127]
    ds_read_b64_tr_b16 v[206:207], v19 offset:12288
    v_mfma_f32_16x16x32_bf16 v[128:131], v[48:51], v[24:27], v[128:131]
    ds_read_b64_tr_b16 v[208:209], v20 offset:8192
    v_mfma_f32_16x16x32_bf16 v[144:147], v[48:51], v[28:31], v[144:147]
    ds_read_b64_tr_b16 v[210:211], v20 offset:12288
    v_mfma_f32_16x16x32_bf16 v[160:163], v[48:51], v[32:35], 0
    ds_read_b64_tr_b16 v[212:213], v21 offset:8192
    v_mfma_f32_16x16x32_bf16 v[176:179], v[48:51], v[36:39], 0
    ds_read_b64_tr_b16 v[214:215], v21 offset:12288
    s_add_u32 s42, s42, 16384
    s_cmp_eq_u32 s42, 49152
    s_cselect_b32 s42, 0, s42
    v_mfma_f32_16x16x32_bf16 v[180:183], v[52:55], v[36:39], 0
    s_add_u32 s48, s48, 16384
    s_cmp_eq_u32 s48, 98304
    s_cselect_b32 s48, 0, s48
    v_mfma_f32_16x16x32_bf16 v[164:167], v[52:55], v[32:35], 0
    v_add_u32 v17, s42, v12
    v_add_u32 v18, s48, v13
    v_add_u32 v19, s48, v14
    v_mfma_f32_16x16x32_bf16 v[148:151], v[52:55], v[28:31], v[148:151]
    v_add_u32 v20, s48, v15
    v_add_u32 v21, s48, v16
    v_mfma_f32_16x16x32_bf16 v[132:135], v[52:55], v[24:27], v[132:135]
    s_waitcnt lgkmcnt(0)
    s_barrier
    v_mfma_f32_16x16x32_bf16 v[120:123], v[200:203], v[184:187], v[120:123]
    ds_read_b128 v[24:27], v17 offset:0
    ds_read_b128 v[28:31], v17 offset:2048
    v_mfma_f32_16x16x32_bf16 v[136:139], v[200:203], v[188:191], v[136:139]
    ds_read_b128 v[32:35], v17 offset:4096
    v_mfma_f32_16x16x32_bf16 v[152:155], v[200:203], v[192:195], v[152:155]
    ds_read_b128 v[36:39], v17 offset:6144
    v_mfma_f32_16x16x32_bf16 v[168:171], v[200:203], v[196:199], v[168:171]
    s_add_u32 s36, s46, 229376
    buffer_store_dwordx4 v[234:237], v2, s[16:19], s36 offen sc1
    v_mfma_f32_16x16x32_bf16 v[172:175], v[204:207], v[196:199], v[172:175]
    ds_read_b64_tr_b16 v[40:41], v18 offset:0
    v_mfma_f32_16x16x32_bf16 v[156:159], v[204:207], v[192:195], v[156:159]
    ds_read_b64_tr_b16 v[42:43], v18 offset:4096
    v_mfma_f32_16x16x32_bf16 v[140:143], v[204:207], v[188:191], v[140:143]
    ds_read_b64_tr_b16 v[44:45], v19 offset:0
    s_add_u32 s36, s47, 229376
    buffer_store_dwordx2 v[248:249], v254, s[16:19], s36 offen sc1
    v_mfma_f32_16x16x32_bf16 v[124:127], v[204:207], v[184:187], v[124:127]
    ds_read_b64_tr_b16 v[46:47], v19 offset:4096
    v_mfma_f32_16x16x32_bf16 v[128:131], v[208:211], v[184:187], v[128:131]
    ds_read_b64_tr_b16 v[48:49], v20 offset:0
    v_mfma_f32_16x16x32_bf16 v[144:147], v[208:211], v[188:191], v[144:147]
    ds_read_b64_tr_b16 v[50:51], v20 offset:4096
    v_mfma_f32_16x16x32_bf16 v[160:163], v[208:211], v[192:195], v[160:163]
    ds_read_b64_tr_b16 v[52:53], v21 offset:0
    v_mfma_f32_16x16x32_bf16 v[176:179], v[208:211], v[196:199], v[176:179]
    ds_read_b64_tr_b16 v[54:55], v21 offset:4096
    s_add_u32 s43, s43, 1
    v_mfma_f32_16x16x32_bf16 v[180:183], v[212:215], v[196:199], v[180:183]
    s_cmp_lt_u32 s43, 27
    v_mfma_f32_16x16x32_bf16 v[164:167], v[212:215], v[192:195], v[164:167]
    v_mfma_f32_16x16x32_bf16 v[148:151], v[212:215], v[188:191], v[148:151]
    v_mfma_f32_16x16x32_bf16 v[132:135], v[212:215], v[184:187], v[132:135]
    s_waitcnt lgkmcnt(0)
    v_mfma_f32_16x16x32_bf16 v[120:123], v[40:43], v[24:27], v[120:123]
    ds_read_b128 v[184:187], v17 offset:1024
    ds_read_b128 v[188:191], v17 offset:3072
    v_mfma_f32_16x16x32_bf16 v[136:139], v[40:43], v[28:31], v[136:139]
    ds_read_b128 v[192:195], v17 offset:5120
    v_mfma_f32_16x16x32_bf16 v[152:155], v[40:43], v[32:35], v[152:155]
    ds_read_b128 v[196:199], v17 offset:7168
    v_mfma_f32_16x16x32_bf16 v[168:171], v[40:43], v[36:39], v[168:171]
    s_add_u32 s36, s46, 458752
    buffer_store_dwordx4 v[238:241], v2, s[16:19], s36 offen sc1
    v_mfma_f32_16x16x32_bf16 v[172:175], v[44:47], v[36:39], v[172:175]
    ds_read_b64_tr_b16 v[200:201], v18 offset:8192
    v_mfma_f32_16x16x32_bf16 v[156:159], v[44:47], v[32:35], v[156:159]
    ds_read_b64_tr_b16 v[202:203], v18 offset:12288
    v_mfma_f32_16x16x32_bf16 v[140:143], v[44:47], v[28:31], v[140:143]
    ds_read_b64_tr_b16 v[204:205], v19 offset:8192
    s_add_u32 s36, s47, 458752
    buffer_store_dwordx2 v[250:251], v254, s[16:19], s36 offen sc1
    v_mfma_f32_16x16x32_bf16 v[124:127], v[44:47], v[24:27], v[124:127]
    ds_read_b64_tr_b16 v[206:207], v19 offset:12288
    v_mfma_f32_16x16x32_bf16 v[128:131], v[48:51], v[24:27], v[128:131]
    ds_read_b64_tr_b16 v[208:209], v20 offset:8192
    v_mfma_f32_16x16x32_bf16 v[144:147], v[48:51], v[28:31], v[144:147]
    ds_read_b64_tr_b16 v[210:211], v20 offset:12288
    v_mfma_f32_16x16x32_bf16 v[160:163], v[48:51], v[32:35], v[160:163]
    ds_read_b64_tr_b16 v[212:213], v21 offset:8192
    v_mfma_f32_16x16x32_bf16 v[176:179], v[48:51], v[36:39], v[176:179]
    ds_read_b64_tr_b16 v[214:215], v21 offset:12288
    s_add_u32 s42, s42, 16384
    s_cmp_eq_u32 s42, 49152
    s_cselect_b32 s42, 0, s42
    v_mfma_f32_16x16x32_bf16 v[180:183], v[52:55], v[36:39], v[180:183]
    s_add_u32 s48, s48, 16384
    s_cmp_eq_u32 s48, 98304
    s_cselect_b32 s48, 0, s48
    v_mfma_f32_16x16x32_bf16 v[164:167], v[52:55], v[32:35], v[164:167]
    v_add_u32 v17, s42, v12
    v_add_u32 v18, s48, v13
    v_add_u32 v19, s48, v14
    v_mfma_f32_16x16x32_bf16 v[148:151], v[52:55], v[28:31], v[148:151]
    v_add_u32 v20, s48, v15
    v_add_u32 v21, s48, v16
    v_mfma_f32_16x16x32_bf16 v[132:135], v[52:55], v[24:27], v[132:135]
    s_waitcnt lgkmcnt(0)
    s_barrier
    v_mfma_f32_16x16x32_bf16 v[120:123], v[200:203], v[184:187], v[120:123]
    ds_read_b128 v[24:27], v17 offset:0
    ds_read_b128 v[28:31], v17 offset:2048
    v_mfma_f32_16x16x32_bf16 v[136:139], v[200:203], v[188:191], v[136:139]
    ds_read_b128 v[32:35], v17 offset:4096
    v_mfma_f32_16x16x32_bf16 v[152:155], v[200:203], v[192:195], v[152:155]
    ds_read_b128 v[36:39], v17 offset:6144
    v_mfma_f32_16x16x32_bf16 v[168:171], v[200:203], v[196:199], v[168:171]
    s_add_u32 s36, s46, 688128
    buffer_store_dwordx4 v[242:245], v2, s[16:19], s36 offen sc1
    v_mfma_f32_16x16x32_bf16 v[172:175], v[204:207], v[196:199], v[172:175]
    ds_read_b64_tr_b16 v[40:41], v18 offset:0
    v_mfma_f32_16x16x32_bf16 v[156:159], v[204:207], v[192:195], v[156:159]
    ds_read_b64_tr_b16 v[42:43], v18 offset:4096
    v_mfma_f32_16x16x32_bf16 v[140:143], v[204:207], v[188:191], v[140:143]
    ds_read_b64_tr_b16 v[44:45], v19 offset:0
    s_add_u32 s36, s47, 688128
    buffer_store_dwordx2 v[252:253], v254, s[16:19], s36 offen sc1
    v_mfma_f32_16x16x32_bf16 v[124:127], v[204:207], v[184:187], v[124:127]
    ds_read_b64_tr_b16 v[46:47], v19 offset:4096
    v_mfma_f32_16x16x32_bf16 v[128:131], v[208:211], v[184:187], v[128:131]
    ds_read_b64_tr_b16 v[48:49], v20 offset:0
    v_mfma_f32_16x16x32_bf16 v[144:147], v[208:211], v[188:191], v[144:147]
    ds_read_b64_tr_b16 v[50:51], v20 offset:4096
    v_mfma_f32_16x16x32_bf16 v[160:163], v[208:211], v[192:195], v[160:163]
    ds_read_b64_tr_b16 v[52:53], v21 offset:0
    v_mfma_f32_16x16x32_bf16 v[176:179], v[208:211], v[196:199], v[176:179]
    ds_read_b64_tr_b16 v[54:55], v21 offset:4096
    s_add_u32 s43, s43, 1
    v_mfma_f32_16x16x32_bf16 v[180:183], v[212:215], v[196:199], v[180:183]
    s_cmp_lt_u32 s43, 27
    v_mfma_f32_16x16x32_bf16 v[164:167], v[212:215], v[192:195], v[164:167]
    v_mfma_f32_16x16x32_bf16 v[148:151], v[212:215], v[188:191], v[148:151]
    v_mfma_f32_16x16x32_bf16 v[132:135], v[212:215], v[184:187], v[132:135]
    s_waitcnt vmcnt(8)
    buffer_atomic_add v8, v9, s[56:59], s49 offen offset:512 sc1
mm_21:
    s_waitcnt lgkmcnt(0)
    v_mfma_f32_16x16x32_bf16 v[120:123], v[40:43], v[24:27], v[120:123]
    ds_read_b128 v[184:187], v17 offset:1024
    v_mfma_f32_16x16x32_bf16 v[136:139], v[40:43], v[28:31], v[136:139]
    ds_read_b128 v[188:191], v17 offset:3072
    v_mfma_f32_16x16x32_bf16 v[152:155], v[40:43], v[32:35], v[152:155]
    ds_read_b128 v[192:195], v17 offset:5120
    v_mfma_f32_16x16x32_bf16 v[168:171], v[40:43], v[36:39], v[168:171]
    ds_read_b128 v[196:199], v17 offset:7168
    v_mfma_f32_16x16x32_bf16 v[172:175], v[44:47], v[36:39], v[172:175]
    ds_read_b64_tr_b16 v[200:201], v18 offset:8192
    v_mfma_f32_16x16x32_bf16 v[156:159], v[44:47], v[32:35], v[156:159]
    ds_read_b64_tr_b16 v[202:203], v18 offset:12288
    v_mfma_f32_16x16x32_bf16 v[140:143], v[44:47], v[28:31], v[140:143]
    ds_read_b64_tr_b16 v[204:205], v19 offset:8192
    v_mfma_f32_16x16x32_bf16 v[124:127], v[44:47], v[24:27], v[124:127]
    ds_read_b64_tr_b16 v[206:207], v19 offset:12288
    v_mfma_f32_16x16x32_bf16 v[128:131], v[48:51], v[24:27], v[128:131]
    ds_read_b64_tr_b16 v[208:209], v20 offset:8192
    v_mfma_f32_16x16x32_bf16 v[144:147], v[48:51], v[28:31], v[144:147]
    ds_read_b64_tr_b16 v[210:211], v20 offset:12288
    v_mfma_f32_16x16x32_bf16 v[160:163], v[48:51], v[32:35], v[160:163]
    ds_read_b64_tr_b16 v[212:213], v21 offset:8192
    v_mfma_f32_16x16x32_bf16 v[176:179], v[48:51], v[36:39], v[176:179]
    ds_read_b64_tr_b16 v[214:215], v21 offset:12288
    s_add_u32 s42, s42, 16384
    s_cmp_eq_u32 s42, 49152
    s_cselect_b32 s42, 0, s42
    v_mfma_f32_16x16x32_bf16 v[180:183], v[52:55], v[36:39], v[180:183]
    s_add_u32 s48, s48, 16384
    s_cmp_eq_u32 s48, 98304
    s_cselect_b32 s48, 0, s48
    v_mfma_f32_16x16x32_bf16 v[164:167], v[52:55], v[32:35], v[164:167]
    v_add_u32 v17, s42, v12
    v_add_u32 v18, s48, v13
    v_add_u32 v19, s48, v14
    v_mfma_f32_16x16x32_bf16 v[148:151], v[52:55], v[28:31], v[148:151]
    v_add_u32 v20, s48, v15
    v_add_u32 v21, s48, v16
    v_mfma_f32_16x16x32_bf16 v[132:135], v[52:55], v[24:27], v[132:135]
    s_waitcnt lgkmcnt(0)
    s_barrier
    v_mfma_f32_16x16x32_bf16 v[120:123], v[200:203], v[184:187], v[120:123]
    ds_read_b128 v[24:27], v17 offset:0
    v_mfma_f32_16x16x32_bf16 v[136:139], v[200:203], v[188:191], v[136:139]
    ds_read_b128 v[28:31], v17 offset:2048
    v_mfma_f32_16x16x32_bf16 v[152:155], v[200:203], v[192:195], v[152:155]
    ds_read_b128 v[32:35], v17 offset:4096
    v_mfma_f32_16x16x32_bf16 v[168:171], v[200:203], v[196:199], v[168:171]
    ds_read_b128 v[36:39], v17 offset:6144
    v_mfma_f32_16x16x32_bf16 v[172:175], v[204:207], v[196:199], v[172:175]
    ds_read_b64_tr_b16 v[40:41], v18 offset:0
    v_mfma_f32_16x16x32_bf16 v[156:159], v[204:207], v[192:195], v[156:159]
    ds_read_b64_tr_b16 v[42:43], v18 offset:4096
    v_mfma_f32_16x16x32_bf16 v[140:143], v[204:207], v[188:191], v[140:143]
    ds_read_b64_tr_b16 v[44:45], v19 offset:0
    v_mfma_f32_16x16x32_bf16 v[124:127], v[204:207], v[184:187], v[124:127]
    ds_read_b64_tr_b16 v[46:47], v19 offset:4096
    v_mfma_f32_16x16x32_bf16 v[128:131], v[208:211], v[184:187], v[128:131]
    ds_read_b64_tr_b16 v[48:49], v20 offset:0
    v_mfma_f32_16x16x32_bf16 v[144:147], v[208:211], v[188:191], v[144:147]
    ds_read_b64_tr_b16 v[50:51], v20 offset:4096
    v_mfma_f32_16x16x32_bf16 v[160:163], v[208:211], v[192:195], v[160:163]
    ds_read_b64_tr_b16 v[52:53], v21 offset:0
    v_mfma_f32_16x16x32_bf16 v[176:179], v[208:211], v[196:199], v[176:179]
    ds_read_b64_tr_b16 v[54:55], v21 offset:4096
    s_add_u32 s43, s43, 1
    v_mfma_f32_16x16x32_bf16 v[180:183], v[212:215], v[196:199], v[180:183]
    s_cmp_lt_u32 s43, 4
    v_mfma_f32_16x16x32_bf16 v[164:167], v[212:215], v[192:195], v[164:167]
    v_mfma_f32_16x16x32_bf16 v[148:151], v[212:215], v[188:191], v[148:151]
    v_mfma_f32_16x16x32_bf16 v[132:135], v[212:215], v[184:187], v[132:135]
    s_cbranch_scc1 mm_21
    s_waitcnt vmcnt(0)
    buffer_atomic_add v8, v9, s[56:59], s49 offen offset:1024 sc1
mm_22:
    s_waitcnt lgkmcnt(0)
    v_mfma_f32_16x16x32_bf16 v[120:123], v[40:43], v[24:27], v[120:123]
    ds_read_b128 v[184:187], v17 offset:1024
    v_mfma_f32_16x16x32_bf16 v[136:139], v[40:43], v[28:31], v[136:139]
    ds_read_b128 v[188:191], v17 offset:3072
    v_mfma_f32_16x16x32_bf16 v[152:155], v[40:43], v[32:35], v[152:155]
    ds_read_b128 v[192:195], v17 offset:5120
    v_mfma_f32_16x16x32_bf16 v[168:171], v[40:43], v[36:39], v[168:171]
    ds_read_b128 v[196:199], v17 offset:7168
    v_mfma_f32_16x16x32_bf16 v[172:175], v[44:47], v[36:39], v[172:175]
    ds_read_b64_tr_b16 v[200:201], v18 offset:8192
    v_mfma_f32_16x16x32_bf16 v[156:159], v[44:47], v[32:35], v[156:159]
    ds_read_b64_tr_b16 v[202:203], v18 offset:12288
    v_mfma_f32_16x16x32_bf16 v[140:143], v[44:47], v[28:31], v[140:143]
    ds_read_b64_tr_b16 v[204:205], v19 offset:8192
    v_mfma_f32_16x16x32_bf16 v[124:127], v[44:47], v[24:27], v[124:127]
    ds_read_b64_tr_b16 v[206:207], v19 offset:12288
    v_mfma_f32_16x16x32_bf16 v[128:131], v[48:51], v[24:27], v[128:131]
    ds_read_b64_tr_b16 v[208:209], v20 offset:8192
    v_mfma_f32_16x16x32_bf16 v[144:147], v[48:51], v[28:31], v[144:147]
    ds_read_b64_tr_b16 v[210:211], v20 offset:12288
    v_mfma_f32_16x16x32_bf16 v[160:163], v[48:51], v[32:35], v[160:163]
    ds_read_b64_tr_b16 v[212:213], v21 offset:8192
    v_mfma_f32_16x16x32_bf16 v[176:179], v[48:51], v[36:39], v[176:179]
    ds_read_b64_tr_b16 v[214:215], v21 offset:12288
    s_add_u32 s42, s42, 16384
    s_cmp_eq_u32 s42, 49152
    s_cselect_b32 s42, 0, s42
    v_mfma_f32_16x16x32_bf16 v[180:183], v[52:55], v[36:39], v[180:183]
    s_add_u32 s48, s48, 16384
    s_cmp_eq_u32 s48, 98304
    s_cselect_b32 s48, 0, s48
    v_mfma_f32_16x16x32_bf16 v[164:167], v[52:55], v[32:35], v[164:167]
    v_add_u32 v17, s42, v12
    v_add_u32 v18, s48, v13
    v_add_u32 v19, s48, v14
    v_mfma_f32_16x16x32_bf16 v[148:151], v[52:55], v[28:31], v[148:151]
    v_add_u32 v20, s48, v15
    v_add_u32 v21, s48, v16
    v_mfma_f32_16x16x32_bf16 v[132:135], v[52:55], v[24:27], v[132:135]
    s_waitcnt lgkmcnt(0)
    s_barrier
    v_mfma_f32_16x16x32_bf16 v[120:123], v[200:203], v[184:187], v[120:123]
    ds_read_b128 v[24:27], v17 offset:0
    v_mfma_f32_16x16x32_bf16 v[136:139], v[200:203], v[188:191], v[136:139]
    ds_read_b128 v[28:31], v17 offset:2048
    v_mfma_f32_16x16x32_bf16 v[152:155], v[200:203], v[192:195], v[152:155]
    ds_read_b128 v[32:35], v17 offset:4096
    v_mfma_f32_16x16x32_bf16 v[168:171], v[200:203], v[196:199], v[168:171]
    ds_read_b128 v[36:39], v17 offset:6144
    v_mfma_f32_16x16x32_bf16 v[172:175], v[204:207], v[196:199], v[172:175]
    ds_read_b64_tr_b16 v[40:41], v18 offset:0
    v_mfma_f32_16x16x32_bf16 v[156:159], v[204:207], v[192:195], v[156:159]
    ds_read_b64_tr_b16 v[42:43], v18 offset:4096
    v_mfma_f32_16x16x32_bf16 v[140:143], v[204:207], v[188:191], v[140:143]
    ds_read_b64_tr_b16 v[44:45], v19 offset:0
    v_mfma_f32_16x16x32_bf16 v[124:127], v[204:207], v[184:187], v[124:127]
    ds_read_b64_tr_b16 v[46:47], v19 offset:4096
    v_mfma_f32_16x16x32_bf16 v[128:131], v[208:211], v[184:187], v[128:131]
    ds_read_b64_tr_b16 v[48:49], v20 offset:0
    v_mfma_f32_16x16x32_bf16 v[144:147], v[208:211], v[188:191], v[144:147]
    ds_read_b64_tr_b16 v[50:51], v20 offset:4096
    v_mfma_f32_16x16x32_bf16 v[160:163], v[208:211], v[192:195], v[160:163]
    ds_read_b64_tr_b16 v[52:53], v21 offset:0
    v_mfma_f32_16x16x32_bf16 v[176:179], v[208:211], v[196:199], v[176:179]
    ds_read_b64_tr_b16 v[54:55], v21 offset:4096
    s_add_u32 s43, s43, 1
    v_mfma_f32_16x16x32_bf16 v[180:183], v[212:215], v[196:199], v[180:183]
    s_cmp_lt_u32 s43, 21
    v_mfma_f32_16x16x32_bf16 v[164:167], v[212:215], v[192:195], v[164:167]
    v_mfma_f32_16x16x32_bf16 v[148:151], v[212:215], v[188:191], v[148:151]
    v_mfma_f32_16x16x32_bf16 v[132:135], v[212:215], v[184:187], v[132:135]
    s_cbranch_scc1 mm_22
    s_waitcnt lgkmcnt(0)
    v_mfma_f32_16x16x32_bf16 v[120:123], v[40:43], v[24:27], v[120:123]
    ds_read_b128 v[184:187], v17 offset:1024
    v_mfma_f32_16x16x32_bf16 v[136:139], v[40:43], v[28:31], v[136:139]
    ds_read_b128 v[188:191], v17 offset:3072
    v_mfma_f32_16x16x32_bf16 v[152:155], v[40:43], v[32:35], v[152:155]
    ds_read_b128 v[192:195], v17 offset:5120
    v_mfma_f32_16x16x32_bf16 v[168:171], v[40:43], v[36:39], v[168:171]
    ds_read_b128 v[196:199], v17 offset:7168
    v_mfma_f32_16x16x32_bf16 v[172:175], v[44:47], v[36:39], v[172:175]
    ds_read_b64_tr_b16 v[200:201], v18 offset:8192
    v_mfma_f32_16x16x32_bf16 v[156:159], v[44:47], v[32:35], v[156:159]
    ds_read_b64_tr_b16 v[202:203], v18 offset:12288
    v_mfma_f32_16x16x32_bf16 v[140:143], v[44:47], v[28:31], v[140:143]
    ds_read_b64_tr_b16 v[204:205], v19 offset:8192
    v_mfma_f32_16x16x32_bf16 v[124:127], v[44:47], v[24:27], v[124:127]
    ds_read_b64_tr_b16 v[206:207], v19 offset:12288
    v_mfma_f32_16x16x32_bf16 v[128:131], v[48:51], v[24:27], v[128:131]
    ds_read_b64_tr_b16 v[208:209], v20 offset:8192
    v_mfma_f32_16x16x32_bf16 v[144:147], v[48:51], v[28:31], v[144:147]
    ds_read_b64_tr_b16 v[210:211], v20 offset:12288
    v_mfma_f32_16x16x32_bf16 v[160:163], v[48:51], v[32:35], v[160:163]
    ds_read_b64_tr_b16 v[212:213], v21 offset:8192
    v_mfma_f32_16x16x32_bf16 v[176:179], v[48:51], v[36:39], v[176:179]
    ds_read_b64_tr_b16 v[214:215], v21 offset:12288
    v_add_u32 v18, 49152, v13
    v_mfma_f32_16x16x32_bf16 v[180:183], v[52:55], v[36:39], v[180:183]
    v_add_u32 v19, 49152, v14
    v_mfma_f32_16x16x32_bf16 v[164:167], v[52:55], v[32:35], v[164:167]
    v_add_u32 v20, 49152, v15
    v_mfma_f32_16x16x32_bf16 v[148:151], v[52:55], v[28:31], v[148:151]
    v_add_u32 v21, 49152, v16
    v_mfma_f32_16x16x32_bf16 v[132:135], v[52:55], v[24:27], v[132:135]
    s_waitcnt lgkmcnt(0)
    s_barrier
    v_mfma_f32_16x16x32_bf16 v[120:123], v[200:203], v[184:187], v[120:123]
    ds_read_b128 v[232:235], v12 offset:16384
    ds_read_b128 v[236:239], v12 offset:18432
    v_mfma_f32_16x16x32_bf16 v[136:139], v[200:203], v[188:191], v[136:139]
    ds_read_b128 v[240:243], v12 offset:17408
    ds_read_b128 v[244:247], v12 offset:19456
    v_mfma_f32_16x16x32_bf16 v[152:155], v[200:203], v[192:195], v[152:155]
    ds_read_b64_tr_b16 v[24:25], v18 offset:16384
    v_mfma_f32_16x16x32_bf16 v[168:171], v[200:203], v[196:199], v[168:171]
    ds_read_b64_tr_b16 v[26:27], v18 offset:20480
    ds_read_b64_tr_b16 v[28:29], v19 offset:16384
    v_mfma_f32_16x16x32_bf16 v[172:175], v[204:207], v[196:199], v[172:175]
    ds_read_b64_tr_b16 v[30:31], v19 offset:20480
    ds_read_b64_tr_b16 v[32:33], v20 offset:16384
    v_mfma_f32_16x16x32_bf16 v[156:159], v[204:207], v[192:195], v[156:159]
    ds_read_b64_tr_b16 v[34:35], v20 offset:20480
    v_mfma_f32_16x16x32_bf16 v[140:143], v[204:207], v[188:191], v[140:143]
    ds_read_b64_tr_b16 v[36:37], v21 offset:16384
    ds_read_b64_tr_b16 v[38:39], v21 offset:20480
    v_mfma_f32_16x16x32_bf16 v[124:127], v[204:207], v[184:187], v[124:127]
    ds_read_b64_tr_b16 v[40:41], v18 offset:24576
    ds_read_b64_tr_b16 v[42:43], v18 offset:28672
    v_mfma_f32_16x16x32_bf16 v[128:131], v[208:211], v[184:187], v[128:131]
    ds_read_b64_tr_b16 v[44:45], v19 offset:24576
    v_mfma_f32_16x16x32_bf16 v[144:147], v[208:211], v[188:191], v[144:147]
    ds_read_b64_tr_b16 v[46:47], v19 offset:28672
    ds_read_b64_tr_b16 v[48:49], v20 offset:24576
    v_mfma_f32_16x16x32_bf16 v[160:163], v[208:211], v[192:195], v[160:163]
    ds_read_b64_tr_b16 v[50:51], v20 offset:28672
    ds_read_b64_tr_b16 v[52:53], v21 offset:24576
    v_mfma_f32_16x16x32_bf16 v[176:179], v[208:211], v[196:199], v[176:179]
    ds_read_b64_tr_b16 v[54:55], v21 offset:28672
    v_mfma_f32_16x16x32_bf16 v[180:183], v[212:215], v[196:199], v[180:183]
    v_mfma_f32_16x16x32_bf16 v[164:167], v[212:215], v[192:195], v[164:167]
    v_mfma_f32_16x16x32_bf16 v[148:151], v[212:215], v[188:191], v[148:151]
    v_mfma_f32_16x16x32_bf16 v[132:135], v[212:215], v[184:187], v[132:135]
    s_waitcnt lgkmcnt(8)
    v_mfma_f32_16x16x32_bf16 v[152:155], v[24:27], v[232:235], v[152:155]
    ds_read_b128 v[88:91], v12 offset:20480
    ds_read_b128 v[92:95], v12 offset:22528
    v_mfma_f32_16x16x32_bf16 v[168:171], v[24:27], v[236:239], v[168:171]
    ds_read_b128 v[96:99], v12 offset:21504
    v_mfma_f32_16x16x32_bf16 v[172:175], v[28:31], v[236:239], v[172:175]
    ds_read_b128 v[100:103], v12 offset:23552
    v_mfma_f32_16x16x32_bf16 v[156:159], v[28:31], v[232:235], v[156:159]
    ds_read_b64_tr_b16 v[184:185], v18 offset:32768
    v_mfma_f32_16x16x32_bf16 v[160:163], v[32:35], v[232:235], v[160:163]
    ds_read_b64_tr_b16 v[186:187], v18 offset:36864
    ds_read_b64_tr_b16 v[188:189], v19 offset:32768
    v_mfma_f32_16x16x32_bf16 v[176:179], v[32:35], v[236:239], v[176:179]
    ds_read_b64_tr_b16 v[190:191], v19 offset:36864
    v_mfma_f32_16x16x32_bf16 v[180:183], v[36:39], v[236:239], v[180:183]
    ds_read_b64_tr_b16 v[192:193], v20 offset:32768
    v_mfma_f32_16x16x32_bf16 v[164:167], v[36:39], v[232:235], v[164:167]
    ds_read_b64_tr_b16 v[194:195], v20 offset:36864
    s_waitcnt lgkmcnt(10)
    v_mfma_f32_16x16x32_bf16 v[152:155], v[40:43], v[240:243], v[152:155]
    ds_read_b64_tr_b16 v[196:197], v21 offset:32768
    ds_read_b64_tr_b16 v[198:199], v21 offset:36864
    v_mfma_f32_16x16x32_bf16 v[168:171], v[40:43], v[244:247], v[168:171]
    ds_read_b64_tr_b16 v[200:201], v18 offset:40960
    v_mfma_f32_16x16x32_bf16 v[172:175], v[44:47], v[244:247], v[172:175]
    ds_read_b64_tr_b16 v[202:203], v18 offset:45056
    v_mfma_f32_16x16x32_bf16 v[156:159], v[44:47], v[240:243], v[156:159]
    ds_read_b64_tr_b16 v[204:205], v19 offset:40960
    v_mfma_f32_16x16x32_bf16 v[160:163], v[48:51], v[240:243], v[160:163]
    ds_read_b64_tr_b16 v[206:207], v19 offset:45056
    ds_read_b64_tr_b16 v[208:209], v20 offset:40960
    v_mfma_f32_16x16x32_bf16 v[176:179], v[48:51], v[244:247], v[176:179]
    ds_read_b64_tr_b16 v[210:211], v20 offset:45056
    v_mfma_f32_16x16x32_bf16 v[180:183], v[52:55], v[244:247], v[180:183]
    ds_read_b64_tr_b16 v[212:213], v21 offset:40960
    v_mfma_f32_16x16x32_bf16 v[164:167], v[52:55], v[240:243], v[164:167]
    ds_read_b64_tr_b16 v[214:215], v21 offset:45056
    s_waitcnt lgkmcnt(8)
    s_barrier
    v_mfma_f32_16x16x32_bf16 v[152:155], v[184:187], v[88:91], v[152:155]
    ds_read_b128 v[232:235], v12 offset:32768
    ds_read_b128 v[236:239], v12 offset:34816
    v_mfma_f32_16x16x32_bf16 v[168:171], v[184:187], v[92:95], v[168:171]
    ds_read_b128 v[240:243], v12 offset:33792
    v_mfma_f32_16x16x32_bf16 v[172:175], v[188:191], v[92:95], v[172:175]
    ds_read_b128 v[244:247], v12 offset:35840
    v_mfma_f32_16x16x32_bf16 v[156:159], v[188:191], v[88:91], v[156:159]
    ds_read_b64_tr_b16 v[24:25], v13 offset:0
    v_mfma_f32_16x16x32_bf16 v[160:163], v[192:195], v[88:91], v[160:163]
    ds_read_b64_tr_b16 v[26:27], v13 offset:4096
    ds_read_b64_tr_b16 v[28:29], v14 offset:0
    v_mfma_f32_16x16x32_bf16 v[176:179], v[192:195], v[92:95], v[176:179]
    ds_read_b64_tr_b16 v[30:31], v14 offset:4096
    v_mfma_f32_16x16x32_bf16 v[180:183], v[196:199], v[92:95], v[180:183]
    ds_read_b64_tr_b16 v[32:33], v15 offset:0
    v_mfma_f32_16x16x32_bf16 v[164:167], v[196:199], v[88:91], v[164:167]
    ds_read_b64_tr_b16 v[34:35], v15 offset:4096
    s_waitcnt lgkmcnt(10)
    v_mfma_f32_16x16x32_bf16 v[152:155], v[200:203], v[96:99], v[152:155]
    ds_read_b64_tr_b16 v[36:37], v16 offset:0
    ds_read_b64_tr_b16 v[38:39], v16 offset:4096
    v_mfma_f32_16x16x32_bf16 v[168:171], v[200:203], v[100:103], v[168:171]
    ds_read_b64_tr_b16 v[40:41], v13 offset:8192
    v_mfma_f32_16x16x32_bf16 v[172:175], v[204:207], v[100:103], v[172:175]
    ds_read_b64_tr_b16 v[42:43], v13 offset:12288
    v_mfma_f32_16x16x32_bf16 v[156:159], v[204:207], v[96:99], v[156:159]
    ds_read_b64_tr_b16 v[44:45], v14 offset:8192
    v_mfma_f32_16x16x32_bf16 v[160:163], v[208:211], v[96:99], v[160:163]
    ds_read_b64_tr_b16 v[46:47], v14 offset:12288
    ds_read_b64_tr_b16 v[48:49], v15 offset:8192
    v_mfma_f32_16x16x32_bf16 v[176:179], v[208:211], v[100:103], v[176:179]
    ds_read_b64_tr_b16 v[50:51], v15 offset:12288
    v_mfma_f32_16x16x32_bf16 v[180:183], v[212:215], v[100:103], v[180:183]
    ds_read_b64_tr_b16 v[52:53], v16 offset:8192
    v_mfma_f32_16x16x32_bf16 v[164:167], v[212:215], v[96:99], v[164:167]
    ds_read_b64_tr_b16 v[54:55], v16 offset:12288
    s_waitcnt lgkmcnt(8)
    v_mfma_f32_16x16x32_bf16 v[152:155], v[24:27], v[232:235], v[152:155]
    ds_read_b128 v[88:91], v12 offset:36864
    ds_read_b128 v[92:95], v12 offset:38912
    v_mfma_f32_16x16x32_bf16 v[168:171], v[24:27], v[236:239], v[168:171]
    ds_read_b128 v[96:99], v12 offset:37888
    v_mfma_f32_16x16x32_bf16 v[172:175], v[28:31], v[236:239], v[172:175]
    ds_read_b128 v[100:103], v12 offset:39936
    v_mfma_f32_16x16x32_bf16 v[156:159], v[28:31], v[232:235], v[156:159]
    ds_read_b64_tr_b16 v[184:185], v13 offset:16384
    v_mfma_f32_16x16x32_bf16 v[160:163], v[32:35], v[232:235], v[160:163]
    ds_read_b64_tr_b16 v[186:187], v13 offset:20480
    ds_read_b64_tr_b16 v[188:189], v14 offset:16384
    v_mfma_f32_16x16x32_bf16 v[176:179], v[32:35], v[236:239], v[176:179]
    ds_read_b64_tr_b16 v[190:191], v14 offset:20480
    v_mfma_f32_16x16x32_bf16 v[180:183], v[36:39], v[236:239], v[180:183]
    ds_read_b64_tr_b16 v[192:193], v15 offset:16384
    v_mfma_f32_16x16x32_bf16 v[164:167], v[36:39], v[232:235], v[164:167]
    ds_read_b64_tr_b16 v[194:195], v15 offset:20480
    s_waitcnt lgkmcnt(10)
    v_mfma_f32_16x16x32_bf16 v[152:155], v[40:43], v[240:243], v[152:155]
    ds_read_b64_tr_b16 v[196:197], v16 offset:16384
    ds_read_b64_tr_b16 v[198:199], v16 offset:20480
    v_mfma_f32_16x16x32_bf16 v[168:171], v[40:43], v[244:247], v[168:171]
    ds_read_b64_tr_b16 v[200:201], v13 offset:24576
    v_mfma_f32_16x16x32_bf16 v[172:175], v[44:47], v[244:247], v[172:175]
    ds_read_b64_tr_b16 v[202:203], v13 offset:28672
    v_mfma_f32_16x16x32_bf16 v[156:159], v[44:47], v[240:243], v[156:159]
    ds_read_b64_tr_b16 v[204:205], v14 offset:24576
    v_mfma_f32_16x16x32_bf16 v[160:163], v[48:51], v[240:243], v[160:163]
    ds_read_b64_tr_b16 v[206:207], v14 offset:28672
    ds_read_b64_tr_b16 v[208:209], v15 offset:24576
    v_mfma_f32_16x16x32_bf16 v[176:179], v[48:51], v[244:247], v[176:179]
    ds_read_b64_tr_b16 v[210:211], v15 offset:28672
    v_mfma_f32_16x16x32_bf16 v[180:183], v[52:55], v[244:247], v[180:183]
    ds_read_b64_tr_b16 v[212:213], v16 offset:24576
    v_mfma_f32_16x16x32_bf16 v[164:167], v[52:55], v[240:243], v[164:167]
    ds_read_b64_tr_b16 v[214:215], v16 offset:28672
    s_waitcnt lgkmcnt(8)
    s_barrier
    v_mfma_f32_16x16x32_bf16 v[152:155], v[184:187], v[88:91], v[152:155]
    ds_read_b128 v[232:235], v12 offset:0
    ds_read_b128 v[236:239], v12 offset:2048
    v_mfma_f32_16x16x32_bf16 v[168:171], v[184:187], v[92:95], v[168:171]
    ds_read_b128 v[240:243], v12 offset:1024
    v_mfma_f32_16x16x32_bf16 v[172:175], v[188:191], v[92:95], v[172:175]
    ds_read_b128 v[244:247], v12 offset:3072
    v_mfma_f32_16x16x32_bf16 v[156:159], v[188:191], v[88:91], v[156:159]
    ds_read_b64_tr_b16 v[24:25], v13 offset:32768
    v_mfma_f32_16x16x32_bf16 v[160:163], v[192:195], v[88:91], v[160:163]
    ds_read_b64_tr_b16 v[26:27], v13 offset:36864
    ds_read_b64_tr_b16 v[28:29], v14 offset:32768
    v_mfma_f32_16x16x32_bf16 v[176:179], v[192:195], v[92:95], v[176:179]
    ds_read_b64_tr_b16 v[30:31], v14 offset:36864
    v_mfma_f32_16x16x32_bf16 v[180:183], v[196:199], v[92:95], v[180:183]
    ds_read_b64_tr_b16 v[32:33], v15 offset:32768
    v_mfma_f32_16x16x32_bf16 v[164:167], v[196:199], v[88:91], v[164:167]
    ds_read_b64_tr_b16 v[34:35], v15 offset:36864
    s_waitcnt lgkmcnt(10)
    v_mfma_f32_16x16x32_bf16 v[152:155], v[200:203], v[96:99], v[152:155]
    ds_read_b64_tr_b16 v[36:37], v16 offset:32768
    ds_read_b64_tr_b16 v[38:39], v16 offset:36864
    v_mfma_f32_16x16x32_bf16 v[168:171], v[200:203], v[100:103], v[168:171]
    ds_read_b64_tr_b16 v[40:41], v13 offset:40960
    v_mfma_f32_16x16x32_bf16 v[172:175], v[204:207], v[100:103], v[172:175]
    ds_read_b64_tr_b16 v[42:43], v13 offset:45056
    v_mfma_f32_16x16x32_bf16 v[156:159], v[204:207], v[96:99], v[156:159]
    ds_read_b64_tr_b16 v[44:45], v14 offset:40960
    v_mfma_f32_16x16x32_bf16 v[160:163], v[208:211], v[96:99], v[160:163]
    ds_read_b64_tr_b16 v[46:47], v14 offset:45056
    ds_read_b64_tr_b16 v[48:49], v15 offset:40960
    v_mfma_f32_16x16x32_bf16 v[176:179], v[208:211], v[100:103], v[176:179]
    ds_read_b64_tr_b16 v[50:51], v15 offset:45056
    v_mfma_f32_16x16x32_bf16 v[180:183], v[212:215], v[100:103], v[180:183]
    ds_read_b64_tr_b16 v[52:53], v16 offset:40960
    v_mfma_f32_16x16x32_bf16 v[164:167], v[212:215], v[96:99], v[164:167]
    ds_read_b64_tr_b16 v[54:55], v16 offset:45056
    s_waitcnt lgkmcnt(8)
    v_mfma_f32_16x16x32_bf16 v[152:155], v[24:27], v[232:235], v[152:155]
    ds_read_b128 v[88:91], v12 offset:4096
    ds_read_b128 v[92:95], v12 offset:6144
    v_mfma_f32_16x16x32_bf16 v[168:171], v[24:27], v[236:239], v[168:171]
    ds_read_b128 v[96:99], v12 offset:5120
    v_mfma_f32_16x16x32_bf16 v[172:175], v[28:31], v[236:239], v[172:175]
    ds_read_b128 v[100:103], v12 offset:7168
    v_mfma_f32_16x16x32_bf16 v[156:159], v[28:31], v[232:235], v[156:159]
    ds_read_b64_tr_b16 v[184:185], v18 offset:0
    v_mfma_f32_16x16x32_bf16 v[160:163], v[32:35], v[232:235], v[160:163]
    ds_read_b64_tr_b16 v[186:187], v18 offset:4096
    ds_read_b64_tr_b16 v[188:189], v19 offset:0
    v_mfma_f32_16x16x32_bf16 v[176:179], v[32:35], v[236:239], v[176:179]
    ds_read_b64_tr_b16 v[190:191], v19 offset:4096
    v_mfma_f32_16x16x32_bf16 v[180:183], v[36:39], v[236:239], v[180:183]
    ds_read_b64_tr_b16 v[192:193], v20 offset:0
    v_mfma_f32_16x16x32_bf16 v[164:167], v[36:39], v[232:235], v[164:167]
    ds_read_b64_tr_b16 v[194:195], v20 offset:4096
    s_waitcnt lgkmcnt(10)
    v_mfma_f32_16x16x32_bf16 v[152:155], v[40:43], v[240:243], v[152:155]
    ds_read_b64_tr_b16 v[196:197], v21 offset:0
    ds_read_b64_tr_b16 v[198:199], v21 offset:4096
    v_mfma_f32_16x16x32_bf16 v[168:171], v[40:43], v[244:247], v[168:171]
    ds_read_b64_tr_b16 v[200:201], v18 offset:8192
    v_mfma_f32_16x16x32_bf16 v[172:175], v[44:47], v[244:247], v[172:175]
    ds_read_b64_tr_b16 v[202:203], v18 offset:12288
    v_mfma_f32_16x16x32_bf16 v[156:159], v[44:47], v[240:243], v[156:159]
    ds_read_b64_tr_b16 v[204:205], v19 offset:8192
    v_mfma_f32_16x16x32_bf16 v[160:163], v[48:51], v[240:243], v[160:163]
    ds_read_b64_tr_b16 v[206:207], v19 offset:12288
    ds_read_b64_tr_b16 v[208:209], v20 offset:8192
    v_mfma_f32_16x16x32_bf16 v[176:179], v[48:51], v[244:247], v[176:179]
    ds_read_b64_tr_b16 v[210:211], v20 offset:12288
    v_mfma_f32_16x16x32_bf16 v[180:183], v[52:55], v[244:247], v[180:183]
    ds_read_b64_tr_b16 v[212:213], v21 offset:8192
    v_mfma_f32_16x16x32_bf16 v[164:167], v[52:55], v[240:243], v[164:167]
    ds_read_b64_tr_b16 v[214:215], v21 offset:12288
    s_waitcnt lgkmcnt(8)
    s_barrier
    v_mfma_f32_16x16x32_bf16 v[152:155], v[184:187], v[88:91], v[152:155]
    ds_read_b128 v[232:235], v12 offset:16384
    ds_read_b128 v[236:239], v12 offset:18432
    v_mfma_f32_16x16x32_bf16 v[168:171], v[184:187], v[92:95], v[168:171]
    ds_read_b128 v[240:243], v12 offset:17408
    v_mfma_f32_16x16x32_bf16 v[172:175], v[188:191], v[92:95], v[172:175]
    ds_read_b128 v[244:247], v12 offset:19456
    v_mfma_f32_16x16x32_bf16 v[156:159], v[188:191], v[88:91], v[156:159]
    ds_read_b64_tr_b16 v[24:25], v18 offset:16384
    v_mfma_f32_16x16x32_bf16 v[160:163], v[192:195], v[88:91], v[160:163]
    ds_read_b64_tr_b16 v[26:27], v18 offset:20480
    ds_read_b64_tr_b16 v[28:29], v19 offset:16384
    v_mfma_f32_16x16x32_bf16 v[176:179], v[192:195], v[92:95], v[176:179]
    ds_read_b64_tr_b16 v[30:31], v19 offset:20480
    v_mfma_f32_16x16x32_bf16 v[180:183], v[196:199], v[92:95], v[180:183]
    ds_read_b64_tr_b16 v[32:33], v20 offset:16384
    v_mfma_f32_16x16x32_bf16 v[164:167], v[196:199], v[88:91], v[164:167]
    ds_read_b64_tr_b16 v[34:35], v20 offset:20480
    s_waitcnt lgkmcnt(10)
    v_mfma_f32_16x16x32_bf16 v[152:155], v[200:203], v[96:99], v[152:155]
    ds_read_b64_tr_b16 v[36:37], v21 offset:16384
    ds_read_b64_tr_b16 v[38:39], v21 offset:20480
    v_mfma_f32_16x16x32_bf16 v[168:171], v[200:203], v[100:103], v[168:171]
    ds_read_b64_tr_b16 v[40:41], v18 offset:24576
    v_mfma_f32_16x16x32_bf16 v[172:175], v[204:207], v[100:103], v[172:175]
    ds_read_b64_tr_b16 v[42:43], v18 offset:28672
    v_mfma_f32_16x16x32_bf16 v[156:159], v[204:207], v[96:99], v[156:159]
    ds_read_b64_tr_b16 v[44:45], v19 offset:24576
    v_mfma_f32_16x16x32_bf16 v[160:163], v[208:211], v[96:99], v[160:163]
    ds_read_b64_tr_b16 v[46:47], v19 offset:28672
    ds_read_b64_tr_b16 v[48:49], v20 offset:24576
    v_mfma_f32_16x16x32_bf16 v[176:179], v[208:211], v[100:103], v[176:179]
    ds_read_b64_tr_b16 v[50:51], v20 offset:28672
    v_mfma_f32_16x16x32_bf16 v[180:183], v[212:215], v[100:103], v[180:183]
    ds_read_b64_tr_b16 v[52:53], v21 offset:24576
    v_mfma_f32_16x16x32_bf16 v[164:167], v[212:215], v[96:99], v[164:167]
    ds_read_b64_tr_b16 v[54:55], v21 offset:28672
    s_waitcnt lgkmcnt(8)
    v_mfma_f32_16x16x32_bf16 v[120:123], v[24:27], v[232:235], v[120:123]
    ds_read_b128 v[88:91], v12 offset:20480
    ds_read_b128 v[92:95], v12 offset:22528
    v_mfma_f32_16x16x32_bf16 v[136:139], v[24:27], v[236:239], v[136:139]
    ds_read_b128 v[96:99], v12 offset:21504
    v_mfma_f32_16x16x32_bf16 v[140:143], v[28:31], v[236:239], v[140:143]
    ds_read_b128 v[100:103], v12 offset:23552
    v_mfma_f32_16x16x32_bf16 v[124:127], v[28:31], v[232:235], v[124:127]
    ds_read_b64_tr_b16 v[184:185], v18 offset:32768
    v_and_or_b32 v152, v152, s15, v56
    v_and_or_b32 v154, v154, s15, v56
    v_and_or_b32 v156, v156, s15, v56
    v_and_or_b32 v158, v158, s15, v56
    v_cvt_pk_bf16_f32 v152, v152, v153
    v_cvt_pk_bf16_f32 v153, v154, v155
    v_cvt_pk_bf16_f32 v154, v156, v157
    v_cvt_pk_bf16_f32 v155, v158, v159
    buffer_store_dwordx4 v[152:155], v2, s[24:27], s41 offen offset:0 sc1
    v_and_or_b32 v160, v160, s15, v56
    v_and_or_b32 v162, v162, s15, v56
    v_and_or_b32 v164, v164, s15, v56
    v_and_or_b32 v166, v166, s15, v56
    v_cvt_pk_bf16_f32 v160, v160, v161
    v_cvt_pk_bf16_f32 v161, v162, v163
    v_cvt_pk_bf16_f32 v162, v164, v165
    v_cvt_pk_bf16_f32 v163, v166, v167
    buffer_store_dwordx4 v[160:163], v2, s[24:27], s41 offen offset:1024 sc1
    s_add_u32 s36, s41, 65536
    v_and_or_b32 v168, v168, s15, v56
    v_and_or_b32 v170, v170, s15, v56
    v_and_or_b32 v172, v172, s15, v56
    v_and_or_b32 v174, v174, s15, v56
    v_cvt_pk_bf16_f32 v168, v168, v169
    v_cvt_pk_bf16_f32 v169, v170, v171
    v_cvt_pk_bf16_f32 v170, v172, v173
    v_cvt_pk_bf16_f32 v171, v174, v175
    buffer_store_dwordx4 v[168:171], v2, s[24:27], s36 offen offset:0 sc1
    v_and_or_b32 v176, v176, s15, v56
    v_and_or_b32 v178, v178, s15, v56
    v_and_or_b32 v180, v180, s15, v56
    v_and_or_b32 v182, v182, s15, v56
    v_cvt_pk_bf16_f32 v176, v176, v177
    v_cvt_pk_bf16_f32 v177, v178, v179
    v_cvt_pk_bf16_f32 v178, v180, v181
    v_cvt_pk_bf16_f32 v179, v182, v183
    buffer_store_dwordx4 v[176:179], v2, s[24:27], s36 offen offset:1024 sc1
    v_mfma_f32_16x16x32_bf16 v[128:131], v[32:35], v[232:235], v[128:131]
    ds_read_b64_tr_b16 v[186:187], v18 offset:36864
    ds_read_b64_tr_b16 v[188:189], v19 offset:32768
    v_mfma_f32_16x16x32_bf16 v[144:147], v[32:35], v[236:239], v[144:147]
    ds_read_b64_tr_b16 v[190:191], v19 offset:36864
    v_mfma_f32_16x16x32_bf16 v[148:151], v[36:39], v[236:239], v[148:151]
    ds_read_b64_tr_b16 v[192:193], v20 offset:32768
    v_mfma_f32_16x16x32_bf16 v[132:135], v[36:39], v[232:235], v[132:135]
    ds_read_b64_tr_b16 v[194:195], v20 offset:36864
    s_waitcnt lgkmcnt(10)
    v_mfma_f32_16x16x32_bf16 v[120:123], v[40:43], v[240:243], v[120:123]
    ds_read_b64_tr_b16 v[196:197], v21 offset:32768
    ds_read_b64_tr_b16 v[198:199], v21 offset:36864
    v_mfma_f32_16x16x32_bf16 v[136:139], v[40:43], v[244:247], v[136:139]
    ds_read_b64_tr_b16 v[200:201], v18 offset:40960
    v_mfma_f32_16x16x32_bf16 v[140:143], v[44:47], v[244:247], v[140:143]
    ds_read_b64_tr_b16 v[202:203], v18 offset:45056
    v_mfma_f32_16x16x32_bf16 v[124:127], v[44:47], v[240:243], v[124:127]
    ds_read_b64_tr_b16 v[204:205], v19 offset:40960
    v_mfma_f32_16x16x32_bf16 v[128:131], v[48:51], v[240:243], v[128:131]
    ds_read_b64_tr_b16 v[206:207], v19 offset:45056
    ds_read_b64_tr_b16 v[208:209], v20 offset:40960
    v_mfma_f32_16x16x32_bf16 v[144:147], v[48:51], v[244:247], v[144:147]
    ds_read_b64_tr_b16 v[210:211], v20 offset:45056
    v_mfma_f32_16x16x32_bf16 v[148:151], v[52:55], v[244:247], v[148:151]
    ds_read_b64_tr_b16 v[212:213], v21 offset:40960
    v_mfma_f32_16x16x32_bf16 v[132:135], v[52:55], v[240:243], v[132:135]
    ds_read_b64_tr_b16 v[214:215], v21 offset:45056
    s_waitcnt lgkmcnt(8)
    s_barrier
    v_mfma_f32_16x16x32_bf16 v[120:123], v[184:187], v[88:91], v[120:123]
    ds_read_b128 v[232:235], v12 offset:32768
    ds_read_b128 v[236:239], v12 offset:34816
    v_mfma_f32_16x16x32_bf16 v[136:139], v[184:187], v[92:95], v[136:139]
    ds_read_b128 v[240:243], v12 offset:33792
    v_mfma_f32_16x16x32_bf16 v[140:143], v[188:191], v[92:95], v[140:143]
    ds_read_b128 v[244:247], v12 offset:35840
    v_mfma_f32_16x16x32_bf16 v[124:127], v[188:191], v[88:91], v[124:127]
    ds_read_b64_tr_b16 v[24:25], v13 offset:0
    v_mfma_f32_16x16x32_bf16 v[128:131], v[192:195], v[88:91], v[128:131]
    ds_read_b64_tr_b16 v[26:27], v13 offset:4096
    ds_read_b64_tr_b16 v[28:29], v14 offset:0
    v_mfma_f32_16x16x32_bf16 v[144:147], v[192:195], v[92:95], v[144:147]
    ds_read_b64_tr_b16 v[30:31], v14 offset:4096
    v_mfma_f32_16x16x32_bf16 v[148:151], v[196:199], v[92:95], v[148:151]
    ds_read_b64_tr_b16 v[32:33], v15 offset:0
    v_mfma_f32_16x16x32_bf16 v[132:135], v[196:199], v[88:91], v[132:135]
    ds_read_b64_tr_b16 v[34:35], v15 offset:4096
    s_waitcnt lgkmcnt(10)
    v_mfma_f32_16x16x32_bf16 v[120:123], v[200:203], v[96:99], v[120:123]
    ds_read_b64_tr_b16 v[36:37], v16 offset:0
    ds_read_b64_tr_b16 v[38:39], v16 offset:4096
    v_mfma_f32_16x16x32_bf16 v[136:139], v[200:203], v[100:103], v[136:139]
    ds_read_b64_tr_b16 v[40:41], v13 offset:8192
    v_mfma_f32_16x16x32_bf16 v[140:143], v[204:207], v[100:103], v[140:143]
    ds_read_b64_tr_b16 v[42:43], v13 offset:12288
    v_mfma_f32_16x16x32_bf16 v[124:127], v[204:207], v[96:99], v[124:127]
    ds_read_b64_tr_b16 v[44:45], v14 offset:8192
    v_mfma_f32_16x16x32_bf16 v[128:131], v[208:211], v[96:99], v[128:131]
    ds_read_b64_tr_b16 v[46:47], v14 offset:12288
    ds_read_b64_tr_b16 v[48:49], v15 offset:8192
    v_mfma_f32_16x16x32_bf16 v[144:147], v[208:211], v[100:103], v[144:147]
    ds_read_b64_tr_b16 v[50:51], v15 offset:12288
    v_mfma_f32_16x16x32_bf16 v[148:151], v[212:215], v[100:103], v[148:151]
    ds_read_b64_tr_b16 v[52:53], v16 offset:8192
    v_mfma_f32_16x16x32_bf16 v[132:135], v[212:215], v[96:99], v[132:135]
    ds_read_b64_tr_b16 v[54:55], v16 offset:12288
    s_waitcnt lgkmcnt(8)
    v_mfma_f32_16x16x32_bf16 v[120:123], v[24:27], v[232:235], v[120:123]
    ds_read_b128 v[88:91], v12 offset:36864
    ds_read_b128 v[92:95], v12 offset:38912
    v_mfma_f32_16x16x32_bf16 v[136:139], v[24:27], v[236:239], v[136:139]
    ds_read_b128 v[96:99], v12 offset:37888
    v_mfma_f32_16x16x32_bf16 v[140:143], v[28:31], v[236:239], v[140:143]
    ds_read_b128 v[100:103], v12 offset:39936
    v_mfma_f32_16x16x32_bf16 v[124:127], v[28:31], v[232:235], v[124:127]
    ds_read_b64_tr_b16 v[184:185], v13 offset:16384
    v_mfma_f32_16x16x32_bf16 v[128:131], v[32:35], v[232:235], v[128:131]
    ds_read_b64_tr_b16 v[186:187], v13 offset:20480
    ds_read_b64_tr_b16 v[188:189], v14 offset:16384
    v_mfma_f32_16x16x32_bf16 v[144:147], v[32:35], v[236:239], v[144:147]
    ds_read_b64_tr_b16 v[190:191], v14 offset:20480
    v_mfma_f32_16x16x32_bf16 v[148:151], v[36:39], v[236:239], v[148:151]
    ds_read_b64_tr_b16 v[192:193], v15 offset:16384
    v_mfma_f32_16x16x32_bf16 v[132:135], v[36:39], v[232:235], v[132:135]
    ds_read_b64_tr_b16 v[194:195], v15 offset:20480
    s_waitcnt lgkmcnt(10)
    v_mfma_f32_16x16x32_bf16 v[120:123], v[40:43], v[240:243], v[120:123]
    ds_read_b64_tr_b16 v[196:197], v16 offset:16384
    ds_read_b64_tr_b16 v[198:199], v16 offset:20480
    v_mfma_f32_16x16x32_bf16 v[136:139], v[40:43], v[244:247], v[136:139]
    ds_read_b64_tr_b16 v[200:201], v13 offset:24576
    v_mfma_f32_16x16x32_bf16 v[140:143], v[44:47], v[244:247], v[140:143]
    ds_read_b64_tr_b16 v[202:203], v13 offset:28672
    v_mfma_f32_16x16x32_bf16 v[124:127], v[44:47], v[240:243], v[124:127]
    ds_read_b64_tr_b16 v[204:205], v14 offset:24576
    v_mfma_f32_16x16x32_bf16 v[128:131], v[48:51], v[240:243], v[128:131]
    ds_read_b64_tr_b16 v[206:207], v14 offset:28672
    ds_read_b64_tr_b16 v[208:209], v15 offset:24576
    v_mfma_f32_16x16x32_bf16 v[144:147], v[48:51], v[244:247], v[144:147]
    ds_read_b64_tr_b16 v[210:211], v15 offset:28672
    v_mfma_f32_16x16x32_bf16 v[148:151], v[52:55], v[244:247], v[148:151]
    ds_read_b64_tr_b16 v[212:213], v16 offset:24576
    v_mfma_f32_16x16x32_bf16 v[132:135], v[52:55], v[240:243], v[132:135]
    ds_read_b64_tr_b16 v[214:215], v16 offset:28672
    s_waitcnt lgkmcnt(8)
    s_barrier
    v_mfma_f32_16x16x32_bf16 v[120:123], v[184:187], v[88:91], v[120:123]
    ds_read_b128 v[232:235], v12 offset:0
    ds_read_b128 v[236:239], v12 offset:2048
    v_mfma_f32_16x16x32_bf16 v[136:139], v[184:187], v[92:95], v[136:139]
    ds_read_b128 v[240:243], v12 offset:1024
    v_mfma_f32_16x16x32_bf16 v[140:143], v[188:191], v[92:95], v[140:143]
    ds_read_b128 v[244:247], v12 offset:3072
    v_mfma_f32_16x16x32_bf16 v[124:127], v[188:191], v[88:91], v[124:127]
    ds_read_b64_tr_b16 v[24:25], v13 offset:32768
    v_mfma_f32_16x16x32_bf16 v[128:131], v[192:195], v[88:91], v[128:131]
    ds_read_b64_tr_b16 v[26:27], v13 offset:36864
    ds_read_b64_tr_b16 v[28:29], v14 offset:32768
    v_mfma_f32_16x16x32_bf16 v[144:147], v[192:195], v[92:95], v[144:147]
    ds_read_b64_tr_b16 v[30:31], v14 offset:36864
    v_mfma_f32_16x16x32_bf16 v[148:151], v[196:199], v[92:95], v[148:151]
    ds_read_b64_tr_b16 v[32:33], v15 offset:32768
    v_mfma_f32_16x16x32_bf16 v[132:135], v[196:199], v[88:91], v[132:135]
    ds_read_b64_tr_b16 v[34:35], v15 offset:36864
    s_waitcnt lgkmcnt(10)
    v_mfma_f32_16x16x32_bf16 v[120:123], v[200:203], v[96:99], v[120:123]
    ds_read_b64_tr_b16 v[36:37], v16 offset:32768
    ds_read_b64_tr_b16 v[38:39], v16 offset:36864
    v_mfma_f32_16x16x32_bf16 v[136:139], v[200:203], v[100:103], v[136:139]
    ds_read_b64_tr_b16 v[40:41], v13 offset:40960
    v_mfma_f32_16x16x32_bf16 v[140:143], v[204:207], v[100:103], v[140:143]
    ds_read_b64_tr_b16 v[42:43], v13 offset:45056
    v_mfma_f32_16x16x32_bf16 v[124:127], v[204:207], v[96:99], v[124:127]
    ds_read_b64_tr_b16 v[44:45], v14 offset:40960
    v_mfma_f32_16x16x32_bf16 v[128:131], v[208:211], v[96:99], v[128:131]
    ds_read_b64_tr_b16 v[46:47], v14 offset:45056
    ds_read_b64_tr_b16 v[48:49], v15 offset:40960
    v_mfma_f32_16x16x32_bf16 v[144:147], v[208:211], v[100:103], v[144:147]
    ds_read_b64_tr_b16 v[50:51], v15 offset:45056
    v_mfma_f32_16x16x32_bf16 v[148:151], v[212:215], v[100:103], v[148:151]
    ds_read_b64_tr_b16 v[52:53], v16 offset:40960
    v_mfma_f32_16x16x32_bf16 v[132:135], v[212:215], v[96:99], v[132:135]
    ds_read_b64_tr_b16 v[54:55], v16 offset:45056
    s_waitcnt lgkmcnt(8)
    v_mfma_f32_16x16x32_bf16 v[120:123], v[24:27], v[232:235], v[120:123]
    ds_read_b128 v[88:91], v12 offset:4096
    ds_read_b128 v[92:95], v12 offset:6144
    v_mfma_f32_16x16x32_bf16 v[136:139], v[24:27], v[236:239], v[136:139]
    ds_read_b128 v[96:99], v12 offset:5120
    v_mfma_f32_16x16x32_bf16 v[140:143], v[28:31], v[236:239], v[140:143]
    ds_read_b128 v[100:103], v12 offset:7168
    v_mfma_f32_16x16x32_bf16 v[124:127], v[28:31], v[232:235], v[124:127]
    ds_read_b64_tr_b16 v[184:185], v18 offset:0
    buffer_load_dwordx4 v[152:155], v2, s[24:27], s40 offen offset:0 sc1
    buffer_load_dwordx4 v[156:159], v2, s[24:27], s40 offen offset:1024 sc1
    buffer_load_dwordx4 v[160:163], v2, s[24:27], s12 offen offset:0 sc1
    buffer_load_dwordx4 v[164:167], v2, s[24:27], s12 offen offset:1024 sc1
    v_mfma_f32_16x16x32_bf16 v[128:131], v[32:35], v[232:235], v[128:131]
    ds_read_b64_tr_b16 v[186:187], v18 offset:4096
    ds_read_b64_tr_b16 v[188:189], v19 offset:0
    v_mfma_f32_16x16x32_bf16 v[144:147], v[32:35], v[236:239], v[144:147]
    ds_read_b64_tr_b16 v[190:191], v19 offset:4096
    v_mfma_f32_16x16x32_bf16 v[148:151], v[36:39], v[236:239], v[148:151]
    ds_read_b64_tr_b16 v[192:193], v20 offset:0
    v_mfma_f32_16x16x32_bf16 v[132:135], v[36:39], v[232:235], v[132:135]
    ds_read_b64_tr_b16 v[194:195], v20 offset:4096
    s_waitcnt lgkmcnt(10)
    v_mfma_f32_16x16x32_bf16 v[120:123], v[40:43], v[240:243], v[120:123]
    ds_read_b64_tr_b16 v[196:197], v21 offset:0
    ds_read_b64_tr_b16 v[198:199], v21 offset:4096
    v_mfma_f32_16x16x32_bf16 v[136:139], v[40:43], v[244:247], v[136:139]
    ds_read_b64_tr_b16 v[200:201], v18 offset:8192
    v_mfma_f32_16x16x32_bf16 v[140:143], v[44:47], v[244:247], v[140:143]
    ds_read_b64_tr_b16 v[202:203], v18 offset:12288
    v_mfma_f32_16x16x32_bf16 v[124:127], v[44:47], v[240:243], v[124:127]
    ds_read_b64_tr_b16 v[204:205], v19 offset:8192
    v_mfma_f32_16x16x32_bf16 v[128:131], v[48:51], v[240:243], v[128:131]
    ds_read_b64_tr_b16 v[206:207], v19 offset:12288
    ds_read_b64_tr_b16 v[208:209], v20 offset:8192
    v_mfma_f32_16x16x32_bf16 v[144:147], v[48:51], v[244:247], v[144:147]
    ds_read_b64_tr_b16 v[210:211], v20 offset:12288
    v_mfma_f32_16x16x32_bf16 v[148:151], v[52:55], v[244:247], v[148:151]
    ds_read_b64_tr_b16 v[212:213], v21 offset:8192
    v_mfma_f32_16x16x32_bf16 v[132:135], v[52:55], v[240:243], v[132:135]
    ds_read_b64_tr_b16 v[214:215], v21 offset:12288
    s_waitcnt lgkmcnt(8)
    v_mfma_f32_16x16x32_bf16 v[120:123], v[184:187], v[88:91], v[120:123]
    v_mfma_f32_16x16x32_bf16 v[136:139], v[184:187], v[92:95], v[136:139]
    v_mfma_f32_16x16x32_bf16 v[140:143], v[188:191], v[92:95], v[140:143]
    v_mfma_f32_16x16x32_bf16 v[124:127], v[188:191], v[88:91], v[124:127]
    v_mfma_f32_16x16x32_bf16 v[128:131], v[192:195], v[88:91], v[128:131]
    v_mfma_f32_16x16x32_bf16 v[144:147], v[192:195], v[92:95], v[144:147]
    v_mfma_f32_16x16x32_bf16 v[148:151], v[196:199], v[92:95], v[148:151]
    v_mfma_f32_16x16x32_bf16 v[132:135], v[196:199], v[88:91], v[132:135]
    s_waitcnt lgkmcnt(0)
    s_barrier
    v_mfma_f32_16x16x32_bf16 v[120:123], v[200:203], v[96:99], v[120:123]
    v_mfma_f32_16x16x32_bf16 v[136:139], v[200:203], v[100:103], v[136:139]
    v_mfma_f32_16x16x32_bf16 v[140:143], v[204:207], v[100:103], v[140:143]
    v_mfma_f32_16x16x32_bf16 v[124:127], v[204:207], v[96:99], v[124:127]
    v_mfma_f32_16x16x32_bf16 v[128:131], v[208:211], v[96:99], v[128:131]
    v_mfma_f32_16x16x32_bf16 v[144:147], v[208:211], v[100:103], v[144:147]
    v_mfma_f32_16x16x32_bf16 v[148:151], v[212:215], v[100:103], v[148:151]
    v_mfma_f32_16x16x32_bf16 v[132:135], v[212:215], v[96:99], v[132:135]
    s_mov_b32 s53, 0
dw_23:
    s_waitcnt vmcnt(0)
    v_and_b32 v6, v152, v153
    v_and_b32 v7, v160, v161
    v_bitop3_b32 v6, v154, v155, v6 bitop3:0x80
    v_bitop3_b32 v7, v162, v163, v7 bitop3:0x80
    v_bitop3_b32 v6, v156, v157, v6 bitop3:0x80
    v_bitop3_b32 v7, v164, v165, v7 bitop3:0x80
    v_bitop3_b32 v6, v158, v159, v6 bitop3:0x80
    v_bitop3_b32 v7, v166, v167, v7 bitop3:0x80
    v_bitop3_b32 v6, v6, v7, 1 bitop3:0x80
    v_cmp_eq_u32 vcc, 0, v6
    s_nop 0
    s_cmp_eq_u64 vcc, 0
    s_cbranch_scc1 dok_24
    s_mov_b64 exec, vcc
    s_sleep 1
    buffer_load_dwordx4 v[152:155], v2, s[24:27], s40 offen offset:0 sc1
    buffer_load_dwordx4 v[156:159], v2, s[24:27], s40 offen offset:1024 sc1
    buffer_load_dwordx4 v[160:163], v2, s[24:27], s12 offen offset:0 sc1
    buffer_load_dwordx4 v[164:167], v2, s[24:27], s12 offen offset:1024 sc1
    s_add_u32 s53, s53, 1
    s_cmp_lt_u32 s53, s61
    s_cbranch_scc1 dw_23
    s_mov_b32 s61, 0
    s_waitcnt vmcnt(0)
dok_24:
    s_mov_b64 exec, -1
    v_mfma_f32_16x16x32_bf16 v[120:123], v[226:229], v[152:155], v[120:123]
    v_mfma_f32_16x16x32_bf16 v[124:127], v[224:227], v[152:155], v[124:127]
    v_mfma_f32_16x16x32_bf16 v[128:131], v[226:229], v[156:159], v[128:131]
    v_mfma_f32_16x16x32_bf16 v[132:135], v[224:227], v[156:159], v[132:135]
    v_mfma_f32_16x16x32_bf16 v[136:139], v[226:229], v[160:163], v[136:139]
    v_mfma_f32_16x16x32_bf16 v[140:143], v[224:227], v[160:163], v[140:143]
    v_mfma_f32_16x16x32_bf16 v[144:147], v[226:229], v[164:167], v[144:147]
    v_mfma_f32_16x16x32_bf16 v[148:151], v[224:227], v[164:167], v[148:151]
    s_cmp_eq_u32 s60, 1
    s_cbranch_scc1 G4_last
    v_and_or_b32 v120, v120, s15, v56
    v_and_or_b32 v122, v122, s15, v56
    v_and_or_b32 v124, v124, s15, v56
    v_and_or_b32 v126, v126, s15, v56
    v_cvt_pk_bf16_f32 v120, v120, v121
    v_cvt_pk_bf16_f32 v121, v122, v123
    v_cvt_pk_bf16_f32 v122, v124, v125
    v_cvt_pk_bf16_f32 v123, v126, v127
    buffer_store_dwordx4 v[120:123], v2, s[88:91], s40 offen offset:0 sc1
    v_and_or_b32 v128, v128, s15, v56
    v_and_or_b32 v130, v130, s15, v56
    v_and_or_b32 v132, v132, s15, v56
    v_and_or_b32 v134, v134, s15, v56
    v_cvt_pk_bf16_f32 v128, v128, v129
    v_cvt_pk_bf16_f32 v129, v130, v131
    v_cvt_pk_bf16_f32 v130, v132, v133
    v_cvt_pk_bf16_f32 v131, v134, v135
    buffer_store_dwordx4 v[128:131], v2, s[88:91], s40 offen offset:1024 sc1
    s_add_u32 s36, s40, 65536
    v_and_or_b32 v136, v136, s15, v56
    v_and_or_b32 v138, v138, s15, v56
    v_and_or_b32 v140, v140, s15, v56
    v_and_or_b32 v142, v142, s15, v56
    v_cvt_pk_bf16_f32 v136, v136, v137
    v_cvt_pk_bf16_f32 v137, v138, v139
    v_cvt_pk_bf16_f32 v138, v140, v141
    v_cvt_pk_bf16_f32 v139, v142, v143
    buffer_store_dwordx4 v[136:139], v2, s[88:91], s36 offen offset:0 sc1
    v_and_or_b32 v144, v144, s15, v56
    v_and_or_b32 v146, v146, s15, v56
    v_and_or_b32 v148, v148, s15, v56
    v_and_or_b32 v150, v150, s15, v56
    v_cvt_pk_bf16_f32 v144, v144, v145
    v_cvt_pk_bf16_f32 v145, v146, v147
    v_cvt_pk_bf16_f32 v146, v148, v149
    v_cvt_pk_bf16_f32 v147, v150, v151
    buffer_store_dwordx4 v[144:147], v2, s[88:91], s36 offen offset:1024 sc1
    v_and_b32 v81, 7, v0
    v_lshrrev_b32 v84, 6, v0
    v_lshlrev_b32 v84, 4, v84
    v_bfe_u32 v85, v0, 3, 3
    v_add_u32 v84, v84, v85
    s_lshr_b32 s78, s29, 1
    s_lshl_b32 s78, s78, 16
    s_and_b32 s79, s29, 1
    s_lshl_b32 s79, s79, 7
    s_add_u32 s78, s78, s79
    s_lshr_b32 s79, s30, 1
    s_lshl_b32 s79, s79, 13
    s_add_u32 s78, s78, s79
    v_lshlrev_b32 v78, 8, v84
    v_lshl_add_u32 v78, v81, 4, v78
    v_add_u32 v78, s78, v78
    s_lshl_b32 s78, s28, 7
    s_lshl_b32 s79, s29, 3
    s_add_u32 s78, s78, s79
    v_add_u32 v79, s78, v81
    v_lshlrev_b32 v80, 11, v79
    v_and_b32 v85, 3, v79
    v_lshrrev_b32 v82, 2, v79
    v_lshlrev_b32 v82, 14, v82
    v_lshl_add_u32 v82, v85, 11, v82
    v_lshl_add_u32 v82, v84, 4, v82
    v_lshrrev_b32 v85, 2, v84
    v_lshlrev_b32 v85, 3, v85
    v_and_b32 v84, 3, v84
    v_add_u32 v84, v84, v85
    v_lshl_add_u32 v80, v84, 3, v80
    v_lshlrev_b32 v79, 3, v79
    v_lshl_add_u32 v79, v84, 14, v79
    s_add_u32 s80, s4, 0x1800000
    s_addc_u32 s81, s5, 0
    s_mov_b32 s82, 0x400000
    s_mov_b32 s83, 0x20000
    s_mov_b32 s78, 0
    buffer_load_dwordx2 v[110:111], v79, s[80:83], s78 offen sc1
    s_mov_b32 s78, 65536
    buffer_load_dwordx2 v[112:113], v79, s[80:83], s78 offen sc1
    s_mov_b32 s78, 262144
    buffer_load_dwordx2 v[114:115], v79, s[80:83], s78 offen sc1
    s_mov_b32 s78, 327680
    buffer_load_dwordx2 v[116:117], v79, s[80:83], s78 offen sc1
    s_branch NEXT
G4_last:
    v_cvt_pk_bf16_f32 v120, v120, v121
    v_cvt_pk_bf16_f32 v121, v122, v123
    v_cvt_pk_bf16_f32 v122, v124, v125
    v_cvt_pk_bf16_f32 v123, v126, v127
    s_nop 0
    v_permlane16_swap_b32 v120, v122
    v_permlane16_swap_b32 v121, v123
    v_cvt_pk_bf16_f32 v128, v128, v129
    v_cvt_pk_bf16_f32 v129, v130, v131
    v_cvt_pk_bf16_f32 v130, v132, v133
    v_cvt_pk_bf16_f32 v131, v134, v135
    s_nop 0
    v_permlane16_swap_b32 v128, v130
    v_permlane16_swap_b32 v129, v131
    v_mov_b32 v132, v120
    v_mov_b32 v133, v121
    v_mov_b32 v134, v122
    v_mov_b32 v135, v123
    v_mov_b32_dpp v120, v128 row_ror:8 row_mask:0xf bank_mask:0xc
    v_mov_b32_dpp v121, v129 row_ror:8 row_mask:0xf bank_mask:0xc
    v_mov_b32_dpp v122, v130 row_ror:8 row_mask:0xf bank_mask:0xc
    v_mov_b32_dpp v123, v131 row_ror:8 row_mask:0xf bank_mask:0xc
    v_mov_b32_dpp v128, v132 row_ror:8 row_mask:0xf bank_mask:0x3
    v_mov_b32_dpp v129, v133 row_ror:8 row_mask:0xf bank_mask:0x3
    v_mov_b32_dpp v130, v134 row_ror:8 row_mask:0xf bank_mask:0x3
    v_mov_b32_dpp v131, v135 row_ror:8 row_mask:0xf bank_mask:0x3
    buffer_store_dwordx4 v[120:123], v10, s[20:23], s38 offen sc1
    buffer_store_dwordx4 v[128:131], v11, s[20:23], s38 offen sc1
    v_cvt_pk_bf16_f32 v136, v136, v137
    v_cvt_pk_bf16_f32 v137, v138, v139
    v_cvt_pk_bf16_f32 v138, v140, v141
    v_cvt_pk_bf16_f32 v139, v142, v143
    s_nop 0
    v_permlane16_swap_b32 v136, v138
    v_permlane16_swap_b32 v137, v139
    v_cvt_pk_bf16_f32 v144, v144, v145
    v_cvt_pk_bf16_f32 v145, v146, v147
    v_cvt_pk_bf16_f32 v146, v148, v149
    v_cvt_pk_bf16_f32 v147, v150, v151
    s_nop 0
    v_permlane16_swap_b32 v144, v146
    v_permlane16_swap_b32 v145, v147
    v_mov_b32 v148, v136
    v_mov_b32 v149, v137
    v_mov_b32 v150, v138
    v_mov_b32 v151, v139
    v_mov_b32_dpp v136, v144 row_ror:8 row_mask:0xf bank_mask:0xc
    v_mov_b32_dpp v137, v145 row_ror:8 row_mask:0xf bank_mask:0xc
    v_mov_b32_dpp v138, v146 row_ror:8 row_mask:0xf bank_mask:0xc
    v_mov_b32_dpp v139, v147 row_ror:8 row_mask:0xf bank_mask:0xc
    v_mov_b32_dpp v144, v148 row_ror:8 row_mask:0xf bank_mask:0x3
    v_mov_b32_dpp v145, v149 row_ror:8 row_mask:0xf bank_mask:0x3
    v_mov_b32_dpp v146, v150 row_ror:8 row_mask:0xf bank_mask:0x3
    v_mov_b32_dpp v147, v151 row_ror:8 row_mask:0xf bank_mask:0x3
    buffer_store_dwordx4 v[136:139], v10, s[20:23], s39 offen sc1
    buffer_store_dwordx4 v[144:147], v11, s[20:23], s39 offen sc1
    s_branch K_fin
LOADERS:
    s_mov_b64 s[80:81], s[68:69]
    s_mov_b32 s82, 2097152
    s_mov_b32 s83, 0x20000
    s_cmp_lg_u32 s60, 0
    s_cbranch_scc1 WY_1
    ds_read_b64_tr_b16 v[128:129], v74 offset:0
    ds_read_b64_tr_b16 v[130:131], v74 offset:2048
    ds_read_b64_tr_b16 v[136:137], v74 offset:4096
    ds_read_b64_tr_b16 v[138:139], v74 offset:6144
    ds_read_b64_tr_b16 v[144:145], v74 offset:8192
    ds_read_b64_tr_b16 v[146:147], v74 offset:10240
    ds_read_b64_tr_b16 v[152:153], v74 offset:12288
    ds_read_b64_tr_b16 v[154:155], v74 offset:14336
    ds_read_b64_tr_b16 v[160:161], v74 offset:16384
    ds_read_b64_tr_b16 v[162:163], v74 offset:18432
    ds_read_b64_tr_b16 v[168:169], v74 offset:20480
    ds_read_b64_tr_b16 v[170:171], v74 offset:22528
    ds_read_b64_tr_b16 v[176:177], v75 offset:16384
    ds_read_b64_tr_b16 v[178:179], v75 offset:18432
    ds_read_b64_tr_b16 v[184:185], v75 offset:20480
    ds_read_b64_tr_b16 v[186:187], v75 offset:22528
    ds_read_b64_tr_b16 v[192:193], v75 offset:24576
    ds_read_b64_tr_b16 v[194:195], v75 offset:26624
    ds_read_b64_tr_b16 v[200:201], v75 offset:28672
    ds_read_b64_tr_b16 v[202:203], v75 offset:30720
    ds_read_b64_tr_b16 v[208:209], v74 offset:32768
    ds_read_b64_tr_b16 v[210:211], v74 offset:34816
    ds_read_b64_tr_b16 v[216:217], v74 offset:36864
    ds_read_b64_tr_b16 v[218:219], v74 offset:38912
    ds_read_b64_tr_b16 v[224:225], v74 offset:40960
    ds_read_b64_tr_b16 v[226:227], v74 offset:43008
    ds_read_b64_tr_b16 v[232:233], v74 offset:45056
    ds_read_b64_tr_b16 v[234:235], v74 offset:47104
    ds_read_b64_tr_b16 v[240:241], v75 offset:32768
    ds_read_b64_tr_b16 v[242:243], v75 offset:34816
    ds_read_b64_tr_b16 v[248:249], v75 offset:36864
    ds_read_b64_tr_b16 v[250:251], v75 offset:38912
    s_branch WY_2
WY_1:
    s_and_b32 s49, s30, 3
    s_lshl_b32 s36, s49, 14
    s_lshl_b32 s48, s29, 7
    s_add_u32 s48, s48, s36
    s_lshl_b32 s49, s49, 10
    s_xor_b32 s48, s48, 128
    s_add_u32 s36, s48, 917504
    s_add_u32 m0, s49, 81920
    s_nop 0
    buffer_load_dwordx4 v118, s[80:83], s36 offen lds
    s_add_u32 s36, s36, 65536
    s_add_u32 m0, s49, 86016
    s_nop 0
    buffer_load_dwordx4 v118, s[80:83], s36 offen lds
    s_add_u32 s36, s48, 1048576
    s_add_u32 m0, s49, 90112
    s_nop 0
    buffer_load_dwordx4 v118, s[80:83], s36 offen lds
    s_add_u32 s36, s36, 65536
    s_add_u32 m0, s49, 94208
    s_nop 0
    buffer_load_dwordx4 v118, s[80:83], s36 offen lds
WY_2:
    v_and_b32 v8, 15, v1
    v_lshrrev_b32 v9, 4, v1
    s_and_b32 s34, s30, 1
    s_and_b32 s37, s30, 3
    s_lshr_b32 s38, s29, 3
    s_add_u32 s38, s38, 1
    s_sub_u32 s39, 0, s38
    s_bitcmp1_b32 s29, 2
    s_cselect_b32 s38, s38, s39
    s_lshl_b32 s35, s28, 7
    s_cmp_lt_u32 s37, 2
    s_cselect_b32 s36, s38, 0
    s_add_u32 s36, s36, s35
    s_lshl_b32 s45, s34, 6
    s_add_u32 s36, s36, s45
    v_add_u32 v72, s36, v1
    s_movk_i32 s45, 2048
    v_cmp_gt_u32 s[46:47], s45, v72
    v_lshlrev_b32 v72, 4, v72
    s_lshl_b32 s22, s60, 15
    s_add_u32 s22, s22, 23199744
    s_add_u32 s20, s4, s22
    s_addc_u32 s21, s5, 0
    s_mov_b32 s22, 32768
    s_mov_b32 s23, 0x20000
    s_lshl_b32 s36, s37, 2
    v_add_u32 v6, s36, v9
    v_xor_b32 v10, v6, v8
    s_add_u32 s36, s35, s38
    s_add_u32 s36, s36, 16
    v_add_u32 v6, s36, v6
    v_and_b32 v7, 3, v6
    v_lshrrev_b32 v11, 2, v6
    v_lshlrev_b32 v11, 14, v11
    v_lshl_add_u32 v11, v7, 11, v11
    v_lshl_add_u32 v11, v10, 4, v11
    v_subrev_u32 v10, 65536, v11
    s_lshl_b32 s44, s37, 10
    s_lshl_b32 s14, s60, 24
    s_lshl_b32 s15, s94, 13
    s_add_u32 s14, s14, s15
    s_add_u32 s14, s14, 167772160
    s_add_u32 s12, s4, s14
    s_addc_u32 s13, s5, 0
    s_mov_b32 s14, 8380416
    s_mov_b32 s15, 0x20000
    s_cmp_lg_u32 s60, 0
    s_waitcnt vmcnt(4)
    s_cbranch_scc1 WY_6
    s_waitcnt vmcnt(0) lgkmcnt(0)
    s_barrier
    s_and_b32 s49, s30, 3
    s_lshl_b32 s36, s49, 14
    s_lshl_b32 s48, s29, 7
    s_add_u32 s48, s48, s36
    s_lshl_b32 s49, s49, 10
    s_xor_b32 s48, s48, 128
    s_add_u32 s36, s48, 917504
    s_add_u32 m0, s49, 81920
    s_nop 0
    buffer_load_dwordx4 v118, s[80:83], s36 offen lds
    s_add_u32 s36, s36, 65536
    s_add_u32 m0, s49, 86016
    s_nop 0
    buffer_load_dwordx4 v118, s[80:83], s36 offen lds
    s_add_u32 s36, s48, 1048576
    s_add_u32 m0, s49, 90112
    s_nop 0
    buffer_load_dwordx4 v118, s[80:83], s36 offen lds
    s_add_u32 s36, s36, 65536
    s_add_u32 m0, s49, 94208
    s_nop 0
    buffer_load_dwordx4 v118, s[80:83], s36 offen lds
    s_branch WY_7
WY_6:
    s_barrier
WY_7:
    s_add_u32 s36, s48, 131072
    s_add_u32 m0, s49, 32768
    s_nop 0
    buffer_load_dwordx4 v118, s[80:83], s36 offen lds
    s_add_u32 s36, s36, 65536
    s_add_u32 m0, s49, 36864
    s_nop 0
    buffer_load_dwordx4 v118, s[80:83], s36 offen lds
    s_add_u32 s36, s48, 262144
    s_add_u32 m0, s49, 40960
    s_nop 0
    buffer_load_dwordx4 v118, s[80:83], s36 offen lds
    s_add_u32 s36, s36, 65536
    s_add_u32 m0, s49, 45056
    s_nop 0
    buffer_load_dwordx4 v118, s[80:83], s36 offen lds
    s_add_u32 s36, s48, 1179648
    s_add_u32 m0, s49, 98304
    s_nop 0
    buffer_load_dwordx4 v118, s[80:83], s36 offen lds
    s_add_u32 s36, s36, 65536
    s_add_u32 m0, s49, 102400
    s_nop 0
    buffer_load_dwordx4 v118, s[80:83], s36 offen lds
    s_add_u32 s36, s48, 1310720
    s_add_u32 m0, s49, 106496
    s_nop 0
    buffer_load_dwordx4 v118, s[80:83], s36 offen lds
    s_add_u32 s36, s36, 65536
    s_add_u32 m0, s49, 110592
    s_nop 0
    buffer_load_dwordx4 v118, s[80:83], s36 offen lds
    v_lshrrev_b32 v6, 3, v1
    v_and_b32 v17, 7, v1
    v_xor_b32 v17, v17, v6
    s_lshl_b32 s36, s37, 3
    s_add_u32 s36, s36, s35
    v_add_u32 v6, s36, v6
    v_and_b32 v7, 3, v6
    v_lshrrev_b32 v12, 2, v6
    v_lshlrev_b32 v12, 14, v12
    v_lshl_add_u32 v12, v7, 11, v12
    s_lshl_b32 s36, s29, 7
    v_lshl_add_u32 v12, v17, 4, v12
    v_add_u32 v12, s36, v12
    v_lshrrev_b32 v6, 1, v9
    s_lshl_b32 s36, s37, 1
    v_add_u32 v6, s36, v6
    v_and_b32 v7, 7, v8
    v_xor_b32 v6, v6, v7
    v_lshlrev_b32 v17, 7, v8
    v_lshl_add_u32 v17, v6, 4, v17
    v_and_b32 v6, 1, v9
    v_lshl_add_u32 v17, v6, 3, v17
    v_and_b32 v6, 1, v9
    v_lshlrev_b32 v13, 16, v6
    v_lshrrev_b32 v6, 1, v9
    v_lshl_add_u32 v13, v6, 8, v13
    v_lshl_add_u32 v13, v8, 4, v13
    s_bfe_u32 s36, s30, 0x10001
    s_lshl1_add_u32 s36, s29, s36
    s_lshr_b32 s53, s36, 3
    s_lshl_b32 s53, s53, 14
    s_and_b32 s39, s36, 7
    s_lshl_b32 s39, s39, 10
    s_add_u32 s39, s39, s53
    s_and_b32 s36, s30, 1
    s_lshl_b32 s36, s36, 9
    s_add_u32 s39, s39, s36
    v_mov_b32 v14, v2
    v_add_u32 v15, 106496, v2
    v_lshrrev_b32 v6, 5, v13
    v_and_b32 v6, 2048, v6
    v_and_b32 v16, 511, v13
    v_add_u32 v16, v16, v6
    s_lshl_b32 s36, s37, 9
    v_add_u32 v16, s36, v16
    s_add_u32 s16, s62, 0x400000
    s_addc_u32 s17, s63, 0
    s_mov_b32 s18, 0x7e000
    s_mov_b32 s19, 0x20000
    s_add_u32 s24, s62, 0x480000
    s_addc_u32 s25, s63, 0
    s_mov_b32 s26, 0x7e000
    s_mov_b32 s27, 0x20000
    s_and_b32 s78, s30, 3
    s_lshl_b32 s78, s78, 15
    s_and_b32 s53, s30, 2
    s_lshl_b32 s53, s53, 11
    s_and_b32 s82, s30, 1
    s_lshl_b32 s82, s82, 13
    s_add_u32 s82, s82, s53
    s_and_b32 s84, s30, 1
    s_lshl_b32 s84, s84, 8
    s_add_u32 s84, s84, s55
    s_add_u32 s85, s52, 16
    s_mov_b64 s[8:9], s[72:73]
    s_mov_b32 s10, 7340032
    s_mov_b32 s11, 0x20000
    s_add_u32 s89, s29, 1
    s_and_b32 s89, s89, 15
    s_cmp_lg_u32 s28, s29
    s_cselect_b32 s89, s28, s89
    s_and_b32 s90, s30, 3
    s_mul_i32 s36, s29, 448
    s_lshl2_add_u32 s88, s29, s90
    s_mul_i32 s88, s88, 114688
    s_add_u32 s88, s88, s36
    s_lshl2_add_u32 s89, s89, s90
    s_mul_i32 s89, s89, 114688
    s_add_u32 s89, s89, s36
    s_mul_i32 s90, s90, 7168
    s_waitcnt vmcnt(0) lgkmcnt(0)
    s_setprio 1
    s_add_u32 m0, s44, 122880
    s_mov_b32 s49, 0
    s_barrier
    buffer_load_dwordx4 v[52:55], v72, s[20:23], 0 offen sc1
    buffer_load_dwordx4 v10, s[12:15], s49 offen offset:0 sc1 lds
    s_add_u32 m0, s44, 130048
    s_nop 0
    buffer_load_dwordx4 v10, s[12:15], s49 offen offset:1024 sc1 lds
    s_add_u32 m0, s44, 126976
    s_nop 0
    buffer_load_dwordx4 v11, s[12:15], s49 offen offset:0 sc1 lds
    s_add_u32 m0, s44, 134144
    s_nop 0
    buffer_load_dwordx4 v11, s[12:15], s49 offen offset:1024 sc1 lds
    s_add_u32 m0, s44, 139264
    s_mov_b32 s49, 256
    buffer_load_dwordx4 v10, s[12:15], s49 offen offset:0 sc1 lds
    s_add_u32 m0, s44, 146432
    s_nop 0
    buffer_load_dwordx4 v10, s[12:15], s49 offen offset:1024 sc1 lds
    s_add_u32 m0, s44, 143360
    s_nop 0
    buffer_load_dwordx4 v11, s[12:15], s49 offen offset:0 sc1 lds
    s_add_u32 m0, s44, 150528
    s_nop 0
    buffer_load_dwordx4 v11, s[12:15], s49 offen offset:1024 sc1 lds
    s_add_u32 m0, s44, 16384
    s_mov_b32 s49, 512
    buffer_load_dwordx4 v10, s[12:15], s49 offen offset:0 sc1 lds
    s_add_u32 m0, s44, 23552
    s_nop 0
    buffer_load_dwordx4 v10, s[12:15], s49 offen offset:1024 sc1 lds
    s_add_u32 m0, s44, 20480
    s_nop 0
    buffer_load_dwordx4 v11, s[12:15], s49 offen offset:0 sc1 lds
    s_add_u32 m0, s44, 27648
    s_nop 0
    buffer_load_dwordx4 v11, s[12:15], s49 offen offset:1024 sc1 lds
    s_add_u32 m0, s44, 32768
    s_mov_b32 s49, 768
    s_waitcnt vmcnt(8)
    s_barrier
    buffer_load_dwordx4 v10, s[12:15], s49 offen offset:0 sc1 lds
    s_add_u32 m0, s44, 39936
    s_nop 0
    buffer_load_dwordx4 v10, s[12:15], s49 offen offset:1024 sc1 lds
    s_add_u32 m0, s44, 36864
    s_nop 0
    buffer_load_dwordx4 v11, s[12:15], s49 offen offset:0 sc1 lds
    s_add_u32 m0, s44, 44032
    s_nop 0
    buffer_load_dwordx4 v11, s[12:15], s49 offen offset:1024 sc1 lds
    v_mov_b32 v10, v11
    v_add_u32 v11, 65536, v11
    s_mov_b32 s53, 0
lns_25:
    v_cmp_eq_u32 vcc, s52, v53
    v_cmp_eq_u32 s[50:51], s52, v55
    s_nop 0
    s_and_b64 vcc, vcc, s[50:51]
    s_orn2_b64 vcc, vcc, s[46:47]
    s_cmp_eq_u64 vcc, -1
    s_cbranch_scc1 lnk_26
    buffer_load_dwordx4 v[52:55], v72, s[20:23], 0 offen sc1
    s_waitcnt vmcnt(0)
    s_add_u32 s53, s53, 1
    s_cmp_lt_u32 s53, s61
    s_cbranch_scc1 lns_25
    s_mov_b32 s61, 0
lnk_26:
    v_lshlrev_b32 v56, 16, v52
    v_and_b32 v57, 0xffff0000, v52
    v_lshlrev_b32 v58, 16, v54
    v_and_b32 v59, 0xffff0000, v54
    v_cndmask_b32 v57, 1.0, v57, s[46:47]
    v_cndmask_b32 v59, 1.0, v59, s[46:47]
    s_lshl_b32 s36, s34, 10
    s_add_u32 s36, s36, 155648
    v_add_u32 v6, s36, v2
    s_cmp_ge_u32 s37, 2
    s_cbranch_scc1 lnx_27
    v_mul_f32 v66, v57, v59
    v_fma_f32 v60, -v58, v57, -v56
    v_rcp_f32 v7, v66
    v_mov_b32 v67, v66
    v_mov_b32 v61, v60
    v_mul_f32 v62, 0xc0135761, v7
    v_mul_f32 v7, v7, v7
    v_mov_b32 v63, v62
    v_mul_f32 v7, 0x3d372713, v7
    v_mul_f32 v64, v7, v62
    v_mov_b32 v65, v64
    ds_write_b128 v6, v[60:63] offset:0
    ds_write_b128 v6, v[64:67] offset:2048
    s_branch lnd_28
lnx_27:
    v_rcp_f32 v60, v57
    s_nop 0
    v_mul_f32 v62, -v56, v60
    v_mov_b32 v61, v60
    v_mov_b32 v63, v62
    ds_write_b128 v6, v[60:63] offset:5120
lnd_28:
    v_lshlrev_b32 v7, 4, v8
    v_add_u32 v7, 160768, v7
    s_add_u32 m0, s44, 106496
    s_mov_b32 s49, 65536
    s_waitcnt vmcnt(8)
    s_barrier
    buffer_load_dwordx4 v10, s[12:15], s49 offen offset:0 sc1 lds
    s_add_u32 m0, s44, 113664
    s_nop 0
    buffer_load_dwordx4 v10, s[12:15], s49 offen offset:1024 sc1 lds
    s_add_u32 m0, s44, 110592
    s_nop 0
    buffer_load_dwordx4 v11, s[12:15], s49 offen offset:0 sc1 lds
    s_add_u32 m0, s44, 117760
    s_nop 0
    buffer_load_dwordx4 v11, s[12:15], s49 offen offset:1024 sc1 lds
    s_add_u32 m0, s44, 122880
    s_mov_b32 s49, 65792
    s_waitcnt vmcnt(8)
    s_barrier
    buffer_load_dwordx4 v10, s[12:15], s49 offen offset:0 sc1 lds
    s_add_u32 m0, s44, 130048
    s_nop 0
    buffer_load_dwordx4 v10, s[12:15], s49 offen offset:1024 sc1 lds
    s_add_u32 m0, s44, 126976
    s_nop 0
    buffer_load_dwordx4 v11, s[12:15], s49 offen offset:0 sc1 lds
    s_add_u32 m0, s44, 134144
    s_nop 0
    buffer_load_dwordx4 v11, s[12:15], s49 offen offset:1024 sc1 lds
    s_add_u32 m0, s44, 139264
    s_mov_b32 s49, 66048
    s_waitcnt vmcnt(8)
    s_barrier
    buffer_load_dwordx4 v10, s[12:15], s49 offen offset:0 sc1 lds
    s_add_u32 m0, s44, 146432
    s_nop 0
    buffer_load_dwordx4 v10, s[12:15], s49 offen offset:1024 sc1 lds
    s_add_u32 m0, s44, 143360
    s_nop 0
    buffer_load_dwordx4 v11, s[12:15], s49 offen offset:0 sc1 lds
    s_add_u32 m0, s44, 150528
    s_nop 0
    buffer_load_dwordx4 v11, s[12:15], s49 offen offset:1024 sc1 lds
    s_waitcnt lgkmcnt(0)
    s_add_u32 m0, s44, 16384
    s_mov_b32 s49, 66304
    s_waitcnt vmcnt(8)
    s_barrier
    buffer_load_dwordx4 v10, s[12:15], s49 offen offset:0 sc1 lds
    s_add_u32 m0, s44, 23552
    s_nop 0
    buffer_load_dwordx4 v10, s[12:15], s49 offen offset:1024 sc1 lds
    s_add_u32 m0, s44, 20480
    s_nop 0
    buffer_load_dwordx4 v11, s[12:15], s49 offen offset:0 sc1 lds
    s_add_u32 m0, s44, 27648
    s_nop 0
    buffer_load_dwordx4 v11, s[12:15], s49 offen offset:1024 sc1 lds
    s_add_u32 m0, s44, 0
    s_mov_b32 s36, 0
    buffer_load_dwordx4 v12, s[12:15], s36 offen sc1 lds
    s_add_u32 m0, s44, 4096
    s_mov_b32 s36, 131072
    buffer_load_dwordx4 v12, s[12:15], s36 offen sc1 lds
    s_add_u32 m0, s44, 8192
    s_mov_b32 s36, 262144
    buffer_load_dwordx4 v12, s[12:15], s36 offen sc1 lds
    s_add_u32 m0, s44, 12288
    s_mov_b32 s36, 393216
    buffer_load_dwordx4 v12, s[12:15], s36 offen sc1 lds
    s_add_u32 m0, s90, 77824
    s_nop 0
    buffer_load_dwordx4 v121, s[8:11], s89 offen lds
    s_add_u32 m0, s90, 78848
    s_nop 0
    buffer_load_dwordx4 v122, s[8:11], s89 offen lds
    s_add_u32 m0, s44, 32768
    s_mov_b32 s49, 196608
    s_waitcnt vmcnt(14)
    s_barrier
    buffer_load_dwordx4 v10, s[12:15], s49 offen offset:0 sc1 lds
    s_add_u32 m0, s44, 39936
    s_nop 0
    buffer_load_dwordx4 v10, s[12:15], s49 offen offset:1024 sc1 lds
    s_add_u32 m0, s44, 36864
    s_nop 0
    buffer_load_dwordx4 v11, s[12:15], s49 offen offset:0 sc1 lds
    s_add_u32 m0, s44, 44032
    s_nop 0
    buffer_load_dwordx4 v11, s[12:15], s49 offen offset:1024 sc1 lds
    s_add_u32 m0, s44, 106496
    s_mov_b32 s49, 196864
    s_waitcnt vmcnt(14)
    s_barrier
    buffer_load_dwordx4 v10, s[12:15], s49 offen offset:0 sc1 lds
    s_add_u32 m0, s44, 113664
    s_nop 0
    buffer_load_dwordx4 v10, s[12:15], s49 offen offset:1024 sc1 lds
    s_add_u32 m0, s44, 110592
    s_nop 0
    buffer_load_dwordx4 v11, s[12:15], s49 offen offset:0 sc1 lds
    s_add_u32 m0, s44, 117760
    s_nop 0
    buffer_load_dwordx4 v11, s[12:15], s49 offen offset:1024 sc1 lds
    s_add_u32 m0, s44, 122880
    s_mov_b32 s49, 197120
    s_waitcnt vmcnt(10)
    s_barrier
    buffer_load_dwordx4 v10, s[12:15], s49 offen offset:0 sc1 lds
    s_add_u32 m0, s44, 130048
    s_nop 0
    buffer_load_dwordx4 v10, s[12:15], s49 offen offset:1024 sc1 lds
    s_add_u32 m0, s44, 126976
    s_nop 0
    buffer_load_dwordx4 v11, s[12:15], s49 offen offset:0 sc1 lds
    s_add_u32 m0, s44, 134144
    s_nop 0
    buffer_load_dwordx4 v11, s[12:15], s49 offen offset:1024 sc1 lds
    ds_read_b64 v[22:23], v17 offset:0
    ds_read_b128 v[60:63], v7 offset:0
    ds_read_b64 v[26:27], v17 offset:2048
    ds_read_b128 v[64:67], v7 offset:256
    s_add_u32 m0, s44, 139264
    s_mov_b32 s49, 197376
    s_waitcnt vmcnt(8)
    s_barrier
    buffer_load_dwordx4 v10, s[12:15], s49 offen offset:0 sc1 lds
    s_waitcnt lgkmcnt(0)
    v_lshlrev_b32 v20, 16, v22
    v_and_b32 v21, 0xffff0000, v22
    v_lshlrev_b32 v22, 16, v23
    v_and_b32 v23, 0xffff0000, v23
    s_add_u32 m0, s44, 146432
    s_nop 0
    buffer_load_dwordx4 v10, s[12:15], s49 offen offset:1024 sc1 lds
    v_pk_fma_f32 v[20:21], v[20:21], v[60:61], v[62:63]
    v_pk_fma_f32 v[22:23], v[22:23], v[60:61], v[62:63]
    v_lshlrev_b32 v24, 16, v26
    v_and_b32 v25, 0xffff0000, v26
    v_lshlrev_b32 v26, 16, v27
    s_add_u32 m0, s44, 143360
    s_nop 0
    buffer_load_dwordx4 v11, s[12:15], s49 offen offset:0 sc1 lds
    v_and_b32 v27, 0xffff0000, v27
    v_pk_fma_f32 v[24:25], v[24:25], v[64:65], v[66:67]
    v_pk_fma_f32 v[26:27], v[26:27], v[64:65], v[66:67]
    s_add_u32 m0, s44, 150528
    s_nop 0
    buffer_load_dwordx4 v11, s[12:15], s49 offen offset:1024 sc1 lds
    ds_read_b64 v[30:31], v17 offset:4096
    ds_read_b128 v[60:63], v7 offset:512
    ds_read_b64 v[34:35], v17 offset:6144
    ds_read_b128 v[64:67], v7 offset:768
    s_add_u32 m0, s90, 79872
    s_nop 0
    buffer_load_dwordx4 v123, s[8:11], s89 offen lds
    s_add_u32 m0, s90, 80896
    s_nop 0
    buffer_load_dwordx4 v124, s[8:11], s89 offen lds
    s_add_u32 m0, s90, 81920
    s_nop 0
    buffer_load_dwordx4 v125, s[8:11], s89 offen lds
    s_add_u32 m0, s90, 82944
    s_nop 0
    buffer_load_dwordx4 v126, s[8:11], s89 offen lds
    s_add_u32 m0, s90, 83968
    s_nop 0
    buffer_load_dwordx4 v127, s[8:11], s89 offen lds
    s_add_u32 m0, s90, 49152
    s_nop 0
    buffer_load_dwordx4 v121, s[8:11], s88 offen lds
    s_add_u32 m0, s44, 16384
    s_mov_b32 s49, 327680
    s_waitcnt vmcnt(14)
    s_barrier
    buffer_load_dwordx4 v10, s[12:15], s49 offen offset:0 sc1 lds
    s_waitcnt lgkmcnt(0)
    v_lshlrev_b32 v28, 16, v30
    v_and_b32 v29, 0xffff0000, v30
    v_lshlrev_b32 v30, 16, v31
    v_and_b32 v31, 0xffff0000, v31
    s_add_u32 m0, s44, 23552
    s_nop 0
    buffer_load_dwordx4 v10, s[12:15], s49 offen offset:1024 sc1 lds
    v_pk_fma_f32 v[28:29], v[28:29], v[60:61], v[62:63]
    v_pk_fma_f32 v[30:31], v[30:31], v[60:61], v[62:63]
    v_lshlrev_b32 v32, 16, v34
    v_and_b32 v33, 0xffff0000, v34
    v_lshlrev_b32 v34, 16, v35
    s_add_u32 m0, s44, 20480
    s_nop 0
    buffer_load_dwordx4 v11, s[12:15], s49 offen offset:0 sc1 lds
    v_and_b32 v35, 0xffff0000, v35
    v_pk_fma_f32 v[32:33], v[32:33], v[64:65], v[66:67]
    v_pk_fma_f32 v[34:35], v[34:35], v[64:65], v[66:67]
    s_add_u32 m0, s44, 27648
    s_nop 0
    buffer_load_dwordx4 v11, s[12:15], s49 offen offset:1024 sc1 lds
    ds_read_b64 v[38:39], v17 offset:8192
    ds_read_b128 v[60:63], v7 offset:1024
    ds_read_b64 v[42:43], v17 offset:10240
    ds_read_b128 v[64:67], v7 offset:1280
    s_add_u32 m0, s44, 32768
    s_mov_b32 s49, 327936
    s_waitcnt vmcnt(14)
    s_barrier
    buffer_load_dwordx4 v10, s[12:15], s49 offen offset:0 sc1 lds
    s_waitcnt lgkmcnt(0)
    v_lshlrev_b32 v36, 16, v38
    v_and_b32 v37, 0xffff0000, v38
    v_lshlrev_b32 v38, 16, v39
    v_and_b32 v39, 0xffff0000, v39
    s_add_u32 m0, s44, 39936
    s_nop 0
    buffer_load_dwordx4 v10, s[12:15], s49 offen offset:1024 sc1 lds
    v_pk_fma_f32 v[36:37], v[36:37], v[60:61], v[62:63]
    v_pk_fma_f32 v[38:39], v[38:39], v[60:61], v[62:63]
    v_lshlrev_b32 v40, 16, v42
    v_and_b32 v41, 0xffff0000, v42
    v_lshlrev_b32 v42, 16, v43
    s_add_u32 m0, s44, 36864
    s_nop 0
    buffer_load_dwordx4 v11, s[12:15], s49 offen offset:0 sc1 lds
    v_and_b32 v43, 0xffff0000, v43
    v_pk_fma_f32 v[40:41], v[40:41], v[64:65], v[66:67]
    v_pk_fma_f32 v[42:43], v[42:43], v[64:65], v[66:67]
    s_add_u32 m0, s44, 44032
    s_nop 0
    buffer_load_dwordx4 v11, s[12:15], s49 offen offset:1024 sc1 lds
    ds_read_b64 v[46:47], v17 offset:12288
    ds_read_b128 v[60:63], v7 offset:1536
    ds_read_b64 v[50:51], v17 offset:14336
    ds_read_b128 v[64:67], v7 offset:1792
    s_add_u32 m0, s44, 106496
    s_mov_b32 s49, 328192
    s_waitcnt vmcnt(14)
    s_barrier
    buffer_load_dwordx4 v10, s[12:15], s49 offen offset:0 sc1 lds
    s_waitcnt lgkmcnt(0)
    v_lshlrev_b32 v44, 16, v46
    v_and_b32 v45, 0xffff0000, v46
    v_lshlrev_b32 v46, 16, v47
    v_and_b32 v47, 0xffff0000, v47
    s_add_u32 m0, s44, 113664
    s_nop 0
    buffer_load_dwordx4 v10, s[12:15], s49 offen offset:1024 sc1 lds
    v_pk_fma_f32 v[44:45], v[44:45], v[60:61], v[62:63]
    v_pk_fma_f32 v[46:47], v[46:47], v[60:61], v[62:63]
    v_lshlrev_b32 v48, 16, v50
    v_and_b32 v49, 0xffff0000, v50
    v_lshlrev_b32 v50, 16, v51
    s_add_u32 m0, s44, 110592
    s_nop 0
    buffer_load_dwordx4 v11, s[12:15], s49 offen offset:0 sc1 lds
    v_and_b32 v51, 0xffff0000, v51
    v_pk_fma_f32 v[48:49], v[48:49], v[64:65], v[66:67]
    v_pk_fma_f32 v[50:51], v[50:51], v[64:65], v[66:67]
    s_add_u32 m0, s44, 117760
    s_nop 0
    buffer_load_dwordx4 v11, s[12:15], s49 offen offset:1024 sc1 lds
    s_add_u32 m0, s44, 122880
    s_mov_b32 s49, 328448
    s_waitcnt vmcnt(8)
    s_barrier
    s_load_dword s32, s[4:5], s84 offset:2048
    s_load_dword s3, s[4:5], s84 offset:2176
    buffer_load_dwordx4 v10, s[12:15], s49 offen offset:0 sc1 lds
    s_add_u32 m0, s44, 130048
    s_nop 0
    buffer_load_dwordx4 v10, s[12:15], s49 offen offset:1024 sc1 lds
    s_add_u32 m0, s44, 126976
    s_nop 0
    buffer_load_dwordx4 v11, s[12:15], s49 offen offset:0 sc1 lds
    s_add_u32 m0, s44, 134144
    s_nop 0
    buffer_load_dwordx4 v11, s[12:15], s49 offen offset:1024 sc1 lds
    s_add_u32 m0, s90, 50176
    s_nop 0
    buffer_load_dwordx4 v122, s[8:11], s88 offen lds
    s_add_u32 m0, s90, 51200
    s_nop 0
    buffer_load_dwordx4 v123, s[8:11], s88 offen lds
    s_add_u32 m0, s90, 52224
    s_nop 0
    buffer_load_dwordx4 v124, s[8:11], s88 offen lds
    s_add_u32 m0, s90, 53248
    s_nop 0
    buffer_load_dwordx4 v125, s[8:11], s88 offen lds
    s_add_u32 m0, s90, 54272
    s_nop 0
    buffer_load_dwordx4 v126, s[8:11], s88 offen lds
    s_add_u32 m0, s90, 55296
    s_nop 0
    buffer_load_dwordx4 v127, s[8:11], s88 offen lds
    s_add_u32 m0, s82, 139264
    s_add_u32 s49, s78, 0
    s_waitcnt vmcnt(14)
    s_barrier
    s_waitcnt lgkmcnt(0)
    s_cmp_eq_u32 s32, s85
    s_cselect_b32 s32, s3, 0
    s_cmp_eq_u32 s32, s85
    s_cbranch_scc1 hok_29
    s_add_u32 s53, s84, 2048
    v_lshlrev_b32 v109, 7, v1
    v_add_u32 v109, s53, v109
    s_mov_b32 s53, 0
    s_add_u32 s54, s52, 16
    s_bfm_b64 exec, 2, 0
poll_30:
    buffer_load_dword v108, v109, s[56:59], 0 offen sc1
    s_waitcnt vmcnt(0)
    v_cmp_eq_u32 vcc, s54, v108
    s_nop 0
    s_cmp_eq_u64 vcc, exec
    s_cbranch_scc1 pok_31
    s_sleep 8
    s_add_u32 s53, s53, 1
    s_cmp_lt_u32 s53, s61
    s_cbranch_scc1 poll_30
    s_mov_b32 s61, 0
pok_31:
    s_mov_b64 exec, -1
hok_29:
    buffer_load_dwordx4 v2, s[16:19], s49 offen offset:0 sc1 lds
    buffer_load_dwordx4 v2, s[16:19], s49 offen offset:1024 sc1 lds
    buffer_load_dwordx4 v2, s[16:19], s49 offen offset:2048 sc1 lds
    buffer_load_dwordx4 v2, s[16:19], s49 offen offset:3072 sc1 lds
    s_add_u32 m0, s82, 16384
    s_add_u32 s49, s78, 4096
    s_waitcnt vmcnt(14)
    s_barrier
    buffer_load_dwordx4 v2, s[16:19], s49 offen offset:0 sc1 lds
    buffer_load_dwordx4 v2, s[16:19], s49 offen offset:1024 sc1 lds
    buffer_load_dwordx4 v2, s[16:19], s49 offen offset:2048 sc1 lds
    buffer_load_dwordx4 v2, s[16:19], s49 offen offset:3072 sc1 lds
    s_add_u32 m0, s82, 32768
    s_add_u32 s49, s78, 16384
    s_waitcnt vmcnt(14)
    s_barrier
    buffer_load_dwordx4 v2, s[16:19], s49 offen offset:0 sc1 lds
    buffer_load_dwordx4 v2, s[16:19], s49 offen offset:1024 sc1 lds
    buffer_load_dwordx4 v2, s[16:19], s49 offen offset:2048 sc1 lds
    buffer_load_dwordx4 v2, s[16:19], s49 offen offset:3072 sc1 lds
    s_setprio 0
    s_waitcnt vmcnt(8)
    s_barrier
    ds_read_b128 v[52:55], v15 offset:32768
    ds_read_b128 v[56:59], v15 offset:36864
    ds_read_b128 v[60:63], v15 offset:40960
    ds_read_b128 v[64:67], v15 offset:45056
    ds_read_b128 v[68:71], v15 offset:33792
    ds_read_b128 v[72:75], v15 offset:37888
    ds_read_b128 v[76:79], v15 offset:41984
    ds_read_b128 v[80:83], v15 offset:46080
    s_waitcnt lgkmcnt(4)
    v_mfma_f32_16x16x32_bf16 v[20:23], v[128:131], v[52:55], v[20:23]
    ds_read_b128 v[84:87], v15 offset:34816
    v_mfma_f32_16x16x32_bf16 v[24:27], v[128:131], v[56:59], v[24:27]
    ds_read_b128 v[88:91], v15 offset:38912
    v_mfma_f32_16x16x32_bf16 v[24:27], v[132:135], v[64:67], v[24:27]
    ds_read_b128 v[92:95], v15 offset:43008
    v_mfma_f32_16x16x32_bf16 v[20:23], v[132:135], v[60:63], v[20:23]
    ds_read_b128 v[96:99], v15 offset:47104
    s_waitcnt lgkmcnt(4)
    v_mfma_f32_16x16x32_bf16 v[20:23], v[136:139], v[68:71], v[20:23]
    ds_read_b128 v[52:55], v15 offset:35840
    v_mfma_f32_16x16x32_bf16 v[24:27], v[136:139], v[72:75], v[24:27]
    ds_read_b128 v[56:59], v15 offset:39936
    v_mfma_f32_16x16x32_bf16 v[24:27], v[140:143], v[80:83], v[24:27]
    ds_read_b128 v[60:63], v15 offset:44032
    v_mfma_f32_16x16x32_bf16 v[20:23], v[140:143], v[76:79], v[20:23]
    ds_read_b128 v[64:67], v15 offset:48128
    s_waitcnt vmcnt(4)
    s_barrier
    s_waitcnt lgkmcnt(4)
    v_mfma_f32_16x16x32_bf16 v[20:23], v[144:147], v[84:87], v[20:23]
    ds_read_b128 v[68:71], v14 offset:16384
    v_mfma_f32_16x16x32_bf16 v[24:27], v[144:147], v[88:91], v[24:27]
    ds_read_b128 v[72:75], v14 offset:20480
    v_mfma_f32_16x16x32_bf16 v[24:27], v[148:151], v[96:99], v[24:27]
    ds_read_b128 v[76:79], v14 offset:24576
    v_mfma_f32_16x16x32_bf16 v[20:23], v[148:151], v[92:95], v[20:23]
    ds_read_b128 v[80:83], v14 offset:28672
    s_waitcnt lgkmcnt(4)
    v_mfma_f32_16x16x32_bf16 v[20:23], v[152:155], v[52:55], v[20:23]
    ds_read_b128 v[84:87], v14 offset:17408
    v_mfma_f32_16x16x32_bf16 v[24:27], v[152:155], v[56:59], v[24:27]
    ds_read_b128 v[88:91], v14 offset:21504
    v_mfma_f32_16x16x32_bf16 v[24:27], v[156:159], v[64:67], v[24:27]
    ds_read_b128 v[92:95], v14 offset:25600
    v_mfma_f32_16x16x32_bf16 v[20:23], v[156:159], v[60:63], v[20:23]
    ds_read_b128 v[96:99], v14 offset:29696
    s_waitcnt lgkmcnt(4)
    v_mfma_f32_16x16x32_bf16 v[20:23], v[160:163], v[68:71], v[20:23]
    ds_read_b128 v[52:55], v14 offset:18432
    v_mfma_f32_16x16x32_bf16 v[24:27], v[160:163], v[72:75], v[24:27]
    ds_read_b128 v[56:59], v14 offset:22528
    v_mfma_f32_16x16x32_bf16 v[24:27], v[164:167], v[80:83], v[24:27]
    ds_read_b128 v[60:63], v14 offset:26624
    v_mfma_f32_16x16x32_bf16 v[20:23], v[164:167], v[76:79], v[20:23]
    ds_read_b128 v[64:67], v14 offset:30720
    s_waitcnt lgkmcnt(4)
    v_mfma_f32_16x16x32_bf16 v[20:23], v[168:171], v[84:87], v[20:23]
    ds_read_b128 v[68:71], v14 offset:19456
    v_mfma_f32_16x16x32_bf16 v[24:27], v[168:171], v[88:91], v[24:27]
    ds_read_b128 v[72:75], v14 offset:23552
    v_mfma_f32_16x16x32_bf16 v[24:27], v[172:175], v[96:99], v[24:27]
    ds_read_b128 v[76:79], v14 offset:27648
    v_mfma_f32_16x16x32_bf16 v[20:23], v[172:175], v[92:95], v[20:23]
    ds_read_b128 v[80:83], v14 offset:31744
    s_waitcnt vmcnt(0)
    s_barrier
    s_waitcnt lgkmcnt(4)
    v_mfma_f32_16x16x32_bf16 v[20:23], v[176:179], v[52:55], v[20:23]
    ds_read_b128 v[84:87], v14 offset:32768
    v_mfma_f32_16x16x32_bf16 v[24:27], v[176:179], v[56:59], v[24:27]
    ds_read_b128 v[88:91], v14 offset:36864
    v_mfma_f32_16x16x32_bf16 v[24:27], v[180:183], v[64:67], v[24:27]
    ds_read_b128 v[92:95], v14 offset:40960
    v_mfma_f32_16x16x32_bf16 v[20:23], v[180:183], v[60:63], v[20:23]
    ds_read_b128 v[96:99], v14 offset:45056
    s_waitcnt lgkmcnt(4)
    v_mfma_f32_16x16x32_bf16 v[20:23], v[184:187], v[68:71], v[20:23]
    ds_read_b128 v[52:55], v14 offset:33792
    v_mfma_f32_16x16x32_bf16 v[24:27], v[184:187], v[72:75], v[24:27]
    ds_read_b128 v[56:59], v14 offset:37888
    v_mfma_f32_16x16x32_bf16 v[24:27], v[188:191], v[80:83], v[24:27]
    ds_read_b128 v[60:63], v14 offset:41984
    v_mfma_f32_16x16x32_bf16 v[20:23], v[188:191], v[76:79], v[20:23]
    ds_read_b128 v[64:67], v14 offset:46080
    s_waitcnt lgkmcnt(4)
    v_mfma_f32_16x16x32_bf16 v[20:23], v[192:195], v[84:87], v[20:23]
    ds_read_b128 v[68:71], v14 offset:34816
    v_mfma_f32_16x16x32_bf16 v[24:27], v[192:195], v[88:91], v[24:27]
    ds_read_b128 v[72:75], v14 offset:38912
    v_mfma_f32_16x16x32_bf16 v[24:27], v[196:199], v[96:99], v[24:27]
    ds_read_b128 v[76:79], v14 offset:43008
    v_mfma_f32_16x16x32_bf16 v[20:23], v[196:199], v[92:95], v[20:23]
    ds_read_b128 v[80:83], v14 offset:47104
    s_waitcnt lgkmcnt(4)
    v_mfma_f32_16x16x32_bf16 v[20:23], v[200:203], v[52:55], v[20:23]
    ds_read_b128 v[84:87], v14 offset:35840
    v_mfma_f32_16x16x32_bf16 v[24:27], v[200:203], v[56:59], v[24:27]
    ds_read_b128 v[88:91], v14 offset:39936
    v_mfma_f32_16x16x32_bf16 v[24:27], v[204:207], v[64:67], v[24:27]
    ds_read_b128 v[92:95], v14 offset:44032
    v_mfma_f32_16x16x32_bf16 v[20:23], v[204:207], v[60:63], v[20:23]
    ds_read_b128 v[96:99], v14 offset:48128
    s_barrier
    s_waitcnt lgkmcnt(4)
    v_mfma_f32_16x16x32_bf16 v[20:23], v[208:211], v[68:71], v[20:23]
    ds_read_b128 v[52:55], v15 offset:0
    v_mfma_f32_16x16x32_bf16 v[24:27], v[208:211], v[72:75], v[24:27]
    ds_read_b128 v[56:59], v15 offset:4096
    v_mfma_f32_16x16x32_bf16 v[24:27], v[212:215], v[80:83], v[24:27]
    ds_read_b128 v[60:63], v15 offset:8192
    v_mfma_f32_16x16x32_bf16 v[20:23], v[212:215], v[76:79], v[20:23]
    ds_read_b128 v[64:67], v15 offset:12288
    s_waitcnt lgkmcnt(4)
    v_mfma_f32_16x16x32_bf16 v[20:23], v[216:219], v[84:87], v[20:23]
    ds_read_b128 v[68:71], v15 offset:1024
    v_mfma_f32_16x16x32_bf16 v[24:27], v[216:219], v[88:91], v[24:27]
    ds_read_b128 v[72:75], v15 offset:5120
    v_mfma_f32_16x16x32_bf16 v[24:27], v[220:223], v[96:99], v[24:27]
    ds_read_b128 v[76:79], v15 offset:9216
    v_mfma_f32_16x16x32_bf16 v[20:23], v[220:223], v[92:95], v[20:23]
    ds_read_b128 v[80:83], v15 offset:13312
    s_waitcnt lgkmcnt(4)
    v_mfma_f32_16x16x32_bf16 v[20:23], v[224:227], v[52:55], v[20:23]
    ds_read_b128 v[84:87], v15 offset:2048
    v_mfma_f32_16x16x32_bf16 v[24:27], v[224:227], v[56:59], v[24:27]
    ds_read_b128 v[88:91], v15 offset:6144
    v_mfma_f32_16x16x32_bf16 v[24:27], v[228:231], v[64:67], v[24:27]
    ds_read_b128 v[92:95], v15 offset:10240
    v_mfma_f32_16x16x32_bf16 v[20:23], v[228:231], v[60:63], v[20:23]
    ds_read_b128 v[96:99], v15 offset:14336
    s_waitcnt lgkmcnt(4)
    v_mfma_f32_16x16x32_bf16 v[20:23], v[232:235], v[68:71], v[20:23]
    ds_read_b128 v[52:55], v15 offset:3072
    v_mfma_f32_16x16x32_bf16 v[24:27], v[232:235], v[72:75], v[24:27]
    ds_read_b128 v[56:59], v15 offset:7168
    v_mfma_f32_16x16x32_bf16 v[24:27], v[236:239], v[80:83], v[24:27]
    ds_read_b128 v[60:63], v15 offset:11264
    v_mfma_f32_16x16x32_bf16 v[20:23], v[236:239], v[76:79], v[20:23]
    ds_read_b128 v[64:67], v15 offset:15360
    s_barrier
    s_waitcnt lgkmcnt(4)
    v_mfma_f32_16x16x32_bf16 v[20:23], v[240:243], v[84:87], v[20:23]
    ds_read_b128 v[68:71], v15 offset:16384
    v_mfma_f32_16x16x32_bf16 v[24:27], v[240:243], v[88:91], v[24:27]
    ds_read_b128 v[72:75], v15 offset:20480
    v_mfma_f32_16x16x32_bf16 v[24:27], v[244:247], v[96:99], v[24:27]
    ds_read_b128 v[76:79], v15 offset:24576
    v_mfma_f32_16x16x32_bf16 v[20:23], v[244:247], v[92:95], v[20:23]
    ds_read_b128 v[80:83], v15 offset:28672
    s_waitcnt lgkmcnt(4)
    v_mfma_f32_16x16x32_bf16 v[20:23], v[248:251], v[52:55], v[20:23]
    ds_read_b128 v[84:87], v15 offset:17408
    v_mfma_f32_16x16x32_bf16 v[24:27], v[248:251], v[56:59], v[24:27]
    ds_read_b128 v[88:91], v15 offset:21504
    v_mfma_f32_16x16x32_bf16 v[24:27], v[252:255], v[64:67], v[24:27]
    ds_read_b128 v[92:95], v15 offset:25600
    v_mfma_f32_16x16x32_bf16 v[20:23], v[252:255], v[60:63], v[20:23]
    ds_read_b128 v[96:99], v15 offset:29696
    s_waitcnt lgkmcnt(4)
    v_mfma_f32_16x16x32_bf16 v[28:31], v[128:131], v[68:71], v[28:31]
    ds_read_b128 v[52:55], v15 offset:18432
    v_mfma_f32_16x16x32_bf16 v[32:35], v[128:131], v[72:75], v[32:35]
    ds_read_b128 v[56:59], v15 offset:22528
    v_mfma_f32_16x16x32_bf16 v[32:35], v[132:135], v[80:83], v[32:35]
    ds_read_b128 v[60:63], v15 offset:26624
    v_mfma_f32_16x16x32_bf16 v[28:31], v[132:135], v[76:79], v[28:31]
    ds_read_b128 v[64:67], v15 offset:30720
    v_add_u32 v20, 0x10000, v20
    v_add_u32 v22, 0x10000, v22
    v_add_u32 v24, 0x10000, v24
    v_add_u32 v26, 0x10000, v26
    v_and_b32 v20, 0xfffe0000, v20
    v_and_b32 v22, 0xfffe0000, v22
    v_and_b32 v24, 0xfffe0000, v24
    v_and_b32 v26, 0xfffe0000, v26
    v_cvt_pk_bf16_f32 v20, v20, v21
    v_cvt_pk_bf16_f32 v21, v22, v23
    v_cvt_pk_bf16_f32 v22, v24, v25
    v_cvt_pk_bf16_f32 v23, v26, v27
    s_add_u32 s36, s39, 0
    v_permlane16_swap_b32 v20, v22
    v_permlane16_swap_b32 v21, v23
    s_waitcnt lgkmcnt(4)
    v_mfma_f32_16x16x32_bf16 v[28:31], v[136:139], v[84:87], v[28:31]
    ds_read_b128 v[68:71], v15 offset:19456
    v_mfma_f32_16x16x32_bf16 v[32:35], v[136:139], v[88:91], v[32:35]
    ds_read_b128 v[72:75], v15 offset:23552
    v_mfma_f32_16x16x32_bf16 v[32:35], v[140:143], v[96:99], v[32:35]
    ds_read_b128 v[76:79], v15 offset:27648
    v_mfma_f32_16x16x32_bf16 v[28:31], v[140:143], v[92:95], v[28:31]
    ds_read_b128 v[80:83], v15 offset:31744
    s_barrier
    s_waitcnt lgkmcnt(4)
    v_mfma_f32_16x16x32_bf16 v[28:31], v[144:147], v[52:55], v[28:31]
    ds_read_b128 v[84:87], v15 offset:32768
    v_mfma_f32_16x16x32_bf16 v[32:35], v[144:147], v[56:59], v[32:35]
    ds_read_b128 v[88:91], v15 offset:36864
    v_mfma_f32_16x16x32_bf16 v[32:35], v[148:151], v[64:67], v[32:35]
    ds_read_b128 v[92:95], v15 offset:40960
    v_mfma_f32_16x16x32_bf16 v[28:31], v[148:151], v[60:63], v[28:31]
    ds_read_b128 v[96:99], v15 offset:45056
    s_waitcnt lgkmcnt(4)
    v_mfma_f32_16x16x32_bf16 v[28:31], v[152:155], v[68:71], v[28:31]
    ds_read_b128 v[52:55], v15 offset:33792
    v_mfma_f32_16x16x32_bf16 v[32:35], v[152:155], v[72:75], v[32:35]
    ds_read_b128 v[56:59], v15 offset:37888
    v_mfma_f32_16x16x32_bf16 v[32:35], v[156:159], v[80:83], v[32:35]
    ds_read_b128 v[60:63], v15 offset:41984
    v_mfma_f32_16x16x32_bf16 v[28:31], v[156:159], v[76:79], v[28:31]
    ds_read_b128 v[64:67], v15 offset:46080
    s_waitcnt lgkmcnt(4)
    v_mfma_f32_16x16x32_bf16 v[28:31], v[160:163], v[84:87], v[28:31]
    ds_read_b128 v[68:71], v15 offset:34816
    v_mfma_f32_16x16x32_bf16 v[32:35], v[160:163], v[88:91], v[32:35]
    ds_read_b128 v[72:75], v15 offset:38912
    v_mfma_f32_16x16x32_bf16 v[32:35], v[164:167], v[96:99], v[32:35]
    ds_read_b128 v[76:79], v15 offset:43008
    v_mfma_f32_16x16x32_bf16 v[28:31], v[164:167], v[92:95], v[28:31]
    ds_read_b128 v[80:83], v15 offset:47104
    s_waitcnt lgkmcnt(4)
    v_mfma_f32_16x16x32_bf16 v[28:31], v[168:171], v[52:55], v[28:31]
    ds_read_b128 v[84:87], v15 offset:35840
    v_mfma_f32_16x16x32_bf16 v[32:35], v[168:171], v[56:59], v[32:35]
    ds_read_b128 v[88:91], v15 offset:39936
    v_mfma_f32_16x16x32_bf16 v[32:35], v[172:175], v[64:67], v[32:35]
    ds_read_b128 v[92:95], v15 offset:44032
    v_mfma_f32_16x16x32_bf16 v[28:31], v[172:175], v[60:63], v[28:31]
    ds_read_b128 v[96:99], v15 offset:48128
    s_barrier
    s_waitcnt lgkmcnt(4)
    v_mfma_f32_16x16x32_bf16 v[28:31], v[176:179], v[68:71], v[28:31]
    ds_read_b128 v[52:55], v14 offset:16384
    v_mfma_f32_16x16x32_bf16 v[32:35], v[176:179], v[72:75], v[32:35]
    ds_read_b128 v[56:59], v14 offset:20480
    v_mfma_f32_16x16x32_bf16 v[32:35], v[180:183], v[80:83], v[32:35]
    ds_read_b128 v[60:63], v14 offset:24576
    v_mfma_f32_16x16x32_bf16 v[28:31], v[180:183], v[76:79], v[28:31]
    ds_read_b128 v[64:67], v14 offset:28672
    s_waitcnt lgkmcnt(4)
    v_mfma_f32_16x16x32_bf16 v[28:31], v[184:187], v[84:87], v[28:31]
    ds_read_b128 v[68:71], v14 offset:17408
    v_mfma_f32_16x16x32_bf16 v[32:35], v[184:187], v[88:91], v[32:35]
    ds_read_b128 v[72:75], v14 offset:21504
    v_mfma_f32_16x16x32_bf16 v[32:35], v[188:191], v[96:99], v[32:35]
    ds_read_b128 v[76:79], v14 offset:25600
    v_mfma_f32_16x16x32_bf16 v[28:31], v[188:191], v[92:95], v[28:31]
    ds_read_b128 v[80:83], v14 offset:29696
    s_waitcnt lgkmcnt(4)
    v_mfma_f32_16x16x32_bf16 v[28:31], v[192:195], v[52:55], v[28:31]
    ds_read_b128 v[84:87], v14 offset:18432
    v_mfma_f32_16x16x32_bf16 v[32:35], v[192:195], v[56:59], v[32:35]
    ds_read_b128 v[88:91], v14 offset:22528
    v_mfma_f32_16x16x32_bf16 v[32:35], v[196:199], v[64:67], v[32:35]
    ds_read_b128 v[92:95], v14 offset:26624
    v_mfma_f32_16x16x32_bf16 v[28:31], v[196:199], v[60:63], v[28:31]
    ds_read_b128 v[96:99], v14 offset:30720
    s_waitcnt lgkmcnt(4)
    v_mfma_f32_16x16x32_bf16 v[28:31], v[200:203], v[68:71], v[28:31]
    ds_read_b128 v[52:55], v14 offset:19456
    v_mfma_f32_16x16x32_bf16 v[32:35], v[200:203], v[72:75], v[32:35]
    ds_read_b128 v[56:59], v14 offset:23552
    v_mfma_f32_16x16x32_bf16 v[32:35], v[204:207], v[80:83], v[32:35]
    ds_read_b128 v[60:63], v14 offset:27648
    v_mfma_f32_16x16x32_bf16 v[28:31], v[204:207], v[76:79], v[28:31]
    ds_read_b128 v[64:67], v14 offset:31744
    s_barrier
    s_waitcnt lgkmcnt(4)
    v_mfma_f32_16x16x32_bf16 v[28:31], v[208:211], v[84:87], v[28:31]
    ds_read_b128 v[68:71], v14 offset:32768
    v_mfma_f32_16x16x32_bf16 v[32:35], v[208:211], v[88:91], v[32:35]
    ds_read_b128 v[72:75], v14 offset:36864
    v_mfma_f32_16x16x32_bf16 v[32:35], v[212:215], v[96:99], v[32:35]
    ds_read_b128 v[76:79], v14 offset:40960
    v_mfma_f32_16x16x32_bf16 v[28:31], v[212:215], v[92:95], v[28:31]
    ds_read_b128 v[80:83], v14 offset:45056
    s_waitcnt lgkmcnt(4)
    v_mfma_f32_16x16x32_bf16 v[28:31], v[216:219], v[52:55], v[28:31]
    ds_read_b128 v[84:87], v14 offset:33792
    v_mfma_f32_16x16x32_bf16 v[32:35], v[216:219], v[56:59], v[32:35]
    ds_read_b128 v[88:91], v14 offset:37888
    v_mfma_f32_16x16x32_bf16 v[32:35], v[220:223], v[64:67], v[32:35]
    ds_read_b128 v[92:95], v14 offset:41984
    v_mfma_f32_16x16x32_bf16 v[28:31], v[220:223], v[60:63], v[28:31]
    ds_read_b128 v[96:99], v14 offset:46080
    s_waitcnt lgkmcnt(4)
    v_mfma_f32_16x16x32_bf16 v[28:31], v[224:227], v[68:71], v[28:31]
    ds_read_b128 v[52:55], v14 offset:34816
    v_mfma_f32_16x16x32_bf16 v[32:35], v[224:227], v[72:75], v[32:35]
    ds_read_b128 v[56:59], v14 offset:38912
    v_mfma_f32_16x16x32_bf16 v[32:35], v[228:231], v[80:83], v[32:35]
    ds_read_b128 v[60:63], v14 offset:43008
    v_mfma_f32_16x16x32_bf16 v[28:31], v[228:231], v[76:79], v[28:31]
    ds_read_b128 v[64:67], v14 offset:47104
    s_waitcnt lgkmcnt(4)
    v_mfma_f32_16x16x32_bf16 v[28:31], v[232:235], v[84:87], v[28:31]
    ds_read_b128 v[68:71], v14 offset:35840
    v_mfma_f32_16x16x32_bf16 v[32:35], v[232:235], v[88:91], v[32:35]
    ds_read_b128 v[72:75], v14 offset:39936
    v_mfma_f32_16x16x32_bf16 v[32:35], v[236:239], v[96:99], v[32:35]
    ds_read_b128 v[76:79], v14 offset:44032
    v_mfma_f32_16x16x32_bf16 v[28:31], v[236:239], v[92:95], v[28:31]
    ds_read_b128 v[80:83], v14 offset:48128
    s_barrier
    s_waitcnt lgkmcnt(4)
    v_mfma_f32_16x16x32_bf16 v[28:31], v[240:243], v[52:55], v[28:31]
    ds_read_b128 v[84:87], v15 offset:0
    v_mfma_f32_16x16x32_bf16 v[32:35], v[240:243], v[56:59], v[32:35]
    ds_read_b128 v[88:91], v15 offset:4096
    v_mfma_f32_16x16x32_bf16 v[32:35], v[244:247], v[64:67], v[32:35]
    ds_read_b128 v[92:95], v15 offset:8192
    v_mfma_f32_16x16x32_bf16 v[28:31], v[244:247], v[60:63], v[28:31]
    ds_read_b128 v[96:99], v15 offset:12288
    s_waitcnt lgkmcnt(4)
    v_mfma_f32_16x16x32_bf16 v[28:31], v[248:251], v[68:71], v[28:31]
    ds_read_b128 v[52:55], v15 offset:1024
    v_mfma_f32_16x16x32_bf16 v[32:35], v[248:251], v[72:75], v[32:35]
    ds_read_b128 v[56:59], v15 offset:5120
    v_mfma_f32_16x16x32_bf16 v[32:35], v[252:255], v[80:83], v[32:35]
    ds_read_b128 v[60:63], v15 offset:9216
    v_mfma_f32_16x16x32_bf16 v[28:31], v[252:255], v[76:79], v[28:31]
    ds_read_b128 v[64:67], v15 offset:13312
    s_waitcnt lgkmcnt(4)
    v_mfma_f32_16x16x32_bf16 v[36:39], v[128:131], v[84:87], v[36:39]
    ds_read_b128 v[68:71], v15 offset:2048
    v_mfma_f32_16x16x32_bf16 v[40:43], v[128:131], v[88:91], v[40:43]
    ds_read_b128 v[72:75], v15 offset:6144
    v_mfma_f32_16x16x32_bf16 v[40:43], v[132:135], v[96:99], v[40:43]
    ds_read_b128 v[76:79], v15 offset:10240
    v_mfma_f32_16x16x32_bf16 v[36:39], v[132:135], v[92:95], v[36:39]
    ds_read_b128 v[80:83], v15 offset:14336
    v_add_u32 v28, 0x10000, v28
    v_add_u32 v30, 0x10000, v30
    v_add_u32 v32, 0x10000, v32
    v_add_u32 v34, 0x10000, v34
    v_and_b32 v28, 0xfffe0000, v28
    v_and_b32 v30, 0xfffe0000, v30
    v_and_b32 v32, 0xfffe0000, v32
    v_and_b32 v34, 0xfffe0000, v34
    v_cvt_pk_bf16_f32 v28, v28, v29
    v_cvt_pk_bf16_f32 v29, v30, v31
    v_cvt_pk_bf16_f32 v30, v32, v33
    v_cvt_pk_bf16_f32 v31, v34, v35
    s_add_u32 s36, s39, 131072
    v_permlane16_swap_b32 v28, v30
    v_permlane16_swap_b32 v29, v31
    s_waitcnt lgkmcnt(4)
    v_mfma_f32_16x16x32_bf16 v[36:39], v[136:139], v[52:55], v[36:39]
    ds_read_b128 v[84:87], v15 offset:3072
    v_mfma_f32_16x16x32_bf16 v[40:43], v[136:139], v[56:59], v[40:43]
    ds_read_b128 v[88:91], v15 offset:7168
    v_mfma_f32_16x16x32_bf16 v[40:43], v[140:143], v[64:67], v[40:43]
    ds_read_b128 v[92:95], v15 offset:11264
    v_mfma_f32_16x16x32_bf16 v[36:39], v[140:143], v[60:63], v[36:39]
    ds_read_b128 v[96:99], v15 offset:15360
    s_barrier
    s_waitcnt lgkmcnt(4)
    v_mfma_f32_16x16x32_bf16 v[36:39], v[144:147], v[68:71], v[36:39]
    ds_read_b128 v[52:55], v15 offset:16384
    v_mfma_f32_16x16x32_bf16 v[40:43], v[144:147], v[72:75], v[40:43]
    ds_read_b128 v[56:59], v15 offset:20480
    v_mfma_f32_16x16x32_bf16 v[40:43], v[148:151], v[80:83], v[40:43]
    ds_read_b128 v[60:63], v15 offset:24576
    v_mfma_f32_16x16x32_bf16 v[36:39], v[148:151], v[76:79], v[36:39]
    ds_read_b128 v[64:67], v15 offset:28672
    s_waitcnt lgkmcnt(4)
    v_mfma_f32_16x16x32_bf16 v[36:39], v[152:155], v[84:87], v[36:39]
    ds_read_b128 v[68:71], v15 offset:17408
    v_mfma_f32_16x16x32_bf16 v[40:43], v[152:155], v[88:91], v[40:43]
    ds_read_b128 v[72:75], v15 offset:21504
    v_mfma_f32_16x16x32_bf16 v[40:43], v[156:159], v[96:99], v[40:43]
    ds_read_b128 v[76:79], v15 offset:25600
    v_mfma_f32_16x16x32_bf16 v[36:39], v[156:159], v[92:95], v[36:39]
    ds_read_b128 v[80:83], v15 offset:29696
    s_waitcnt lgkmcnt(4)
    v_mfma_f32_16x16x32_bf16 v[36:39], v[160:163], v[52:55], v[36:39]
    ds_read_b128 v[84:87], v15 offset:18432
    v_mfma_f32_16x16x32_bf16 v[40:43], v[160:163], v[56:59], v[40:43]
    ds_read_b128 v[88:91], v15 offset:22528
    v_mfma_f32_16x16x32_bf16 v[40:43], v[164:167], v[64:67], v[40:43]
    ds_read_b128 v[92:95], v15 offset:26624
    v_mfma_f32_16x16x32_bf16 v[36:39], v[164:167], v[60:63], v[36:39]
    ds_read_b128 v[96:99], v15 offset:30720
    s_waitcnt lgkmcnt(4)
    v_mfma_f32_16x16x32_bf16 v[36:39], v[168:171], v[68:71], v[36:39]
    ds_read_b128 v[52:55], v15 offset:19456
    v_mfma_f32_16x16x32_bf16 v[40:43], v[168:171], v[72:75], v[40:43]
    ds_read_b128 v[56:59], v15 offset:23552
    v_mfma_f32_16x16x32_bf16 v[40:43], v[172:175], v[80:83], v[40:43]
    ds_read_b128 v[60:63], v15 offset:27648
    v_mfma_f32_16x16x32_bf16 v[36:39], v[172:175], v[76:79], v[36:39]
    ds_read_b128 v[64:67], v15 offset:31744
    s_barrier
    s_waitcnt lgkmcnt(4)
    v_mfma_f32_16x16x32_bf16 v[36:39], v[176:179], v[84:87], v[36:39]
    ds_read_b128 v[68:71], v15 offset:32768
    v_mfma_f32_16x16x32_bf16 v[40:43], v[176:179], v[88:91], v[40:43]
    ds_read_b128 v[72:75], v15 offset:36864
    v_mfma_f32_16x16x32_bf16 v[40:43], v[180:183], v[96:99], v[40:43]
    ds_read_b128 v[76:79], v15 offset:40960
    v_mfma_f32_16x16x32_bf16 v[36:39], v[180:183], v[92:95], v[36:39]
    ds_read_b128 v[80:83], v15 offset:45056
    s_waitcnt lgkmcnt(4)
    v_mfma_f32_16x16x32_bf16 v[36:39], v[184:187], v[52:55], v[36:39]
    ds_read_b128 v[84:87], v15 offset:33792
    v_mfma_f32_16x16x32_bf16 v[40:43], v[184:187], v[56:59], v[40:43]
    ds_read_b128 v[88:91], v15 offset:37888
    v_mfma_f32_16x16x32_bf16 v[40:43], v[188:191], v[64:67], v[40:43]
    ds_read_b128 v[92:95], v15 offset:41984
    v_mfma_f32_16x16x32_bf16 v[36:39], v[188:191], v[60:63], v[36:39]
    ds_read_b128 v[96:99], v15 offset:46080
    s_waitcnt lgkmcnt(4)
    v_mfma_f32_16x16x32_bf16 v[36:39], v[192:195], v[68:71], v[36:39]
    ds_read_b128 v[52:55], v15 offset:34816
    v_mfma_f32_16x16x32_bf16 v[40:43], v[192:195], v[72:75], v[40:43]
    ds_read_b128 v[56:59], v15 offset:38912
    v_mfma_f32_16x16x32_bf16 v[40:43], v[196:199], v[80:83], v[40:43]
    ds_read_b128 v[60:63], v15 offset:43008
    v_mfma_f32_16x16x32_bf16 v[36:39], v[196:199], v[76:79], v[36:39]
    ds_read_b128 v[64:67], v15 offset:47104
    s_waitcnt lgkmcnt(4)
    v_mfma_f32_16x16x32_bf16 v[36:39], v[200:203], v[84:87], v[36:39]
    ds_read_b128 v[68:71], v15 offset:35840
    v_mfma_f32_16x16x32_bf16 v[40:43], v[200:203], v[88:91], v[40:43]
    ds_read_b128 v[72:75], v15 offset:39936
    v_mfma_f32_16x16x32_bf16 v[40:43], v[204:207], v[96:99], v[40:43]
    ds_read_b128 v[76:79], v15 offset:44032
    v_mfma_f32_16x16x32_bf16 v[36:39], v[204:207], v[92:95], v[36:39]
    ds_read_b128 v[80:83], v15 offset:48128
    s_barrier
    s_waitcnt lgkmcnt(4)
    v_mfma_f32_16x16x32_bf16 v[36:39], v[208:211], v[52:55], v[36:39]
    ds_read_b128 v[84:87], v14 offset:16384
    v_mfma_f32_16x16x32_bf16 v[40:43], v[208:211], v[56:59], v[40:43]
    ds_read_b128 v[88:91], v14 offset:20480
    v_mfma_f32_16x16x32_bf16 v[40:43], v[212:215], v[64:67], v[40:43]
    ds_read_b128 v[92:95], v14 offset:24576
    v_mfma_f32_16x16x32_bf16 v[36:39], v[212:215], v[60:63], v[36:39]
    ds_read_b128 v[96:99], v14 offset:28672
    s_waitcnt lgkmcnt(4)
    v_mfma_f32_16x16x32_bf16 v[36:39], v[216:219], v[68:71], v[36:39]
    ds_read_b128 v[52:55], v14 offset:17408
    v_mfma_f32_16x16x32_bf16 v[40:43], v[216:219], v[72:75], v[40:43]
    ds_read_b128 v[56:59], v14 offset:21504
    v_mfma_f32_16x16x32_bf16 v[40:43], v[220:223], v[80:83], v[40:43]
    ds_read_b128 v[60:63], v14 offset:25600
    v_mfma_f32_16x16x32_bf16 v[36:39], v[220:223], v[76:79], v[36:39]
    ds_read_b128 v[64:67], v14 offset:29696
    s_waitcnt lgkmcnt(4)
    v_mfma_f32_16x16x32_bf16 v[36:39], v[224:227], v[84:87], v[36:39]
    ds_read_b128 v[68:71], v14 offset:18432
    v_mfma_f32_16x16x32_bf16 v[40:43], v[224:227], v[88:91], v[40:43]
    ds_read_b128 v[72:75], v14 offset:22528
    v_mfma_f32_16x16x32_bf16 v[40:43], v[228:231], v[96:99], v[40:43]
    ds_read_b128 v[76:79], v14 offset:26624
    v_mfma_f32_16x16x32_bf16 v[36:39], v[228:231], v[92:95], v[36:39]
    ds_read_b128 v[80:83], v14 offset:30720
    s_waitcnt lgkmcnt(4)
    v_mfma_f32_16x16x32_bf16 v[36:39], v[232:235], v[52:55], v[36:39]
    ds_read_b128 v[84:87], v14 offset:19456
    v_mfma_f32_16x16x32_bf16 v[40:43], v[232:235], v[56:59], v[40:43]
    ds_read_b128 v[88:91], v14 offset:23552
    v_mfma_f32_16x16x32_bf16 v[40:43], v[236:239], v[64:67], v[40:43]
    ds_read_b128 v[92:95], v14 offset:27648
    v_mfma_f32_16x16x32_bf16 v[36:39], v[236:239], v[60:63], v[36:39]
    ds_read_b128 v[96:99], v14 offset:31744
    s_barrier
    s_waitcnt lgkmcnt(4)
    v_mfma_f32_16x16x32_bf16 v[36:39], v[240:243], v[68:71], v[36:39]
    ds_read_b128 v[52:55], v14 offset:32768
    v_mfma_f32_16x16x32_bf16 v[40:43], v[240:243], v[72:75], v[40:43]
    ds_read_b128 v[56:59], v14 offset:36864
    v_mfma_f32_16x16x32_bf16 v[40:43], v[244:247], v[80:83], v[40:43]
    ds_read_b128 v[60:63], v14 offset:40960
    v_mfma_f32_16x16x32_bf16 v[36:39], v[244:247], v[76:79], v[36:39]
    ds_read_b128 v[64:67], v14 offset:45056
    s_waitcnt lgkmcnt(4)
    v_mfma_f32_16x16x32_bf16 v[36:39], v[248:251], v[84:87], v[36:39]
    ds_read_b128 v[68:71], v14 offset:33792
    v_mfma_f32_16x16x32_bf16 v[40:43], v[248:251], v[88:91], v[40:43]
    ds_read_b128 v[72:75], v14 offset:37888
    v_mfma_f32_16x16x32_bf16 v[40:43], v[252:255], v[96:99], v[40:43]
    ds_read_b128 v[76:79], v14 offset:41984
    v_mfma_f32_16x16x32_bf16 v[36:39], v[252:255], v[92:95], v[36:39]
    ds_read_b128 v[80:83], v14 offset:46080
    s_waitcnt lgkmcnt(4)
    v_mfma_f32_16x16x32_bf16 v[44:47], v[128:131], v[52:55], v[44:47]
    ds_read_b128 v[84:87], v14 offset:34816
    v_mfma_f32_16x16x32_bf16 v[48:51], v[128:131], v[56:59], v[48:51]
    ds_read_b128 v[88:91], v14 offset:38912
    v_mfma_f32_16x16x32_bf16 v[48:51], v[132:135], v[64:67], v[48:51]
    ds_read_b128 v[92:95], v14 offset:43008
    v_mfma_f32_16x16x32_bf16 v[44:47], v[132:135], v[60:63], v[44:47]
    ds_read_b128 v[96:99], v14 offset:47104
    v_add_u32 v36, 0x10000, v36
    v_add_u32 v38, 0x10000, v38
    v_add_u32 v40, 0x10000, v40
    v_add_u32 v42, 0x10000, v42
    v_and_b32 v36, 0xfffe0000, v36
    v_and_b32 v38, 0xfffe0000, v38
    v_and_b32 v40, 0xfffe0000, v40
    v_and_b32 v42, 0xfffe0000, v42
    v_cvt_pk_bf16_f32 v36, v36, v37
    v_cvt_pk_bf16_f32 v37, v38, v39
    v_cvt_pk_bf16_f32 v38, v40, v41
    v_cvt_pk_bf16_f32 v39, v42, v43
    s_add_u32 s36, s39, 262144
    v_permlane16_swap_b32 v36, v38
    v_permlane16_swap_b32 v37, v39
    s_waitcnt lgkmcnt(4)
    v_mfma_f32_16x16x32_bf16 v[44:47], v[136:139], v[68:71], v[44:47]
    ds_read_b128 v[52:55], v14 offset:35840
    v_mfma_f32_16x16x32_bf16 v[48:51], v[136:139], v[72:75], v[48:51]
    ds_read_b128 v[56:59], v14 offset:39936
    v_mfma_f32_16x16x32_bf16 v[48:51], v[140:143], v[80:83], v[48:51]
    ds_read_b128 v[60:63], v14 offset:44032
    v_mfma_f32_16x16x32_bf16 v[44:47], v[140:143], v[76:79], v[44:47]
    ds_read_b128 v[64:67], v14 offset:48128
    s_barrier
    s_waitcnt lgkmcnt(4)
    v_mfma_f32_16x16x32_bf16 v[44:47], v[144:147], v[84:87], v[44:47]
    ds_read_b128 v[68:71], v15 offset:0
    v_mfma_f32_16x16x32_bf16 v[48:51], v[144:147], v[88:91], v[48:51]
    ds_read_b128 v[72:75], v15 offset:4096
    v_mfma_f32_16x16x32_bf16 v[48:51], v[148:151], v[96:99], v[48:51]
    ds_read_b128 v[76:79], v15 offset:8192
    v_mfma_f32_16x16x32_bf16 v[44:47], v[148:151], v[92:95], v[44:47]
    ds_read_b128 v[80:83], v15 offset:12288
    s_add_u32 s36, s39, 0
    buffer_store_dwordx4 v[20:23], v13, s[24:27], s36 offen sc1
    s_waitcnt lgkmcnt(4)
    v_mfma_f32_16x16x32_bf16 v[44:47], v[152:155], v[52:55], v[44:47]
    ds_read_b128 v[84:87], v15 offset:1024
    v_mfma_f32_16x16x32_bf16 v[48:51], v[152:155], v[56:59], v[48:51]
    ds_read_b128 v[88:91], v15 offset:5120
    v_mfma_f32_16x16x32_bf16 v[48:51], v[156:159], v[64:67], v[48:51]
    ds_read_b128 v[92:95], v15 offset:9216
    v_mfma_f32_16x16x32_bf16 v[44:47], v[156:159], v[60:63], v[44:47]
    ds_read_b128 v[96:99], v15 offset:13312
    s_add_u32 s36, s39, 131072
    buffer_store_dwordx4 v[28:31], v13, s[24:27], s36 offen sc1
    s_waitcnt lgkmcnt(4)
    v_mfma_f32_16x16x32_bf16 v[44:47], v[160:163], v[68:71], v[44:47]
    ds_read_b128 v[52:55], v15 offset:2048
    v_mfma_f32_16x16x32_bf16 v[48:51], v[160:163], v[72:75], v[48:51]
    ds_read_b128 v[56:59], v15 offset:6144
    v_mfma_f32_16x16x32_bf16 v[48:51], v[164:167], v[80:83], v[48:51]
    ds_read_b128 v[60:63], v15 offset:10240
    v_mfma_f32_16x16x32_bf16 v[44:47], v[164:167], v[76:79], v[44:47]
    ds_read_b128 v[64:67], v15 offset:14336
    s_add_u32 s36, s39, 262144
    buffer_store_dwordx4 v[36:39], v13, s[24:27], s36 offen sc1
    s_waitcnt lgkmcnt(4)
    v_mfma_f32_16x16x32_bf16 v[44:47], v[168:171], v[84:87], v[44:47]
    ds_read_b128 v[68:71], v15 offset:3072
    v_mfma_f32_16x16x32_bf16 v[48:51], v[168:171], v[88:91], v[48:51]
    ds_read_b128 v[72:75], v15 offset:7168
    v_mfma_f32_16x16x32_bf16 v[48:51], v[172:175], v[96:99], v[48:51]
    ds_read_b128 v[76:79], v15 offset:11264
    v_mfma_f32_16x16x32_bf16 v[44:47], v[172:175], v[92:95], v[44:47]
    ds_read_b128 v[80:83], v15 offset:15360
    s_barrier
    s_waitcnt lgkmcnt(4)
    v_mfma_f32_16x16x32_bf16 v[44:47], v[176:179], v[52:55], v[44:47]
    ds_read_b128 v[84:87], v15 offset:16384
    v_mfma_f32_16x16x32_bf16 v[48:51], v[176:179], v[56:59], v[48:51]
    ds_read_b128 v[88:91], v15 offset:20480
    v_mfma_f32_16x16x32_bf16 v[48:51], v[180:183], v[64:67], v[48:51]
    ds_read_b128 v[92:95], v15 offset:24576
    v_mfma_f32_16x16x32_bf16 v[44:47], v[180:183], v[60:63], v[44:47]
    ds_read_b128 v[96:99], v15 offset:28672
    s_waitcnt lgkmcnt(4)
    v_mfma_f32_16x16x32_bf16 v[44:47], v[184:187], v[68:71], v[44:47]
    ds_read_b128 v[52:55], v15 offset:17408
    v_mfma_f32_16x16x32_bf16 v[48:51], v[184:187], v[72:75], v[48:51]
    ds_read_b128 v[56:59], v15 offset:21504
    v_mfma_f32_16x16x32_bf16 v[48:51], v[188:191], v[80:83], v[48:51]
    ds_read_b128 v[60:63], v15 offset:25600
    v_mfma_f32_16x16x32_bf16 v[44:47], v[188:191], v[76:79], v[44:47]
    ds_read_b128 v[64:67], v15 offset:29696
    s_waitcnt lgkmcnt(4)
    v_mfma_f32_16x16x32_bf16 v[44:47], v[192:195], v[84:87], v[44:47]
    ds_read_b128 v[68:71], v15 offset:18432
    v_mfma_f32_16x16x32_bf16 v[48:51], v[192:195], v[88:91], v[48:51]
    ds_read_b128 v[72:75], v15 offset:22528
    v_mfma_f32_16x16x32_bf16 v[48:51], v[196:199], v[96:99], v[48:51]
    ds_read_b128 v[76:79], v15 offset:26624
    v_mfma_f32_16x16x32_bf16 v[44:47], v[196:199], v[92:95], v[44:47]
    ds_read_b128 v[80:83], v15 offset:30720
    s_waitcnt lgkmcnt(4)
    v_mfma_f32_16x16x32_bf16 v[44:47], v[200:203], v[52:55], v[44:47]
    ds_read_b128 v[84:87], v15 offset:19456
    v_mfma_f32_16x16x32_bf16 v[48:51], v[200:203], v[56:59], v[48:51]
    ds_read_b128 v[88:91], v15 offset:23552
    v_mfma_f32_16x16x32_bf16 v[48:51], v[204:207], v[64:67], v[48:51]
    ds_read_b128 v[92:95], v15 offset:27648
    v_mfma_f32_16x16x32_bf16 v[44:47], v[204:207], v[60:63], v[44:47]
    ds_read_b128 v[96:99], v15 offset:31744
    s_barrier
    s_waitcnt lgkmcnt(4)
    v_mfma_f32_16x16x32_bf16 v[44:47], v[208:211], v[68:71], v[44:47]
    ds_read_b128 v[52:55], v15 offset:32768
    v_mfma_f32_16x16x32_bf16 v[48:51], v[208:211], v[72:75], v[48:51]
    ds_read_b128 v[56:59], v15 offset:36864
    v_mfma_f32_16x16x32_bf16 v[48:51], v[212:215], v[80:83], v[48:51]
    ds_read_b128 v[60:63], v15 offset:40960
    v_mfma_f32_16x16x32_bf16 v[44:47], v[212:215], v[76:79], v[44:47]
    ds_read_b128 v[64:67], v15 offset:45056
    s_waitcnt lgkmcnt(4)
    v_mfma_f32_16x16x32_bf16 v[44:47], v[216:219], v[84:87], v[44:47]
    ds_read_b128 v[68:71], v15 offset:33792
    v_mfma_f32_16x16x32_bf16 v[48:51], v[216:219], v[88:91], v[48:51]
    ds_read_b128 v[72:75], v15 offset:37888
    v_mfma_f32_16x16x32_bf16 v[48:51], v[220:223], v[96:99], v[48:51]
    ds_read_b128 v[76:79], v15 offset:41984
    v_mfma_f32_16x16x32_bf16 v[44:47], v[220:223], v[92:95], v[44:47]
    ds_read_b128 v[80:83], v15 offset:46080
    s_waitcnt lgkmcnt(4)
    v_mfma_f32_16x16x32_bf16 v[44:47], v[224:227], v[52:55], v[44:47]
    ds_read_b128 v[84:87], v15 offset:34816
    v_mfma_f32_16x16x32_bf16 v[48:51], v[224:227], v[56:59], v[48:51]
    ds_read_b128 v[88:91], v15 offset:38912
    v_mfma_f32_16x16x32_bf16 v[48:51], v[228:231], v[64:67], v[48:51]
    ds_read_b128 v[92:95], v15 offset:43008
    v_mfma_f32_16x16x32_bf16 v[44:47], v[228:231], v[60:63], v[44:47]
    ds_read_b128 v[96:99], v15 offset:47104
    s_waitcnt lgkmcnt(4)
    v_mfma_f32_16x16x32_bf16 v[44:47], v[232:235], v[68:71], v[44:47]
    ds_read_b128 v[52:55], v15 offset:35840
    v_mfma_f32_16x16x32_bf16 v[48:51], v[232:235], v[72:75], v[48:51]
    ds_read_b128 v[56:59], v15 offset:39936
    v_mfma_f32_16x16x32_bf16 v[48:51], v[236:239], v[80:83], v[48:51]
    ds_read_b128 v[60:63], v15 offset:44032
    v_mfma_f32_16x16x32_bf16 v[44:47], v[236:239], v[76:79], v[44:47]
    ds_read_b128 v[64:67], v15 offset:48128
    ds_write_b128 v16, v[20:23] offset:0
    ds_write_b128 v16, v[28:31] offset:4096
    ds_write_b128 v16, v[36:39] offset:8192
    s_waitcnt lgkmcnt(7)
    v_mfma_f32_16x16x32_bf16 v[44:47], v[240:243], v[84:87], v[44:47]
    v_mfma_f32_16x16x32_bf16 v[48:51], v[240:243], v[88:91], v[48:51]
    v_mfma_f32_16x16x32_bf16 v[48:51], v[244:247], v[96:99], v[48:51]
    v_mfma_f32_16x16x32_bf16 v[44:47], v[244:247], v[92:95], v[44:47]
    s_waitcnt lgkmcnt(3)
    v_mfma_f32_16x16x32_bf16 v[44:47], v[248:251], v[52:55], v[44:47]
    v_mfma_f32_16x16x32_bf16 v[48:51], v[248:251], v[56:59], v[48:51]
    v_mfma_f32_16x16x32_bf16 v[48:51], v[252:255], v[64:67], v[48:51]
    v_mfma_f32_16x16x32_bf16 v[44:47], v[252:255], v[60:63], v[44:47]
    s_setprio 0
    s_nop 6
    v_add_u32 v44, 0x10000, v44
    v_add_u32 v46, 0x10000, v46
    v_add_u32 v48, 0x10000, v48
    v_add_u32 v50, 0x10000, v50
    v_and_b32 v44, 0xfffe0000, v44
    v_and_b32 v46, 0xfffe0000, v46
    v_and_b32 v48, 0xfffe0000, v48
    v_and_b32 v50, 0xfffe0000, v50
    v_cvt_pk_bf16_f32 v44, v44, v45
    v_cvt_pk_bf16_f32 v45, v46, v47
    v_cvt_pk_bf16_f32 v46, v48, v49
    v_cvt_pk_bf16_f32 v47, v50, v51
    s_add_u32 s36, s39, 393216
    v_permlane16_swap_b32 v44, v46
    v_permlane16_swap_b32 v45, v47
    s_add_u32 s36, s39, 393216
    buffer_store_dwordx4 v[44:47], v13, s[24:27], s36 offen sc1
    ds_write_b128 v16, v[44:47] offset:12288
    s_waitcnt lgkmcnt(0)
    s_barrier
    s_cmp_ge_u32 s30, 6
    s_cbranch_scc1 WLOAD
    s_and_b32 s35, s30, 1
    s_add_u32 s12, s62, 0x480000
    s_addc_u32 s13, s63, 0
    s_mov_b32 s14, 0x7e000
    s_mov_b32 s15, 0x20000
    s_mul_i32 s38, s35, 262144
    s_lshl_b32 s41, s35, 13
    s_mov_b32 s42, 0
    s_mov_b32 s44, s29
    s_add_u32 s54, s55, 1024
    v_mov_b32 v9, s54
    v_lshl_add_u32 v9, v1, 7, v9
    s_add_u32 s44, s44, 1
    s_and_b32 s44, s44, 15
    s_add_u32 s46, s29, 1
    s_and_b32 s46, s46, 15
    s_cmp_eq_u32 s28, s29
    s_cselect_b32 s47, s46, s28
    s_mov_b32 s42, 16384
    s_and_b32 s35, s30, 1
    s_lshl_b32 s35, s35, 7
    s_add_u32 s35, s35, s55
    s_add_u32 s35, s35, 0x1600
    s_and_b32 s40, s30, 1
    s_lshl_b32 s40, s40, 13
    s_lshl_b32 s53, s29, 7
    s_add_u32 s40, s40, s53
    s_add_u32 s40, s40, 23068672
    v_lshlrev_b32 v10, 3, v1
    s_add_u32 s20, s62, 0x1c8000
    s_addc_u32 s21, s63, 0
    s_mov_b32 s22, 0x6000
    s_mov_b32 s23, 0x20000
    s_and_b32 s34, s30, 1
    s_lshl_b32 s34, s34, 9
    s_call_b64 s[76:77], PREP_a_issue_3
    s_mov_b32 m0, s19
    s_mov_b32 s39, s16
    s_and_b32 s53, s30, 3
    s_lshl_b32 s53, s53, 7
    s_add_u32 s53, s53, s55
    s_add_u32 s53, s53, 0x400
    v_mov_b32 v14, 1
    v_mov_b32 v15, 0
    s_mov_b64 exec, 1
    s_waitcnt vmcnt(0)
    buffer_atomic_add v14, v15, s[56:59], s53 offen sc1
    s_mov_b64 exec, -1
    s_call_b64 s[76:77], SUB_rest_2
    s_waitcnt lgkmcnt(0)
    s_mov_b32 s53, 0
    s_add_u32 s54, s52, 16
    s_bfm_b64 exec, 4, 0
poll_32:
    buffer_load_dword v8, v9, s[56:59], 0 offen sc1
    s_waitcnt vmcnt(0)
    v_cmp_eq_u32 vcc, s54, v8
    s_nop 0
    s_cmp_eq_u64 vcc, exec
    s_cbranch_scc1 pok_33
    s_sleep 5
    s_add_u32 s53, s53, 1
    s_cmp_lt_u32 s53, s61
    s_cbranch_scc1 poll_32
    s_mov_b32 s61, 0
pok_33:
    s_mov_b64 exec, -1
    buffer_load_dwordx4 v2, s[12:15], s39 offen sc1 lds
    buffer_load_dwordx4 v2, s[12:15], s39 offen offset:1024 sc1 lds
    s_call_b64 s[76:77], PREP_a_issue_3
    s_add_u32 m0, m0, 2048
    s_add_u32 s39, s39, 65536
    buffer_load_dwordx4 v2, s[12:15], s39 offen sc1 lds
    buffer_load_dwordx4 v2, s[12:15], s39 offen offset:1024 sc1 lds
    s_add_u32 m0, m0, 2048
    s_add_u32 s39, s39, 65536
    buffer_load_dwordx4 v2, s[12:15], s39 offen sc1 lds
    buffer_load_dwordx4 v2, s[12:15], s39 offen offset:1024 sc1 lds
    s_add_u32 m0, m0, 2048
    s_add_u32 s39, s39, 65536
    buffer_load_dwordx4 v2, s[12:15], s39 offen sc1 lds
    buffer_load_dwordx4 v2, s[12:15], s39 offen offset:1024 sc1 lds
    s_mov_b32 m0, s19
    s_mov_b32 s39, s16
    buffer_load_dwordx4 v2, s[12:15], s39 offen sc1 lds
    buffer_load_dwordx4 v2, s[12:15], s39 offen offset:1024 sc1 lds
    s_call_b64 s[76:77], PREP_a_issue_3
    s_add_u32 m0, m0, 2048
    s_add_u32 s39, s39, 65536
    buffer_load_dwordx4 v2, s[12:15], s39 offen sc1 lds
    buffer_load_dwordx4 v2, s[12:15], s39 offen offset:1024 sc1 lds
    s_add_u32 m0, m0, 2048
    s_add_u32 s39, s39, 65536
    buffer_load_dwordx4 v2, s[12:15], s39 offen sc1 lds
    buffer_load_dwordx4 v2, s[12:15], s39 offen offset:1024 sc1 lds
    s_add_u32 m0, m0, 2048
    s_add_u32 s39, s39, 65536
    buffer_load_dwordx4 v2, s[12:15], s39 offen sc1 lds
    buffer_load_dwordx4 v2, s[12:15], s39 offen offset:1024 sc1 lds
    s_mov_b32 m0, s19
    s_mov_b32 s39, s16
    s_waitcnt vmcnt(8)
    s_barrier
    buffer_load_dwordx4 v2, s[12:15], s39 offen sc1 lds
    buffer_load_dwordx4 v2, s[12:15], s39 offen offset:1024 sc1 lds
    s_call_b64 s[76:77], PREP_a_issue_3
    s_add_u32 m0, m0, 2048
    s_add_u32 s39, s39, 65536
    buffer_load_dwordx4 v2, s[12:15], s39 offen sc1 lds
    buffer_load_dwordx4 v2, s[12:15], s39 offen offset:1024 sc1 lds
    s_add_u32 m0, m0, 2048
    s_add_u32 s39, s39, 65536
    buffer_load_dwordx4 v2, s[12:15], s39 offen sc1 lds
    buffer_load_dwordx4 v2, s[12:15], s39 offen offset:1024 sc1 lds
    s_add_u32 m0, m0, 2048
    s_add_u32 s39, s39, 65536
    buffer_load_dwordx4 v2, s[12:15], s39 offen sc1 lds
    buffer_load_dwordx4 v2, s[12:15], s39 offen offset:1024 sc1 lds
    s_mov_b32 m0, s19
    s_mov_b32 s39, s16
    s_add_u32 s36, s34, 155648
    v_add_u32 v51, s36, v10
    ds_read_b64 v[18:19], v51 offset:0
    ds_read_b64 v[20:21], v51 offset:1024
    ds_read_b64 v[22:23], v51 offset:2048
    ds_read_b64 v[24:25], v51 offset:3072
    s_lshr_b32 s53, s29, 3
    s_lshl_b32 s53, s53, 14
    s_and_b32 s36, s29, 7
    s_lshl_b32 s36, s36, 10
    s_add_u32 s36, s36, s53
    s_add_u32 s36, s36, s34
    s_waitcnt lgkmcnt(0)
    v_pk_add_f32 v[18:19], v[18:19], v[20:21]
    v_pk_add_f32 v[18:19], v[18:19], v[22:23]
    v_pk_add_f32 v[18:19], v[18:19], v[24:25]
    buffer_store_dwordx2 v[18:19], v10, s[20:23], s36 offen sc1
    s_waitcnt vmcnt(9)
    s_barrier
    buffer_load_dwordx4 v2, s[12:15], s39 offen sc1 lds
    buffer_load_dwordx4 v2, s[12:15], s39 offen offset:1024 sc1 lds
    s_call_b64 s[76:77], PREP_a_issue_3
    s_add_u32 m0, m0, 2048
    s_add_u32 s39, s39, 65536
    buffer_load_dwordx4 v2, s[12:15], s39 offen sc1 lds
    buffer_load_dwordx4 v2, s[12:15], s39 offen offset:1024 sc1 lds
    s_add_u32 m0, m0, 2048
    s_add_u32 s39, s39, 65536
    buffer_load_dwordx4 v2, s[12:15], s39 offen sc1 lds
    buffer_load_dwordx4 v2, s[12:15], s39 offen offset:1024 sc1 lds
    s_add_u32 m0, m0, 2048
    s_add_u32 s39, s39, 65536
    buffer_load_dwordx4 v2, s[12:15], s39 offen sc1 lds
    buffer_load_dwordx4 v2, s[12:15], s39 offen offset:1024 sc1 lds
    s_mov_b32 m0, s19
    s_mov_b32 s39, s16
    s_waitcnt vmcnt(9)
    s_barrier
    buffer_load_dwordx4 v2, s[12:15], s39 offen sc1 lds
    buffer_load_dwordx4 v2, s[12:15], s39 offen offset:1024 sc1 lds
    s_call_b64 s[76:77], PREP_a_issue_3
    s_add_u32 m0, m0, 2048
    s_add_u32 s39, s39, 65536
    buffer_load_dwordx4 v2, s[12:15], s39 offen sc1 lds
    buffer_load_dwordx4 v2, s[12:15], s39 offen offset:1024 sc1 lds
    s_add_u32 m0, m0, 2048
    s_add_u32 s39, s39, 65536
    buffer_load_dwordx4 v2, s[12:15], s39 offen sc1 lds
    buffer_load_dwordx4 v2, s[12:15], s39 offen offset:1024 sc1 lds
    s_add_u32 m0, m0, 2048
    s_add_u32 s39, s39, 65536
    buffer_load_dwordx4 v2, s[12:15], s39 offen sc1 lds
    buffer_load_dwordx4 v2, s[12:15], s39 offen offset:1024 sc1 lds
    s_mov_b32 m0, s19
    s_mov_b32 s39, s16
    s_waitcnt vmcnt(16)
    s_and_b32 s53, s30, 1
    s_lshl_b32 s53, s53, 7
    s_add_u32 s53, s53, s55
    s_add_u32 s53, s53, 0x1600
    v_mov_b32 v14, 1
    v_mov_b32 v15, 0
    s_mov_b64 exec, 1
    buffer_atomic_add v14, v15, s[56:59], s53 offen sc1
    s_mov_b64 exec, -1
    s_waitcnt vmcnt(9)
    s_barrier
    buffer_load_dwordx4 v2, s[12:15], s39 offen sc1 lds
    buffer_load_dwordx4 v2, s[12:15], s39 offen offset:1024 sc1 lds
    s_call_b64 s[76:77], PREP_a_issue_3
    s_add_u32 m0, m0, 2048
    s_add_u32 s39, s39, 65536
    buffer_load_dwordx4 v2, s[12:15], s39 offen sc1 lds
    buffer_load_dwordx4 v2, s[12:15], s39 offen offset:1024 sc1 lds
    s_add_u32 m0, m0, 2048
    s_add_u32 s39, s39, 65536
    buffer_load_dwordx4 v2, s[12:15], s39 offen sc1 lds
    buffer_load_dwordx4 v2, s[12:15], s39 offen offset:1024 sc1 lds
    s_add_u32 m0, m0, 2048
    s_add_u32 s39, s39, 65536
    buffer_load_dwordx4 v2, s[12:15], s39 offen sc1 lds
    buffer_load_dwordx4 v2, s[12:15], s39 offen offset:1024 sc1 lds
    s_mov_b32 m0, s19
    s_mov_b32 s39, s16
    s_waitcnt vmcnt(9)
    s_barrier
    buffer_load_dwordx4 v2, s[12:15], s39 offen sc1 lds
    buffer_load_dwordx4 v2, s[12:15], s39 offen offset:1024 sc1 lds
    s_call_b64 s[76:77], PREP_a_issue_3
    s_add_u32 m0, m0, 2048
    s_add_u32 s39, s39, 65536
    buffer_load_dwordx4 v2, s[12:15], s39 offen sc1 lds
    buffer_load_dwordx4 v2, s[12:15], s39 offen offset:1024 sc1 lds
    s_add_u32 m0, m0, 2048
    s_add_u32 s39, s39, 65536
    buffer_load_dwordx4 v2, s[12:15], s39 offen sc1 lds
    buffer_load_dwordx4 v2, s[12:15], s39 offen offset:1024 sc1 lds
    s_add_u32 m0, m0, 2048
    s_add_u32 s39, s39, 65536
    buffer_load_dwordx4 v2, s[12:15], s39 offen sc1 lds
    buffer_load_dwordx4 v2, s[12:15], s39 offen offset:1024 sc1 lds
    s_mov_b32 m0, s19
    s_mov_b32 s39, s16
    s_waitcnt vmcnt(8)
    s_barrier
    buffer_load_dwordx4 v2, s[12:15], s39 offen sc1 lds
    buffer_load_dwordx4 v2, s[12:15], s39 offen offset:1024 sc1 lds
    s_call_b64 s[76:77], PREP_a_issue_3
    s_add_u32 m0, m0, 2048
    s_add_u32 s39, s39, 65536
    buffer_load_dwordx4 v2, s[12:15], s39 offen sc1 lds
    buffer_load_dwordx4 v2, s[12:15], s39 offen offset:1024 sc1 lds
    s_add_u32 m0, m0, 2048
    s_add_u32 s39, s39, 65536
    buffer_load_dwordx4 v2, s[12:15], s39 offen sc1 lds
    buffer_load_dwordx4 v2, s[12:15], s39 offen offset:1024 sc1 lds
    s_add_u32 m0, m0, 2048
    s_add_u32 s39, s39, 65536
    buffer_load_dwordx4 v2, s[12:15], s39 offen sc1 lds
    buffer_load_dwordx4 v2, s[12:15], s39 offen offset:1024 sc1 lds
    s_mov_b32 m0, s19
    s_mov_b32 s39, s16
    s_waitcnt vmcnt(8)
    s_barrier
    buffer_load_dwordx4 v2, s[12:15], s39 offen sc1 lds
    buffer_load_dwordx4 v2, s[12:15], s39 offen offset:1024 sc1 lds
    s_call_b64 s[76:77], PREP_a_issue_3
    s_add_u32 m0, m0, 2048
    s_add_u32 s39, s39, 65536
    buffer_load_dwordx4 v2, s[12:15], s39 offen sc1 lds
    buffer_load_dwordx4 v2, s[12:15], s39 offen offset:1024 sc1 lds
    s_add_u32 m0, m0, 2048
    s_add_u32 s39, s39, 65536
    buffer_load_dwordx4 v2, s[12:15], s39 offen sc1 lds
    buffer_load_dwordx4 v2, s[12:15], s39 offen offset:1024 sc1 lds
    s_add_u32 m0, m0, 2048
    s_add_u32 s39, s39, 65536
    buffer_load_dwordx4 v2, s[12:15], s39 offen sc1 lds
    buffer_load_dwordx4 v2, s[12:15], s39 offen offset:1024 sc1 lds
    s_mov_b32 m0, s19
    s_mov_b32 s39, s16
    s_load_dword s32, s[4:5], s35
    s_load_dword s3, s[4:5], s40
    s_waitcnt vmcnt(8)
    s_barrier
    buffer_load_dwordx4 v2, s[12:15], s39 offen sc1 lds
    buffer_load_dwordx4 v2, s[12:15], s39 offen offset:1024 sc1 lds
    s_call_b64 s[76:77], PREP_a_issue_3
    s_add_u32 m0, m0, 2048
    s_add_u32 s39, s39, 65536
    buffer_load_dwordx4 v2, s[12:15], s39 offen sc1 lds
    buffer_load_dwordx4 v2, s[12:15], s39 offen offset:1024 sc1 lds
    s_add_u32 m0, m0, 2048
    s_add_u32 s39, s39, 65536
    buffer_load_dwordx4 v2, s[12:15], s39 offen sc1 lds
    buffer_load_dwordx4 v2, s[12:15], s39 offen offset:1024 sc1 lds
    s_add_u32 m0, m0, 2048
    s_add_u32 s39, s39, 65536
    buffer_load_dwordx4 v2, s[12:15], s39 offen sc1 lds
    buffer_load_dwordx4 v2, s[12:15], s39 offen offset:1024 sc1 lds
    s_mov_b32 m0, s19
    s_mov_b32 s39, s16
    s_add_u32 s54, s52, 16
    s_waitcnt lgkmcnt(0)
    s_cmp_eq_u32 s32, s54
    s_cbranch_scc1 fok_34
    v_mov_b32 v15, s35
    s_mov_b32 s53, 0
    s_add_u32 s54, s52, 16
    s_bfm_b64 exec, 1, 0
poll_35:
    buffer_load_dword v14, v15, s[56:59], 0 offen sc1
    s_waitcnt vmcnt(0)
    v_cmp_eq_u32 vcc, s54, v14
    s_nop 0
    s_cmp_eq_u64 vcc, exec
    s_cbranch_scc1 pok_36
    s_sleep 5
    s_add_u32 s53, s53, 1
    s_cmp_lt_u32 s53, s61
    s_cbranch_scc1 poll_35
    s_mov_b32 s61, 0
pok_36:
    s_mov_b64 exec, -1
fok_34:
    s_add_u32 s36, s34, 0
    buffer_load_dwordx2 v[18:19], v10, s[20:23], s36 offen offset:0 sc1
    buffer_load_dwordx2 v[20:21], v10, s[20:23], s36 offen offset:1024 sc1
    buffer_load_dwordx2 v[22:23], v10, s[20:23], s36 offen offset:2048 sc1
    buffer_load_dwordx2 v[24:25], v10, s[20:23], s36 offen offset:3072 sc1
    s_add_u32 s36, s36, 4096
    buffer_load_dwordx2 v[26:27], v10, s[20:23], s36 offen offset:0 sc1
    buffer_load_dwordx2 v[28:29], v10, s[20:23], s36 offen offset:1024 sc1
    buffer_load_dwordx2 v[30:31], v10, s[20:23], s36 offen offset:2048 sc1
    buffer_load_dwordx2 v[32:33], v10, s[20:23], s36 offen offset:3072 sc1
    s_waitcnt vmcnt(16)
    s_barrier
    buffer_load_dwordx4 v2, s[12:15], s39 offen sc1 lds
    buffer_load_dwordx4 v2, s[12:15], s39 offen offset:1024 sc1 lds
    s_call_b64 s[76:77], PREP_a_issue_3
    s_add_u32 m0, m0, 2048
    s_add_u32 s39, s39, 65536
    buffer_load_dwordx4 v2, s[12:15], s39 offen sc1 lds
    buffer_load_dwordx4 v2, s[12:15], s39 offen offset:1024 sc1 lds
    s_add_u32 m0, m0, 2048
    s_add_u32 s39, s39, 65536
    buffer_load_dwordx4 v2, s[12:15], s39 offen sc1 lds
    buffer_load_dwordx4 v2, s[12:15], s39 offen offset:1024 sc1 lds
    s_add_u32 m0, m0, 2048
    s_add_u32 s39, s39, 65536
    buffer_load_dwordx4 v2, s[12:15], s39 offen sc1 lds
    buffer_load_dwordx4 v2, s[12:15], s39 offen offset:1024 sc1 lds
    s_mov_b32 m0, s19
    s_mov_b32 s39, s16
    s_add_u32 s36, s34, 16384
    buffer_load_dwordx2 v[34:35], v10, s[20:23], s36 offen offset:0 sc1
    buffer_load_dwordx2 v[36:37], v10, s[20:23], s36 offen offset:1024 sc1
    buffer_load_dwordx2 v[38:39], v10, s[20:23], s36 offen offset:2048 sc1
    buffer_load_dwordx2 v[40:41], v10, s[20:23], s36 offen offset:3072 sc1
    s_add_u32 s36, s36, 4096
    buffer_load_dwordx2 v[42:43], v10, s[20:23], s36 offen offset:0 sc1
    buffer_load_dwordx2 v[44:45], v10, s[20:23], s36 offen offset:1024 sc1
    buffer_load_dwordx2 v[46:47], v10, s[20:23], s36 offen offset:2048 sc1
    buffer_load_dwordx2 v[48:49], v10, s[20:23], s36 offen offset:3072 sc1
    s_waitcnt vmcnt(24)
    s_barrier
    buffer_load_dwordx4 v2, s[12:15], s39 offen sc1 lds
    buffer_load_dwordx4 v2, s[12:15], s39 offen offset:1024 sc1 lds
    s_call_b64 s[76:77], PREP_a_issue_3
    s_add_u32 m0, m0, 2048
    s_add_u32 s39, s39, 65536
    buffer_load_dwordx4 v2, s[12:15], s39 offen sc1 lds
    buffer_load_dwordx4 v2, s[12:15], s39 offen offset:1024 sc1 lds
    s_add_u32 m0, m0, 2048
    s_add_u32 s39, s39, 65536
    buffer_load_dwordx4 v2, s[12:15], s39 offen sc1 lds
    buffer_load_dwordx4 v2, s[12:15], s39 offen offset:1024 sc1 lds
    s_add_u32 m0, m0, 2048
    s_add_u32 s39, s39, 65536
    buffer_load_dwordx4 v2, s[12:15], s39 offen sc1 lds
    buffer_load_dwordx4 v2, s[12:15], s39 offen offset:1024 sc1 lds
    s_mov_b32 m0, s19
    s_mov_b32 s39, s16
    s_add_u32 s54, s52, 16
    s_waitcnt lgkmcnt(0)
    s_cmp_eq_u32 s3, s54
    s_cbranch_scc1 fok_37
    v_mov_b32 v15, s40
    s_mov_b32 s53, 0
    s_add_u32 s54, s52, 16
    s_bfm_b64 exec, 1, 0
poll_38:
    buffer_load_dword v14, v15, s[56:59], 0 offen sc1
    s_waitcnt vmcnt(0)
    v_cmp_eq_u32 vcc, s54, v14
    s_nop 0
    s_cmp_eq_u64 vcc, exec
    s_cbranch_scc1 pok_39
    s_sleep 5
    s_add_u32 s53, s53, 1
    s_cmp_lt_u32 s53, s61
    s_cbranch_scc1 poll_38
    s_mov_b32 s61, 0
pok_39:
    s_mov_b64 exec, -1
fok_37:
    s_add_u32 s24, s4, 0x1420000
    s_addc_u32 s25, s5, 0
    s_mov_b32 s26, 0x38000
    s_mov_b32 s27, 0x20000
    s_cmp_eq_u32 s60, 0
    s_cselect_b32 s26, s26, 0
    s_and_b32 s36, s30, 1
    s_mul_i32 s36, s36, 448
    s_mul_i32 s37, s29, 896
    s_add_u32 s37, s36, s37
    v_lshrrev_b32 v13, 5, v1
    v_mul_u32_u24 v13, 14336, v13
    v_and_b32 v6, 496, v2
    v_add_u32 v13, v13, v6
    buffer_load_dwordx4 v[54:57], v13, s[24:27], s37 offen sc1
    s_add_u32 s37, s37, 28672
    buffer_load_dwordx4 v[58:61], v13, s[24:27], s37 offen sc1
    s_add_u32 s37, s37, 28672
    buffer_load_dwordx4 v[62:65], v13, s[24:27], s37 offen sc1
    s_add_u32 s37, s37, 28672
    buffer_load_dwordx4 v[66:69], v13, s[24:27], s37 offen sc1
    s_add_u32 s37, s37, 28672
    buffer_load_dwordx4 v[70:73], v13, s[24:27], s37 offen sc1
    s_add_u32 s37, s37, 28672
    buffer_load_dwordx4 v[74:77], v13, s[24:27], s37 offen sc1
    s_add_u32 s37, s37, 28672
    buffer_load_dwordx4 v[78:81], v13, s[24:27], s37 offen sc1
    s_add_u32 s37, s37, 28672
    buffer_load_dwordx4 v[82:85], v13, s[24:27], s37 offen sc1
    s_add_u32 s37, s37, 28672
    s_waitcnt vmcnt(24)
    s_barrier
    buffer_load_dwordx4 v2, s[12:15], s39 offen sc1 lds
    buffer_load_dwordx4 v2, s[12:15], s39 offen offset:1024 sc1 lds
    s_call_b64 s[76:77], PREP_a_issue_3
    s_add_u32 m0, m0, 2048
    s_add_u32 s39, s39, 65536
    buffer_load_dwordx4 v2, s[12:15], s39 offen sc1 lds
    buffer_load_dwordx4 v2, s[12:15], s39 offen offset:1024 sc1 lds
    s_add_u32 m0, m0, 2048
    s_add_u32 s39, s39, 65536
    buffer_load_dwordx4 v2, s[12:15], s39 offen sc1 lds
    buffer_load_dwordx4 v2, s[12:15], s39 offen offset:1024 sc1 lds
    s_add_u32 m0, m0, 2048
    s_add_u32 s39, s39, 65536
    buffer_load_dwordx4 v2, s[12:15], s39 offen sc1 lds
    buffer_load_dwordx4 v2, s[12:15], s39 offen offset:1024 sc1 lds
    s_mov_b32 m0, s19
    s_mov_b32 s39, s16
    s_waitcnt vmcnt(24)
    v_pk_add_f32 v[18:19], v[18:19], v[34:35]
    v_pk_add_f32 v[20:21], v[20:21], v[36:37]
    v_pk_add_f32 v[22:23], v[22:23], v[38:39]
    v_pk_add_f32 v[24:25], v[24:25], v[40:41]
    v_pk_add_f32 v[26:27], v[26:27], v[42:43]
    v_pk_add_f32 v[28:29], v[28:29], v[44:45]
    v_pk_add_f32 v[30:31], v[30:31], v[46:47]
    v_pk_add_f32 v[32:33], v[32:33], v[48:49]
    v_pk_add_f32 v[18:19], v[18:19], v[26:27]
    v_pk_add_f32 v[20:21], v[20:21], v[28:29]
    v_pk_add_f32 v[22:23], v[22:23], v[30:31]
    v_pk_add_f32 v[24:25], v[24:25], v[32:33]
    v_pk_add_f32 v[18:19], v[18:19], v[22:23]
    v_pk_add_f32 v[20:21], v[20:21], v[24:25]
    s_waitcnt vmcnt(16)
    s_barrier
    buffer_load_dwordx4 v2, s[12:15], s39 offen sc1 lds
    buffer_load_dwordx4 v2, s[12:15], s39 offen offset:1024 sc1 lds
    s_call_b64 s[76:77], PREP_a_issue_3
    s_add_u32 m0, m0, 2048
    s_add_u32 s39, s39, 65536
    buffer_load_dwordx4 v2, s[12:15], s39 offen sc1 lds
    buffer_load_dwordx4 v2, s[12:15], s39 offen offset:1024 sc1 lds
    s_add_u32 m0, m0, 2048
    s_add_u32 s39, s39, 65536
    buffer_load_dwordx4 v2, s[12:15], s39 offen sc1 lds
    buffer_load_dwordx4 v2, s[12:15], s39 offen offset:1024 sc1 lds
    s_add_u32 m0, m0, 2048
    s_add_u32 s39, s39, 65536
    buffer_load_dwordx4 v2, s[12:15], s39 offen sc1 lds
    buffer_load_dwordx4 v2, s[12:15], s39 offen offset:1024 sc1 lds
    s_mov_b32 m0, s19
    s_mov_b32 s39, s16
    v_pk_add_f32 v[18:19], v[18:19], v[20:21]
    v_mul_f32 v52, 0x3a800000, v18
    v_mul_f32 v50, 0x3a800000, v19
    v_fma_f32 v50, -v52, v52, v50
    v_max_f32 v50, 0, v50
    v_cvt_pk_bf16_f32 v52, v52, v52
    v_lshlrev_b32 v52, 16, v52
    v_cvt_pk_bf16_f32 v50, v50, v50
    v_lshlrev_b32 v50, 16, v50
    v_add_f32 v50, 0x3727c5ac, v50
    v_cvt_pk_bf16_f32 v50, v50, v50
    v_lshlrev_b32 v50, 16, v50
    v_sqrt_f32 v50, v50
    s_nop 0
    v_cvt_pk_bf16_f32 v50, v50, v50
    s_waitcnt vmcnt(8)
    s_barrier
    buffer_load_dwordx4 v2, s[12:15], s39 offen sc1 lds
    buffer_load_dwordx4 v2, s[12:15], s39 offen offset:1024 sc1 lds
    s_add_u32 m0, m0, 2048
    s_add_u32 s39, s39, 65536
    buffer_load_dwordx4 v2, s[12:15], s39 offen sc1 lds
    buffer_load_dwordx4 v2, s[12:15], s39 offen offset:1024 sc1 lds
    s_add_u32 m0, m0, 2048
    s_add_u32 s39, s39, 65536
    buffer_load_dwordx4 v2, s[12:15], s39 offen sc1 lds
    buffer_load_dwordx4 v2, s[12:15], s39 offen offset:1024 sc1 lds
    s_add_u32 m0, m0, 2048
    s_add_u32 s39, s39, 65536
    buffer_load_dwordx4 v2, s[12:15], s39 offen sc1 lds
    buffer_load_dwordx4 v2, s[12:15], s39 offen offset:1024 sc1 lds
    s_waitcnt vmcnt(24)
    v_lshlrev_b32 v50, 16, v50
    v_rcp_f32 v53, v50
    v_mov_b32 v18, v52
    v_mov_b32 v19, v50
    v_mul_f32 v20, 0xc0135761, v53
    v_mul_f32 v53, v53, v53
    v_mul_f32 v53, 0x3d372713, v53
    v_mul_f32 v21, v53, v20
    s_lshl1_add_u32 s36, s34, 160768
    v_add_u32 v51, s36, v2
    ds_write_b128 v51, v[18:21]
    s_cmp_lg_u32 s60, 0
    s_cbranch_scc1 pc_43
    v_pk_add_f32 v[54:55], v[54:55], v[58:59]
    v_pk_add_f32 v[56:57], v[56:57], v[60:61]
    v_pk_add_f32 v[54:55], v[54:55], v[62:63]
    v_pk_add_f32 v[56:57], v[56:57], v[64:65]
    v_pk_add_f32 v[54:55], v[54:55], v[66:67]
    v_pk_add_f32 v[56:57], v[56:57], v[68:69]
    v_pk_add_f32 v[54:55], v[54:55], v[70:71]
    v_pk_add_f32 v[56:57], v[56:57], v[72:73]
pc_43:
    s_waitcnt vmcnt(8)
    s_barrier
    s_cmp_lg_u32 s60, 0
    s_cbranch_scc1 pc_44
    v_pk_add_f32 v[54:55], v[54:55], v[74:75]
    v_pk_add_f32 v[56:57], v[56:57], v[76:77]
    v_pk_add_f32 v[54:55], v[54:55], v[78:79]
    v_pk_add_f32 v[56:57], v[56:57], v[80:81]
    v_pk_add_f32 v[54:55], v[54:55], v[82:83]
    v_pk_add_f32 v[56:57], v[56:57], v[84:85]
    v_mov_b32 v58, v54
    v_mov_b32 v59, v55
    v_mov_b32 v60, v56
    v_mov_b32 v61, v57
    v_permlane32_swap_b32 v54, v58
    v_permlane32_swap_b32 v55, v59
    v_permlane32_swap_b32 v56, v60
    v_permlane32_swap_b32 v57, v61
    v_pk_add_f32 v[54:55], v[54:55], v[58:59]
    v_pk_add_f32 v[56:57], v[56:57], v[60:61]
    s_and_b32 s36, s30, 1
    s_mul_i32 s36, s36, 448
    s_add_u32 s36, s36, 159744
    v_add_u32 v6, s36, v2
    s_bfm_b64 exec, 28, 0
    ds_write_b128 v6, v[54:57]
    s_mov_b64 exec, -1
    s_waitcnt lgkmcnt(0)
pc_44:
    s_waitcnt lgkmcnt(0)
    s_waitcnt vmcnt(0)
    s_barrier
    s_cmp_lg_u32 s60, 0
    s_cbranch_scc1 tw4_46
    s_mov_b64 s[48:49], s[74:75]
    s_lshl_b32 s45, s2, 1
    s_and_b32 s50, s30, 1
    s_add_u32 s45, s45, s50
    s_mul_i32 s45, s45, 14336
    s_mov_b32 s50, 7340032
    s_mov_b32 s51, 0x20000
    buffer_load_dwordx4 v[90:93], v2, s[48:51], s45 offen offset:0
    buffer_load_dwordx4 v[90:93], v2, s[48:51], s45 offen offset:1024
    buffer_load_dwordx4 v[90:93], v2, s[48:51], s45 offen offset:2048
    buffer_load_dwordx4 v[90:93], v2, s[48:51], s45 offen offset:3072
    s_add_u32 s45, s45, 4096
    buffer_load_dwordx4 v[90:93], v2, s[48:51], s45 offen offset:0
    buffer_load_dwordx4 v[90:93], v2, s[48:51], s45 offen offset:1024
    buffer_load_dwordx4 v[90:93], v2, s[48:51], s45 offen offset:2048
    buffer_load_dwordx4 v[90:93], v2, s[48:51], s45 offen offset:3072
    s_add_u32 s45, s45, 4096
    buffer_load_dwordx4 v[90:93], v2, s[48:51], s45 offen offset:0
    buffer_load_dwordx4 v[90:93], v2, s[48:51], s45 offen offset:1024
    buffer_load_dwordx4 v[90:93], v2, s[48:51], s45 offen offset:2048
    buffer_load_dwordx4 v[90:93], v2, s[48:51], s45 offen offset:3072
    s_add_u32 s45, s45, 4096
    buffer_load_dwordx4 v[90:93], v2, s[48:51], s45 offen offset:0
    buffer_load_dwordx4 v[90:93], v2, s[48:51], s45 offen offset:1024
tw4_46:
    s_barrier
    s_and_b32 s35, s30, 1
    s_mov_b32 s12, s62
    s_mov_b32 s13, s63
    s_mov_b32 s14, 0x1be000
    s_mov_b32 s15, 0x20000
    s_mul_i32 s38, s35, 917504
    s_mul_i32 s36, s31, 573440
    s_add_u32 s38, s38, s36
    s_mul_i32 s37, s31, 917504
    s_sub_u32 s37, 229376, s37
    s_lshl_b32 s41, s35, 13
    s_mov_b32 s42, 0
    s_mov_b32 s44, 0
    s_and_b32 s34, s30, 1
    s_lshl1_add_u32 s34, s31, s34
    s_lshl_b32 s34, s34, 7
    s_add_u32 s34, s34, s55
    s_add_u32 s34, s34, 0x1200
    s_and_b32 s35, s30, 1
    s_lshl1_add_u32 s35, s31, s35
    s_lshl_b32 s35, s35, 7
    s_add_u32 s35, s35, s55
    s_add_u32 s35, s35, 0x1400
    s_sub_u32 s48, s34, 512
    s_mov_b32 s44, 3
    s_add_u32 s36, s33, 4
    s_and_b32 s36, s36, 7
    s_mul_i32 s36, s36, 7
    s_add_u32 s36, s36, 2
    s_lshr_b32 s53, s36, 3
    s_lshl_b32 s53, s53, 14
    s_and_b32 s78, s36, 7
    s_lshl_b32 s78, s78, 10
    s_add_u32 s78, s78, s53
    s_add_u32 s36, s33, 4
    s_and_b32 s36, s36, 7
    s_mul_i32 s36, s36, 7
    s_add_u32 s36, s36, 6
    s_lshr_b32 s53, s36, 3
    s_lshl_b32 s53, s53, 14
    s_and_b32 s79, s36, 7
    s_lshl_b32 s79, s79, 10
    s_add_u32 s79, s79, s53
    s_add_u32 s36, s33, 4
    s_and_b32 s36, s36, 7
    s_mul_i32 s36, s36, 7
    s_add_u32 s36, s36, 3
    s_lshr_b32 s53, s36, 3
    s_lshl_b32 s53, s53, 14
    s_and_b32 s80, s36, 7
    s_lshl_b32 s80, s80, 10
    s_add_u32 s80, s80, s53
    s_add_u32 s36, s33, 5
    s_and_b32 s36, s36, 7
    s_mul_i32 s36, s36, 7
    s_add_u32 s36, s36, 2
    s_lshr_b32 s53, s36, 3
    s_lshl_b32 s53, s53, 14
    s_and_b32 s81, s36, 7
    s_lshl_b32 s81, s81, 10
    s_add_u32 s81, s81, s53
    s_add_u32 s36, s33, 5
    s_and_b32 s36, s36, 7
    s_mul_i32 s36, s36, 7
    s_add_u32 s36, s36, 6
    s_lshr_b32 s53, s36, 3
    s_lshl_b32 s53, s53, 14
    s_and_b32 s82, s36, 7
    s_lshl_b32 s82, s82, 10
    s_add_u32 s82, s82, s53
    s_add_u32 s36, s33, 5
    s_and_b32 s36, s36, 7
    s_mul_i32 s36, s36, 7
    s_add_u32 s36, s36, 3
    s_lshr_b32 s53, s36, 3
    s_lshl_b32 s53, s53, 14
    s_and_b32 s83, s36, 7
    s_lshl_b32 s83, s83, 10
    s_add_u32 s83, s83, s53
    s_add_u32 s36, s33, 6
    s_and_b32 s36, s36, 7
    s_mul_i32 s36, s36, 7
    s_add_u32 s36, s36, 2
    s_lshr_b32 s53, s36, 3
    s_lshl_b32 s53, s53, 14
    s_and_b32 s84, s36, 7
    s_lshl_b32 s84, s84, 10
    s_add_u32 s84, s84, s53
    s_add_u32 s36, s33, 6
    s_and_b32 s36, s36, 7
    s_mul_i32 s36, s36, 7
    s_add_u32 s36, s36, 6
    s_lshr_b32 s53, s36, 3
    s_lshl_b32 s53, s53, 14
    s_and_b32 s85, s36, 7
    s_lshl_b32 s85, s85, 10
    s_add_u32 s85, s85, s53
    s_add_u32 s36, s33, 6
    s_and_b32 s36, s36, 7
    s_mul_i32 s36, s36, 7
    s_add_u32 s36, s36, 3
    s_lshr_b32 s53, s36, 3
    s_lshl_b32 s53, s53, 14
    s_and_b32 s86, s36, 7
    s_lshl_b32 s86, s86, 10
    s_add_u32 s86, s86, s53
    s_add_u32 s36, s33, 7
    s_and_b32 s36, s36, 7
    s_mul_i32 s36, s36, 7
    s_add_u32 s36, s36, 2
    s_lshr_b32 s53, s36, 3
    s_lshl_b32 s53, s53, 14
    s_and_b32 s87, s36, 7
    s_lshl_b32 s87, s87, 10
    s_add_u32 s87, s87, s53
    s_add_u32 s36, s33, 7
    s_and_b32 s36, s36, 7
    s_mul_i32 s36, s36, 7
    s_add_u32 s36, s36, 6
    s_lshr_b32 s53, s36, 3
    s_lshl_b32 s53, s53, 14
    s_and_b32 s88, s36, 7
    s_lshl_b32 s88, s88, 10
    s_add_u32 s88, s88, s53
    s_add_u32 s36, s33, 7
    s_and_b32 s36, s36, 7
    s_mul_i32 s36, s36, 7
    s_add_u32 s36, s36, 3
    s_lshr_b32 s53, s36, 3
    s_lshl_b32 s53, s53, 14
    s_and_b32 s89, s36, 7
    s_lshl_b32 s89, s89, 10
    s_add_u32 s89, s89, s53
    s_mov_b64 s[8:9], s[68:69]
    s_mov_b32 s10, 2097152
    s_mov_b32 s11, 0x20000
    s_and_b32 s3, s30, 3
    s_lshl_b32 s36, s3, 14
    s_lshl_b32 s90, s29, 7
    s_add_u32 s90, s90, s36
    s_xor_b32 s90, s90, 128
    s_lshl_b32 s3, s3, 10
    s_call_b64 s[76:77], PREP_a_issue_4
    s_mov_b32 m0, s19
    s_mov_b32 s39, s16
    s_mov_b32 s40, s17
    s_waitcnt vmcnt(16)
    s_barrier
    s_load_dword s32, s[4:5], s48
    s_waitcnt vmcnt(8)
    s_barrier
    s_add_u32 s54, s52, 16
    s_waitcnt lgkmcnt(0)
    s_cmp_eq_u32 s32, s54
    s_cbranch_scc1 fok_47
    v_mov_b32 v9, s48
    s_mov_b32 s53, 0
    s_add_u32 s54, s52, 16
    s_bfm_b64 exec, 1, 0
poll_48:
    buffer_load_dword v8, v9, s[56:59], 0 offen sc1
    s_waitcnt vmcnt(0)
    v_cmp_eq_u32 vcc, s54, v8
    s_nop 0
    s_cmp_eq_u64 vcc, exec
    s_cbranch_scc1 pok_49
    s_sleep 5
    s_add_u32 s53, s53, 1
    s_cmp_lt_u32 s53, s61
    s_cbranch_scc1 poll_48
    s_mov_b32 s61, 0
pok_49:
    s_mov_b64 exec, -1
fok_47:
    buffer_load_dwordx4 v2, s[12:15], s39 offen sc1 lds
    s_add_u32 m0, m0, 1024
    s_nop 0
    buffer_load_dwordx4 v2, s[12:15], s40 offen sc1 lds
    s_call_b64 s[76:77], PREP_a_issue_4
    s_add_u32 m0, m0, 1024
    s_add_u32 s39, s39, 229376
    buffer_load_dwordx4 v2, s[12:15], s39 offen sc1 lds
    s_add_u32 m0, m0, 1024
    s_add_u32 s40, s40, 229376
    buffer_load_dwordx4 v2, s[12:15], s40 offen sc1 lds
    s_add_u32 m0, m0, 1024
    s_add_u32 s39, s39, s37
    buffer_load_dwordx4 v2, s[12:15], s39 offen sc1 lds
    s_add_u32 m0, m0, 1024
    s_add_u32 s40, s40, s37
    buffer_load_dwordx4 v2, s[12:15], s40 offen sc1 lds
    s_add_u32 m0, m0, 1024
    s_add_u32 s39, s39, 229376
    buffer_load_dwordx4 v2, s[12:15], s39 offen sc1 lds
    s_add_u32 m0, m0, 1024
    s_add_u32 s40, s40, 229376
    buffer_load_dwordx4 v2, s[12:15], s40 offen sc1 lds
    s_mov_b32 m0, s19
    s_mov_b32 s39, s16
    s_mov_b32 s40, s17
    s_waitcnt vmcnt(8)
    s_barrier
    buffer_load_dwordx4 v2, s[12:15], s39 offen sc1 lds
    s_add_u32 m0, m0, 1024
    s_nop 0
    buffer_load_dwordx4 v2, s[12:15], s40 offen sc1 lds
    s_mov_b32 s43, 1
ld_50:
    s_add_u32 s19, s41, s42
    s_lshl_b32 s45, s44, 1
    s_add_u32 s45, s45, 0
    s_sub_u32 s45, s45, 32
    s_mul_i32 s46, s45, 86
    s_lshr_b32 s46, s46, 8
    s_mul_i32 s47, s46, 3
    s_sub_u32 s47, s45, s47
    s_lshl_b32 s47, s47, 2
    s_lshr_b32 s47, 0x362, s47
    s_and_b32 s47, s47, 7
    s_cmp_ge_u32 s44, 10
    s_cselect_b32 s45, 9, 2
    s_cselect_b32 s51, 1, 0
    s_sub_u32 s45, s44, s45
    s_cmp_lt_u32 s44, 3
    s_cselect_b32 s45, 0, s45
    s_cselect_b32 s51, s44, s51
    s_lshl2_add_u32 s51, 0, s51
    s_cmp_lt_u32 s44, 17
    s_cselect_b32 s47, s51, s47
    s_cselect_b32 s46, s45, s46
    s_add_u32 s46, s46, s33
    s_and_b32 s46, s46, 7
    s_mul_i32 s46, s46, 7
    s_add_u32 s16, s46, s47
    s_lshr_b32 s53, s16, 3
    s_lshl_b32 s53, s53, 14
    s_and_b32 s16, s16, 7
    s_lshl_b32 s16, s16, 10
    s_add_u32 s16, s16, s53
    s_add_u32 s16, s16, s38
    s_lshl_b32 s45, s44, 1
    s_add_u32 s45, s45, 1
    s_sub_u32 s45, s45, 32
    s_mul_i32 s46, s45, 86
    s_lshr_b32 s46, s46, 8
    s_mul_i32 s47, s46, 3
    s_sub_u32 s47, s45, s47
    s_lshl_b32 s47, s47, 2
    s_lshr_b32 s47, 0x362, s47
    s_and_b32 s47, s47, 7
    s_cmp_ge_u32 s44, 10
    s_cselect_b32 s45, 9, 2
    s_cselect_b32 s51, 1, 0
    s_sub_u32 s45, s44, s45
    s_cmp_lt_u32 s44, 3
    s_cselect_b32 s45, 0, s45
    s_cselect_b32 s51, s44, s51
    s_lshl2_add_u32 s51, 1, s51
    s_cmp_lt_u32 s44, 17
    s_cselect_b32 s47, s51, s47
    s_cselect_b32 s46, s45, s46
    s_add_u32 s46, s46, s33
    s_and_b32 s46, s46, 7
    s_mul_i32 s46, s46, 7
    s_add_u32 s17, s46, s47
    s_lshr_b32 s53, s17, 3
    s_lshl_b32 s53, s53, 14
    s_and_b32 s17, s17, 7
    s_lshl_b32 s17, s17, 10
    s_add_u32 s17, s17, s53
    s_add_u32 s17, s17, s38
    s_add_u32 s44, s44, 1
    s_add_u32 s42, s42, 16384
    s_cmp_eq_u32 s42, 49152
    s_cselect_b32 s42, 0, s42
    s_add_u32 m0, m0, 1024
    s_add_u32 s39, s39, 229376
    buffer_load_dwordx4 v2, s[12:15], s39 offen sc1 lds
    s_add_u32 m0, m0, 1024
    s_add_u32 s40, s40, 229376
    buffer_load_dwordx4 v2, s[12:15], s40 offen sc1 lds
    s_add_u32 m0, m0, 1024
    s_add_u32 s39, s39, s37
    buffer_load_dwordx4 v2, s[12:15], s39 offen sc1 lds
    s_add_u32 m0, m0, 1024
    s_add_u32 s40, s40, s37
    buffer_load_dwordx4 v2, s[12:15], s40 offen sc1 lds
    s_add_u32 m0, m0, 1024
    s_add_u32 s39, s39, 229376
    buffer_load_dwordx4 v2, s[12:15], s39 offen sc1 lds
    s_add_u32 m0, m0, 1024
    s_add_u32 s40, s40, 229376
    buffer_load_dwordx4 v2, s[12:15], s40 offen sc1 lds
    s_mov_b32 m0, s19
    s_mov_b32 s39, s16
    s_mov_b32 s40, s17
    s_waitcnt vmcnt(8)
    s_barrier
    buffer_load_dwordx4 v2, s[12:15], s39 offen sc1 lds
    s_add_u32 m0, m0, 1024
    s_nop 0
    buffer_load_dwordx4 v2, s[12:15], s40 offen sc1 lds
    s_add_u32 s43, s43, 1
    s_cmp_lt_u32 s43, 4
    s_cbranch_scc1 ld_50
    s_call_b64 s[76:77], PREP_a_issue_4
    s_add_u32 m0, m0, 1024
    s_add_u32 s39, s39, 229376
    buffer_load_dwordx4 v2, s[12:15], s39 offen sc1 lds
    s_add_u32 m0, m0, 1024
    s_add_u32 s40, s40, 229376
    buffer_load_dwordx4 v2, s[12:15], s40 offen sc1 lds
    s_add_u32 m0, m0, 1024
    s_add_u32 s39, s39, s37
    buffer_load_dwordx4 v2, s[12:15], s39 offen sc1 lds
    s_add_u32 m0, m0, 1024
    s_add_u32 s40, s40, s37
    buffer_load_dwordx4 v2, s[12:15], s40 offen sc1 lds
    s_add_u32 m0, m0, 1024
    s_add_u32 s39, s39, 229376
    buffer_load_dwordx4 v2, s[12:15], s39 offen sc1 lds
    s_add_u32 m0, m0, 1024
    s_add_u32 s40, s40, 229376
    buffer_load_dwordx4 v2, s[12:15], s40 offen sc1 lds
    s_mov_b32 m0, s19
    s_mov_b32 s39, s16
    s_mov_b32 s40, s17
    s_waitcnt vmcnt(8)
    s_barrier
    buffer_load_dwordx4 v2, s[12:15], s39 offen sc1 lds
    s_add_u32 m0, m0, 1024
    s_nop 0
    buffer_load_dwordx4 v2, s[12:15], s40 offen sc1 lds
    s_load_dword s32, s[4:5], s34
    s_call_b64 s[76:77], PREP_a_issue_4
    s_add_u32 m0, m0, 1024
    s_add_u32 s39, s39, 229376
    buffer_load_dwordx4 v2, s[12:15], s39 offen sc1 lds
    s_add_u32 m0, m0, 1024
    s_add_u32 s40, s40, 229376
    buffer_load_dwordx4 v2, s[12:15], s40 offen sc1 lds
    s_add_u32 m0, m0, 1024
    s_add_u32 s39, s39, s37
    buffer_load_dwordx4 v2, s[12:15], s39 offen sc1 lds
    s_add_u32 m0, m0, 1024
    s_add_u32 s40, s40, s37
    buffer_load_dwordx4 v2, s[12:15], s40 offen sc1 lds
    s_add_u32 m0, m0, 1024
    s_add_u32 s39, s39, 229376
    buffer_load_dwordx4 v2, s[12:15], s39 offen sc1 lds
    s_add_u32 m0, m0, 1024
    s_add_u32 s40, s40, 229376
    buffer_load_dwordx4 v2, s[12:15], s40 offen sc1 lds
    s_mov_b32 m0, s19
    s_mov_b32 s39, s16
    s_mov_b32 s40, s17
    s_waitcnt vmcnt(8)
    s_barrier
    buffer_load_dwordx4 v2, s[12:15], s39 offen sc1 lds
    s_add_u32 m0, m0, 1024
    s_nop 0
    buffer_load_dwordx4 v2, s[12:15], s40 offen sc1 lds
    s_add_u32 s54, s52, 16
    s_waitcnt lgkmcnt(0)
    s_cmp_eq_u32 s32, s54
    s_cbranch_scc1 fok_51
    v_mov_b32 v9, s34
    s_mov_b32 s53, 0
    s_add_u32 s54, s52, 16
    s_bfm_b64 exec, 1, 0
poll_52:
    buffer_load_dword v8, v9, s[56:59], 0 offen sc1
    s_waitcnt vmcnt(0)
    v_cmp_eq_u32 vcc, s54, v8
    s_nop 0
    s_cmp_eq_u64 vcc, exec
    s_cbranch_scc1 pok_53
    s_sleep 5
    s_add_u32 s53, s53, 1
    s_cmp_lt_u32 s53, s61
    s_cbranch_scc1 poll_52
    s_mov_b32 s61, 0
pok_53:
    s_mov_b64 exec, -1
fok_51:
    s_call_b64 s[76:77], PREP_a_issue_4
    s_add_u32 m0, m0, 1024
    s_add_u32 s39, s39, 229376
    buffer_load_dwordx4 v2, s[12:15], s39 offen sc1 lds
    s_add_u32 m0, m0, 1024
    s_add_u32 s40, s40, 229376
    buffer_load_dwordx4 v2, s[12:15], s40 offen sc1 lds
    s_add_u32 m0, m0, 1024
    s_add_u32 s39, s39, s37
    buffer_load_dwordx4 v2, s[12:15], s39 offen sc1 lds
    s_add_u32 m0, m0, 1024
    s_add_u32 s40, s40, s37
    buffer_load_dwordx4 v2, s[12:15], s40 offen sc1 lds
    s_add_u32 m0, m0, 1024
    s_add_u32 s39, s39, 229376
    buffer_load_dwordx4 v2, s[12:15], s39 offen sc1 lds
    s_add_u32 m0, m0, 1024
    s_add_u32 s40, s40, 229376
    buffer_load_dwordx4 v2, s[12:15], s40 offen sc1 lds
    s_mov_b32 m0, s19
    s_mov_b32 s39, s16
    s_mov_b32 s40, s17
    s_waitcnt vmcnt(8)
    s_barrier
    buffer_load_dwordx4 v2, s[12:15], s39 offen sc1 lds
    s_add_u32 m0, m0, 1024
    s_nop 0
    buffer_load_dwordx4 v2, s[12:15], s40 offen sc1 lds
    s_mov_b32 s43, 1
ld_54:
    s_add_u32 s19, s41, s42
    s_lshl_b32 s45, s44, 1
    s_add_u32 s45, s45, 0
    s_sub_u32 s45, s45, 32
    s_mul_i32 s46, s45, 86
    s_lshr_b32 s46, s46, 8
    s_mul_i32 s47, s46, 3
    s_sub_u32 s47, s45, s47
    s_lshl_b32 s47, s47, 2
    s_lshr_b32 s47, 0x362, s47
    s_and_b32 s47, s47, 7
    s_cmp_ge_u32 s44, 10
    s_cselect_b32 s45, 9, 2
    s_cselect_b32 s51, 1, 0
    s_sub_u32 s45, s44, s45
    s_cmp_lt_u32 s44, 3
    s_cselect_b32 s45, 0, s45
    s_cselect_b32 s51, s44, s51
    s_lshl2_add_u32 s51, 0, s51
    s_cmp_lt_u32 s44, 17
    s_cselect_b32 s47, s51, s47
    s_cselect_b32 s46, s45, s46
    s_add_u32 s46, s46, s33
    s_and_b32 s46, s46, 7
    s_mul_i32 s46, s46, 7
    s_add_u32 s16, s46, s47
    s_lshr_b32 s53, s16, 3
    s_lshl_b32 s53, s53, 14
    s_and_b32 s16, s16, 7
    s_lshl_b32 s16, s16, 10
    s_add_u32 s16, s16, s53
    s_add_u32 s16, s16, s38
    s_lshl_b32 s45, s44, 1
    s_add_u32 s45, s45, 1
    s_sub_u32 s45, s45, 32
    s_mul_i32 s46, s45, 86
    s_lshr_b32 s46, s46, 8
    s_mul_i32 s47, s46, 3
    s_sub_u32 s47, s45, s47
    s_lshl_b32 s47, s47, 2
    s_lshr_b32 s47, 0x362, s47
    s_and_b32 s47, s47, 7
    s_cmp_ge_u32 s44, 10
    s_cselect_b32 s45, 9, 2
    s_cselect_b32 s51, 1, 0
    s_sub_u32 s45, s44, s45
    s_cmp_lt_u32 s44, 3
    s_cselect_b32 s45, 0, s45
    s_cselect_b32 s51, s44, s51
    s_lshl2_add_u32 s51, 1, s51
    s_cmp_lt_u32 s44, 17
    s_cselect_b32 s47, s51, s47
    s_cselect_b32 s46, s45, s46
    s_add_u32 s46, s46, s33
    s_and_b32 s46, s46, 7
    s_mul_i32 s46, s46, 7
    s_add_u32 s17, s46, s47
    s_lshr_b32 s53, s17, 3
    s_lshl_b32 s53, s53, 14
    s_and_b32 s17, s17, 7
    s_lshl_b32 s17, s17, 10
    s_add_u32 s17, s17, s53
    s_add_u32 s17, s17, s38
    s_add_u32 s44, s44, 1
    s_add_u32 s42, s42, 16384
    s_cmp_eq_u32 s42, 49152
    s_cselect_b32 s42, 0, s42
    s_add_u32 m0, m0, 1024
    s_add_u32 s39, s39, 229376
    buffer_load_dwordx4 v2, s[12:15], s39 offen sc1 lds
    s_add_u32 m0, m0, 1024
    s_add_u32 s40, s40, 229376
    buffer_load_dwordx4 v2, s[12:15], s40 offen sc1 lds
    s_add_u32 m0, m0, 1024
    s_add_u32 s39, s39, s37
    buffer_load_dwordx4 v2, s[12:15], s39 offen sc1 lds
    s_add_u32 m0, m0, 1024
    s_add_u32 s40, s40, s37
    buffer_load_dwordx4 v2, s[12:15], s40 offen sc1 lds
    s_add_u32 m0, m0, 1024
    s_add_u32 s39, s39, 229376
    buffer_load_dwordx4 v2, s[12:15], s39 offen sc1 lds
    s_add_u32 m0, m0, 1024
    s_add_u32 s40, s40, 229376
    buffer_load_dwordx4 v2, s[12:15], s40 offen sc1 lds
    s_mov_b32 m0, s19
    s_mov_b32 s39, s16
    s_mov_b32 s40, s17
    s_waitcnt vmcnt(8)
    s_barrier
    buffer_load_dwordx4 v2, s[12:15], s39 offen sc1 lds
    s_add_u32 m0, m0, 1024
    s_nop 0
    buffer_load_dwordx4 v2, s[12:15], s40 offen sc1 lds
    s_add_u32 s43, s43, 1
    s_cmp_lt_u32 s43, 5
    s_cbranch_scc1 ld_54
    s_call_b64 s[76:77], PREP_a_issue_4
    s_add_u32 m0, m0, 1024
    s_add_u32 s39, s39, 229376
    buffer_load_dwordx4 v2, s[12:15], s39 offen sc1 lds
    s_add_u32 m0, m0, 1024
    s_add_u32 s40, s40, 229376
    buffer_load_dwordx4 v2, s[12:15], s40 offen sc1 lds
    s_add_u32 m0, m0, 1024
    s_add_u32 s39, s39, s37
    buffer_load_dwordx4 v2, s[12:15], s39 offen sc1 lds
    s_add_u32 m0, m0, 1024
    s_add_u32 s40, s40, s37
    buffer_load_dwordx4 v2, s[12:15], s40 offen sc1 lds
    s_add_u32 m0, m0, 1024
    s_add_u32 s39, s39, 229376
    buffer_load_dwordx4 v2, s[12:15], s39 offen sc1 lds
    s_add_u32 m0, m0, 1024
    s_add_u32 s40, s40, 229376
    buffer_load_dwordx4 v2, s[12:15], s40 offen sc1 lds
    s_mov_b32 m0, s19
    s_mov_b32 s39, s16
    s_mov_b32 s40, s17
    s_waitcnt vmcnt(8)
    s_barrier
    buffer_load_dwordx4 v2, s[12:15], s39 offen sc1 lds
    s_add_u32 m0, m0, 1024
    s_nop 0
    buffer_load_dwordx4 v2, s[12:15], s40 offen sc1 lds
    s_load_dword s32, s[4:5], s35
    s_call_b64 s[76:77], PREP_a_issue_4
    s_add_u32 m0, m0, 1024
    s_add_u32 s39, s39, 229376
    buffer_load_dwordx4 v2, s[12:15], s39 offen sc1 lds
    s_add_u32 m0, m0, 1024
    s_add_u32 s40, s40, 229376
    buffer_load_dwordx4 v2, s[12:15], s40 offen sc1 lds
    s_add_u32 m0, m0, 1024
    s_add_u32 s39, s39, s37
    buffer_load_dwordx4 v2, s[12:15], s39 offen sc1 lds
    s_add_u32 m0, m0, 1024
    s_add_u32 s40, s40, s37
    buffer_load_dwordx4 v2, s[12:15], s40 offen sc1 lds
    s_add_u32 m0, m0, 1024
    s_add_u32 s39, s39, 229376
    buffer_load_dwordx4 v2, s[12:15], s39 offen sc1 lds
    s_add_u32 m0, m0, 1024
    s_add_u32 s40, s40, 229376
    buffer_load_dwordx4 v2, s[12:15], s40 offen sc1 lds
    s_mov_b32 m0, s19
    s_mov_b32 s39, s16
    s_mov_b32 s40, s17
    s_waitcnt vmcnt(8)
    s_barrier
    buffer_load_dwordx4 v2, s[12:15], s39 offen sc1 lds
    s_add_u32 m0, m0, 1024
    s_nop 0
    buffer_load_dwordx4 v2, s[12:15], s40 offen sc1 lds
    s_add_u32 s54, s52, 16
    s_waitcnt lgkmcnt(0)
    s_cmp_eq_u32 s32, s54
    s_cbranch_scc1 fok_55
    v_mov_b32 v9, s35
    s_mov_b32 s53, 0
    s_add_u32 s54, s52, 16
    s_bfm_b64 exec, 1, 0
poll_56:
    buffer_load_dword v8, v9, s[56:59], 0 offen sc1
    s_waitcnt vmcnt(0)
    v_cmp_eq_u32 vcc, s54, v8
    s_nop 0
    s_cmp_eq_u64 vcc, exec
    s_cbranch_scc1 pok_57
    s_sleep 5
    s_add_u32 s53, s53, 1
    s_cmp_lt_u32 s53, s61
    s_cbranch_scc1 poll_56
    s_mov_b32 s61, 0
pok_57:
    s_mov_b64 exec, -1
fok_55:
    s_call_b64 s[76:77], PREP_a_issue_4
    s_add_u32 m0, m0, 1024
    s_add_u32 s39, s39, 229376
    buffer_load_dwordx4 v2, s[12:15], s39 offen sc1 lds
    s_add_u32 m0, m0, 1024
    s_add_u32 s40, s40, 229376
    buffer_load_dwordx4 v2, s[12:15], s40 offen sc1 lds
    s_add_u32 m0, m0, 1024
    s_add_u32 s39, s39, s37
    buffer_load_dwordx4 v2, s[12:15], s39 offen sc1 lds
    s_add_u32 m0, m0, 1024
    s_add_u32 s40, s40, s37
    buffer_load_dwordx4 v2, s[12:15], s40 offen sc1 lds
    s_add_u32 m0, m0, 1024
    s_add_u32 s39, s39, 229376
    buffer_load_dwordx4 v2, s[12:15], s39 offen sc1 lds
    s_add_u32 m0, m0, 1024
    s_add_u32 s40, s40, 229376
    buffer_load_dwordx4 v2, s[12:15], s40 offen sc1 lds
    s_mov_b32 m0, s19
    s_mov_b32 s39, s16
    s_mov_b32 s40, s17
    s_waitcnt vmcnt(8)
    s_barrier
    buffer_load_dwordx4 v2, s[12:15], s39 offen sc1 lds
    s_add_u32 m0, m0, 1024
    s_nop 0
    buffer_load_dwordx4 v2, s[12:15], s40 offen sc1 lds
    s_mov_b32 s43, 1
ld_58:
    s_add_u32 s19, s41, s42
    s_lshl_b32 s45, s44, 1
    s_add_u32 s45, s45, 0
    s_sub_u32 s45, s45, 32
    s_mul_i32 s46, s45, 86
    s_lshr_b32 s46, s46, 8
    s_mul_i32 s47, s46, 3
    s_sub_u32 s47, s45, s47
    s_lshl_b32 s47, s47, 2
    s_lshr_b32 s47, 0x362, s47
    s_and_b32 s47, s47, 7
    s_cmp_ge_u32 s44, 10
    s_cselect_b32 s45, 9, 2
    s_cselect_b32 s51, 1, 0
    s_sub_u32 s45, s44, s45
    s_cmp_lt_u32 s44, 3
    s_cselect_b32 s45, 0, s45
    s_cselect_b32 s51, s44, s51
    s_lshl2_add_u32 s51, 0, s51
    s_cmp_lt_u32 s44, 17
    s_cselect_b32 s47, s51, s47
    s_cselect_b32 s46, s45, s46
    s_add_u32 s46, s46, s33
    s_and_b32 s46, s46, 7
    s_mul_i32 s46, s46, 7
    s_add_u32 s16, s46, s47
    s_lshr_b32 s53, s16, 3
    s_lshl_b32 s53, s53, 14
    s_and_b32 s16, s16, 7
    s_lshl_b32 s16, s16, 10
    s_add_u32 s16, s16, s53
    s_add_u32 s16, s16, s38
    s_lshl_b32 s45, s44, 1
    s_add_u32 s45, s45, 1
    s_sub_u32 s45, s45, 32
    s_mul_i32 s46, s45, 86
    s_lshr_b32 s46, s46, 8
    s_mul_i32 s47, s46, 3
    s_sub_u32 s47, s45, s47
    s_lshl_b32 s47, s47, 2
    s_lshr_b32 s47, 0x362, s47
    s_and_b32 s47, s47, 7
    s_cmp_ge_u32 s44, 10
    s_cselect_b32 s45, 9, 2
    s_cselect_b32 s51, 1, 0
    s_sub_u32 s45, s44, s45
    s_cmp_lt_u32 s44, 3
    s_cselect_b32 s45, 0, s45
    s_cselect_b32 s51, s44, s51
    s_lshl2_add_u32 s51, 1, s51
    s_cmp_lt_u32 s44, 17
    s_cselect_b32 s47, s51, s47
    s_cselect_b32 s46, s45, s46
    s_add_u32 s46, s46, s33
    s_and_b32 s46, s46, 7
    s_mul_i32 s46, s46, 7
    s_add_u32 s17, s46, s47
    s_lshr_b32 s53, s17, 3
    s_lshl_b32 s53, s53, 14
    s_and_b32 s17, s17, 7
    s_lshl_b32 s17, s17, 10
    s_add_u32 s17, s17, s53
    s_add_u32 s17, s17, s38
    s_add_u32 s44, s44, 1
    s_add_u32 s42, s42, 16384
    s_cmp_eq_u32 s42, 49152
    s_cselect_b32 s42, 0, s42
    s_add_u32 m0, m0, 1024
    s_add_u32 s39, s39, 229376
    buffer_load_dwordx4 v2, s[12:15], s39 offen sc1 lds
    s_add_u32 m0, m0, 1024
    s_add_u32 s40, s40, 229376
    buffer_load_dwordx4 v2, s[12:15], s40 offen sc1 lds
    s_add_u32 m0, m0, 1024
    s_add_u32 s39, s39, s37
    buffer_load_dwordx4 v2, s[12:15], s39 offen sc1 lds
    s_add_u32 m0, m0, 1024
    s_add_u32 s40, s40, s37
    buffer_load_dwordx4 v2, s[12:15], s40 offen sc1 lds
    s_add_u32 m0, m0, 1024
    s_add_u32 s39, s39, 229376
    buffer_load_dwordx4 v2, s[12:15], s39 offen sc1 lds
    s_add_u32 m0, m0, 1024
    s_add_u32 s40, s40, 229376
    buffer_load_dwordx4 v2, s[12:15], s40 offen sc1 lds
    s_mov_b32 m0, s19
    s_mov_b32 s39, s16
    s_mov_b32 s40, s17
    s_waitcnt vmcnt(8)
    s_barrier
    buffer_load_dwordx4 v2, s[12:15], s39 offen sc1 lds
    s_add_u32 m0, m0, 1024
    s_nop 0
    buffer_load_dwordx4 v2, s[12:15], s40 offen sc1 lds
    s_add_u32 s43, s43, 1
    s_cmp_lt_u32 s43, 5
    s_cbranch_scc1 ld_58
    s_call_b64 s[76:77], PREP_a_issue_4
    s_add_u32 m0, m0, 1024
    s_add_u32 s39, s39, 229376
    buffer_load_dwordx4 v2, s[12:15], s39 offen sc1 lds
    s_add_u32 m0, m0, 1024
    s_add_u32 s40, s40, 229376
    buffer_load_dwordx4 v2, s[12:15], s40 offen sc1 lds
    s_add_u32 m0, m0, 1024
    s_add_u32 s39, s39, s37
    buffer_load_dwordx4 v2, s[12:15], s39 offen sc1 lds
    s_add_u32 m0, m0, 1024
    s_add_u32 s40, s40, s37
    buffer_load_dwordx4 v2, s[12:15], s40 offen sc1 lds
    s_add_u32 m0, m0, 1024
    s_add_u32 s39, s39, 229376
    buffer_load_dwordx4 v2, s[12:15], s39 offen sc1 lds
    s_add_u32 m0, m0, 1024
    s_add_u32 s40, s40, 229376
    buffer_load_dwordx4 v2, s[12:15], s40 offen sc1 lds
    s_mov_b32 m0, s19
    s_mov_b32 s39, s16
    s_mov_b32 s40, s17
    s_waitcnt vmcnt(8)
    s_barrier
    s_add_u32 s39, s38, s37
    s_add_u32 s39, s39, 229376
    s_add_u32 m0, s41, 16384
    s_add_u32 s16, s39, s78
    s_add_u32 s17, s39, s79
    buffer_load_dwordx4 v2, s[12:15], s16 offen sc1 lds
    s_add_u32 m0, m0, 1024
    s_nop 0
    buffer_load_dwordx4 v2, s[12:15], s17 offen sc1 lds
    s_add_u32 m0, m0, 1024
    s_add_u32 s16, s16, 229376
    buffer_load_dwordx4 v2, s[12:15], s16 offen sc1 lds
    s_add_u32 m0, m0, 1024
    s_add_u32 s17, s17, 229376
    buffer_load_dwordx4 v2, s[12:15], s17 offen sc1 lds
    s_add_u32 m0, m0, 1024
    s_add_u32 s16, s39, s80
    s_add_u32 s17, s39, s81
    buffer_load_dwordx4 v2, s[12:15], s16 offen sc1 lds
    s_add_u32 m0, m0, 1024
    s_nop 0
    buffer_load_dwordx4 v2, s[12:15], s17 offen sc1 lds
    s_add_u32 m0, m0, 1024
    s_add_u32 s16, s16, 229376
    buffer_load_dwordx4 v2, s[12:15], s16 offen sc1 lds
    s_add_u32 m0, m0, 1024
    s_add_u32 s17, s17, 229376
    buffer_load_dwordx4 v2, s[12:15], s17 offen sc1 lds
    s_waitcnt vmcnt(8)
    s_barrier
    s_add_u32 m0, s41, 32768
    s_add_u32 s16, s39, s82
    s_add_u32 s17, s39, s83
    buffer_load_dwordx4 v2, s[12:15], s16 offen sc1 lds
    s_add_u32 m0, m0, 1024
    s_nop 0
    buffer_load_dwordx4 v2, s[12:15], s17 offen sc1 lds
    s_add_u32 m0, m0, 1024
    s_add_u32 s16, s16, 229376
    buffer_load_dwordx4 v2, s[12:15], s16 offen sc1 lds
    s_add_u32 m0, m0, 1024
    s_add_u32 s17, s17, 229376
    buffer_load_dwordx4 v2, s[12:15], s17 offen sc1 lds
    s_add_u32 m0, m0, 1024
    s_add_u32 s16, s39, s84
    s_add_u32 s17, s39, s85
    buffer_load_dwordx4 v2, s[12:15], s16 offen sc1 lds
    s_add_u32 m0, m0, 1024
    s_nop 0
    buffer_load_dwordx4 v2, s[12:15], s17 offen sc1 lds
    s_add_u32 m0, m0, 1024
    s_add_u32 s16, s16, 229376
    buffer_load_dwordx4 v2, s[12:15], s16 offen sc1 lds
    s_add_u32 m0, m0, 1024
    s_add_u32 s17, s17, 229376
    buffer_load_dwordx4 v2, s[12:15], s17 offen sc1 lds
    s_waitcnt vmcnt(8)
    s_barrier
    s_add_u32 m0, s41, 0
    s_add_u32 s16, s39, s86
    s_add_u32 s17, s39, s87
    buffer_load_dwordx4 v2, s[12:15], s16 offen sc1 lds
    s_add_u32 m0, m0, 1024
    s_nop 0
    buffer_load_dwordx4 v2, s[12:15], s17 offen sc1 lds
    s_add_u32 m0, m0, 1024
    s_add_u32 s16, s16, 229376
    buffer_load_dwordx4 v2, s[12:15], s16 offen sc1 lds
    s_add_u32 m0, m0, 1024
    s_add_u32 s17, s17, 229376
    buffer_load_dwordx4 v2, s[12:15], s17 offen sc1 lds
    s_add_u32 m0, m0, 1024
    s_add_u32 s16, s39, s88
    s_add_u32 s17, s39, s89
    buffer_load_dwordx4 v2, s[12:15], s16 offen sc1 lds
    s_add_u32 m0, m0, 1024
    s_nop 0
    buffer_load_dwordx4 v2, s[12:15], s17 offen sc1 lds
    s_add_u32 m0, m0, 1024
    s_add_u32 s16, s16, 229376
    buffer_load_dwordx4 v2, s[12:15], s16 offen sc1 lds
    s_add_u32 m0, m0, 1024
    s_add_u32 s17, s17, 229376
    buffer_load_dwordx4 v2, s[12:15], s17 offen sc1 lds
    s_cmp_lg_u32 s60, 0
    s_cbranch_scc1 tl_59
    s_call_b64 s[76:77], SUB_w1_piece_23
    s_waitcnt vmcnt(10)
    s_branch tz_60
tl_59:
    s_waitcnt vmcnt(8)
tz_60:
    s_barrier
    s_mov_b32 s39, s38
    s_add_u32 m0, s41, 16384
    s_add_u32 s16, s39, s78
    s_add_u32 s17, s39, s79
    buffer_load_dwordx4 v2, s[12:15], s16 offen sc1 lds
    s_add_u32 m0, m0, 1024
    s_nop 0
    buffer_load_dwordx4 v2, s[12:15], s17 offen sc1 lds
    s_add_u32 m0, m0, 1024
    s_add_u32 s16, s16, 229376
    buffer_load_dwordx4 v2, s[12:15], s16 offen sc1 lds
    s_add_u32 m0, m0, 1024
    s_add_u32 s17, s17, 229376
    buffer_load_dwordx4 v2, s[12:15], s17 offen sc1 lds
    s_add_u32 m0, m0, 1024
    s_add_u32 s16, s39, s80
    s_add_u32 s17, s39, s81
    buffer_load_dwordx4 v2, s[12:15], s16 offen sc1 lds
    s_add_u32 m0, m0, 1024
    s_nop 0
    buffer_load_dwordx4 v2, s[12:15], s17 offen sc1 lds
    s_add_u32 m0, m0, 1024
    s_add_u32 s16, s16, 229376
    buffer_load_dwordx4 v2, s[12:15], s16 offen sc1 lds
    s_add_u32 m0, m0, 1024
    s_add_u32 s17, s17, 229376
    buffer_load_dwordx4 v2, s[12:15], s17 offen sc1 lds
    s_cmp_lg_u32 s60, 0
    s_cbranch_scc1 tl_61
    s_call_b64 s[76:77], SUB_w1_piece_24
    s_waitcnt vmcnt(14)
    s_branch tz_62
tl_61:
    s_waitcnt vmcnt(8)
tz_62:
    s_barrier
    s_add_u32 m0, s41, 32768
    s_add_u32 s16, s39, s82
    s_add_u32 s17, s39, s83
    buffer_load_dwordx4 v2, s[12:15], s16 offen sc1 lds
    s_add_u32 m0, m0, 1024
    s_nop 0
    buffer_load_dwordx4 v2, s[12:15], s17 offen sc1 lds
    s_add_u32 m0, m0, 1024
    s_add_u32 s16, s16, 229376
    buffer_load_dwordx4 v2, s[12:15], s16 offen sc1 lds
    s_add_u32 m0, m0, 1024
    s_add_u32 s17, s17, 229376
    buffer_load_dwordx4 v2, s[12:15], s17 offen sc1 lds
    s_add_u32 m0, m0, 1024
    s_add_u32 s16, s39, s84
    s_add_u32 s17, s39, s85
    buffer_load_dwordx4 v2, s[12:15], s16 offen sc1 lds
    s_add_u32 m0, m0, 1024
    s_nop 0
    buffer_load_dwordx4 v2, s[12:15], s17 offen sc1 lds
    s_add_u32 m0, m0, 1024
    s_add_u32 s16, s16, 229376
    buffer_load_dwordx4 v2, s[12:15], s16 offen sc1 lds
    s_add_u32 m0, m0, 1024
    s_add_u32 s17, s17, 229376
    buffer_load_dwordx4 v2, s[12:15], s17 offen sc1 lds
    s_cmp_lg_u32 s60, 0
    s_cbranch_scc1 tl_63
    s_call_b64 s[76:77], SUB_w1_piece_25
    s_waitcnt vmcnt(16)
    s_branch tz_64
tl_63:
    s_waitcnt vmcnt(8)
tz_64:
    s_barrier
    s_add_u32 m0, s41, 0
    s_add_u32 s16, s39, s86
    s_add_u32 s17, s39, s87
    buffer_load_dwordx4 v2, s[12:15], s16 offen sc1 lds
    s_add_u32 m0, m0, 1024
    s_nop 0
    buffer_load_dwordx4 v2, s[12:15], s17 offen sc1 lds
    s_add_u32 m0, m0, 1024
    s_add_u32 s16, s16, 229376
    buffer_load_dwordx4 v2, s[12:15], s16 offen sc1 lds
    s_add_u32 m0, m0, 1024
    s_add_u32 s17, s17, 229376
    buffer_load_dwordx4 v2, s[12:15], s17 offen sc1 lds
    s_add_u32 m0, m0, 1024
    s_add_u32 s16, s39, s88
    s_add_u32 s17, s39, s89
    buffer_load_dwordx4 v2, s[12:15], s16 offen sc1 lds
    s_add_u32 m0, m0, 1024
    s_nop 0
    buffer_load_dwordx4 v2, s[12:15], s17 offen sc1 lds
    s_add_u32 m0, m0, 1024
    s_add_u32 s16, s16, 229376
    buffer_load_dwordx4 v2, s[12:15], s16 offen sc1 lds
    s_add_u32 m0, m0, 1024
    s_add_u32 s17, s17, 229376
    buffer_load_dwordx4 v2, s[12:15], s17 offen sc1 lds
    s_cmp_lg_u32 s60, 0
    s_cbranch_scc1 tl_65
    s_call_b64 s[76:77], SUB_w1_piece_26
    s_waitcnt vmcnt(18)
    s_branch tz_66
tl_65:
    s_waitcnt vmcnt(8)
tz_66:
    s_barrier
    s_cmp_lg_u32 s60, 0
    s_cbranch_scc1 tl_67
    s_call_b64 s[76:77], SUB_w1_piece_27
    s_waitcnt vmcnt(10)
    s_branch tz_68
tl_67:
    s_waitcnt vmcnt(0)
tz_68:
    s_barrier
    s_cmp_eq_u32 s60, 1
    s_cbranch_scc1 K_fin
    s_branch Y_END
WLOAD:
    s_mov_b64 s[12:13], s[72:73]
    s_mov_b32 s14, 7340032
    s_mov_b32 s15, 0x20000
    s_and_b32 s35, s30, 1
    s_mul_i32 s38, s29, 448
    s_mul_i32 s41, s35, 229376
    s_add_u32 s38, s38, s41
    s_mul_i32 s41, s35, 14336
    s_add_u32 s41, s41, 49152
    s_mov_b32 s42, 0
    s_mov_b32 s44, s29
    s_add_u32 s44, s44, 1
    s_and_b32 s44, s44, 15
    s_add_u32 s44, s44, 1
    s_and_b32 s44, s44, 15
    s_add_u32 s46, s29, 1
    s_and_b32 s46, s46, 15
    s_cmp_eq_u32 s28, s29
    s_cselect_b32 s47, s46, s28
    s_mov_b32 s42, 57344
    s_call_b64 s[76:77], PREP_w_issue_3
    s_mov_b32 m0, s19
    s_mov_b32 s39, s16
    s_waitcnt vmcnt(0)
    s_and_b32 s53, s30, 3
    s_lshl_b32 s53, s53, 7
    s_add_u32 s53, s53, s55
    s_add_u32 s53, s53, 0x400
    v_mov_b32 v14, 1
    v_mov_b32 v15, 0
    s_mov_b64 exec, 1
    buffer_atomic_add v14, v15, s[56:59], s53 offen sc1
    s_mov_b64 exec, -1
    s_call_b64 s[76:77], SUB_rest_2
    s_waitcnt lgkmcnt(0)
    buffer_load_dwordx4 v121, s[12:15], s39 offen  lds
    s_add_u32 m0, m0, 1024
    s_nop 0
    buffer_load_dwordx4 v122, s[12:15], s39 offen  lds
    s_add_u32 m0, m0, 1024
    s_nop 0
    buffer_load_dwordx4 v123, s[12:15], s39 offen  lds
    s_call_b64 s[76:77], PREP_w_issue_3
    s_add_u32 m0, m0, 1024
    s_nop 0
    buffer_load_dwordx4 v124, s[12:15], s39 offen  lds
    s_add_u32 m0, m0, 1024
    s_nop 0
    buffer_load_dwordx4 v125, s[12:15], s39 offen  lds
    s_add_u32 m0, m0, 1024
    s_nop 0
    buffer_load_dwordx4 v126, s[12:15], s39 offen  lds
    s_add_u32 m0, m0, 1024
    s_nop 0
    buffer_load_dwordx4 v127, s[12:15], s39 offen  lds
    s_add_u32 m0, m0, 1024
    s_add_u32 s39, s39, 114688
    buffer_load_dwordx4 v121, s[12:15], s39 offen  lds
    s_add_u32 m0, m0, 1024
    s_nop 0
    buffer_load_dwordx4 v122, s[12:15], s39 offen  lds
    s_add_u32 m0, m0, 1024
    s_nop 0
    buffer_load_dwordx4 v123, s[12:15], s39 offen  lds
    s_add_u32 m0, m0, 1024
    s_nop 0
    buffer_load_dwordx4 v124, s[12:15], s39 offen  lds
    s_add_u32 m0, m0, 1024
    s_nop 0
    buffer_load_dwordx4 v125, s[12:15], s39 offen  lds
    s_add_u32 m0, m0, 1024
    s_nop 0
    buffer_load_dwordx4 v126, s[12:15], s39 offen  lds
    s_add_u32 m0, m0, 1024
    s_nop 0
    buffer_load_dwordx4 v127, s[12:15], s39 offen  lds
    s_mov_b32 m0, s19
    s_mov_b32 s39, s16
    s_cmp_lg_u32 s60, 0
    s_cbranch_scc1 cs_69
    s_and_b32 s35, s30, 1
    v_lshrrev_b32 v112, 2, v1
    v_mul_u32_u24 v104, 448, v112
    v_and_b32 v113, 3, v1
    v_lshl_add_u32 v104, v113, 3, v104
    v_add_u32 v104, 49152, v104
    v_mul_u32_u24 v106, 448, v112
    v_and_b32 v113, 2, v1
    v_lshl_add_u32 v106, v113, 2, v106
    v_bfe_u32 v112, v1, 4, 1
    v_and_b32 v113, 1, v1
    v_xor_b32 v113, v113, v112
    v_lshl_add_u32 v106, v113, 5, v106
    s_lshl_b32 s36, s35, 4
    s_add_u32 s36, s36, 49344
    v_add_u32 v106, s36, v106
    s_lshl_b32 s36, s35, 8
    v_add_u32 v104, s36, v104
    v_lshlrev_b32 v112, 5, v112
    v_sub_u32 v105, v104, v112
    v_add_u32 v104, v104, v112
    s_cmp_eq_u32 s28, s29
    s_cselect_b32 s36, 0, 28672
    v_add_u32 v104, s36, v104
    v_add_u32 v105, s36, v105
    v_add_u32 v106, s36, v106
    ds_read_b64_tr_b16 v[48:49], v104 offset:0
    ds_read_b64_tr_b16 v[50:51], v104 offset:7168
    ds_read_b64_tr_b16 v[52:53], v104 offset:14336
    ds_read_b64_tr_b16 v[54:55], v104 offset:21504
    ds_read_b64_tr_b16 v[56:57], v105 offset:32
    ds_read_b64_tr_b16 v[58:59], v105 offset:7200
    ds_read_b64_tr_b16 v[60:61], v105 offset:14368
    ds_read_b64_tr_b16 v[62:63], v105 offset:21536
    ds_read_b64_tr_b16 v[64:65], v104 offset:64
    ds_read_b64_tr_b16 v[66:67], v104 offset:7232
    ds_read_b64_tr_b16 v[68:69], v104 offset:14400
    ds_read_b64_tr_b16 v[70:71], v104 offset:21568
    ds_read_b64_tr_b16 v[72:73], v105 offset:96
    ds_read_b64_tr_b16 v[74:75], v105 offset:7264
    ds_read_b64_tr_b16 v[76:77], v105 offset:14432
    ds_read_b64_tr_b16 v[78:79], v105 offset:21600
    ds_read_b64_tr_b16 v[80:81], v104 offset:128
    ds_read_b64_tr_b16 v[82:83], v104 offset:7296
    ds_read_b64_tr_b16 v[84:85], v104 offset:14464
    ds_read_b64_tr_b16 v[86:87], v104 offset:21632
    ds_read_b64_tr_b16 v[88:89], v105 offset:160
    ds_read_b64_tr_b16 v[90:91], v105 offset:7328
    ds_read_b64_tr_b16 v[92:93], v105 offset:14496
    ds_read_b64_tr_b16 v[94:95], v105 offset:21664
    ds_read_b64_tr_b16 v[96:97], v106 offset:0
    ds_read_b64_tr_b16 v[98:99], v106 offset:7168
    ds_read_b64_tr_b16 v[100:101], v106 offset:14336
    ds_read_b64_tr_b16 v[102:103], v106 offset:21504
    v_and_b32 v112, 15, v1
    v_mov_b32 v113, 0x3f803f80
    v_cmp_eq_u32 vcc, 0, v112
    s_nop 1
    v_cndmask_b32 v20, 0, v113, vcc
    v_cndmask_b32 v21, 0, v113, vcc
    v_cndmask_b32 v22, 0, v113, vcc
    v_cndmask_b32 v23, 0, v113, vcc
    v_cmp_eq_u32 vcc, 1, v112
    s_nop 1
    v_cndmask_b32 v24, 0, v113, vcc
    v_cndmask_b32 v25, 0, v113, vcc
    v_cndmask_b32 v26, 0, v113, vcc
    v_cndmask_b32 v27, 0, v113, vcc
    v_cmp_eq_u32 vcc, 2, v112
    s_nop 1
    v_cndmask_b32 v28, 0, v113, vcc
    v_cndmask_b32 v29, 0, v113, vcc
    v_cndmask_b32 v30, 0, v113, vcc
    v_cndmask_b32 v31, 0, v113, vcc
    v_cmp_eq_u32 vcc, 3, v112
    s_nop 1
    v_cndmask_b32 v32, 0, v113, vcc
    v_cndmask_b32 v33, 0, v113, vcc
    v_cndmask_b32 v34, 0, v113, vcc
    v_cndmask_b32 v35, 0, v113, vcc
    v_cmp_eq_u32 vcc, 4, v112
    s_nop 1
    v_cndmask_b32 v36, 0, v113, vcc
    v_cndmask_b32 v37, 0, v113, vcc
    v_cndmask_b32 v38, 0, v113, vcc
    v_cndmask_b32 v39, 0, v113, vcc
    v_cmp_eq_u32 vcc, 5, v112
    s_nop 1
    v_cndmask_b32 v40, 0, v113, vcc
    v_cndmask_b32 v41, 0, v113, vcc
    v_cndmask_b32 v42, 0, v113, vcc
    v_cndmask_b32 v43, 0, v113, vcc
    v_cmp_eq_u32 vcc, 6, v112
    s_nop 1
    v_cndmask_b32 v44, 0, v113, vcc
    v_cndmask_b32 v45, 0, v113, vcc
    v_cndmask_b32 v46, 0, v113, vcc
    v_cndmask_b32 v47, 0, v113, vcc
    v_and_b32 v114, 48, v1
    v_lshl_add_u32 v114, v112, 6, v114
    v_mov_b32 v113, 0x7f000000
    v_cmp_gt_u32 vcc, 7, v112
    s_nop 1
    v_cndmask_b32 v114, v113, v114, vcc
    s_add_u32 s20, s4, 0x1420000
    s_addc_u32 s21, s5, 0
    s_mov_b32 s22, 0x38000
    s_mov_b32 s23, 0x20000
    s_mul_i32 s36, s28, 14336
    s_lshl1_add_u32 s35, s29, s35
    s_mul_i32 s35, s35, 448
    s_add_u32 s35, s35, s36
    s_waitcnt lgkmcnt(0)
    v_mfma_f32_16x16x32_bf16 v[108:111], v[48:51], v[20:23], 0
    v_mfma_f32_16x16x32_bf16 v[108:111], v[52:55], v[20:23], v[108:111]
    v_mfma_f32_16x16x32_bf16 v[108:111], v[56:59], v[24:27], v[108:111]
    v_mfma_f32_16x16x32_bf16 v[108:111], v[60:63], v[24:27], v[108:111]
    v_mfma_f32_16x16x32_bf16 v[108:111], v[64:67], v[28:31], v[108:111]
    v_mfma_f32_16x16x32_bf16 v[108:111], v[68:71], v[28:31], v[108:111]
    v_mfma_f32_16x16x32_bf16 v[108:111], v[72:75], v[32:35], v[108:111]
    v_mfma_f32_16x16x32_bf16 v[108:111], v[76:79], v[32:35], v[108:111]
    v_mfma_f32_16x16x32_bf16 v[108:111], v[80:83], v[36:39], v[108:111]
    v_mfma_f32_16x16x32_bf16 v[108:111], v[84:87], v[36:39], v[108:111]
    v_mfma_f32_16x16x32_bf16 v[108:111], v[88:91], v[40:43], v[108:111]
    v_mfma_f32_16x16x32_bf16 v[108:111], v[92:95], v[40:43], v[108:111]
    v_mfma_f32_16x16x32_bf16 v[108:111], v[96:99], v[44:47], v[108:111]
    v_mfma_f32_16x16x32_bf16 v[108:111], v[100:103], v[44:47], v[108:111]
    s_nop 7
    buffer_store_dwordx4 v[108:111], v114, s[20:23], s35 offen sc1
cs_69:
    s_waitcnt vmcnt(15)
    s_barrier
    buffer_load_dwordx4 v121, s[12:15], s39 offen  lds
    s_add_u32 m0, m0, 1024
    s_nop 0
    buffer_load_dwordx4 v122, s[12:15], s39 offen  lds
    s_add_u32 m0, m0, 1024
    s_nop 0
    buffer_load_dwordx4 v123, s[12:15], s39 offen  lds
    s_call_b64 s[76:77], PREP_w_issue_3
    s_add_u32 m0, m0, 1024
    s_nop 0
    buffer_load_dwordx4 v124, s[12:15], s39 offen  lds
    s_add_u32 m0, m0, 1024
    s_nop 0
    buffer_load_dwordx4 v125, s[12:15], s39 offen  lds
    s_add_u32 m0, m0, 1024
    s_nop 0
    buffer_load_dwordx4 v126, s[12:15], s39 offen  lds
    s_add_u32 m0, m0, 1024
    s_nop 0
    buffer_load_dwordx4 v127, s[12:15], s39 offen  lds
    s_add_u32 m0, m0, 1024
    s_add_u32 s39, s39, 114688
    buffer_load_dwordx4 v121, s[12:15], s39 offen  lds
    s_add_u32 m0, m0, 1024
    s_nop 0
    buffer_load_dwordx4 v122, s[12:15], s39 offen  lds
    s_add_u32 m0, m0, 1024
    s_nop 0
    buffer_load_dwordx4 v123, s[12:15], s39 offen  lds
    s_add_u32 m0, m0, 1024
    s_nop 0
    buffer_load_dwordx4 v124, s[12:15], s39 offen  lds
    s_add_u32 m0, m0, 1024
    s_nop 0
    buffer_load_dwordx4 v125, s[12:15], s39 offen  lds
    s_add_u32 m0, m0, 1024
    s_nop 0
    buffer_load_dwordx4 v126, s[12:15], s39 offen  lds
    s_add_u32 m0, m0, 1024
    s_nop 0
    buffer_load_dwordx4 v127, s[12:15], s39 offen  lds
    s_mov_b32 m0, s19
    s_mov_b32 s39, s16
    s_waitcnt vmcnt(14)
    s_barrier
    buffer_load_dwordx4 v121, s[12:15], s39 offen  lds
    s_add_u32 m0, m0, 1024
    s_nop 0
    buffer_load_dwordx4 v122, s[12:15], s39 offen  lds
    s_add_u32 m0, m0, 1024
    s_nop 0
    buffer_load_dwordx4 v123, s[12:15], s39 offen  lds
    s_call_b64 s[76:77], PREP_w_issue_3
    s_add_u32 m0, m0, 1024
    s_nop 0
    buffer_load_dwordx4 v124, s[12:15], s39 offen  lds
    s_add_u32 m0, m0, 1024
    s_nop 0
    buffer_load_dwordx4 v125, s[12:15], s39 offen  lds
    s_add_u32 m0, m0, 1024
    s_nop 0
    buffer_load_dwordx4 v126, s[12:15], s39 offen  lds
    s_add_u32 m0, m0, 1024
    s_nop 0
    buffer_load_dwordx4 v127, s[12:15], s39 offen  lds
    s_add_u32 m0, m0, 1024
    s_add_u32 s39, s39, 114688
    buffer_load_dwordx4 v121, s[12:15], s39 offen  lds
    s_add_u32 m0, m0, 1024
    s_nop 0
    buffer_load_dwordx4 v122, s[12:15], s39 offen  lds
    s_add_u32 m0, m0, 1024
    s_nop 0
    buffer_load_dwordx4 v123, s[12:15], s39 offen  lds
    s_add_u32 m0, m0, 1024
    s_nop 0
    buffer_load_dwordx4 v124, s[12:15], s39 offen  lds
    s_add_u32 m0, m0, 1024
    s_nop 0
    buffer_load_dwordx4 v125, s[12:15], s39 offen  lds
    s_add_u32 m0, m0, 1024
    s_nop 0
    buffer_load_dwordx4 v126, s[12:15], s39 offen  lds
    s_add_u32 m0, m0, 1024
    s_nop 0
    buffer_load_dwordx4 v127, s[12:15], s39 offen  lds
    s_mov_b32 m0, s19
    s_mov_b32 s39, s16
    s_waitcnt vmcnt(14)
    s_barrier
    buffer_load_dwordx4 v121, s[12:15], s39 offen  lds
    s_add_u32 m0, m0, 1024
    s_nop 0
    buffer_load_dwordx4 v122, s[12:15], s39 offen  lds
    s_add_u32 m0, m0, 1024
    s_nop 0
    buffer_load_dwordx4 v123, s[12:15], s39 offen  lds
    s_call_b64 s[76:77], PREP_w_issue_3
    s_add_u32 m0, m0, 1024
    s_nop 0
    buffer_load_dwordx4 v124, s[12:15], s39 offen  lds
    s_add_u32 m0, m0, 1024
    s_nop 0
    buffer_load_dwordx4 v125, s[12:15], s39 offen  lds
    s_add_u32 m0, m0, 1024
    s_nop 0
    buffer_load_dwordx4 v126, s[12:15], s39 offen  lds
    s_add_u32 m0, m0, 1024
    s_nop 0
    buffer_load_dwordx4 v127, s[12:15], s39 offen  lds
    s_add_u32 m0, m0, 1024
    s_add_u32 s39, s39, 114688
    buffer_load_dwordx4 v121, s[12:15], s39 offen  lds
    s_add_u32 m0, m0, 1024
    s_nop 0
    buffer_load_dwordx4 v122, s[12:15], s39 offen  lds
    s_add_u32 m0, m0, 1024
    s_nop 0
    buffer_load_dwordx4 v123, s[12:15], s39 offen  lds
    s_add_u32 m0, m0, 1024
    s_nop 0
    buffer_load_dwordx4 v124, s[12:15], s39 offen  lds
    s_add_u32 m0, m0, 1024
    s_nop 0
    buffer_load_dwordx4 v125, s[12:15], s39 offen  lds
    s_add_u32 m0, m0, 1024
    s_nop 0
    buffer_load_dwordx4 v126, s[12:15], s39 offen  lds
    s_add_u32 m0, m0, 1024
    s_nop 0
    buffer_load_dwordx4 v127, s[12:15], s39 offen  lds
    s_mov_b32 m0, s19
    s_mov_b32 s39, s16
    s_waitcnt vmcnt(28)
    s_cmp_lg_u32 s60, 0
    s_cbranch_scc1 cs_70
    s_and_b32 s36, s30, 1
    s_lshl_b32 s36, s36, 13
    s_lshl_b32 s53, s29, 7
    s_add_u32 s36, s36, s53
    s_add_u32 s36, s36, 23068672
    v_mov_b32 v14, 1
    v_mov_b32 v15, 0
    s_mov_b64 exec, 1
    buffer_atomic_add v14, v15, s[56:59], s36 offen sc1
    s_mov_b64 exec, -1
cs_70:
    s_waitcnt vmcnt(14)
    s_barrier
    buffer_load_dwordx4 v121, s[12:15], s39 offen  lds
    s_add_u32 m0, m0, 1024
    s_nop 0
    buffer_load_dwordx4 v122, s[12:15], s39 offen  lds
    s_add_u32 m0, m0, 1024
    s_nop 0
    buffer_load_dwordx4 v123, s[12:15], s39 offen  lds
    s_mov_b32 s43, 1
ld_71:
    s_add_u32 s19, s41, s42
    s_cmp_eq_u32 s44, s47
    s_cselect_b32 s16, s46, s44
    s_mul_i32 s16, s16, 458752
    s_add_u32 s16, s16, s38
    s_add_u32 s44, s44, 1
    s_and_b32 s44, s44, 15
    s_add_u32 s42, s42, 28672
    s_cmp_eq_u32 s42, 86016
    s_cselect_b32 s42, 0, s42
    s_add_u32 m0, m0, 1024
    s_nop 0
    buffer_load_dwordx4 v124, s[12:15], s39 offen  lds
    s_add_u32 m0, m0, 1024
    s_nop 0
    buffer_load_dwordx4 v125, s[12:15], s39 offen  lds
    s_add_u32 m0, m0, 1024
    s_nop 0
    buffer_load_dwordx4 v126, s[12:15], s39 offen  lds
    s_add_u32 m0, m0, 1024
    s_nop 0
    buffer_load_dwordx4 v127, s[12:15], s39 offen  lds
    s_add_u32 m0, m0, 1024
    s_add_u32 s39, s39, 114688
    buffer_load_dwordx4 v121, s[12:15], s39 offen  lds
    s_add_u32 m0, m0, 1024
    s_nop 0
    buffer_load_dwordx4 v122, s[12:15], s39 offen  lds
    s_add_u32 m0, m0, 1024
    s_nop 0
    buffer_load_dwordx4 v123, s[12:15], s39 offen  lds
    s_add_u32 m0, m0, 1024
    s_nop 0
    buffer_load_dwordx4 v124, s[12:15], s39 offen  lds
    s_add_u32 m0, m0, 1024
    s_nop 0
    buffer_load_dwordx4 v125, s[12:15], s39 offen  lds
    s_add_u32 m0, m0, 1024
    s_nop 0
    buffer_load_dwordx4 v126, s[12:15], s39 offen  lds
    s_add_u32 m0, m0, 1024
    s_nop 0
    buffer_load_dwordx4 v127, s[12:15], s39 offen  lds
    s_mov_b32 m0, s19
    s_mov_b32 s39, s16
    s_waitcnt vmcnt(14)
    s_barrier
    buffer_load_dwordx4 v121, s[12:15], s39 offen  lds
    s_add_u32 m0, m0, 1024
    s_nop 0
    buffer_load_dwordx4 v122, s[12:15], s39 offen  lds
    s_add_u32 m0, m0, 1024
    s_nop 0
    buffer_load_dwordx4 v123, s[12:15], s39 offen  lds
    s_add_u32 s43, s43, 1
    s_cmp_lt_u32 s43, 9
    s_cbranch_scc1 ld_71
    s_call_b64 s[76:77], PREP_w_issue_3
    s_add_u32 m0, m0, 1024
    s_nop 0
    buffer_load_dwordx4 v124, s[12:15], s39 offen  lds
    s_add_u32 m0, m0, 1024
    s_nop 0
    buffer_load_dwordx4 v125, s[12:15], s39 offen  lds
    s_add_u32 m0, m0, 1024
    s_nop 0
    buffer_load_dwordx4 v126, s[12:15], s39 offen  lds
    s_add_u32 m0, m0, 1024
    s_nop 0
    buffer_load_dwordx4 v127, s[12:15], s39 offen  lds
    s_add_u32 m0, m0, 1024
    s_add_u32 s39, s39, 114688
    buffer_load_dwordx4 v121, s[12:15], s39 offen  lds
    s_add_u32 m0, m0, 1024
    s_nop 0
    buffer_load_dwordx4 v122, s[12:15], s39 offen  lds
    s_add_u32 m0, m0, 1024
    s_nop 0
    buffer_load_dwordx4 v123, s[12:15], s39 offen  lds
    s_add_u32 m0, m0, 1024
    s_nop 0
    buffer_load_dwordx4 v124, s[12:15], s39 offen  lds
    s_add_u32 m0, m0, 1024
    s_nop 0
    buffer_load_dwordx4 v125, s[12:15], s39 offen  lds
    s_add_u32 m0, m0, 1024
    s_nop 0
    buffer_load_dwordx4 v126, s[12:15], s39 offen  lds
    s_add_u32 m0, m0, 1024
    s_nop 0
    buffer_load_dwordx4 v127, s[12:15], s39 offen  lds
    s_mov_b32 m0, s19
    s_mov_b32 s39, s16
    s_waitcnt vmcnt(14)
    s_barrier
    buffer_load_dwordx4 v121, s[12:15], s39 offen  lds
    s_add_u32 m0, m0, 1024
    s_nop 0
    buffer_load_dwordx4 v122, s[12:15], s39 offen  lds
    s_add_u32 m0, m0, 1024
    s_nop 0
    buffer_load_dwordx4 v123, s[12:15], s39 offen  lds
    s_add_u32 m0, m0, 1024
    s_nop 0
    buffer_load_dwordx4 v124, s[12:15], s39 offen  lds
    s_add_u32 m0, m0, 1024
    s_nop 0
    buffer_load_dwordx4 v125, s[12:15], s39 offen  lds
    s_add_u32 m0, m0, 1024
    s_nop 0
    buffer_load_dwordx4 v126, s[12:15], s39 offen  lds
    s_add_u32 m0, m0, 1024
    s_nop 0
    buffer_load_dwordx4 v127, s[12:15], s39 offen  lds
    s_add_u32 m0, m0, 1024
    s_add_u32 s39, s39, 114688
    buffer_load_dwordx4 v121, s[12:15], s39 offen  lds
    s_add_u32 m0, m0, 1024
    s_nop 0
    buffer_load_dwordx4 v122, s[12:15], s39 offen  lds
    s_add_u32 m0, m0, 1024
    s_nop 0
    buffer_load_dwordx4 v123, s[12:15], s39 offen  lds
    s_add_u32 m0, m0, 1024
    s_nop 0
    buffer_load_dwordx4 v124, s[12:15], s39 offen  lds
    s_add_u32 m0, m0, 1024
    s_nop 0
    buffer_load_dwordx4 v125, s[12:15], s39 offen  lds
    s_add_u32 m0, m0, 1024
    s_nop 0
    buffer_load_dwordx4 v126, s[12:15], s39 offen  lds
    s_add_u32 m0, m0, 1024
    s_nop 0
    buffer_load_dwordx4 v127, s[12:15], s39 offen  lds
    s_waitcnt vmcnt(14)
    s_barrier
    s_waitcnt vmcnt(0)
    s_barrier
    s_barrier
    s_mov_b64 s[12:13], s[74:75]
    s_mov_b32 s14, 7340032
    s_mov_b32 s15, 0x20000
    s_and_b32 s35, s30, 1
    s_mul_i32 s38, s33, 256
    s_mul_i32 s41, s31, 3670016
    s_add_u32 s38, s38, s41
    s_mul_i32 s41, s35, 8192
    s_add_u32 s41, s41, 49152
    s_mov_b32 s42, 0
    s_mov_b32 s44, 0
    s_mov_b32 s49, s44
    s_and_b32 s43, s28, 0
    s_mul_i32 s43, s43, 6
    s_lshr_b32 s43, s43, 2
    s_mov_b32 s50, 0
wpre_72:
    s_mul_i32 s42, s43, 16384
    s_add_u32 s44, s49, s43
    s_add_u32 s19, s41, s42
    s_and_b32 s40, s30, 1
    s_lshl_b32 s45, s44, 1
    s_add_u32 s45, s45, s40
    s_sub_u32 s45, s45, 32
    s_mul_i32 s46, s45, 86
    s_lshr_b32 s46, s46, 8
    s_mul_i32 s47, s46, 3
    s_sub_u32 s47, s45, s47
    s_lshl_b32 s47, s47, 2
    s_lshr_b32 s47, 0x362, s47
    s_and_b32 s47, s47, 7
    s_cmp_ge_u32 s44, 10
    s_cselect_b32 s45, 9, 2
    s_cselect_b32 s51, 1, 0
    s_sub_u32 s45, s44, s45
    s_cmp_lt_u32 s44, 3
    s_cselect_b32 s45, 0, s45
    s_cselect_b32 s51, s44, s51
    s_lshl2_add_u32 s51, s40, s51
    s_cmp_lt_u32 s44, 17
    s_cselect_b32 s47, s51, s47
    s_cselect_b32 s46, s45, s46
    s_add_u32 s46, s46, s33
    s_and_b32 s46, s46, 7
    s_mul_i32 s46, s46, 7
    s_add_u32 s16, s46, s47
    s_mul_i32 s16, s16, 65536
    s_add_u32 s16, s16, s38
    s_add_u32 s44, s44, 1
    s_add_u32 s42, s42, 16384
    s_cmp_eq_u32 s42, 98304
    s_cselect_b32 s42, 0, s42
    s_mov_b32 m0, s19
    s_mov_b32 s39, s16
    buffer_load_dwordx4 v119, s[12:15], s39 offen  lds
    s_add_u32 m0, m0, 1024
    s_add_u32 s39, s39, 8192
    buffer_load_dwordx4 v120, s[12:15], s39 offen  lds
    s_add_u32 m0, m0, 1024
    s_add_u32 s39, s39, 8192
    buffer_load_dwordx4 v119, s[12:15], s39 offen  lds
    s_add_u32 m0, m0, 1024
    s_add_u32 s39, s39, 8192
    buffer_load_dwordx4 v120, s[12:15], s39 offen  lds
    s_waitcnt vmcnt(8)
    s_add_u32 m0, m0, 1024
    s_add_u32 s39, s39, 8192
    buffer_load_dwordx4 v119, s[12:15], s39 offen  lds
    s_add_u32 m0, m0, 1024
    s_add_u32 s39, s39, 8192
    buffer_load_dwordx4 v120, s[12:15], s39 offen  lds
    s_add_u32 m0, m0, 1024
    s_add_u32 s39, s39, 8192
    buffer_load_dwordx4 v119, s[12:15], s39 offen  lds
    s_add_u32 m0, m0, 1024
    s_add_u32 s39, s39, 8192
    buffer_load_dwordx4 v120, s[12:15], s39 offen  lds
    s_waitcnt vmcnt(8)
    s_add_u32 s43, s43, 1
    s_cmp_eq_u32 s43, 6
    s_cselect_b32 s43, 0, s43
    s_add_u32 s50, s50, 1
    s_cmp_lt_u32 s50, 6
    s_cbranch_scc1 wpre_72
    s_mov_b32 s42, 0
    s_add_u32 s44, s49, 6
    s_mov_b64 s[8:9], s[68:69]
    s_mov_b32 s10, 2097152
    s_mov_b32 s11, 0x20000
    s_and_b32 s3, s30, 3
    s_lshl_b32 s36, s3, 14
    s_lshl_b32 s90, s29, 7
    s_add_u32 s90, s90, s36
    s_xor_b32 s90, s90, 128
    s_lshl_b32 s3, s3, 10
    s_call_b64 s[76:77], PREP_w_issue_4
    s_mov_b32 m0, s19
    s_mov_b32 s39, s16
    s_waitcnt vmcnt(40)
    s_barrier
    s_waitcnt vmcnt(32)
    s_barrier
    buffer_load_dwordx4 v119, s[12:15], s39 offen  lds
    s_add_u32 m0, m0, 1024
    s_add_u32 s39, s39, 8192
    buffer_load_dwordx4 v120, s[12:15], s39 offen  lds
    s_mov_b32 s43, 1
ld_73:
    s_add_u32 s19, s41, s42
    s_and_b32 s40, s30, 1
    s_lshl_b32 s45, s44, 1
    s_add_u32 s45, s45, s40
    s_sub_u32 s45, s45, 32
    s_mul_i32 s46, s45, 86
    s_lshr_b32 s46, s46, 8
    s_mul_i32 s47, s46, 3
    s_sub_u32 s47, s45, s47
    s_lshl_b32 s47, s47, 2
    s_lshr_b32 s47, 0x362, s47
    s_and_b32 s47, s47, 7
    s_cmp_ge_u32 s44, 10
    s_cselect_b32 s45, 9, 2
    s_cselect_b32 s51, 1, 0
    s_sub_u32 s45, s44, s45
    s_cmp_lt_u32 s44, 3
    s_cselect_b32 s45, 0, s45
    s_cselect_b32 s51, s44, s51
    s_lshl2_add_u32 s51, s40, s51
    s_cmp_lt_u32 s44, 17
    s_cselect_b32 s47, s51, s47
    s_cselect_b32 s46, s45, s46
    s_add_u32 s46, s46, s33
    s_and_b32 s46, s46, 7
    s_mul_i32 s46, s46, 7
    s_add_u32 s16, s46, s47
    s_mul_i32 s16, s16, 65536
    s_add_u32 s16, s16, s38
    s_add_u32 s44, s44, 1
    s_add_u32 s42, s42, 16384
    s_cmp_eq_u32 s42, 98304
    s_cselect_b32 s42, 0, s42
    s_add_u32 m0, m0, 1024
    s_add_u32 s39, s39, 8192
    buffer_load_dwordx4 v119, s[12:15], s39 offen  lds
    s_add_u32 m0, m0, 1024
    s_add_u32 s39, s39, 8192
    buffer_load_dwordx4 v120, s[12:15], s39 offen  lds
    s_add_u32 m0, m0, 1024
    s_add_u32 s39, s39, 8192
    buffer_load_dwordx4 v119, s[12:15], s39 offen  lds
    s_add_u32 m0, m0, 1024
    s_add_u32 s39, s39, 8192
    buffer_load_dwordx4 v120, s[12:15], s39 offen  lds
    s_add_u32 m0, m0, 1024
    s_add_u32 s39, s39, 8192
    buffer_load_dwordx4 v119, s[12:15], s39 offen  lds
    s_add_u32 m0, m0, 1024
    s_add_u32 s39, s39, 8192
    buffer_load_dwordx4 v120, s[12:15], s39 offen  lds
    s_mov_b32 m0, s19
    s_mov_b32 s39, s16
    s_waitcnt vmcnt(32)
    s_barrier
    buffer_load_dwordx4 v119, s[12:15], s39 offen  lds
    s_add_u32 m0, m0, 1024
    s_add_u32 s39, s39, 8192
    buffer_load_dwordx4 v120, s[12:15], s39 offen  lds
    s_add_u32 s43, s43, 1
    s_cmp_lt_u32 s43, 20
    s_cbranch_scc1 ld_73
    s_call_b64 s[76:77], PREP_w_issue_4
    s_add_u32 m0, m0, 1024
    s_add_u32 s39, s39, 8192
    buffer_load_dwordx4 v119, s[12:15], s39 offen  lds
    s_add_u32 m0, m0, 1024
    s_add_u32 s39, s39, 8192
    buffer_load_dwordx4 v120, s[12:15], s39 offen  lds
    s_add_u32 m0, m0, 1024
    s_add_u32 s39, s39, 8192
    buffer_load_dwordx4 v119, s[12:15], s39 offen  lds
    s_add_u32 m0, m0, 1024
    s_add_u32 s39, s39, 8192
    buffer_load_dwordx4 v120, s[12:15], s39 offen  lds
    s_add_u32 m0, m0, 1024
    s_add_u32 s39, s39, 8192
    buffer_load_dwordx4 v119, s[12:15], s39 offen  lds
    s_add_u32 m0, m0, 1024
    s_add_u32 s39, s39, 8192
    buffer_load_dwordx4 v120, s[12:15], s39 offen  lds
    s_mov_b32 m0, s19
    s_mov_b32 s39, s16
    s_waitcnt vmcnt(32)
    s_barrier
    buffer_load_dwordx4 v119, s[12:15], s39 offen  lds
    s_add_u32 m0, m0, 1024
    s_add_u32 s39, s39, 8192
    buffer_load_dwordx4 v120, s[12:15], s39 offen  lds
    s_add_u32 m0, m0, 1024
    s_add_u32 s39, s39, 8192
    buffer_load_dwordx4 v119, s[12:15], s39 offen  lds
    s_add_u32 m0, m0, 1024
    s_add_u32 s39, s39, 8192
    buffer_load_dwordx4 v120, s[12:15], s39 offen  lds
    s_add_u32 m0, m0, 1024
    s_add_u32 s39, s39, 8192
    buffer_load_dwordx4 v119, s[12:15], s39 offen  lds
    s_add_u32 m0, m0, 1024
    s_add_u32 s39, s39, 8192
    buffer_load_dwordx4 v120, s[12:15], s39 offen  lds
    s_add_u32 m0, m0, 1024
    s_add_u32 s39, s39, 8192
    buffer_load_dwordx4 v119, s[12:15], s39 offen  lds
    s_add_u32 m0, m0, 1024
    s_add_u32 s39, s39, 8192
    buffer_load_dwordx4 v120, s[12:15], s39 offen  lds
    s_call_b64 s[76:77], PREP_w_issue_4
    s_mov_b32 m0, s19
    s_mov_b32 s39, s16
    s_waitcnt vmcnt(24)
    s_barrier
    buffer_load_dwordx4 v119, s[12:15], s39 offen  lds
    s_add_u32 m0, m0, 1024
    s_add_u32 s39, s39, 8192
    buffer_load_dwordx4 v120, s[12:15], s39 offen  lds
    s_add_u32 m0, m0, 1024
    s_add_u32 s39, s39, 8192
    buffer_load_dwordx4 v119, s[12:15], s39 offen  lds
    s_add_u32 m0, m0, 1024
    s_add_u32 s39, s39, 8192
    buffer_load_dwordx4 v120, s[12:15], s39 offen  lds
    s_add_u32 m0, m0, 1024
    s_add_u32 s39, s39, 8192
    buffer_load_dwordx4 v119, s[12:15], s39 offen  lds
    s_add_u32 m0, m0, 1024
    s_add_u32 s39, s39, 8192
    buffer_load_dwordx4 v120, s[12:15], s39 offen  lds
    s_add_u32 m0, m0, 1024
    s_add_u32 s39, s39, 8192
    buffer_load_dwordx4 v119, s[12:15], s39 offen  lds
    s_add_u32 m0, m0, 1024
    s_add_u32 s39, s39, 8192
    buffer_load_dwordx4 v120, s[12:15], s39 offen  lds
    s_cmp_lg_u32 s60, 0
    s_cbranch_scc1 tl_74
    s_call_b64 s[76:77], SUB_w1_piece_23
    s_waitcnt vmcnt(18)
    s_branch tz_75
tl_74:
    s_waitcnt vmcnt(16)
tz_75:
    s_barrier
    s_cmp_lg_u32 s60, 0
    s_cbranch_scc1 tl_76
    s_call_b64 s[76:77], SUB_w1_piece_24
    s_waitcnt vmcnt(6)
    s_branch tz_77
tl_76:
    s_waitcnt vmcnt(0)
tz_77:
    s_barrier
    s_cmp_lg_u32 s60, 0
    s_cbranch_scc1 tl_78
    s_call_b64 s[76:77], SUB_w1_piece_25
tl_78:
tz_79:
    s_barrier
    s_cmp_lg_u32 s60, 0
    s_cbranch_scc1 tl_80
    s_call_b64 s[76:77], SUB_w1_piece_26
tl_80:
tz_81:
    s_barrier
    s_cmp_lg_u32 s60, 0
    s_cbranch_scc1 tl_82
    s_call_b64 s[76:77], SUB_w1_piece_27
tl_82:
tz_83:
    s_barrier
    s_cmp_eq_u32 s60, 1
    s_cbranch_scc1 K_fin
    s_branch Y_END
Y_END:
    v_and_b32 v81, 7, v0
    v_lshrrev_b32 v84, 6, v0
    v_lshlrev_b32 v84, 4, v84
    v_bfe_u32 v85, v0, 3, 3
    v_add_u32 v84, v84, v85
    s_lshr_b32 s78, s29, 1
    s_lshl_b32 s78, s78, 16
    s_and_b32 s79, s29, 1
    s_lshl_b32 s79, s79, 7
    s_add_u32 s78, s78, s79
    s_lshr_b32 s79, s30, 1
    s_lshl_b32 s79, s79, 13
    s_add_u32 s78, s78, s79
    v_lshlrev_b32 v78, 8, v84
    v_lshl_add_u32 v78, v81, 4, v78
    v_add_u32 v78, s78, v78
    s_lshl_b32 s78, s28, 7
    s_lshl_b32 s79, s29, 3
    s_add_u32 s78, s78, s79
    v_add_u32 v79, s78, v81
    v_lshlrev_b32 v80, 11, v79
    v_and_b32 v85, 3, v79
    v_lshrrev_b32 v82, 2, v79
    v_lshlrev_b32 v82, 14, v82
    v_lshl_add_u32 v82, v85, 11, v82
    v_lshl_add_u32 v82, v84, 4, v82
    v_lshrrev_b32 v85, 2, v84
    v_lshlrev_b32 v85, 3, v85
    v_and_b32 v84, 3, v84
    v_add_u32 v84, v84, v85
    v_lshl_add_u32 v80, v84, 3, v80
    v_lshlrev_b32 v79, 3, v79
    v_lshl_add_u32 v79, v84, 14, v79
    s_add_u32 s80, s4, 0x1800000
    s_addc_u32 s81, s5, 0
    s_mov_b32 s82, 0x400000
    s_mov_b32 s83, 0x20000
    s_mov_b32 s78, 0
    buffer_load_dwordx2 v[110:111], v79, s[80:83], s78 offen sc1
    s_mov_b32 s78, 65536
    buffer_load_dwordx2 v[112:113], v79, s[80:83], s78 offen sc1
    s_mov_b32 s78, 262144
    buffer_load_dwordx2 v[114:115], v79, s[80:83], s78 offen sc1
    s_mov_b32 s78, 327680
    buffer_load_dwordx2 v[116:117], v79, s[80:83], s78 offen sc1
    s_waitcnt vmcnt(10)
    s_barrier
    s_and_b32 s36, s30, 3
    s_lshl_b32 s36, s36, 10
    v_add_u32 v8, s36, v2
    v_add_u32 v9, 65536, v8
    v_add_u32 v10, 131072, v8
    ds_write_b128 v8, v[12:15] offset:49152
    ds_write_b128 v8, v[16:19] offset:53248
    ds_write_b128 v8, v[20:23] offset:57344
    ds_write_b128 v8, v[24:27] offset:61440
    ds_write_b128 v9, v[28:31] offset:0
    ds_write_b128 v9, v[32:35] offset:4096
    ds_write_b128 v9, v[36:39] offset:8192
    ds_write_b128 v9, v[40:43] offset:12288
    ds_write_b128 v10, v[44:47] offset:0
    ds_write_b128 v10, v[48:51] offset:4096
    ds_write_b128 v10, v[52:55] offset:8192
    ds_write_b128 v10, v[56:59] offset:12288
    ds_write_b128 v8, v[60:63] offset:24576
    ds_write_b128 v8, v[64:67] offset:28672
    s_waitcnt lgkmcnt(0)
NEXT:
    s_setprio 0
    s_add_u32 s60, s60, 1
    s_add_u32 s55, s55, 67108864
    s_add_u32 s62, s62, 67108864
    s_addc_u32 s63, s63, 0
    s_branch LAYER
K_fin:
    s_endpgm
PREP_a_issue_3:
    s_add_u32 s19, s41, s42
    s_cmp_eq_u32 s44, s47
    s_cselect_b32 s16, s46, s44
    s_cmp_eq_u32 s44, s46
    s_cselect_b32 s16, s47, s16
    s_lshr_b32 s45, s16, 2
    s_lshl_b32 s45, s45, 14
    s_and_b32 s16, s16, 3
    s_lshl_b32 s16, s16, 11
    s_add_u32 s16, s16, s45
    s_add_u32 s16, s16, s38
    s_add_u32 s44, s44, 1
    s_and_b32 s44, s44, 15
    s_add_u32 s42, s42, 16384
    s_cmp_eq_u32 s42, 49152
    s_cselect_b32 s42, 0, s42
    s_setpc_b64 s[76:77]
SUB_rest_2:
    v_lshlrev_b32 v108, 16, v20
    v_and_b32 v109, 0xffff0000, v20
    v_lshlrev_b32 v110, 16, v21
    v_and_b32 v111, 0xffff0000, v21
    v_lshlrev_b32 v112, 16, v22
    v_and_b32 v113, 0xffff0000, v22
    v_lshlrev_b32 v114, 16, v23
    v_and_b32 v115, 0xffff0000, v23
    v_pk_add_f32 v[24:25], v[108:109], v[110:111]
    v_pk_mul_f32 v[26:27], v[108:109], v[108:109]
    v_pk_fma_f32 v[26:27], v[110:111], v[110:111], v[26:27]
    v_pk_add_f32 v[24:25], v[24:25], v[112:113]
    v_pk_fma_f32 v[26:27], v[112:113], v[112:113], v[26:27]
    v_pk_add_f32 v[24:25], v[24:25], v[114:115]
    v_pk_fma_f32 v[26:27], v[114:115], v[114:115], v[26:27]
    v_add_f32 v100, v24, v25
    v_add_f32 v101, v26, v27
    v_lshlrev_b32 v108, 16, v28
    v_and_b32 v109, 0xffff0000, v28
    v_lshlrev_b32 v110, 16, v29
    v_and_b32 v111, 0xffff0000, v29
    v_lshlrev_b32 v112, 16, v30
    v_and_b32 v113, 0xffff0000, v30
    v_lshlrev_b32 v114, 16, v31
    v_and_b32 v115, 0xffff0000, v31
    v_pk_add_f32 v[32:33], v[108:109], v[110:111]
    v_pk_mul_f32 v[34:35], v[108:109], v[108:109]
    v_pk_fma_f32 v[34:35], v[110:111], v[110:111], v[34:35]
    v_pk_add_f32 v[32:33], v[32:33], v[112:113]
    v_pk_fma_f32 v[34:35], v[112:113], v[112:113], v[34:35]
    v_pk_add_f32 v[32:33], v[32:33], v[114:115]
    v_pk_fma_f32 v[34:35], v[114:115], v[114:115], v[34:35]
    v_add_f32 v102, v32, v33
    v_add_f32 v103, v34, v35
    v_lshlrev_b32 v108, 16, v36
    v_and_b32 v109, 0xffff0000, v36
    v_lshlrev_b32 v110, 16, v37
    v_and_b32 v111, 0xffff0000, v37
    v_lshlrev_b32 v112, 16, v38
    v_and_b32 v113, 0xffff0000, v38
    v_lshlrev_b32 v114, 16, v39
    v_and_b32 v115, 0xffff0000, v39
    v_pk_add_f32 v[40:41], v[108:109], v[110:111]
    v_pk_mul_f32 v[42:43], v[108:109], v[108:109]
    v_pk_fma_f32 v[42:43], v[110:111], v[110:111], v[42:43]
    v_pk_add_f32 v[40:41], v[40:41], v[112:113]
    v_pk_fma_f32 v[42:43], v[112:113], v[112:113], v[42:43]
    v_pk_add_f32 v[40:41], v[40:41], v[114:115]
    v_pk_fma_f32 v[42:43], v[114:115], v[114:115], v[42:43]
    v_add_f32 v104, v40, v41
    v_add_f32 v105, v42, v43
    v_lshlrev_b32 v108, 16, v44
    v_and_b32 v109, 0xffff0000, v44
    v_lshlrev_b32 v110, 16, v45
    v_and_b32 v111, 0xffff0000, v45
    v_lshlrev_b32 v112, 16, v46
    v_and_b32 v113, 0xffff0000, v46
    v_lshlrev_b32 v114, 16, v47
    v_and_b32 v115, 0xffff0000, v47
    v_pk_add_f32 v[48:49], v[108:109], v[110:111]
    v_pk_mul_f32 v[50:51], v[108:109], v[108:109]
    v_pk_fma_f32 v[50:51], v[110:111], v[110:111], v[50:51]
    v_pk_add_f32 v[48:49], v[48:49], v[112:113]
    v_pk_fma_f32 v[50:51], v[112:113], v[112:113], v[50:51]
    v_pk_add_f32 v[48:49], v[48:49], v[114:115]
    v_pk_fma_f32 v[50:51], v[114:115], v[114:115], v[50:51]
    v_add_f32 v106, v48, v49
    v_add_f32 v107, v50, v51
    s_and_b32 s36, s30, 3
    s_lshl_b32 s36, s36, 10
    s_add_u32 s36, s36, 155648
    v_lshlrev_b32 v6, 3, v1
    v_add_u32 v6, s36, v6
    v_permlane32_swap_b32 v100, v102
    v_permlane32_swap_b32 v104, v106
    v_permlane32_swap_b32 v101, v103
    v_permlane32_swap_b32 v105, v107
    v_pk_add_f32 v[100:101], v[100:101], v[102:103]
    v_pk_add_f32 v[104:105], v[104:105], v[106:107]
    ds_write_b64 v6, v[100:101] offset:0
    ds_write_b64 v6, v[104:105] offset:512
    s_setpc_b64 s[76:77]
PREP_a_issue_4:
    s_add_u32 s19, s41, s42
    s_lshl_b32 s45, s44, 1
    s_add_u32 s45, s45, 0
    s_sub_u32 s45, s45, 32
    s_mul_i32 s46, s45, 86
    s_lshr_b32 s46, s46, 8
    s_mul_i32 s47, s46, 3
    s_sub_u32 s47, s45, s47
    s_lshl_b32 s47, s47, 2
    s_lshr_b32 s47, 0x362, s47
    s_and_b32 s47, s47, 7
    s_cmp_ge_u32 s44, 10
    s_cselect_b32 s45, 9, 2
    s_cselect_b32 s51, 1, 0
    s_sub_u32 s45, s44, s45
    s_cmp_lt_u32 s44, 3
    s_cselect_b32 s45, 0, s45
    s_cselect_b32 s51, s44, s51
    s_lshl2_add_u32 s51, 0, s51
    s_cmp_lt_u32 s44, 17
    s_cselect_b32 s47, s51, s47
    s_cselect_b32 s46, s45, s46
    s_add_u32 s46, s46, s33
    s_and_b32 s46, s46, 7
    s_mul_i32 s46, s46, 7
    s_add_u32 s16, s46, s47
    s_lshr_b32 s53, s16, 3
    s_lshl_b32 s53, s53, 14
    s_and_b32 s16, s16, 7
    s_lshl_b32 s16, s16, 10
    s_add_u32 s16, s16, s53
    s_add_u32 s16, s16, s38
    s_lshl_b32 s45, s44, 1
    s_add_u32 s45, s45, 1
    s_sub_u32 s45, s45, 32
    s_mul_i32 s46, s45, 86
    s_lshr_b32 s46, s46, 8
    s_mul_i32 s47, s46, 3
    s_sub_u32 s47, s45, s47
    s_lshl_b32 s47, s47, 2
    s_lshr_b32 s47, 0x362, s47
    s_and_b32 s47, s47, 7
    s_cmp_ge_u32 s44, 10
    s_cselect_b32 s45, 9, 2
    s_cselect_b32 s51, 1, 0
    s_sub_u32 s45, s44, s45
    s_cmp_lt_u32 s44, 3
    s_cselect_b32 s45, 0, s45
    s_cselect_b32 s51, s44, s51
    s_lshl2_add_u32 s51, 1, s51
    s_cmp_lt_u32 s44, 17
    s_cselect_b32 s47, s51, s47
    s_cselect_b32 s46, s45, s46
    s_add_u32 s46, s46, s33
    s_and_b32 s46, s46, 7
    s_mul_i32 s46, s46, 7
    s_add_u32 s17, s46, s47
    s_lshr_b32 s53, s17, 3
    s_lshl_b32 s53, s53, 14
    s_and_b32 s17, s17, 7
    s_lshl_b32 s17, s17, 10
    s_add_u32 s17, s17, s53
    s_add_u32 s17, s17, s38
    s_add_u32 s44, s44, 1
    s_add_u32 s42, s42, 16384
    s_cmp_eq_u32 s42, 49152
    s_cselect_b32 s42, 0, s42
    s_setpc_b64 s[76:77]
SUB_w1_piece_23:
    s_add_u32 s36, s90, 393216
    buffer_load_dwordx4 v[12:15], v118, s[8:11], s36 offen
    s_add_u32 s36, s36, 65536
    buffer_load_dwordx4 v[16:19], v118, s[8:11], s36 offen
    s_setpc_b64 s[76:77]
SUB_w1_piece_24:
    s_add_u32 s36, s90, 524288
    buffer_load_dwordx4 v[20:23], v118, s[8:11], s36 offen
    s_add_u32 s36, s36, 65536
    buffer_load_dwordx4 v[24:27], v118, s[8:11], s36 offen
    s_add_u32 s36, s90, 655360
    buffer_load_dwordx4 v[28:31], v118, s[8:11], s36 offen
    s_add_u32 s36, s36, 65536
    buffer_load_dwordx4 v[32:35], v118, s[8:11], s36 offen
    s_setpc_b64 s[76:77]
SUB_w1_piece_25:
    s_add_u32 s36, s90, 786432
    buffer_load_dwordx4 v[36:39], v118, s[8:11], s36 offen
    s_add_u32 s36, s36, 65536
    buffer_load_dwordx4 v[40:43], v118, s[8:11], s36 offen
    s_add_u32 s36, s90, 1703936
    buffer_load_dwordx4 v[44:47], v118, s[8:11], s36 offen
    s_add_u32 s36, s36, 65536
    buffer_load_dwordx4 v[48:51], v118, s[8:11], s36 offen
    s_setpc_b64 s[76:77]
SUB_w1_piece_26:
    s_add_u32 s36, s90, 1835008
    buffer_load_dwordx4 v[52:55], v118, s[8:11], s36 offen
    s_add_u32 s36, s36, 65536
    buffer_load_dwordx4 v[56:59], v118, s[8:11], s36 offen
    s_add_u32 s36, s90, 0
    buffer_load_dwordx4 v[60:63], v118, s[8:11], s36 offen
    s_add_u32 s36, s36, 65536
    buffer_load_dwordx4 v[64:67], v118, s[8:11], s36 offen
    s_add_u32 s36, s90, 1966080
    s_add_u32 m0, s3, 147456
    s_nop 0
    buffer_load_dwordx4 v118, s[8:11], s36 offen lds
    s_add_u32 s36, s36, 65536
    s_add_u32 m0, s3, 151552
    s_nop 0
    buffer_load_dwordx4 v118, s[8:11], s36 offen lds
    s_setpc_b64 s[76:77]
SUB_w1_piece_27:
    s_add_u32 s36, s90, 1441792
    s_add_u32 m0, s3, 114688
    s_nop 0
    buffer_load_dwordx4 v118, s[8:11], s36 offen lds
    s_add_u32 s36, s36, 65536
    s_add_u32 m0, s3, 118784
    s_nop 0
    buffer_load_dwordx4 v118, s[8:11], s36 offen lds
    s_add_u32 s36, s90, 1572864
    s_add_u32 m0, s3, 122880
    s_nop 0
    buffer_load_dwordx4 v118, s[8:11], s36 offen lds
    s_add_u32 s36, s36, 65536
    s_add_u32 m0, s3, 126976
    s_nop 0
    buffer_load_dwordx4 v118, s[8:11], s36 offen lds
    s_setpc_b64 s[76:77]
PREP_w_issue_3:
    s_add_u32 s19, s41, s42
    s_cmp_eq_u32 s44, s47
    s_cselect_b32 s16, s46, s44
    s_mul_i32 s16, s16, 458752
    s_add_u32 s16, s16, s38
    s_add_u32 s44, s44, 1
    s_and_b32 s44, s44, 15
    s_add_u32 s42, s42, 28672
    s_cmp_eq_u32 s42, 86016
    s_cselect_b32 s42, 0, s42
    s_setpc_b64 s[76:77]
PREP_w_issue_4:
    s_add_u32 s19, s41, s42
    s_and_b32 s40, s30, 1
    s_lshl_b32 s45, s44, 1
    s_add_u32 s45, s45, s40
    s_sub_u32 s45, s45, 32
    s_mul_i32 s46, s45, 86
    s_lshr_b32 s46, s46, 8
    s_mul_i32 s47, s46, 3
    s_sub_u32 s47, s45, s47
    s_lshl_b32 s47, s47, 2
    s_lshr_b32 s47, 0x362, s47
    s_and_b32 s47, s47, 7
    s_cmp_ge_u32 s44, 10
    s_cselect_b32 s45, 9, 2
    s_cselect_b32 s51, 1, 0
    s_sub_u32 s45, s44, s45
    s_cmp_lt_u32 s44, 3
    s_cselect_b32 s45, 0, s45
    s_cselect_b32 s51, s44, s51
    s_lshl2_add_u32 s51, s40, s51
    s_cmp_lt_u32 s44, 17
    s_cselect_b32 s47, s51, s47
    s_cselect_b32 s46, s45, s46
    s_add_u32 s46, s46, s33
    s_and_b32 s46, s46, 7
    s_mul_i32 s46, s46, 7
    s_add_u32 s16, s46, s47
    s_mul_i32 s16, s16, 65536
    s_add_u32 s16, s16, s38
    s_add_u32 s44, s44, 1
    s_add_u32 s42, s42, 16384
    s_cmp_eq_u32 s42, 98304
    s_cselect_b32 s42, 0, s42
    s_setpc_b64 s[76:77]
K_end:
    s_endpgm
.section .rodata,"a"
.p2align 6
.amdhsa_kernel interleave_layers__ssm_conv_h3__mixer_s_mlp__prompt_kernel
  .amdhsa_next_free_vgpr 256
  .amdhsa_next_free_sgpr 102
  .amdhsa_accum_offset 256
  .amdhsa_group_segment_fixed_size 0
  .amdhsa_kernarg_size 112
  .amdhsa_user_sgpr_count 2
  .amdhsa_user_sgpr_kernarg_segment_ptr 1
  .amdhsa_system_sgpr_workgroup_id_x 1
  .amdhsa_float_denorm_mode_32 3
.end_amdhsa_kernel
```

```asm
; @launch grid=(256,1,1) block=(512,1,1) lds=163840
.amdgcn_target "amdgcn-amd-amdhsa--gfx950"
.text
.globl interleave_layers__ssm_conv_h3__mixer_s_mlp__prompt_kernel
.p2align 8
.type interleave_layers__ssm_conv_h3__mixer_s_mlp__prompt_kernel,@function
interleave_layers__ssm_conv_h3__mixer_s_mlp__prompt_kernel:
    s_cmp_ge_u32 s2, 256
    s_cbranch_scc1 K_end
    s_load_dwordx8 s[8:15], s[0:1], 8
    s_load_dwordx2 s[6:7], s[0:1], 0
    s_load_dwordx8 s[68:75], s[0:1], 56
    s_load_dwordx2 s[4:5], s[0:1], 104
    s_load_dwordx2 s[84:85], s[0:1], 96
    s_memrealtime s[46:47]
    s_load_dwordx2 s[76:77], s[0:1], 40
    v_lshrrev_b32 v1, 6, v0
    s_nop 0
    v_readfirstlane_b32 s30, v1
    s_getpc_b64 s[48:49]
K_pc:
    s_lshr_b32 s36, s2, 3
    s_lshl_b32 s36, s36, 12
    v_lshlrev_b32 v252, 3, v0
    v_add_u32 v252, s36, v252
    v_cmp_gt_u32 vcc, K_end-K_pc-8, v252
    s_nop 0
    s_and_saveexec_b64 s[36:37], vcc
    s_cbranch_execz K_3
    v_mov_b32 v253, s49
    v_add_co_u32 v252, vcc, s48, v252
    s_nop 1
    v_addc_co_u32 v253, vcc, 0, v253, vcc
    global_load_dword v250, v[252:253], off
K_3:
    s_mov_b64 exec, -1
    v_bfe_u32 v8, v0, 4, 2
    v_and_b32 v9, 15, v0
    v_lshlrev_b32 v6, 11, v8
    v_lshlrev_b32 v8, 1, v8
    v_xor_b32 v8, v8, v9
    v_lshl_add_u32 v8, v8, 4, v6
    s_and_b32 s34, s2, 7
    s_lshr_b32 s35, s2, 3
    s_lshl_b32 s36, s35, 17
    s_lshl_b32 s37, s34, 8
    s_add_u32 s36, s36, s37
    s_lshl_b32 s37, s30, 6
    s_and_b32 s38, s37, 128
    s_add_u32 s37, s37, 64
    s_and_b32 s37, s37, 128
    v_xor_b32 v6, s38, v8
    v_xor_b32 v7, s37, v8
    s_lshl_b32 s37, s30, 14
    s_add_u32 s37, s37, s36
    s_add_u32 s38, s37, 8192
    s_lshl_b32 s39, s30, 11
    s_mov_b32 s18, 4194304
    s_mov_b32 s19, 0x20000
    s_mov_b32 s22, s18
    s_mov_b32 s23, s19
    s_add_u32 m0, s39, 99328
    s_waitcnt lgkmcnt(0)
    s_mov_b64 s[16:17], s[8:9]
    s_mov_b64 s[20:21], s[10:11]
    buffer_load_dwordx4 v6, s[16:19], s37 offen nt lds
    s_add_u32 m0, m0, 1024
    s_nop 0
    buffer_load_dwordx4 v7, s[16:19], s38 offen nt lds
    s_add_u32 m0, s39, 115712
    s_nop 0
    buffer_load_dwordx4 v6, s[20:23], s37 offen nt lds
    s_add_u32 m0, m0, 1024
    s_nop 0
    buffer_load_dwordx4 v6, s[20:23], s38 offen nt lds
    s_mov_b32 s86, 256
    s_mov_b32 s87, 0x20000
    v_mov_b32 v10, 0
    s_cmp_lg_u32 s30, 0
    s_cbranch_scc1 KV_t0
    s_sub_u32 s36, s36, 8192
    v_add_u32 v8, s36, v8
    s_mov_b32 m0, 98304
    s_nop 0
    buffer_load_dwordx4 v8, s[16:19], 0 offen nt lds
    s_cmp_lg_u32 s2, 0
    s_cbranch_scc1 KV_t0
    s_lshl_b32 s44, s46, 6
    s_or_b32 s44, s44, 1
    v_mov_b32 v9, s44
    s_mov_b64 exec, 1
    buffer_store_dword v9, v10, s[84:87], 0 offen sc1
    s_mov_b64 exec, -1
KV_t0:
    s_lshl_b32 s37, s34, 10
    s_lshl_b32 s38, s30, 7
    s_add_u32 s37, s37, s38
    v_and_b32 v9, 15, v0
    v_lshlrev_b32 v9, 3, v9
    s_mov_b32 s24, s12
    s_mov_b32 s25, s13
    s_mov_b32 s26, 0x2000
    s_mov_b32 s27, 0x20000
    buffer_load_dwordx2 v[12:13], v9, s[24:27], s37 offen
    v_and_b32 v1, 63, v0
    v_lshlrev_b32 v2, 4, v1
    v_lshlrev_b32 v3, 2, v1
    s_and_b32 s32, s2, 7
    s_lshr_b32 s33, s2, 3
    s_and_b32 s28, s32, 2
    s_lshr_b32 s34, s32, 2
    s_or_b32 s28, s28, s34
    s_lshl_b32 s28, s28, 2
    s_and_b32 s34, s33, 3
    s_add_u32 s28, s28, s34
    s_and_b32 s31, s32, 1
    s_lshr_b32 s33, s33, 2
    s_lshl_b32 s29, s31, 3
    s_add_u32 s29, s29, s33
    s_and_b32 s67, s33, 4
    s_add_u32 s67, s67, s33
    s_lshl2_add_u32 s67, s31, s67
    s_mov_b32 s60, 0
    s_mov_b32 s61, 40000
    s_mov_b32 s52, 0
    s_mov_b32 s55, 0
    s_mov_b32 s92, 0
    s_mov_b32 s93, 0
    s_mov_b32 s94, 0
    s_mov_b32 s98, 1
    s_mov_b32 s56, s4
    s_mov_b32 s57, s5
    s_mov_b32 s58, 0xa000000
    s_mov_b32 s59, 0x20000
    s_add_u32 s62, s4, 33554432
    s_addc_u32 s63, s5, 0
    s_cmp_lg_u32 s30, 4
    s_cbranch_scc1 HB_1
    v_add_u32 v14, 162816, v3
    ds_write_b32 v14, v10
HB_1:
    s_mov_b64 s[88:89], s[70:71]
    s_mov_b32 s90, 2097152
    s_mov_b32 s91, 0x20000
    s_lshl3_add_u32 s36, s2, s30
    s_lshl_b32 s36, s36, 10
    s_mov_b64 s[80:81], s[68:69]
    s_mov_b32 s82, 2097152
    s_mov_b32 s83, 0x20000
    s_mov_b32 s50, s36
    v_lshrrev_b32 v14, 3, v1
    v_lshlrev_b32 v118, 11, v14
    v_and_b32 v14, 6, v14
    v_and_b32 v15, 7, v1
    v_xor_b32 v14, v14, v15
    v_lshl_add_u32 v118, v14, 4, v118
    v_mov_b32 v119, 0
    v_mov_b32 v120, 0
    v_mov_b32 v121, 0
    v_mov_b32 v122, 0
    v_mov_b32 v123, 0
    v_mov_b32 v124, 0
    v_mov_b32 v125, 0
    v_mov_b32 v126, 0
    v_mov_b32 v127, 0
    s_lshl_b32 s48, s29, 7
    s_lshl_b32 s36, s30, 14
    s_add_u32 s48, s48, s36
    s_lshl_b32 s49, s30, 10
    s_add_u32 s48, s48, 1048576
    s_and_b32 s41, s30, 3
    s_and_b32 s38, s2, 7
    s_lshl_b32 s38, s38, 5
    s_lshr_b32 s39, s2, 3
    s_add_u32 s38, s38, s39
    s_lshl_b32 s39, s38, 2
    s_add_u32 s39, s39, s41
    s_mul_i32 s40, s41, 21504
    s_lshl_b32 s36, s39, 12
    s_add_u32 s12, s14, s36
    s_addc_u32 s13, s15, 0
    s_mov_b32 s14, 4096
    s_mov_b32 s15, 0x20000
    s_lshr_b32 s45, s30, 2
    s_lshl_b32 s45, s45, 11
    s_add_u32 s36, s45, 0xffffffc0
    v_add_u32 v22, s36, v2
    v_add_u32 v23, 16, v22
    s_add_u32 s36, s45, 0x3c0
    v_add_u32 v24, s36, v2
    v_add_u32 v25, 16, v24
    s_mov_b32 s36, 4032
    v_add_u32 v26, s36, v2
    v_add_u32 v27, 16, v26
    v_add_u32 v19, s40, v2
    v_add_u32 v20, s45, v19
    s_lshl_b32 s36, s38, 14
    s_add_u32 s36, s36, 25165824
    s_add_u32 s20, s4, s36
    s_addc_u32 s21, s5, 0
    s_mov_b32 s22, 16384
    s_mov_b32 s23, 0x20000
    s_lshl_b32 s36, s30, 6
    v_lshrrev_b32 v94, 2, v1
    v_and_b32 v97, 48, v2
    v_lshl_add_u32 v97, v94, 8, v97
    v_add_u32 v97, s36, v97
    s_lshr_b32 s36, s39, 1
    s_lshl_b32 s36, s36, 2
    s_load_dword s41, s[76:77], s36
    v_and_b32 v100, 15, v1
    v_lshrrev_b32 v101, 4, v1
    v_and_b32 v94, 3, v100
    v_mul_u32_u24 v98, 4160, v94
    v_lshl_add_u32 v98, v101, 4, v98
    v_lshrrev_b32 v94, 2, v100
    v_lshl_add_u32 v98, v94, 3, v98
    v_add_u32 v98, s40, v98
    v_sub_u32 v94, 15, v100
    v_lshlrev_b32 v99, 5, v94
    v_add_u32 v99, s40, v99
    v_lshl_add_u32 v99, v101, 4, v99
    s_lshr_b32 s36, s38, 2
    s_lshl_b32 s36, s36, 12
    s_add_u32 s36, s36, 23330816
    v_lshlrev_b32 v102, 7, v1
    v_add_u32 v102, s36, v102
    v_and_b32 v81, 7, v0
    v_lshrrev_b32 v84, 6, v0
    v_lshlrev_b32 v84, 4, v84
    v_bfe_u32 v85, v0, 3, 3
    v_add_u32 v84, v84, v85
    s_lshr_b32 s78, s67, 1
    s_lshl_b32 s78, s78, 16
    s_and_b32 s79, s67, 1
    s_lshl_b32 s79, s79, 7
    s_add_u32 s78, s78, s79
    s_lshr_b32 s79, s30, 1
    s_lshl_b32 s79, s79, 13
    s_add_u32 s78, s78, s79
    v_lshlrev_b32 v78, 8, v84
    v_lshl_add_u32 v78, v81, 4, v78
    v_add_u32 v78, s78, v78
    s_lshl_b32 s78, s28, 7
    s_lshl_b32 s79, s67, 3
    s_add_u32 s78, s78, s79
    v_add_u32 v79, s78, v81
    v_lshlrev_b32 v80, 11, v79
    v_and_b32 v85, 3, v79
    v_lshrrev_b32 v82, 2, v79
    v_lshlrev_b32 v82, 14, v82
    v_lshl_add_u32 v82, v85, 11, v82
    v_lshl_add_u32 v82, v84, 4, v82
    v_lshrrev_b32 v85, 2, v84
    v_lshlrev_b32 v85, 3, v85
    v_and_b32 v84, 3, v84
    v_add_u32 v84, v84, v85
    v_lshl_add_u32 v80, v84, 3, v80
    v_lshlrev_b32 v79, 3, v79
    v_lshl_add_u32 v79, v84, 14, v79
    s_mov_b32 s8, s6
    s_mov_b32 s9, s7
    s_mov_b32 s10, 0x400000
    s_mov_b32 s11, 0x20000
    v_mov_b32 v60, 0
    v_mov_b32 v61, 0
    v_mov_b32 v62, 0
    v_mov_b32 v63, 0
    s_bfm_b64 exec, 40, 0
    ds_write_b128 v19, v[60:63] offset:20736
    s_mov_b64 exec, -1
    s_and_b32 s34, s2, 7
    s_lshr_b32 s35, s2, 3
    v_bfe_u32 v14, v1, 2, 3
    v_xor_b32 v14, s30, v14
    v_lshlrev_b32 v16, 5, v14
    v_and_b32 v14, 3, v1
    v_lshl_add_u32 v16, v14, 3, v16
    v_bfe_u32 v14, v1, 2, 2
    v_lshl_add_u32 v16, v14, 8, v16
    v_lshrrev_b32 v14, 4, v1
    v_lshl_add_u32 v16, v14, 12, v16
    v_add_u32 v16, 98304, v16
    v_xor_b32 v17, 128, v16
    s_add_u32 s16, s4, 0x1800000
    s_addc_u32 s17, s5, 0
    s_mov_b32 s18, 0x400000
    s_mov_b32 s19, 0x20000
    v_bfe_u32 v18, v1, 2, 2
    v_lshlrev_b32 v18, 14, v18
    v_and_b32 v14, 3, v1
    v_lshl_add_u32 v18, v14, 6, v18
    v_bfe_u32 v14, v1, 4, 1
    v_lshrrev_b32 v15, 5, v1
    v_lshl_add_u32 v14, v14, 1, v15
    v_xor_b32 v14, 3, v14
    v_lshl_add_u32 v18, v14, 4, v18
    s_lshl3_add_u32 s42, s34, s30
    s_lshl_b32 s43, s42, 16
    s_sub_u32 s37, 31, s35
    s_lshl_b32 s37, s37, 9
    s_add_u32 s43, s43, s37
    s_lshl_b32 s44, s42, 5
    s_add_u32 s44, s44, s35
    s_lshl_b32 s44, s44, 7
    s_add_u32 s44, s44, 23330816
    s_cmp_lt_u32 s30, 4
    s_cbranch_scc1 HB_4
    v_lshrrev_b32 v14, 4, v1
    v_lshlrev_b32 v119, 11, v14
    v_add_u32 v14, 0, v14
    v_lshlrev_b32 v14, 1, v14
    v_and_b32 v15, 15, v1
    v_xor_b32 v14, v14, v15
    v_lshl_add_u32 v119, v14, 4, v119
    v_lshrrev_b32 v14, 4, v1
    v_lshlrev_b32 v120, 11, v14
    v_add_u32 v14, 4, v14
    v_lshlrev_b32 v14, 1, v14
    v_and_b32 v15, 15, v1
    v_xor_b32 v14, v14, v15
    v_lshl_add_u32 v120, v14, 4, v120
    v_add_u32 v15, 0, v1
    v_mul_u32_u24 v14, 2341, v15
    v_lshrrev_b32 v14, 16, v14
    v_mul_u32_u24 v121, 28, v14
    v_sub_u32 v15, v15, v121
    v_mul_u32_u24 v121, 7168, v14
    v_lshrrev_b32 v14, 1, v14
    v_and_b32 v14, 2, v14
    v_xor_b32 v15, v15, v14
    v_lshl_add_u32 v121, v15, 4, v121
    v_add_u32 v15, 64, v1
    v_mul_u32_u24 v14, 2341, v15
    v_lshrrev_b32 v14, 16, v14
    v_mul_u32_u24 v122, 28, v14
    v_sub_u32 v15, v15, v122
    v_mul_u32_u24 v122, 7168, v14
    v_lshrrev_b32 v14, 1, v14
    v_and_b32 v14, 2, v14
    v_xor_b32 v15, v15, v14
    v_lshl_add_u32 v122, v15, 4, v122
    v_add_u32 v15, 128, v1
    v_mul_u32_u24 v14, 2341, v15
    v_lshrrev_b32 v14, 16, v14
    v_mul_u32_u24 v123, 28, v14
    v_sub_u32 v15, v15, v123
    v_mul_u32_u24 v123, 7168, v14
    v_lshrrev_b32 v14, 1, v14
    v_and_b32 v14, 2, v14
    v_xor_b32 v15, v15, v14
    v_lshl_add_u32 v123, v15, 4, v123
    v_add_u32 v15, 192, v1
    v_mul_u32_u24 v14, 2341, v15
    v_lshrrev_b32 v14, 16, v14
    v_mul_u32_u24 v124, 28, v14
    v_sub_u32 v15, v15, v124
    v_mul_u32_u24 v124, 7168, v14
    v_lshrrev_b32 v14, 1, v14
    v_and_b32 v14, 2, v14
    v_xor_b32 v15, v15, v14
    v_lshl_add_u32 v124, v15, 4, v124
    v_add_u32 v15, 256, v1
    v_mul_u32_u24 v14, 2341, v15
    v_lshrrev_b32 v14, 16, v14
    v_mul_u32_u24 v125, 28, v14
    v_sub_u32 v15, v15, v125
    v_mul_u32_u24 v125, 7168, v14
    v_lshrrev_b32 v14, 1, v14
    v_and_b32 v14, 2, v14
    v_xor_b32 v15, v15, v14
    v_lshl_add_u32 v125, v15, 4, v125
    v_add_u32 v15, 320, v1
    v_mul_u32_u24 v14, 2341, v15
    v_lshrrev_b32 v14, 16, v14
    v_mul_u32_u24 v126, 28, v14
    v_sub_u32 v15, v15, v126
    v_mul_u32_u24 v126, 7168, v14
    v_lshrrev_b32 v14, 1, v14
    v_and_b32 v14, 2, v14
    v_xor_b32 v15, v15, v14
    v_lshl_add_u32 v126, v15, 4, v126
    v_add_u32 v15, 384, v1
    v_mul_u32_u24 v14, 2341, v15
    v_lshrrev_b32 v14, 16, v14
    v_mul_u32_u24 v127, 28, v14
    v_sub_u32 v15, v15, v127
    v_mul_u32_u24 v127, 7168, v14
    v_lshrrev_b32 v14, 1, v14
    v_and_b32 v14, 2, v14
    v_xor_b32 v15, v15, v14
    v_lshl_add_u32 v127, v15, 4, v127
HB_4:
    buffer_load_dwordx4 v[28:31], v22, s[12:15], 0 offen nt
    buffer_load_dwordx2 v[32:33], v23, s[12:15], 0 offen nt
    buffer_load_dwordx4 v[34:37], v24, s[12:15], 0 offen nt
    buffer_load_dwordx2 v[38:39], v25, s[12:15], 0 offen nt
    buffer_load_dwordx4 v[40:43], v26, s[12:15], 0 offen nt
    buffer_load_dwordx2 v[44:45], v27, s[12:15], 0 offen nt
    buffer_load_dwordx4 v[240:243], v2, s[88:91], s50 offen
    s_cmp_ge_u32 s30, 4
    s_cbranch_scc1 HB_3
    s_mul_i32 s36, s30, 21568
    v_lshrrev_b32 v94, 1, v100
    v_mul_u32_u24 v108, 72, v94
    v_and_b32 v94, 1, v100
    v_lshl_add_u32 v108, v94, 4, v108
    v_lshl_add_u32 v108, v101, 2, v108
    v_add_u32 v108, s36, v108
    v_add_u32 v109, 1152, v108
    v_add_u32 v110, 2304, v108
    v_add_u32 v111, 3456, v108
    v_bfe_u32 v94, v1, 2, 2
    v_mul_u32_u24 v103, 21568, v94
    v_mul_u32_u24 v94, 72, v101
    v_add_u32 v103, v103, v94
    v_and_b32 v94, 3, v1
    v_lshl_add_u32 v103, v94, 3, v103
    s_mul_i32 s36, s30, 1152
    v_add_u32 v103, s36, v103
    s_waitcnt lgkmcnt(0)
    s_bitcmp1_b32 s39, 0
    s_cselect_b32 s36, 0, 16
    s_lshl_b32 s41, s41, s36
    s_and_b32 s41, s41, 0xffff0000
    s_lshr_b32 s36, s41, 16
    v_lshl_add_u32 v94, v101, 3, v100
    v_sub_u32 v94, 15, v94
    v_and_b32 v95, 1, v94
    v_cmp_eq_u32 vcc, 1, v95
    v_mov_b32 v95, s36
    v_mov_b32 v96, s41
    v_cndmask_b32 v95, v95, v96, vcc
    v_ashrrev_i32 v94, 1, v94
    v_cmp_eq_u32 vcc, 0, v94
    s_nop 1
    v_cndmask_b32 v104, 0, v95, vcc
    v_cmp_eq_u32 vcc, 1, v94
    s_nop 1
    v_cndmask_b32 v105, 0, v95, vcc
    v_cmp_eq_u32 vcc, 2, v94
    s_nop 1
    v_cndmask_b32 v106, 0, v95, vcc
    v_cmp_eq_u32 vcc, 3, v94
    s_nop 1
    v_cndmask_b32 v107, 0, v95, vcc
HB_3:
    s_waitcnt vmcnt(7) lgkmcnt(0)
    s_barrier
    ds_read_b64_tr_b16 v[128:129], v16 offset:0
    ds_read_b64_tr_b16 v[130:131], v16 offset:1024
    ds_read_b64_tr_b16 v[132:133], v16 offset:2048
    ds_read_b64_tr_b16 v[134:135], v16 offset:3072
    ds_read_b64_tr_b16 v[136:137], v17 offset:4096
    ds_read_b64_tr_b16 v[138:139], v16 offset:17408
    ds_read_b64_tr_b16 v[140:141], v16 offset:18432
    ds_read_b64_tr_b16 v[142:143], v16 offset:19456
    ds_read_b64_tr_b16 v[144:145], v16 offset:20480
    s_load_dword s52, s[84:85], 0
    v_lshlrev_b32 v46, 16, v12
    v_and_b32 v47, 0xffff0000, v12
    v_lshlrev_b32 v48, 16, v13
    v_and_b32 v49, 0xffff0000, v13
    s_waitcnt lgkmcnt(0)
    v_lshlrev_b32 v146, 16, v128
    v_and_b32 v147, 0xffff0000, v128
    v_lshlrev_b32 v148, 16, v129
    v_and_b32 v149, 0xffff0000, v129
    v_lshlrev_b32 v150, 16, v130
    v_and_b32 v151, 0xffff0000, v130
    v_lshlrev_b32 v152, 16, v131
    v_and_b32 v153, 0xffff0000, v131
    v_lshlrev_b32 v154, 16, v132
    v_and_b32 v155, 0xffff0000, v132
    v_lshlrev_b32 v156, 16, v133
    v_and_b32 v157, 0xffff0000, v133
    v_lshlrev_b32 v158, 16, v134
    v_and_b32 v159, 0xffff0000, v134
    v_lshlrev_b32 v160, 16, v135
    v_and_b32 v161, 0xffff0000, v135
    v_lshlrev_b32 v162, 16, v136
    v_and_b32 v163, 0xffff0000, v136
    v_lshlrev_b32 v164, 16, v137
    v_and_b32 v165, 0xffff0000, v137
    v_mul_f32 v166, v147, v49
    v_mul_f32 v167, v148, v49
    v_mul_f32 v168, v149, v49
    v_mul_f32 v169, v150, v49
    v_mul_f32 v170, v151, v49
    v_mul_f32 v171, v152, v49
    v_mul_f32 v172, v153, v49
    v_mul_f32 v173, v154, v49
    v_mul_f32 v174, v155, v49
    v_mul_f32 v175, v156, v49
    v_mul_f32 v176, v157, v49
    v_mul_f32 v177, v158, v49
    v_mul_f32 v178, v159, v49
    v_mul_f32 v179, v160, v49
    v_mul_f32 v180, v161, v49
    v_mul_f32 v181, v162, v49
    v_fmac_f32 v166, v148, v48
    v_fmac_f32 v167, v149, v48
    v_fmac_f32 v168, v150, v48
    v_fmac_f32 v169, v151, v48
    v_fmac_f32 v170, v152, v48
    v_fmac_f32 v171, v153, v48
    v_fmac_f32 v172, v154, v48
    v_fmac_f32 v173, v155, v48
    v_fmac_f32 v174, v156, v48
    v_fmac_f32 v175, v157, v48
    v_fmac_f32 v176, v158, v48
    v_fmac_f32 v177, v159, v48
    v_fmac_f32 v178, v160, v48
    v_fmac_f32 v179, v161, v48
    v_fmac_f32 v180, v162, v48
    v_fmac_f32 v181, v163, v48
    v_fmac_f32 v166, v149, v47
    v_fmac_f32 v167, v150, v47
    v_fmac_f32 v168, v151, v47
    v_fmac_f32 v169, v152, v47
    v_fmac_f32 v170, v153, v47
    v_fmac_f32 v171, v154, v47
    v_fmac_f32 v172, v155, v47
    v_fmac_f32 v173, v156, v47
    v_fmac_f32 v174, v157, v47
    v_fmac_f32 v175, v158, v47
    v_fmac_f32 v176, v159, v47
    v_fmac_f32 v177, v160, v47
    v_fmac_f32 v178, v161, v47
    v_fmac_f32 v179, v162, v47
    v_fmac_f32 v180, v163, v47
    v_fmac_f32 v181, v164, v47
    v_fmac_f32 v166, v150, v46
    v_fmac_f32 v167, v151, v46
    v_fmac_f32 v168, v152, v46
    v_fmac_f32 v169, v153, v46
    v_fmac_f32 v170, v154, v46
    v_fmac_f32 v171, v155, v46
    v_fmac_f32 v172, v156, v46
    v_fmac_f32 v173, v157, v46
    v_fmac_f32 v174, v158, v46
    v_fmac_f32 v175, v159, v46
    v_fmac_f32 v176, v160, v46
    v_fmac_f32 v177, v161, v46
    v_fmac_f32 v178, v162, v46
    v_fmac_f32 v179, v163, v46
    v_fmac_f32 v180, v164, v46
    v_fmac_f32 v181, v165, v46
    v_lshlrev_b32 v146, 16, v138
    v_and_b32 v147, 0xffff0000, v138
    v_lshlrev_b32 v148, 16, v139
    v_and_b32 v149, 0xffff0000, v139
    v_lshlrev_b32 v150, 16, v140
    v_and_b32 v151, 0xffff0000, v140
    v_lshlrev_b32 v152, 16, v141
    v_and_b32 v153, 0xffff0000, v141
    v_lshlrev_b32 v154, 16, v142
    v_and_b32 v155, 0xffff0000, v142
    v_lshlrev_b32 v156, 16, v143
    v_and_b32 v157, 0xffff0000, v143
    v_lshlrev_b32 v158, 16, v144
    v_and_b32 v159, 0xffff0000, v144
    v_lshlrev_b32 v160, 16, v145
    v_and_b32 v161, 0xffff0000, v145
    v_mul_f32 v166, v166, v146
    v_mul_f32 v167, v167, v147
    v_mul_f32 v168, v168, v148
    v_mul_f32 v169, v169, v149
    v_mul_f32 v170, v170, v150
    v_mul_f32 v171, v171, v151
    v_mul_f32 v172, v172, v152
    v_mul_f32 v173, v173, v153
    v_mul_f32 v174, v174, v154
    v_mul_f32 v175, v175, v155
    v_mul_f32 v176, v176, v156
    v_mul_f32 v177, v177, v157
    v_mul_f32 v178, v178, v158
    v_mul_f32 v179, v179, v159
    v_mul_f32 v180, v180, v160
    v_mul_f32 v181, v181, v161
    v_add_u32 v167, 0x10000, v167
    v_and_b32 v167, 0xfffe0000, v167
    v_add_u32 v169, 0x10000, v169
    v_and_b32 v169, 0xfffe0000, v169
    v_add_u32 v171, 0x10000, v171
    v_and_b32 v171, 0xfffe0000, v171
    v_add_u32 v173, 0x10000, v173
    v_and_b32 v173, 0xfffe0000, v173
    v_add_u32 v175, 0x10000, v175
    v_and_b32 v175, 0xfffe0000, v175
    v_add_u32 v177, 0x10000, v177
    v_and_b32 v177, 0xfffe0000, v177
    v_add_u32 v179, 0x10000, v179
    v_and_b32 v179, 0xfffe0000, v179
    v_add_u32 v181, 0x10000, v181
    v_and_b32 v181, 0xfffe0000, v181
    v_cvt_pk_bf16_f32 v52, v173, v172
    v_cvt_pk_bf16_f32 v53, v171, v170
    v_cvt_pk_bf16_f32 v54, v169, v168
    v_cvt_pk_bf16_f32 v55, v167, v166
    v_cvt_pk_bf16_f32 v56, v181, v180
    v_cvt_pk_bf16_f32 v57, v179, v178
    v_cvt_pk_bf16_f32 v58, v177, v176
    v_cvt_pk_bf16_f32 v59, v175, v174
    s_cmp_lg_u32 s52, 0
    s_cbranch_scc1 HB_q
    s_mov_b32 s53, 0
HB_p:
    buffer_load_dword v14, v10, s[84:87], 0 offen sc1
    s_waitcnt vmcnt(0)
    v_readfirstlane_b32 s52, v14
    s_nop 0
    s_cmp_lg_u32 s52, 0
    s_cbranch_scc1 HB_q
    s_add_u32 s53, s53, 1
    s_cmp_lt_u32 s53, s61
    s_cbranch_scc1 HB_p
    s_mov_b32 s52, 1
    s_mov_b32 s61, 0
HB_q:
    v_permlane32_swap_b32 v52, v56
    v_permlane32_swap_b32 v53, v57
    v_permlane32_swap_b32 v54, v58
    v_permlane32_swap_b32 v55, v59
    v_mov_b32 v14, s52
    buffer_store_dwordx4 v[52:55], v18, s[16:19], s43 offen offset:256 sc1
    buffer_store_dwordx4 v[56:59], v18, s[16:19], s43 offen offset:0 sc1
    s_waitcnt vmcnt(3)
    v_alignbit_b32 v128, v29, v28, 16
    v_mov_b32 v132, v29
    v_alignbit_b32 v136, v30, v29, 16
    v_alignbit_b32 v129, v30, v29, 16
    v_mov_b32 v133, v30
    v_alignbit_b32 v137, v31, v30, 16
    v_alignbit_b32 v130, v31, v30, 16
    v_mov_b32 v134, v31
    v_alignbit_b32 v138, v32, v31, 16
    v_alignbit_b32 v131, v32, v31, 16
    v_mov_b32 v135, v32
    v_alignbit_b32 v139, v33, v32, 16
    ds_write_b128 v20, v[128:131] offset:0
    ds_write_b128 v20, v[132:135] offset:4160
    ds_write_b128 v20, v[136:139] offset:8320
    ds_write_b128 v20, v[30:33] offset:12480
    v_alignbit_b32 v140, v35, v34, 16
    v_mov_b32 v144, v35
    v_alignbit_b32 v148, v36, v35, 16
    v_alignbit_b32 v141, v36, v35, 16
    v_mov_b32 v145, v36
    v_alignbit_b32 v149, v37, v36, 16
    v_alignbit_b32 v142, v37, v36, 16
    v_mov_b32 v146, v37
    v_alignbit_b32 v150, v38, v37, 16
    v_alignbit_b32 v143, v38, v37, 16
    v_mov_b32 v147, v38
    v_alignbit_b32 v151, v39, v38, 16
    ds_write_b128 v20, v[140:143] offset:1024
    ds_write_b128 v20, v[144:147] offset:5184
    ds_write_b128 v20, v[148:151] offset:9344
    ds_write_b128 v20, v[36:39] offset:13504
    s_waitcnt vmcnt(0)
    s_mov_b64 exec, 1
    buffer_store_dword v14, v10, s[56:59], s44 offen sc1
    s_mov_b64 exec, -1
    s_cmp_lg_u32 s30, 5
    s_cbranch_scc1 KV_n3
    s_lshl_b32 s36, s2, 14
    s_add_u32 s36, s36, 29360128
    v_lshrrev_b32 v15, 3, v1
    v_mul_u32_u24 v15, 8064, v15
    v_add_u32 v15, v15, v2
    s_mov_b64 exec, 0xffff
    buffer_store_dwordx4 v[60:63], v15, s[56:59], s36 offen sc1
    s_mov_b64 exec, -1
KV_n3:
    v_alignbit_b32 v152, v41, v40, 16
    v_mov_b32 v156, v41
    v_alignbit_b32 v160, v42, v41, 16
    v_alignbit_b32 v153, v42, v41, 16
    v_mov_b32 v157, v42
    v_alignbit_b32 v161, v43, v42, 16
    v_alignbit_b32 v154, v43, v42, 16
    v_mov_b32 v158, v43
    v_alignbit_b32 v162, v44, v43, 16
    v_alignbit_b32 v155, v44, v43, 16
    v_mov_b32 v159, v44
    v_alignbit_b32 v163, v45, v44, 16
    s_mov_b64 exec, 0xf
    ds_write_b128 v19, v[152:155] offset:4096
    ds_write_b128 v19, v[156:159] offset:8256
    ds_write_b128 v19, v[160:163] offset:12416
    ds_write_b128 v19, v[42:45] offset:16576
    s_mov_b64 exec, -1
    s_waitcnt lgkmcnt(0)
    s_barrier
    s_add_u32 s36, s48, 0
    s_add_u32 m0, s49, 90112
    s_nop 0
    buffer_load_dwordx4 v118, s[88:91], s36 offen lds
    s_add_u32 s36, s48, 131072
    s_add_u32 m0, s49, 98304
    s_nop 0
    buffer_load_dwordx4 v118, s[88:91], s36 offen lds
    s_add_u32 s36, s48, 262144
    s_add_u32 m0, s49, 106496
    s_nop 0
    buffer_load_dwordx4 v118, s[88:91], s36 offen lds
    s_add_u32 s36, s48, 393216
    s_add_u32 m0, s49, 114688
    s_nop 0
    buffer_load_dwordx4 v118, s[88:91], s36 offen lds
    s_add_u32 s36, s48, 524288
    s_add_u32 m0, s49, 122880
    s_nop 0
    buffer_load_dwordx4 v118, s[88:91], s36 offen lds
    s_add_u32 s36, s48, 655360
    s_add_u32 m0, s49, 131072
    s_nop 0
    buffer_load_dwordx4 v118, s[88:91], s36 offen lds
    s_add_u32 s36, s48, 786432
    s_add_u32 m0, s49, 139264
    s_nop 0
    buffer_load_dwordx4 v118, s[88:91], s36 offen lds
    s_add_u32 s36, s48, 917504
    s_add_u32 m0, s49, 147456
    s_nop 0
    buffer_load_dwordx4 v118, s[88:91], s36 offen lds
    s_cmp_ge_u32 s30, 4
    s_cbranch_scc1 FR_b
    s_lshl_b32 s44, s30, 12
    s_mov_b32 s45, 0x07060302
    s_cmp_lg_u32 s30, 0
    s_cbranch_scc1 CV_w
    s_mov_b32 s53, 0
    s_add_u32 s54, s52, 0
    s_bfm_b64 exec, 32, 0
poll_1:
    buffer_load_dword v8, v102, s[56:59], 0 offen sc1
    s_waitcnt vmcnt(0)
    v_cmp_eq_u32 vcc, s54, v8
    s_nop 0
    s_cmp_eq_u64 vcc, exec
    s_cbranch_scc1 pok_2
    s_sleep 5
    s_add_u32 s53, s53, 1
    s_cmp_lt_u32 s53, s61
    s_cbranch_scc1 poll_1
    s_mov_b32 s61, 0
pok_2:
    s_mov_b64 exec, -1
CV_w:
    s_add_u32 m0, s40, 16640
    s_mov_b32 s36, 0
    s_waitcnt vmcnt(0)
    s_barrier
    buffer_load_dwordx4 v97, s[20:23], s36 offen offset:0 sc1 lds
    s_add_u32 s36, s36, 3072
    buffer_load_dwordx4 v97, s[20:23], s36 offen offset:1024 sc1 lds
    s_add_u32 s36, s36, 3072
    buffer_load_dwordx4 v97, s[20:23], s36 offen offset:2048 sc1 lds
    s_add_u32 s36, s36, 3072
    buffer_load_dwordx4 v97, s[20:23], s36 offen offset:3072 sc1 lds
    s_barrier
    buffer_load_dwordx2 v[86:87], v80, s[8:11], 0 offen offset:0 nt
    buffer_load_dwordx2 v[88:89], v80, s[8:11], 0 offen offset:32 nt
    buffer_load_dwordx2 v[90:91], v80, s[8:11], 0 offen offset:128 nt
    buffer_load_dwordx2 v[92:93], v80, s[8:11], 0 offen offset:160 nt
    ds_read_b64 v[120:121], v98 offset:32
    ds_read_b64 v[122:123], v98 offset:40
    ds_read_b64 v[124:125], v98 offset:544
    ds_read_b64 v[126:127], v98 offset:552
    ds_read_b64 v[128:129], v98 offset:1056
    ds_read_b64 v[130:131], v98 offset:1064
    ds_read_b64 v[132:133], v98 offset:1568
    ds_read_b64 v[134:135], v98 offset:1576
    ds_read_b64 v[136:137], v98 offset:2080
    ds_read_b64 v[138:139], v98 offset:2088
    ds_read_b64 v[140:141], v98 offset:2592
    ds_read_b64 v[142:143], v98 offset:2600
    ds_read_b64 v[144:145], v98 offset:3104
    ds_read_b64 v[146:147], v98 offset:3112
    ds_read_b64 v[148:149], v98 offset:3616
    ds_read_b64 v[150:151], v98 offset:3624
    s_waitcnt vmcnt(4)
    ds_read_b128 v[184:187], v99 offset:20224
    ds_read_b128 v[188:191], v99 offset:19712
    ds_read_b128 v[192:195], v99 offset:19200
    ds_read_b128 v[196:199], v99 offset:18688
    ds_read_b128 v[200:203], v99 offset:18176
    ds_read_b128 v[204:207], v99 offset:17664
    ds_read_b128 v[208:211], v99 offset:17152
    ds_read_b128 v[212:215], v99 offset:16640
    s_waitcnt lgkmcnt(0)
    v_mfma_f32_16x16x32_bf16 v[12:15], v[104:107], v[184:187], 0
    v_mfma_f32_16x16x32_bf16 v[16:19], v[104:107], v[188:191], 0
    v_mfma_f32_16x16x32_bf16 v[20:23], v[104:107], v[192:195], 0
    v_mfma_f32_16x16x32_bf16 v[24:27], v[104:107], v[196:199], 0
    v_mfma_f32_16x16x32_bf16 v[28:31], v[104:107], v[200:203], 0
    v_mfma_f32_16x16x32_bf16 v[32:35], v[104:107], v[204:207], 0
    v_mfma_f32_16x16x32_bf16 v[36:39], v[104:107], v[208:211], 0
    v_mfma_f32_16x16x32_bf16 v[40:43], v[104:107], v[212:215], 0
    s_mov_b32 s43, 0
CV_r:
    s_waitcnt lgkmcnt(0)
    v_mfma_f32_16x16x32_bf16 v[12:15], v[120:123], v[184:187], v[12:15]
    ds_read_b128 v[216:219], v99 offset:20288
    v_mfma_f32_16x16x32_bf16 v[16:19], v[120:123], v[188:191], v[16:19]
    ds_read_b128 v[220:223], v99 offset:19776
    v_mfma_f32_16x16x32_bf16 v[20:23], v[120:123], v[192:195], v[20:23]
    ds_read_b128 v[224:227], v99 offset:19264
    v_mfma_f32_16x16x32_bf16 v[24:27], v[120:123], v[196:199], v[24:27]
    ds_read_b128 v[228:231], v99 offset:18752
    v_mfma_f32_16x16x32_bf16 v[28:31], v[120:123], v[200:203], v[28:31]
    ds_read_b128 v[232:235], v99 offset:18240
    v_mfma_f32_16x16x32_bf16 v[32:35], v[120:123], v[204:207], v[32:35]
    ds_read_b128 v[236:239], v99 offset:17728
    v_mfma_f32_16x16x32_bf16 v[36:39], v[120:123], v[208:211], v[36:39]
    ds_read_b128 v[240:243], v99 offset:17216
    v_mfma_f32_16x16x32_bf16 v[40:43], v[120:123], v[212:215], v[40:43]
    ds_read_b128 v[244:247], v99 offset:16704
    v_mfma_f32_16x16x32_bf16 v[16:19], v[124:127], v[184:187], v[16:19]
    ds_read_b64 v[152:153], v98 offset:96
    v_mfma_f32_16x16x32_bf16 v[20:23], v[124:127], v[188:191], v[20:23]
    ds_read_b64 v[154:155], v98 offset:104
    v_mfma_f32_16x16x32_bf16 v[24:27], v[124:127], v[192:195], v[24:27]
    ds_read_b64 v[156:157], v98 offset:608
    v_mfma_f32_16x16x32_bf16 v[28:31], v[124:127], v[196:199], v[28:31]
    ds_read_b64 v[158:159], v98 offset:616
    v_mfma_f32_16x16x32_bf16 v[32:35], v[124:127], v[200:203], v[32:35]
    ds_read_b64 v[160:161], v98 offset:1120
    v_mfma_f32_16x16x32_bf16 v[36:39], v[124:127], v[204:207], v[36:39]
    ds_read_b64 v[162:163], v98 offset:1128
    v_mfma_f32_16x16x32_bf16 v[40:43], v[124:127], v[208:211], v[40:43]
    v_mfma_f32_16x16x32_bf16 v[20:23], v[128:131], v[184:187], v[20:23]
    v_mfma_f32_16x16x32_bf16 v[24:27], v[128:131], v[188:191], v[24:27]
    v_mfma_f32_16x16x32_bf16 v[28:31], v[128:131], v[192:195], v[28:31]
    v_mfma_f32_16x16x32_bf16 v[32:35], v[128:131], v[196:199], v[32:35]
    v_mfma_f32_16x16x32_bf16 v[36:39], v[128:131], v[200:203], v[36:39]
    v_mfma_f32_16x16x32_bf16 v[40:43], v[128:131], v[204:207], v[40:43]
    v_mfma_f32_16x16x32_bf16 v[24:27], v[132:135], v[184:187], v[24:27]
    v_mfma_f32_16x16x32_bf16 v[28:31], v[132:135], v[188:191], v[28:31]
    v_mfma_f32_16x16x32_bf16 v[32:35], v[132:135], v[192:195], v[32:35]
    v_mfma_f32_16x16x32_bf16 v[36:39], v[132:135], v[196:199], v[36:39]
    v_mfma_f32_16x16x32_bf16 v[40:43], v[132:135], v[200:203], v[40:43]
    v_mfma_f32_16x16x32_bf16 v[28:31], v[136:139], v[184:187], v[28:31]
    v_mfma_f32_16x16x32_bf16 v[32:35], v[136:139], v[188:191], v[32:35]
    v_mfma_f32_16x16x32_bf16 v[36:39], v[136:139], v[192:195], v[36:39]
    v_mfma_f32_16x16x32_bf16 v[40:43], v[136:139], v[196:199], v[40:43]
    v_mfma_f32_16x16x32_bf16 v[32:35], v[140:143], v[184:187], v[32:35]
    v_mfma_f32_16x16x32_bf16 v[36:39], v[140:143], v[188:191], v[36:39]
    v_mfma_f32_16x16x32_bf16 v[40:43], v[140:143], v[192:195], v[40:43]
    v_mfma_f32_16x16x32_bf16 v[36:39], v[144:147], v[184:187], v[36:39]
    v_mfma_f32_16x16x32_bf16 v[40:43], v[144:147], v[188:191], v[40:43]
    v_mfma_f32_16x16x32_bf16 v[40:43], v[148:151], v[184:187], v[40:43]
    ds_read_b64 v[164:165], v98 offset:1632
    ds_read_b64 v[166:167], v98 offset:1640
    ds_read_b64 v[168:169], v98 offset:2144
    ds_read_b64 v[170:171], v98 offset:2152
    ds_read_b64 v[172:173], v98 offset:2656
    ds_read_b64 v[174:175], v98 offset:2664
    ds_read_b64 v[176:177], v98 offset:3168
    ds_read_b64 v[178:179], v98 offset:3176
    ds_read_b64 v[180:181], v98 offset:3680
    ds_read_b64 v[182:183], v98 offset:3688
    s_waitcnt lgkmcnt(0)
    v_mfma_f32_16x16x32_bf16 v[12:15], v[152:155], v[216:219], v[12:15]
    ds_read_b128 v[184:187], v99 offset:20352
    v_mfma_f32_16x16x32_bf16 v[16:19], v[152:155], v[220:223], v[16:19]
    ds_read_b128 v[188:191], v99 offset:19840
    v_mfma_f32_16x16x32_bf16 v[20:23], v[152:155], v[224:227], v[20:23]
    ds_read_b128 v[192:195], v99 offset:19328
    v_mfma_f32_16x16x32_bf16 v[24:27], v[152:155], v[228:231], v[24:27]
    ds_read_b128 v[196:199], v99 offset:18816
    v_mfma_f32_16x16x32_bf16 v[28:31], v[152:155], v[232:235], v[28:31]
    ds_read_b128 v[200:203], v99 offset:18304
    v_mfma_f32_16x16x32_bf16 v[32:35], v[152:155], v[236:239], v[32:35]
    ds_read_b128 v[204:207], v99 offset:17792
    v_mfma_f32_16x16x32_bf16 v[36:39], v[152:155], v[240:243], v[36:39]
    ds_read_b128 v[208:211], v99 offset:17280
    v_mfma_f32_16x16x32_bf16 v[40:43], v[152:155], v[244:247], v[40:43]
    ds_read_b128 v[212:215], v99 offset:16768
    v_mfma_f32_16x16x32_bf16 v[16:19], v[156:159], v[216:219], v[16:19]
    ds_read_b64 v[120:121], v98 offset:160
    v_mfma_f32_16x16x32_bf16 v[20:23], v[156:159], v[220:223], v[20:23]
    ds_read_b64 v[122:123], v98 offset:168
    v_mfma_f32_16x16x32_bf16 v[24:27], v[156:159], v[224:227], v[24:27]
    ds_read_b64 v[124:125], v98 offset:672
    v_mfma_f32_16x16x32_bf16 v[28:31], v[156:159], v[228:231], v[28:31]
    ds_read_b64 v[126:127], v98 offset:680
    v_mfma_f32_16x16x32_bf16 v[32:35], v[156:159], v[232:235], v[32:35]
    ds_read_b64 v[128:129], v98 offset:1184
    v_mfma_f32_16x16x32_bf16 v[36:39], v[156:159], v[236:239], v[36:39]
    ds_read_b64 v[130:131], v98 offset:1192
    v_mfma_f32_16x16x32_bf16 v[40:43], v[156:159], v[240:243], v[40:43]
    v_mfma_f32_16x16x32_bf16 v[20:23], v[160:163], v[216:219], v[20:23]
    v_mfma_f32_16x16x32_bf16 v[24:27], v[160:163], v[220:223], v[24:27]
    v_mfma_f32_16x16x32_bf16 v[28:31], v[160:163], v[224:227], v[28:31]
    v_mfma_f32_16x16x32_bf16 v[32:35], v[160:163], v[228:231], v[32:35]
    v_mfma_f32_16x16x32_bf16 v[36:39], v[160:163], v[232:235], v[36:39]
    v_mfma_f32_16x16x32_bf16 v[40:43], v[160:163], v[236:239], v[40:43]
    v_mfma_f32_16x16x32_bf16 v[24:27], v[164:167], v[216:219], v[24:27]
    v_mfma_f32_16x16x32_bf16 v[28:31], v[164:167], v[220:223], v[28:31]
    v_mfma_f32_16x16x32_bf16 v[32:35], v[164:167], v[224:227], v[32:35]
    v_mfma_f32_16x16x32_bf16 v[36:39], v[164:167], v[228:231], v[36:39]
    v_mfma_f32_16x16x32_bf16 v[40:43], v[164:167], v[232:235], v[40:43]
    v_mfma_f32_16x16x32_bf16 v[28:31], v[168:171], v[216:219], v[28:31]
    v_mfma_f32_16x16x32_bf16 v[32:35], v[168:171], v[220:223], v[32:35]
    v_mfma_f32_16x16x32_bf16 v[36:39], v[168:171], v[224:227], v[36:39]
    v_mfma_f32_16x16x32_bf16 v[40:43], v[168:171], v[228:231], v[40:43]
    v_mfma_f32_16x16x32_bf16 v[32:35], v[172:175], v[216:219], v[32:35]
    v_mfma_f32_16x16x32_bf16 v[36:39], v[172:175], v[220:223], v[36:39]
    v_mfma_f32_16x16x32_bf16 v[40:43], v[172:175], v[224:227], v[40:43]
    v_mfma_f32_16x16x32_bf16 v[36:39], v[176:179], v[216:219], v[36:39]
    v_mfma_f32_16x16x32_bf16 v[40:43], v[176:179], v[220:223], v[40:43]
    v_mfma_f32_16x16x32_bf16 v[40:43], v[180:183], v[216:219], v[40:43]
    ds_read_b64 v[132:133], v98 offset:1696
    ds_read_b64 v[134:135], v98 offset:1704
    ds_read_b64 v[136:137], v98 offset:2208
    ds_read_b64 v[138:139], v98 offset:2216
    ds_read_b64 v[140:141], v98 offset:2720
    ds_read_b64 v[142:143], v98 offset:2728
    ds_read_b64 v[144:145], v98 offset:3232
    ds_read_b64 v[146:147], v98 offset:3240
    ds_read_b64 v[148:149], v98 offset:3744
    ds_read_b64 v[150:151], v98 offset:3752
    v_add_u32 v98, 128, v98
    v_add_u32 v99, 128, v99
    s_add_u32 s43, s43, 1
    s_cmp_lt_u32 s43, 3
    s_cbranch_scc1 CV_r
CV_l:
    s_waitcnt lgkmcnt(0)
    v_mfma_f32_16x16x32_bf16 v[12:15], v[120:123], v[184:187], v[12:15]
    ds_read_b128 v[216:219], v99 offset:20288
    v_mfma_f32_16x16x32_bf16 v[16:19], v[120:123], v[188:191], v[16:19]
    ds_read_b128 v[220:223], v99 offset:19776
    v_mfma_f32_16x16x32_bf16 v[20:23], v[120:123], v[192:195], v[20:23]
    ds_read_b128 v[224:227], v99 offset:19264
    v_mfma_f32_16x16x32_bf16 v[24:27], v[120:123], v[196:199], v[24:27]
    ds_read_b128 v[228:231], v99 offset:18752
    v_mfma_f32_16x16x32_bf16 v[28:31], v[120:123], v[200:203], v[28:31]
    ds_read_b128 v[232:235], v99 offset:18240
    v_mfma_f32_16x16x32_bf16 v[32:35], v[120:123], v[204:207], v[32:35]
    ds_read_b128 v[236:239], v99 offset:17728
    v_mfma_f32_16x16x32_bf16 v[36:39], v[120:123], v[208:211], v[36:39]
    ds_read_b128 v[240:243], v99 offset:17216
    v_mfma_f32_16x16x32_bf16 v[40:43], v[120:123], v[212:215], v[40:43]
    ds_read_b128 v[244:247], v99 offset:16704
    v_mfma_f32_16x16x32_bf16 v[16:19], v[124:127], v[184:187], v[16:19]
    ds_read_b64 v[152:153], v98 offset:96
    v_mfma_f32_16x16x32_bf16 v[20:23], v[124:127], v[188:191], v[20:23]
    ds_read_b64 v[154:155], v98 offset:104
    v_mfma_f32_16x16x32_bf16 v[24:27], v[124:127], v[192:195], v[24:27]
    ds_read_b64 v[156:157], v98 offset:608
    v_mfma_f32_16x16x32_bf16 v[28:31], v[124:127], v[196:199], v[28:31]
    ds_read_b64 v[158:159], v98 offset:616
    v_mfma_f32_16x16x32_bf16 v[32:35], v[124:127], v[200:203], v[32:35]
    ds_read_b64 v[160:161], v98 offset:1120
    v_mfma_f32_16x16x32_bf16 v[36:39], v[124:127], v[204:207], v[36:39]
    ds_read_b64 v[162:163], v98 offset:1128
    v_mfma_f32_16x16x32_bf16 v[40:43], v[124:127], v[208:211], v[40:43]
    ds_read_b64 v[164:165], v98 offset:1632
    v_mfma_f32_16x16x32_bf16 v[20:23], v[128:131], v[184:187], v[20:23]
    ds_read_b64 v[166:167], v98 offset:1640
    v_mfma_f32_16x16x32_bf16 v[24:27], v[128:131], v[188:191], v[24:27]
    ds_read_b64 v[168:169], v98 offset:2144
    v_mfma_f32_16x16x32_bf16 v[28:31], v[128:131], v[192:195], v[28:31]
    ds_read_b64 v[170:171], v98 offset:2152
    v_mfma_f32_16x16x32_bf16 v[32:35], v[128:131], v[196:199], v[32:35]
    ds_read_b64 v[172:173], v98 offset:2656
    v_mfma_f32_16x16x32_bf16 v[36:39], v[128:131], v[200:203], v[36:39]
    ds_read_b64 v[174:175], v98 offset:2664
    v_mfma_f32_16x16x32_bf16 v[40:43], v[128:131], v[204:207], v[40:43]
    ds_read_b64 v[176:177], v98 offset:3168
    v_mfma_f32_16x16x32_bf16 v[24:27], v[132:135], v[184:187], v[24:27]
    ds_read_b64 v[178:179], v98 offset:3176
    v_mfma_f32_16x16x32_bf16 v[28:31], v[132:135], v[188:191], v[28:31]
    ds_read_b64 v[180:181], v98 offset:3680
    v_mfma_f32_16x16x32_bf16 v[32:35], v[132:135], v[192:195], v[32:35]
    ds_read_b64 v[182:183], v98 offset:3688
    v_mfma_f32_16x16x32_bf16 v[36:39], v[132:135], v[196:199], v[36:39]
    v_mfma_f32_16x16x32_bf16 v[40:43], v[132:135], v[200:203], v[40:43]
    v_mfma_f32_16x16x32_bf16 v[28:31], v[136:139], v[184:187], v[28:31]
    v_mfma_f32_16x16x32_bf16 v[32:35], v[136:139], v[188:191], v[32:35]
    v_mfma_f32_16x16x32_bf16 v[36:39], v[136:139], v[192:195], v[36:39]
    v_mfma_f32_16x16x32_bf16 v[40:43], v[136:139], v[196:199], v[40:43]
    v_mfma_f32_16x16x32_bf16 v[32:35], v[140:143], v[184:187], v[32:35]
    v_mfma_f32_16x16x32_bf16 v[36:39], v[140:143], v[188:191], v[36:39]
    v_mfma_f32_16x16x32_bf16 v[40:43], v[140:143], v[192:195], v[40:43]
    v_mfma_f32_16x16x32_bf16 v[36:39], v[144:147], v[184:187], v[36:39]
    v_mfma_f32_16x16x32_bf16 v[40:43], v[144:147], v[188:191], v[40:43]
    v_mfma_f32_16x16x32_bf16 v[40:43], v[148:151], v[184:187], v[40:43]
    s_waitcnt lgkmcnt(0)
    v_mfma_f32_16x16x32_bf16 v[12:15], v[152:155], v[216:219], v[12:15]
    ds_read_b128 v[184:187], v99 offset:20352
    v_mfma_f32_16x16x32_bf16 v[16:19], v[152:155], v[220:223], v[16:19]
    ds_read_b128 v[188:191], v99 offset:19840
    v_mfma_f32_16x16x32_bf16 v[20:23], v[152:155], v[224:227], v[20:23]
    ds_read_b128 v[192:195], v99 offset:19328
    v_mfma_f32_16x16x32_bf16 v[24:27], v[152:155], v[228:231], v[24:27]
    ds_read_b128 v[196:199], v99 offset:18816
    v_mfma_f32_16x16x32_bf16 v[28:31], v[152:155], v[232:235], v[28:31]
    ds_read_b128 v[200:203], v99 offset:18304
    v_mfma_f32_16x16x32_bf16 v[32:35], v[152:155], v[236:239], v[32:35]
    ds_read_b128 v[204:207], v99 offset:17792
    v_mfma_f32_16x16x32_bf16 v[36:39], v[152:155], v[240:243], v[36:39]
    ds_read_b128 v[208:211], v99 offset:17280
    v_mfma_f32_16x16x32_bf16 v[40:43], v[152:155], v[244:247], v[40:43]
    ds_read_b128 v[212:215], v99 offset:16768
    v_mfma_f32_16x16x32_bf16 v[16:19], v[156:159], v[216:219], v[16:19]
    ds_read_b64 v[120:121], v98 offset:160
    v_mfma_f32_16x16x32_bf16 v[20:23], v[156:159], v[220:223], v[20:23]
    ds_read_b64 v[122:123], v98 offset:168
    v_mfma_f32_16x16x32_bf16 v[24:27], v[156:159], v[224:227], v[24:27]
    ds_read_b64 v[124:125], v98 offset:672
    v_mfma_f32_16x16x32_bf16 v[28:31], v[156:159], v[228:231], v[28:31]
    ds_read_b64 v[126:127], v98 offset:680
    v_mfma_f32_16x16x32_bf16 v[32:35], v[156:159], v[232:235], v[32:35]
    ds_read_b64 v[128:129], v98 offset:1184
    v_mfma_f32_16x16x32_bf16 v[36:39], v[156:159], v[236:239], v[36:39]
    ds_read_b64 v[130:131], v98 offset:1192
    v_mfma_f32_16x16x32_bf16 v[40:43], v[156:159], v[240:243], v[40:43]
    ds_read_b64 v[132:133], v98 offset:1696
    v_mfma_f32_16x16x32_bf16 v[20:23], v[160:163], v[216:219], v[20:23]
    ds_read_b64 v[134:135], v98 offset:1704
    v_mfma_f32_16x16x32_bf16 v[24:27], v[160:163], v[220:223], v[24:27]
    ds_read_b64 v[136:137], v98 offset:2208
    v_mfma_f32_16x16x32_bf16 v[28:31], v[160:163], v[224:227], v[28:31]
    ds_read_b64 v[138:139], v98 offset:2216
    v_mfma_f32_16x16x32_bf16 v[32:35], v[160:163], v[228:231], v[32:35]
    ds_read_b64 v[140:141], v98 offset:2720
    v_mfma_f32_16x16x32_bf16 v[36:39], v[160:163], v[232:235], v[36:39]
    ds_read_b64 v[142:143], v98 offset:2728
    v_mfma_f32_16x16x32_bf16 v[40:43], v[160:163], v[236:239], v[40:43]
    ds_read_b64 v[144:145], v98 offset:3232
    v_mfma_f32_16x16x32_bf16 v[24:27], v[164:167], v[216:219], v[24:27]
    ds_read_b64 v[146:147], v98 offset:3240
    v_mfma_f32_16x16x32_bf16 v[28:31], v[164:167], v[220:223], v[28:31]
    ds_read_b64 v[148:149], v98 offset:3744
    v_mfma_f32_16x16x32_bf16 v[32:35], v[164:167], v[224:227], v[32:35]
    ds_read_b64 v[150:151], v98 offset:3752
    v_mfma_f32_16x16x32_bf16 v[36:39], v[164:167], v[228:231], v[36:39]
    v_add_u32 v98, 128, v98
    v_mfma_f32_16x16x32_bf16 v[40:43], v[164:167], v[232:235], v[40:43]
    v_add_u32 v99, 128, v99
    v_mfma_f32_16x16x32_bf16 v[28:31], v[168:171], v[216:219], v[28:31]
    s_add_u32 s43, s43, 1
    v_mfma_f32_16x16x32_bf16 v[32:35], v[168:171], v[220:223], v[32:35]
    s_cmp_lt_u32 s43, 4
    v_mfma_f32_16x16x32_bf16 v[36:39], v[168:171], v[224:227], v[36:39]
    v_mfma_f32_16x16x32_bf16 v[40:43], v[168:171], v[228:231], v[40:43]
    v_mfma_f32_16x16x32_bf16 v[32:35], v[172:175], v[216:219], v[32:35]
    v_mfma_f32_16x16x32_bf16 v[36:39], v[172:175], v[220:223], v[36:39]
    v_mfma_f32_16x16x32_bf16 v[40:43], v[172:175], v[224:227], v[40:43]
    v_mfma_f32_16x16x32_bf16 v[36:39], v[176:179], v[216:219], v[36:39]
    v_mfma_f32_16x16x32_bf16 v[40:43], v[176:179], v[220:223], v[40:43]
    v_mfma_f32_16x16x32_bf16 v[40:43], v[180:183], v[216:219], v[40:43]
    s_cbranch_scc1 CV_l
    s_bitcmp1_b32 s30, 0
    s_waitcnt lgkmcnt(0)
    s_cbranch_scc1 CV_o
    v_perm_b32 v12, v14, v12, s45
    v_perm_b32 v13, v15, v13, s45
    v_or_b32 v12, 0x10001, v12
    v_or_b32 v13, 0x10001, v13
    ds_write2_b32 v108, v12, v13 offset0:0 offset1:8
    v_perm_b32 v16, v18, v16, s45
    v_perm_b32 v17, v19, v17, s45
    v_or_b32 v16, 0x10001, v16
    v_or_b32 v17, 0x10001, v17
    ds_write2_b32 v108, v16, v17 offset0:144 offset1:152
    v_perm_b32 v20, v22, v20, s45
    v_perm_b32 v21, v23, v21, s45
    v_or_b32 v20, 0x10001, v20
    v_or_b32 v21, 0x10001, v21
    ds_write2_b32 v109, v20, v21 offset0:0 offset1:8
    v_perm_b32 v24, v26, v24, s45
    v_perm_b32 v25, v27, v25, s45
    v_or_b32 v24, 0x10001, v24
    v_or_b32 v25, 0x10001, v25
    ds_write2_b32 v109, v24, v25 offset0:144 offset1:152
    v_perm_b32 v28, v30, v28, s45
    v_perm_b32 v29, v31, v29, s45
    v_or_b32 v28, 0x10001, v28
    v_or_b32 v29, 0x10001, v29
    ds_write2_b32 v110, v28, v29 offset0:0 offset1:8
    v_perm_b32 v32, v34, v32, s45
    v_perm_b32 v33, v35, v33, s45
    v_or_b32 v32, 0x10001, v32
    v_or_b32 v33, 0x10001, v33
    ds_write2_b32 v110, v32, v33 offset0:144 offset1:152
    v_perm_b32 v36, v38, v36, s45
    v_perm_b32 v37, v39, v37, s45
    v_or_b32 v36, 0x10001, v36
    v_or_b32 v37, 0x10001, v37
    ds_write2_b32 v111, v36, v37 offset0:0 offset1:8
    v_perm_b32 v40, v42, v40, s45
    v_perm_b32 v41, v43, v41, s45
    v_or_b32 v40, 0x10001, v40
    v_or_b32 v41, 0x10001, v41
    ds_write2_b32 v111, v40, v41 offset0:144 offset1:152
    s_branch CV_e
CV_o:
    v_cvt_pk_bf16_f32 v12, v12, v14
    v_cvt_pk_bf16_f32 v13, v13, v15
    ds_write2_b32 v108, v12, v13 offset0:0 offset1:8
    v_cvt_pk_bf16_f32 v16, v16, v18
    v_cvt_pk_bf16_f32 v17, v17, v19
    ds_write2_b32 v108, v16, v17 offset0:144 offset1:152
    v_cvt_pk_bf16_f32 v20, v20, v22
    v_cvt_pk_bf16_f32 v21, v21, v23
    ds_write2_b32 v109, v20, v21 offset0:0 offset1:8
    v_cvt_pk_bf16_f32 v24, v24, v26
    v_cvt_pk_bf16_f32 v25, v25, v27
    ds_write2_b32 v109, v24, v25 offset0:144 offset1:152
    v_cvt_pk_bf16_f32 v28, v28, v30
    v_cvt_pk_bf16_f32 v29, v29, v31
    ds_write2_b32 v110, v28, v29 offset0:0 offset1:8
    v_cvt_pk_bf16_f32 v32, v32, v34
    v_cvt_pk_bf16_f32 v33, v33, v35
    ds_write2_b32 v110, v32, v33 offset0:144 offset1:152
    v_cvt_pk_bf16_f32 v36, v36, v38
    v_cvt_pk_bf16_f32 v37, v37, v39
    ds_write2_b32 v111, v36, v37 offset0:0 offset1:8
    v_cvt_pk_bf16_f32 v40, v40, v42
    v_cvt_pk_bf16_f32 v41, v41, v43
    ds_write2_b32 v111, v40, v41 offset0:144 offset1:152
CV_e:
    v_mov_b32 v8, 162824
    v_mov_b32 v9, 1
    s_waitcnt lgkmcnt(0)
    s_mov_b64 exec, 1
    ds_add_u32 v8, v9
    s_mov_b64 exec, -1
    v_mov_b32 v8, 162824
spin_3:
    ds_read_b32 v9, v8
    s_waitcnt lgkmcnt(0)
    v_readfirstlane_b32 s53, v9
    s_nop 0
    s_cmp_ge_u32 s53, 8
    s_cbranch_scc0 spin_3
    ds_read_b64_tr_b16 v[120:121], v103 offset:0
    ds_read_b64_tr_b16 v[122:123], v103 offset:32
    ds_read_b64_tr_b16 v[124:125], v103 offset:288
    ds_read_b64_tr_b16 v[126:127], v103 offset:320
    ds_read_b64_tr_b16 v[128:129], v103 offset:576
    ds_read_b64_tr_b16 v[130:131], v103 offset:608
    ds_read_b64_tr_b16 v[132:133], v103 offset:864
    ds_read_b64_tr_b16 v[134:135], v103 offset:896
    s_waitcnt lgkmcnt(6)
    buffer_store_dwordx4 v[120:123], v2, s[20:23], s44 offen offset:0 sc1
    s_waitcnt lgkmcnt(4)
    buffer_store_dwordx4 v[124:127], v2, s[20:23], s44 offen offset:1024 sc1
    s_waitcnt lgkmcnt(2)
    buffer_store_dwordx4 v[128:131], v2, s[20:23], s44 offen offset:2048 sc1
    s_waitcnt lgkmcnt(0)
    buffer_store_dwordx4 v[132:135], v2, s[20:23], s44 offen offset:3072 sc1
    s_waitcnt vmcnt(4)
    s_branch FR_end
FR_b:
    v_lshrrev_b32 v10, 2, v1
    v_lshlrev_b32 v74, 7, v10
    v_bfe_u32 v10, v10, 1, 2
    s_and_b32 s35, s30, 2
    v_and_b32 v11, 1, v1
    v_or_b32 v11, s35, v11
    v_xor_b32 v10, v10, v11
    v_lshl_add_u32 v74, v10, 5, v74
    v_and_b32 v10, 2, v1
    v_lshl_add_u32 v74, v10, 2, v74
    s_and_b32 s35, s30, 1
    s_lshl_b32 s35, s35, 4
    v_add_u32 v74, s35, v74
    v_add_u32 v75, 65536, v74
    v_add_u32 v76, 131072, v74
    s_and_b32 s36, s30, 3
    s_lshl_b32 s36, s36, 14
    s_lshl_b32 s48, s29, 7
    s_add_u32 s48, s48, s36
    s_cmp_lg_u32 s30, 5
    s_cbranch_scc1 FB_np
    s_waitcnt vmcnt(8)
    s_lshl_b32 s42, s2, 14
    s_add_u32 s42, s42, 29360128
    s_memtime s[34:35]
    s_waitcnt lgkmcnt(0)
    s_load_dword s32, s[4:5], s42 offset:0 glc
    s_waitcnt lgkmcnt(0)
    s_memtime s[40:41]
    s_waitcnt lgkmcnt(0)
    s_sub_u32 s46, s40, s34
    s_memtime s[34:35]
    s_waitcnt lgkmcnt(0)
    s_load_dword s32, s[4:5], s42 offset:8192 glc
    s_waitcnt lgkmcnt(0)
    s_memtime s[40:41]
    s_waitcnt lgkmcnt(0)
    s_sub_u32 s47, s40, s34
    s_cmp_lt_u32 s47, s46
    s_cselect_b32 s45, 1, 0
    s_lshr_b32 s46, s28, 2
    s_xor_b32 s45, s45, s46
    s_lshr_b32 s46, s2, 7
    s_xor_b32 s45, s45, s46
    s_and_b32 s45, s45, 1
    s_lshl_b32 s45, s45, 1
FB_np:
    s_lshr_b32 s53, s28, 3
    s_lshl_b32 s53, s53, 2
    s_and_b32 s54, s28, 3
    s_add_u32 s53, s53, s54
    s_lshl_b32 s53, s53, 23
    s_lshr_b32 s54, s28, 2
    s_xor_b32 s54, s54, s94
    s_and_b32 s54, s54, 1
    s_lshl_b32 s54, s54, 13
    s_add_u32 s37, s53, s54
    s_add_u32 s37, s37, 33554432
    s_andn2_b32 s37, s37, 0x2000
    s_lshl_b32 s43, s29, 7
    s_add_u32 s37, s37, s43
    s_add_u32 s37, s37, 1835008
    s_add_u32 s43, s43, 23068672
    v_mov_b32 v102, s52
    v_and_b32 v103, 1, v1
    v_lshlrev_b32 v103, 13, v103
    v_bfe_u32 v104, v1, 1, 1
    v_lshl_add_u32 v103, v104, 26, v103
    v_lshrrev_b32 v104, 2, v1
    v_lshl_add_u32 v103, v104, 11, v103
    s_waitcnt vmcnt(0) lgkmcnt(0)
    s_barrier
    ds_read_b64_tr_b16 v[132:133], v75 offset:24576
    ds_read_b64_tr_b16 v[134:135], v75 offset:26624
    ds_read_b64_tr_b16 v[140:141], v75 offset:28672
    ds_read_b64_tr_b16 v[142:143], v75 offset:30720
    ds_read_b64_tr_b16 v[148:149], v75 offset:32768
    ds_read_b64_tr_b16 v[150:151], v75 offset:34816
    ds_read_b64_tr_b16 v[156:157], v75 offset:36864
    ds_read_b64_tr_b16 v[158:159], v75 offset:38912
    ds_read_b64_tr_b16 v[164:165], v75 offset:40960
    ds_read_b64_tr_b16 v[166:167], v75 offset:43008
    ds_read_b64_tr_b16 v[172:173], v75 offset:45056
    ds_read_b64_tr_b16 v[174:175], v75 offset:47104
    ds_read_b64_tr_b16 v[180:181], v75 offset:49152
    ds_read_b64_tr_b16 v[182:183], v75 offset:51200
    ds_read_b64_tr_b16 v[188:189], v75 offset:53248
    ds_read_b64_tr_b16 v[190:191], v75 offset:55296
    ds_read_b64_tr_b16 v[196:197], v75 offset:57344
    ds_read_b64_tr_b16 v[198:199], v75 offset:59392
    ds_read_b64_tr_b16 v[204:205], v75 offset:61440
    ds_read_b64_tr_b16 v[206:207], v75 offset:63488
    ds_read_b64_tr_b16 v[212:213], v76 offset:0
    ds_read_b64_tr_b16 v[214:215], v76 offset:2048
    ds_read_b64_tr_b16 v[220:221], v76 offset:4096
    ds_read_b64_tr_b16 v[222:223], v76 offset:6144
    ds_read_b64_tr_b16 v[228:229], v76 offset:8192
    ds_read_b64_tr_b16 v[230:231], v76 offset:10240
    ds_read_b64_tr_b16 v[236:237], v76 offset:12288
    ds_read_b64_tr_b16 v[238:239], v76 offset:14336
    ds_read_b64_tr_b16 v[244:245], v76 offset:16384
    ds_read_b64_tr_b16 v[246:247], v76 offset:18432
    ds_read_b64_tr_b16 v[252:253], v76 offset:20480
    ds_read_b64_tr_b16 v[254:255], v76 offset:22528
    s_waitcnt lgkmcnt(0)
    s_barrier
    s_cmp_lg_u32 s30, 5
    s_cbranch_scc1 FB_na
    s_lshl_b32 s36, s2, 7
    s_add_u32 s36, s36, 23592960
    s_add_u32 s45, s45, s52
    s_getreg_b32 s53, hwreg(HW_REG_XCC_ID, 0, 4)
    s_lshl2_add_u32 s45, s53, s45
    v_mov_b32 v8, s45
    s_mov_b64 exec, 1
    buffer_store_dword v8, v2, s[56:59], s36 offen sc1
    s_mov_b64 exec, -1
FB_na:
    buffer_load_dwordx4 v[12:15], v2, s[80:83], s50 offen
    s_sub_u32 s50, s50, 4096
    buffer_load_dwordx4 v[12:15], v2, s[80:83], s50 offen
    s_sub_u32 s50, s50, 4096
    buffer_load_dwordx2 v[86:87], v80, s[8:11], 0 offen offset:0 nt
    buffer_load_dwordx2 v[88:89], v80, s[8:11], 0 offen offset:32 nt
    buffer_load_dwordx2 v[90:91], v80, s[8:11], 0 offen offset:128 nt
    buffer_load_dwordx2 v[92:93], v80, s[8:11], 0 offen offset:160 nt
    s_setprio 0
    s_cmp_lg_u32 s30, 4
    s_cbranch_scc1 FB_ni
    s_mov_b64 exec, 0xfff
    buffer_store_dword v102, v103, s[56:59], s37 offen sc1
    s_cmp_lg_u32 s28, 0
    s_cbranch_scc1 FB_n2
    s_mov_b64 exec, 3
    buffer_store_dword v102, v103, s[56:59], s43 offen sc1
FB_n2:
    s_mov_b64 exec, -1
FB_ni:
    s_add_u32 s36, s48, 0
    buffer_load_dwordx4 v[128:131], v118, s[88:91], s36 offen
    s_add_u32 s36, s36, 65536
    buffer_load_dwordx4 v[136:139], v118, s[88:91], s36 offen
    s_add_u32 s36, s48, 131072
    buffer_load_dwordx4 v[144:147], v118, s[88:91], s36 offen
    s_add_u32 s36, s36, 65536
    buffer_load_dwordx4 v[152:155], v118, s[88:91], s36 offen
    s_and_b32 s49, s30, 3
    s_lshl_b32 s36, s49, 14
    s_lshl_b32 s48, s29, 7
    s_add_u32 s48, s48, s36
    s_lshl_b32 s49, s49, 10
    s_xor_b32 s48, s48, 128
    s_add_u32 s36, s48, 1441792
    s_add_u32 m0, s49, 114688
    s_nop 0
    buffer_load_dwordx4 v118, s[80:83], s36 offen lds
    s_add_u32 s36, s36, 65536
    s_add_u32 m0, s49, 118784
    s_nop 0
    buffer_load_dwordx4 v118, s[80:83], s36 offen lds
    s_add_u32 s36, s48, 1572864
    s_add_u32 m0, s49, 122880
    s_nop 0
    buffer_load_dwordx4 v118, s[80:83], s36 offen lds
    s_add_u32 s36, s36, 65536
    s_add_u32 m0, s49, 126976
    s_nop 0
    buffer_load_dwordx4 v118, s[80:83], s36 offen lds
    s_add_u32 s36, s48, 1966080
    s_add_u32 m0, s49, 147456
    s_nop 0
    buffer_load_dwordx4 v118, s[80:83], s36 offen lds
    s_add_u32 s36, s36, 65536
    s_add_u32 m0, s49, 151552
    s_nop 0
    buffer_load_dwordx4 v118, s[80:83], s36 offen lds
    s_add_u32 s36, s48, 1703936
    s_add_u32 m0, s49, 131072
    s_nop 0
    buffer_load_dwordx4 v118, s[80:83], s36 offen lds
    s_add_u32 s36, s36, 65536
    s_add_u32 m0, s49, 135168
    s_nop 0
    buffer_load_dwordx4 v118, s[80:83], s36 offen lds
    s_add_u32 s36, s48, 1835008
    s_add_u32 m0, s49, 139264
    s_nop 0
    buffer_load_dwordx4 v118, s[80:83], s36 offen lds
    s_add_u32 s36, s36, 65536
    s_add_u32 m0, s49, 143360
    s_nop 0
    buffer_load_dwordx4 v118, s[80:83], s36 offen lds
    s_waitcnt vmcnt(14)
    v_mov_b32 v6, 162824
    v_mov_b32 v7, 1
    s_waitcnt lgkmcnt(0)
    s_mov_b64 exec, 1
    ds_add_u32 v6, v7
    s_mov_b64 exec, -1
    s_add_u32 s36, s48, 393216
    buffer_load_dwordx4 v[28:31], v118, s[80:83], s36 offen
    s_add_u32 s36, s36, 65536
    buffer_load_dwordx4 v[32:35], v118, s[80:83], s36 offen
    s_add_u32 s36, s48, 524288
    buffer_load_dwordx4 v[36:39], v118, s[80:83], s36 offen
    s_add_u32 s36, s36, 65536
    buffer_load_dwordx4 v[40:43], v118, s[80:83], s36 offen
    s_add_u32 s36, s48, 655360
    buffer_load_dwordx4 v[52:55], v118, s[80:83], s36 offen
    s_add_u32 s36, s36, 65536
    buffer_load_dwordx4 v[56:59], v118, s[80:83], s36 offen
    s_add_u32 s36, s48, 786432
    buffer_load_dwordx4 v[60:63], v118, s[80:83], s36 offen
    s_add_u32 s36, s36, 65536
    buffer_load_dwordx4 v[64:67], v118, s[80:83], s36 offen
    s_add_u32 s36, s48, 0
    buffer_load_dwordx4 v[94:97], v118, s[80:83], s36 offen
    s_add_u32 s36, s36, 65536
    buffer_load_dwordx4 v[98:101], v118, s[80:83], s36 offen
    s_xor_b32 s48, s48, 128
    s_add_u32 s36, s48, 262144
    buffer_load_dwordx4 v[160:163], v118, s[88:91], s36 offen
    s_add_u32 s36, s36, 65536
    buffer_load_dwordx4 v[168:171], v118, s[88:91], s36 offen
    s_add_u32 s36, s48, 393216
    buffer_load_dwordx4 v[176:179], v118, s[88:91], s36 offen
    s_add_u32 s36, s36, 65536
    buffer_load_dwordx4 v[184:187], v118, s[88:91], s36 offen
    s_add_u32 s36, s48, 524288
    buffer_load_dwordx4 v[192:195], v118, s[88:91], s36 offen
    s_add_u32 s36, s36, 65536
    buffer_load_dwordx4 v[200:203], v118, s[88:91], s36 offen
    s_and_b32 s42, s30, 3
    s_lshl_b32 s42, s42, 13
    s_add_u32 s42, s42, 23592960
    v_lshlrev_b32 v8, 7, v1
    buffer_load_dword v10, v8, s[56:59], s42 offen sc1
    s_add_u32 s36, s48, 655360
    buffer_load_dwordx4 v[208:211], v118, s[88:91], s36 offen
    s_add_u32 s36, s36, 65536
    buffer_load_dwordx4 v[216:219], v118, s[88:91], s36 offen
    s_add_u32 s36, s48, 786432
    buffer_load_dwordx4 v[224:227], v118, s[88:91], s36 offen
    s_add_u32 s36, s36, 65536
    buffer_load_dwordx4 v[232:235], v118, s[88:91], s36 offen
    s_add_u32 s36, s48, 917504
    buffer_load_dwordx4 v[240:243], v118, s[88:91], s36 offen
    s_add_u32 s36, s36, 65536
    buffer_load_dwordx4 v[248:251], v118, s[88:91], s36 offen
    s_setprio 0
    s_mov_b32 s53, 0
    s_waitcnt vmcnt(6)
R_fp:
    v_and_b32 v11, 0xffffffc1, v10
    v_cmp_eq_u32 vcc, s52, v11
    s_nop 0
    s_cmp_eq_u64 vcc, exec
    s_cbranch_scc1 R_fq
    s_sleep 3
    buffer_load_dword v10, v8, s[56:59], s42 offen sc1
    s_waitcnt vmcnt(0)
    s_add_u32 s53, s53, 1
    s_cmp_lt_u32 s53, s61
    s_cbranch_scc1 R_fp
    s_mov_b32 s61, 0
R_fq:
    s_getreg_b32 s53, hwreg(HW_REG_XCC_ID, 0, 4)
    v_bfe_u32 v11, v10, 2, 4
    v_cmp_ne_u32 s[34:35], s53, v11
    v_and_b32 v11, 2, v10
    v_cmp_ne_u32 vcc, 0, v11
    s_nop 0
    s_bcnt1_i32_b64 s36, vcc
    s_or_b32 s34, s34, s35
    s_bitcmp1_b32 s34, s2
    s_cselect_b32 s34, 0x10000, 0
    s_add_u32 s36, s36, s34
    v_mov_b32 v10, s36
    v_mov_b32 v11, 162844
    s_mov_b64 exec, 1
    ds_add_u32 v11, v10
    s_mov_b64 exec, -1
FR_end:
    v_and_b32 v81, 7, v0
    v_lshlrev_b32 v72, 6, v81
    v_add_u32 v72, 161792, v72
    s_lshl_b32 s35, s30, 3
    v_add_u32 v71, s35, v72
    v_lshlrev_b32 v12, 16, v86
    v_and_b32 v13, 0xffff0000, v86
    v_lshlrev_b32 v14, 16, v87
    v_and_b32 v15, 0xffff0000, v87
    v_lshlrev_b32 v16, 16, v88
    v_and_b32 v17, 0xffff0000, v88
    v_lshlrev_b32 v18, 16, v89
    v_and_b32 v19, 0xffff0000, v89
    v_lshlrev_b32 v20, 16, v90
    v_and_b32 v21, 0xffff0000, v90
    v_lshlrev_b32 v22, 16, v91
    v_and_b32 v23, 0xffff0000, v91
    v_lshlrev_b32 v24, 16, v92
    v_and_b32 v25, 0xffff0000, v92
    v_lshlrev_b32 v26, 16, v93
    v_and_b32 v27, 0xffff0000, v93
    v_pk_add_f32 v[48:49], v[12:13], v[14:15]
    v_pk_mul_f32 v[50:51], v[12:13], v[12:13]
    v_pk_fma_f32 v[50:51], v[14:15], v[14:15], v[50:51]
    v_pk_add_f32 v[48:49], v[48:49], v[16:17]
    v_pk_fma_f32 v[50:51], v[16:17], v[16:17], v[50:51]
    v_pk_add_f32 v[48:49], v[48:49], v[18:19]
    v_pk_fma_f32 v[50:51], v[18:19], v[18:19], v[50:51]
    v_pk_add_f32 v[48:49], v[48:49], v[20:21]
    v_pk_fma_f32 v[50:51], v[20:21], v[20:21], v[50:51]
    v_pk_add_f32 v[48:49], v[48:49], v[22:23]
    v_pk_fma_f32 v[50:51], v[22:23], v[22:23], v[50:51]
    v_pk_add_f32 v[48:49], v[48:49], v[24:25]
    v_pk_fma_f32 v[50:51], v[24:25], v[24:25], v[50:51]
    v_pk_add_f32 v[48:49], v[48:49], v[26:27]
    v_pk_fma_f32 v[50:51], v[26:27], v[26:27], v[50:51]
    v_add_f32 v46, v48, v49
    v_add_f32 v47, v50, v51
    s_nop 0
    v_add_f32_dpp v46, v46, v46 row_ror:8 row_mask:0xf bank_mask:0xf
    v_add_f32_dpp v47, v47, v47 row_ror:8 row_mask:0xf bank_mask:0xf
    v_mov_b32 v48, v46
    v_mov_b32 v49, v47
    s_nop 0
    v_permlane16_swap_b32 v46, v48
    v_permlane16_swap_b32 v47, v49
    v_pk_add_f32 v[46:47], v[46:47], v[48:49]
    v_mov_b32 v48, v46
    v_mov_b32 v49, v47
    s_nop 0
    v_permlane32_swap_b32 v46, v48
    v_permlane32_swap_b32 v47, v49
    v_pk_add_f32 v[46:47], v[46:47], v[48:49]
    ds_write_b64 v71, v[46:47] offset:0
    s_waitcnt lgkmcnt(0)
    s_barrier
LAYER:
    v_and_b32 v81, 7, v0
    v_lshlrev_b32 v72, 6, v81
    v_add_u32 v72, 161792, v72
    s_lshl_b32 s35, s30, 3
    v_add_u32 v71, s35, v72
    v_lshrrev_b32 v6, 2, v1
    v_lshlrev_b32 v74, 7, v6
    v_bfe_u32 v6, v6, 1, 2
    s_and_b32 s35, s30, 2
    v_and_b32 v7, 1, v1
    v_or_b32 v7, s35, v7
    v_xor_b32 v6, v6, v7
    v_lshl_add_u32 v74, v6, 5, v74
    v_and_b32 v6, 2, v1
    v_lshl_add_u32 v74, v6, 2, v74
    s_and_b32 s35, s30, 1
    s_lshl_b32 s35, s35, 4
    v_add_u32 v74, s35, v74
    v_add_u32 v75, 65536, v74
    v_add_u32 v76, 131072, v74
    s_cmp_eq_u32 s60, 0
    s_cbranch_scc1 R_l0
    s_sub_u32 s12, s62, 0x3b80000
    s_subb_u32 s13, s63, 0
    s_mov_b32 s14, 0x7e000
    s_mov_b32 s15, 0x20000
    s_lshl_b32 s22, s60, 24
    s_lshl_b32 s23, s94, 13
    s_add_u32 s22, s22, s23
    s_add_u32 s22, s22, 167772160
    s_add_u32 s20, s4, s22
    s_addc_u32 s21, s5, 0
    s_mov_b32 s22, 8380416
    s_mov_b32 s23, 0x20000
    buffer_load_dwordx4 v[86:89], v78, s[12:15], 0 offen offset:0 sc1
    buffer_load_dwordx4 v[90:93], v78, s[12:15], 0 offen offset:2048 sc1
    s_waitcnt vmcnt(2)
    v_lshlrev_b32 v102, 16, v110
    v_and_b32 v103, 0xffff0000, v110
    v_lshlrev_b32 v104, 16, v111
    v_and_b32 v105, 0xffff0000, v111
    v_lshlrev_b32 v106, 16, v112
    v_and_b32 v107, 0xffff0000, v112
    v_lshlrev_b32 v108, 16, v113
    v_and_b32 v109, 0xffff0000, v113
    v_lshlrev_b32 v110, 16, v114
    v_and_b32 v111, 0xffff0000, v114
    v_lshlrev_b32 v112, 16, v115
    v_and_b32 v113, 0xffff0000, v115
    v_lshlrev_b32 v114, 16, v116
    v_and_b32 v115, 0xffff0000, v116
    v_lshlrev_b32 v116, 16, v117
    v_and_b32 v117, 0xffff0000, v117
    s_mov_b32 s53, 0
dw_4:
    s_waitcnt vmcnt(0)
    v_and_b32 v6, v86, v87
    v_and_b32 v7, v90, v91
    v_bitop3_b32 v6, v88, v89, v6 bitop3:0x80
    v_bitop3_b32 v7, v92, v93, v7 bitop3:0x80
    v_bitop3_b32 v6, v6, v7, 1 bitop3:0x80
    v_cmp_eq_u32 vcc, 0, v6
    s_nop 0
    s_cmp_eq_u64 vcc, 0
    s_cbranch_scc1 dok_5
    s_mov_b64 exec, vcc
    s_sleep 2
    buffer_load_dwordx4 v[86:89], v78, s[12:15], 0 offen offset:0 sc1
    buffer_load_dwordx4 v[90:93], v78, s[12:15], 0 offen offset:2048 sc1
    s_add_u32 s53, s53, 1
    s_cmp_lt_u32 s53, s61
    s_cbranch_scc1 dw_4
    s_mov_b32 s61, 0
    s_waitcnt vmcnt(0)
dok_5:
    s_mov_b64 exec, -1
    s_mov_b32 s36, 0x3f803f80
    v_dot2_f32_bf16 v48, v86, s36, 0
    v_dot2_f32_bf16 v50, v86, v86, 0
    v_dot2_f32_bf16 v49, v87, s36, 0
    v_dot2_f32_bf16 v51, v87, v87, 0
    v_dot2_f32_bf16 v48, v88, s36, v48
    v_dot2_f32_bf16 v50, v88, v88, v50
    v_dot2_f32_bf16 v49, v89, s36, v49
    v_dot2_f32_bf16 v51, v89, v89, v51
    v_dot2_f32_bf16 v48, v90, s36, v48
    v_dot2_f32_bf16 v50, v90, v90, v50
    v_dot2_f32_bf16 v49, v91, s36, v49
    v_dot2_f32_bf16 v51, v91, v91, v51
    v_dot2_f32_bf16 v48, v92, s36, v48
    v_dot2_f32_bf16 v50, v92, v92, v50
    v_dot2_f32_bf16 v49, v93, s36, v49
    v_dot2_f32_bf16 v51, v93, v93, v51
    s_nop 2
    v_add_f32 v46, v48, v49
    v_add_f32 v47, v50, v51
    s_nop 0
    v_add_f32_dpp v46, v46, v46 row_ror:8 row_mask:0xf bank_mask:0xf
    v_add_f32_dpp v47, v47, v47 row_ror:8 row_mask:0xf bank_mask:0xf
    v_mov_b32 v48, v46
    v_mov_b32 v49, v47
    s_nop 0
    v_permlane16_swap_b32 v46, v48
    v_permlane16_swap_b32 v47, v49
    v_pk_add_f32 v[46:47], v[46:47], v[48:49]
    v_mov_b32 v48, v46
    v_mov_b32 v49, v47
    s_nop 0
    v_permlane32_swap_b32 v46, v48
    v_permlane32_swap_b32 v47, v49
    v_pk_add_f32 v[46:47], v[46:47], v[48:49]
    ds_write_b64 v71, v[46:47] offset:0
    v_lshlrev_b32 v12, 16, v86
    v_and_b32 v13, 0xffff0000, v86
    v_lshlrev_b32 v14, 16, v87
    v_and_b32 v15, 0xffff0000, v87
    v_lshlrev_b32 v16, 16, v88
    v_and_b32 v17, 0xffff0000, v88
    v_lshlrev_b32 v18, 16, v89
    v_and_b32 v19, 0xffff0000, v89
    v_lshlrev_b32 v20, 16, v90
    v_and_b32 v21, 0xffff0000, v90
    v_lshlrev_b32 v22, 16, v91
    v_and_b32 v23, 0xffff0000, v91
    v_lshlrev_b32 v24, 16, v92
    v_and_b32 v25, 0xffff0000, v92
    v_lshlrev_b32 v26, 16, v93
    v_and_b32 v27, 0xffff0000, v93
    s_waitcnt lgkmcnt(0)
    s_barrier
    ds_read_b128 v[52:55], v72 offset:0
    ds_read_b128 v[56:59], v72 offset:16
    ds_read_b128 v[60:63], v72 offset:32
    ds_read_b128 v[64:67], v72 offset:48
    s_waitcnt lgkmcnt(0)
    v_pk_add_f32 v[52:53], v[52:53], v[54:55]
    v_pk_add_f32 v[56:57], v[56:57], v[58:59]
    v_pk_add_f32 v[60:61], v[60:61], v[62:63]
    v_pk_add_f32 v[64:65], v[64:65], v[66:67]
    v_pk_add_f32 v[52:53], v[52:53], v[56:57]
    v_pk_add_f32 v[60:61], v[60:61], v[64:65]
    v_pk_add_f32 v[52:53], v[52:53], v[60:61]
    v_mul_f32 v68, 0x3a800000, v52
    v_mul_f32 v70, 0x3a800000, v53
    v_fma_f32 v70, -v68, v68, v70
    v_max_f32 v70, 0, v70
    v_add_f32 v70, 0x3727c5ac, v70
    v_rsq_f32 v69, v70
    s_nop 0
    v_mul_f32 v68, -v68, v69
    v_pk_fma_f32 v[28:29], v[12:13], v[68:69], v[68:69] op_sel:[0,1,0] op_sel_hi:[1,1,0]
    v_pk_fma_f32 v[30:31], v[14:15], v[68:69], v[68:69] op_sel:[0,1,0] op_sel_hi:[1,1,0]
    v_pk_fma_f32 v[32:33], v[16:17], v[68:69], v[68:69] op_sel:[0,1,0] op_sel_hi:[1,1,0]
    v_pk_fma_f32 v[34:35], v[18:19], v[68:69], v[68:69] op_sel:[0,1,0] op_sel_hi:[1,1,0]
    v_pk_fma_f32 v[36:37], v[20:21], v[68:69], v[68:69] op_sel:[0,1,0] op_sel_hi:[1,1,0]
    v_pk_fma_f32 v[38:39], v[22:23], v[68:69], v[68:69] op_sel:[0,1,0] op_sel_hi:[1,1,0]
    v_pk_fma_f32 v[40:41], v[24:25], v[68:69], v[68:69] op_sel:[0,1,0] op_sel_hi:[1,1,0]
    v_pk_fma_f32 v[42:43], v[26:27], v[68:69], v[68:69] op_sel:[0,1,0] op_sel_hi:[1,1,0]
    s_branch R_s2
R_l0:
    s_cmp_lt_u32 s30, 4
    s_cbranch_scc1 R_f2
    s_and_b32 s36, s30, 3
    s_lshl_b32 s36, s36, 10
    v_add_u32 v8, s36, v2
    v_add_u32 v9, 65536, v8
    ds_write_b128 v8, v[28:31] offset:49152
    ds_write_b128 v8, v[32:35] offset:53248
    ds_write_b128 v8, v[36:39] offset:57344
    ds_write_b128 v8, v[40:43] offset:61440
    ds_write_b128 v9, v[52:55] offset:0
    ds_write_b128 v9, v[56:59] offset:4096
    ds_write_b128 v9, v[60:63] offset:8192
    ds_write_b128 v9, v[64:67] offset:12288
    ds_write_b128 v8, v[94:97] offset:24576
    ds_write_b128 v8, v[98:101] offset:28672
R_f2:
    v_mov_b32 v6, 162844
    ds_read_b32 v7, v6
    ds_read_b128 v[52:55], v72 offset:0
    ds_read_b128 v[56:59], v72 offset:16
    ds_read_b128 v[60:63], v72 offset:32
    ds_read_b128 v[64:67], v72 offset:48
    s_waitcnt lgkmcnt(0)
    v_pk_add_f32 v[52:53], v[52:53], v[54:55]
    v_pk_add_f32 v[56:57], v[56:57], v[58:59]
    v_pk_add_f32 v[60:61], v[60:61], v[62:63]
    v_pk_add_f32 v[64:65], v[64:65], v[66:67]
    v_pk_add_f32 v[52:53], v[52:53], v[56:57]
    v_pk_add_f32 v[60:61], v[60:61], v[64:65]
    v_pk_add_f32 v[52:53], v[52:53], v[60:61]
    v_mul_f32 v68, 0x3a800000, v52
    v_mul_f32 v70, 0x3a800000, v53
    v_fma_f32 v70, -v68, v68, v70
    v_max_f32 v70, 0, v70
    v_add_f32 v70, 0x3727c5ac, v70
    v_rsq_f32 v69, v70
    s_nop 0
    v_mul_f32 v68, -v68, v69
    v_pk_fma_f32 v[28:29], v[12:13], v[68:69], v[68:69] op_sel:[0,1,0] op_sel_hi:[1,1,0]
    v_pk_fma_f32 v[30:31], v[14:15], v[68:69], v[68:69] op_sel:[0,1,0] op_sel_hi:[1,1,0]
    v_pk_fma_f32 v[32:33], v[16:17], v[68:69], v[68:69] op_sel:[0,1,0] op_sel_hi:[1,1,0]
    v_pk_fma_f32 v[34:35], v[18:19], v[68:69], v[68:69] op_sel:[0,1,0] op_sel_hi:[1,1,0]
    v_pk_fma_f32 v[36:37], v[20:21], v[68:69], v[68:69] op_sel:[0,1,0] op_sel_hi:[1,1,0]
    v_pk_fma_f32 v[38:39], v[22:23], v[68:69], v[68:69] op_sel:[0,1,0] op_sel_hi:[1,1,0]
    v_pk_fma_f32 v[40:41], v[24:25], v[68:69], v[68:69] op_sel:[0,1,0] op_sel_hi:[1,1,0]
    v_pk_fma_f32 v[42:43], v[26:27], v[68:69], v[68:69] op_sel:[0,1,0] op_sel_hi:[1,1,0]
    v_readfirstlane_b32 s94, v7
    s_nop 0
    s_lshr_b32 s98, s94, 16
    s_and_b32 s94, s94, 0xffff
    s_cmp_gt_u32 s94, 127
    s_cselect_b32 s94, 1, 0
    s_lshr_b32 s53, s28, 3
    s_lshl_b32 s53, s53, 2
    s_and_b32 s54, s28, 3
    s_add_u32 s53, s53, s54
    s_lshl_b32 s53, s53, 23
    s_lshr_b32 s54, s28, 2
    s_xor_b32 s54, s54, s94
    s_and_b32 s54, s54, 1
    s_lshl_b32 s54, s54, 13
    s_add_u32 s55, s53, s54
    s_add_u32 s55, s55, 33554432
    s_add_u32 s62, s4, s55
    s_addc_u32 s63, s5, 0
    s_sub_u32 s36, s28, 1
    s_max_i32 s36, s36, 0
    s_lshr_b32 s53, s36, 3
    s_lshl_b32 s53, s53, 2
    s_and_b32 s54, s36, 3
    s_add_u32 s53, s53, s54
    s_lshl_b32 s53, s53, 23
    s_lshr_b32 s54, s36, 2
    s_xor_b32 s54, s54, s94
    s_and_b32 s54, s54, 1
    s_lshl_b32 s54, s54, 13
    s_add_u32 s92, s53, s54
    s_add_u32 s92, s92, 33554432
    s_sub_u32 s92, s92, s55
    s_add_u32 s36, s28, 1
    s_min_u32 s36, s36, 15
    s_lshr_b32 s53, s36, 3
    s_lshl_b32 s53, s53, 2
    s_and_b32 s54, s36, 3
    s_add_u32 s53, s53, s54
    s_lshl_b32 s53, s53, 23
    s_lshr_b32 s54, s36, 2
    s_xor_b32 s54, s54, s94
    s_and_b32 s54, s54, 1
    s_lshl_b32 s54, s54, 13
    s_add_u32 s93, s53, s54
    s_add_u32 s93, s93, 33554432
    s_sub_u32 s93, s93, s55
    s_add_u32 s55, s55, 1835008
    s_lshl_b32 s22, s60, 24
    s_lshl_b32 s23, s94, 13
    s_add_u32 s22, s22, s23
    s_add_u32 s22, s22, 167772160
    s_add_u32 s20, s4, s22
    s_addc_u32 s21, s5, 0
    s_mov_b32 s22, 8380416
    s_mov_b32 s23, 0x20000
    s_add_u32 s80, s4, 0x1800000
    s_addc_u32 s81, s5, 0
    s_mov_b32 s82, 0x400000
    s_mov_b32 s83, 0x20000
    s_mov_b32 s78, 0
    buffer_load_dwordx2 v[110:111], v79, s[80:83], s78 offen sc1
    s_mov_b32 s78, 65536
    buffer_load_dwordx2 v[112:113], v79, s[80:83], s78 offen sc1
    s_mov_b32 s78, 262144
    buffer_load_dwordx2 v[114:115], v79, s[80:83], s78 offen sc1
    s_mov_b32 s78, 327680
    buffer_load_dwordx2 v[116:117], v79, s[80:83], s78 offen sc1
    s_cmp_lt_u32 s30, 4
    s_cbranch_scc1 R_f3
    s_waitcnt vmcnt(4)
    s_and_b32 s36, s30, 3
    s_lshl_b32 s36, s36, 10
    v_add_u32 v8, s36, v2
    v_add_u32 v9, 65536, v8
    ds_write_b128 v8, v[128:131] offset:0
    ds_write_b128 v8, v[136:139] offset:4096
    ds_write_b128 v8, v[144:147] offset:8192
    ds_write_b128 v8, v[152:155] offset:12288
    ds_write_b128 v8, v[160:163] offset:16384
    ds_write_b128 v8, v[168:171] offset:20480
    ds_write_b128 v9, v[176:179] offset:16384
    ds_write_b128 v9, v[184:187] offset:20480
    ds_write_b128 v9, v[192:195] offset:24576
    ds_write_b128 v9, v[200:203] offset:28672
    ds_write_b128 v8, v[208:211] offset:32768
    ds_write_b128 v8, v[216:219] offset:36864
    ds_write_b128 v8, v[224:227] offset:40960
    ds_write_b128 v8, v[232:235] offset:45056
    ds_write_b128 v9, v[240:243] offset:32768
    ds_write_b128 v9, v[248:251] offset:36864
R_f3:
    s_mov_b32 s53, 0
dw_6:
    s_waitcnt vmcnt(0)
    v_and_b32 v6, v110, v111
    v_and_b32 v7, v114, v115
    v_bitop3_b32 v6, v112, v113, v6 bitop3:0x80
    v_bitop3_b32 v7, v116, v117, v7 bitop3:0x80
    v_bitop3_b32 v6, v6, v7, 1 bitop3:0x80
    v_cmp_eq_u32 vcc, 0, v6
    s_nop 0
    s_cmp_eq_u64 vcc, 0
    s_cbranch_scc1 dok_7
    s_mov_b64 exec, vcc
    s_sleep 4
    s_mov_b32 s78, 0
    buffer_load_dwordx2 v[110:111], v79, s[80:83], s78 offen sc1
    s_mov_b32 s78, 65536
    buffer_load_dwordx2 v[112:113], v79, s[80:83], s78 offen sc1
    s_mov_b32 s78, 262144
    buffer_load_dwordx2 v[114:115], v79, s[80:83], s78 offen sc1
    s_mov_b32 s78, 327680
    buffer_load_dwordx2 v[116:117], v79, s[80:83], s78 offen sc1
    s_add_u32 s53, s53, 1
    s_cmp_lt_u32 s53, s61
    s_cbranch_scc1 dw_6
    s_mov_b32 s61, 0
    s_waitcnt vmcnt(0)
dok_7:
    s_mov_b64 exec, -1
    v_lshlrev_b32 v102, 16, v110
    v_and_b32 v103, 0xffff0000, v110
    v_lshlrev_b32 v104, 16, v111
    v_and_b32 v105, 0xffff0000, v111
    v_lshlrev_b32 v106, 16, v112
    v_and_b32 v107, 0xffff0000, v112
    v_lshlrev_b32 v108, 16, v113
    v_and_b32 v109, 0xffff0000, v113
    v_lshlrev_b32 v110, 16, v114
    v_and_b32 v111, 0xffff0000, v114
    v_lshlrev_b32 v112, 16, v115
    v_and_b32 v113, 0xffff0000, v115
    v_lshlrev_b32 v114, 16, v116
    v_and_b32 v115, 0xffff0000, v116
    v_lshlrev_b32 v116, 16, v117
    v_and_b32 v117, 0xffff0000, v117
R_s2:
    v_pk_fma_f32 v[12:13], v[28:29], v[102:103], v[12:13]
    v_pk_fma_f32 v[14:15], v[30:31], v[104:105], v[14:15]
    v_pk_fma_f32 v[16:17], v[32:33], v[106:107], v[16:17]
    v_pk_fma_f32 v[18:19], v[34:35], v[108:109], v[18:19]
    v_cvt_pk_bf16_f32 v86, v12, v13
    v_cvt_pk_bf16_f32 v87, v14, v15
    v_cvt_pk_bf16_f32 v88, v16, v17
    v_cvt_pk_bf16_f32 v89, v18, v19
    buffer_store_dwordx4 v[86:89], v82, s[20:23], 0 offen offset:0 sc1
    v_pk_fma_f32 v[20:21], v[36:37], v[110:111], v[20:21]
    v_pk_fma_f32 v[22:23], v[38:39], v[112:113], v[22:23]
    v_pk_fma_f32 v[24:25], v[40:41], v[114:115], v[24:25]
    v_pk_fma_f32 v[26:27], v[42:43], v[116:117], v[26:27]
    v_cvt_pk_bf16_f32 v90, v20, v21
    v_cvt_pk_bf16_f32 v91, v22, v23
    v_cvt_pk_bf16_f32 v92, v24, v25
    v_cvt_pk_bf16_f32 v93, v26, v27
    buffer_store_dwordx4 v[90:93], v82, s[20:23], 0 offen offset:128 sc1
    v_pk_add_f32 v[48:49], v[12:13], v[14:15]
    v_pk_mul_f32 v[50:51], v[12:13], v[12:13]
    v_pk_fma_f32 v[50:51], v[14:15], v[14:15], v[50:51]
    v_pk_add_f32 v[48:49], v[48:49], v[16:17]
    v_pk_fma_f32 v[50:51], v[16:17], v[16:17], v[50:51]
    v_pk_add_f32 v[48:49], v[48:49], v[18:19]
    v_pk_fma_f32 v[50:51], v[18:19], v[18:19], v[50:51]
    v_pk_add_f32 v[48:49], v[48:49], v[20:21]
    v_pk_fma_f32 v[50:51], v[20:21], v[20:21], v[50:51]
    v_pk_add_f32 v[48:49], v[48:49], v[22:23]
    v_pk_fma_f32 v[50:51], v[22:23], v[22:23], v[50:51]
    v_pk_add_f32 v[48:49], v[48:49], v[24:25]
    v_pk_fma_f32 v[50:51], v[24:25], v[24:25], v[50:51]
    v_pk_add_f32 v[48:49], v[48:49], v[26:27]
    v_pk_fma_f32 v[50:51], v[26:27], v[26:27], v[50:51]
    v_add_f32 v46, v48, v49
    v_add_f32 v47, v50, v51
    s_nop 0
    v_add_f32_dpp v46, v46, v46 row_ror:8 row_mask:0xf bank_mask:0xf
    v_add_f32_dpp v47, v47, v47 row_ror:8 row_mask:0xf bank_mask:0xf
    v_mov_b32 v48, v46
    v_mov_b32 v49, v47
    s_nop 0
    v_permlane16_swap_b32 v46, v48
    v_permlane16_swap_b32 v47, v49
    v_pk_add_f32 v[46:47], v[46:47], v[48:49]
    v_mov_b32 v48, v46
    v_mov_b32 v49, v47
    s_nop 0
    v_permlane32_swap_b32 v46, v48
    v_permlane32_swap_b32 v47, v49
    v_pk_add_f32 v[46:47], v[46:47], v[48:49]
    ds_write_b64 v71, v[46:47] offset:1536
    s_waitcnt lgkmcnt(0)
    s_barrier
    s_cmp_ge_u32 s30, 4
    s_cbranch_scc1 LOADERS
    s_cmp_lg_u32 s30, 3
    s_cbranch_scc1 R_nl
    ds_read_b128 v[52:55], v72 offset:1536
    ds_read_b128 v[56:59], v72 offset:1552
    ds_read_b128 v[60:63], v72 offset:1568
    ds_read_b128 v[64:67], v72 offset:1584
    s_waitcnt lgkmcnt(0)
    v_pk_add_f32 v[52:53], v[52:53], v[54:55]
    v_pk_add_f32 v[56:57], v[56:57], v[58:59]
    v_pk_add_f32 v[60:61], v[60:61], v[62:63]
    v_pk_add_f32 v[64:65], v[64:65], v[66:67]
    v_pk_add_f32 v[52:53], v[52:53], v[56:57]
    v_pk_add_f32 v[60:61], v[60:61], v[64:65]
    v_pk_add_f32 v[52:53], v[52:53], v[60:61]
    v_mul_f32 v68, 0x3a800000, v52
    v_mul_f32 v70, 0x3a800000, v53
    v_fma_f32 v70, -v68, v68, v70
    v_max_f32 v70, 0, v70
    v_mov_b32 v32, v68
    v_mov_b32 v33, v70
    v_cvt_pk_bf16_f32 v68, v68, v68
    v_lshlrev_b32 v68, 16, v68
    v_cvt_pk_bf16_f32 v70, v70, v70
    v_lshlrev_b32 v70, 16, v70
    v_add_f32 v70, 0x3727c5ac, v70
    v_cvt_pk_bf16_f32 v70, v70, v70
    v_lshlrev_b32 v70, 16, v70
    v_sqrt_f32 v70, v70
    s_nop 0
    v_cvt_pk_bf16_f32 v70, v70, v70
    v_lshlrev_b32 v70, 16, v70
    v_rcp_f32 v69, v70
    v_sub_f32 v32, v32, v68
    v_mul_f32 v32, v32, v69
    v_mul_f32 v33, v33, v69
    v_mul_f32 v33, v33, v69
    v_cvt_pk_bf16_f32 v32, v32, v32
    v_lshlrev_b32 v32, 16, v32
    v_cvt_pk_bf16_f32 v33, v33, v33
    v_lshlrev_b32 v33, 16, v33
    v_add_f32 v33, 0x3727c5ac, v33
    v_cvt_pk_bf16_f32 v33, v33, v33
    v_lshlrev_b32 v33, 16, v33
    v_sqrt_f32 v33, v33
    s_nop 0
    v_cvt_pk_bf16_f32 v33, v33, v33
    v_lshlrev_b32 v33, 16, v33
    v_cvt_pk_bf16_f32 v28, v68, v70
    v_cvt_pk_bf16_f32 v30, v32, v33
    v_mov_b32 v29, s52
    v_mov_b32 v31, s52
    s_lshl_b32 s26, s60, 15
    s_add_u32 s26, s26, 23199744
    s_add_u32 s24, s4, s26
    s_addc_u32 s25, s5, 0
    s_mov_b32 s26, 32768
    s_mov_b32 s27, 0x20000
    s_lshl_b32 s36, s28, 4
    s_add_u32 s36, s36, s67
    s_lshl_b32 s36, s36, 7
    s_mov_b64 exec, 0xff
    buffer_store_dwordx4 v[28:31], v2, s[24:27], s36 offen sc1
    s_mov_b64 exec, -1
R_nl:
    v_mov_b32 v6, 1
    v_mov_b32 v7, 0
    s_cmp_eq_u32 s30, 3
    s_waitcnt vmcnt(1)
    s_cbranch_scc1 R_n2
    s_waitcnt vmcnt(0)
R_n2:
    s_barrier
    s_cmp_lg_u32 s30, 0
    s_cbranch_scc1 R_n3
    s_mov_b64 exec, 1
    buffer_atomic_add v6, v7, s[56:59], s55 offen sc1
    s_mov_b64 exec, -1
R_n3:
    ds_read_b64_tr_b16 v[180:181], v75 offset:49152
    ds_read_b64_tr_b16 v[182:183], v75 offset:51200
    ds_read_b64_tr_b16 v[188:189], v75 offset:53248
    ds_read_b64_tr_b16 v[190:191], v75 offset:55296
    ds_read_b64_tr_b16 v[196:197], v75 offset:57344
    ds_read_b64_tr_b16 v[198:199], v75 offset:59392
    ds_read_b64_tr_b16 v[204:205], v75 offset:61440
    ds_read_b64_tr_b16 v[206:207], v75 offset:63488
    ds_read_b64_tr_b16 v[244:245], v76 offset:16384
    ds_read_b64_tr_b16 v[246:247], v76 offset:18432
    ds_read_b64_tr_b16 v[252:253], v76 offset:20480
    ds_read_b64_tr_b16 v[254:255], v76 offset:22528
    ds_read_b64_tr_b16 v[212:213], v76 offset:0
    ds_read_b64_tr_b16 v[214:215], v76 offset:2048
    ds_read_b64_tr_b16 v[220:221], v76 offset:4096
    ds_read_b64_tr_b16 v[222:223], v76 offset:6144
    ds_read_b64_tr_b16 v[228:229], v76 offset:8192
    ds_read_b64_tr_b16 v[230:231], v76 offset:10240
    ds_read_b64_tr_b16 v[236:237], v76 offset:12288
    ds_read_b64_tr_b16 v[238:239], v76 offset:14336
    ds_read_b64_tr_b16 v[176:177], v74 offset:49152
    ds_read_b64_tr_b16 v[178:179], v74 offset:51200
    ds_read_b64_tr_b16 v[184:185], v74 offset:53248
    ds_read_b64_tr_b16 v[186:187], v74 offset:55296
    ds_read_b64_tr_b16 v[192:193], v74 offset:57344
    ds_read_b64_tr_b16 v[194:195], v74 offset:59392
    ds_read_b64_tr_b16 v[200:201], v74 offset:61440
    ds_read_b64_tr_b16 v[202:203], v74 offset:63488
    ds_read_b64_tr_b16 v[208:209], v75 offset:0
    ds_read_b64_tr_b16 v[210:211], v75 offset:2048
    ds_read_b64_tr_b16 v[216:217], v75 offset:4096
    ds_read_b64_tr_b16 v[218:219], v75 offset:6144
    ds_read_b64_tr_b16 v[224:225], v75 offset:8192
    ds_read_b64_tr_b16 v[226:227], v75 offset:10240
    ds_read_b64_tr_b16 v[232:233], v75 offset:12288
    ds_read_b64_tr_b16 v[234:235], v75 offset:14336
    ds_read_b64_tr_b16 v[128:129], v74 offset:24576
    ds_read_b64_tr_b16 v[130:131], v74 offset:26624
    ds_read_b64_tr_b16 v[136:137], v74 offset:28672
    ds_read_b64_tr_b16 v[138:139], v74 offset:30720
    v_and_b32 v8, 15, v1
    v_lshrrev_b32 v9, 4, v1
    v_xor_b32 v6, v9, v8
    v_lshlrev_b32 v7, 8, v8
    v_xor_b32 v10, 0, v6
    v_lshl_add_u32 v10, v10, 4, v7
    v_add_u32 v14, 106496, v10
    v_xor_b32 v11, 4, v6
    v_lshl_add_u32 v11, v11, 4, v7
    v_add_u32 v15, 106496, v11
    v_xor_b32 v12, 8, v6
    v_lshl_add_u32 v12, v12, 4, v7
    v_add_u32 v16, 106496, v12
    v_xor_b32 v13, 12, v6
    v_lshl_add_u32 v13, v13, 4, v7
    v_add_u32 v17, 106496, v13
    v_lshlrev_b32 v18, 4, v8
    v_add_u32 v18, 155648, v18
    s_add_u32 s16, s62, 0x400000
    s_addc_u32 s17, s63, 0
    s_mov_b32 s18, 0x7e000
    s_mov_b32 s19, 0x20000
    v_and_b32 v6, 1, v9
    v_lshlrev_b32 v114, 16, v6
    v_lshrrev_b32 v6, 1, v9
    v_lshl_add_u32 v114, v6, 8, v114
    v_lshl_add_u32 v114, v8, 4, v114
    s_bfe_u32 s36, s30, 0x10001
    s_lshl1_add_u32 s36, s29, s36
    s_xor_b32 s36, s36, 2
    s_lshr_b32 s53, s36, 3
    s_lshl_b32 s53, s53, 14
    s_and_b32 s39, s36, 7
    s_lshl_b32 s39, s39, 10
    s_add_u32 s39, s39, s53
    s_and_b32 s36, s30, 1
    s_lshl_b32 s36, s36, 9
    s_add_u32 s39, s39, s36
    s_and_b32 s8, s30, 3
    s_lshl_b32 s8, s8, 15
    s_and_b32 s53, s30, 2
    s_lshl_b32 s53, s53, 11
    s_and_b32 s12, s30, 1
    s_lshl_b32 s12, s12, 13
    s_add_u32 s12, s12, s53
    s_and_b32 s20, s30, 1
    s_lshl_b32 s20, s20, 8
    s_add_u32 s20, s20, s55
    s_add_u32 s21, s52, 16
    v_mov_b32 v112, 0x7f000000
    v_writelane_b32 v112, 0, 0
    v_mov_b32 v113, 1
    s_and_b32 s40, s30, 1
    s_lshl1_add_u32 s40, s31, s40
    s_lshl_b32 s40, s40, 7
    s_add_u32 s40, s40, s55
    v_mov_b32 v88, 0x3f803f80
    v_mov_b32 v89, 0x3f803f80
    v_mov_b32 v90, 0x3f803f80
    v_mov_b32 v91, 0x3f803f80
    s_waitcnt lgkmcnt(0)
    s_nop 0
    v_mfma_f32_16x16x32_bf16 v[84:87], v[180:183], v[88:91], 0
    v_mfma_f32_16x16x32_bf16 v[84:87], v[188:191], v[88:91], v[84:87]
    v_mfma_f32_16x16x32_bf16 v[84:87], v[196:199], v[88:91], v[84:87]
    v_mfma_f32_16x16x32_bf16 v[84:87], v[204:207], v[88:91], v[84:87]
    v_mfma_f32_16x16x32_bf16 v[84:87], v[244:247], v[88:91], v[84:87]
    v_mfma_f32_16x16x32_bf16 v[84:87], v[252:255], v[88:91], v[84:87]
    v_mfma_f32_16x16x32_bf16 v[84:87], v[212:215], v[88:91], v[84:87]
    v_mfma_f32_16x16x32_bf16 v[84:87], v[220:223], v[88:91], v[84:87]
    v_mfma_f32_16x16x32_bf16 v[84:87], v[228:231], v[88:91], v[84:87]
    v_mfma_f32_16x16x32_bf16 v[84:87], v[236:239], v[88:91], v[84:87]
    v_mfma_f32_16x16x32_bf16 v[84:87], v[176:179], v[88:91], v[84:87]
    v_mfma_f32_16x16x32_bf16 v[84:87], v[184:187], v[88:91], v[84:87]
    v_mfma_f32_16x16x32_bf16 v[84:87], v[192:195], v[88:91], v[84:87]
    v_mfma_f32_16x16x32_bf16 v[84:87], v[200:203], v[88:91], v[84:87]
    v_mfma_f32_16x16x32_bf16 v[84:87], v[208:211], v[88:91], v[84:87]
    v_mfma_f32_16x16x32_bf16 v[84:87], v[216:219], v[88:91], v[84:87]
    v_mfma_f32_16x16x32_bf16 v[84:87], v[224:227], v[88:91], v[84:87]
    v_mfma_f32_16x16x32_bf16 v[84:87], v[232:235], v[88:91], v[84:87]
    v_mfma_f32_16x16x32_bf16 v[84:87], v[128:131], v[88:91], v[84:87]
    v_mfma_f32_16x16x32_bf16 v[84:87], v[136:139], v[88:91], v[84:87]
    s_cmp_lg_u32 s30, 0
    s_cbranch_scc1 pdone_8
    s_add_u32 s54, s55, 0
    s_bitcmp1_b32 s29, 2
    s_cselect_b32 s53, s93, s92
    s_add_u32 s53, s53, s54
    v_mov_b32 v105, s54
    v_writelane_b32 v105, s53, 1
    s_mov_b32 s53, 0
    s_add_u32 s54, s52, 16
    s_bfm_b64 exec, 2, 0
poll_9:
    buffer_load_dword v104, v105, s[56:59], 0 offen sc1
    s_waitcnt vmcnt(0)
    v_cmp_eq_u32 vcc, s54, v104
    s_nop 0
    s_cmp_eq_u64 vcc, exec
    s_cbranch_scc1 pok_10
    s_sleep 3
    s_add_u32 s53, s53, 1
    s_cmp_lt_u32 s53, s61
    s_cbranch_scc1 poll_9
    s_mov_b32 s61, 0
pok_10:
    s_mov_b64 exec, -1
pdone_8:
    s_waitcnt lgkmcnt(0)
    s_barrier
    ds_read_b64_tr_b16 v[240:241], v75 offset:16384
    ds_read_b64_tr_b16 v[242:243], v75 offset:18432
    ds_read_b64_tr_b16 v[248:249], v75 offset:20480
    ds_read_b64_tr_b16 v[250:251], v75 offset:22528
    ds_read_b64_tr_b16 v[132:133], v75 offset:24576
    ds_read_b64_tr_b16 v[134:135], v75 offset:26624
    ds_read_b64_tr_b16 v[140:141], v75 offset:28672
    ds_read_b64_tr_b16 v[142:143], v75 offset:30720
    ds_read_b64_tr_b16 v[144:145], v74 offset:32768
    ds_read_b64_tr_b16 v[146:147], v74 offset:34816
    ds_read_b64_tr_b16 v[152:153], v74 offset:36864
    ds_read_b64_tr_b16 v[154:155], v74 offset:38912
    ds_read_b64_tr_b16 v[160:161], v74 offset:40960
    ds_read_b64_tr_b16 v[162:163], v74 offset:43008
    ds_read_b64_tr_b16 v[168:169], v74 offset:45056
    ds_read_b64_tr_b16 v[170:171], v74 offset:47104
    ds_read_b64_tr_b16 v[148:149], v75 offset:32768
    ds_read_b64_tr_b16 v[150:151], v75 offset:34816
    ds_read_b64_tr_b16 v[156:157], v75 offset:36864
    ds_read_b64_tr_b16 v[158:159], v75 offset:38912
    ds_read_b64_tr_b16 v[164:165], v75 offset:40960
    ds_read_b64_tr_b16 v[166:167], v75 offset:43008
    ds_read_b64_tr_b16 v[172:173], v75 offset:45056
    ds_read_b64_tr_b16 v[174:175], v75 offset:47104
    s_waitcnt lgkmcnt(12)
    v_mfma_f32_16x16x32_bf16 v[84:87], v[240:243], v[88:91], v[84:87]
    v_mfma_f32_16x16x32_bf16 v[84:87], v[248:251], v[88:91], v[84:87]
    v_mfma_f32_16x16x32_bf16 v[84:87], v[132:135], v[88:91], v[84:87]
    v_mfma_f32_16x16x32_bf16 v[84:87], v[140:143], v[88:91], v[84:87]
    v_mfma_f32_16x16x32_bf16 v[84:87], v[144:147], v[88:91], v[84:87]
    v_mfma_f32_16x16x32_bf16 v[84:87], v[152:155], v[88:91], v[84:87]
    s_waitcnt lgkmcnt(0)
    v_mfma_f32_16x16x32_bf16 v[84:87], v[160:163], v[88:91], v[84:87]
    v_mfma_f32_16x16x32_bf16 v[84:87], v[168:171], v[88:91], v[84:87]
    v_mfma_f32_16x16x32_bf16 v[84:87], v[148:151], v[88:91], v[84:87]
    v_mfma_f32_16x16x32_bf16 v[84:87], v[156:159], v[88:91], v[84:87]
    v_mfma_f32_16x16x32_bf16 v[84:87], v[164:167], v[88:91], v[84:87]
    v_mfma_f32_16x16x32_bf16 v[84:87], v[172:175], v[88:91], v[84:87]
    s_barrier
    ds_read_b128 v[36:39], v14 offset:16384
    ds_read_b128 v[40:43], v14 offset:20480
    ds_read_b128 v[44:47], v14 offset:24576
    ds_read_b128 v[48:51], v14 offset:28672
    ds_read_b128 v[52:55], v15 offset:16384
    ds_read_b128 v[56:59], v15 offset:20480
    ds_read_b128 v[60:63], v15 offset:24576
    ds_read_b128 v[64:67], v15 offset:28672
    s_waitcnt lgkmcnt(4)
    v_mfma_f32_16x16x32_bf16 v[20:23], v[128:131], v[36:39], 0
    ds_read_b128 v[68:71], v16 offset:16384
    v_mfma_f32_16x16x32_bf16 v[24:27], v[128:131], v[40:43], 0
    ds_read_b128 v[72:75], v16 offset:20480
    v_mfma_f32_16x16x32_bf16 v[24:27], v[132:135], v[48:51], v[24:27]
    ds_read_b128 v[76:79], v16 offset:24576
    v_mfma_f32_16x16x32_bf16 v[20:23], v[132:135], v[44:47], v[20:23]
    ds_read_b128 v[80:83], v16 offset:28672
    s_waitcnt lgkmcnt(4)
    v_mfma_f32_16x16x32_bf16 v[20:23], v[136:139], v[52:55], v[20:23]
    ds_read_b128 v[36:39], v17 offset:16384
    v_mfma_f32_16x16x32_bf16 v[24:27], v[136:139], v[56:59], v[24:27]
    ds_read_b128 v[40:43], v17 offset:20480
    v_mfma_f32_16x16x32_bf16 v[24:27], v[140:143], v[64:67], v[24:27]
    ds_read_b128 v[44:47], v17 offset:24576
    v_mfma_f32_16x16x32_bf16 v[20:23], v[140:143], v[60:63], v[20:23]
    ds_read_b128 v[48:51], v17 offset:28672
    s_barrier
    s_waitcnt lgkmcnt(4)
    v_mfma_f32_16x16x32_bf16 v[20:23], v[144:147], v[68:71], v[20:23]
    ds_read_b128 v[52:55], v14 offset:32768
    v_mfma_f32_16x16x32_bf16 v[24:27], v[144:147], v[72:75], v[24:27]
    ds_read_b128 v[56:59], v14 offset:36864
    v_mfma_f32_16x16x32_bf16 v[24:27], v[148:151], v[80:83], v[24:27]
    ds_read_b128 v[60:63], v14 offset:40960
    v_mfma_f32_16x16x32_bf16 v[20:23], v[148:151], v[76:79], v[20:23]
    ds_read_b128 v[64:67], v14 offset:45056
    s_waitcnt lgkmcnt(4)
    v_mfma_f32_16x16x32_bf16 v[20:23], v[152:155], v[36:39], v[20:23]
    ds_read_b128 v[68:71], v15 offset:32768
    v_mfma_f32_16x16x32_bf16 v[24:27], v[152:155], v[40:43], v[24:27]
    ds_read_b128 v[72:75], v15 offset:36864
    v_mfma_f32_16x16x32_bf16 v[24:27], v[156:159], v[48:51], v[24:27]
    ds_read_b128 v[76:79], v15 offset:40960
    v_mfma_f32_16x16x32_bf16 v[20:23], v[156:159], v[44:47], v[20:23]
    ds_read_b128 v[80:83], v15 offset:45056
    s_waitcnt lgkmcnt(4)
    v_mfma_f32_16x16x32_bf16 v[20:23], v[160:163], v[52:55], v[20:23]
    ds_read_b128 v[36:39], v16 offset:32768
    v_mfma_f32_16x16x32_bf16 v[24:27], v[160:163], v[56:59], v[24:27]
    ds_read_b128 v[40:43], v16 offset:36864
    v_mfma_f32_16x16x32_bf16 v[24:27], v[164:167], v[64:67], v[24:27]
    ds_read_b128 v[44:47], v16 offset:40960
    v_mfma_f32_16x16x32_bf16 v[20:23], v[164:167], v[60:63], v[20:23]
    ds_read_b128 v[48:51], v16 offset:45056
    s_waitcnt lgkmcnt(4)
    v_mfma_f32_16x16x32_bf16 v[20:23], v[168:171], v[68:71], v[20:23]
    ds_read_b128 v[52:55], v17 offset:32768
    v_mfma_f32_16x16x32_bf16 v[24:27], v[168:171], v[72:75], v[24:27]
    ds_read_b128 v[56:59], v17 offset:36864
    v_mfma_f32_16x16x32_bf16 v[24:27], v[172:175], v[80:83], v[24:27]
    ds_read_b128 v[60:63], v17 offset:40960
    v_mfma_f32_16x16x32_bf16 v[20:23], v[172:175], v[76:79], v[20:23]
    ds_read_b128 v[64:67], v17 offset:45056
    s_barrier
    s_waitcnt lgkmcnt(4)
    v_mfma_f32_16x16x32_bf16 v[20:23], v[176:179], v[36:39], v[20:23]
    ds_read_b128 v[68:71], v10 offset:16384
    v_mfma_f32_16x16x32_bf16 v[24:27], v[176:179], v[40:43], v[24:27]
    ds_read_b128 v[72:75], v10 offset:20480
    v_mfma_f32_16x16x32_bf16 v[24:27], v[180:183], v[48:51], v[24:27]
    ds_read_b128 v[76:79], v10 offset:24576
    v_mfma_f32_16x16x32_bf16 v[20:23], v[180:183], v[44:47], v[20:23]
    ds_read_b128 v[80:83], v10 offset:28672
    s_waitcnt lgkmcnt(4)
    v_mfma_f32_16x16x32_bf16 v[20:23], v[184:187], v[52:55], v[20:23]
    ds_read_b128 v[36:39], v11 offset:16384
    v_mfma_f32_16x16x32_bf16 v[24:27], v[184:187], v[56:59], v[24:27]
    ds_read_b128 v[40:43], v11 offset:20480
    v_mfma_f32_16x16x32_bf16 v[24:27], v[188:191], v[64:67], v[24:27]
    ds_read_b128 v[44:47], v11 offset:24576
    v_mfma_f32_16x16x32_bf16 v[20:23], v[188:191], v[60:63], v[20:23]
    ds_read_b128 v[48:51], v11 offset:28672
    s_waitcnt lgkmcnt(4)
    v_mfma_f32_16x16x32_bf16 v[20:23], v[192:195], v[68:71], v[20:23]
    ds_read_b128 v[52:55], v12 offset:16384
    v_mfma_f32_16x16x32_bf16 v[24:27], v[192:195], v[72:75], v[24:27]
    ds_read_b128 v[56:59], v12 offset:20480
    v_mfma_f32_16x16x32_bf16 v[24:27], v[196:199], v[80:83], v[24:27]
    ds_read_b128 v[60:63], v12 offset:24576
    v_mfma_f32_16x16x32_bf16 v[20:23], v[196:199], v[76:79], v[20:23]
    ds_read_b128 v[64:67], v12 offset:28672
    s_waitcnt lgkmcnt(4)
    v_mfma_f32_16x16x32_bf16 v[20:23], v[200:203], v[36:39], v[20:23]
    ds_read_b128 v[68:71], v13 offset:16384
    v_mfma_f32_16x16x32_bf16 v[24:27], v[200:203], v[40:43], v[24:27]
    ds_read_b128 v[72:75], v13 offset:20480
    v_mfma_f32_16x16x32_bf16 v[24:27], v[204:207], v[48:51], v[24:27]
    ds_read_b128 v[76:79], v13 offset:24576
    v_mfma_f32_16x16x32_bf16 v[20:23], v[204:207], v[44:47], v[20:23]
    ds_read_b128 v[80:83], v13 offset:28672
    s_barrier
    s_waitcnt lgkmcnt(4)
    v_mfma_f32_16x16x32_bf16 v[20:23], v[208:211], v[52:55], v[20:23]
    ds_read_b128 v[36:39], v10 offset:32768
    v_mfma_f32_16x16x32_bf16 v[24:27], v[208:211], v[56:59], v[24:27]
    ds_read_b128 v[40:43], v10 offset:36864
    v_mfma_f32_16x16x32_bf16 v[24:27], v[212:215], v[64:67], v[24:27]
    ds_read_b128 v[44:47], v10 offset:40960
    v_mfma_f32_16x16x32_bf16 v[20:23], v[212:215], v[60:63], v[20:23]
    ds_read_b128 v[48:51], v10 offset:45056
    s_waitcnt lgkmcnt(4)
    v_mfma_f32_16x16x32_bf16 v[20:23], v[216:219], v[68:71], v[20:23]
    ds_read_b128 v[52:55], v11 offset:32768
    v_mfma_f32_16x16x32_bf16 v[24:27], v[216:219], v[72:75], v[24:27]
    ds_read_b128 v[56:59], v11 offset:36864
    v_mfma_f32_16x16x32_bf16 v[24:27], v[220:223], v[80:83], v[24:27]
    ds_read_b128 v[60:63], v11 offset:40960
    v_mfma_f32_16x16x32_bf16 v[20:23], v[220:223], v[76:79], v[20:23]
    ds_read_b128 v[64:67], v11 offset:45056
    s_waitcnt lgkmcnt(4)
    v_mfma_f32_16x16x32_bf16 v[20:23], v[224:227], v[36:39], v[20:23]
    ds_read_b128 v[68:71], v12 offset:32768
    v_mfma_f32_16x16x32_bf16 v[24:27], v[224:227], v[40:43], v[24:27]
    ds_read_b128 v[72:75], v12 offset:36864
    v_mfma_f32_16x16x32_bf16 v[24:27], v[228:231], v[48:51], v[24:27]
    ds_read_b128 v[76:79], v12 offset:40960
    v_mfma_f32_16x16x32_bf16 v[20:23], v[228:231], v[44:47], v[20:23]
    ds_read_b128 v[80:83], v12 offset:45056
    s_waitcnt lgkmcnt(4)
    v_mfma_f32_16x16x32_bf16 v[20:23], v[232:235], v[52:55], v[20:23]
    ds_read_b128 v[36:39], v13 offset:32768
    v_mfma_f32_16x16x32_bf16 v[24:27], v[232:235], v[56:59], v[24:27]
    ds_read_b128 v[40:43], v13 offset:36864
    v_mfma_f32_16x16x32_bf16 v[24:27], v[236:239], v[64:67], v[24:27]
    ds_read_b128 v[44:47], v13 offset:40960
    v_mfma_f32_16x16x32_bf16 v[20:23], v[236:239], v[60:63], v[20:23]
    ds_read_b128 v[48:51], v13 offset:45056
    s_barrier
    ds_read_b128 v[88:91], v18 offset:0
    ds_read_b128 v[92:95], v18 offset:2048
    ds_read_b128 v[96:99], v18 offset:256
    ds_read_b128 v[100:103], v18 offset:2304
    s_waitcnt lgkmcnt(8)
    v_mfma_f32_16x16x32_bf16 v[20:23], v[240:243], v[68:71], v[20:23]
    ds_read_b128 v[52:55], v14 offset:0
    v_mfma_f32_16x16x32_bf16 v[24:27], v[240:243], v[72:75], v[24:27]
    ds_read_b128 v[56:59], v14 offset:4096
    v_mfma_f32_16x16x32_bf16 v[24:27], v[244:247], v[80:83], v[24:27]
    ds_read_b128 v[60:63], v14 offset:8192
    v_mfma_f32_16x16x32_bf16 v[20:23], v[244:247], v[76:79], v[20:23]
    ds_read_b128 v[64:67], v14 offset:12288
    s_waitcnt lgkmcnt(8)
    v_mfma_f32_16x16x32_bf16 v[20:23], v[248:251], v[36:39], v[20:23]
    ds_read_b128 v[68:71], v15 offset:0
    v_mfma_f32_16x16x32_bf16 v[24:27], v[248:251], v[40:43], v[24:27]
    ds_read_b128 v[72:75], v15 offset:4096
    v_mfma_f32_16x16x32_bf16 v[24:27], v[252:255], v[48:51], v[24:27]
    ds_read_b128 v[76:79], v15 offset:8192
    v_mfma_f32_16x16x32_bf16 v[20:23], v[252:255], v[44:47], v[20:23]
    ds_read_b128 v[80:83], v15 offset:12288
    s_waitcnt lgkmcnt(4)
    v_mfma_f32_16x16x32_bf16 v[28:31], v[128:131], v[52:55], 0
    ds_read_b128 v[36:39], v16 offset:0
    v_mfma_f32_16x16x32_bf16 v[32:35], v[128:131], v[56:59], 0
    ds_read_b128 v[40:43], v16 offset:4096
    v_mfma_f32_16x16x32_bf16 v[32:35], v[132:135], v[64:67], v[32:35]
    ds_read_b128 v[44:47], v16 offset:8192
    v_mfma_f32_16x16x32_bf16 v[28:31], v[132:135], v[60:63], v[28:31]
    ds_read_b128 v[48:51], v16 offset:12288
    v_pk_fma_f32 v[20:21], v[88:89], v[84:85], v[20:21]
    v_pk_fma_f32 v[22:23], v[88:89], v[86:87], v[22:23]
    v_pk_fma_f32 v[24:25], v[96:97], v[84:85], v[24:25]
    v_pk_fma_f32 v[26:27], v[96:97], v[86:87], v[26:27]
    v_pk_mul_f32 v[104:105], v[20:21], v[20:21]
    v_pk_mul_f32 v[106:107], v[22:23], v[22:23]
    v_pk_mul_f32 v[108:109], v[24:25], v[24:25]
    v_pk_mul_f32 v[110:111], v[26:27], v[26:27]
    v_pk_fma_f32 v[104:105], v[104:105], v[92:93], v[90:91]
    v_pk_fma_f32 v[106:107], v[106:107], v[92:93], v[90:91]
    v_pk_fma_f32 v[108:109], v[108:109], v[100:101], v[98:99]
    v_pk_fma_f32 v[110:111], v[110:111], v[100:101], v[98:99]
    v_pk_mul_f32 v[104:105], v[104:105], v[20:21]
    v_pk_mul_f32 v[106:107], v[106:107], v[22:23]
    v_pk_mul_f32 v[108:109], v[108:109], v[24:25]
    v_pk_mul_f32 v[110:111], v[110:111], v[26:27]
    v_exp_f32 v104, v104
    v_exp_f32 v105, v105
    v_exp_f32 v106, v106
    v_exp_f32 v107, v107
    v_exp_f32 v108, v108
    v_exp_f32 v109, v109
    v_exp_f32 v110, v110
    v_exp_f32 v111, v111
    v_pk_fma_f32 v[104:105], v[104:105], v[94:95], v[94:95]
    v_pk_fma_f32 v[106:107], v[106:107], v[94:95], v[94:95]
    v_pk_fma_f32 v[108:109], v[108:109], v[102:103], v[102:103]
    v_pk_fma_f32 v[110:111], v[110:111], v[102:103], v[102:103]
    v_rcp_f32 v104, v104
    v_rcp_f32 v105, v105
    v_rcp_f32 v106, v106
    v_rcp_f32 v107, v107
    v_rcp_f32 v108, v108
    v_rcp_f32 v109, v109
    v_rcp_f32 v110, v110
    v_rcp_f32 v111, v111
    v_pk_mul_f32 v[20:21], v[20:21], v[104:105]
    v_pk_mul_f32 v[22:23], v[22:23], v[106:107]
    v_pk_mul_f32 v[24:25], v[24:25], v[108:109]
    v_pk_mul_f32 v[26:27], v[26:27], v[110:111]
    v_add_u32 v20, 0x10000, v20
    v_add_u32 v22, 0x10000, v22
    v_add_u32 v24, 0x10000, v24
    v_add_u32 v26, 0x10000, v26
    v_and_b32 v20, 0xfffe0000, v20
    v_and_b32 v22, 0xfffe0000, v22
    v_and_b32 v24, 0xfffe0000, v24
    v_and_b32 v26, 0xfffe0000, v26
    v_cvt_pk_bf16_f32 v104, v20, v21
    v_cvt_pk_bf16_f32 v105, v22, v23
    v_cvt_pk_bf16_f32 v106, v24, v25
    v_cvt_pk_bf16_f32 v107, v26, v27
    s_add_u32 s36, s39, 0
    v_permlane16_swap_b32 v104, v106
    v_permlane16_swap_b32 v105, v107
    buffer_store_dwordx4 v[104:107], v114, s[16:19], s36 offen sc1
    s_waitcnt lgkmcnt(4)
    v_mfma_f32_16x16x32_bf16 v[28:31], v[136:139], v[68:71], v[28:31]
    ds_read_b128 v[52:55], v17 offset:0
    v_mfma_f32_16x16x32_bf16 v[32:35], v[136:139], v[72:75], v[32:35]
    ds_read_b128 v[56:59], v17 offset:4096
    v_mfma_f32_16x16x32_bf16 v[32:35], v[140:143], v[80:83], v[32:35]
    ds_read_b128 v[60:63], v17 offset:8192
    v_mfma_f32_16x16x32_bf16 v[28:31], v[140:143], v[76:79], v[28:31]
    ds_read_b128 v[64:67], v17 offset:12288
    s_barrier
    s_waitcnt lgkmcnt(4)
    v_mfma_f32_16x16x32_bf16 v[28:31], v[144:147], v[36:39], v[28:31]
    ds_read_b128 v[68:71], v14 offset:16384
    v_mfma_f32_16x16x32_bf16 v[32:35], v[144:147], v[40:43], v[32:35]
    ds_read_b128 v[72:75], v14 offset:20480
    v_mfma_f32_16x16x32_bf16 v[32:35], v[148:151], v[48:51], v[32:35]
    ds_read_b128 v[76:79], v14 offset:24576
    v_mfma_f32_16x16x32_bf16 v[28:31], v[148:151], v[44:47], v[28:31]
    ds_read_b128 v[80:83], v14 offset:28672
    s_waitcnt lgkmcnt(4)
    v_mfma_f32_16x16x32_bf16 v[28:31], v[152:155], v[52:55], v[28:31]
    ds_read_b128 v[36:39], v15 offset:16384
    v_mfma_f32_16x16x32_bf16 v[32:35], v[152:155], v[56:59], v[32:35]
    ds_read_b128 v[40:43], v15 offset:20480
    v_mfma_f32_16x16x32_bf16 v[32:35], v[156:159], v[64:67], v[32:35]
    ds_read_b128 v[44:47], v15 offset:24576
    v_mfma_f32_16x16x32_bf16 v[28:31], v[156:159], v[60:63], v[28:31]
    ds_read_b128 v[48:51], v15 offset:28672
    s_waitcnt lgkmcnt(4)
    v_mfma_f32_16x16x32_bf16 v[28:31], v[160:163], v[68:71], v[28:31]
    ds_read_b128 v[52:55], v16 offset:16384
    v_mfma_f32_16x16x32_bf16 v[32:35], v[160:163], v[72:75], v[32:35]
    ds_read_b128 v[56:59], v16 offset:20480
    v_mfma_f32_16x16x32_bf16 v[32:35], v[164:167], v[80:83], v[32:35]
    ds_read_b128 v[60:63], v16 offset:24576
    v_mfma_f32_16x16x32_bf16 v[28:31], v[164:167], v[76:79], v[28:31]
    ds_read_b128 v[64:67], v16 offset:28672
    s_waitcnt lgkmcnt(4)
    v_mfma_f32_16x16x32_bf16 v[28:31], v[168:171], v[36:39], v[28:31]
    ds_read_b128 v[68:71], v17 offset:16384
    v_mfma_f32_16x16x32_bf16 v[32:35], v[168:171], v[40:43], v[32:35]
    ds_read_b128 v[72:75], v17 offset:20480
    v_mfma_f32_16x16x32_bf16 v[32:35], v[172:175], v[48:51], v[32:35]
    ds_read_b128 v[76:79], v17 offset:24576
    v_mfma_f32_16x16x32_bf16 v[28:31], v[172:175], v[44:47], v[28:31]
    ds_read_b128 v[80:83], v17 offset:28672
    s_barrier
    s_waitcnt lgkmcnt(4)
    v_mfma_f32_16x16x32_bf16 v[28:31], v[176:179], v[52:55], v[28:31]
    ds_read_b128 v[36:39], v14 offset:32768
    v_mfma_f32_16x16x32_bf16 v[32:35], v[176:179], v[56:59], v[32:35]
    ds_read_b128 v[40:43], v14 offset:36864
    v_mfma_f32_16x16x32_bf16 v[32:35], v[180:183], v[64:67], v[32:35]
    ds_read_b128 v[44:47], v14 offset:40960
    v_mfma_f32_16x16x32_bf16 v[28:31], v[180:183], v[60:63], v[28:31]
    ds_read_b128 v[48:51], v14 offset:45056
    s_waitcnt lgkmcnt(4)
    v_mfma_f32_16x16x32_bf16 v[28:31], v[184:187], v[68:71], v[28:31]
    ds_read_b128 v[52:55], v15 offset:32768
    v_mfma_f32_16x16x32_bf16 v[32:35], v[184:187], v[72:75], v[32:35]
    ds_read_b128 v[56:59], v15 offset:36864
    v_mfma_f32_16x16x32_bf16 v[32:35], v[188:191], v[80:83], v[32:35]
    ds_read_b128 v[60:63], v15 offset:40960
    v_mfma_f32_16x16x32_bf16 v[28:31], v[188:191], v[76:79], v[28:31]
    ds_read_b128 v[64:67], v15 offset:45056
    s_waitcnt lgkmcnt(4)
    v_mfma_f32_16x16x32_bf16 v[28:31], v[192:195], v[36:39], v[28:31]
    ds_read_b128 v[68:71], v16 offset:32768
    v_mfma_f32_16x16x32_bf16 v[32:35], v[192:195], v[40:43], v[32:35]
    ds_read_b128 v[72:75], v16 offset:36864
    v_mfma_f32_16x16x32_bf16 v[32:35], v[196:199], v[48:51], v[32:35]
    ds_read_b128 v[76:79], v16 offset:40960
    v_mfma_f32_16x16x32_bf16 v[28:31], v[196:199], v[44:47], v[28:31]
    ds_read_b128 v[80:83], v16 offset:45056
    s_waitcnt lgkmcnt(4)
    v_mfma_f32_16x16x32_bf16 v[28:31], v[200:203], v[52:55], v[28:31]
    ds_read_b128 v[36:39], v17 offset:32768
    v_mfma_f32_16x16x32_bf16 v[32:35], v[200:203], v[56:59], v[32:35]
    ds_read_b128 v[40:43], v17 offset:36864
    v_mfma_f32_16x16x32_bf16 v[32:35], v[204:207], v[64:67], v[32:35]
    ds_read_b128 v[44:47], v17 offset:40960
    v_mfma_f32_16x16x32_bf16 v[28:31], v[204:207], v[60:63], v[28:31]
    ds_read_b128 v[48:51], v17 offset:45056
    s_barrier
    s_waitcnt lgkmcnt(4)
    v_mfma_f32_16x16x32_bf16 v[28:31], v[208:211], v[68:71], v[28:31]
    ds_read_b128 v[52:55], v10 offset:16384
    v_mfma_f32_16x16x32_bf16 v[32:35], v[208:211], v[72:75], v[32:35]
    ds_read_b128 v[56:59], v10 offset:20480
    v_mfma_f32_16x16x32_bf16 v[32:35], v[212:215], v[80:83], v[32:35]
    ds_read_b128 v[60:63], v10 offset:24576
    v_mfma_f32_16x16x32_bf16 v[28:31], v[212:215], v[76:79], v[28:31]
    ds_read_b128 v[64:67], v10 offset:28672
    s_waitcnt lgkmcnt(4)
    v_mfma_f32_16x16x32_bf16 v[28:31], v[216:219], v[36:39], v[28:31]
    ds_read_b128 v[68:71], v11 offset:16384
    v_mfma_f32_16x16x32_bf16 v[32:35], v[216:219], v[40:43], v[32:35]
    ds_read_b128 v[72:75], v11 offset:20480
    v_mfma_f32_16x16x32_bf16 v[32:35], v[220:223], v[48:51], v[32:35]
    ds_read_b128 v[76:79], v11 offset:24576
    v_mfma_f32_16x16x32_bf16 v[28:31], v[220:223], v[44:47], v[28:31]
    ds_read_b128 v[80:83], v11 offset:28672
    s_waitcnt lgkmcnt(4)
    v_mfma_f32_16x16x32_bf16 v[28:31], v[224:227], v[52:55], v[28:31]
    ds_read_b128 v[36:39], v12 offset:16384
    v_mfma_f32_16x16x32_bf16 v[32:35], v[224:227], v[56:59], v[32:35]
    ds_read_b128 v[40:43], v12 offset:20480
    v_mfma_f32_16x16x32_bf16 v[32:35], v[228:231], v[64:67], v[32:35]
    ds_read_b128 v[44:47], v12 offset:24576
    v_mfma_f32_16x16x32_bf16 v[28:31], v[228:231], v[60:63], v[28:31]
    ds_read_b128 v[48:51], v12 offset:28672
    s_waitcnt lgkmcnt(4)
    v_mfma_f32_16x16x32_bf16 v[28:31], v[232:235], v[68:71], v[28:31]
    ds_read_b128 v[52:55], v13 offset:16384
    v_mfma_f32_16x16x32_bf16 v[32:35], v[232:235], v[72:75], v[32:35]
    ds_read_b128 v[56:59], v13 offset:20480
    v_mfma_f32_16x16x32_bf16 v[32:35], v[236:239], v[80:83], v[32:35]
    ds_read_b128 v[60:63], v13 offset:24576
    v_mfma_f32_16x16x32_bf16 v[28:31], v[236:239], v[76:79], v[28:31]
    ds_read_b128 v[64:67], v13 offset:28672
    s_barrier
    ds_read_b128 v[88:91], v18 offset:512
    ds_read_b128 v[92:95], v18 offset:2560
    ds_read_b128 v[96:99], v18 offset:768
    ds_read_b128 v[100:103], v18 offset:2816
    s_waitcnt vmcnt(0)
    buffer_atomic_add v113, v112, s[56:59], s40 offen offset:2048 sc1
    s_waitcnt lgkmcnt(8)
    v_mfma_f32_16x16x32_bf16 v[28:31], v[240:243], v[36:39], v[28:31]
    ds_read_b128 v[68:71], v10 offset:32768
    v_mfma_f32_16x16x32_bf16 v[32:35], v[240:243], v[40:43], v[32:35]
    ds_read_b128 v[72:75], v10 offset:36864
    v_mfma_f32_16x16x32_bf16 v[32:35], v[244:247], v[48:51], v[32:35]
    ds_read_b128 v[76:79], v10 offset:40960
    v_mfma_f32_16x16x32_bf16 v[28:31], v[244:247], v[44:47], v[28:31]
    ds_read_b128 v[80:83], v10 offset:45056
    s_waitcnt lgkmcnt(8)
    v_mfma_f32_16x16x32_bf16 v[28:31], v[248:251], v[52:55], v[28:31]
    ds_read_b128 v[36:39], v11 offset:32768
    v_mfma_f32_16x16x32_bf16 v[32:35], v[248:251], v[56:59], v[32:35]
    ds_read_b128 v[40:43], v11 offset:36864
    v_mfma_f32_16x16x32_bf16 v[32:35], v[252:255], v[64:67], v[32:35]
    ds_read_b128 v[44:47], v11 offset:40960
    v_mfma_f32_16x16x32_bf16 v[28:31], v[252:255], v[60:63], v[28:31]
    ds_read_b128 v[48:51], v11 offset:45056
    s_waitcnt lgkmcnt(4)
    v_mfma_f32_16x16x32_bf16 v[20:23], v[128:131], v[68:71], 0
    ds_read_b128 v[52:55], v12 offset:32768
    v_mfma_f32_16x16x32_bf16 v[24:27], v[128:131], v[72:75], 0
    ds_read_b128 v[56:59], v12 offset:36864
    v_mfma_f32_16x16x32_bf16 v[24:27], v[132:135], v[80:83], v[24:27]
    ds_read_b128 v[60:63], v12 offset:40960
    v_mfma_f32_16x16x32_bf16 v[20:23], v[132:135], v[76:79], v[20:23]
    ds_read_b128 v[64:67], v12 offset:45056
    v_pk_fma_f32 v[28:29], v[88:89], v[84:85], v[28:29]
    v_pk_fma_f32 v[30:31], v[88:89], v[86:87], v[30:31]
    v_pk_fma_f32 v[32:33], v[96:97], v[84:85], v[32:33]
    v_pk_fma_f32 v[34:35], v[96:97], v[86:87], v[34:35]
    v_pk_mul_f32 v[104:105], v[28:29], v[28:29]
    v_pk_mul_f32 v[106:107], v[30:31], v[30:31]
    v_pk_mul_f32 v[108:109], v[32:33], v[32:33]
    v_pk_mul_f32 v[110:111], v[34:35], v[34:35]
    v_pk_fma_f32 v[104:105], v[104:105], v[92:93], v[90:91]
    v_pk_fma_f32 v[106:107], v[106:107], v[92:93], v[90:91]
    v_pk_fma_f32 v[108:109], v[108:109], v[100:101], v[98:99]
    v_pk_fma_f32 v[110:111], v[110:111], v[100:101], v[98:99]
    v_pk_mul_f32 v[104:105], v[104:105], v[28:29]
    v_pk_mul_f32 v[106:107], v[106:107], v[30:31]
    v_pk_mul_f32 v[108:109], v[108:109], v[32:33]
    v_pk_mul_f32 v[110:111], v[110:111], v[34:35]
    v_exp_f32 v104, v104
    v_exp_f32 v105, v105
    v_exp_f32 v106, v106
    v_exp_f32 v107, v107
    v_exp_f32 v108, v108
    v_exp_f32 v109, v109
    v_exp_f32 v110, v110
    v_exp_f32 v111, v111
    v_pk_fma_f32 v[104:105], v[104:105], v[94:95], v[94:95]
    v_pk_fma_f32 v[106:107], v[106:107], v[94:95], v[94:95]
    v_pk_fma_f32 v[108:109], v[108:109], v[102:103], v[102:103]
    v_pk_fma_f32 v[110:111], v[110:111], v[102:103], v[102:103]
    v_rcp_f32 v104, v104
    v_rcp_f32 v105, v105
    v_rcp_f32 v106, v106
    v_rcp_f32 v107, v107
    v_rcp_f32 v108, v108
    v_rcp_f32 v109, v109
    v_rcp_f32 v110, v110
    v_rcp_f32 v111, v111
    v_pk_mul_f32 v[28:29], v[28:29], v[104:105]
    v_pk_mul_f32 v[30:31], v[30:31], v[106:107]
    v_pk_mul_f32 v[32:33], v[32:33], v[108:109]
    v_pk_mul_f32 v[34:35], v[34:35], v[110:111]
    v_add_u32 v28, 0x10000, v28
    v_add_u32 v30, 0x10000, v30
    v_add_u32 v32, 0x10000, v32
    v_add_u32 v34, 0x10000, v34
    v_and_b32 v28, 0xfffe0000, v28
    v_and_b32 v30, 0xfffe0000, v30
    v_and_b32 v32, 0xfffe0000, v32
    v_and_b32 v34, 0xfffe0000, v34
    v_cvt_pk_bf16_f32 v104, v28, v29
    v_cvt_pk_bf16_f32 v105, v30, v31
    v_cvt_pk_bf16_f32 v106, v32, v33
    v_cvt_pk_bf16_f32 v107, v34, v35
    s_add_u32 s36, s39, 131072
    v_permlane16_swap_b32 v104, v106
    v_permlane16_swap_b32 v105, v107
    buffer_store_dwordx4 v[104:107], v114, s[16:19], s36 offen sc1
    s_waitcnt lgkmcnt(4)
    v_mfma_f32_16x16x32_bf16 v[20:23], v[136:139], v[36:39], v[20:23]
    ds_read_b128 v[68:71], v13 offset:32768
    v_mfma_f32_16x16x32_bf16 v[24:27], v[136:139], v[40:43], v[24:27]
    ds_read_b128 v[72:75], v13 offset:36864
    v_mfma_f32_16x16x32_bf16 v[24:27], v[140:143], v[48:51], v[24:27]
    ds_read_b128 v[76:79], v13 offset:40960
    v_mfma_f32_16x16x32_bf16 v[20:23], v[140:143], v[44:47], v[20:23]
    ds_read_b128 v[80:83], v13 offset:45056
    s_barrier
    s_waitcnt lgkmcnt(4)
    v_mfma_f32_16x16x32_bf16 v[20:23], v[144:147], v[52:55], v[20:23]
    ds_read_b128 v[36:39], v14 offset:0
    v_mfma_f32_16x16x32_bf16 v[24:27], v[144:147], v[56:59], v[24:27]
    ds_read_b128 v[40:43], v14 offset:4096
    v_mfma_f32_16x16x32_bf16 v[24:27], v[148:151], v[64:67], v[24:27]
    ds_read_b128 v[44:47], v14 offset:8192
    v_mfma_f32_16x16x32_bf16 v[20:23], v[148:151], v[60:63], v[20:23]
    ds_read_b128 v[48:51], v14 offset:12288
    s_waitcnt lgkmcnt(4)
    v_mfma_f32_16x16x32_bf16 v[20:23], v[152:155], v[68:71], v[20:23]
    ds_read_b128 v[52:55], v15 offset:0
    v_mfma_f32_16x16x32_bf16 v[24:27], v[152:155], v[72:75], v[24:27]
    ds_read_b128 v[56:59], v15 offset:4096
    v_mfma_f32_16x16x32_bf16 v[24:27], v[156:159], v[80:83], v[24:27]
    ds_read_b128 v[60:63], v15 offset:8192
    v_mfma_f32_16x16x32_bf16 v[20:23], v[156:159], v[76:79], v[20:23]
    ds_read_b128 v[64:67], v15 offset:12288
    s_waitcnt lgkmcnt(4)
    v_mfma_f32_16x16x32_bf16 v[20:23], v[160:163], v[36:39], v[20:23]
    ds_read_b128 v[68:71], v16 offset:0
    v_mfma_f32_16x16x32_bf16 v[24:27], v[160:163], v[40:43], v[24:27]
    ds_read_b128 v[72:75], v16 offset:4096
    v_mfma_f32_16x16x32_bf16 v[24:27], v[164:167], v[48:51], v[24:27]
    ds_read_b128 v[76:79], v16 offset:8192
    v_mfma_f32_16x16x32_bf16 v[20:23], v[164:167], v[44:47], v[20:23]
    ds_read_b128 v[80:83], v16 offset:12288
    s_waitcnt lgkmcnt(4)
    v_mfma_f32_16x16x32_bf16 v[20:23], v[168:171], v[52:55], v[20:23]
    ds_read_b128 v[36:39], v17 offset:0
    v_mfma_f32_16x16x32_bf16 v[24:27], v[168:171], v[56:59], v[24:27]
    ds_read_b128 v[40:43], v17 offset:4096
    v_mfma_f32_16x16x32_bf16 v[24:27], v[172:175], v[64:67], v[24:27]
    ds_read_b128 v[44:47], v17 offset:8192
    v_mfma_f32_16x16x32_bf16 v[20:23], v[172:175], v[60:63], v[20:23]
    ds_read_b128 v[48:51], v17 offset:12288
    s_barrier
    s_waitcnt lgkmcnt(4)
    v_mfma_f32_16x16x32_bf16 v[20:23], v[176:179], v[68:71], v[20:23]
    ds_read_b128 v[52:55], v14 offset:16384
    v_mfma_f32_16x16x32_bf16 v[24:27], v[176:179], v[72:75], v[24:27]
    ds_read_b128 v[56:59], v14 offset:20480
    v_mfma_f32_16x16x32_bf16 v[24:27], v[180:183], v[80:83], v[24:27]
    ds_read_b128 v[60:63], v14 offset:24576
    v_mfma_f32_16x16x32_bf16 v[20:23], v[180:183], v[76:79], v[20:23]
    ds_read_b128 v[64:67], v14 offset:28672
    s_waitcnt lgkmcnt(4)
    v_mfma_f32_16x16x32_bf16 v[20:23], v[184:187], v[36:39], v[20:23]
    ds_read_b128 v[68:71], v15 offset:16384
    v_mfma_f32_16x16x32_bf16 v[24:27], v[184:187], v[40:43], v[24:27]
    ds_read_b128 v[72:75], v15 offset:20480
    v_mfma_f32_16x16x32_bf16 v[24:27], v[188:191], v[48:51], v[24:27]
    ds_read_b128 v[76:79], v15 offset:24576
    v_mfma_f32_16x16x32_bf16 v[20:23], v[188:191], v[44:47], v[20:23]
    ds_read_b128 v[80:83], v15 offset:28672
    s_waitcnt lgkmcnt(4)
    v_mfma_f32_16x16x32_bf16 v[20:23], v[192:195], v[52:55], v[20:23]
    ds_read_b128 v[36:39], v16 offset:16384
    v_mfma_f32_16x16x32_bf16 v[24:27], v[192:195], v[56:59], v[24:27]
    ds_read_b128 v[40:43], v16 offset:20480
    v_mfma_f32_16x16x32_bf16 v[24:27], v[196:199], v[64:67], v[24:27]
    ds_read_b128 v[44:47], v16 offset:24576
    v_mfma_f32_16x16x32_bf16 v[20:23], v[196:199], v[60:63], v[20:23]
    ds_read_b128 v[48:51], v16 offset:28672
    s_waitcnt lgkmcnt(4)
    v_mfma_f32_16x16x32_bf16 v[20:23], v[200:203], v[68:71], v[20:23]
    ds_read_b128 v[52:55], v17 offset:16384
    v_mfma_f32_16x16x32_bf16 v[24:27], v[200:203], v[72:75], v[24:27]
    ds_read_b128 v[56:59], v17 offset:20480
    v_mfma_f32_16x16x32_bf16 v[24:27], v[204:207], v[80:83], v[24:27]
    ds_read_b128 v[60:63], v17 offset:24576
    v_mfma_f32_16x16x32_bf16 v[20:23], v[204:207], v[76:79], v[20:23]
    ds_read_b128 v[64:67], v17 offset:28672
    s_barrier
    s_waitcnt lgkmcnt(4)
    v_mfma_f32_16x16x32_bf16 v[20:23], v[208:211], v[36:39], v[20:23]
    ds_read_b128 v[68:71], v14 offset:32768
    v_mfma_f32_16x16x32_bf16 v[24:27], v[208:211], v[40:43], v[24:27]
    ds_read_b128 v[72:75], v14 offset:36864
    v_mfma_f32_16x16x32_bf16 v[24:27], v[212:215], v[48:51], v[24:27]
    ds_read_b128 v[76:79], v14 offset:40960
    v_mfma_f32_16x16x32_bf16 v[20:23], v[212:215], v[44:47], v[20:23]
    ds_read_b128 v[80:83], v14 offset:45056
    s_waitcnt lgkmcnt(4)
    v_mfma_f32_16x16x32_bf16 v[20:23], v[216:219], v[52:55], v[20:23]
    ds_read_b128 v[36:39], v15 offset:32768
    v_mfma_f32_16x16x32_bf16 v[24:27], v[216:219], v[56:59], v[24:27]
    ds_read_b128 v[40:43], v15 offset:36864
    v_mfma_f32_16x16x32_bf16 v[24:27], v[220:223], v[64:67], v[24:27]
    ds_read_b128 v[44:47], v15 offset:40960
    v_mfma_f32_16x16x32_bf16 v[20:23], v[220:223], v[60:63], v[20:23]
    ds_read_b128 v[48:51], v15 offset:45056
    s_waitcnt lgkmcnt(4)
    v_mfma_f32_16x16x32_bf16 v[20:23], v[224:227], v[68:71], v[20:23]
    ds_read_b128 v[52:55], v16 offset:32768
    v_mfma_f32_16x16x32_bf16 v[24:27], v[224:227], v[72:75], v[24:27]
    ds_read_b128 v[56:59], v16 offset:36864
    v_mfma_f32_16x16x32_bf16 v[24:27], v[228:231], v[80:83], v[24:27]
    ds_read_b128 v[60:63], v16 offset:40960
    v_mfma_f32_16x16x32_bf16 v[20:23], v[228:231], v[76:79], v[20:23]
    ds_read_b128 v[64:67], v16 offset:45056
    s_waitcnt lgkmcnt(4)
    v_mfma_f32_16x16x32_bf16 v[20:23], v[232:235], v[36:39], v[20:23]
    ds_read_b128 v[68:71], v17 offset:32768
    v_mfma_f32_16x16x32_bf16 v[24:27], v[232:235], v[40:43], v[24:27]
    ds_read_b128 v[72:75], v17 offset:36864
    v_mfma_f32_16x16x32_bf16 v[24:27], v[236:239], v[48:51], v[24:27]
    ds_read_b128 v[76:79], v17 offset:40960
    v_mfma_f32_16x16x32_bf16 v[20:23], v[236:239], v[44:47], v[20:23]
    ds_read_b128 v[80:83], v17 offset:45056
    s_barrier
    ds_read_b128 v[88:91], v18 offset:1024
    ds_read_b128 v[92:95], v18 offset:3072
    ds_read_b128 v[96:99], v18 offset:1280
    ds_read_b128 v[100:103], v18 offset:3328
    s_waitcnt vmcnt(0)
    buffer_atomic_add v113, v112, s[56:59], s40 offen offset:2560 sc1
    s_waitcnt lgkmcnt(8)
    v_mfma_f32_16x16x32_bf16 v[20:23], v[240:243], v[52:55], v[20:23]
    ds_read_b128 v[36:39], v10 offset:16384
    v_mfma_f32_16x16x32_bf16 v[24:27], v[240:243], v[56:59], v[24:27]
    ds_read_b128 v[40:43], v10 offset:20480
    v_mfma_f32_16x16x32_bf16 v[24:27], v[244:247], v[64:67], v[24:27]
    ds_read_b128 v[44:47], v10 offset:24576
    v_mfma_f32_16x16x32_bf16 v[20:23], v[244:247], v[60:63], v[20:23]
    ds_read_b128 v[48:51], v10 offset:28672
    s_waitcnt lgkmcnt(8)
    v_mfma_f32_16x16x32_bf16 v[20:23], v[248:251], v[68:71], v[20:23]
    ds_read_b128 v[52:55], v11 offset:16384
    v_mfma_f32_16x16x32_bf16 v[24:27], v[248:251], v[72:75], v[24:27]
    ds_read_b128 v[56:59], v11 offset:20480
    v_mfma_f32_16x16x32_bf16 v[24:27], v[252:255], v[80:83], v[24:27]
    ds_read_b128 v[60:63], v11 offset:24576
    v_mfma_f32_16x16x32_bf16 v[20:23], v[252:255], v[76:79], v[20:23]
    ds_read_b128 v[64:67], v11 offset:28672
    s_waitcnt lgkmcnt(4)
    v_mfma_f32_16x16x32_bf16 v[28:31], v[128:131], v[36:39], 0
    ds_read_b128 v[68:71], v12 offset:16384
    v_mfma_f32_16x16x32_bf16 v[32:35], v[128:131], v[40:43], 0
    ds_read_b128 v[72:75], v12 offset:20480
    v_mfma_f32_16x16x32_bf16 v[32:35], v[132:135], v[48:51], v[32:35]
    ds_read_b128 v[76:79], v12 offset:24576
    v_mfma_f32_16x16x32_bf16 v[28:31], v[132:135], v[44:47], v[28:31]
    ds_read_b128 v[80:83], v12 offset:28672
    v_pk_fma_f32 v[20:21], v[88:89], v[84:85], v[20:21]
    v_pk_fma_f32 v[22:23], v[88:89], v[86:87], v[22:23]
    v_pk_fma_f32 v[24:25], v[96:97], v[84:85], v[24:25]
    v_pk_fma_f32 v[26:27], v[96:97], v[86:87], v[26:27]
    v_pk_mul_f32 v[104:105], v[20:21], v[20:21]
    v_pk_mul_f32 v[106:107], v[22:23], v[22:23]
    v_pk_mul_f32 v[108:109], v[24:25], v[24:25]
    v_pk_mul_f32 v[110:111], v[26:27], v[26:27]
    v_pk_fma_f32 v[104:105], v[104:105], v[92:93], v[90:91]
    v_pk_fma_f32 v[106:107], v[106:107], v[92:93], v[90:91]
    v_pk_fma_f32 v[108:109], v[108:109], v[100:101], v[98:99]
    v_pk_fma_f32 v[110:111], v[110:111], v[100:101], v[98:99]
    v_pk_mul_f32 v[104:105], v[104:105], v[20:21]
    v_pk_mul_f32 v[106:107], v[106:107], v[22:23]
    v_pk_mul_f32 v[108:109], v[108:109], v[24:25]
    v_pk_mul_f32 v[110:111], v[110:111], v[26:27]
    v_exp_f32 v104, v104
    v_exp_f32 v105, v105
    v_exp_f32 v106, v106
    v_exp_f32 v107, v107
    v_exp_f32 v108, v108
    v_exp_f32 v109, v109
    v_exp_f32 v110, v110
    v_exp_f32 v111, v111
    v_pk_fma_f32 v[104:105], v[104:105], v[94:95], v[94:95]
    v_pk_fma_f32 v[106:107], v[106:107], v[94:95], v[94:95]
    v_pk_fma_f32 v[108:109], v[108:109], v[102:103], v[102:103]
    v_pk_fma_f32 v[110:111], v[110:111], v[102:103], v[102:103]
    v_rcp_f32 v104, v104
    v_rcp_f32 v105, v105
    v_rcp_f32 v106, v106
    v_rcp_f32 v107, v107
    v_rcp_f32 v108, v108
    v_rcp_f32 v109, v109
    v_rcp_f32 v110, v110
    v_rcp_f32 v111, v111
    v_pk_mul_f32 v[20:21], v[20:21], v[104:105]
    v_pk_mul_f32 v[22:23], v[22:23], v[106:107]
    v_pk_mul_f32 v[24:25], v[24:25], v[108:109]
    v_pk_mul_f32 v[26:27], v[26:27], v[110:111]
    v_add_u32 v20, 0x10000, v20
    v_add_u32 v22, 0x10000, v22
    v_add_u32 v24, 0x10000, v24
    v_add_u32 v26, 0x10000, v26
    v_and_b32 v20, 0xfffe0000, v20
    v_and_b32 v22, 0xfffe0000, v22
    v_and_b32 v24, 0xfffe0000, v24
    v_and_b32 v26, 0xfffe0000, v26
    v_cvt_pk_bf16_f32 v104, v20, v21
    v_cvt_pk_bf16_f32 v105, v22, v23
    v_cvt_pk_bf16_f32 v106, v24, v25
    v_cvt_pk_bf16_f32 v107, v26, v27
    s_add_u32 s36, s39, 262144
    v_permlane16_swap_b32 v104, v106
    v_permlane16_swap_b32 v105, v107
    buffer_store_dwordx4 v[104:107], v114, s[16:19], s36 offen sc1
    s_waitcnt lgkmcnt(4)
    v_mfma_f32_16x16x32_bf16 v[28:31], v[136:139], v[52:55], v[28:31]
    ds_read_b128 v[36:39], v13 offset:16384
    v_mfma_f32_16x16x32_bf16 v[32:35], v[136:139], v[56:59], v[32:35]
    ds_read_b128 v[40:43], v13 offset:20480
    v_mfma_f32_16x16x32_bf16 v[32:35], v[140:143], v[64:67], v[32:35]
    ds_read_b128 v[44:47], v13 offset:24576
    v_mfma_f32_16x16x32_bf16 v[28:31], v[140:143], v[60:63], v[28:31]
    ds_read_b128 v[48:51], v13 offset:28672
    s_barrier
    s_waitcnt lgkmcnt(4)
    v_mfma_f32_16x16x32_bf16 v[28:31], v[144:147], v[68:71], v[28:31]
    ds_read_b128 v[52:55], v10 offset:32768
    v_mfma_f32_16x16x32_bf16 v[32:35], v[144:147], v[72:75], v[32:35]
    ds_read_b128 v[56:59], v10 offset:36864
    v_mfma_f32_16x16x32_bf16 v[32:35], v[148:151], v[80:83], v[32:35]
    ds_read_b128 v[60:63], v10 offset:40960
    v_mfma_f32_16x16x32_bf16 v[28:31], v[148:151], v[76:79], v[28:31]
    ds_read_b128 v[64:67], v10 offset:45056
    s_waitcnt lgkmcnt(4)
    v_mfma_f32_16x16x32_bf16 v[28:31], v[152:155], v[36:39], v[28:31]
    ds_read_b128 v[68:71], v11 offset:32768
    v_mfma_f32_16x16x32_bf16 v[32:35], v[152:155], v[40:43], v[32:35]
    ds_read_b128 v[72:75], v11 offset:36864
    v_mfma_f32_16x16x32_bf16 v[32:35], v[156:159], v[48:51], v[32:35]
    ds_read_b128 v[76:79], v11 offset:40960
    v_mfma_f32_16x16x32_bf16 v[28:31], v[156:159], v[44:47], v[28:31]
    ds_read_b128 v[80:83], v11 offset:45056
    s_waitcnt lgkmcnt(4)
    v_mfma_f32_16x16x32_bf16 v[28:31], v[160:163], v[52:55], v[28:31]
    ds_read_b128 v[36:39], v12 offset:32768
    v_mfma_f32_16x16x32_bf16 v[32:35], v[160:163], v[56:59], v[32:35]
    ds_read_b128 v[40:43], v12 offset:36864
    v_mfma_f32_16x16x32_bf16 v[32:35], v[164:167], v[64:67], v[32:35]
    ds_read_b128 v[44:47], v12 offset:40960
    v_mfma_f32_16x16x32_bf16 v[28:31], v[164:167], v[60:63], v[28:31]
    ds_read_b128 v[48:51], v12 offset:45056
    s_waitcnt lgkmcnt(4)
    v_mfma_f32_16x16x32_bf16 v[28:31], v[168:171], v[68:71], v[28:31]
    ds_read_b128 v[52:55], v13 offset:32768
    v_mfma_f32_16x16x32_bf16 v[32:35], v[168:171], v[72:75], v[32:35]
    ds_read_b128 v[56:59], v13 offset:36864
    v_mfma_f32_16x16x32_bf16 v[32:35], v[172:175], v[80:83], v[32:35]
    ds_read_b128 v[60:63], v13 offset:40960
    v_mfma_f32_16x16x32_bf16 v[28:31], v[172:175], v[76:79], v[28:31]
    ds_read_b128 v[64:67], v13 offset:45056
    s_barrier
    s_waitcnt lgkmcnt(4)
    v_mfma_f32_16x16x32_bf16 v[28:31], v[176:179], v[36:39], v[28:31]
    ds_read_b128 v[68:71], v14 offset:0
    v_mfma_f32_16x16x32_bf16 v[32:35], v[176:179], v[40:43], v[32:35]
    ds_read_b128 v[72:75], v14 offset:4096
    v_mfma_f32_16x16x32_bf16 v[32:35], v[180:183], v[48:51], v[32:35]
    ds_read_b128 v[76:79], v14 offset:8192
    v_mfma_f32_16x16x32_bf16 v[28:31], v[180:183], v[44:47], v[28:31]
    ds_read_b128 v[80:83], v14 offset:12288
    s_waitcnt lgkmcnt(4)
    v_mfma_f32_16x16x32_bf16 v[28:31], v[184:187], v[52:55], v[28:31]
    ds_read_b128 v[36:39], v15 offset:0
    v_mfma_f32_16x16x32_bf16 v[32:35], v[184:187], v[56:59], v[32:35]
    ds_read_b128 v[40:43], v15 offset:4096
    v_mfma_f32_16x16x32_bf16 v[32:35], v[188:191], v[64:67], v[32:35]
    ds_read_b128 v[44:47], v15 offset:8192
    v_mfma_f32_16x16x32_bf16 v[28:31], v[188:191], v[60:63], v[28:31]
    ds_read_b128 v[48:51], v15 offset:12288
    s_waitcnt lgkmcnt(4)
    v_mfma_f32_16x16x32_bf16 v[28:31], v[192:195], v[68:71], v[28:31]
    ds_read_b128 v[52:55], v16 offset:0
    v_mfma_f32_16x16x32_bf16 v[32:35], v[192:195], v[72:75], v[32:35]
    ds_read_b128 v[56:59], v16 offset:4096
    v_mfma_f32_16x16x32_bf16 v[32:35], v[196:199], v[80:83], v[32:35]
    ds_read_b128 v[60:63], v16 offset:8192
    v_mfma_f32_16x16x32_bf16 v[28:31], v[196:199], v[76:79], v[28:31]
    ds_read_b128 v[64:67], v16 offset:12288
    s_waitcnt lgkmcnt(4)
    v_mfma_f32_16x16x32_bf16 v[28:31], v[200:203], v[36:39], v[28:31]
    ds_read_b128 v[68:71], v17 offset:0
    v_mfma_f32_16x16x32_bf16 v[32:35], v[200:203], v[40:43], v[32:35]
    ds_read_b128 v[72:75], v17 offset:4096
    v_mfma_f32_16x16x32_bf16 v[32:35], v[204:207], v[48:51], v[32:35]
    ds_read_b128 v[76:79], v17 offset:8192
    v_mfma_f32_16x16x32_bf16 v[28:31], v[204:207], v[44:47], v[28:31]
    ds_read_b128 v[80:83], v17 offset:12288
    s_barrier
    s_waitcnt lgkmcnt(4)
    v_mfma_f32_16x16x32_bf16 v[28:31], v[208:211], v[52:55], v[28:31]
    ds_read_b128 v[36:39], v14 offset:16384
    v_mfma_f32_16x16x32_bf16 v[32:35], v[208:211], v[56:59], v[32:35]
    ds_read_b128 v[40:43], v14 offset:20480
    v_mfma_f32_16x16x32_bf16 v[32:35], v[212:215], v[64:67], v[32:35]
    ds_read_b128 v[44:47], v14 offset:24576
    v_mfma_f32_16x16x32_bf16 v[28:31], v[212:215], v[60:63], v[28:31]
    ds_read_b128 v[48:51], v14 offset:28672
    s_waitcnt lgkmcnt(4)
    v_mfma_f32_16x16x32_bf16 v[28:31], v[216:219], v[68:71], v[28:31]
    ds_read_b128 v[52:55], v15 offset:16384
    v_mfma_f32_16x16x32_bf16 v[32:35], v[216:219], v[72:75], v[32:35]
    ds_read_b128 v[56:59], v15 offset:20480
    v_mfma_f32_16x16x32_bf16 v[32:35], v[220:223], v[80:83], v[32:35]
    ds_read_b128 v[60:63], v15 offset:24576
    v_mfma_f32_16x16x32_bf16 v[28:31], v[220:223], v[76:79], v[28:31]
    ds_read_b128 v[64:67], v15 offset:28672
    s_waitcnt vmcnt(0)
    buffer_atomic_add v113, v112, s[56:59], s40 offen offset:3072 sc1
    s_waitcnt lgkmcnt(4)
    v_mfma_f32_16x16x32_bf16 v[28:31], v[224:227], v[36:39], v[28:31]
    ds_read_b128 v[68:71], v16 offset:16384
    v_mfma_f32_16x16x32_bf16 v[32:35], v[224:227], v[40:43], v[32:35]
    ds_read_b128 v[72:75], v16 offset:20480
    v_mfma_f32_16x16x32_bf16 v[32:35], v[228:231], v[48:51], v[32:35]
    ds_read_b128 v[76:79], v16 offset:24576
    v_mfma_f32_16x16x32_bf16 v[28:31], v[228:231], v[44:47], v[28:31]
    ds_read_b128 v[80:83], v16 offset:28672
    s_waitcnt lgkmcnt(4)
    v_mfma_f32_16x16x32_bf16 v[28:31], v[232:235], v[52:55], v[28:31]
    ds_read_b128 v[36:39], v17 offset:16384
    v_mfma_f32_16x16x32_bf16 v[32:35], v[232:235], v[56:59], v[32:35]
    ds_read_b128 v[40:43], v17 offset:20480
    v_mfma_f32_16x16x32_bf16 v[32:35], v[236:239], v[64:67], v[32:35]
    ds_read_b128 v[44:47], v17 offset:24576
    v_mfma_f32_16x16x32_bf16 v[28:31], v[236:239], v[60:63], v[28:31]
    ds_read_b128 v[48:51], v17 offset:28672
    s_barrier
    ds_read_b128 v[88:91], v18 offset:1536
    ds_read_b128 v[92:95], v18 offset:3584
    ds_read_b128 v[96:99], v18 offset:1792
    ds_read_b128 v[100:103], v18 offset:3840
    s_waitcnt lgkmcnt(8)
    v_mfma_f32_16x16x32_bf16 v[28:31], v[240:243], v[68:71], v[28:31]
    v_mfma_f32_16x16x32_bf16 v[32:35], v[240:243], v[72:75], v[32:35]
    v_mfma_f32_16x16x32_bf16 v[32:35], v[244:247], v[80:83], v[32:35]
    v_mfma_f32_16x16x32_bf16 v[28:31], v[244:247], v[76:79], v[28:31]
    s_waitcnt lgkmcnt(4)
    v_mfma_f32_16x16x32_bf16 v[28:31], v[248:251], v[36:39], v[28:31]
    v_mfma_f32_16x16x32_bf16 v[32:35], v[248:251], v[40:43], v[32:35]
    v_mfma_f32_16x16x32_bf16 v[32:35], v[252:255], v[48:51], v[32:35]
    v_mfma_f32_16x16x32_bf16 v[28:31], v[252:255], v[44:47], v[28:31]
    s_setprio 1
    s_waitcnt lgkmcnt(0)
    s_load_dword s32, s[4:5], s20 offset:2560
    s_load_dword s3, s[4:5], s20 offset:2688
    s_add_u32 m0, s12, 106496
    s_add_u32 s49, s8, 20480
    buffer_load_dwordx4 v2, s[16:19], s49 offen offset:0 sc1 lds
    buffer_load_dwordx4 v2, s[16:19], s49 offen offset:1024 sc1 lds
    buffer_load_dwordx4 v2, s[16:19], s49 offen offset:2048 sc1 lds
    buffer_load_dwordx4 v2, s[16:19], s49 offen offset:3072 sc1 lds
    v_pk_fma_f32 v[28:29], v[88:89], v[84:85], v[28:29]
    v_pk_fma_f32 v[30:31], v[88:89], v[86:87], v[30:31]
    v_pk_fma_f32 v[32:33], v[96:97], v[84:85], v[32:33]
    v_pk_fma_f32 v[34:35], v[96:97], v[86:87], v[34:35]
    v_pk_mul_f32 v[104:105], v[28:29], v[28:29]
    v_pk_mul_f32 v[106:107], v[30:31], v[30:31]
    v_pk_mul_f32 v[108:109], v[32:33], v[32:33]
    v_pk_mul_f32 v[110:111], v[34:35], v[34:35]
    v_pk_fma_f32 v[104:105], v[104:105], v[92:93], v[90:91]
    v_pk_fma_f32 v[106:107], v[106:107], v[92:93], v[90:91]
    v_pk_fma_f32 v[108:109], v[108:109], v[100:101], v[98:99]
    v_pk_fma_f32 v[110:111], v[110:111], v[100:101], v[98:99]
    v_pk_mul_f32 v[104:105], v[104:105], v[28:29]
    v_pk_mul_f32 v[106:107], v[106:107], v[30:31]
    v_pk_mul_f32 v[108:109], v[108:109], v[32:33]
    v_pk_mul_f32 v[110:111], v[110:111], v[34:35]
    v_exp_f32 v104, v104
    v_exp_f32 v105, v105
    v_exp_f32 v106, v106
    v_exp_f32 v107, v107
    v_exp_f32 v108, v108
    v_exp_f32 v109, v109
    v_exp_f32 v110, v110
    v_exp_f32 v111, v111
    v_pk_fma_f32 v[104:105], v[104:105], v[94:95], v[94:95]
    v_pk_fma_f32 v[106:107], v[106:107], v[94:95], v[94:95]
    v_pk_fma_f32 v[108:109], v[108:109], v[102:103], v[102:103]
    v_pk_fma_f32 v[110:111], v[110:111], v[102:103], v[102:103]
    v_rcp_f32 v104, v104
    v_rcp_f32 v105, v105
    v_rcp_f32 v106, v106
    v_rcp_f32 v107, v107
    v_rcp_f32 v108, v108
    v_rcp_f32 v109, v109
    v_rcp_f32 v110, v110
    v_rcp_f32 v111, v111
    v_pk_mul_f32 v[28:29], v[28:29], v[104:105]
    v_pk_mul_f32 v[30:31], v[30:31], v[106:107]
    v_pk_mul_f32 v[32:33], v[32:33], v[108:109]
    v_pk_mul_f32 v[34:35], v[34:35], v[110:111]
    v_add_u32 v28, 0x10000, v28
    v_add_u32 v30, 0x10000, v30
    v_add_u32 v32, 0x10000, v32
    v_add_u32 v34, 0x10000, v34
    v_and_b32 v28, 0xfffe0000, v28
    v_and_b32 v30, 0xfffe0000, v30
    v_and_b32 v32, 0xfffe0000, v32
    v_and_b32 v34, 0xfffe0000, v34
    v_cvt_pk_bf16_f32 v104, v28, v29
    v_cvt_pk_bf16_f32 v105, v30, v31
    v_cvt_pk_bf16_f32 v106, v32, v33
    v_cvt_pk_bf16_f32 v107, v34, v35
    s_add_u32 s36, s39, 393216
    v_permlane16_swap_b32 v104, v106
    v_permlane16_swap_b32 v105, v107
    buffer_store_dwordx4 v[104:107], v114, s[16:19], s36 offen sc1
    s_add_u32 m0, s12, 122880
    s_add_u32 s49, s8, 131072
    s_barrier
    s_waitcnt lgkmcnt(0)
    s_cmp_eq_u32 s32, s21
    s_cselect_b32 s32, s3, 0
    s_cmp_eq_u32 s32, s21
    s_cbranch_scc1 hok_11
    s_add_u32 s53, s20, 2560
    v_lshlrev_b32 v85, 7, v1
    v_add_u32 v85, s53, v85
    s_mov_b32 s53, 0
    s_add_u32 s54, s52, 16
    s_bfm_b64 exec, 2, 0
poll_12:
    buffer_load_dword v84, v85, s[56:59], 0 offen sc1
    s_waitcnt vmcnt(0)
    v_cmp_eq_u32 vcc, s54, v84
    s_nop 0
    s_cmp_eq_u64 vcc, exec
    s_cbranch_scc1 pok_13
    s_sleep 8
    s_add_u32 s53, s53, 1
    s_cmp_lt_u32 s53, s61
    s_cbranch_scc1 poll_12
    s_mov_b32 s61, 0
pok_13:
    s_mov_b64 exec, -1
hok_11:
    buffer_load_dwordx4 v2, s[16:19], s49 offen offset:0 sc1 lds
    buffer_load_dwordx4 v2, s[16:19], s49 offen offset:1024 sc1 lds
    buffer_load_dwordx4 v2, s[16:19], s49 offen offset:2048 sc1 lds
    buffer_load_dwordx4 v2, s[16:19], s49 offen offset:3072 sc1 lds
    s_add_u32 m0, s12, 139264
    s_add_u32 s49, s8, 135168
    s_barrier
    buffer_load_dwordx4 v2, s[16:19], s49 offen offset:0 sc1 lds
    buffer_load_dwordx4 v2, s[16:19], s49 offen offset:1024 sc1 lds
    buffer_load_dwordx4 v2, s[16:19], s49 offen offset:2048 sc1 lds
    buffer_load_dwordx4 v2, s[16:19], s49 offen offset:3072 sc1 lds
    s_add_u32 m0, s12, 16384
    s_add_u32 s49, s8, 147456
    s_waitcnt vmcnt(9)
    s_barrier
    s_waitcnt vmcnt(8)
    buffer_atomic_add v113, v112, s[56:59], s40 offen offset:3584 sc1
    buffer_load_dwordx4 v2, s[16:19], s49 offen offset:0 sc1 lds
    buffer_load_dwordx4 v2, s[16:19], s49 offen offset:1024 sc1 lds
    buffer_load_dwordx4 v2, s[16:19], s49 offen offset:2048 sc1 lds
    buffer_load_dwordx4 v2, s[16:19], s49 offen offset:3072 sc1 lds
    s_add_u32 m0, s12, 32768
    s_add_u32 s49, s8, 151552
    s_waitcnt vmcnt(9)
    s_barrier
    s_load_dword s32, s[4:5], s20 offset:3072
    s_load_dword s3, s[4:5], s20 offset:3200
    buffer_load_dwordx4 v2, s[16:19], s49 offen offset:0 sc1 lds
    buffer_load_dwordx4 v2, s[16:19], s49 offen offset:1024 sc1 lds
    buffer_load_dwordx4 v2, s[16:19], s49 offen offset:2048 sc1 lds
    buffer_load_dwordx4 v2, s[16:19], s49 offen offset:3072 sc1 lds
    s_add_u32 m0, s12, 106496
    s_add_u32 s49, s8, 262144
    s_waitcnt vmcnt(9)
    s_barrier
    s_waitcnt lgkmcnt(0)
    s_cmp_eq_u32 s32, s21
    s_cselect_b32 s32, s3, 0
    s_cmp_eq_u32 s32, s21
    s_cbranch_scc1 hok_14
    s_add_u32 s53, s20, 3072
    v_lshlrev_b32 v85, 7, v1
    v_add_u32 v85, s53, v85
    s_mov_b32 s53, 0
    s_add_u32 s54, s52, 16
    s_bfm_b64 exec, 2, 0
poll_15:
    buffer_load_dword v84, v85, s[56:59], 0 offen sc1
    s_waitcnt vmcnt(0)
    v_cmp_eq_u32 vcc, s54, v84
    s_nop 0
    s_cmp_eq_u64 vcc, exec
    s_cbranch_scc1 pok_16
    s_sleep 8
    s_add_u32 s53, s53, 1
    s_cmp_lt_u32 s53, s61
    s_cbranch_scc1 poll_15
    s_mov_b32 s61, 0
pok_16:
    s_mov_b64 exec, -1
hok_14:
    buffer_load_dwordx4 v2, s[16:19], s49 offen offset:0 sc1 lds
    buffer_load_dwordx4 v2, s[16:19], s49 offen offset:1024 sc1 lds
    buffer_load_dwordx4 v2, s[16:19], s49 offen offset:2048 sc1 lds
    buffer_load_dwordx4 v2, s[16:19], s49 offen offset:3072 sc1 lds
    s_add_u32 m0, s12, 122880
    s_add_u32 s49, s8, 266240
    s_waitcnt vmcnt(8)
    s_barrier
    buffer_load_dwordx4 v2, s[16:19], s49 offen offset:0 sc1 lds
    buffer_load_dwordx4 v2, s[16:19], s49 offen offset:1024 sc1 lds
    buffer_load_dwordx4 v2, s[16:19], s49 offen offset:2048 sc1 lds
    buffer_load_dwordx4 v2, s[16:19], s49 offen offset:3072 sc1 lds
    s_add_u32 m0, s12, 139264
    s_add_u32 s49, s8, 278528
    s_waitcnt vmcnt(8)
    s_barrier
    buffer_load_dwordx4 v2, s[16:19], s49 offen offset:0 sc1 lds
    buffer_load_dwordx4 v2, s[16:19], s49 offen offset:1024 sc1 lds
    buffer_load_dwordx4 v2, s[16:19], s49 offen offset:2048 sc1 lds
    buffer_load_dwordx4 v2, s[16:19], s49 offen offset:3072 sc1 lds
    s_add_u32 m0, s12, 16384
    s_add_u32 s49, s8, 282624
    s_waitcnt vmcnt(8)
    s_barrier
    s_load_dword s32, s[4:5], s20 offset:3584
    s_load_dword s3, s[4:5], s20 offset:3712
    buffer_load_dwordx4 v2, s[16:19], s49 offen offset:0 sc1 lds
    buffer_load_dwordx4 v2, s[16:19], s49 offen offset:1024 sc1 lds
    buffer_load_dwordx4 v2, s[16:19], s49 offen offset:2048 sc1 lds
    buffer_load_dwordx4 v2, s[16:19], s49 offen offset:3072 sc1 lds
    s_add_u32 m0, s12, 32768
    s_add_u32 s49, s8, 393216
    s_waitcnt vmcnt(8)
    s_barrier
    s_waitcnt lgkmcnt(0)
    s_cmp_eq_u32 s32, s21
    s_cselect_b32 s32, s3, 0
    s_cmp_eq_u32 s32, s21
    s_cbranch_scc1 hok_17
    s_add_u32 s53, s20, 3584
    v_lshlrev_b32 v85, 7, v1
    v_add_u32 v85, s53, v85
    s_mov_b32 s53, 0
    s_add_u32 s54, s52, 16
    s_bfm_b64 exec, 2, 0
poll_18:
    buffer_load_dword v84, v85, s[56:59], 0 offen sc1
    s_waitcnt vmcnt(0)
    v_cmp_eq_u32 vcc, s54, v84
    s_nop 0
    s_cmp_eq_u64 vcc, exec
    s_cbranch_scc1 pok_19
    s_sleep 8
    s_add_u32 s53, s53, 1
    s_cmp_lt_u32 s53, s61
    s_cbranch_scc1 poll_18
    s_mov_b32 s61, 0
pok_19:
    s_mov_b64 exec, -1
hok_17:
    buffer_load_dwordx4 v2, s[16:19], s49 offen offset:0 sc1 lds
    buffer_load_dwordx4 v2, s[16:19], s49 offen offset:1024 sc1 lds
    buffer_load_dwordx4 v2, s[16:19], s49 offen offset:2048 sc1 lds
    buffer_load_dwordx4 v2, s[16:19], s49 offen offset:3072 sc1 lds
    s_add_u32 m0, s12, 106496
    s_add_u32 s49, s8, 397312
    s_waitcnt vmcnt(8)
    s_barrier
    buffer_load_dwordx4 v2, s[16:19], s49 offen offset:0 sc1 lds
    buffer_load_dwordx4 v2, s[16:19], s49 offen offset:1024 sc1 lds
    buffer_load_dwordx4 v2, s[16:19], s49 offen offset:2048 sc1 lds
    buffer_load_dwordx4 v2, s[16:19], s49 offen offset:3072 sc1 lds
    s_add_u32 m0, s12, 122880
    s_add_u32 s49, s8, 409600
    s_waitcnt vmcnt(8)
    s_barrier
    buffer_load_dwordx4 v2, s[16:19], s49 offen offset:0 sc1 lds
    buffer_load_dwordx4 v2, s[16:19], s49 offen offset:1024 sc1 lds
    buffer_load_dwordx4 v2, s[16:19], s49 offen offset:2048 sc1 lds
    buffer_load_dwordx4 v2, s[16:19], s49 offen offset:3072 sc1 lds
    s_add_u32 m0, s12, 139264
    s_add_u32 s49, s8, 413696
    s_waitcnt vmcnt(8)
    s_barrier
    buffer_load_dwordx4 v2, s[16:19], s49 offen offset:0 sc1 lds
    buffer_load_dwordx4 v2, s[16:19], s49 offen offset:1024 sc1 lds
    buffer_load_dwordx4 v2, s[16:19], s49 offen offset:2048 sc1 lds
    buffer_load_dwordx4 v2, s[16:19], s49 offen offset:3072 sc1 lds
    s_waitcnt vmcnt(8)
    s_barrier
    s_lshr_b32 s34, s30, 1
    s_and_b32 s35, s30, 1
    v_and_b32 v22, 15, v1
    v_lshrrev_b32 v23, 4, v1
    s_mul_i32 s37, s34, 4
    s_mul_i32 s36, s34, 8192
    v_add_u32 v12, s36, v2
    v_lshrrev_b32 v18, 2, v1
    v_mul_u32_u24 v13, 448, v18
    v_and_b32 v19, 3, v1
    v_lshl_add_u32 v13, v19, 3, v13
    v_add_u32 v13, 49152, v13
    v_mul_u32_u24 v15, 448, v18
    v_and_b32 v19, 2, v1
    v_lshl_add_u32 v15, v19, 2, v15
    v_bfe_u32 v18, v1, 4, 1
    v_and_b32 v19, 1, v1
    v_xor_b32 v19, v19, v18
    v_lshl_add_u32 v15, v19, 5, v15
    s_lshl_b32 s36, s35, 4
    s_add_u32 s36, s36, 49344
    v_add_u32 v15, s36, v15
    s_lshl_b32 s36, s35, 8
    v_add_u32 v13, s36, v13
    v_lshlrev_b32 v18, 5, v18
    v_sub_u32 v14, v13, v18
    v_add_u32 v13, v13, v18
    s_mov_b32 s42, 0
    s_mov_b32 s43, 0
    s_mov_b32 s48, 0
    v_mov_b32 v17, v12
    v_mov_b32 v18, v13
    v_mov_b32 v19, v14
    v_mov_b32 v20, v15
    s_waitcnt vmcnt(4)
    s_barrier
    s_waitcnt vmcnt(0)
    s_barrier
    s_setprio 0
    s_waitcnt lgkmcnt(0)
    s_barrier
    ds_read_b128 v[136:139], v17 offset:0
    ds_read_b128 v[140:143], v17 offset:2048
    ds_read_b128 v[144:147], v17 offset:4096
    ds_read_b128 v[148:151], v17 offset:6144
    ds_read_b64_tr_b16 v[152:153], v18 offset:0
    ds_read_b64_tr_b16 v[154:155], v18 offset:7168
    ds_read_b64_tr_b16 v[156:157], v19 offset:32
    ds_read_b64_tr_b16 v[158:159], v19 offset:7200
    ds_read_b64_tr_b16 v[160:161], v18 offset:64
    ds_read_b64_tr_b16 v[162:163], v18 offset:7232
    ds_read_b64_tr_b16 v[164:165], v19 offset:96
    ds_read_b64_tr_b16 v[166:167], v19 offset:7264
    ds_read_b64_tr_b16 v[168:169], v18 offset:128
    ds_read_b64_tr_b16 v[170:171], v18 offset:7296
    ds_read_b64_tr_b16 v[172:173], v19 offset:160
    ds_read_b64_tr_b16 v[174:175], v19 offset:7328
    ds_read_b64_tr_b16 v[176:177], v20 offset:0
    ds_read_b64_tr_b16 v[178:179], v20 offset:7168
    s_waitcnt lgkmcnt(0)
    v_mfma_f32_16x16x32_bf16 v[24:27], v[152:155], v[136:139], 0
    ds_read_b128 v[180:183], v17 offset:1024
    v_mfma_f32_16x16x32_bf16 v[52:55], v[152:155], v[140:143], 0
    ds_read_b128 v[184:187], v17 offset:3072
    v_mfma_f32_16x16x32_bf16 v[80:83], v[152:155], v[144:147], 0
    ds_read_b128 v[188:191], v17 offset:5120
    v_mfma_f32_16x16x32_bf16 v[108:111], v[152:155], v[148:151], 0
    ds_read_b128 v[192:195], v17 offset:7168
    v_mfma_f32_16x16x32_bf16 v[112:115], v[156:159], v[148:151], 0
    ds_read_b64_tr_b16 v[196:197], v18 offset:14336
    v_mfma_f32_16x16x32_bf16 v[84:87], v[156:159], v[144:147], 0
    ds_read_b64_tr_b16 v[198:199], v18 offset:21504
    v_mfma_f32_16x16x32_bf16 v[56:59], v[156:159], v[140:143], 0
    v_mfma_f32_16x16x32_bf16 v[28:31], v[156:159], v[136:139], 0
    ds_read_b64_tr_b16 v[200:201], v19 offset:14368
    v_mfma_f32_16x16x32_bf16 v[32:35], v[160:163], v[136:139], 0
    ds_read_b64_tr_b16 v[202:203], v19 offset:21536
    v_mfma_f32_16x16x32_bf16 v[60:63], v[160:163], v[140:143], 0
    ds_read_b64_tr_b16 v[204:205], v18 offset:14400
    v_mfma_f32_16x16x32_bf16 v[88:91], v[160:163], v[144:147], 0
    ds_read_b64_tr_b16 v[206:207], v18 offset:21568
    v_mfma_f32_16x16x32_bf16 v[116:119], v[160:163], v[148:151], 0
    ds_read_b64_tr_b16 v[208:209], v19 offset:14432
    v_mfma_f32_16x16x32_bf16 v[120:123], v[164:167], v[148:151], 0
    ds_read_b64_tr_b16 v[210:211], v19 offset:21600
    v_mfma_f32_16x16x32_bf16 v[92:95], v[164:167], v[144:147], 0
    v_mfma_f32_16x16x32_bf16 v[64:67], v[164:167], v[140:143], 0
    ds_read_b64_tr_b16 v[212:213], v18 offset:14464
    v_mfma_f32_16x16x32_bf16 v[36:39], v[164:167], v[136:139], 0
    ds_read_b64_tr_b16 v[214:215], v18 offset:21632
    v_mfma_f32_16x16x32_bf16 v[40:43], v[168:171], v[136:139], 0
    ds_read_b64_tr_b16 v[216:217], v19 offset:14496
    v_mfma_f32_16x16x32_bf16 v[68:71], v[168:171], v[140:143], 0
    ds_read_b64_tr_b16 v[218:219], v19 offset:21664
    v_mfma_f32_16x16x32_bf16 v[96:99], v[168:171], v[144:147], 0
    ds_read_b64_tr_b16 v[220:221], v20 offset:14336
    v_mfma_f32_16x16x32_bf16 v[124:127], v[168:171], v[148:151], 0
    ds_read_b64_tr_b16 v[222:223], v20 offset:21504
    v_mfma_f32_16x16x32_bf16 v[128:131], v[172:175], v[148:151], 0
    s_add_u32 s42, s42, 16384
    s_cmp_eq_u32 s42, 49152
    v_mfma_f32_16x16x32_bf16 v[100:103], v[172:175], v[144:147], 0
    s_cselect_b32 s42, 0, s42
    s_add_u32 s48, s48, 28672
    v_mfma_f32_16x16x32_bf16 v[72:75], v[172:175], v[140:143], 0
    s_cmp_eq_u32 s48, 86016
    s_cselect_b32 s48, 0, s48
    v_mfma_f32_16x16x32_bf16 v[44:47], v[172:175], v[136:139], 0
    v_add_u32 v17, s42, v12
    v_add_u32 v18, s48, v13
    v_mfma_f32_16x16x32_bf16 v[48:51], v[176:179], v[136:139], 0
    v_add_u32 v19, s48, v14
    v_add_u32 v20, s48, v15
    v_mfma_f32_16x16x32_bf16 v[76:79], v[176:179], v[140:143], 0
    v_mfma_f32_16x16x32_bf16 v[104:107], v[176:179], v[144:147], 0
    v_mfma_f32_16x16x32_bf16 v[132:135], v[176:179], v[148:151], 0
    s_waitcnt lgkmcnt(0)
    v_mfma_f32_16x16x32_bf16 v[24:27], v[196:199], v[180:183], v[24:27]
    v_mfma_f32_16x16x32_bf16 v[52:55], v[196:199], v[184:187], v[52:55]
    v_mfma_f32_16x16x32_bf16 v[80:83], v[196:199], v[188:191], v[80:83]
    v_mfma_f32_16x16x32_bf16 v[108:111], v[196:199], v[192:195], v[108:111]
    v_mfma_f32_16x16x32_bf16 v[112:115], v[200:203], v[192:195], v[112:115]
    v_mfma_f32_16x16x32_bf16 v[84:87], v[200:203], v[188:191], v[84:87]
    v_mfma_f32_16x16x32_bf16 v[56:59], v[200:203], v[184:187], v[56:59]
    v_mfma_f32_16x16x32_bf16 v[28:31], v[200:203], v[180:183], v[28:31]
    v_mfma_f32_16x16x32_bf16 v[32:35], v[204:207], v[180:183], v[32:35]
    v_mfma_f32_16x16x32_bf16 v[60:63], v[204:207], v[184:187], v[60:63]
    v_mfma_f32_16x16x32_bf16 v[88:91], v[204:207], v[188:191], v[88:91]
    v_mfma_f32_16x16x32_bf16 v[116:119], v[204:207], v[192:195], v[116:119]
    v_mfma_f32_16x16x32_bf16 v[120:123], v[208:211], v[192:195], v[120:123]
    v_mfma_f32_16x16x32_bf16 v[92:95], v[208:211], v[188:191], v[92:95]
    v_mfma_f32_16x16x32_bf16 v[64:67], v[208:211], v[184:187], v[64:67]
    v_mfma_f32_16x16x32_bf16 v[36:39], v[208:211], v[180:183], v[36:39]
    v_mfma_f32_16x16x32_bf16 v[40:43], v[212:215], v[180:183], v[40:43]
    v_mfma_f32_16x16x32_bf16 v[68:71], v[212:215], v[184:187], v[68:71]
    v_mfma_f32_16x16x32_bf16 v[96:99], v[212:215], v[188:191], v[96:99]
    v_mfma_f32_16x16x32_bf16 v[124:127], v[212:215], v[192:195], v[124:127]
    v_mfma_f32_16x16x32_bf16 v[128:131], v[216:219], v[192:195], v[128:131]
    s_add_u32 s43, s43, 1
    v_mfma_f32_16x16x32_bf16 v[100:103], v[216:219], v[188:191], v[100:103]
    v_mfma_f32_16x16x32_bf16 v[72:75], v[216:219], v[184:187], v[72:75]
    v_mfma_f32_16x16x32_bf16 v[44:47], v[216:219], v[180:183], v[44:47]
    v_mfma_f32_16x16x32_bf16 v[48:51], v[220:223], v[180:183], v[48:51]
    v_mfma_f32_16x16x32_bf16 v[76:79], v[220:223], v[184:187], v[76:79]
    v_mfma_f32_16x16x32_bf16 v[104:107], v[220:223], v[188:191], v[104:107]
    v_mfma_f32_16x16x32_bf16 v[132:135], v[220:223], v[192:195], v[132:135]
    s_load_dwordx2 s[6:7], s[0:1], 88
    s_mov_b32 s16, s62
    s_mov_b32 s17, s63
    s_mov_b32 s18, 0x1be000
    s_mov_b32 s19, 0x20000
    s_mul_i32 s39, s37, 229376
    s_mul_i32 s40, s29, 7
    s_lshl2_add_u32 s41, s35, s40
    s_add_u32 s36, s41, 0
    s_lshr_b32 s53, s36, 3
    s_lshl_b32 s53, s53, 14
    s_and_b32 s44, s36, 7
    s_lshl_b32 s44, s44, 10
    s_add_u32 s44, s44, s53
    s_add_u32 s44, s44, s39
    s_add_u32 s36, s41, 1
    s_lshr_b32 s53, s36, 3
    s_lshl_b32 s53, s53, 14
    s_and_b32 s45, s36, 7
    s_lshl_b32 s45, s45, 10
    s_add_u32 s45, s45, s53
    s_add_u32 s45, s45, s39
    s_add_u32 s36, s41, 2
    s_lshr_b32 s53, s36, 3
    s_lshl_b32 s53, s53, 14
    s_and_b32 s46, s36, 7
    s_lshl_b32 s46, s46, 10
    s_add_u32 s46, s46, s53
    s_add_u32 s46, s46, s39
    s_add_u32 s36, s40, 3
    s_lshr_b32 s53, s36, 3
    s_lshl_b32 s53, s53, 14
    s_and_b32 s47, s36, 7
    s_lshl_b32 s47, s47, 10
    s_add_u32 s47, s47, s53
    s_add_u32 s47, s47, s39
    s_lshl_b32 s36, s35, 9
    s_add_u32 s47, s47, s36
    s_lshl1_add_u32 s49, s31, s34
    s_lshl_b32 s49, s49, 7
    s_add_u32 s49, s49, s55
    s_add_u32 s49, s49, 0x1000
    s_lshl_b32 s86, s60, 24
    s_lshl_b32 s87, s94, 13
    s_add_u32 s86, s86, s87
    s_add_u32 s86, s86, 167772160
    s_add_u32 s84, s4, s86
    s_addc_u32 s85, s5, 0
    s_mov_b32 s86, 8380416
    s_mov_b32 s87, 0x20000
    s_add_u32 s88, s62, 0x480000
    s_addc_u32 s89, s63, 0
    s_mov_b32 s90, 0x7e000
    s_mov_b32 s91, 0x20000
    s_add_u32 s24, s62, 0x400000
    s_addc_u32 s25, s63, 0
    s_mov_b32 s26, 0x7e000
    s_mov_b32 s27, 0x20000
    s_lshl1_add_u32 s39, s33, s35
    s_lshl_b32 s36, s39, 1
    s_lshr_b32 s53, s36, 3
    s_lshl_b32 s53, s53, 14
    s_and_b32 s40, s36, 7
    s_lshl_b32 s40, s40, 10
    s_add_u32 s40, s40, s53
    s_lshl1_add_u32 s38, s31, s37
    s_lshl_b32 s36, s38, 16
    s_add_u32 s40, s40, s36
    s_add_u32 s12, s40, 65536
    s_xor_b32 s41, s40, 0x20000
    s_lshl3_add_u32 s38, s28, s38
    s_lshl_b32 s39, s39, 7
    s_lshl_b32 s13, s38, 16
    s_add_u32 s13, s13, s39
    s_add_u32 s14, s13, 65536
    s_lshl_b32 s38, s38, 15
    s_add_u32 s38, s38, s39
    s_add_u32 s39, s38, 32768
    s_mov_b32 s15, 0xffff0000
    s_waitcnt lgkmcnt(0)
    s_mov_b32 s20, s6
    s_mov_b32 s21, s7
    s_mov_b32 s22, 0x400000
    s_mov_b32 s23, 0x20000
    v_lshrrev_b32 v254, 1, v23
    v_lshlrev_b32 v254, 8, v254
    v_lshl_add_u32 v254, v22, 4, v254
    v_and_b32 v6, 1, v23
    v_lshl_add_u32 v254, v6, 3, v254
    v_lshrrev_b32 v6, 2, v22
    v_cmp_eq_u32 vcc, v6, v23
    v_and_b32 v6, 1, v22
    v_lshlrev_b32 v6, 4, v6
    v_mov_b32 v224, 0x3f80
    v_lshlrev_b32 v6, v6, v224
    v_cndmask_b32 v6, 0, v6, vcc
    v_and_b32 v224, 2, v22
    v_cmp_eq_u32 vcc, 0, v224
    v_mov_b32 v224, 0
    v_mov_b32 v225, 0
    v_mov_b32 v228, 0
    v_mov_b32 v229, 0
    v_cndmask_b32 v226, 0, v6, vcc
    v_cndmask_b32 v227, v6, v224, vcc
    v_and_b32 v6, 3, v22
    v_lshrrev_b32 v255, 2, v22
    v_lshlrev_b32 v255, 14, v255
    v_lshl_add_u32 v255, v6, 11, v255
    v_lshl_add_u32 v255, v23, 4, v255
    v_mov_b32 v8, 1
    v_mov_b32 v9, 0x7f000000
    v_writelane_b32 v9, 0, 0
    v_and_b32 v11, 1, v23
    v_lshlrev_b32 v10, 11, v22
    v_lshl_add_u32 v10, v11, 5, v10
    v_lshrrev_b32 v11, 1, v23
    v_lshl_add_u32 v10, v11, 4, v10
    v_lshrrev_b32 v11, 3, v22
    v_mul_u32_u24 v11, 16320, v11
    v_sub_u32 v10, v10, v11
    v_add_u32 v11, 16384, v10
    s_mul_i32 s36, s35, 448
    s_add_u32 s36, s36, 159744
    v_lshlrev_b32 v6, 4, v23
    v_add_u32 v6, s36, v6
    s_lshl_b32 s36, s34, 10
    s_add_u32 s36, s36, 160768
    v_lshlrev_b32 v7, 4, v22
    v_add_u32 v7, s36, v7
    s_lshl1_add_u32 s36, s37, s35
    s_lshl2_add_u32 s36, s31, s36
    s_lshl_b32 s36, s36, 10
    v_add_u32 v22, s36, v2
    v_xor_b32 v23, 4096, v22
    s_barrier
    ds_read_b128 v[136:139], v17 offset:0
    ds_read_b128 v[140:143], v17 offset:2048
    ds_read_b128 v[144:147], v17 offset:4096
    ds_read_b128 v[148:151], v17 offset:6144
    ds_read_b64_tr_b16 v[152:153], v18 offset:0
    ds_read_b64_tr_b16 v[154:155], v18 offset:7168
    ds_read_b64_tr_b16 v[156:157], v19 offset:32
    ds_read_b64_tr_b16 v[158:159], v19 offset:7200
    ds_read_b64_tr_b16 v[160:161], v18 offset:64
    ds_read_b64_tr_b16 v[162:163], v18 offset:7232
    ds_read_b64_tr_b16 v[164:165], v19 offset:96
    ds_read_b64_tr_b16 v[166:167], v19 offset:7264
    ds_read_b64_tr_b16 v[168:169], v18 offset:128
    ds_read_b64_tr_b16 v[170:171], v18 offset:7296
    ds_read_b64_tr_b16 v[172:173], v19 offset:160
    ds_read_b64_tr_b16 v[174:175], v19 offset:7328
    ds_read_b64_tr_b16 v[176:177], v20 offset:0
    ds_read_b64_tr_b16 v[178:179], v20 offset:7168
mm_20:
    s_waitcnt lgkmcnt(0)
    v_mfma_f32_16x16x32_bf16 v[24:27], v[152:155], v[136:139], v[24:27]
    ds_read_b128 v[180:183], v17 offset:1024
    v_mfma_f32_16x16x32_bf16 v[52:55], v[152:155], v[140:143], v[52:55]
    ds_read_b128 v[184:187], v17 offset:3072
    v_mfma_f32_16x16x32_bf16 v[80:83], v[152:155], v[144:147], v[80:83]
    ds_read_b128 v[188:191], v17 offset:5120
    v_mfma_f32_16x16x32_bf16 v[108:111], v[152:155], v[148:151], v[108:111]
    ds_read_b128 v[192:195], v17 offset:7168
    v_mfma_f32_16x16x32_bf16 v[112:115], v[156:159], v[148:151], v[112:115]
    ds_read_b64_tr_b16 v[196:197], v18 offset:14336
    v_mfma_f32_16x16x32_bf16 v[84:87], v[156:159], v[144:147], v[84:87]
    ds_read_b64_tr_b16 v[198:199], v18 offset:21504
    v_mfma_f32_16x16x32_bf16 v[56:59], v[156:159], v[140:143], v[56:59]
    v_mfma_f32_16x16x32_bf16 v[28:31], v[156:159], v[136:139], v[28:31]
    ds_read_b64_tr_b16 v[200:201], v19 offset:14368
    v_mfma_f32_16x16x32_bf16 v[32:35], v[160:163], v[136:139], v[32:35]
    ds_read_b64_tr_b16 v[202:203], v19 offset:21536
    v_mfma_f32_16x16x32_bf16 v[60:63], v[160:163], v[140:143], v[60:63]
    ds_read_b64_tr_b16 v[204:205], v18 offset:14400
    v_mfma_f32_16x16x32_bf16 v[88:91], v[160:163], v[144:147], v[88:91]
    ds_read_b64_tr_b16 v[206:207], v18 offset:21568
    v_mfma_f32_16x16x32_bf16 v[116:119], v[160:163], v[148:151], v[116:119]
    ds_read_b64_tr_b16 v[208:209], v19 offset:14432
    v_mfma_f32_16x16x32_bf16 v[120:123], v[164:167], v[148:151], v[120:123]
    ds_read_b64_tr_b16 v[210:211], v19 offset:21600
    v_mfma_f32_16x16x32_bf16 v[92:95], v[164:167], v[144:147], v[92:95]
    v_mfma_f32_16x16x32_bf16 v[64:67], v[164:167], v[140:143], v[64:67]
    ds_read_b64_tr_b16 v[212:213], v18 offset:14464
    v_mfma_f32_16x16x32_bf16 v[36:39], v[164:167], v[136:139], v[36:39]
    ds_read_b64_tr_b16 v[214:215], v18 offset:21632
    v_mfma_f32_16x16x32_bf16 v[40:43], v[168:171], v[136:139], v[40:43]
    ds_read_b64_tr_b16 v[216:217], v19 offset:14496
    v_mfma_f32_16x16x32_bf16 v[68:71], v[168:171], v[140:143], v[68:71]
    ds_read_b64_tr_b16 v[218:219], v19 offset:21664
    v_mfma_f32_16x16x32_bf16 v[96:99], v[168:171], v[144:147], v[96:99]
    ds_read_b64_tr_b16 v[220:221], v20 offset:14336
    v_mfma_f32_16x16x32_bf16 v[124:127], v[168:171], v[148:151], v[124:127]
    ds_read_b64_tr_b16 v[222:223], v20 offset:21504
    v_mfma_f32_16x16x32_bf16 v[128:131], v[172:175], v[148:151], v[128:131]
    s_add_u32 s42, s42, 16384
    s_cmp_eq_u32 s42, 49152
    v_mfma_f32_16x16x32_bf16 v[100:103], v[172:175], v[144:147], v[100:103]
    s_cselect_b32 s42, 0, s42
    s_add_u32 s48, s48, 28672
    v_mfma_f32_16x16x32_bf16 v[72:75], v[172:175], v[140:143], v[72:75]
    s_cmp_eq_u32 s48, 86016
    s_cselect_b32 s48, 0, s48
    v_mfma_f32_16x16x32_bf16 v[44:47], v[172:175], v[136:139], v[44:47]
    v_add_u32 v17, s42, v12
    v_add_u32 v18, s48, v13
    v_mfma_f32_16x16x32_bf16 v[48:51], v[176:179], v[136:139], v[48:51]
    v_add_u32 v19, s48, v14
    v_add_u32 v20, s48, v15
    v_mfma_f32_16x16x32_bf16 v[76:79], v[176:179], v[140:143], v[76:79]
    v_mfma_f32_16x16x32_bf16 v[104:107], v[176:179], v[144:147], v[104:107]
    v_mfma_f32_16x16x32_bf16 v[132:135], v[176:179], v[148:151], v[132:135]
    s_waitcnt lgkmcnt(0)
    s_barrier
    v_mfma_f32_16x16x32_bf16 v[24:27], v[196:199], v[180:183], v[24:27]
    ds_read_b128 v[136:139], v17 offset:0
    v_mfma_f32_16x16x32_bf16 v[52:55], v[196:199], v[184:187], v[52:55]
    ds_read_b128 v[140:143], v17 offset:2048
    v_mfma_f32_16x16x32_bf16 v[80:83], v[196:199], v[188:191], v[80:83]
    ds_read_b128 v[144:147], v17 offset:4096
    v_mfma_f32_16x16x32_bf16 v[108:111], v[196:199], v[192:195], v[108:111]
    ds_read_b128 v[148:151], v17 offset:6144
    v_mfma_f32_16x16x32_bf16 v[112:115], v[200:203], v[192:195], v[112:115]
    ds_read_b64_tr_b16 v[152:153], v18 offset:0
    v_mfma_f32_16x16x32_bf16 v[84:87], v[200:203], v[188:191], v[84:87]
    ds_read_b64_tr_b16 v[154:155], v18 offset:7168
    v_mfma_f32_16x16x32_bf16 v[56:59], v[200:203], v[184:187], v[56:59]
    v_mfma_f32_16x16x32_bf16 v[28:31], v[200:203], v[180:183], v[28:31]
    ds_read_b64_tr_b16 v[156:157], v19 offset:32
    v_mfma_f32_16x16x32_bf16 v[32:35], v[204:207], v[180:183], v[32:35]
    ds_read_b64_tr_b16 v[158:159], v19 offset:7200
    v_mfma_f32_16x16x32_bf16 v[60:63], v[204:207], v[184:187], v[60:63]
    ds_read_b64_tr_b16 v[160:161], v18 offset:64
    v_mfma_f32_16x16x32_bf16 v[88:91], v[204:207], v[188:191], v[88:91]
    ds_read_b64_tr_b16 v[162:163], v18 offset:7232
    v_mfma_f32_16x16x32_bf16 v[116:119], v[204:207], v[192:195], v[116:119]
    ds_read_b64_tr_b16 v[164:165], v19 offset:96
    v_mfma_f32_16x16x32_bf16 v[120:123], v[208:211], v[192:195], v[120:123]
    ds_read_b64_tr_b16 v[166:167], v19 offset:7264
    v_mfma_f32_16x16x32_bf16 v[92:95], v[208:211], v[188:191], v[92:95]
    v_mfma_f32_16x16x32_bf16 v[64:67], v[208:211], v[184:187], v[64:67]
    ds_read_b64_tr_b16 v[168:169], v18 offset:128
    v_mfma_f32_16x16x32_bf16 v[36:39], v[208:211], v[180:183], v[36:39]
    ds_read_b64_tr_b16 v[170:171], v18 offset:7296
    v_mfma_f32_16x16x32_bf16 v[40:43], v[212:215], v[180:183], v[40:43]
    ds_read_b64_tr_b16 v[172:173], v19 offset:160
    v_mfma_f32_16x16x32_bf16 v[68:71], v[212:215], v[184:187], v[68:71]
    ds_read_b64_tr_b16 v[174:175], v19 offset:7328
    v_mfma_f32_16x16x32_bf16 v[96:99], v[212:215], v[188:191], v[96:99]
    ds_read_b64_tr_b16 v[176:177], v20 offset:0
    v_mfma_f32_16x16x32_bf16 v[124:127], v[212:215], v[192:195], v[124:127]
    ds_read_b64_tr_b16 v[178:179], v20 offset:7168
    v_mfma_f32_16x16x32_bf16 v[128:131], v[216:219], v[192:195], v[128:131]
    s_add_u32 s43, s43, 1
    v_mfma_f32_16x16x32_bf16 v[100:103], v[216:219], v[188:191], v[100:103]
    s_cmp_lt_u32 s43, 15
    v_mfma_f32_16x16x32_bf16 v[72:75], v[216:219], v[184:187], v[72:75]
    v_mfma_f32_16x16x32_bf16 v[44:47], v[216:219], v[180:183], v[44:47]
    v_mfma_f32_16x16x32_bf16 v[48:51], v[220:223], v[180:183], v[48:51]
    v_mfma_f32_16x16x32_bf16 v[76:79], v[220:223], v[184:187], v[76:79]
    v_mfma_f32_16x16x32_bf16 v[104:107], v[220:223], v[188:191], v[104:107]
    v_mfma_f32_16x16x32_bf16 v[132:135], v[220:223], v[192:195], v[132:135]
    s_cbranch_scc1 mm_20
    s_waitcnt lgkmcnt(0)
    v_mfma_f32_16x16x32_bf16 v[24:27], v[152:155], v[136:139], v[24:27]
    ds_read_b128 v[180:183], v17 offset:1024
    v_mfma_f32_16x16x32_bf16 v[52:55], v[152:155], v[140:143], v[52:55]
    ds_read_b128 v[184:187], v17 offset:3072
    v_mfma_f32_16x16x32_bf16 v[80:83], v[152:155], v[144:147], v[80:83]
    ds_read_b128 v[188:191], v17 offset:5120
    v_mfma_f32_16x16x32_bf16 v[108:111], v[152:155], v[148:151], v[108:111]
    ds_read_b128 v[192:195], v17 offset:7168
    v_mfma_f32_16x16x32_bf16 v[112:115], v[156:159], v[148:151], v[112:115]
    ds_read_b64_tr_b16 v[196:197], v18 offset:14336
    v_mfma_f32_16x16x32_bf16 v[84:87], v[156:159], v[144:147], v[84:87]
    ds_read_b64_tr_b16 v[198:199], v18 offset:21504
    v_mfma_f32_16x16x32_bf16 v[56:59], v[156:159], v[140:143], v[56:59]
    v_mfma_f32_16x16x32_bf16 v[28:31], v[156:159], v[136:139], v[28:31]
    ds_read_b64_tr_b16 v[200:201], v19 offset:14368
    v_mfma_f32_16x16x32_bf16 v[32:35], v[160:163], v[136:139], v[32:35]
    ds_read_b64_tr_b16 v[202:203], v19 offset:21536
    v_mfma_f32_16x16x32_bf16 v[60:63], v[160:163], v[140:143], v[60:63]
    ds_read_b64_tr_b16 v[204:205], v18 offset:14400
    v_mfma_f32_16x16x32_bf16 v[88:91], v[160:163], v[144:147], v[88:91]
    ds_read_b64_tr_b16 v[206:207], v18 offset:21568
    v_mfma_f32_16x16x32_bf16 v[116:119], v[160:163], v[148:151], v[116:119]
    ds_read_b64_tr_b16 v[208:209], v19 offset:14432
    v_mfma_f32_16x16x32_bf16 v[120:123], v[164:167], v[148:151], v[120:123]
    ds_read_b64_tr_b16 v[210:211], v19 offset:21600
    v_mfma_f32_16x16x32_bf16 v[92:95], v[164:167], v[144:147], v[92:95]
    v_mfma_f32_16x16x32_bf16 v[64:67], v[164:167], v[140:143], v[64:67]
    ds_read_b64_tr_b16 v[212:213], v18 offset:14464
    v_mfma_f32_16x16x32_bf16 v[36:39], v[164:167], v[136:139], v[36:39]
    ds_read_b64_tr_b16 v[214:215], v18 offset:21632
    v_mfma_f32_16x16x32_bf16 v[40:43], v[168:171], v[136:139], v[40:43]
    ds_read_b64_tr_b16 v[216:217], v19 offset:14496
    v_mfma_f32_16x16x32_bf16 v[68:71], v[168:171], v[140:143], v[68:71]
    ds_read_b64_tr_b16 v[218:219], v19 offset:21664
    v_mfma_f32_16x16x32_bf16 v[96:99], v[168:171], v[144:147], v[96:99]
    ds_read_b64_tr_b16 v[220:221], v20 offset:14336
    v_mfma_f32_16x16x32_bf16 v[124:127], v[168:171], v[148:151], v[124:127]
    ds_read_b64_tr_b16 v[222:223], v20 offset:21504
    v_mfma_f32_16x16x32_bf16 v[128:131], v[172:175], v[148:151], v[128:131]
    v_mfma_f32_16x16x32_bf16 v[100:103], v[172:175], v[144:147], v[100:103]
    v_mfma_f32_16x16x32_bf16 v[72:75], v[172:175], v[140:143], v[72:75]
    v_mfma_f32_16x16x32_bf16 v[44:47], v[172:175], v[136:139], v[44:47]
    v_mfma_f32_16x16x32_bf16 v[48:51], v[176:179], v[136:139], v[48:51]
    v_mfma_f32_16x16x32_bf16 v[76:79], v[176:179], v[140:143], v[76:79]
    v_mfma_f32_16x16x32_bf16 v[104:107], v[176:179], v[144:147], v[104:107]
    v_mfma_f32_16x16x32_bf16 v[132:135], v[176:179], v[148:151], v[132:135]
    s_waitcnt lgkmcnt(0)
    s_barrier
    v_mfma_f32_16x16x32_bf16 v[24:27], v[196:199], v[180:183], v[24:27]
    ds_read_b128 v[136:139], v6 offset:0
    v_mfma_f32_16x16x32_bf16 v[52:55], v[196:199], v[184:187], v[52:55]
    ds_read_b128 v[140:143], v6 offset:64
    v_mfma_f32_16x16x32_bf16 v[80:83], v[196:199], v[188:191], v[80:83]
    v_mfma_f32_16x16x32_bf16 v[108:111], v[196:199], v[192:195], v[108:111]
    ds_read_b128 v[144:147], v6 offset:128
    v_mfma_f32_16x16x32_bf16 v[112:115], v[200:203], v[192:195], v[112:115]
    v_mfma_f32_16x16x32_bf16 v[84:87], v[200:203], v[188:191], v[84:87]
    ds_read_b128 v[148:151], v6 offset:192
    v_mfma_f32_16x16x32_bf16 v[56:59], v[200:203], v[184:187], v[56:59]
    v_mfma_f32_16x16x32_bf16 v[28:31], v[200:203], v[180:183], v[28:31]
    ds_read_b128 v[152:155], v6 offset:256
    v_mfma_f32_16x16x32_bf16 v[32:35], v[204:207], v[180:183], v[32:35]
    v_mfma_f32_16x16x32_bf16 v[60:63], v[204:207], v[184:187], v[60:63]
    ds_read_b128 v[156:159], v6 offset:320
    v_mfma_f32_16x16x32_bf16 v[88:91], v[204:207], v[188:191], v[88:91]
    v_mfma_f32_16x16x32_bf16 v[116:119], v[204:207], v[192:195], v[116:119]
    ds_read_b128 v[160:163], v6 offset:384
    v_mfma_f32_16x16x32_bf16 v[120:123], v[208:211], v[192:195], v[120:123]
    v_mfma_f32_16x16x32_bf16 v[92:95], v[208:211], v[188:191], v[92:95]
    ds_read_b128 v[164:167], v7 offset:0
    v_mfma_f32_16x16x32_bf16 v[64:67], v[208:211], v[184:187], v[64:67]
    v_mfma_f32_16x16x32_bf16 v[36:39], v[208:211], v[180:183], v[36:39]
    ds_read_b128 v[168:171], v7 offset:256
    v_mfma_f32_16x16x32_bf16 v[40:43], v[212:215], v[180:183], v[40:43]
    v_mfma_f32_16x16x32_bf16 v[68:71], v[212:215], v[184:187], v[68:71]
    ds_read_b128 v[172:175], v7 offset:512
    v_mfma_f32_16x16x32_bf16 v[96:99], v[212:215], v[188:191], v[96:99]
    v_mfma_f32_16x16x32_bf16 v[124:127], v[212:215], v[192:195], v[124:127]
    ds_read_b128 v[176:179], v7 offset:768
    v_mfma_f32_16x16x32_bf16 v[128:131], v[216:219], v[192:195], v[128:131]
    v_mfma_f32_16x16x32_bf16 v[100:103], v[216:219], v[188:191], v[100:103]
    v_mfma_f32_16x16x32_bf16 v[72:75], v[216:219], v[184:187], v[72:75]
    v_mfma_f32_16x16x32_bf16 v[44:47], v[216:219], v[180:183], v[44:47]
    v_mfma_f32_16x16x32_bf16 v[48:51], v[220:223], v[180:183], v[48:51]
    v_mfma_f32_16x16x32_bf16 v[76:79], v[220:223], v[184:187], v[76:79]
    v_mfma_f32_16x16x32_bf16 v[104:107], v[220:223], v[188:191], v[104:107]
    v_mfma_f32_16x16x32_bf16 v[132:135], v[220:223], v[192:195], v[132:135]
    s_waitcnt lgkmcnt(0)
    s_nop 7
    v_pk_fma_f32 v[24:25], v[164:165], v[136:137], v[24:25] op_sel_hi:[0,1,1] neg_lo:[1,0,0] neg_hi:[1,0,0]
    v_pk_fma_f32 v[26:27], v[164:165], v[138:139], v[26:27] op_sel_hi:[0,1,1] neg_lo:[1,0,0] neg_hi:[1,0,0]
    v_pk_fma_f32 v[28:29], v[164:165], v[140:141], v[28:29] op_sel_hi:[0,1,1] neg_lo:[1,0,0] neg_hi:[1,0,0]
    v_pk_fma_f32 v[30:31], v[164:165], v[142:143], v[30:31] op_sel_hi:[0,1,1] neg_lo:[1,0,0] neg_hi:[1,0,0]
    v_pk_mul_f32 v[192:193], v[24:25], v[24:25]
    v_pk_mul_f32 v[194:195], v[26:27], v[26:27]
    v_pk_mul_f32 v[196:197], v[28:29], v[28:29]
    v_pk_mul_f32 v[198:199], v[30:31], v[30:31]
    v_pk_fma_f32 v[192:193], v[192:193], v[166:167], v[166:167] op_sel:[0,1,0] op_sel_hi:[1,1,0]
    v_pk_fma_f32 v[194:195], v[194:195], v[166:167], v[166:167] op_sel:[0,1,0] op_sel_hi:[1,1,0]
    v_pk_fma_f32 v[196:197], v[196:197], v[166:167], v[166:167] op_sel:[0,1,0] op_sel_hi:[1,1,0]
    v_pk_fma_f32 v[198:199], v[198:199], v[166:167], v[166:167] op_sel:[0,1,0] op_sel_hi:[1,1,0]
    v_pk_mul_f32 v[192:193], v[192:193], v[24:25]
    v_pk_mul_f32 v[194:195], v[194:195], v[26:27]
    v_pk_mul_f32 v[196:197], v[196:197], v[28:29]
    v_pk_mul_f32 v[198:199], v[198:199], v[30:31]
    v_exp_f32 v192, v192
    v_exp_f32 v193, v193
    v_exp_f32 v194, v194
    v_exp_f32 v195, v195
    v_exp_f32 v196, v196
    v_exp_f32 v197, v197
    v_exp_f32 v198, v198
    v_exp_f32 v199, v199
    v_pk_fma_f32 v[192:193], v[192:193], v[164:165], v[164:165] op_sel:[0,1,1] op_sel_hi:[1,1,1]
    v_pk_fma_f32 v[194:195], v[194:195], v[164:165], v[164:165] op_sel:[0,1,1] op_sel_hi:[1,1,1]
    v_pk_fma_f32 v[196:197], v[196:197], v[164:165], v[164:165] op_sel:[0,1,1] op_sel_hi:[1,1,1]
    v_pk_fma_f32 v[198:199], v[198:199], v[164:165], v[164:165] op_sel:[0,1,1] op_sel_hi:[1,1,1]
    v_rcp_f32 v192, v192
    v_rcp_f32 v193, v193
    v_rcp_f32 v194, v194
    v_rcp_f32 v195, v195
    v_rcp_f32 v196, v196
    v_rcp_f32 v197, v197
    v_rcp_f32 v198, v198
    v_rcp_f32 v199, v199
    v_pk_mul_f32 v[24:25], v[24:25], v[192:193]
    v_pk_mul_f32 v[26:27], v[26:27], v[194:195]
    v_pk_mul_f32 v[28:29], v[28:29], v[196:197]
    v_pk_mul_f32 v[30:31], v[30:31], v[198:199]
    v_cvt_pk_bf16_f32 v24, v24, v25
    v_cvt_pk_bf16_f32 v25, v26, v27
    v_cvt_pk_bf16_f32 v26, v28, v29
    v_cvt_pk_bf16_f32 v27, v30, v31
    ds_write_b128 v22, v[24:27] offset:0
    s_add_u32 s36, s44, 0
    buffer_store_dwordx4 v[24:27], v2, s[16:19], s36 offen sc1
    v_pk_fma_f32 v[52:53], v[168:169], v[136:137], v[52:53] op_sel_hi:[0,1,1] neg_lo:[1,0,0] neg_hi:[1,0,0]
    v_pk_fma_f32 v[54:55], v[168:169], v[138:139], v[54:55] op_sel_hi:[0,1,1] neg_lo:[1,0,0] neg_hi:[1,0,0]
    v_pk_fma_f32 v[56:57], v[168:169], v[140:141], v[56:57] op_sel_hi:[0,1,1] neg_lo:[1,0,0] neg_hi:[1,0,0]
    v_pk_fma_f32 v[58:59], v[168:169], v[142:143], v[58:59] op_sel_hi:[0,1,1] neg_lo:[1,0,0] neg_hi:[1,0,0]
    v_pk_mul_f32 v[192:193], v[52:53], v[52:53]
    v_pk_mul_f32 v[194:195], v[54:55], v[54:55]
    v_pk_mul_f32 v[196:197], v[56:57], v[56:57]
    v_pk_mul_f32 v[198:199], v[58:59], v[58:59]
    v_pk_fma_f32 v[192:193], v[192:193], v[170:171], v[170:171] op_sel:[0,1,0] op_sel_hi:[1,1,0]
    v_pk_fma_f32 v[194:195], v[194:195], v[170:171], v[170:171] op_sel:[0,1,0] op_sel_hi:[1,1,0]
    v_pk_fma_f32 v[196:197], v[196:197], v[170:171], v[170:171] op_sel:[0,1,0] op_sel_hi:[1,1,0]
    v_pk_fma_f32 v[198:199], v[198:199], v[170:171], v[170:171] op_sel:[0,1,0] op_sel_hi:[1,1,0]
    v_pk_mul_f32 v[192:193], v[192:193], v[52:53]
    v_pk_mul_f32 v[194:195], v[194:195], v[54:55]
    v_pk_mul_f32 v[196:197], v[196:197], v[56:57]
    v_pk_mul_f32 v[198:199], v[198:199], v[58:59]
    v_exp_f32 v192, v192
    v_exp_f32 v193, v193
    v_exp_f32 v194, v194
    v_exp_f32 v195, v195
    v_exp_f32 v196, v196
    v_exp_f32 v197, v197
    v_exp_f32 v198, v198
    v_exp_f32 v199, v199
    v_pk_fma_f32 v[192:193], v[192:193], v[168:169], v[168:169] op_sel:[0,1,1] op_sel_hi:[1,1,1]
    v_pk_fma_f32 v[194:195], v[194:195], v[168:169], v[168:169] op_sel:[0,1,1] op_sel_hi:[1,1,1]
    v_pk_fma_f32 v[196:197], v[196:197], v[168:169], v[168:169] op_sel:[0,1,1] op_sel_hi:[1,1,1]
    v_pk_fma_f32 v[198:199], v[198:199], v[168:169], v[168:169] op_sel:[0,1,1] op_sel_hi:[1,1,1]
    v_rcp_f32 v192, v192
    v_rcp_f32 v193, v193
    v_rcp_f32 v194, v194
    v_rcp_f32 v195, v195
    v_rcp_f32 v196, v196
    v_rcp_f32 v197, v197
    v_rcp_f32 v198, v198
    v_rcp_f32 v199, v199
    v_pk_mul_f32 v[52:53], v[52:53], v[192:193]
    v_pk_mul_f32 v[54:55], v[54:55], v[194:195]
    v_pk_mul_f32 v[56:57], v[56:57], v[196:197]
    v_pk_mul_f32 v[58:59], v[58:59], v[198:199]
    v_cvt_pk_bf16_f32 v52, v52, v53
    v_cvt_pk_bf16_f32 v53, v54, v55
    v_cvt_pk_bf16_f32 v54, v56, v57
    v_cvt_pk_bf16_f32 v55, v58, v59
    ds_write_b128 v22, v[52:55] offset:2048
    s_add_u32 s36, s44, 229376
    buffer_store_dwordx4 v[52:55], v2, s[16:19], s36 offen sc1
    v_pk_fma_f32 v[80:81], v[172:173], v[136:137], v[80:81] op_sel_hi:[0,1,1] neg_lo:[1,0,0] neg_hi:[1,0,0]
    v_pk_fma_f32 v[82:83], v[172:173], v[138:139], v[82:83] op_sel_hi:[0,1,1] neg_lo:[1,0,0] neg_hi:[1,0,0]
    v_pk_fma_f32 v[84:85], v[172:173], v[140:141], v[84:85] op_sel_hi:[0,1,1] neg_lo:[1,0,0] neg_hi:[1,0,0]
    v_pk_fma_f32 v[86:87], v[172:173], v[142:143], v[86:87] op_sel_hi:[0,1,1] neg_lo:[1,0,0] neg_hi:[1,0,0]
    v_pk_mul_f32 v[192:193], v[80:81], v[80:81]
    v_pk_mul_f32 v[194:195], v[82:83], v[82:83]
    v_pk_mul_f32 v[196:197], v[84:85], v[84:85]
    v_pk_mul_f32 v[198:199], v[86:87], v[86:87]
    v_pk_fma_f32 v[192:193], v[192:193], v[174:175], v[174:175] op_sel:[0,1,0] op_sel_hi:[1,1,0]
    v_pk_fma_f32 v[194:195], v[194:195], v[174:175], v[174:175] op_sel:[0,1,0] op_sel_hi:[1,1,0]
    v_pk_fma_f32 v[196:197], v[196:197], v[174:175], v[174:175] op_sel:[0,1,0] op_sel_hi:[1,1,0]
    v_pk_fma_f32 v[198:199], v[198:199], v[174:175], v[174:175] op_sel:[0,1,0] op_sel_hi:[1,1,0]
    v_pk_mul_f32 v[192:193], v[192:193], v[80:81]
    v_pk_mul_f32 v[194:195], v[194:195], v[82:83]
    v_pk_mul_f32 v[196:197], v[196:197], v[84:85]
    v_pk_mul_f32 v[198:199], v[198:199], v[86:87]
    v_exp_f32 v192, v192
    v_exp_f32 v193, v193
    v_exp_f32 v194, v194
    v_exp_f32 v195, v195
    v_exp_f32 v196, v196
    v_exp_f32 v197, v197
    v_exp_f32 v198, v198
    v_exp_f32 v199, v199
    v_pk_fma_f32 v[192:193], v[192:193], v[172:173], v[172:173] op_sel:[0,1,1] op_sel_hi:[1,1,1]
    v_pk_fma_f32 v[194:195], v[194:195], v[172:173], v[172:173] op_sel:[0,1,1] op_sel_hi:[1,1,1]
    v_pk_fma_f32 v[196:197], v[196:197], v[172:173], v[172:173] op_sel:[0,1,1] op_sel_hi:[1,1,1]
    v_pk_fma_f32 v[198:199], v[198:199], v[172:173], v[172:173] op_sel:[0,1,1] op_sel_hi:[1,1,1]
    v_rcp_f32 v192, v192
    v_rcp_f32 v193, v193
    v_rcp_f32 v194, v194
    v_rcp_f32 v195, v195
    v_rcp_f32 v196, v196
    v_rcp_f32 v197, v197
    v_rcp_f32 v198, v198
    v_rcp_f32 v199, v199
    v_pk_mul_f32 v[80:81], v[80:81], v[192:193]
    v_pk_mul_f32 v[82:83], v[82:83], v[194:195]
    v_pk_mul_f32 v[84:85], v[84:85], v[196:197]
    v_pk_mul_f32 v[86:87], v[86:87], v[198:199]
    v_cvt_pk_bf16_f32 v80, v80, v81
    v_cvt_pk_bf16_f32 v81, v82, v83
    v_cvt_pk_bf16_f32 v82, v84, v85
    v_cvt_pk_bf16_f32 v83, v86, v87
    ds_write_b128 v23, v[80:83] offset:0
    s_add_u32 s36, s44, 458752
    buffer_store_dwordx4 v[80:83], v2, s[16:19], s36 offen sc1
    v_pk_fma_f32 v[108:109], v[176:177], v[136:137], v[108:109] op_sel_hi:[0,1,1] neg_lo:[1,0,0] neg_hi:[1,0,0]
    v_pk_fma_f32 v[110:111], v[176:177], v[138:139], v[110:111] op_sel_hi:[0,1,1] neg_lo:[1,0,0] neg_hi:[1,0,0]
    v_pk_fma_f32 v[112:113], v[176:177], v[140:141], v[112:113] op_sel_hi:[0,1,1] neg_lo:[1,0,0] neg_hi:[1,0,0]
    v_pk_fma_f32 v[114:115], v[176:177], v[142:143], v[114:115] op_sel_hi:[0,1,1] neg_lo:[1,0,0] neg_hi:[1,0,0]
    v_pk_mul_f32 v[192:193], v[108:109], v[108:109]
    v_pk_mul_f32 v[194:195], v[110:111], v[110:111]
    v_pk_mul_f32 v[196:197], v[112:113], v[112:113]
    v_pk_mul_f32 v[198:199], v[114:115], v[114:115]
    v_pk_fma_f32 v[192:193], v[192:193], v[178:179], v[178:179] op_sel:[0,1,0] op_sel_hi:[1,1,0]
    v_pk_fma_f32 v[194:195], v[194:195], v[178:179], v[178:179] op_sel:[0,1,0] op_sel_hi:[1,1,0]
    v_pk_fma_f32 v[196:197], v[196:197], v[178:179], v[178:179] op_sel:[0,1,0] op_sel_hi:[1,1,0]
    v_pk_fma_f32 v[198:199], v[198:199], v[178:179], v[178:179] op_sel:[0,1,0] op_sel_hi:[1,1,0]
    v_pk_mul_f32 v[192:193], v[192:193], v[108:109]
    v_pk_mul_f32 v[194:195], v[194:195], v[110:111]
    v_pk_mul_f32 v[196:197], v[196:197], v[112:113]
    v_pk_mul_f32 v[198:199], v[198:199], v[114:115]
    v_exp_f32 v192, v192
    v_exp_f32 v193, v193
    v_exp_f32 v194, v194
    v_exp_f32 v195, v195
    v_exp_f32 v196, v196
    v_exp_f32 v197, v197
    v_exp_f32 v198, v198
    v_exp_f32 v199, v199
    v_pk_fma_f32 v[192:193], v[192:193], v[176:177], v[176:177] op_sel:[0,1,1] op_sel_hi:[1,1,1]
    v_pk_fma_f32 v[194:195], v[194:195], v[176:177], v[176:177] op_sel:[0,1,1] op_sel_hi:[1,1,1]
    v_pk_fma_f32 v[196:197], v[196:197], v[176:177], v[176:177] op_sel:[0,1,1] op_sel_hi:[1,1,1]
    v_pk_fma_f32 v[198:199], v[198:199], v[176:177], v[176:177] op_sel:[0,1,1] op_sel_hi:[1,1,1]
    v_rcp_f32 v192, v192
    v_rcp_f32 v193, v193
    v_rcp_f32 v194, v194
    v_rcp_f32 v195, v195
    v_rcp_f32 v196, v196
    v_rcp_f32 v197, v197
    v_rcp_f32 v198, v198
    v_rcp_f32 v199, v199
    v_pk_mul_f32 v[108:109], v[108:109], v[192:193]
    v_pk_mul_f32 v[110:111], v[110:111], v[194:195]
    v_pk_mul_f32 v[112:113], v[112:113], v[196:197]
    v_pk_mul_f32 v[114:115], v[114:115], v[198:199]
    v_cvt_pk_bf16_f32 v108, v108, v109
    v_cvt_pk_bf16_f32 v109, v110, v111
    v_cvt_pk_bf16_f32 v110, v112, v113
    v_cvt_pk_bf16_f32 v111, v114, v115
    ds_write_b128 v23, v[108:111] offset:2048
    s_add_u32 s36, s44, 688128
    buffer_store_dwordx4 v[108:111], v2, s[16:19], s36 offen sc1
    v_pk_fma_f32 v[32:33], v[164:165], v[144:145], v[32:33] op_sel_hi:[0,1,1] neg_lo:[1,0,0] neg_hi:[1,0,0]
    v_pk_fma_f32 v[34:35], v[164:165], v[146:147], v[34:35] op_sel_hi:[0,1,1] neg_lo:[1,0,0] neg_hi:[1,0,0]
    v_pk_fma_f32 v[36:37], v[164:165], v[148:149], v[36:37] op_sel_hi:[0,1,1] neg_lo:[1,0,0] neg_hi:[1,0,0]
    v_pk_fma_f32 v[38:39], v[164:165], v[150:151], v[38:39] op_sel_hi:[0,1,1] neg_lo:[1,0,0] neg_hi:[1,0,0]
    v_pk_mul_f32 v[192:193], v[32:33], v[32:33]
    v_pk_mul_f32 v[194:195], v[34:35], v[34:35]
    v_pk_mul_f32 v[196:197], v[36:37], v[36:37]
    v_pk_mul_f32 v[198:199], v[38:39], v[38:39]
    v_pk_fma_f32 v[192:193], v[192:193], v[166:167], v[166:167] op_sel:[0,1,0] op_sel_hi:[1,1,0]
    v_pk_fma_f32 v[194:195], v[194:195], v[166:167], v[166:167] op_sel:[0,1,0] op_sel_hi:[1,1,0]
    v_pk_fma_f32 v[196:197], v[196:197], v[166:167], v[166:167] op_sel:[0,1,0] op_sel_hi:[1,1,0]
    v_pk_fma_f32 v[198:199], v[198:199], v[166:167], v[166:167] op_sel:[0,1,0] op_sel_hi:[1,1,0]
    v_pk_mul_f32 v[192:193], v[192:193], v[32:33]
    v_pk_mul_f32 v[194:195], v[194:195], v[34:35]
    v_pk_mul_f32 v[196:197], v[196:197], v[36:37]
    v_pk_mul_f32 v[198:199], v[198:199], v[38:39]
    v_exp_f32 v192, v192
    v_exp_f32 v193, v193
    v_exp_f32 v194, v194
    v_exp_f32 v195, v195
    v_exp_f32 v196, v196
    v_exp_f32 v197, v197
    v_exp_f32 v198, v198
    v_exp_f32 v199, v199
    v_pk_fma_f32 v[192:193], v[192:193], v[164:165], v[164:165] op_sel:[0,1,1] op_sel_hi:[1,1,1]
    v_pk_fma_f32 v[194:195], v[194:195], v[164:165], v[164:165] op_sel:[0,1,1] op_sel_hi:[1,1,1]
    v_pk_fma_f32 v[196:197], v[196:197], v[164:165], v[164:165] op_sel:[0,1,1] op_sel_hi:[1,1,1]
    v_pk_fma_f32 v[198:199], v[198:199], v[164:165], v[164:165] op_sel:[0,1,1] op_sel_hi:[1,1,1]
    v_rcp_f32 v192, v192
    v_rcp_f32 v193, v193
    v_rcp_f32 v194, v194
    v_rcp_f32 v195, v195
    v_rcp_f32 v196, v196
    v_rcp_f32 v197, v197
    v_rcp_f32 v198, v198
    v_rcp_f32 v199, v199
    v_pk_mul_f32 v[32:33], v[32:33], v[192:193]
    v_pk_mul_f32 v[34:35], v[34:35], v[194:195]
    v_pk_mul_f32 v[36:37], v[36:37], v[196:197]
    v_pk_mul_f32 v[38:39], v[38:39], v[198:199]
    v_cvt_pk_bf16_f32 v32, v32, v33
    v_cvt_pk_bf16_f32 v33, v34, v35
    v_cvt_pk_bf16_f32 v34, v36, v37
    v_cvt_pk_bf16_f32 v35, v38, v39
    ds_write_b128 v22, v[32:35] offset:16384
    v_pk_fma_f32 v[60:61], v[168:169], v[144:145], v[60:61] op_sel_hi:[0,1,1] neg_lo:[1,0,0] neg_hi:[1,0,0]
    v_pk_fma_f32 v[62:63], v[168:169], v[146:147], v[62:63] op_sel_hi:[0,1,1] neg_lo:[1,0,0] neg_hi:[1,0,0]
    v_pk_fma_f32 v[64:65], v[168:169], v[148:149], v[64:65] op_sel_hi:[0,1,1] neg_lo:[1,0,0] neg_hi:[1,0,0]
    v_pk_fma_f32 v[66:67], v[168:169], v[150:151], v[66:67] op_sel_hi:[0,1,1] neg_lo:[1,0,0] neg_hi:[1,0,0]
    v_pk_mul_f32 v[192:193], v[60:61], v[60:61]
    v_pk_mul_f32 v[194:195], v[62:63], v[62:63]
    v_pk_mul_f32 v[196:197], v[64:65], v[64:65]
    v_pk_mul_f32 v[198:199], v[66:67], v[66:67]
    v_pk_fma_f32 v[192:193], v[192:193], v[170:171], v[170:171] op_sel:[0,1,0] op_sel_hi:[1,1,0]
    v_pk_fma_f32 v[194:195], v[194:195], v[170:171], v[170:171] op_sel:[0,1,0] op_sel_hi:[1,1,0]
    v_pk_fma_f32 v[196:197], v[196:197], v[170:171], v[170:171] op_sel:[0,1,0] op_sel_hi:[1,1,0]
    v_pk_fma_f32 v[198:199], v[198:199], v[170:171], v[170:171] op_sel:[0,1,0] op_sel_hi:[1,1,0]
    v_pk_mul_f32 v[192:193], v[192:193], v[60:61]
    v_pk_mul_f32 v[194:195], v[194:195], v[62:63]
    v_pk_mul_f32 v[196:197], v[196:197], v[64:65]
    v_pk_mul_f32 v[198:199], v[198:199], v[66:67]
    v_exp_f32 v192, v192
    v_exp_f32 v193, v193
    v_exp_f32 v194, v194
    v_exp_f32 v195, v195
    v_exp_f32 v196, v196
    v_exp_f32 v197, v197
    v_exp_f32 v198, v198
    v_exp_f32 v199, v199
    v_pk_fma_f32 v[192:193], v[192:193], v[168:169], v[168:169] op_sel:[0,1,1] op_sel_hi:[1,1,1]
    v_pk_fma_f32 v[194:195], v[194:195], v[168:169], v[168:169] op_sel:[0,1,1] op_sel_hi:[1,1,1]
    v_pk_fma_f32 v[196:197], v[196:197], v[168:169], v[168:169] op_sel:[0,1,1] op_sel_hi:[1,1,1]
    v_pk_fma_f32 v[198:199], v[198:199], v[168:169], v[168:169] op_sel:[0,1,1] op_sel_hi:[1,1,1]
    v_rcp_f32 v192, v192
    v_rcp_f32 v193, v193
    v_rcp_f32 v194, v194
    v_rcp_f32 v195, v195
    v_rcp_f32 v196, v196
    v_rcp_f32 v197, v197
    v_rcp_f32 v198, v198
    v_rcp_f32 v199, v199
    v_pk_mul_f32 v[60:61], v[60:61], v[192:193]
    v_pk_mul_f32 v[62:63], v[62:63], v[194:195]
    v_pk_mul_f32 v[64:65], v[64:65], v[196:197]
    v_pk_mul_f32 v[66:67], v[66:67], v[198:199]
    v_cvt_pk_bf16_f32 v60, v60, v61
    v_cvt_pk_bf16_f32 v61, v62, v63
    v_cvt_pk_bf16_f32 v62, v64, v65
    v_cvt_pk_bf16_f32 v63, v66, v67
    ds_write_b128 v22, v[60:63] offset:18432
    v_pk_fma_f32 v[88:89], v[172:173], v[144:145], v[88:89] op_sel_hi:[0,1,1] neg_lo:[1,0,0] neg_hi:[1,0,0]
    v_pk_fma_f32 v[90:91], v[172:173], v[146:147], v[90:91] op_sel_hi:[0,1,1] neg_lo:[1,0,0] neg_hi:[1,0,0]
    v_pk_fma_f32 v[92:93], v[172:173], v[148:149], v[92:93] op_sel_hi:[0,1,1] neg_lo:[1,0,0] neg_hi:[1,0,0]
    v_pk_fma_f32 v[94:95], v[172:173], v[150:151], v[94:95] op_sel_hi:[0,1,1] neg_lo:[1,0,0] neg_hi:[1,0,0]
    v_pk_mul_f32 v[192:193], v[88:89], v[88:89]
    v_pk_mul_f32 v[194:195], v[90:91], v[90:91]
    v_pk_mul_f32 v[196:197], v[92:93], v[92:93]
    v_pk_mul_f32 v[198:199], v[94:95], v[94:95]
    v_pk_fma_f32 v[192:193], v[192:193], v[174:175], v[174:175] op_sel:[0,1,0] op_sel_hi:[1,1,0]
    v_pk_fma_f32 v[194:195], v[194:195], v[174:175], v[174:175] op_sel:[0,1,0] op_sel_hi:[1,1,0]
    v_pk_fma_f32 v[196:197], v[196:197], v[174:175], v[174:175] op_sel:[0,1,0] op_sel_hi:[1,1,0]
    v_pk_fma_f32 v[198:199], v[198:199], v[174:175], v[174:175] op_sel:[0,1,0] op_sel_hi:[1,1,0]
    v_pk_mul_f32 v[192:193], v[192:193], v[88:89]
    v_pk_mul_f32 v[194:195], v[194:195], v[90:91]
    v_pk_mul_f32 v[196:197], v[196:197], v[92:93]
    v_pk_mul_f32 v[198:199], v[198:199], v[94:95]
    v_exp_f32 v192, v192
    v_exp_f32 v193, v193
    v_exp_f32 v194, v194
    v_exp_f32 v195, v195
    v_exp_f32 v196, v196
    v_exp_f32 v197, v197
    v_exp_f32 v198, v198
    v_exp_f32 v199, v199
    v_pk_fma_f32 v[192:193], v[192:193], v[172:173], v[172:173] op_sel:[0,1,1] op_sel_hi:[1,1,1]
    v_pk_fma_f32 v[194:195], v[194:195], v[172:173], v[172:173] op_sel:[0,1,1] op_sel_hi:[1,1,1]
    v_pk_fma_f32 v[196:197], v[196:197], v[172:173], v[172:173] op_sel:[0,1,1] op_sel_hi:[1,1,1]
    v_pk_fma_f32 v[198:199], v[198:199], v[172:173], v[172:173] op_sel:[0,1,1] op_sel_hi:[1,1,1]
    v_rcp_f32 v192, v192
    v_rcp_f32 v193, v193
    v_rcp_f32 v194, v194
    v_rcp_f32 v195, v195
    v_rcp_f32 v196, v196
    v_rcp_f32 v197, v197
    v_rcp_f32 v198, v198
    v_rcp_f32 v199, v199
    v_pk_mul_f32 v[88:89], v[88:89], v[192:193]
    v_pk_mul_f32 v[90:91], v[90:91], v[194:195]
    v_pk_mul_f32 v[92:93], v[92:93], v[196:197]
    v_pk_mul_f32 v[94:95], v[94:95], v[198:199]
    v_cvt_pk_bf16_f32 v88, v88, v89
    v_cvt_pk_bf16_f32 v89, v90, v91
    v_cvt_pk_bf16_f32 v90, v92, v93
    v_cvt_pk_bf16_f32 v91, v94, v95
    ds_write_b128 v23, v[88:91] offset:16384
    s_waitcnt vmcnt(0)
    buffer_atomic_add v8, v9, s[56:59], s49 offen offset:0 sc1
    buffer_load_dwordx4 v[180:183], v255, s[84:87], s13 offen offset:0 sc1
    buffer_load_dwordx4 v[184:187], v2, s[88:91], s40 offen offset:0 sc1
    v_pk_fma_f32 v[116:117], v[176:177], v[144:145], v[116:117] op_sel_hi:[0,1,1] neg_lo:[1,0,0] neg_hi:[1,0,0]
    v_pk_fma_f32 v[118:119], v[176:177], v[146:147], v[118:119] op_sel_hi:[0,1,1] neg_lo:[1,0,0] neg_hi:[1,0,0]
    v_pk_fma_f32 v[120:121], v[176:177], v[148:149], v[120:121] op_sel_hi:[0,1,1] neg_lo:[1,0,0] neg_hi:[1,0,0]
    v_pk_fma_f32 v[122:123], v[176:177], v[150:151], v[122:123] op_sel_hi:[0,1,1] neg_lo:[1,0,0] neg_hi:[1,0,0]
    v_pk_mul_f32 v[192:193], v[116:117], v[116:117]
    v_pk_mul_f32 v[194:195], v[118:119], v[118:119]
    v_pk_mul_f32 v[196:197], v[120:121], v[120:121]
    v_pk_mul_f32 v[198:199], v[122:123], v[122:123]
    v_pk_fma_f32 v[192:193], v[192:193], v[178:179], v[178:179] op_sel:[0,1,0] op_sel_hi:[1,1,0]
    v_pk_fma_f32 v[194:195], v[194:195], v[178:179], v[178:179] op_sel:[0,1,0] op_sel_hi:[1,1,0]
    v_pk_fma_f32 v[196:197], v[196:197], v[178:179], v[178:179] op_sel:[0,1,0] op_sel_hi:[1,1,0]
    v_pk_fma_f32 v[198:199], v[198:199], v[178:179], v[178:179] op_sel:[0,1,0] op_sel_hi:[1,1,0]
    v_pk_mul_f32 v[192:193], v[192:193], v[116:117]
    v_pk_mul_f32 v[194:195], v[194:195], v[118:119]
    v_pk_mul_f32 v[196:197], v[196:197], v[120:121]
    v_pk_mul_f32 v[198:199], v[198:199], v[122:123]
    v_exp_f32 v192, v192
    v_exp_f32 v193, v193
    v_exp_f32 v194, v194
    v_exp_f32 v195, v195
    v_exp_f32 v196, v196
    v_exp_f32 v197, v197
    v_exp_f32 v198, v198
    v_exp_f32 v199, v199
    v_pk_fma_f32 v[192:193], v[192:193], v[176:177], v[176:177] op_sel:[0,1,1] op_sel_hi:[1,1,1]
    v_pk_fma_f32 v[194:195], v[194:195], v[176:177], v[176:177] op_sel:[0,1,1] op_sel_hi:[1,1,1]
    v_pk_fma_f32 v[196:197], v[196:197], v[176:177], v[176:177] op_sel:[0,1,1] op_sel_hi:[1,1,1]
    v_pk_fma_f32 v[198:199], v[198:199], v[176:177], v[176:177] op_sel:[0,1,1] op_sel_hi:[1,1,1]
    v_rcp_f32 v192, v192
    v_rcp_f32 v193, v193
    v_rcp_f32 v194, v194
    v_rcp_f32 v195, v195
    v_rcp_f32 v196, v196
    v_rcp_f32 v197, v197
    v_rcp_f32 v198, v198
    v_rcp_f32 v199, v199
    v_pk_mul_f32 v[116:117], v[116:117], v[192:193]
    v_pk_mul_f32 v[118:119], v[118:119], v[194:195]
    v_pk_mul_f32 v[120:121], v[120:121], v[196:197]
    v_pk_mul_f32 v[122:123], v[122:123], v[198:199]
    v_cvt_pk_bf16_f32 v116, v116, v117
    v_cvt_pk_bf16_f32 v117, v118, v119
    v_cvt_pk_bf16_f32 v118, v120, v121
    v_cvt_pk_bf16_f32 v119, v122, v123
    ds_write_b128 v23, v[116:119] offset:18432
    buffer_load_dwordx4 v[200:203], v255, s[84:87], s13 offen offset:64 sc1
    buffer_load_dwordx4 v[204:207], v2, s[88:91], s40 offen offset:1024 sc1
    v_pk_fma_f32 v[40:41], v[164:165], v[152:153], v[40:41] op_sel_hi:[0,1,1] neg_lo:[1,0,0] neg_hi:[1,0,0]
    v_pk_fma_f32 v[42:43], v[164:165], v[154:155], v[42:43] op_sel_hi:[0,1,1] neg_lo:[1,0,0] neg_hi:[1,0,0]
    v_pk_fma_f32 v[44:45], v[164:165], v[156:157], v[44:45] op_sel_hi:[0,1,1] neg_lo:[1,0,0] neg_hi:[1,0,0]
    v_pk_fma_f32 v[46:47], v[164:165], v[158:159], v[46:47] op_sel_hi:[0,1,1] neg_lo:[1,0,0] neg_hi:[1,0,0]
    v_pk_mul_f32 v[192:193], v[40:41], v[40:41]
    v_pk_mul_f32 v[194:195], v[42:43], v[42:43]
    v_pk_mul_f32 v[196:197], v[44:45], v[44:45]
    v_pk_mul_f32 v[198:199], v[46:47], v[46:47]
    v_pk_fma_f32 v[192:193], v[192:193], v[166:167], v[166:167] op_sel:[0,1,0] op_sel_hi:[1,1,0]
    v_pk_fma_f32 v[194:195], v[194:195], v[166:167], v[166:167] op_sel:[0,1,0] op_sel_hi:[1,1,0]
    v_pk_fma_f32 v[196:197], v[196:197], v[166:167], v[166:167] op_sel:[0,1,0] op_sel_hi:[1,1,0]
    v_pk_fma_f32 v[198:199], v[198:199], v[166:167], v[166:167] op_sel:[0,1,0] op_sel_hi:[1,1,0]
    v_pk_mul_f32 v[192:193], v[192:193], v[40:41]
    v_pk_mul_f32 v[194:195], v[194:195], v[42:43]
    v_pk_mul_f32 v[196:197], v[196:197], v[44:45]
    v_pk_mul_f32 v[198:199], v[198:199], v[46:47]
    v_exp_f32 v192, v192
    v_exp_f32 v193, v193
    v_exp_f32 v194, v194
    v_exp_f32 v195, v195
    v_exp_f32 v196, v196
    v_exp_f32 v197, v197
    v_exp_f32 v198, v198
    v_exp_f32 v199, v199
    v_pk_fma_f32 v[192:193], v[192:193], v[164:165], v[164:165] op_sel:[0,1,1] op_sel_hi:[1,1,1]
    v_pk_fma_f32 v[194:195], v[194:195], v[164:165], v[164:165] op_sel:[0,1,1] op_sel_hi:[1,1,1]
    v_pk_fma_f32 v[196:197], v[196:197], v[164:165], v[164:165] op_sel:[0,1,1] op_sel_hi:[1,1,1]
    v_pk_fma_f32 v[198:199], v[198:199], v[164:165], v[164:165] op_sel:[0,1,1] op_sel_hi:[1,1,1]
    v_rcp_f32 v192, v192
    v_rcp_f32 v193, v193
    v_rcp_f32 v194, v194
    v_rcp_f32 v195, v195
    v_rcp_f32 v196, v196
    v_rcp_f32 v197, v197
    v_rcp_f32 v198, v198
    v_rcp_f32 v199, v199
    v_pk_mul_f32 v[40:41], v[40:41], v[192:193]
    v_pk_mul_f32 v[42:43], v[42:43], v[194:195]
    v_pk_mul_f32 v[44:45], v[44:45], v[196:197]
    v_pk_mul_f32 v[46:47], v[46:47], v[198:199]
    v_cvt_pk_bf16_f32 v230, v40, v41
    v_cvt_pk_bf16_f32 v231, v42, v43
    v_cvt_pk_bf16_f32 v232, v44, v45
    v_cvt_pk_bf16_f32 v233, v46, v47
    ds_write_b128 v22, v[230:233] offset:32768
    buffer_load_dwordx4 v[208:211], v255, s[84:87], s14 offen offset:0 sc1
    buffer_load_dwordx4 v[212:215], v2, s[88:91], s12 offen offset:0 sc1
    v_pk_fma_f32 v[68:69], v[168:169], v[152:153], v[68:69] op_sel_hi:[0,1,1] neg_lo:[1,0,0] neg_hi:[1,0,0]
    v_pk_fma_f32 v[70:71], v[168:169], v[154:155], v[70:71] op_sel_hi:[0,1,1] neg_lo:[1,0,0] neg_hi:[1,0,0]
    v_pk_fma_f32 v[72:73], v[168:169], v[156:157], v[72:73] op_sel_hi:[0,1,1] neg_lo:[1,0,0] neg_hi:[1,0,0]
    v_pk_fma_f32 v[74:75], v[168:169], v[158:159], v[74:75] op_sel_hi:[0,1,1] neg_lo:[1,0,0] neg_hi:[1,0,0]
    v_pk_mul_f32 v[192:193], v[68:69], v[68:69]
    v_pk_mul_f32 v[194:195], v[70:71], v[70:71]
    v_pk_mul_f32 v[196:197], v[72:73], v[72:73]
    v_pk_mul_f32 v[198:199], v[74:75], v[74:75]
    v_pk_fma_f32 v[192:193], v[192:193], v[170:171], v[170:171] op_sel:[0,1,0] op_sel_hi:[1,1,0]
    v_pk_fma_f32 v[194:195], v[194:195], v[170:171], v[170:171] op_sel:[0,1,0] op_sel_hi:[1,1,0]
    v_pk_fma_f32 v[196:197], v[196:197], v[170:171], v[170:171] op_sel:[0,1,0] op_sel_hi:[1,1,0]
    v_pk_fma_f32 v[198:199], v[198:199], v[170:171], v[170:171] op_sel:[0,1,0] op_sel_hi:[1,1,0]
    v_pk_mul_f32 v[192:193], v[192:193], v[68:69]
    v_pk_mul_f32 v[194:195], v[194:195], v[70:71]
    v_pk_mul_f32 v[196:197], v[196:197], v[72:73]
    v_pk_mul_f32 v[198:199], v[198:199], v[74:75]
    v_exp_f32 v192, v192
    v_exp_f32 v193, v193
    v_exp_f32 v194, v194
    v_exp_f32 v195, v195
    v_exp_f32 v196, v196
    v_exp_f32 v197, v197
    v_exp_f32 v198, v198
    v_exp_f32 v199, v199
    v_pk_fma_f32 v[192:193], v[192:193], v[168:169], v[168:169] op_sel:[0,1,1] op_sel_hi:[1,1,1]
    v_pk_fma_f32 v[194:195], v[194:195], v[168:169], v[168:169] op_sel:[0,1,1] op_sel_hi:[1,1,1]
    v_pk_fma_f32 v[196:197], v[196:197], v[168:169], v[168:169] op_sel:[0,1,1] op_sel_hi:[1,1,1]
    v_pk_fma_f32 v[198:199], v[198:199], v[168:169], v[168:169] op_sel:[0,1,1] op_sel_hi:[1,1,1]
    v_rcp_f32 v192, v192
    v_rcp_f32 v193, v193
    v_rcp_f32 v194, v194
    v_rcp_f32 v195, v195
    v_rcp_f32 v196, v196
    v_rcp_f32 v197, v197
    v_rcp_f32 v198, v198
    v_rcp_f32 v199, v199
    v_pk_mul_f32 v[68:69], v[68:69], v[192:193]
    v_pk_mul_f32 v[70:71], v[70:71], v[194:195]
    v_pk_mul_f32 v[72:73], v[72:73], v[196:197]
    v_pk_mul_f32 v[74:75], v[74:75], v[198:199]
    v_cvt_pk_bf16_f32 v234, v68, v69
    v_cvt_pk_bf16_f32 v235, v70, v71
    v_cvt_pk_bf16_f32 v236, v72, v73
    v_cvt_pk_bf16_f32 v237, v74, v75
    ds_write_b128 v22, v[234:237] offset:34816
    buffer_load_dwordx4 v[216:219], v255, s[84:87], s14 offen offset:64 sc1
    buffer_load_dwordx4 v[220:223], v2, s[88:91], s12 offen offset:1024 sc1
    v_pk_fma_f32 v[96:97], v[172:173], v[152:153], v[96:97] op_sel_hi:[0,1,1] neg_lo:[1,0,0] neg_hi:[1,0,0]
    v_pk_fma_f32 v[98:99], v[172:173], v[154:155], v[98:99] op_sel_hi:[0,1,1] neg_lo:[1,0,0] neg_hi:[1,0,0]
    v_pk_fma_f32 v[100:101], v[172:173], v[156:157], v[100:101] op_sel_hi:[0,1,1] neg_lo:[1,0,0] neg_hi:[1,0,0]
    v_pk_fma_f32 v[102:103], v[172:173], v[158:159], v[102:103] op_sel_hi:[0,1,1] neg_lo:[1,0,0] neg_hi:[1,0,0]
    v_pk_mul_f32 v[192:193], v[96:97], v[96:97]
    v_pk_mul_f32 v[194:195], v[98:99], v[98:99]
    v_pk_mul_f32 v[196:197], v[100:101], v[100:101]
    v_pk_mul_f32 v[198:199], v[102:103], v[102:103]
    v_pk_fma_f32 v[192:193], v[192:193], v[174:175], v[174:175] op_sel:[0,1,0] op_sel_hi:[1,1,0]
    v_pk_fma_f32 v[194:195], v[194:195], v[174:175], v[174:175] op_sel:[0,1,0] op_sel_hi:[1,1,0]
    v_pk_fma_f32 v[196:197], v[196:197], v[174:175], v[174:175] op_sel:[0,1,0] op_sel_hi:[1,1,0]
    v_pk_fma_f32 v[198:199], v[198:199], v[174:175], v[174:175] op_sel:[0,1,0] op_sel_hi:[1,1,0]
    v_pk_mul_f32 v[192:193], v[192:193], v[96:97]
    v_pk_mul_f32 v[194:195], v[194:195], v[98:99]
    v_pk_mul_f32 v[196:197], v[196:197], v[100:101]
    v_pk_mul_f32 v[198:199], v[198:199], v[102:103]
    v_exp_f32 v192, v192
    v_exp_f32 v193, v193
    v_exp_f32 v194, v194
    v_exp_f32 v195, v195
    v_exp_f32 v196, v196
    v_exp_f32 v197, v197
    v_exp_f32 v198, v198
    v_exp_f32 v199, v199
    v_pk_fma_f32 v[192:193], v[192:193], v[172:173], v[172:173] op_sel:[0,1,1] op_sel_hi:[1,1,1]
    v_pk_fma_f32 v[194:195], v[194:195], v[172:173], v[172:173] op_sel:[0,1,1] op_sel_hi:[1,1,1]
    v_pk_fma_f32 v[196:197], v[196:197], v[172:173], v[172:173] op_sel:[0,1,1] op_sel_hi:[1,1,1]
    v_pk_fma_f32 v[198:199], v[198:199], v[172:173], v[172:173] op_sel:[0,1,1] op_sel_hi:[1,1,1]
    v_rcp_f32 v192, v192
    v_rcp_f32 v193, v193
    v_rcp_f32 v194, v194
    v_rcp_f32 v195, v195
    v_rcp_f32 v196, v196
    v_rcp_f32 v197, v197
    v_rcp_f32 v198, v198
    v_rcp_f32 v199, v199
    v_pk_mul_f32 v[96:97], v[96:97], v[192:193]
    v_pk_mul_f32 v[98:99], v[98:99], v[194:195]
    v_pk_mul_f32 v[100:101], v[100:101], v[196:197]
    v_pk_mul_f32 v[102:103], v[102:103], v[198:199]
    v_cvt_pk_bf16_f32 v238, v96, v97
    v_cvt_pk_bf16_f32 v239, v98, v99
    v_cvt_pk_bf16_f32 v240, v100, v101
    v_cvt_pk_bf16_f32 v241, v102, v103
    ds_write_b128 v23, v[238:241] offset:32768
    v_pk_fma_f32 v[124:125], v[176:177], v[152:153], v[124:125] op_sel_hi:[0,1,1] neg_lo:[1,0,0] neg_hi:[1,0,0]
    v_pk_fma_f32 v[126:127], v[176:177], v[154:155], v[126:127] op_sel_hi:[0,1,1] neg_lo:[1,0,0] neg_hi:[1,0,0]
    v_pk_fma_f32 v[128:129], v[176:177], v[156:157], v[128:129] op_sel_hi:[0,1,1] neg_lo:[1,0,0] neg_hi:[1,0,0]
    v_pk_fma_f32 v[130:131], v[176:177], v[158:159], v[130:131] op_sel_hi:[0,1,1] neg_lo:[1,0,0] neg_hi:[1,0,0]
    v_pk_mul_f32 v[192:193], v[124:125], v[124:125]
    v_pk_mul_f32 v[194:195], v[126:127], v[126:127]
    v_pk_mul_f32 v[196:197], v[128:129], v[128:129]
    v_pk_mul_f32 v[198:199], v[130:131], v[130:131]
    v_pk_fma_f32 v[192:193], v[192:193], v[178:179], v[178:179] op_sel:[0,1,0] op_sel_hi:[1,1,0]
    v_pk_fma_f32 v[194:195], v[194:195], v[178:179], v[178:179] op_sel:[0,1,0] op_sel_hi:[1,1,0]
    v_pk_fma_f32 v[196:197], v[196:197], v[178:179], v[178:179] op_sel:[0,1,0] op_sel_hi:[1,1,0]
    v_pk_fma_f32 v[198:199], v[198:199], v[178:179], v[178:179] op_sel:[0,1,0] op_sel_hi:[1,1,0]
    v_pk_mul_f32 v[192:193], v[192:193], v[124:125]
    v_pk_mul_f32 v[194:195], v[194:195], v[126:127]
    v_pk_mul_f32 v[196:197], v[196:197], v[128:129]
    v_pk_mul_f32 v[198:199], v[198:199], v[130:131]
    v_exp_f32 v192, v192
    v_exp_f32 v193, v193
    v_exp_f32 v194, v194
    v_exp_f32 v195, v195
    v_exp_f32 v196, v196
    v_exp_f32 v197, v197
    v_exp_f32 v198, v198
    v_exp_f32 v199, v199
    v_pk_fma_f32 v[192:193], v[192:193], v[176:177], v[176:177] op_sel:[0,1,1] op_sel_hi:[1,1,1]
    v_pk_fma_f32 v[194:195], v[194:195], v[176:177], v[176:177] op_sel:[0,1,1] op_sel_hi:[1,1,1]
    v_pk_fma_f32 v[196:197], v[196:197], v[176:177], v[176:177] op_sel:[0,1,1] op_sel_hi:[1,1,1]
    v_pk_fma_f32 v[198:199], v[198:199], v[176:177], v[176:177] op_sel:[0,1,1] op_sel_hi:[1,1,1]
    v_rcp_f32 v192, v192
    v_rcp_f32 v193, v193
    v_rcp_f32 v194, v194
    v_rcp_f32 v195, v195
    v_rcp_f32 v196, v196
    v_rcp_f32 v197, v197
    v_rcp_f32 v198, v198
    v_rcp_f32 v199, v199
    v_pk_mul_f32 v[124:125], v[124:125], v[192:193]
    v_pk_mul_f32 v[126:127], v[126:127], v[194:195]
    v_pk_mul_f32 v[128:129], v[128:129], v[196:197]
    v_pk_mul_f32 v[130:131], v[130:131], v[198:199]
    v_cvt_pk_bf16_f32 v242, v124, v125
    v_cvt_pk_bf16_f32 v243, v126, v127
    v_cvt_pk_bf16_f32 v244, v128, v129
    v_cvt_pk_bf16_f32 v245, v130, v131
    ds_write_b128 v23, v[242:245] offset:34816
    v_pk_fma_f32 v[48:49], v[164:165], v[160:161], v[48:49] op_sel_hi:[0,1,1] neg_lo:[1,0,0] neg_hi:[1,0,0]
    v_pk_fma_f32 v[50:51], v[164:165], v[162:163], v[50:51] op_sel_hi:[0,1,1] neg_lo:[1,0,0] neg_hi:[1,0,0]
    v_pk_fma_f32 v[76:77], v[168:169], v[160:161], v[76:77] op_sel_hi:[0,1,1] neg_lo:[1,0,0] neg_hi:[1,0,0]
    v_pk_fma_f32 v[78:79], v[168:169], v[162:163], v[78:79] op_sel_hi:[0,1,1] neg_lo:[1,0,0] neg_hi:[1,0,0]
    v_pk_mul_f32 v[192:193], v[48:49], v[48:49]
    v_pk_mul_f32 v[194:195], v[50:51], v[50:51]
    v_pk_mul_f32 v[196:197], v[76:77], v[76:77]
    v_pk_mul_f32 v[198:199], v[78:79], v[78:79]
    v_pk_fma_f32 v[192:193], v[192:193], v[166:167], v[166:167] op_sel:[0,1,0] op_sel_hi:[1,1,0]
    v_pk_fma_f32 v[194:195], v[194:195], v[166:167], v[166:167] op_sel:[0,1,0] op_sel_hi:[1,1,0]
    v_pk_fma_f32 v[196:197], v[196:197], v[170:171], v[170:171] op_sel:[0,1,0] op_sel_hi:[1,1,0]
    v_pk_fma_f32 v[198:199], v[198:199], v[170:171], v[170:171] op_sel:[0,1,0] op_sel_hi:[1,1,0]
    v_pk_mul_f32 v[192:193], v[192:193], v[48:49]
    v_pk_mul_f32 v[194:195], v[194:195], v[50:51]
    v_pk_mul_f32 v[196:197], v[196:197], v[76:77]
    v_pk_mul_f32 v[198:199], v[198:199], v[78:79]
    v_exp_f32 v192, v192
    v_exp_f32 v193, v193
    v_exp_f32 v194, v194
    v_exp_f32 v195, v195
    v_exp_f32 v196, v196
    v_exp_f32 v197, v197
    v_exp_f32 v198, v198
    v_exp_f32 v199, v199
    v_pk_fma_f32 v[192:193], v[192:193], v[164:165], v[164:165] op_sel:[0,1,1] op_sel_hi:[1,1,1]
    v_pk_fma_f32 v[194:195], v[194:195], v[164:165], v[164:165] op_sel:[0,1,1] op_sel_hi:[1,1,1]
    v_pk_fma_f32 v[196:197], v[196:197], v[168:169], v[168:169] op_sel:[0,1,1] op_sel_hi:[1,1,1]
    v_pk_fma_f32 v[198:199], v[198:199], v[168:169], v[168:169] op_sel:[0,1,1] op_sel_hi:[1,1,1]
    v_rcp_f32 v192, v192
    v_rcp_f32 v193, v193
    v_rcp_f32 v194, v194
    v_rcp_f32 v195, v195
    v_rcp_f32 v196, v196
    v_rcp_f32 v197, v197
    v_rcp_f32 v198, v198
    v_rcp_f32 v199, v199
    v_pk_mul_f32 v[48:49], v[48:49], v[192:193]
    v_pk_mul_f32 v[50:51], v[50:51], v[194:195]
    v_pk_mul_f32 v[76:77], v[76:77], v[196:197]
    v_pk_mul_f32 v[78:79], v[78:79], v[198:199]
    v_cvt_pk_bf16_f32 v246, v48, v49
    v_cvt_pk_bf16_f32 v247, v50, v51
    s_add_u32 s36, s45, 0
    buffer_store_dwordx4 v[32:35], v2, s[16:19], s36 offen sc1
    v_cvt_pk_bf16_f32 v248, v76, v77
    v_cvt_pk_bf16_f32 v249, v78, v79
    s_add_u32 s36, s45, 229376
    buffer_store_dwordx4 v[60:63], v2, s[16:19], s36 offen sc1
    v_pk_fma_f32 v[104:105], v[172:173], v[160:161], v[104:105] op_sel_hi:[0,1,1] neg_lo:[1,0,0] neg_hi:[1,0,0]
    v_pk_fma_f32 v[106:107], v[172:173], v[162:163], v[106:107] op_sel_hi:[0,1,1] neg_lo:[1,0,0] neg_hi:[1,0,0]
    v_pk_fma_f32 v[132:133], v[176:177], v[160:161], v[132:133] op_sel_hi:[0,1,1] neg_lo:[1,0,0] neg_hi:[1,0,0]
    v_pk_fma_f32 v[134:135], v[176:177], v[162:163], v[134:135] op_sel_hi:[0,1,1] neg_lo:[1,0,0] neg_hi:[1,0,0]
    v_pk_mul_f32 v[192:193], v[104:105], v[104:105]
    v_pk_mul_f32 v[194:195], v[106:107], v[106:107]
    v_pk_mul_f32 v[196:197], v[132:133], v[132:133]
    v_pk_mul_f32 v[198:199], v[134:135], v[134:135]
    v_pk_fma_f32 v[192:193], v[192:193], v[174:175], v[174:175] op_sel:[0,1,0] op_sel_hi:[1,1,0]
    v_pk_fma_f32 v[194:195], v[194:195], v[174:175], v[174:175] op_sel:[0,1,0] op_sel_hi:[1,1,0]
    v_pk_fma_f32 v[196:197], v[196:197], v[178:179], v[178:179] op_sel:[0,1,0] op_sel_hi:[1,1,0]
    v_pk_fma_f32 v[198:199], v[198:199], v[178:179], v[178:179] op_sel:[0,1,0] op_sel_hi:[1,1,0]
    v_pk_mul_f32 v[192:193], v[192:193], v[104:105]
    v_pk_mul_f32 v[194:195], v[194:195], v[106:107]
    v_pk_mul_f32 v[196:197], v[196:197], v[132:133]
    v_pk_mul_f32 v[198:199], v[198:199], v[134:135]
    v_exp_f32 v192, v192
    v_exp_f32 v193, v193
    v_exp_f32 v194, v194
    v_exp_f32 v195, v195
    v_exp_f32 v196, v196
    v_exp_f32 v197, v197
    v_exp_f32 v198, v198
    v_exp_f32 v199, v199
    v_pk_fma_f32 v[192:193], v[192:193], v[172:173], v[172:173] op_sel:[0,1,1] op_sel_hi:[1,1,1]
    v_pk_fma_f32 v[194:195], v[194:195], v[172:173], v[172:173] op_sel:[0,1,1] op_sel_hi:[1,1,1]
    v_pk_fma_f32 v[196:197], v[196:197], v[176:177], v[176:177] op_sel:[0,1,1] op_sel_hi:[1,1,1]
    v_pk_fma_f32 v[198:199], v[198:199], v[176:177], v[176:177] op_sel:[0,1,1] op_sel_hi:[1,1,1]
    v_rcp_f32 v192, v192
    v_rcp_f32 v193, v193
    v_rcp_f32 v194, v194
    v_rcp_f32 v195, v195
    v_rcp_f32 v196, v196
    v_rcp_f32 v197, v197
    v_rcp_f32 v198, v198
    v_rcp_f32 v199, v199
    v_pk_mul_f32 v[104:105], v[104:105], v[192:193]
    v_pk_mul_f32 v[106:107], v[106:107], v[194:195]
    v_pk_mul_f32 v[132:133], v[132:133], v[196:197]
    v_pk_mul_f32 v[134:135], v[134:135], v[198:199]
    v_cvt_pk_bf16_f32 v250, v104, v105
    v_cvt_pk_bf16_f32 v251, v106, v107
    s_add_u32 s36, s45, 458752
    buffer_store_dwordx4 v[88:91], v2, s[16:19], s36 offen sc1
    v_cvt_pk_bf16_f32 v252, v132, v133
    v_cvt_pk_bf16_f32 v253, v134, v135
    s_add_u32 s36, s45, 688128
    buffer_store_dwordx4 v[116:119], v2, s[16:19], s36 offen sc1
    s_waitcnt vmcnt(4) lgkmcnt(0)
    v_lshrrev_b32 v18, 2, v1
    v_mul_u32_u24 v13, 256, v18
    v_and_b32 v19, 3, v1
    v_lshl_add_u32 v13, v19, 3, v13
    v_add_u32 v13, 49152, v13
    v_and_b32 v18, 7, v18
    s_mul_i32 s36, s35, 4
    s_add_u32 s36, s36, 3
    v_xor_b32 v19, s36, v18
    v_lshl_add_u32 v16, v19, 5, v13
    s_mul_i32 s36, s35, 4
    s_add_u32 s36, s36, 2
    v_xor_b32 v19, s36, v18
    v_lshl_add_u32 v15, v19, 5, v13
    s_mul_i32 s36, s35, 4
    s_add_u32 s36, s36, 1
    v_xor_b32 v19, s36, v18
    v_lshl_add_u32 v14, v19, 5, v13
    s_mul_i32 s36, s35, 4
    s_add_u32 s36, s36, 0
    v_xor_b32 v19, s36, v18
    v_lshl_add_u32 v13, v19, 5, v13
    s_mov_b32 s42, 0
    s_mov_b32 s43, 0
    s_mov_b32 s48, 0
    v_mov_b32 v17, v12
    v_mov_b32 v18, v13
    v_mov_b32 v19, v14
    v_mov_b32 v20, v15
    v_mov_b32 v21, v16
    v_mov_b32 v56, 0x10000
    s_waitcnt lgkmcnt(0)
    s_barrier
    ds_read_b128 v[24:27], v17 offset:0
    ds_read_b128 v[28:31], v17 offset:2048
    ds_read_b128 v[32:35], v17 offset:4096
    ds_read_b128 v[36:39], v17 offset:6144
    ds_read_b64_tr_b16 v[40:41], v18 offset:0
    ds_read_b64_tr_b16 v[42:43], v18 offset:4096
    ds_read_b64_tr_b16 v[44:45], v19 offset:0
    ds_read_b64_tr_b16 v[46:47], v19 offset:4096
    ds_read_b64_tr_b16 v[48:49], v20 offset:0
    ds_read_b64_tr_b16 v[50:51], v20 offset:4096
    ds_read_b64_tr_b16 v[52:53], v21 offset:0
    ds_read_b64_tr_b16 v[54:55], v21 offset:4096
    v_mfma_f32_16x16x32_bf16 v[120:123], v[226:229], v[180:183], 0
    v_mfma_f32_16x16x32_bf16 v[124:127], v[224:227], v[180:183], 0
    v_mfma_f32_16x16x32_bf16 v[128:131], v[226:229], v[200:203], 0
    v_mfma_f32_16x16x32_bf16 v[132:135], v[224:227], v[200:203], 0
    v_mfma_f32_16x16x32_bf16 v[136:139], v[226:229], v[208:211], 0
    v_mfma_f32_16x16x32_bf16 v[140:143], v[224:227], v[208:211], 0
    v_mfma_f32_16x16x32_bf16 v[144:147], v[226:229], v[216:219], 0
    v_mfma_f32_16x16x32_bf16 v[148:151], v[224:227], v[216:219], 0
    v_mfma_f32_16x16x32_bf16 v[120:123], v[226:229], v[184:187], v[120:123]
    v_mfma_f32_16x16x32_bf16 v[124:127], v[224:227], v[184:187], v[124:127]
    v_mfma_f32_16x16x32_bf16 v[128:131], v[226:229], v[204:207], v[128:131]
    v_mfma_f32_16x16x32_bf16 v[132:135], v[224:227], v[204:207], v[132:135]
    v_mfma_f32_16x16x32_bf16 v[136:139], v[226:229], v[212:215], v[136:139]
    v_mfma_f32_16x16x32_bf16 v[140:143], v[224:227], v[212:215], v[140:143]
    v_mfma_f32_16x16x32_bf16 v[144:147], v[226:229], v[220:223], v[144:147]
    v_mfma_f32_16x16x32_bf16 v[148:151], v[224:227], v[220:223], v[148:151]
    s_waitcnt lgkmcnt(0)
    v_mfma_f32_16x16x32_bf16 v[120:123], v[40:43], v[24:27], v[120:123]
    ds_read_b128 v[184:187], v17 offset:1024
    ds_read_b128 v[188:191], v17 offset:3072
    v_mfma_f32_16x16x32_bf16 v[136:139], v[40:43], v[28:31], v[136:139]
    ds_read_b128 v[192:195], v17 offset:5120
    v_mfma_f32_16x16x32_bf16 v[152:155], v[40:43], v[32:35], 0
    ds_read_b128 v[196:199], v17 offset:7168
    v_mfma_f32_16x16x32_bf16 v[168:171], v[40:43], v[36:39], 0
    s_add_u32 s36, s46, 0
    buffer_store_dwordx4 v[230:233], v2, s[16:19], s36 offen sc1
    v_mfma_f32_16x16x32_bf16 v[172:175], v[44:47], v[36:39], 0
    ds_read_b64_tr_b16 v[200:201], v18 offset:8192
    v_mfma_f32_16x16x32_bf16 v[156:159], v[44:47], v[32:35], 0
    ds_read_b64_tr_b16 v[202:203], v18 offset:12288
    v_mfma_f32_16x16x32_bf16 v[140:143], v[44:47], v[28:31], v[140:143]
    ds_read_b64_tr_b16 v[204:205], v19 offset:8192
    s_add_u32 s36, s47, 0
    buffer_store_dwordx2 v[246:247], v254, s[16:19], s36 offen sc1
    v_mfma_f32_16x16x32_bf16 v[124:127], v[44:47], v[24:27], v[124:127]
    ds_read_b64_tr_b16 v[206:207], v19 offset:12288
    v_mfma_f32_16x16x32_bf16 v[128:131], v[48:51], v[24:27], v[128:131]
    ds_read_b64_tr_b16 v[208:209], v20 offset:8192
    v_mfma_f32_16x16x32_bf16 v[144:147], v[48:51], v[28:31], v[144:147]
    ds_read_b64_tr_b16 v[210:211], v20 offset:12288
    v_mfma_f32_16x16x32_bf16 v[160:163], v[48:51], v[32:35], 0
    ds_read_b64_tr_b16 v[212:213], v21 offset:8192
    v_mfma_f32_16x16x32_bf16 v[176:179], v[48:51], v[36:39], 0
    ds_read_b64_tr_b16 v[214:215], v21 offset:12288
    s_add_u32 s42, s42, 16384
    s_cmp_eq_u32 s42, 49152
    s_cselect_b32 s42, 0, s42
    v_mfma_f32_16x16x32_bf16 v[180:183], v[52:55], v[36:39], 0
    s_add_u32 s48, s48, 16384
    s_cmp_eq_u32 s48, 98304
    s_cselect_b32 s48, 0, s48
    v_mfma_f32_16x16x32_bf16 v[164:167], v[52:55], v[32:35], 0
    v_add_u32 v17, s42, v12
    v_add_u32 v18, s48, v13
    v_add_u32 v19, s48, v14
    v_mfma_f32_16x16x32_bf16 v[148:151], v[52:55], v[28:31], v[148:151]
    v_add_u32 v20, s48, v15
    v_add_u32 v21, s48, v16
    v_mfma_f32_16x16x32_bf16 v[132:135], v[52:55], v[24:27], v[132:135]
    s_waitcnt lgkmcnt(0)
    s_barrier
    v_mfma_f32_16x16x32_bf16 v[120:123], v[200:203], v[184:187], v[120:123]
    ds_read_b128 v[24:27], v17 offset:0
    ds_read_b128 v[28:31], v17 offset:2048
    v_mfma_f32_16x16x32_bf16 v[136:139], v[200:203], v[188:191], v[136:139]
    ds_read_b128 v[32:35], v17 offset:4096
    v_mfma_f32_16x16x32_bf16 v[152:155], v[200:203], v[192:195], v[152:155]
    ds_read_b128 v[36:39], v17 offset:6144
    v_mfma_f32_16x16x32_bf16 v[168:171], v[200:203], v[196:199], v[168:171]
    s_add_u32 s36, s46, 229376
    buffer_store_dwordx4 v[234:237], v2, s[16:19], s36 offen sc1
    v_mfma_f32_16x16x32_bf16 v[172:175], v[204:207], v[196:199], v[172:175]
    ds_read_b64_tr_b16 v[40:41], v18 offset:0
    v_mfma_f32_16x16x32_bf16 v[156:159], v[204:207], v[192:195], v[156:159]
    ds_read_b64_tr_b16 v[42:43], v18 offset:4096
    v_mfma_f32_16x16x32_bf16 v[140:143], v[204:207], v[188:191], v[140:143]
    ds_read_b64_tr_b16 v[44:45], v19 offset:0
    s_add_u32 s36, s47, 229376
    buffer_store_dwordx2 v[248:249], v254, s[16:19], s36 offen sc1
    v_mfma_f32_16x16x32_bf16 v[124:127], v[204:207], v[184:187], v[124:127]
    ds_read_b64_tr_b16 v[46:47], v19 offset:4096
    v_mfma_f32_16x16x32_bf16 v[128:131], v[208:211], v[184:187], v[128:131]
    ds_read_b64_tr_b16 v[48:49], v20 offset:0
    v_mfma_f32_16x16x32_bf16 v[144:147], v[208:211], v[188:191], v[144:147]
    ds_read_b64_tr_b16 v[50:51], v20 offset:4096
    v_mfma_f32_16x16x32_bf16 v[160:163], v[208:211], v[192:195], v[160:163]
    ds_read_b64_tr_b16 v[52:53], v21 offset:0
    v_mfma_f32_16x16x32_bf16 v[176:179], v[208:211], v[196:199], v[176:179]
    ds_read_b64_tr_b16 v[54:55], v21 offset:4096
    s_add_u32 s43, s43, 1
    v_mfma_f32_16x16x32_bf16 v[180:183], v[212:215], v[196:199], v[180:183]
    s_cmp_lt_u32 s43, 27
    v_mfma_f32_16x16x32_bf16 v[164:167], v[212:215], v[192:195], v[164:167]
    v_mfma_f32_16x16x32_bf16 v[148:151], v[212:215], v[188:191], v[148:151]
    v_mfma_f32_16x16x32_bf16 v[132:135], v[212:215], v[184:187], v[132:135]
    s_waitcnt lgkmcnt(0)
    v_mfma_f32_16x16x32_bf16 v[120:123], v[40:43], v[24:27], v[120:123]
    ds_read_b128 v[184:187], v17 offset:1024
    ds_read_b128 v[188:191], v17 offset:3072
    v_mfma_f32_16x16x32_bf16 v[136:139], v[40:43], v[28:31], v[136:139]
    ds_read_b128 v[192:195], v17 offset:5120
    v_mfma_f32_16x16x32_bf16 v[152:155], v[40:43], v[32:35], v[152:155]
    ds_read_b128 v[196:199], v17 offset:7168
    v_mfma_f32_16x16x32_bf16 v[168:171], v[40:43], v[36:39], v[168:171]
    s_add_u32 s36, s46, 458752
    buffer_store_dwordx4 v[238:241], v2, s[16:19], s36 offen sc1
    v_mfma_f32_16x16x32_bf16 v[172:175], v[44:47], v[36:39], v[172:175]
    ds_read_b64_tr_b16 v[200:201], v18 offset:8192
    v_mfma_f32_16x16x32_bf16 v[156:159], v[44:47], v[32:35], v[156:159]
    ds_read_b64_tr_b16 v[202:203], v18 offset:12288
    v_mfma_f32_16x16x32_bf16 v[140:143], v[44:47], v[28:31], v[140:143]
    ds_read_b64_tr_b16 v[204:205], v19 offset:8192
    s_add_u32 s36, s47, 458752
    buffer_store_dwordx2 v[250:251], v254, s[16:19], s36 offen sc1
    v_mfma_f32_16x16x32_bf16 v[124:127], v[44:47], v[24:27], v[124:127]
    ds_read_b64_tr_b16 v[206:207], v19 offset:12288
    v_mfma_f32_16x16x32_bf16 v[128:131], v[48:51], v[24:27], v[128:131]
    ds_read_b64_tr_b16 v[208:209], v20 offset:8192
    v_mfma_f32_16x16x32_bf16 v[144:147], v[48:51], v[28:31], v[144:147]
    ds_read_b64_tr_b16 v[210:211], v20 offset:12288
    v_mfma_f32_16x16x32_bf16 v[160:163], v[48:51], v[32:35], v[160:163]
    ds_read_b64_tr_b16 v[212:213], v21 offset:8192
    v_mfma_f32_16x16x32_bf16 v[176:179], v[48:51], v[36:39], v[176:179]
    ds_read_b64_tr_b16 v[214:215], v21 offset:12288
    s_add_u32 s42, s42, 16384
    s_cmp_eq_u32 s42, 49152
    s_cselect_b32 s42, 0, s42
    v_mfma_f32_16x16x32_bf16 v[180:183], v[52:55], v[36:39], v[180:183]
    s_add_u32 s48, s48, 16384
    s_cmp_eq_u32 s48, 98304
    s_cselect_b32 s48, 0, s48
    v_mfma_f32_16x16x32_bf16 v[164:167], v[52:55], v[32:35], v[164:167]
    v_add_u32 v17, s42, v12
    v_add_u32 v18, s48, v13
    v_add_u32 v19, s48, v14
    v_mfma_f32_16x16x32_bf16 v[148:151], v[52:55], v[28:31], v[148:151]
    v_add_u32 v20, s48, v15
    v_add_u32 v21, s48, v16
    v_mfma_f32_16x16x32_bf16 v[132:135], v[52:55], v[24:27], v[132:135]
    s_waitcnt lgkmcnt(0)
    s_barrier
    v_mfma_f32_16x16x32_bf16 v[120:123], v[200:203], v[184:187], v[120:123]
    ds_read_b128 v[24:27], v17 offset:0
    ds_read_b128 v[28:31], v17 offset:2048
    v_mfma_f32_16x16x32_bf16 v[136:139], v[200:203], v[188:191], v[136:139]
    ds_read_b128 v[32:35], v17 offset:4096
    v_mfma_f32_16x16x32_bf16 v[152:155], v[200:203], v[192:195], v[152:155]
    ds_read_b128 v[36:39], v17 offset:6144
    v_mfma_f32_16x16x32_bf16 v[168:171], v[200:203], v[196:199], v[168:171]
    s_add_u32 s36, s46, 688128
    buffer_store_dwordx4 v[242:245], v2, s[16:19], s36 offen sc1
    v_mfma_f32_16x16x32_bf16 v[172:175], v[204:207], v[196:199], v[172:175]
    ds_read_b64_tr_b16 v[40:41], v18 offset:0
    v_mfma_f32_16x16x32_bf16 v[156:159], v[204:207], v[192:195], v[156:159]
    ds_read_b64_tr_b16 v[42:43], v18 offset:4096
    v_mfma_f32_16x16x32_bf16 v[140:143], v[204:207], v[188:191], v[140:143]
    ds_read_b64_tr_b16 v[44:45], v19 offset:0
    s_add_u32 s36, s47, 688128
    buffer_store_dwordx2 v[252:253], v254, s[16:19], s36 offen sc1
    v_mfma_f32_16x16x32_bf16 v[124:127], v[204:207], v[184:187], v[124:127]
    ds_read_b64_tr_b16 v[46:47], v19 offset:4096
    v_mfma_f32_16x16x32_bf16 v[128:131], v[208:211], v[184:187], v[128:131]
    ds_read_b64_tr_b16 v[48:49], v20 offset:0
    v_mfma_f32_16x16x32_bf16 v[144:147], v[208:211], v[188:191], v[144:147]
    ds_read_b64_tr_b16 v[50:51], v20 offset:4096
    v_mfma_f32_16x16x32_bf16 v[160:163], v[208:211], v[192:195], v[160:163]
    ds_read_b64_tr_b16 v[52:53], v21 offset:0
    v_mfma_f32_16x16x32_bf16 v[176:179], v[208:211], v[196:199], v[176:179]
    ds_read_b64_tr_b16 v[54:55], v21 offset:4096
    s_add_u32 s43, s43, 1
    v_mfma_f32_16x16x32_bf16 v[180:183], v[212:215], v[196:199], v[180:183]
    s_cmp_lt_u32 s43, 27
    v_mfma_f32_16x16x32_bf16 v[164:167], v[212:215], v[192:195], v[164:167]
    v_mfma_f32_16x16x32_bf16 v[148:151], v[212:215], v[188:191], v[148:151]
    v_mfma_f32_16x16x32_bf16 v[132:135], v[212:215], v[184:187], v[132:135]
    s_waitcnt vmcnt(8)
    buffer_atomic_add v8, v9, s[56:59], s49 offen offset:512 sc1
mm_21:
    s_waitcnt lgkmcnt(0)
    v_mfma_f32_16x16x32_bf16 v[120:123], v[40:43], v[24:27], v[120:123]
    ds_read_b128 v[184:187], v17 offset:1024
    v_mfma_f32_16x16x32_bf16 v[136:139], v[40:43], v[28:31], v[136:139]
    ds_read_b128 v[188:191], v17 offset:3072
    v_mfma_f32_16x16x32_bf16 v[152:155], v[40:43], v[32:35], v[152:155]
    ds_read_b128 v[192:195], v17 offset:5120
    v_mfma_f32_16x16x32_bf16 v[168:171], v[40:43], v[36:39], v[168:171]
    ds_read_b128 v[196:199], v17 offset:7168
    v_mfma_f32_16x16x32_bf16 v[172:175], v[44:47], v[36:39], v[172:175]
    ds_read_b64_tr_b16 v[200:201], v18 offset:8192
    v_mfma_f32_16x16x32_bf16 v[156:159], v[44:47], v[32:35], v[156:159]
    ds_read_b64_tr_b16 v[202:203], v18 offset:12288
    v_mfma_f32_16x16x32_bf16 v[140:143], v[44:47], v[28:31], v[140:143]
    ds_read_b64_tr_b16 v[204:205], v19 offset:8192
    v_mfma_f32_16x16x32_bf16 v[124:127], v[44:47], v[24:27], v[124:127]
    ds_read_b64_tr_b16 v[206:207], v19 offset:12288
    v_mfma_f32_16x16x32_bf16 v[128:131], v[48:51], v[24:27], v[128:131]
    ds_read_b64_tr_b16 v[208:209], v20 offset:8192
    v_mfma_f32_16x16x32_bf16 v[144:147], v[48:51], v[28:31], v[144:147]
    ds_read_b64_tr_b16 v[210:211], v20 offset:12288
    v_mfma_f32_16x16x32_bf16 v[160:163], v[48:51], v[32:35], v[160:163]
    ds_read_b64_tr_b16 v[212:213], v21 offset:8192
    v_mfma_f32_16x16x32_bf16 v[176:179], v[48:51], v[36:39], v[176:179]
    ds_read_b64_tr_b16 v[214:215], v21 offset:12288
    s_add_u32 s42, s42, 16384
    s_cmp_eq_u32 s42, 49152
    s_cselect_b32 s42, 0, s42
    v_mfma_f32_16x16x32_bf16 v[180:183], v[52:55], v[36:39], v[180:183]
    s_add_u32 s48, s48, 16384
    s_cmp_eq_u32 s48, 98304
    s_cselect_b32 s48, 0, s48
    v_mfma_f32_16x16x32_bf16 v[164:167], v[52:55], v[32:35], v[164:167]
    v_add_u32 v17, s42, v12
    v_add_u32 v18, s48, v13
    v_add_u32 v19, s48, v14
    v_mfma_f32_16x16x32_bf16 v[148:151], v[52:55], v[28:31], v[148:151]
    v_add_u32 v20, s48, v15
    v_add_u32 v21, s48, v16
    v_mfma_f32_16x16x32_bf16 v[132:135], v[52:55], v[24:27], v[132:135]
    s_waitcnt lgkmcnt(0)
    s_barrier
    v_mfma_f32_16x16x32_bf16 v[120:123], v[200:203], v[184:187], v[120:123]
    ds_read_b128 v[24:27], v17 offset:0
    v_mfma_f32_16x16x32_bf16 v[136:139], v[200:203], v[188:191], v[136:139]
    ds_read_b128 v[28:31], v17 offset:2048
    v_mfma_f32_16x16x32_bf16 v[152:155], v[200:203], v[192:195], v[152:155]
    ds_read_b128 v[32:35], v17 offset:4096
    v_mfma_f32_16x16x32_bf16 v[168:171], v[200:203], v[196:199], v[168:171]
    ds_read_b128 v[36:39], v17 offset:6144
    v_mfma_f32_16x16x32_bf16 v[172:175], v[204:207], v[196:199], v[172:175]
    ds_read_b64_tr_b16 v[40:41], v18 offset:0
    v_mfma_f32_16x16x32_bf16 v[156:159], v[204:207], v[192:195], v[156:159]
    ds_read_b64_tr_b16 v[42:43], v18 offset:4096
    v_mfma_f32_16x16x32_bf16 v[140:143], v[204:207], v[188:191], v[140:143]
    ds_read_b64_tr_b16 v[44:45], v19 offset:0
    v_mfma_f32_16x16x32_bf16 v[124:127], v[204:207], v[184:187], v[124:127]
    ds_read_b64_tr_b16 v[46:47], v19 offset:4096
    v_mfma_f32_16x16x32_bf16 v[128:131], v[208:211], v[184:187], v[128:131]
    ds_read_b64_tr_b16 v[48:49], v20 offset:0
    v_mfma_f32_16x16x32_bf16 v[144:147], v[208:211], v[188:191], v[144:147]
    ds_read_b64_tr_b16 v[50:51], v20 offset:4096
    v_mfma_f32_16x16x32_bf16 v[160:163], v[208:211], v[192:195], v[160:163]
    ds_read_b64_tr_b16 v[52:53], v21 offset:0
    v_mfma_f32_16x16x32_bf16 v[176:179], v[208:211], v[196:199], v[176:179]
    ds_read_b64_tr_b16 v[54:55], v21 offset:4096
    s_add_u32 s43, s43, 1
    v_mfma_f32_16x16x32_bf16 v[180:183], v[212:215], v[196:199], v[180:183]
    s_cmp_lt_u32 s43, 4
    v_mfma_f32_16x16x32_bf16 v[164:167], v[212:215], v[192:195], v[164:167]
    v_mfma_f32_16x16x32_bf16 v[148:151], v[212:215], v[188:191], v[148:151]
    v_mfma_f32_16x16x32_bf16 v[132:135], v[212:215], v[184:187], v[132:135]
    s_cbranch_scc1 mm_21
    s_waitcnt vmcnt(0)
    buffer_atomic_add v8, v9, s[56:59], s49 offen offset:1024 sc1
mm_22:
    s_waitcnt lgkmcnt(0)
    v_mfma_f32_16x16x32_bf16 v[120:123], v[40:43], v[24:27], v[120:123]
    ds_read_b128 v[184:187], v17 offset:1024
    v_mfma_f32_16x16x32_bf16 v[136:139], v[40:43], v[28:31], v[136:139]
    ds_read_b128 v[188:191], v17 offset:3072
    v_mfma_f32_16x16x32_bf16 v[152:155], v[40:43], v[32:35], v[152:155]
    ds_read_b128 v[192:195], v17 offset:5120
    v_mfma_f32_16x16x32_bf16 v[168:171], v[40:43], v[36:39], v[168:171]
    ds_read_b128 v[196:199], v17 offset:7168
    v_mfma_f32_16x16x32_bf16 v[172:175], v[44:47], v[36:39], v[172:175]
    ds_read_b64_tr_b16 v[200:201], v18 offset:8192
    v_mfma_f32_16x16x32_bf16 v[156:159], v[44:47], v[32:35], v[156:159]
    ds_read_b64_tr_b16 v[202:203], v18 offset:12288
    v_mfma_f32_16x16x32_bf16 v[140:143], v[44:47], v[28:31], v[140:143]
    ds_read_b64_tr_b16 v[204:205], v19 offset:8192
    v_mfma_f32_16x16x32_bf16 v[124:127], v[44:47], v[24:27], v[124:127]
    ds_read_b64_tr_b16 v[206:207], v19 offset:12288
    v_mfma_f32_16x16x32_bf16 v[128:131], v[48:51], v[24:27], v[128:131]
    ds_read_b64_tr_b16 v[208:209], v20 offset:8192
    v_mfma_f32_16x16x32_bf16 v[144:147], v[48:51], v[28:31], v[144:147]
    ds_read_b64_tr_b16 v[210:211], v20 offset:12288
    v_mfma_f32_16x16x32_bf16 v[160:163], v[48:51], v[32:35], v[160:163]
    ds_read_b64_tr_b16 v[212:213], v21 offset:8192
    v_mfma_f32_16x16x32_bf16 v[176:179], v[48:51], v[36:39], v[176:179]
    ds_read_b64_tr_b16 v[214:215], v21 offset:12288
    s_add_u32 s42, s42, 16384
    s_cmp_eq_u32 s42, 49152
    s_cselect_b32 s42, 0, s42
    v_mfma_f32_16x16x32_bf16 v[180:183], v[52:55], v[36:39], v[180:183]
    s_add_u32 s48, s48, 16384
    s_cmp_eq_u32 s48, 98304
    s_cselect_b32 s48, 0, s48
    v_mfma_f32_16x16x32_bf16 v[164:167], v[52:55], v[32:35], v[164:167]
    v_add_u32 v17, s42, v12
    v_add_u32 v18, s48, v13
    v_add_u32 v19, s48, v14
    v_mfma_f32_16x16x32_bf16 v[148:151], v[52:55], v[28:31], v[148:151]
    v_add_u32 v20, s48, v15
    v_add_u32 v21, s48, v16
    v_mfma_f32_16x16x32_bf16 v[132:135], v[52:55], v[24:27], v[132:135]
    s_waitcnt lgkmcnt(0)
    s_barrier
    v_mfma_f32_16x16x32_bf16 v[120:123], v[200:203], v[184:187], v[120:123]
    ds_read_b128 v[24:27], v17 offset:0
    v_mfma_f32_16x16x32_bf16 v[136:139], v[200:203], v[188:191], v[136:139]
    ds_read_b128 v[28:31], v17 offset:2048
    v_mfma_f32_16x16x32_bf16 v[152:155], v[200:203], v[192:195], v[152:155]
    ds_read_b128 v[32:35], v17 offset:4096
    v_mfma_f32_16x16x32_bf16 v[168:171], v[200:203], v[196:199], v[168:171]
    ds_read_b128 v[36:39], v17 offset:6144
    v_mfma_f32_16x16x32_bf16 v[172:175], v[204:207], v[196:199], v[172:175]
    ds_read_b64_tr_b16 v[40:41], v18 offset:0
    v_mfma_f32_16x16x32_bf16 v[156:159], v[204:207], v[192:195], v[156:159]
    ds_read_b64_tr_b16 v[42:43], v18 offset:4096
    v_mfma_f32_16x16x32_bf16 v[140:143], v[204:207], v[188:191], v[140:143]
    ds_read_b64_tr_b16 v[44:45], v19 offset:0
    v_mfma_f32_16x16x32_bf16 v[124:127], v[204:207], v[184:187], v[124:127]
    ds_read_b64_tr_b16 v[46:47], v19 offset:4096
    v_mfma_f32_16x16x32_bf16 v[128:131], v[208:211], v[184:187], v[128:131]
    ds_read_b64_tr_b16 v[48:49], v20 offset:0
    v_mfma_f32_16x16x32_bf16 v[144:147], v[208:211], v[188:191], v[144:147]
    ds_read_b64_tr_b16 v[50:51], v20 offset:4096
    v_mfma_f32_16x16x32_bf16 v[160:163], v[208:211], v[192:195], v[160:163]
    ds_read_b64_tr_b16 v[52:53], v21 offset:0
    v_mfma_f32_16x16x32_bf16 v[176:179], v[208:211], v[196:199], v[176:179]
    ds_read_b64_tr_b16 v[54:55], v21 offset:4096
    s_add_u32 s43, s43, 1
    v_mfma_f32_16x16x32_bf16 v[180:183], v[212:215], v[196:199], v[180:183]
    s_cmp_lt_u32 s43, 21
    v_mfma_f32_16x16x32_bf16 v[164:167], v[212:215], v[192:195], v[164:167]
    v_mfma_f32_16x16x32_bf16 v[148:151], v[212:215], v[188:191], v[148:151]
    v_mfma_f32_16x16x32_bf16 v[132:135], v[212:215], v[184:187], v[132:135]
    s_cbranch_scc1 mm_22
    s_waitcnt lgkmcnt(0)
    v_mfma_f32_16x16x32_bf16 v[120:123], v[40:43], v[24:27], v[120:123]
    ds_read_b128 v[184:187], v17 offset:1024
    v_mfma_f32_16x16x32_bf16 v[136:139], v[40:43], v[28:31], v[136:139]
    ds_read_b128 v[188:191], v17 offset:3072
    v_mfma_f32_16x16x32_bf16 v[152:155], v[40:43], v[32:35], v[152:155]
    ds_read_b128 v[192:195], v17 offset:5120
    v_mfma_f32_16x16x32_bf16 v[168:171], v[40:43], v[36:39], v[168:171]
    ds_read_b128 v[196:199], v17 offset:7168
    v_mfma_f32_16x16x32_bf16 v[172:175], v[44:47], v[36:39], v[172:175]
    ds_read_b64_tr_b16 v[200:201], v18 offset:8192
    v_mfma_f32_16x16x32_bf16 v[156:159], v[44:47], v[32:35], v[156:159]
    ds_read_b64_tr_b16 v[202:203], v18 offset:12288
    v_mfma_f32_16x16x32_bf16 v[140:143], v[44:47], v[28:31], v[140:143]
    ds_read_b64_tr_b16 v[204:205], v19 offset:8192
    v_mfma_f32_16x16x32_bf16 v[124:127], v[44:47], v[24:27], v[124:127]
    ds_read_b64_tr_b16 v[206:207], v19 offset:12288
    v_mfma_f32_16x16x32_bf16 v[128:131], v[48:51], v[24:27], v[128:131]
    ds_read_b64_tr_b16 v[208:209], v20 offset:8192
    v_mfma_f32_16x16x32_bf16 v[144:147], v[48:51], v[28:31], v[144:147]
    ds_read_b64_tr_b16 v[210:211], v20 offset:12288
    v_mfma_f32_16x16x32_bf16 v[160:163], v[48:51], v[32:35], v[160:163]
    ds_read_b64_tr_b16 v[212:213], v21 offset:8192
    v_mfma_f32_16x16x32_bf16 v[176:179], v[48:51], v[36:39], v[176:179]
    ds_read_b64_tr_b16 v[214:215], v21 offset:12288
    v_add_u32 v18, 49152, v13
    v_mfma_f32_16x16x32_bf16 v[180:183], v[52:55], v[36:39], v[180:183]
    v_add_u32 v19, 49152, v14
    v_mfma_f32_16x16x32_bf16 v[164:167], v[52:55], v[32:35], v[164:167]
    v_add_u32 v20, 49152, v15
    v_mfma_f32_16x16x32_bf16 v[148:151], v[52:55], v[28:31], v[148:151]
    v_add_u32 v21, 49152, v16
    v_mfma_f32_16x16x32_bf16 v[132:135], v[52:55], v[24:27], v[132:135]
    s_waitcnt lgkmcnt(0)
    s_barrier
    v_mfma_f32_16x16x32_bf16 v[120:123], v[200:203], v[184:187], v[120:123]
    ds_read_b128 v[232:235], v12 offset:16384
    ds_read_b128 v[236:239], v12 offset:18432
    v_mfma_f32_16x16x32_bf16 v[136:139], v[200:203], v[188:191], v[136:139]
    ds_read_b128 v[240:243], v12 offset:17408
    ds_read_b128 v[244:247], v12 offset:19456
    v_mfma_f32_16x16x32_bf16 v[152:155], v[200:203], v[192:195], v[152:155]
    ds_read_b64_tr_b16 v[24:25], v18 offset:16384
    v_mfma_f32_16x16x32_bf16 v[168:171], v[200:203], v[196:199], v[168:171]
    ds_read_b64_tr_b16 v[26:27], v18 offset:20480
    ds_read_b64_tr_b16 v[28:29], v19 offset:16384
    v_mfma_f32_16x16x32_bf16 v[172:175], v[204:207], v[196:199], v[172:175]
    ds_read_b64_tr_b16 v[30:31], v19 offset:20480
    ds_read_b64_tr_b16 v[32:33], v20 offset:16384
    v_mfma_f32_16x16x32_bf16 v[156:159], v[204:207], v[192:195], v[156:159]
    ds_read_b64_tr_b16 v[34:35], v20 offset:20480
    v_mfma_f32_16x16x32_bf16 v[140:143], v[204:207], v[188:191], v[140:143]
    ds_read_b64_tr_b16 v[36:37], v21 offset:16384
    ds_read_b64_tr_b16 v[38:39], v21 offset:20480
    v_mfma_f32_16x16x32_bf16 v[124:127], v[204:207], v[184:187], v[124:127]
    ds_read_b64_tr_b16 v[40:41], v18 offset:24576
    ds_read_b64_tr_b16 v[42:43], v18 offset:28672
    v_mfma_f32_16x16x32_bf16 v[128:131], v[208:211], v[184:187], v[128:131]
    ds_read_b64_tr_b16 v[44:45], v19 offset:24576
    v_mfma_f32_16x16x32_bf16 v[144:147], v[208:211], v[188:191], v[144:147]
    ds_read_b64_tr_b16 v[46:47], v19 offset:28672
    ds_read_b64_tr_b16 v[48:49], v20 offset:24576
    v_mfma_f32_16x16x32_bf16 v[160:163], v[208:211], v[192:195], v[160:163]
    ds_read_b64_tr_b16 v[50:51], v20 offset:28672
    ds_read_b64_tr_b16 v[52:53], v21 offset:24576
    v_mfma_f32_16x16x32_bf16 v[176:179], v[208:211], v[196:199], v[176:179]
    ds_read_b64_tr_b16 v[54:55], v21 offset:28672
    v_mfma_f32_16x16x32_bf16 v[180:183], v[212:215], v[196:199], v[180:183]
    v_mfma_f32_16x16x32_bf16 v[164:167], v[212:215], v[192:195], v[164:167]
    v_mfma_f32_16x16x32_bf16 v[148:151], v[212:215], v[188:191], v[148:151]
    v_mfma_f32_16x16x32_bf16 v[132:135], v[212:215], v[184:187], v[132:135]
    s_waitcnt lgkmcnt(8)
    v_mfma_f32_16x16x32_bf16 v[152:155], v[24:27], v[232:235], v[152:155]
    ds_read_b128 v[88:91], v12 offset:20480
    ds_read_b128 v[92:95], v12 offset:22528
    v_mfma_f32_16x16x32_bf16 v[168:171], v[24:27], v[236:239], v[168:171]
    ds_read_b128 v[96:99], v12 offset:21504
    v_mfma_f32_16x16x32_bf16 v[172:175], v[28:31], v[236:239], v[172:175]
    ds_read_b128 v[100:103], v12 offset:23552
    v_mfma_f32_16x16x32_bf16 v[156:159], v[28:31], v[232:235], v[156:159]
    ds_read_b64_tr_b16 v[184:185], v18 offset:32768
    v_mfma_f32_16x16x32_bf16 v[160:163], v[32:35], v[232:235], v[160:163]
    ds_read_b64_tr_b16 v[186:187], v18 offset:36864
    ds_read_b64_tr_b16 v[188:189], v19 offset:32768
    v_mfma_f32_16x16x32_bf16 v[176:179], v[32:35], v[236:239], v[176:179]
    ds_read_b64_tr_b16 v[190:191], v19 offset:36864
    v_mfma_f32_16x16x32_bf16 v[180:183], v[36:39], v[236:239], v[180:183]
    ds_read_b64_tr_b16 v[192:193], v20 offset:32768
    v_mfma_f32_16x16x32_bf16 v[164:167], v[36:39], v[232:235], v[164:167]
    ds_read_b64_tr_b16 v[194:195], v20 offset:36864
    s_waitcnt lgkmcnt(10)
    v_mfma_f32_16x16x32_bf16 v[152:155], v[40:43], v[240:243], v[152:155]
    ds_read_b64_tr_b16 v[196:197], v21 offset:32768
    ds_read_b64_tr_b16 v[198:199], v21 offset:36864
    v_mfma_f32_16x16x32_bf16 v[168:171], v[40:43], v[244:247], v[168:171]
    ds_read_b64_tr_b16 v[200:201], v18 offset:40960
    v_mfma_f32_16x16x32_bf16 v[172:175], v[44:47], v[244:247], v[172:175]
    ds_read_b64_tr_b16 v[202:203], v18 offset:45056
    v_mfma_f32_16x16x32_bf16 v[156:159], v[44:47], v[240:243], v[156:159]
    ds_read_b64_tr_b16 v[204:205], v19 offset:40960
    v_mfma_f32_16x16x32_bf16 v[160:163], v[48:51], v[240:243], v[160:163]
    ds_read_b64_tr_b16 v[206:207], v19 offset:45056
    ds_read_b64_tr_b16 v[208:209], v20 offset:40960
    v_mfma_f32_16x16x32_bf16 v[176:179], v[48:51], v[244:247], v[176:179]
    ds_read_b64_tr_b16 v[210:211], v20 offset:45056
    v_mfma_f32_16x16x32_bf16 v[180:183], v[52:55], v[244:247], v[180:183]
    ds_read_b64_tr_b16 v[212:213], v21 offset:40960
    v_mfma_f32_16x16x32_bf16 v[164:167], v[52:55], v[240:243], v[164:167]
    ds_read_b64_tr_b16 v[214:215], v21 offset:45056
    s_waitcnt lgkmcnt(8)
    s_barrier
    v_mfma_f32_16x16x32_bf16 v[152:155], v[184:187], v[88:91], v[152:155]
    ds_read_b128 v[232:235], v12 offset:32768
    ds_read_b128 v[236:239], v12 offset:34816
    v_mfma_f32_16x16x32_bf16 v[168:171], v[184:187], v[92:95], v[168:171]
    ds_read_b128 v[240:243], v12 offset:33792
    v_mfma_f32_16x16x32_bf16 v[172:175], v[188:191], v[92:95], v[172:175]
    ds_read_b128 v[244:247], v12 offset:35840
    v_mfma_f32_16x16x32_bf16 v[156:159], v[188:191], v[88:91], v[156:159]
    ds_read_b64_tr_b16 v[24:25], v13 offset:0
    v_mfma_f32_16x16x32_bf16 v[160:163], v[192:195], v[88:91], v[160:163]
    ds_read_b64_tr_b16 v[26:27], v13 offset:4096
    ds_read_b64_tr_b16 v[28:29], v14 offset:0
    v_mfma_f32_16x16x32_bf16 v[176:179], v[192:195], v[92:95], v[176:179]
    ds_read_b64_tr_b16 v[30:31], v14 offset:4096
    v_mfma_f32_16x16x32_bf16 v[180:183], v[196:199], v[92:95], v[180:183]
    ds_read_b64_tr_b16 v[32:33], v15 offset:0
    v_mfma_f32_16x16x32_bf16 v[164:167], v[196:199], v[88:91], v[164:167]
    ds_read_b64_tr_b16 v[34:35], v15 offset:4096
    s_waitcnt lgkmcnt(10)
    v_mfma_f32_16x16x32_bf16 v[152:155], v[200:203], v[96:99], v[152:155]
    ds_read_b64_tr_b16 v[36:37], v16 offset:0
    ds_read_b64_tr_b16 v[38:39], v16 offset:4096
    v_mfma_f32_16x16x32_bf16 v[168:171], v[200:203], v[100:103], v[168:171]
    ds_read_b64_tr_b16 v[40:41], v13 offset:8192
    v_mfma_f32_16x16x32_bf16 v[172:175], v[204:207], v[100:103], v[172:175]
    ds_read_b64_tr_b16 v[42:43], v13 offset:12288
    v_mfma_f32_16x16x32_bf16 v[156:159], v[204:207], v[96:99], v[156:159]
    ds_read_b64_tr_b16 v[44:45], v14 offset:8192
    v_mfma_f32_16x16x32_bf16 v[160:163], v[208:211], v[96:99], v[160:163]
    ds_read_b64_tr_b16 v[46:47], v14 offset:12288
    ds_read_b64_tr_b16 v[48:49], v15 offset:8192
    v_mfma_f32_16x16x32_bf16 v[176:179], v[208:211], v[100:103], v[176:179]
    ds_read_b64_tr_b16 v[50:51], v15 offset:12288
    v_mfma_f32_16x16x32_bf16 v[180:183], v[212:215], v[100:103], v[180:183]
    ds_read_b64_tr_b16 v[52:53], v16 offset:8192
    v_mfma_f32_16x16x32_bf16 v[164:167], v[212:215], v[96:99], v[164:167]
    ds_read_b64_tr_b16 v[54:55], v16 offset:12288
    s_waitcnt lgkmcnt(8)
    v_mfma_f32_16x16x32_bf16 v[152:155], v[24:27], v[232:235], v[152:155]
    ds_read_b128 v[88:91], v12 offset:36864
    ds_read_b128 v[92:95], v12 offset:38912
    v_mfma_f32_16x16x32_bf16 v[168:171], v[24:27], v[236:239], v[168:171]
    ds_read_b128 v[96:99], v12 offset:37888
    v_mfma_f32_16x16x32_bf16 v[172:175], v[28:31], v[236:239], v[172:175]
    ds_read_b128 v[100:103], v12 offset:39936
    v_mfma_f32_16x16x32_bf16 v[156:159], v[28:31], v[232:235], v[156:159]
    ds_read_b64_tr_b16 v[184:185], v13 offset:16384
    v_mfma_f32_16x16x32_bf16 v[160:163], v[32:35], v[232:235], v[160:163]
    ds_read_b64_tr_b16 v[186:187], v13 offset:20480
    ds_read_b64_tr_b16 v[188:189], v14 offset:16384
    v_mfma_f32_16x16x32_bf16 v[176:179], v[32:35], v[236:239], v[176:179]
    ds_read_b64_tr_b16 v[190:191], v14 offset:20480
    v_mfma_f32_16x16x32_bf16 v[180:183], v[36:39], v[236:239], v[180:183]
    ds_read_b64_tr_b16 v[192:193], v15 offset:16384
    v_mfma_f32_16x16x32_bf16 v[164:167], v[36:39], v[232:235], v[164:167]
    ds_read_b64_tr_b16 v[194:195], v15 offset:20480
    s_waitcnt lgkmcnt(10)
    v_mfma_f32_16x16x32_bf16 v[152:155], v[40:43], v[240:243], v[152:155]
    ds_read_b64_tr_b16 v[196:197], v16 offset:16384
    ds_read_b64_tr_b16 v[198:199], v16 offset:20480
    v_mfma_f32_16x16x32_bf16 v[168:171], v[40:43], v[244:247], v[168:171]
    ds_read_b64_tr_b16 v[200:201], v13 offset:24576
    v_mfma_f32_16x16x32_bf16 v[172:175], v[44:47], v[244:247], v[172:175]
    ds_read_b64_tr_b16 v[202:203], v13 offset:28672
    v_mfma_f32_16x16x32_bf16 v[156:159], v[44:47], v[240:243], v[156:159]
    ds_read_b64_tr_b16 v[204:205], v14 offset:24576
    v_mfma_f32_16x16x32_bf16 v[160:163], v[48:51], v[240:243], v[160:163]
    ds_read_b64_tr_b16 v[206:207], v14 offset:28672
    ds_read_b64_tr_b16 v[208:209], v15 offset:24576
    v_mfma_f32_16x16x32_bf16 v[176:179], v[48:51], v[244:247], v[176:179]
    ds_read_b64_tr_b16 v[210:211], v15 offset:28672
    v_mfma_f32_16x16x32_bf16 v[180:183], v[52:55], v[244:247], v[180:183]
    ds_read_b64_tr_b16 v[212:213], v16 offset:24576
    v_mfma_f32_16x16x32_bf16 v[164:167], v[52:55], v[240:243], v[164:167]
    ds_read_b64_tr_b16 v[214:215], v16 offset:28672
    s_waitcnt lgkmcnt(8)
    s_barrier
    v_mfma_f32_16x16x32_bf16 v[152:155], v[184:187], v[88:91], v[152:155]
    ds_read_b128 v[232:235], v12 offset:0
    ds_read_b128 v[236:239], v12 offset:2048
    v_mfma_f32_16x16x32_bf16 v[168:171], v[184:187], v[92:95], v[168:171]
    ds_read_b128 v[240:243], v12 offset:1024
    v_mfma_f32_16x16x32_bf16 v[172:175], v[188:191], v[92:95], v[172:175]
    ds_read_b128 v[244:247], v12 offset:3072
    v_mfma_f32_16x16x32_bf16 v[156:159], v[188:191], v[88:91], v[156:159]
    ds_read_b64_tr_b16 v[24:25], v13 offset:32768
    v_mfma_f32_16x16x32_bf16 v[160:163], v[192:195], v[88:91], v[160:163]
    ds_read_b64_tr_b16 v[26:27], v13 offset:36864
    ds_read_b64_tr_b16 v[28:29], v14 offset:32768
    v_mfma_f32_16x16x32_bf16 v[176:179], v[192:195], v[92:95], v[176:179]
    ds_read_b64_tr_b16 v[30:31], v14 offset:36864
    v_mfma_f32_16x16x32_bf16 v[180:183], v[196:199], v[92:95], v[180:183]
    ds_read_b64_tr_b16 v[32:33], v15 offset:32768
    v_mfma_f32_16x16x32_bf16 v[164:167], v[196:199], v[88:91], v[164:167]
    ds_read_b64_tr_b16 v[34:35], v15 offset:36864
    s_waitcnt lgkmcnt(10)
    v_mfma_f32_16x16x32_bf16 v[152:155], v[200:203], v[96:99], v[152:155]
    ds_read_b64_tr_b16 v[36:37], v16 offset:32768
    ds_read_b64_tr_b16 v[38:39], v16 offset:36864
    v_mfma_f32_16x16x32_bf16 v[168:171], v[200:203], v[100:103], v[168:171]
    ds_read_b64_tr_b16 v[40:41], v13 offset:40960
    v_mfma_f32_16x16x32_bf16 v[172:175], v[204:207], v[100:103], v[172:175]
    ds_read_b64_tr_b16 v[42:43], v13 offset:45056
    v_mfma_f32_16x16x32_bf16 v[156:159], v[204:207], v[96:99], v[156:159]
    ds_read_b64_tr_b16 v[44:45], v14 offset:40960
    v_mfma_f32_16x16x32_bf16 v[160:163], v[208:211], v[96:99], v[160:163]
    ds_read_b64_tr_b16 v[46:47], v14 offset:45056
    ds_read_b64_tr_b16 v[48:49], v15 offset:40960
    v_mfma_f32_16x16x32_bf16 v[176:179], v[208:211], v[100:103], v[176:179]
    ds_read_b64_tr_b16 v[50:51], v15 offset:45056
    v_mfma_f32_16x16x32_bf16 v[180:183], v[212:215], v[100:103], v[180:183]
    ds_read_b64_tr_b16 v[52:53], v16 offset:40960
    v_mfma_f32_16x16x32_bf16 v[164:167], v[212:215], v[96:99], v[164:167]
    ds_read_b64_tr_b16 v[54:55], v16 offset:45056
    s_waitcnt lgkmcnt(8)
    v_mfma_f32_16x16x32_bf16 v[152:155], v[24:27], v[232:235], v[152:155]
    ds_read_b128 v[88:91], v12 offset:4096
    ds_read_b128 v[92:95], v12 offset:6144
    v_mfma_f32_16x16x32_bf16 v[168:171], v[24:27], v[236:239], v[168:171]
    ds_read_b128 v[96:99], v12 offset:5120
    v_mfma_f32_16x16x32_bf16 v[172:175], v[28:31], v[236:239], v[172:175]
    ds_read_b128 v[100:103], v12 offset:7168
    v_mfma_f32_16x16x32_bf16 v[156:159], v[28:31], v[232:235], v[156:159]
    ds_read_b64_tr_b16 v[184:185], v18 offset:0
    v_mfma_f32_16x16x32_bf16 v[160:163], v[32:35], v[232:235], v[160:163]
    ds_read_b64_tr_b16 v[186:187], v18 offset:4096
    ds_read_b64_tr_b16 v[188:189], v19 offset:0
    v_mfma_f32_16x16x32_bf16 v[176:179], v[32:35], v[236:239], v[176:179]
    ds_read_b64_tr_b16 v[190:191], v19 offset:4096
    v_mfma_f32_16x16x32_bf16 v[180:183], v[36:39], v[236:239], v[180:183]
    ds_read_b64_tr_b16 v[192:193], v20 offset:0
    v_mfma_f32_16x16x32_bf16 v[164:167], v[36:39], v[232:235], v[164:167]
    ds_read_b64_tr_b16 v[194:195], v20 offset:4096
    s_waitcnt lgkmcnt(10)
    v_mfma_f32_16x16x32_bf16 v[152:155], v[40:43], v[240:243], v[152:155]
    ds_read_b64_tr_b16 v[196:197], v21 offset:0
    ds_read_b64_tr_b16 v[198:199], v21 offset:4096
    v_mfma_f32_16x16x32_bf16 v[168:171], v[40:43], v[244:247], v[168:171]
    ds_read_b64_tr_b16 v[200:201], v18 offset:8192
    v_mfma_f32_16x16x32_bf16 v[172:175], v[44:47], v[244:247], v[172:175]
    ds_read_b64_tr_b16 v[202:203], v18 offset:12288
    v_mfma_f32_16x16x32_bf16 v[156:159], v[44:47], v[240:243], v[156:159]
    ds_read_b64_tr_b16 v[204:205], v19 offset:8192
    v_mfma_f32_16x16x32_bf16 v[160:163], v[48:51], v[240:243], v[160:163]
    ds_read_b64_tr_b16 v[206:207], v19 offset:12288
    ds_read_b64_tr_b16 v[208:209], v20 offset:8192
    v_mfma_f32_16x16x32_bf16 v[176:179], v[48:51], v[244:247], v[176:179]
    ds_read_b64_tr_b16 v[210:211], v20 offset:12288
    v_mfma_f32_16x16x32_bf16 v[180:183], v[52:55], v[244:247], v[180:183]
    ds_read_b64_tr_b16 v[212:213], v21 offset:8192
    v_mfma_f32_16x16x32_bf16 v[164:167], v[52:55], v[240:243], v[164:167]
    ds_read_b64_tr_b16 v[214:215], v21 offset:12288
    s_waitcnt lgkmcnt(8)
    s_barrier
    v_mfma_f32_16x16x32_bf16 v[152:155], v[184:187], v[88:91], v[152:155]
    ds_read_b128 v[232:235], v12 offset:16384
    ds_read_b128 v[236:239], v12 offset:18432
    v_mfma_f32_16x16x32_bf16 v[168:171], v[184:187], v[92:95], v[168:171]
    ds_read_b128 v[240:243], v12 offset:17408
    v_mfma_f32_16x16x32_bf16 v[172:175], v[188:191], v[92:95], v[172:175]
    ds_read_b128 v[244:247], v12 offset:19456
    v_mfma_f32_16x16x32_bf16 v[156:159], v[188:191], v[88:91], v[156:159]
    ds_read_b64_tr_b16 v[24:25], v18 offset:16384
    v_mfma_f32_16x16x32_bf16 v[160:163], v[192:195], v[88:91], v[160:163]
    ds_read_b64_tr_b16 v[26:27], v18 offset:20480
    ds_read_b64_tr_b16 v[28:29], v19 offset:16384
    v_mfma_f32_16x16x32_bf16 v[176:179], v[192:195], v[92:95], v[176:179]
    ds_read_b64_tr_b16 v[30:31], v19 offset:20480
    v_mfma_f32_16x16x32_bf16 v[180:183], v[196:199], v[92:95], v[180:183]
    ds_read_b64_tr_b16 v[32:33], v20 offset:16384
    v_mfma_f32_16x16x32_bf16 v[164:167], v[196:199], v[88:91], v[164:167]
    ds_read_b64_tr_b16 v[34:35], v20 offset:20480
    s_waitcnt lgkmcnt(10)
    v_mfma_f32_16x16x32_bf16 v[152:155], v[200:203], v[96:99], v[152:155]
    ds_read_b64_tr_b16 v[36:37], v21 offset:16384
    ds_read_b64_tr_b16 v[38:39], v21 offset:20480
    v_mfma_f32_16x16x32_bf16 v[168:171], v[200:203], v[100:103], v[168:171]
    ds_read_b64_tr_b16 v[40:41], v18 offset:24576
    v_mfma_f32_16x16x32_bf16 v[172:175], v[204:207], v[100:103], v[172:175]
    ds_read_b64_tr_b16 v[42:43], v18 offset:28672
    v_mfma_f32_16x16x32_bf16 v[156:159], v[204:207], v[96:99], v[156:159]
    ds_read_b64_tr_b16 v[44:45], v19 offset:24576
    v_mfma_f32_16x16x32_bf16 v[160:163], v[208:211], v[96:99], v[160:163]
    ds_read_b64_tr_b16 v[46:47], v19 offset:28672
    ds_read_b64_tr_b16 v[48:49], v20 offset:24576
    v_mfma_f32_16x16x32_bf16 v[176:179], v[208:211], v[100:103], v[176:179]
    ds_read_b64_tr_b16 v[50:51], v20 offset:28672
    v_mfma_f32_16x16x32_bf16 v[180:183], v[212:215], v[100:103], v[180:183]
    ds_read_b64_tr_b16 v[52:53], v21 offset:24576
    v_mfma_f32_16x16x32_bf16 v[164:167], v[212:215], v[96:99], v[164:167]
    ds_read_b64_tr_b16 v[54:55], v21 offset:28672
    s_waitcnt lgkmcnt(8)
    v_mfma_f32_16x16x32_bf16 v[120:123], v[24:27], v[232:235], v[120:123]
    ds_read_b128 v[88:91], v12 offset:20480
    ds_read_b128 v[92:95], v12 offset:22528
    v_mfma_f32_16x16x32_bf16 v[136:139], v[24:27], v[236:239], v[136:139]
    ds_read_b128 v[96:99], v12 offset:21504
    v_mfma_f32_16x16x32_bf16 v[140:143], v[28:31], v[236:239], v[140:143]
    ds_read_b128 v[100:103], v12 offset:23552
    v_mfma_f32_16x16x32_bf16 v[124:127], v[28:31], v[232:235], v[124:127]
    ds_read_b64_tr_b16 v[184:185], v18 offset:32768
    v_and_or_b32 v152, v152, s15, v56
    v_and_or_b32 v154, v154, s15, v56
    v_and_or_b32 v156, v156, s15, v56
    v_and_or_b32 v158, v158, s15, v56
    v_cvt_pk_bf16_f32 v152, v152, v153
    v_cvt_pk_bf16_f32 v153, v154, v155
    v_cvt_pk_bf16_f32 v154, v156, v157
    v_cvt_pk_bf16_f32 v155, v158, v159
    buffer_store_dwordx4 v[152:155], v2, s[24:27], s41 offen offset:0 sc1
    v_and_or_b32 v160, v160, s15, v56
    v_and_or_b32 v162, v162, s15, v56
    v_and_or_b32 v164, v164, s15, v56
    v_and_or_b32 v166, v166, s15, v56
    v_cvt_pk_bf16_f32 v160, v160, v161
    v_cvt_pk_bf16_f32 v161, v162, v163
    v_cvt_pk_bf16_f32 v162, v164, v165
    v_cvt_pk_bf16_f32 v163, v166, v167
    buffer_store_dwordx4 v[160:163], v2, s[24:27], s41 offen offset:1024 sc1
    s_add_u32 s36, s41, 65536
    v_and_or_b32 v168, v168, s15, v56
    v_and_or_b32 v170, v170, s15, v56
    v_and_or_b32 v172, v172, s15, v56
    v_and_or_b32 v174, v174, s15, v56
    v_cvt_pk_bf16_f32 v168, v168, v169
    v_cvt_pk_bf16_f32 v169, v170, v171
    v_cvt_pk_bf16_f32 v170, v172, v173
    v_cvt_pk_bf16_f32 v171, v174, v175
    buffer_store_dwordx4 v[168:171], v2, s[24:27], s36 offen offset:0 sc1
    v_and_or_b32 v176, v176, s15, v56
    v_and_or_b32 v178, v178, s15, v56
    v_and_or_b32 v180, v180, s15, v56
    v_and_or_b32 v182, v182, s15, v56
    v_cvt_pk_bf16_f32 v176, v176, v177
    v_cvt_pk_bf16_f32 v177, v178, v179
    v_cvt_pk_bf16_f32 v178, v180, v181
    v_cvt_pk_bf16_f32 v179, v182, v183
    buffer_store_dwordx4 v[176:179], v2, s[24:27], s36 offen offset:1024 sc1
    v_mfma_f32_16x16x32_bf16 v[128:131], v[32:35], v[232:235], v[128:131]
    ds_read_b64_tr_b16 v[186:187], v18 offset:36864
    ds_read_b64_tr_b16 v[188:189], v19 offset:32768
    v_mfma_f32_16x16x32_bf16 v[144:147], v[32:35], v[236:239], v[144:147]
    ds_read_b64_tr_b16 v[190:191], v19 offset:36864
    v_mfma_f32_16x16x32_bf16 v[148:151], v[36:39], v[236:239], v[148:151]
    ds_read_b64_tr_b16 v[192:193], v20 offset:32768
    v_mfma_f32_16x16x32_bf16 v[132:135], v[36:39], v[232:235], v[132:135]
    ds_read_b64_tr_b16 v[194:195], v20 offset:36864
    s_waitcnt lgkmcnt(10)
    v_mfma_f32_16x16x32_bf16 v[120:123], v[40:43], v[240:243], v[120:123]
    ds_read_b64_tr_b16 v[196:197], v21 offset:32768
    ds_read_b64_tr_b16 v[198:199], v21 offset:36864
    v_mfma_f32_16x16x32_bf16 v[136:139], v[40:43], v[244:247], v[136:139]
    ds_read_b64_tr_b16 v[200:201], v18 offset:40960
    v_mfma_f32_16x16x32_bf16 v[140:143], v[44:47], v[244:247], v[140:143]
    ds_read_b64_tr_b16 v[202:203], v18 offset:45056
    v_mfma_f32_16x16x32_bf16 v[124:127], v[44:47], v[240:243], v[124:127]
    ds_read_b64_tr_b16 v[204:205], v19 offset:40960
    v_mfma_f32_16x16x32_bf16 v[128:131], v[48:51], v[240:243], v[128:131]
    ds_read_b64_tr_b16 v[206:207], v19 offset:45056
    ds_read_b64_tr_b16 v[208:209], v20 offset:40960
    v_mfma_f32_16x16x32_bf16 v[144:147], v[48:51], v[244:247], v[144:147]
    ds_read_b64_tr_b16 v[210:211], v20 offset:45056
    v_mfma_f32_16x16x32_bf16 v[148:151], v[52:55], v[244:247], v[148:151]
    ds_read_b64_tr_b16 v[212:213], v21 offset:40960
    v_mfma_f32_16x16x32_bf16 v[132:135], v[52:55], v[240:243], v[132:135]
    ds_read_b64_tr_b16 v[214:215], v21 offset:45056
    s_waitcnt lgkmcnt(8)
    s_barrier
    v_mfma_f32_16x16x32_bf16 v[120:123], v[184:187], v[88:91], v[120:123]
    ds_read_b128 v[232:235], v12 offset:32768
    ds_read_b128 v[236:239], v12 offset:34816
    v_mfma_f32_16x16x32_bf16 v[136:139], v[184:187], v[92:95], v[136:139]
    ds_read_b128 v[240:243], v12 offset:33792
    v_mfma_f32_16x16x32_bf16 v[140:143], v[188:191], v[92:95], v[140:143]
    ds_read_b128 v[244:247], v12 offset:35840
    v_mfma_f32_16x16x32_bf16 v[124:127], v[188:191], v[88:91], v[124:127]
    ds_read_b64_tr_b16 v[24:25], v13 offset:0
    v_mfma_f32_16x16x32_bf16 v[128:131], v[192:195], v[88:91], v[128:131]
    ds_read_b64_tr_b16 v[26:27], v13 offset:4096
    ds_read_b64_tr_b16 v[28:29], v14 offset:0
    v_mfma_f32_16x16x32_bf16 v[144:147], v[192:195], v[92:95], v[144:147]
    ds_read_b64_tr_b16 v[30:31], v14 offset:4096
    v_mfma_f32_16x16x32_bf16 v[148:151], v[196:199], v[92:95], v[148:151]
    ds_read_b64_tr_b16 v[32:33], v15 offset:0
    v_mfma_f32_16x16x32_bf16 v[132:135], v[196:199], v[88:91], v[132:135]
    ds_read_b64_tr_b16 v[34:35], v15 offset:4096
    s_waitcnt lgkmcnt(10)
    v_mfma_f32_16x16x32_bf16 v[120:123], v[200:203], v[96:99], v[120:123]
    ds_read_b64_tr_b16 v[36:37], v16 offset:0
    ds_read_b64_tr_b16 v[38:39], v16 offset:4096
    v_mfma_f32_16x16x32_bf16 v[136:139], v[200:203], v[100:103], v[136:139]
    ds_read_b64_tr_b16 v[40:41], v13 offset:8192
    v_mfma_f32_16x16x32_bf16 v[140:143], v[204:207], v[100:103], v[140:143]
    ds_read_b64_tr_b16 v[42:43], v13 offset:12288
    v_mfma_f32_16x16x32_bf16 v[124:127], v[204:207], v[96:99], v[124:127]
    ds_read_b64_tr_b16 v[44:45], v14 offset:8192
    v_mfma_f32_16x16x32_bf16 v[128:131], v[208:211], v[96:99], v[128:131]
    ds_read_b64_tr_b16 v[46:47], v14 offset:12288
    ds_read_b64_tr_b16 v[48:49], v15 offset:8192
    v_mfma_f32_16x16x32_bf16 v[144:147], v[208:211], v[100:103], v[144:147]
    ds_read_b64_tr_b16 v[50:51], v15 offset:12288
    v_mfma_f32_16x16x32_bf16 v[148:151], v[212:215], v[100:103], v[148:151]
    ds_read_b64_tr_b16 v[52:53], v16 offset:8192
    v_mfma_f32_16x16x32_bf16 v[132:135], v[212:215], v[96:99], v[132:135]
    ds_read_b64_tr_b16 v[54:55], v16 offset:12288
    s_waitcnt lgkmcnt(8)
    v_mfma_f32_16x16x32_bf16 v[120:123], v[24:27], v[232:235], v[120:123]
    ds_read_b128 v[88:91], v12 offset:36864
    ds_read_b128 v[92:95], v12 offset:38912
    v_mfma_f32_16x16x32_bf16 v[136:139], v[24:27], v[236:239], v[136:139]
    ds_read_b128 v[96:99], v12 offset:37888
    v_mfma_f32_16x16x32_bf16 v[140:143], v[28:31], v[236:239], v[140:143]
    ds_read_b128 v[100:103], v12 offset:39936
    v_mfma_f32_16x16x32_bf16 v[124:127], v[28:31], v[232:235], v[124:127]
    ds_read_b64_tr_b16 v[184:185], v13 offset:16384
    v_mfma_f32_16x16x32_bf16 v[128:131], v[32:35], v[232:235], v[128:131]
    ds_read_b64_tr_b16 v[186:187], v13 offset:20480
    ds_read_b64_tr_b16 v[188:189], v14 offset:16384
    v_mfma_f32_16x16x32_bf16 v[144:147], v[32:35], v[236:239], v[144:147]
    ds_read_b64_tr_b16 v[190:191], v14 offset:20480
    v_mfma_f32_16x16x32_bf16 v[148:151], v[36:39], v[236:239], v[148:151]
    ds_read_b64_tr_b16 v[192:193], v15 offset:16384
    v_mfma_f32_16x16x32_bf16 v[132:135], v[36:39], v[232:235], v[132:135]
    ds_read_b64_tr_b16 v[194:195], v15 offset:20480
    s_waitcnt lgkmcnt(10)
    v_mfma_f32_16x16x32_bf16 v[120:123], v[40:43], v[240:243], v[120:123]
    ds_read_b64_tr_b16 v[196:197], v16 offset:16384
    ds_read_b64_tr_b16 v[198:199], v16 offset:20480
    v_mfma_f32_16x16x32_bf16 v[136:139], v[40:43], v[244:247], v[136:139]
    ds_read_b64_tr_b16 v[200:201], v13 offset:24576
    v_mfma_f32_16x16x32_bf16 v[140:143], v[44:47], v[244:247], v[140:143]
    ds_read_b64_tr_b16 v[202:203], v13 offset:28672
    v_mfma_f32_16x16x32_bf16 v[124:127], v[44:47], v[240:243], v[124:127]
    ds_read_b64_tr_b16 v[204:205], v14 offset:24576
    v_mfma_f32_16x16x32_bf16 v[128:131], v[48:51], v[240:243], v[128:131]
    ds_read_b64_tr_b16 v[206:207], v14 offset:28672
    ds_read_b64_tr_b16 v[208:209], v15 offset:24576
    v_mfma_f32_16x16x32_bf16 v[144:147], v[48:51], v[244:247], v[144:147]
    ds_read_b64_tr_b16 v[210:211], v15 offset:28672
    v_mfma_f32_16x16x32_bf16 v[148:151], v[52:55], v[244:247], v[148:151]
    ds_read_b64_tr_b16 v[212:213], v16 offset:24576
    v_mfma_f32_16x16x32_bf16 v[132:135], v[52:55], v[240:243], v[132:135]
    ds_read_b64_tr_b16 v[214:215], v16 offset:28672
    s_waitcnt lgkmcnt(8)
    s_barrier
    v_mfma_f32_16x16x32_bf16 v[120:123], v[184:187], v[88:91], v[120:123]
    ds_read_b128 v[232:235], v12 offset:0
    ds_read_b128 v[236:239], v12 offset:2048
    v_mfma_f32_16x16x32_bf16 v[136:139], v[184:187], v[92:95], v[136:139]
    ds_read_b128 v[240:243], v12 offset:1024
    v_mfma_f32_16x16x32_bf16 v[140:143], v[188:191], v[92:95], v[140:143]
    ds_read_b128 v[244:247], v12 offset:3072
    v_mfma_f32_16x16x32_bf16 v[124:127], v[188:191], v[88:91], v[124:127]
    ds_read_b64_tr_b16 v[24:25], v13 offset:32768
    v_mfma_f32_16x16x32_bf16 v[128:131], v[192:195], v[88:91], v[128:131]
    ds_read_b64_tr_b16 v[26:27], v13 offset:36864
    ds_read_b64_tr_b16 v[28:29], v14 offset:32768
    v_mfma_f32_16x16x32_bf16 v[144:147], v[192:195], v[92:95], v[144:147]
    ds_read_b64_tr_b16 v[30:31], v14 offset:36864
    v_mfma_f32_16x16x32_bf16 v[148:151], v[196:199], v[92:95], v[148:151]
    ds_read_b64_tr_b16 v[32:33], v15 offset:32768
    v_mfma_f32_16x16x32_bf16 v[132:135], v[196:199], v[88:91], v[132:135]
    ds_read_b64_tr_b16 v[34:35], v15 offset:36864
    s_waitcnt lgkmcnt(10)
    v_mfma_f32_16x16x32_bf16 v[120:123], v[200:203], v[96:99], v[120:123]
    ds_read_b64_tr_b16 v[36:37], v16 offset:32768
    ds_read_b64_tr_b16 v[38:39], v16 offset:36864
    v_mfma_f32_16x16x32_bf16 v[136:139], v[200:203], v[100:103], v[136:139]
    ds_read_b64_tr_b16 v[40:41], v13 offset:40960
    v_mfma_f32_16x16x32_bf16 v[140:143], v[204:207], v[100:103], v[140:143]
    ds_read_b64_tr_b16 v[42:43], v13 offset:45056
    v_mfma_f32_16x16x32_bf16 v[124:127], v[204:207], v[96:99], v[124:127]
    ds_read_b64_tr_b16 v[44:45], v14 offset:40960
    v_mfma_f32_16x16x32_bf16 v[128:131], v[208:211], v[96:99], v[128:131]
    ds_read_b64_tr_b16 v[46:47], v14 offset:45056
    ds_read_b64_tr_b16 v[48:49], v15 offset:40960
    v_mfma_f32_16x16x32_bf16 v[144:147], v[208:211], v[100:103], v[144:147]
    ds_read_b64_tr_b16 v[50:51], v15 offset:45056
    v_mfma_f32_16x16x32_bf16 v[148:151], v[212:215], v[100:103], v[148:151]
    ds_read_b64_tr_b16 v[52:53], v16 offset:40960
    v_mfma_f32_16x16x32_bf16 v[132:135], v[212:215], v[96:99], v[132:135]
    ds_read_b64_tr_b16 v[54:55], v16 offset:45056
    s_waitcnt lgkmcnt(8)
    v_mfma_f32_16x16x32_bf16 v[120:123], v[24:27], v[232:235], v[120:123]
    ds_read_b128 v[88:91], v12 offset:4096
    ds_read_b128 v[92:95], v12 offset:6144
    v_mfma_f32_16x16x32_bf16 v[136:139], v[24:27], v[236:239], v[136:139]
    ds_read_b128 v[96:99], v12 offset:5120
    v_mfma_f32_16x16x32_bf16 v[140:143], v[28:31], v[236:239], v[140:143]
    ds_read_b128 v[100:103], v12 offset:7168
    v_mfma_f32_16x16x32_bf16 v[124:127], v[28:31], v[232:235], v[124:127]
    ds_read_b64_tr_b16 v[184:185], v18 offset:0
    buffer_load_dwordx4 v[152:155], v2, s[24:27], s40 offen offset:0 sc1
    buffer_load_dwordx4 v[156:159], v2, s[24:27], s40 offen offset:1024 sc1
    buffer_load_dwordx4 v[160:163], v2, s[24:27], s12 offen offset:0 sc1
    buffer_load_dwordx4 v[164:167], v2, s[24:27], s12 offen offset:1024 sc1
    v_mfma_f32_16x16x32_bf16 v[128:131], v[32:35], v[232:235], v[128:131]
    ds_read_b64_tr_b16 v[186:187], v18 offset:4096
    ds_read_b64_tr_b16 v[188:189], v19 offset:0
    v_mfma_f32_16x16x32_bf16 v[144:147], v[32:35], v[236:239], v[144:147]
    ds_read_b64_tr_b16 v[190:191], v19 offset:4096
    v_mfma_f32_16x16x32_bf16 v[148:151], v[36:39], v[236:239], v[148:151]
    ds_read_b64_tr_b16 v[192:193], v20 offset:0
    v_mfma_f32_16x16x32_bf16 v[132:135], v[36:39], v[232:235], v[132:135]
    ds_read_b64_tr_b16 v[194:195], v20 offset:4096
    s_waitcnt lgkmcnt(10)
    v_mfma_f32_16x16x32_bf16 v[120:123], v[40:43], v[240:243], v[120:123]
    ds_read_b64_tr_b16 v[196:197], v21 offset:0
    ds_read_b64_tr_b16 v[198:199], v21 offset:4096
    v_mfma_f32_16x16x32_bf16 v[136:139], v[40:43], v[244:247], v[136:139]
    ds_read_b64_tr_b16 v[200:201], v18 offset:8192
    v_mfma_f32_16x16x32_bf16 v[140:143], v[44:47], v[244:247], v[140:143]
    ds_read_b64_tr_b16 v[202:203], v18 offset:12288
    v_mfma_f32_16x16x32_bf16 v[124:127], v[44:47], v[240:243], v[124:127]
    ds_read_b64_tr_b16 v[204:205], v19 offset:8192
    v_mfma_f32_16x16x32_bf16 v[128:131], v[48:51], v[240:243], v[128:131]
    ds_read_b64_tr_b16 v[206:207], v19 offset:12288
    ds_read_b64_tr_b16 v[208:209], v20 offset:8192
    v_mfma_f32_16x16x32_bf16 v[144:147], v[48:51], v[244:247], v[144:147]
    ds_read_b64_tr_b16 v[210:211], v20 offset:12288
    v_mfma_f32_16x16x32_bf16 v[148:151], v[52:55], v[244:247], v[148:151]
    ds_read_b64_tr_b16 v[212:213], v21 offset:8192
    v_mfma_f32_16x16x32_bf16 v[132:135], v[52:55], v[240:243], v[132:135]
    ds_read_b64_tr_b16 v[214:215], v21 offset:12288
    s_waitcnt lgkmcnt(8)
    v_mfma_f32_16x16x32_bf16 v[120:123], v[184:187], v[88:91], v[120:123]
    v_mfma_f32_16x16x32_bf16 v[136:139], v[184:187], v[92:95], v[136:139]
    v_mfma_f32_16x16x32_bf16 v[140:143], v[188:191], v[92:95], v[140:143]
    v_mfma_f32_16x16x32_bf16 v[124:127], v[188:191], v[88:91], v[124:127]
    v_mfma_f32_16x16x32_bf16 v[128:131], v[192:195], v[88:91], v[128:131]
    v_mfma_f32_16x16x32_bf16 v[144:147], v[192:195], v[92:95], v[144:147]
    v_mfma_f32_16x16x32_bf16 v[148:151], v[196:199], v[92:95], v[148:151]
    v_mfma_f32_16x16x32_bf16 v[132:135], v[196:199], v[88:91], v[132:135]
    s_waitcnt lgkmcnt(0)
    s_barrier
    v_mfma_f32_16x16x32_bf16 v[120:123], v[200:203], v[96:99], v[120:123]
    v_mfma_f32_16x16x32_bf16 v[136:139], v[200:203], v[100:103], v[136:139]
    v_mfma_f32_16x16x32_bf16 v[140:143], v[204:207], v[100:103], v[140:143]
    v_mfma_f32_16x16x32_bf16 v[124:127], v[204:207], v[96:99], v[124:127]
    v_mfma_f32_16x16x32_bf16 v[128:131], v[208:211], v[96:99], v[128:131]
    v_mfma_f32_16x16x32_bf16 v[144:147], v[208:211], v[100:103], v[144:147]
    v_mfma_f32_16x16x32_bf16 v[148:151], v[212:215], v[100:103], v[148:151]
    v_mfma_f32_16x16x32_bf16 v[132:135], v[212:215], v[96:99], v[132:135]
    s_mov_b32 s53, 0
dw_23:
    s_waitcnt vmcnt(0)
    v_and_b32 v6, v152, v153
    v_and_b32 v7, v160, v161
    v_bitop3_b32 v6, v154, v155, v6 bitop3:0x80
    v_bitop3_b32 v7, v162, v163, v7 bitop3:0x80
    v_bitop3_b32 v6, v156, v157, v6 bitop3:0x80
    v_bitop3_b32 v7, v164, v165, v7 bitop3:0x80
    v_bitop3_b32 v6, v158, v159, v6 bitop3:0x80
    v_bitop3_b32 v7, v166, v167, v7 bitop3:0x80
    v_bitop3_b32 v6, v6, v7, 1 bitop3:0x80
    v_cmp_eq_u32 vcc, 0, v6
    s_nop 0
    s_cmp_eq_u64 vcc, 0
    s_cbranch_scc1 dok_24
    s_mov_b64 exec, vcc
    s_sleep 1
    buffer_load_dwordx4 v[152:155], v2, s[24:27], s40 offen offset:0 sc1
    buffer_load_dwordx4 v[156:159], v2, s[24:27], s40 offen offset:1024 sc1
    buffer_load_dwordx4 v[160:163], v2, s[24:27], s12 offen offset:0 sc1
    buffer_load_dwordx4 v[164:167], v2, s[24:27], s12 offen offset:1024 sc1
    s_add_u32 s53, s53, 1
    s_cmp_lt_u32 s53, s61
    s_cbranch_scc1 dw_23
    s_mov_b32 s61, 0
    s_waitcnt vmcnt(0)
dok_24:
    s_mov_b64 exec, -1
    v_mfma_f32_16x16x32_bf16 v[120:123], v[226:229], v[152:155], v[120:123]
    v_mfma_f32_16x16x32_bf16 v[124:127], v[224:227], v[152:155], v[124:127]
    v_mfma_f32_16x16x32_bf16 v[128:131], v[226:229], v[156:159], v[128:131]
    v_mfma_f32_16x16x32_bf16 v[132:135], v[224:227], v[156:159], v[132:135]
    v_mfma_f32_16x16x32_bf16 v[136:139], v[226:229], v[160:163], v[136:139]
    v_mfma_f32_16x16x32_bf16 v[140:143], v[224:227], v[160:163], v[140:143]
    v_mfma_f32_16x16x32_bf16 v[144:147], v[226:229], v[164:167], v[144:147]
    v_mfma_f32_16x16x32_bf16 v[148:151], v[224:227], v[164:167], v[148:151]
    s_cmp_eq_u32 s60, 1
    s_cbranch_scc1 G4_last
    s_cmp_eq_u32 s98, 0
    s_cbranch_scc1 G4_near
    v_and_or_b32 v120, v120, s15, v56
    v_and_or_b32 v122, v122, s15, v56
    v_and_or_b32 v124, v124, s15, v56
    v_and_or_b32 v126, v126, s15, v56
    v_cvt_pk_bf16_f32 v120, v120, v121
    v_cvt_pk_bf16_f32 v121, v122, v123
    v_cvt_pk_bf16_f32 v122, v124, v125
    v_cvt_pk_bf16_f32 v123, v126, v127
    buffer_store_dwordx4 v[120:123], v2, s[88:91], s40 offen offset:0 sc1
    v_and_or_b32 v128, v128, s15, v56
    v_and_or_b32 v130, v130, s15, v56
    v_and_or_b32 v132, v132, s15, v56
    v_and_or_b32 v134, v134, s15, v56
    v_cvt_pk_bf16_f32 v128, v128, v129
    v_cvt_pk_bf16_f32 v129, v130, v131
    v_cvt_pk_bf16_f32 v130, v132, v133
    v_cvt_pk_bf16_f32 v131, v134, v135
    buffer_store_dwordx4 v[128:131], v2, s[88:91], s40 offen offset:1024 sc1
    s_add_u32 s36, s40, 65536
    v_and_or_b32 v136, v136, s15, v56
    v_and_or_b32 v138, v138, s15, v56
    v_and_or_b32 v140, v140, s15, v56
    v_and_or_b32 v142, v142, s15, v56
    v_cvt_pk_bf16_f32 v136, v136, v137
    v_cvt_pk_bf16_f32 v137, v138, v139
    v_cvt_pk_bf16_f32 v138, v140, v141
    v_cvt_pk_bf16_f32 v139, v142, v143
    buffer_store_dwordx4 v[136:139], v2, s[88:91], s36 offen offset:0 sc1
    v_and_or_b32 v144, v144, s15, v56
    v_and_or_b32 v146, v146, s15, v56
    v_and_or_b32 v148, v148, s15, v56
    v_and_or_b32 v150, v150, s15, v56
    v_cvt_pk_bf16_f32 v144, v144, v145
    v_cvt_pk_bf16_f32 v145, v146, v147
    v_cvt_pk_bf16_f32 v146, v148, v149
    v_cvt_pk_bf16_f32 v147, v150, v151
    buffer_store_dwordx4 v[144:147], v2, s[88:91], s36 offen offset:1024 sc1
    s_branch G4_out
G4_near:
    v_and_or_b32 v120, v120, s15, v56
    v_and_or_b32 v122, v122, s15, v56
    v_and_or_b32 v124, v124, s15, v56
    v_and_or_b32 v126, v126, s15, v56
    v_cvt_pk_bf16_f32 v120, v120, v121
    v_cvt_pk_bf16_f32 v121, v122, v123
    v_cvt_pk_bf16_f32 v122, v124, v125
    v_cvt_pk_bf16_f32 v123, v126, v127
    buffer_store_dwordx4 v[120:123], v2, s[88:91], s40 offen offset:0
    v_and_or_b32 v128, v128, s15, v56
    v_and_or_b32 v130, v130, s15, v56
    v_and_or_b32 v132, v132, s15, v56
    v_and_or_b32 v134, v134, s15, v56
    v_cvt_pk_bf16_f32 v128, v128, v129
    v_cvt_pk_bf16_f32 v129, v130, v131
    v_cvt_pk_bf16_f32 v130, v132, v133
    v_cvt_pk_bf16_f32 v131, v134, v135
    buffer_store_dwordx4 v[128:131], v2, s[88:91], s40 offen offset:1024
    s_add_u32 s36, s40, 65536
    v_and_or_b32 v136, v136, s15, v56
    v_and_or_b32 v138, v138, s15, v56
    v_and_or_b32 v140, v140, s15, v56
    v_and_or_b32 v142, v142, s15, v56
    v_cvt_pk_bf16_f32 v136, v136, v137
    v_cvt_pk_bf16_f32 v137, v138, v139
    v_cvt_pk_bf16_f32 v138, v140, v141
    v_cvt_pk_bf16_f32 v139, v142, v143
    buffer_store_dwordx4 v[136:139], v2, s[88:91], s36 offen offset:0
    v_and_or_b32 v144, v144, s15, v56
    v_and_or_b32 v146, v146, s15, v56
    v_and_or_b32 v148, v148, s15, v56
    v_and_or_b32 v150, v150, s15, v56
    v_cvt_pk_bf16_f32 v144, v144, v145
    v_cvt_pk_bf16_f32 v145, v146, v147
    v_cvt_pk_bf16_f32 v146, v148, v149
    v_cvt_pk_bf16_f32 v147, v150, v151
    buffer_store_dwordx4 v[144:147], v2, s[88:91], s36 offen offset:1024
G4_out:
    v_and_b32 v81, 7, v0
    v_lshrrev_b32 v84, 6, v0
    v_lshlrev_b32 v84, 4, v84
    v_bfe_u32 v85, v0, 3, 3
    v_add_u32 v84, v84, v85
    s_lshr_b32 s78, s67, 1
    s_lshl_b32 s78, s78, 16
    s_and_b32 s79, s67, 1
    s_lshl_b32 s79, s79, 7
    s_add_u32 s78, s78, s79
    s_lshr_b32 s79, s30, 1
    s_lshl_b32 s79, s79, 13
    s_add_u32 s78, s78, s79
    v_lshlrev_b32 v78, 8, v84
    v_lshl_add_u32 v78, v81, 4, v78
    v_add_u32 v78, s78, v78
    s_lshl_b32 s78, s28, 7
    s_lshl_b32 s79, s67, 3
    s_add_u32 s78, s78, s79
    v_add_u32 v79, s78, v81
    v_lshlrev_b32 v80, 11, v79
    v_and_b32 v85, 3, v79
    v_lshrrev_b32 v82, 2, v79
    v_lshlrev_b32 v82, 14, v82
    v_lshl_add_u32 v82, v85, 11, v82
    v_lshl_add_u32 v82, v84, 4, v82
    v_lshrrev_b32 v85, 2, v84
    v_lshlrev_b32 v85, 3, v85
    v_and_b32 v84, 3, v84
    v_add_u32 v84, v84, v85
    v_lshl_add_u32 v80, v84, 3, v80
    v_lshlrev_b32 v79, 3, v79
    v_lshl_add_u32 v79, v84, 14, v79
    s_add_u32 s80, s4, 0x1800000
    s_addc_u32 s81, s5, 0
    s_mov_b32 s82, 0x400000
    s_mov_b32 s83, 0x20000
    s_mov_b32 s78, 0
    buffer_load_dwordx2 v[110:111], v79, s[80:83], s78 offen sc1
    s_mov_b32 s78, 65536
    buffer_load_dwordx2 v[112:113], v79, s[80:83], s78 offen sc1
    s_mov_b32 s78, 262144
    buffer_load_dwordx2 v[114:115], v79, s[80:83], s78 offen sc1
    s_mov_b32 s78, 327680
    buffer_load_dwordx2 v[116:117], v79, s[80:83], s78 offen sc1
    s_branch NEXT
G4_last:
    v_cvt_pk_bf16_f32 v120, v120, v121
    v_cvt_pk_bf16_f32 v121, v122, v123
    v_cvt_pk_bf16_f32 v122, v124, v125
    v_cvt_pk_bf16_f32 v123, v126, v127
    s_nop 0
    v_permlane16_swap_b32 v120, v122
    v_permlane16_swap_b32 v121, v123
    v_cvt_pk_bf16_f32 v128, v128, v129
    v_cvt_pk_bf16_f32 v129, v130, v131
    v_cvt_pk_bf16_f32 v130, v132, v133
    v_cvt_pk_bf16_f32 v131, v134, v135
    s_nop 0
    v_permlane16_swap_b32 v128, v130
    v_permlane16_swap_b32 v129, v131
    v_mov_b32 v132, v120
    v_mov_b32 v133, v121
    v_mov_b32 v134, v122
    v_mov_b32 v135, v123
    v_mov_b32_dpp v120, v128 row_ror:8 row_mask:0xf bank_mask:0xc
    v_mov_b32_dpp v121, v129 row_ror:8 row_mask:0xf bank_mask:0xc
    v_mov_b32_dpp v122, v130 row_ror:8 row_mask:0xf bank_mask:0xc
    v_mov_b32_dpp v123, v131 row_ror:8 row_mask:0xf bank_mask:0xc
    v_mov_b32_dpp v128, v132 row_ror:8 row_mask:0xf bank_mask:0x3
    v_mov_b32_dpp v129, v133 row_ror:8 row_mask:0xf bank_mask:0x3
    v_mov_b32_dpp v130, v134 row_ror:8 row_mask:0xf bank_mask:0x3
    v_mov_b32_dpp v131, v135 row_ror:8 row_mask:0xf bank_mask:0x3
    buffer_store_dwordx4 v[120:123], v10, s[20:23], s38 offen sc1
    buffer_store_dwordx4 v[128:131], v11, s[20:23], s38 offen sc1
    v_cvt_pk_bf16_f32 v136, v136, v137
    v_cvt_pk_bf16_f32 v137, v138, v139
    v_cvt_pk_bf16_f32 v138, v140, v141
    v_cvt_pk_bf16_f32 v139, v142, v143
    s_nop 0
    v_permlane16_swap_b32 v136, v138
    v_permlane16_swap_b32 v137, v139
    v_cvt_pk_bf16_f32 v144, v144, v145
    v_cvt_pk_bf16_f32 v145, v146, v147
    v_cvt_pk_bf16_f32 v146, v148, v149
    v_cvt_pk_bf16_f32 v147, v150, v151
    s_nop 0
    v_permlane16_swap_b32 v144, v146
    v_permlane16_swap_b32 v145, v147
    v_mov_b32 v148, v136
    v_mov_b32 v149, v137
    v_mov_b32 v150, v138
    v_mov_b32 v151, v139
    v_mov_b32_dpp v136, v144 row_ror:8 row_mask:0xf bank_mask:0xc
    v_mov_b32_dpp v137, v145 row_ror:8 row_mask:0xf bank_mask:0xc
    v_mov_b32_dpp v138, v146 row_ror:8 row_mask:0xf bank_mask:0xc
    v_mov_b32_dpp v139, v147 row_ror:8 row_mask:0xf bank_mask:0xc
    v_mov_b32_dpp v144, v148 row_ror:8 row_mask:0xf bank_mask:0x3
    v_mov_b32_dpp v145, v149 row_ror:8 row_mask:0xf bank_mask:0x3
    v_mov_b32_dpp v146, v150 row_ror:8 row_mask:0xf bank_mask:0x3
    v_mov_b32_dpp v147, v151 row_ror:8 row_mask:0xf bank_mask:0x3
    buffer_store_dwordx4 v[136:139], v10, s[20:23], s39 offen sc1
    buffer_store_dwordx4 v[144:147], v11, s[20:23], s39 offen sc1
    s_branch K_fin
LOADERS:
    s_mov_b64 s[80:81], s[68:69]
    s_mov_b32 s82, 2097152
    s_mov_b32 s83, 0x20000
    s_cmp_lg_u32 s60, 0
    s_cbranch_scc1 WY_1
    ds_read_b64_tr_b16 v[128:129], v74 offset:0
    ds_read_b64_tr_b16 v[130:131], v74 offset:2048
    ds_read_b64_tr_b16 v[136:137], v74 offset:4096
    ds_read_b64_tr_b16 v[138:139], v74 offset:6144
    ds_read_b64_tr_b16 v[144:145], v74 offset:8192
    ds_read_b64_tr_b16 v[146:147], v74 offset:10240
    ds_read_b64_tr_b16 v[152:153], v74 offset:12288
    ds_read_b64_tr_b16 v[154:155], v74 offset:14336
    ds_read_b64_tr_b16 v[160:161], v74 offset:16384
    ds_read_b64_tr_b16 v[162:163], v74 offset:18432
    ds_read_b64_tr_b16 v[168:169], v74 offset:20480
    ds_read_b64_tr_b16 v[170:171], v74 offset:22528
    ds_read_b64_tr_b16 v[176:177], v75 offset:16384
    ds_read_b64_tr_b16 v[178:179], v75 offset:18432
    ds_read_b64_tr_b16 v[184:185], v75 offset:20480
    ds_read_b64_tr_b16 v[186:187], v75 offset:22528
    ds_read_b64_tr_b16 v[192:193], v75 offset:24576
    ds_read_b64_tr_b16 v[194:195], v75 offset:26624
    ds_read_b64_tr_b16 v[200:201], v75 offset:28672
    ds_read_b64_tr_b16 v[202:203], v75 offset:30720
    ds_read_b64_tr_b16 v[208:209], v74 offset:32768
    ds_read_b64_tr_b16 v[210:211], v74 offset:34816
    ds_read_b64_tr_b16 v[216:217], v74 offset:36864
    ds_read_b64_tr_b16 v[218:219], v74 offset:38912
    ds_read_b64_tr_b16 v[224:225], v74 offset:40960
    ds_read_b64_tr_b16 v[226:227], v74 offset:43008
    ds_read_b64_tr_b16 v[232:233], v74 offset:45056
    ds_read_b64_tr_b16 v[234:235], v74 offset:47104
    ds_read_b64_tr_b16 v[240:241], v75 offset:32768
    ds_read_b64_tr_b16 v[242:243], v75 offset:34816
    ds_read_b64_tr_b16 v[248:249], v75 offset:36864
    ds_read_b64_tr_b16 v[250:251], v75 offset:38912
    s_branch WY_2
WY_1:
    s_and_b32 s49, s30, 3
    s_lshl_b32 s36, s49, 14
    s_lshl_b32 s48, s29, 7
    s_add_u32 s48, s48, s36
    s_lshl_b32 s49, s49, 10
    s_xor_b32 s48, s48, 128
    s_add_u32 s36, s48, 917504
    s_add_u32 m0, s49, 81920
    s_nop 0
    buffer_load_dwordx4 v118, s[80:83], s36 offen lds
    s_add_u32 s36, s36, 65536
    s_add_u32 m0, s49, 86016
    s_nop 0
    buffer_load_dwordx4 v118, s[80:83], s36 offen lds
    s_add_u32 s36, s48, 1048576
    s_add_u32 m0, s49, 90112
    s_nop 0
    buffer_load_dwordx4 v118, s[80:83], s36 offen lds
    s_add_u32 s36, s36, 65536
    s_add_u32 m0, s49, 94208
    s_nop 0
    buffer_load_dwordx4 v118, s[80:83], s36 offen lds
WY_2:
    v_and_b32 v8, 15, v1
    v_lshrrev_b32 v9, 4, v1
    s_and_b32 s34, s30, 1
    s_and_b32 s37, s30, 3
    s_lshr_b32 s38, s29, 3
    s_add_u32 s38, s38, 1
    s_sub_u32 s39, 0, s38
    s_bitcmp1_b32 s29, 2
    s_cselect_b32 s38, s38, s39
    s_lshl_b32 s35, s28, 7
    s_cmp_lt_u32 s37, 2
    s_cselect_b32 s36, s38, 0
    s_add_u32 s36, s36, s35
    s_lshl_b32 s45, s34, 6
    s_add_u32 s36, s36, s45
    v_add_u32 v72, s36, v1
    s_movk_i32 s45, 2048
    v_cmp_gt_u32 s[46:47], s45, v72
    v_lshlrev_b32 v72, 4, v72
    s_lshl_b32 s22, s60, 15
    s_add_u32 s22, s22, 23199744
    s_add_u32 s20, s4, s22
    s_addc_u32 s21, s5, 0
    s_mov_b32 s22, 32768
    s_mov_b32 s23, 0x20000
    s_lshl_b32 s36, s37, 2
    v_add_u32 v6, s36, v9
    v_xor_b32 v10, v6, v8
    s_add_u32 s36, s35, s38
    s_add_u32 s36, s36, 16
    v_add_u32 v6, s36, v6
    v_and_b32 v7, 3, v6
    v_lshrrev_b32 v11, 2, v6
    v_lshlrev_b32 v11, 14, v11
    v_lshl_add_u32 v11, v7, 11, v11
    v_lshl_add_u32 v11, v10, 4, v11
    v_subrev_u32 v10, 65536, v11
    s_lshl_b32 s44, s37, 10
    s_lshl_b32 s14, s60, 24
    s_lshl_b32 s15, s94, 13
    s_add_u32 s14, s14, s15
    s_add_u32 s14, s14, 167772160
    s_add_u32 s12, s4, s14
    s_addc_u32 s13, s5, 0
    s_mov_b32 s14, 8380416
    s_mov_b32 s15, 0x20000
    s_cmp_lg_u32 s60, 0
    s_waitcnt vmcnt(4)
    s_cbranch_scc1 WY_6
    s_waitcnt vmcnt(0) lgkmcnt(0)
    s_barrier
    s_and_b32 s49, s30, 3
    s_lshl_b32 s36, s49, 14
    s_lshl_b32 s48, s29, 7
    s_add_u32 s48, s48, s36
    s_lshl_b32 s49, s49, 10
    s_xor_b32 s48, s48, 128
    s_add_u32 s36, s48, 917504
    s_add_u32 m0, s49, 81920
    s_nop 0
    buffer_load_dwordx4 v118, s[80:83], s36 offen lds
    s_add_u32 s36, s36, 65536
    s_add_u32 m0, s49, 86016
    s_nop 0
    buffer_load_dwordx4 v118, s[80:83], s36 offen lds
    s_add_u32 s36, s48, 1048576
    s_add_u32 m0, s49, 90112
    s_nop 0
    buffer_load_dwordx4 v118, s[80:83], s36 offen lds
    s_add_u32 s36, s36, 65536
    s_add_u32 m0, s49, 94208
    s_nop 0
    buffer_load_dwordx4 v118, s[80:83], s36 offen lds
    s_branch WY_7
WY_6:
    s_barrier
WY_7:
    s_add_u32 s36, s48, 131072
    s_add_u32 m0, s49, 32768
    s_nop 0
    buffer_load_dwordx4 v118, s[80:83], s36 offen lds
    s_add_u32 s36, s36, 65536
    s_add_u32 m0, s49, 36864
    s_nop 0
    buffer_load_dwordx4 v118, s[80:83], s36 offen lds
    s_add_u32 s36, s48, 262144
    s_add_u32 m0, s49, 40960
    s_nop 0
    buffer_load_dwordx4 v118, s[80:83], s36 offen lds
    s_add_u32 s36, s36, 65536
    s_add_u32 m0, s49, 45056
    s_nop 0
    buffer_load_dwordx4 v118, s[80:83], s36 offen lds
    s_add_u32 s36, s48, 1179648
    s_add_u32 m0, s49, 98304
    s_nop 0
    buffer_load_dwordx4 v118, s[80:83], s36 offen lds
    s_add_u32 s36, s36, 65536
    s_add_u32 m0, s49, 102400
    s_nop 0
    buffer_load_dwordx4 v118, s[80:83], s36 offen lds
    s_add_u32 s36, s48, 1310720
    s_add_u32 m0, s49, 106496
    s_nop 0
    buffer_load_dwordx4 v118, s[80:83], s36 offen lds
    s_add_u32 s36, s36, 65536
    s_add_u32 m0, s49, 110592
    s_nop 0
    buffer_load_dwordx4 v118, s[80:83], s36 offen lds
    v_lshrrev_b32 v6, 3, v1
    v_and_b32 v17, 7, v1
    v_xor_b32 v17, v17, v6
    s_lshl_b32 s36, s37, 3
    s_add_u32 s36, s36, s35
    v_add_u32 v6, s36, v6
    v_and_b32 v7, 3, v6
    v_lshrrev_b32 v12, 2, v6
    v_lshlrev_b32 v12, 14, v12
    v_lshl_add_u32 v12, v7, 11, v12
    s_lshl_b32 s36, s29, 7
    v_lshl_add_u32 v12, v17, 4, v12
    v_add_u32 v12, s36, v12
    v_lshrrev_b32 v6, 1, v9
    s_lshl_b32 s36, s37, 1
    v_add_u32 v6, s36, v6
    v_and_b32 v7, 7, v8
    v_xor_b32 v6, v6, v7
    v_lshlrev_b32 v17, 7, v8
    v_lshl_add_u32 v17, v6, 4, v17
    v_and_b32 v6, 1, v9
    v_lshl_add_u32 v17, v6, 3, v17
    v_and_b32 v6, 1, v9
    v_lshlrev_b32 v13, 16, v6
    v_lshrrev_b32 v6, 1, v9
    v_lshl_add_u32 v13, v6, 8, v13
    v_lshl_add_u32 v13, v8, 4, v13
    s_bfe_u32 s36, s30, 0x10001
    s_lshl1_add_u32 s36, s29, s36
    s_lshr_b32 s53, s36, 3
    s_lshl_b32 s53, s53, 14
    s_and_b32 s39, s36, 7
    s_lshl_b32 s39, s39, 10
    s_add_u32 s39, s39, s53
    s_and_b32 s36, s30, 1
    s_lshl_b32 s36, s36, 9
    s_add_u32 s39, s39, s36
    v_mov_b32 v14, v2
    v_add_u32 v15, 106496, v2
    v_lshrrev_b32 v6, 5, v13
    v_and_b32 v6, 2048, v6
    v_and_b32 v16, 511, v13
    v_add_u32 v16, v16, v6
    s_lshl_b32 s36, s37, 9
    v_add_u32 v16, s36, v16
    s_add_u32 s16, s62, 0x400000
    s_addc_u32 s17, s63, 0
    s_mov_b32 s18, 0x7e000
    s_mov_b32 s19, 0x20000
    s_add_u32 s24, s62, 0x480000
    s_addc_u32 s25, s63, 0
    s_mov_b32 s26, 0x7e000
    s_mov_b32 s27, 0x20000
    s_and_b32 s78, s30, 3
    s_lshl_b32 s78, s78, 15
    s_and_b32 s53, s30, 2
    s_lshl_b32 s53, s53, 11
    s_and_b32 s82, s30, 1
    s_lshl_b32 s82, s82, 13
    s_add_u32 s82, s82, s53
    s_and_b32 s84, s30, 1
    s_lshl_b32 s84, s84, 8
    s_add_u32 s84, s84, s55
    s_add_u32 s85, s52, 16
    s_mov_b64 s[8:9], s[72:73]
    s_mov_b32 s10, 7340032
    s_mov_b32 s11, 0x20000
    s_add_u32 s89, s29, 1
    s_and_b32 s89, s89, 15
    s_cmp_lg_u32 s28, s29
    s_cselect_b32 s89, s28, s89
    s_and_b32 s90, s30, 3
    s_mul_i32 s36, s29, 448
    s_lshl2_add_u32 s88, s29, s90
    s_mul_i32 s88, s88, 114688
    s_add_u32 s88, s88, s36
    s_lshl2_add_u32 s89, s89, s90
    s_mul_i32 s89, s89, 114688
    s_add_u32 s89, s89, s36
    s_mul_i32 s90, s90, 7168
    s_waitcnt vmcnt(0) lgkmcnt(0)
    s_setprio 1
    s_add_u32 m0, s44, 122880
    s_mov_b32 s49, 0
    s_barrier
    buffer_load_dwordx4 v[52:55], v72, s[20:23], 0 offen sc1
    buffer_load_dwordx4 v10, s[12:15], s49 offen offset:0 sc1 lds
    s_add_u32 m0, s44, 130048
    s_nop 0
    buffer_load_dwordx4 v10, s[12:15], s49 offen offset:1024 sc1 lds
    s_add_u32 m0, s44, 126976
    s_nop 0
    buffer_load_dwordx4 v11, s[12:15], s49 offen offset:0 sc1 lds
    s_add_u32 m0, s44, 134144
    s_nop 0
    buffer_load_dwordx4 v11, s[12:15], s49 offen offset:1024 sc1 lds
    s_add_u32 m0, s44, 139264
    s_mov_b32 s49, 256
    buffer_load_dwordx4 v10, s[12:15], s49 offen offset:0 sc1 lds
    s_add_u32 m0, s44, 146432
    s_nop 0
    buffer_load_dwordx4 v10, s[12:15], s49 offen offset:1024 sc1 lds
    s_add_u32 m0, s44, 143360
    s_nop 0
    buffer_load_dwordx4 v11, s[12:15], s49 offen offset:0 sc1 lds
    s_add_u32 m0, s44, 150528
    s_nop 0
    buffer_load_dwordx4 v11, s[12:15], s49 offen offset:1024 sc1 lds
    s_add_u32 m0, s44, 16384
    s_mov_b32 s49, 512
    buffer_load_dwordx4 v10, s[12:15], s49 offen offset:0 sc1 lds
    s_add_u32 m0, s44, 23552
    s_nop 0
    buffer_load_dwordx4 v10, s[12:15], s49 offen offset:1024 sc1 lds
    s_add_u32 m0, s44, 20480
    s_nop 0
    buffer_load_dwordx4 v11, s[12:15], s49 offen offset:0 sc1 lds
    s_add_u32 m0, s44, 27648
    s_nop 0
    buffer_load_dwordx4 v11, s[12:15], s49 offen offset:1024 sc1 lds
    s_add_u32 m0, s44, 32768
    s_mov_b32 s49, 768
    s_waitcnt vmcnt(8)
    s_barrier
    buffer_load_dwordx4 v10, s[12:15], s49 offen offset:0 sc1 lds
    s_add_u32 m0, s44, 39936
    s_nop 0
    buffer_load_dwordx4 v10, s[12:15], s49 offen offset:1024 sc1 lds
    s_add_u32 m0, s44, 36864
    s_nop 0
    buffer_load_dwordx4 v11, s[12:15], s49 offen offset:0 sc1 lds
    s_add_u32 m0, s44, 44032
    s_nop 0
    buffer_load_dwordx4 v11, s[12:15], s49 offen offset:1024 sc1 lds
    v_mov_b32 v10, v11
    v_add_u32 v11, 65536, v11
    s_mov_b32 s53, 0
lns_25:
    v_cmp_eq_u32 vcc, s52, v53
    v_cmp_eq_u32 s[50:51], s52, v55
    s_nop 0
    s_and_b64 vcc, vcc, s[50:51]
    s_orn2_b64 vcc, vcc, s[46:47]
    s_cmp_eq_u64 vcc, -1
    s_cbranch_scc1 lnk_26
    buffer_load_dwordx4 v[52:55], v72, s[20:23], 0 offen sc1
    s_waitcnt vmcnt(0)
    s_add_u32 s53, s53, 1
    s_cmp_lt_u32 s53, s61
    s_cbranch_scc1 lns_25
    s_mov_b32 s61, 0
lnk_26:
    v_lshlrev_b32 v56, 16, v52
    v_and_b32 v57, 0xffff0000, v52
    v_lshlrev_b32 v58, 16, v54
    v_and_b32 v59, 0xffff0000, v54
    v_cndmask_b32 v57, 1.0, v57, s[46:47]
    v_cndmask_b32 v59, 1.0, v59, s[46:47]
    s_lshl_b32 s36, s34, 10
    s_add_u32 s36, s36, 155648
    v_add_u32 v6, s36, v2
    s_cmp_ge_u32 s37, 2
    s_cbranch_scc1 lnx_27
    v_mul_f32 v66, v57, v59
    v_fma_f32 v60, -v58, v57, -v56
    v_rcp_f32 v7, v66
    v_mov_b32 v67, v66
    v_mov_b32 v61, v60
    v_mul_f32 v62, 0xc0135761, v7
    v_mul_f32 v7, v7, v7
    v_mov_b32 v63, v62
    v_mul_f32 v7, 0x3d372713, v7
    v_mul_f32 v64, v7, v62
    v_mov_b32 v65, v64
    ds_write_b128 v6, v[60:63] offset:0
    ds_write_b128 v6, v[64:67] offset:2048
    s_branch lnd_28
lnx_27:
    v_rcp_f32 v60, v57
    s_nop 0
    v_mul_f32 v62, -v56, v60
    v_mov_b32 v61, v60
    v_mov_b32 v63, v62
    ds_write_b128 v6, v[60:63] offset:5120
lnd_28:
    v_lshlrev_b32 v7, 4, v8
    v_add_u32 v7, 160768, v7
    s_add_u32 m0, s44, 106496
    s_mov_b32 s49, 65536
    s_waitcnt vmcnt(8)
    s_barrier
    buffer_load_dwordx4 v10, s[12:15], s49 offen offset:0 sc1 lds
    s_add_u32 m0, s44, 113664
    s_nop 0
    buffer_load_dwordx4 v10, s[12:15], s49 offen offset:1024 sc1 lds
    s_add_u32 m0, s44, 110592
    s_nop 0
    buffer_load_dwordx4 v11, s[12:15], s49 offen offset:0 sc1 lds
    s_add_u32 m0, s44, 117760
    s_nop 0
    buffer_load_dwordx4 v11, s[12:15], s49 offen offset:1024 sc1 lds
    s_add_u32 m0, s44, 122880
    s_mov_b32 s49, 65792
    s_waitcnt vmcnt(8)
    s_barrier
    buffer_load_dwordx4 v10, s[12:15], s49 offen offset:0 sc1 lds
    s_add_u32 m0, s44, 130048
    s_nop 0
    buffer_load_dwordx4 v10, s[12:15], s49 offen offset:1024 sc1 lds
    s_add_u32 m0, s44, 126976
    s_nop 0
    buffer_load_dwordx4 v11, s[12:15], s49 offen offset:0 sc1 lds
    s_add_u32 m0, s44, 134144
    s_nop 0
    buffer_load_dwordx4 v11, s[12:15], s49 offen offset:1024 sc1 lds
    s_add_u32 m0, s44, 139264
    s_mov_b32 s49, 66048
    s_waitcnt vmcnt(8)
    s_barrier
    buffer_load_dwordx4 v10, s[12:15], s49 offen offset:0 sc1 lds
    s_add_u32 m0, s44, 146432
    s_nop 0
    buffer_load_dwordx4 v10, s[12:15], s49 offen offset:1024 sc1 lds
    s_add_u32 m0, s44, 143360
    s_nop 0
    buffer_load_dwordx4 v11, s[12:15], s49 offen offset:0 sc1 lds
    s_add_u32 m0, s44, 150528
    s_nop 0
    buffer_load_dwordx4 v11, s[12:15], s49 offen offset:1024 sc1 lds
    s_waitcnt lgkmcnt(0)
    s_add_u32 m0, s44, 16384
    s_mov_b32 s49, 66304
    s_waitcnt vmcnt(8)
    s_barrier
    buffer_load_dwordx4 v10, s[12:15], s49 offen offset:0 sc1 lds
    s_add_u32 m0, s44, 23552
    s_nop 0
    buffer_load_dwordx4 v10, s[12:15], s49 offen offset:1024 sc1 lds
    s_add_u32 m0, s44, 20480
    s_nop 0
    buffer_load_dwordx4 v11, s[12:15], s49 offen offset:0 sc1 lds
    s_add_u32 m0, s44, 27648
    s_nop 0
    buffer_load_dwordx4 v11, s[12:15], s49 offen offset:1024 sc1 lds
    s_add_u32 m0, s44, 0
    s_mov_b32 s36, 0
    buffer_load_dwordx4 v12, s[12:15], s36 offen sc1 lds
    s_add_u32 m0, s44, 4096
    s_mov_b32 s36, 131072
    buffer_load_dwordx4 v12, s[12:15], s36 offen sc1 lds
    s_add_u32 m0, s44, 8192
    s_mov_b32 s36, 262144
    buffer_load_dwordx4 v12, s[12:15], s36 offen sc1 lds
    s_add_u32 m0, s44, 12288
    s_mov_b32 s36, 393216
    buffer_load_dwordx4 v12, s[12:15], s36 offen sc1 lds
    s_add_u32 m0, s90, 77824
    s_nop 0
    buffer_load_dwordx4 v121, s[8:11], s89 offen lds
    s_add_u32 m0, s90, 78848
    s_nop 0
    buffer_load_dwordx4 v122, s[8:11], s89 offen lds
    s_add_u32 m0, s44, 32768
    s_mov_b32 s49, 196608
    s_waitcnt vmcnt(14)
    s_barrier
    buffer_load_dwordx4 v10, s[12:15], s49 offen offset:0 sc1 lds
    s_add_u32 m0, s44, 39936
    s_nop 0
    buffer_load_dwordx4 v10, s[12:15], s49 offen offset:1024 sc1 lds
    s_add_u32 m0, s44, 36864
    s_nop 0
    buffer_load_dwordx4 v11, s[12:15], s49 offen offset:0 sc1 lds
    s_add_u32 m0, s44, 44032
    s_nop 0
    buffer_load_dwordx4 v11, s[12:15], s49 offen offset:1024 sc1 lds
    s_add_u32 m0, s44, 106496
    s_mov_b32 s49, 196864
    s_waitcnt vmcnt(14)
    s_barrier
    buffer_load_dwordx4 v10, s[12:15], s49 offen offset:0 sc1 lds
    s_add_u32 m0, s44, 113664
    s_nop 0
    buffer_load_dwordx4 v10, s[12:15], s49 offen offset:1024 sc1 lds
    s_add_u32 m0, s44, 110592
    s_nop 0
    buffer_load_dwordx4 v11, s[12:15], s49 offen offset:0 sc1 lds
    s_add_u32 m0, s44, 117760
    s_nop 0
    buffer_load_dwordx4 v11, s[12:15], s49 offen offset:1024 sc1 lds
    s_add_u32 m0, s44, 122880
    s_mov_b32 s49, 197120
    s_waitcnt vmcnt(10)
    s_barrier
    buffer_load_dwordx4 v10, s[12:15], s49 offen offset:0 sc1 lds
    s_add_u32 m0, s44, 130048
    s_nop 0
    buffer_load_dwordx4 v10, s[12:15], s49 offen offset:1024 sc1 lds
    s_add_u32 m0, s44, 126976
    s_nop 0
    buffer_load_dwordx4 v11, s[12:15], s49 offen offset:0 sc1 lds
    s_add_u32 m0, s44, 134144
    s_nop 0
    buffer_load_dwordx4 v11, s[12:15], s49 offen offset:1024 sc1 lds
    ds_read_b64 v[22:23], v17 offset:0
    ds_read_b128 v[60:63], v7 offset:0
    ds_read_b64 v[26:27], v17 offset:2048
    ds_read_b128 v[64:67], v7 offset:256
    s_add_u32 m0, s44, 139264
    s_mov_b32 s49, 197376
    s_waitcnt vmcnt(8)
    s_barrier
    buffer_load_dwordx4 v10, s[12:15], s49 offen offset:0 sc1 lds
    s_waitcnt lgkmcnt(0)
    v_lshlrev_b32 v20, 16, v22
    v_and_b32 v21, 0xffff0000, v22
    v_lshlrev_b32 v22, 16, v23
    v_and_b32 v23, 0xffff0000, v23
    s_add_u32 m0, s44, 146432
    s_nop 0
    buffer_load_dwordx4 v10, s[12:15], s49 offen offset:1024 sc1 lds
    v_pk_fma_f32 v[20:21], v[20:21], v[60:61], v[62:63]
    v_pk_fma_f32 v[22:23], v[22:23], v[60:61], v[62:63]
    v_lshlrev_b32 v24, 16, v26
    v_and_b32 v25, 0xffff0000, v26
    v_lshlrev_b32 v26, 16, v27
    s_add_u32 m0, s44, 143360
    s_nop 0
    buffer_load_dwordx4 v11, s[12:15], s49 offen offset:0 sc1 lds
    v_and_b32 v27, 0xffff0000, v27
    v_pk_fma_f32 v[24:25], v[24:25], v[64:65], v[66:67]
    v_pk_fma_f32 v[26:27], v[26:27], v[64:65], v[66:67]
    s_add_u32 m0, s44, 150528
    s_nop 0
    buffer_load_dwordx4 v11, s[12:15], s49 offen offset:1024 sc1 lds
    ds_read_b64 v[30:31], v17 offset:4096
    ds_read_b128 v[60:63], v7 offset:512
    ds_read_b64 v[34:35], v17 offset:6144
    ds_read_b128 v[64:67], v7 offset:768
    s_add_u32 m0, s90, 79872
    s_nop 0
    buffer_load_dwordx4 v123, s[8:11], s89 offen lds
    s_add_u32 m0, s90, 80896
    s_nop 0
    buffer_load_dwordx4 v124, s[8:11], s89 offen lds
    s_add_u32 m0, s90, 81920
    s_nop 0
    buffer_load_dwordx4 v125, s[8:11], s89 offen lds
    s_add_u32 m0, s90, 82944
    s_nop 0
    buffer_load_dwordx4 v126, s[8:11], s89 offen lds
    s_add_u32 m0, s90, 83968
    s_nop 0
    buffer_load_dwordx4 v127, s[8:11], s89 offen lds
    s_add_u32 m0, s90, 49152
    s_nop 0
    buffer_load_dwordx4 v121, s[8:11], s88 offen lds
    s_add_u32 m0, s44, 16384
    s_mov_b32 s49, 327680
    s_waitcnt vmcnt(14)
    s_barrier
    buffer_load_dwordx4 v10, s[12:15], s49 offen offset:0 sc1 lds
    s_waitcnt lgkmcnt(0)
    v_lshlrev_b32 v28, 16, v30
    v_and_b32 v29, 0xffff0000, v30
    v_lshlrev_b32 v30, 16, v31
    v_and_b32 v31, 0xffff0000, v31
    s_add_u32 m0, s44, 23552
    s_nop 0
    buffer_load_dwordx4 v10, s[12:15], s49 offen offset:1024 sc1 lds
    v_pk_fma_f32 v[28:29], v[28:29], v[60:61], v[62:63]
    v_pk_fma_f32 v[30:31], v[30:31], v[60:61], v[62:63]
    v_lshlrev_b32 v32, 16, v34
    v_and_b32 v33, 0xffff0000, v34
    v_lshlrev_b32 v34, 16, v35
    s_add_u32 m0, s44, 20480
    s_nop 0
    buffer_load_dwordx4 v11, s[12:15], s49 offen offset:0 sc1 lds
    v_and_b32 v35, 0xffff0000, v35
    v_pk_fma_f32 v[32:33], v[32:33], v[64:65], v[66:67]
    v_pk_fma_f32 v[34:35], v[34:35], v[64:65], v[66:67]
    s_add_u32 m0, s44, 27648
    s_nop 0
    buffer_load_dwordx4 v11, s[12:15], s49 offen offset:1024 sc1 lds
    ds_read_b64 v[38:39], v17 offset:8192
    ds_read_b128 v[60:63], v7 offset:1024
    ds_read_b64 v[42:43], v17 offset:10240
    ds_read_b128 v[64:67], v7 offset:1280
    s_add_u32 m0, s44, 32768
    s_mov_b32 s49, 327936
    s_waitcnt vmcnt(14)
    s_barrier
    buffer_load_dwordx4 v10, s[12:15], s49 offen offset:0 sc1 lds
    s_waitcnt lgkmcnt(0)
    v_lshlrev_b32 v36, 16, v38
    v_and_b32 v37, 0xffff0000, v38
    v_lshlrev_b32 v38, 16, v39
    v_and_b32 v39, 0xffff0000, v39
    s_add_u32 m0, s44, 39936
    s_nop 0
    buffer_load_dwordx4 v10, s[12:15], s49 offen offset:1024 sc1 lds
    v_pk_fma_f32 v[36:37], v[36:37], v[60:61], v[62:63]
    v_pk_fma_f32 v[38:39], v[38:39], v[60:61], v[62:63]
    v_lshlrev_b32 v40, 16, v42
    v_and_b32 v41, 0xffff0000, v42
    v_lshlrev_b32 v42, 16, v43
    s_add_u32 m0, s44, 36864
    s_nop 0
    buffer_load_dwordx4 v11, s[12:15], s49 offen offset:0 sc1 lds
    v_and_b32 v43, 0xffff0000, v43
    v_pk_fma_f32 v[40:41], v[40:41], v[64:65], v[66:67]
    v_pk_fma_f32 v[42:43], v[42:43], v[64:65], v[66:67]
    s_add_u32 m0, s44, 44032
    s_nop 0
    buffer_load_dwordx4 v11, s[12:15], s49 offen offset:1024 sc1 lds
    ds_read_b64 v[46:47], v17 offset:12288
    ds_read_b128 v[60:63], v7 offset:1536
    ds_read_b64 v[50:51], v17 offset:14336
    ds_read_b128 v[64:67], v7 offset:1792
    s_add_u32 m0, s44, 106496
    s_mov_b32 s49, 328192
    s_waitcnt vmcnt(14)
    s_barrier
    buffer_load_dwordx4 v10, s[12:15], s49 offen offset:0 sc1 lds
    s_waitcnt lgkmcnt(0)
    v_lshlrev_b32 v44, 16, v46
    v_and_b32 v45, 0xffff0000, v46
    v_lshlrev_b32 v46, 16, v47
    v_and_b32 v47, 0xffff0000, v47
    s_add_u32 m0, s44, 113664
    s_nop 0
    buffer_load_dwordx4 v10, s[12:15], s49 offen offset:1024 sc1 lds
    v_pk_fma_f32 v[44:45], v[44:45], v[60:61], v[62:63]
    v_pk_fma_f32 v[46:47], v[46:47], v[60:61], v[62:63]
    v_lshlrev_b32 v48, 16, v50
    v_and_b32 v49, 0xffff0000, v50
    v_lshlrev_b32 v50, 16, v51
    s_add_u32 m0, s44, 110592
    s_nop 0
    buffer_load_dwordx4 v11, s[12:15], s49 offen offset:0 sc1 lds
    v_and_b32 v51, 0xffff0000, v51
    v_pk_fma_f32 v[48:49], v[48:49], v[64:65], v[66:67]
    v_pk_fma_f32 v[50:51], v[50:51], v[64:65], v[66:67]
    s_add_u32 m0, s44, 117760
    s_nop 0
    buffer_load_dwordx4 v11, s[12:15], s49 offen offset:1024 sc1 lds
    s_add_u32 m0, s44, 122880
    s_mov_b32 s49, 328448
    s_waitcnt vmcnt(8)
    s_barrier
    s_load_dword s32, s[4:5], s84 offset:2048
    s_load_dword s3, s[4:5], s84 offset:2176
    buffer_load_dwordx4 v10, s[12:15], s49 offen offset:0 sc1 lds
    s_add_u32 m0, s44, 130048
    s_nop 0
    buffer_load_dwordx4 v10, s[12:15], s49 offen offset:1024 sc1 lds
    s_add_u32 m0, s44, 126976
    s_nop 0
    buffer_load_dwordx4 v11, s[12:15], s49 offen offset:0 sc1 lds
    s_add_u32 m0, s44, 134144
    s_nop 0
    buffer_load_dwordx4 v11, s[12:15], s49 offen offset:1024 sc1 lds
    s_add_u32 m0, s90, 50176
    s_nop 0
    buffer_load_dwordx4 v122, s[8:11], s88 offen lds
    s_add_u32 m0, s90, 51200
    s_nop 0
    buffer_load_dwordx4 v123, s[8:11], s88 offen lds
    s_add_u32 m0, s90, 52224
    s_nop 0
    buffer_load_dwordx4 v124, s[8:11], s88 offen lds
    s_add_u32 m0, s90, 53248
    s_nop 0
    buffer_load_dwordx4 v125, s[8:11], s88 offen lds
    s_add_u32 m0, s90, 54272
    s_nop 0
    buffer_load_dwordx4 v126, s[8:11], s88 offen lds
    s_add_u32 m0, s90, 55296
    s_nop 0
    buffer_load_dwordx4 v127, s[8:11], s88 offen lds
    s_add_u32 m0, s82, 139264
    s_add_u32 s49, s78, 0
    s_waitcnt vmcnt(14)
    s_barrier
    s_waitcnt lgkmcnt(0)
    s_cmp_eq_u32 s32, s85
    s_cselect_b32 s32, s3, 0
    s_cmp_eq_u32 s32, s85
    s_cbranch_scc1 hok_29
    s_add_u32 s53, s84, 2048
    v_lshlrev_b32 v109, 7, v1
    v_add_u32 v109, s53, v109
    s_mov_b32 s53, 0
    s_add_u32 s54, s52, 16
    s_bfm_b64 exec, 2, 0
poll_30:
    buffer_load_dword v108, v109, s[56:59], 0 offen sc1
    s_waitcnt vmcnt(0)
    v_cmp_eq_u32 vcc, s54, v108
    s_nop 0
    s_cmp_eq_u64 vcc, exec
    s_cbranch_scc1 pok_31
    s_sleep 8
    s_add_u32 s53, s53, 1
    s_cmp_lt_u32 s53, s61
    s_cbranch_scc1 poll_30
    s_mov_b32 s61, 0
pok_31:
    s_mov_b64 exec, -1
hok_29:
    buffer_load_dwordx4 v2, s[16:19], s49 offen offset:0 sc1 lds
    buffer_load_dwordx4 v2, s[16:19], s49 offen offset:1024 sc1 lds
    buffer_load_dwordx4 v2, s[16:19], s49 offen offset:2048 sc1 lds
    buffer_load_dwordx4 v2, s[16:19], s49 offen offset:3072 sc1 lds
    s_add_u32 m0, s82, 16384
    s_add_u32 s49, s78, 4096
    s_waitcnt vmcnt(14)
    s_barrier
    buffer_load_dwordx4 v2, s[16:19], s49 offen offset:0 sc1 lds
    buffer_load_dwordx4 v2, s[16:19], s49 offen offset:1024 sc1 lds
    buffer_load_dwordx4 v2, s[16:19], s49 offen offset:2048 sc1 lds
    buffer_load_dwordx4 v2, s[16:19], s49 offen offset:3072 sc1 lds
    s_add_u32 m0, s82, 32768
    s_add_u32 s49, s78, 16384
    s_waitcnt vmcnt(14)
    s_barrier
    buffer_load_dwordx4 v2, s[16:19], s49 offen offset:0 sc1 lds
    buffer_load_dwordx4 v2, s[16:19], s49 offen offset:1024 sc1 lds
    buffer_load_dwordx4 v2, s[16:19], s49 offen offset:2048 sc1 lds
    buffer_load_dwordx4 v2, s[16:19], s49 offen offset:3072 sc1 lds
    s_setprio 0
    s_waitcnt vmcnt(8)
    s_barrier
    ds_read_b128 v[52:55], v15 offset:32768
    ds_read_b128 v[56:59], v15 offset:36864
    ds_read_b128 v[60:63], v15 offset:40960
    ds_read_b128 v[64:67], v15 offset:45056
    ds_read_b128 v[68:71], v15 offset:33792
    ds_read_b128 v[72:75], v15 offset:37888
    ds_read_b128 v[76:79], v15 offset:41984
    ds_read_b128 v[80:83], v15 offset:46080
    s_waitcnt lgkmcnt(4)
    v_mfma_f32_16x16x32_bf16 v[20:23], v[128:131], v[52:55], v[20:23]
    ds_read_b128 v[84:87], v15 offset:34816
    v_mfma_f32_16x16x32_bf16 v[24:27], v[128:131], v[56:59], v[24:27]
    ds_read_b128 v[88:91], v15 offset:38912
    v_mfma_f32_16x16x32_bf16 v[24:27], v[132:135], v[64:67], v[24:27]
    ds_read_b128 v[92:95], v15 offset:43008
    v_mfma_f32_16x16x32_bf16 v[20:23], v[132:135], v[60:63], v[20:23]
    ds_read_b128 v[96:99], v15 offset:47104
    s_waitcnt lgkmcnt(4)
    v_mfma_f32_16x16x32_bf16 v[20:23], v[136:139], v[68:71], v[20:23]
    ds_read_b128 v[52:55], v15 offset:35840
    v_mfma_f32_16x16x32_bf16 v[24:27], v[136:139], v[72:75], v[24:27]
    ds_read_b128 v[56:59], v15 offset:39936
    v_mfma_f32_16x16x32_bf16 v[24:27], v[140:143], v[80:83], v[24:27]
    ds_read_b128 v[60:63], v15 offset:44032
    v_mfma_f32_16x16x32_bf16 v[20:23], v[140:143], v[76:79], v[20:23]
    ds_read_b128 v[64:67], v15 offset:48128
    s_waitcnt vmcnt(4)
    s_barrier
    s_waitcnt lgkmcnt(4)
    v_mfma_f32_16x16x32_bf16 v[20:23], v[144:147], v[84:87], v[20:23]
    ds_read_b128 v[68:71], v14 offset:16384
    v_mfma_f32_16x16x32_bf16 v[24:27], v[144:147], v[88:91], v[24:27]
    ds_read_b128 v[72:75], v14 offset:20480
    v_mfma_f32_16x16x32_bf16 v[24:27], v[148:151], v[96:99], v[24:27]
    ds_read_b128 v[76:79], v14 offset:24576
    v_mfma_f32_16x16x32_bf16 v[20:23], v[148:151], v[92:95], v[20:23]
    ds_read_b128 v[80:83], v14 offset:28672
    s_waitcnt lgkmcnt(4)
    v_mfma_f32_16x16x32_bf16 v[20:23], v[152:155], v[52:55], v[20:23]
    ds_read_b128 v[84:87], v14 offset:17408
    v_mfma_f32_16x16x32_bf16 v[24:27], v[152:155], v[56:59], v[24:27]
    ds_read_b128 v[88:91], v14 offset:21504
    v_mfma_f32_16x16x32_bf16 v[24:27], v[156:159], v[64:67], v[24:27]
    ds_read_b128 v[92:95], v14 offset:25600
    v_mfma_f32_16x16x32_bf16 v[20:23], v[156:159], v[60:63], v[20:23]
    ds_read_b128 v[96:99], v14 offset:29696
    s_waitcnt lgkmcnt(4)
    v_mfma_f32_16x16x32_bf16 v[20:23], v[160:163], v[68:71], v[20:23]
    ds_read_b128 v[52:55], v14 offset:18432
    v_mfma_f32_16x16x32_bf16 v[24:27], v[160:163], v[72:75], v[24:27]
    ds_read_b128 v[56:59], v14 offset:22528
    v_mfma_f32_16x16x32_bf16 v[24:27], v[164:167], v[80:83], v[24:27]
    ds_read_b128 v[60:63], v14 offset:26624
    v_mfma_f32_16x16x32_bf16 v[20:23], v[164:167], v[76:79], v[20:23]
    ds_read_b128 v[64:67], v14 offset:30720
    s_waitcnt lgkmcnt(4)
    v_mfma_f32_16x16x32_bf16 v[20:23], v[168:171], v[84:87], v[20:23]
    ds_read_b128 v[68:71], v14 offset:19456
    v_mfma_f32_16x16x32_bf16 v[24:27], v[168:171], v[88:91], v[24:27]
    ds_read_b128 v[72:75], v14 offset:23552
    v_mfma_f32_16x16x32_bf16 v[24:27], v[172:175], v[96:99], v[24:27]
    ds_read_b128 v[76:79], v14 offset:27648
    v_mfma_f32_16x16x32_bf16 v[20:23], v[172:175], v[92:95], v[20:23]
    ds_read_b128 v[80:83], v14 offset:31744
    s_waitcnt vmcnt(0)
    s_barrier
    s_waitcnt lgkmcnt(4)
    v_mfma_f32_16x16x32_bf16 v[20:23], v[176:179], v[52:55], v[20:23]
    ds_read_b128 v[84:87], v14 offset:32768
    v_mfma_f32_16x16x32_bf16 v[24:27], v[176:179], v[56:59], v[24:27]
    ds_read_b128 v[88:91], v14 offset:36864
    v_mfma_f32_16x16x32_bf16 v[24:27], v[180:183], v[64:67], v[24:27]
    ds_read_b128 v[92:95], v14 offset:40960
    v_mfma_f32_16x16x32_bf16 v[20:23], v[180:183], v[60:63], v[20:23]
    ds_read_b128 v[96:99], v14 offset:45056
    s_waitcnt lgkmcnt(4)
    v_mfma_f32_16x16x32_bf16 v[20:23], v[184:187], v[68:71], v[20:23]
    ds_read_b128 v[52:55], v14 offset:33792
    v_mfma_f32_16x16x32_bf16 v[24:27], v[184:187], v[72:75], v[24:27]
    ds_read_b128 v[56:59], v14 offset:37888
    v_mfma_f32_16x16x32_bf16 v[24:27], v[188:191], v[80:83], v[24:27]
    ds_read_b128 v[60:63], v14 offset:41984
    v_mfma_f32_16x16x32_bf16 v[20:23], v[188:191], v[76:79], v[20:23]
    ds_read_b128 v[64:67], v14 offset:46080
    s_waitcnt lgkmcnt(4)
    v_mfma_f32_16x16x32_bf16 v[20:23], v[192:195], v[84:87], v[20:23]
    ds_read_b128 v[68:71], v14 offset:34816
    v_mfma_f32_16x16x32_bf16 v[24:27], v[192:195], v[88:91], v[24:27]
    ds_read_b128 v[72:75], v14 offset:38912
    v_mfma_f32_16x16x32_bf16 v[24:27], v[196:199], v[96:99], v[24:27]
    ds_read_b128 v[76:79], v14 offset:43008
    v_mfma_f32_16x16x32_bf16 v[20:23], v[196:199], v[92:95], v[20:23]
    ds_read_b128 v[80:83], v14 offset:47104
    s_waitcnt lgkmcnt(4)
    v_mfma_f32_16x16x32_bf16 v[20:23], v[200:203], v[52:55], v[20:23]
    ds_read_b128 v[84:87], v14 offset:35840
    v_mfma_f32_16x16x32_bf16 v[24:27], v[200:203], v[56:59], v[24:27]
    ds_read_b128 v[88:91], v14 offset:39936
    v_mfma_f32_16x16x32_bf16 v[24:27], v[204:207], v[64:67], v[24:27]
    ds_read_b128 v[92:95], v14 offset:44032
    v_mfma_f32_16x16x32_bf16 v[20:23], v[204:207], v[60:63], v[20:23]
    ds_read_b128 v[96:99], v14 offset:48128
    s_barrier
    s_waitcnt lgkmcnt(4)
    v_mfma_f32_16x16x32_bf16 v[20:23], v[208:211], v[68:71], v[20:23]
    ds_read_b128 v[52:55], v15 offset:0
    v_mfma_f32_16x16x32_bf16 v[24:27], v[208:211], v[72:75], v[24:27]
    ds_read_b128 v[56:59], v15 offset:4096
    v_mfma_f32_16x16x32_bf16 v[24:27], v[212:215], v[80:83], v[24:27]
    ds_read_b128 v[60:63], v15 offset:8192
    v_mfma_f32_16x16x32_bf16 v[20:23], v[212:215], v[76:79], v[20:23]
    ds_read_b128 v[64:67], v15 offset:12288
    s_waitcnt lgkmcnt(4)
    v_mfma_f32_16x16x32_bf16 v[20:23], v[216:219], v[84:87], v[20:23]
    ds_read_b128 v[68:71], v15 offset:1024
    v_mfma_f32_16x16x32_bf16 v[24:27], v[216:219], v[88:91], v[24:27]
    ds_read_b128 v[72:75], v15 offset:5120
    v_mfma_f32_16x16x32_bf16 v[24:27], v[220:223], v[96:99], v[24:27]
    ds_read_b128 v[76:79], v15 offset:9216
    v_mfma_f32_16x16x32_bf16 v[20:23], v[220:223], v[92:95], v[20:23]
    ds_read_b128 v[80:83], v15 offset:13312
    s_waitcnt lgkmcnt(4)
    v_mfma_f32_16x16x32_bf16 v[20:23], v[224:227], v[52:55], v[20:23]
    ds_read_b128 v[84:87], v15 offset:2048
    v_mfma_f32_16x16x32_bf16 v[24:27], v[224:227], v[56:59], v[24:27]
    ds_read_b128 v[88:91], v15 offset:6144
    v_mfma_f32_16x16x32_bf16 v[24:27], v[228:231], v[64:67], v[24:27]
    ds_read_b128 v[92:95], v15 offset:10240
    v_mfma_f32_16x16x32_bf16 v[20:23], v[228:231], v[60:63], v[20:23]
    ds_read_b128 v[96:99], v15 offset:14336
    s_waitcnt lgkmcnt(4)
    v_mfma_f32_16x16x32_bf16 v[20:23], v[232:235], v[68:71], v[20:23]
    ds_read_b128 v[52:55], v15 offset:3072
    v_mfma_f32_16x16x32_bf16 v[24:27], v[232:235], v[72:75], v[24:27]
    ds_read_b128 v[56:59], v15 offset:7168
    v_mfma_f32_16x16x32_bf16 v[24:27], v[236:239], v[80:83], v[24:27]
    ds_read_b128 v[60:63], v15 offset:11264
    v_mfma_f32_16x16x32_bf16 v[20:23], v[236:239], v[76:79], v[20:23]
    ds_read_b128 v[64:67], v15 offset:15360
    s_barrier
    s_waitcnt lgkmcnt(4)
    v_mfma_f32_16x16x32_bf16 v[20:23], v[240:243], v[84:87], v[20:23]
    ds_read_b128 v[68:71], v15 offset:16384
    v_mfma_f32_16x16x32_bf16 v[24:27], v[240:243], v[88:91], v[24:27]
    ds_read_b128 v[72:75], v15 offset:20480
    v_mfma_f32_16x16x32_bf16 v[24:27], v[244:247], v[96:99], v[24:27]
    ds_read_b128 v[76:79], v15 offset:24576
    v_mfma_f32_16x16x32_bf16 v[20:23], v[244:247], v[92:95], v[20:23]
    ds_read_b128 v[80:83], v15 offset:28672
    s_waitcnt lgkmcnt(4)
    v_mfma_f32_16x16x32_bf16 v[20:23], v[248:251], v[52:55], v[20:23]
    ds_read_b128 v[84:87], v15 offset:17408
    v_mfma_f32_16x16x32_bf16 v[24:27], v[248:251], v[56:59], v[24:27]
    ds_read_b128 v[88:91], v15 offset:21504
    v_mfma_f32_16x16x32_bf16 v[24:27], v[252:255], v[64:67], v[24:27]
    ds_read_b128 v[92:95], v15 offset:25600
    v_mfma_f32_16x16x32_bf16 v[20:23], v[252:255], v[60:63], v[20:23]
    ds_read_b128 v[96:99], v15 offset:29696
    s_waitcnt lgkmcnt(4)
    v_mfma_f32_16x16x32_bf16 v[28:31], v[128:131], v[68:71], v[28:31]
    ds_read_b128 v[52:55], v15 offset:18432
    v_mfma_f32_16x16x32_bf16 v[32:35], v[128:131], v[72:75], v[32:35]
    ds_read_b128 v[56:59], v15 offset:22528
    v_mfma_f32_16x16x32_bf16 v[32:35], v[132:135], v[80:83], v[32:35]
    ds_read_b128 v[60:63], v15 offset:26624
    v_mfma_f32_16x16x32_bf16 v[28:31], v[132:135], v[76:79], v[28:31]
    ds_read_b128 v[64:67], v15 offset:30720
    v_add_u32 v20, 0x10000, v20
    v_add_u32 v22, 0x10000, v22
    v_add_u32 v24, 0x10000, v24
    v_add_u32 v26, 0x10000, v26
    v_and_b32 v20, 0xfffe0000, v20
    v_and_b32 v22, 0xfffe0000, v22
    v_and_b32 v24, 0xfffe0000, v24
    v_and_b32 v26, 0xfffe0000, v26
    v_cvt_pk_bf16_f32 v20, v20, v21
    v_cvt_pk_bf16_f32 v21, v22, v23
    v_cvt_pk_bf16_f32 v22, v24, v25
    v_cvt_pk_bf16_f32 v23, v26, v27
    s_add_u32 s36, s39, 0
    v_permlane16_swap_b32 v20, v22
    v_permlane16_swap_b32 v21, v23
    s_waitcnt lgkmcnt(4)
    v_mfma_f32_16x16x32_bf16 v[28:31], v[136:139], v[84:87], v[28:31]
    ds_read_b128 v[68:71], v15 offset:19456
    v_mfma_f32_16x16x32_bf16 v[32:35], v[136:139], v[88:91], v[32:35]
    ds_read_b128 v[72:75], v15 offset:23552
    v_mfma_f32_16x16x32_bf16 v[32:35], v[140:143], v[96:99], v[32:35]
    ds_read_b128 v[76:79], v15 offset:27648
    v_mfma_f32_16x16x32_bf16 v[28:31], v[140:143], v[92:95], v[28:31]
    ds_read_b128 v[80:83], v15 offset:31744
    s_barrier
    s_waitcnt lgkmcnt(4)
    v_mfma_f32_16x16x32_bf16 v[28:31], v[144:147], v[52:55], v[28:31]
    ds_read_b128 v[84:87], v15 offset:32768
    v_mfma_f32_16x16x32_bf16 v[32:35], v[144:147], v[56:59], v[32:35]
    ds_read_b128 v[88:91], v15 offset:36864
    v_mfma_f32_16x16x32_bf16 v[32:35], v[148:151], v[64:67], v[32:35]
    ds_read_b128 v[92:95], v15 offset:40960
    v_mfma_f32_16x16x32_bf16 v[28:31], v[148:151], v[60:63], v[28:31]
    ds_read_b128 v[96:99], v15 offset:45056
    s_waitcnt lgkmcnt(4)
    v_mfma_f32_16x16x32_bf16 v[28:31], v[152:155], v[68:71], v[28:31]
    ds_read_b128 v[52:55], v15 offset:33792
    v_mfma_f32_16x16x32_bf16 v[32:35], v[152:155], v[72:75], v[32:35]
    ds_read_b128 v[56:59], v15 offset:37888
    v_mfma_f32_16x16x32_bf16 v[32:35], v[156:159], v[80:83], v[32:35]
    ds_read_b128 v[60:63], v15 offset:41984
    v_mfma_f32_16x16x32_bf16 v[28:31], v[156:159], v[76:79], v[28:31]
    ds_read_b128 v[64:67], v15 offset:46080
    s_waitcnt lgkmcnt(4)
    v_mfma_f32_16x16x32_bf16 v[28:31], v[160:163], v[84:87], v[28:31]
    ds_read_b128 v[68:71], v15 offset:34816
    v_mfma_f32_16x16x32_bf16 v[32:35], v[160:163], v[88:91], v[32:35]
    ds_read_b128 v[72:75], v15 offset:38912
    v_mfma_f32_16x16x32_bf16 v[32:35], v[164:167], v[96:99], v[32:35]
    ds_read_b128 v[76:79], v15 offset:43008
    v_mfma_f32_16x16x32_bf16 v[28:31], v[164:167], v[92:95], v[28:31]
    ds_read_b128 v[80:83], v15 offset:47104
    s_waitcnt lgkmcnt(4)
    v_mfma_f32_16x16x32_bf16 v[28:31], v[168:171], v[52:55], v[28:31]
    ds_read_b128 v[84:87], v15 offset:35840
    v_mfma_f32_16x16x32_bf16 v[32:35], v[168:171], v[56:59], v[32:35]
    ds_read_b128 v[88:91], v15 offset:39936
    v_mfma_f32_16x16x32_bf16 v[32:35], v[172:175], v[64:67], v[32:35]
    ds_read_b128 v[92:95], v15 offset:44032
    v_mfma_f32_16x16x32_bf16 v[28:31], v[172:175], v[60:63], v[28:31]
    ds_read_b128 v[96:99], v15 offset:48128
    s_barrier
    s_waitcnt lgkmcnt(4)
    v_mfma_f32_16x16x32_bf16 v[28:31], v[176:179], v[68:71], v[28:31]
    ds_read_b128 v[52:55], v14 offset:16384
    v_mfma_f32_16x16x32_bf16 v[32:35], v[176:179], v[72:75], v[32:35]
    ds_read_b128 v[56:59], v14 offset:20480
    v_mfma_f32_16x16x32_bf16 v[32:35], v[180:183], v[80:83], v[32:35]
    ds_read_b128 v[60:63], v14 offset:24576
    v_mfma_f32_16x16x32_bf16 v[28:31], v[180:183], v[76:79], v[28:31]
    ds_read_b128 v[64:67], v14 offset:28672
    s_waitcnt lgkmcnt(4)
    v_mfma_f32_16x16x32_bf16 v[28:31], v[184:187], v[84:87], v[28:31]
    ds_read_b128 v[68:71], v14 offset:17408
    v_mfma_f32_16x16x32_bf16 v[32:35], v[184:187], v[88:91], v[32:35]
    ds_read_b128 v[72:75], v14 offset:21504
    v_mfma_f32_16x16x32_bf16 v[32:35], v[188:191], v[96:99], v[32:35]
    ds_read_b128 v[76:79], v14 offset:25600
    v_mfma_f32_16x16x32_bf16 v[28:31], v[188:191], v[92:95], v[28:31]
    ds_read_b128 v[80:83], v14 offset:29696
    s_waitcnt lgkmcnt(4)
    v_mfma_f32_16x16x32_bf16 v[28:31], v[192:195], v[52:55], v[28:31]
    ds_read_b128 v[84:87], v14 offset:18432
    v_mfma_f32_16x16x32_bf16 v[32:35], v[192:195], v[56:59], v[32:35]
    ds_read_b128 v[88:91], v14 offset:22528
    v_mfma_f32_16x16x32_bf16 v[32:35], v[196:199], v[64:67], v[32:35]
    ds_read_b128 v[92:95], v14 offset:26624
    v_mfma_f32_16x16x32_bf16 v[28:31], v[196:199], v[60:63], v[28:31]
    ds_read_b128 v[96:99], v14 offset:30720
    s_waitcnt lgkmcnt(4)
    v_mfma_f32_16x16x32_bf16 v[28:31], v[200:203], v[68:71], v[28:31]
    ds_read_b128 v[52:55], v14 offset:19456
    v_mfma_f32_16x16x32_bf16 v[32:35], v[200:203], v[72:75], v[32:35]
    ds_read_b128 v[56:59], v14 offset:23552
    v_mfma_f32_16x16x32_bf16 v[32:35], v[204:207], v[80:83], v[32:35]
    ds_read_b128 v[60:63], v14 offset:27648
    v_mfma_f32_16x16x32_bf16 v[28:31], v[204:207], v[76:79], v[28:31]
    ds_read_b128 v[64:67], v14 offset:31744
    s_barrier
    s_waitcnt lgkmcnt(4)
    v_mfma_f32_16x16x32_bf16 v[28:31], v[208:211], v[84:87], v[28:31]
    ds_read_b128 v[68:71], v14 offset:32768
    v_mfma_f32_16x16x32_bf16 v[32:35], v[208:211], v[88:91], v[32:35]
    ds_read_b128 v[72:75], v14 offset:36864
    v_mfma_f32_16x16x32_bf16 v[32:35], v[212:215], v[96:99], v[32:35]
    ds_read_b128 v[76:79], v14 offset:40960
    v_mfma_f32_16x16x32_bf16 v[28:31], v[212:215], v[92:95], v[28:31]
    ds_read_b128 v[80:83], v14 offset:45056
    s_waitcnt lgkmcnt(4)
    v_mfma_f32_16x16x32_bf16 v[28:31], v[216:219], v[52:55], v[28:31]
    ds_read_b128 v[84:87], v14 offset:33792
    v_mfma_f32_16x16x32_bf16 v[32:35], v[216:219], v[56:59], v[32:35]
    ds_read_b128 v[88:91], v14 offset:37888
    v_mfma_f32_16x16x32_bf16 v[32:35], v[220:223], v[64:67], v[32:35]
    ds_read_b128 v[92:95], v14 offset:41984
    v_mfma_f32_16x16x32_bf16 v[28:31], v[220:223], v[60:63], v[28:31]
    ds_read_b128 v[96:99], v14 offset:46080
    s_waitcnt lgkmcnt(4)
    v_mfma_f32_16x16x32_bf16 v[28:31], v[224:227], v[68:71], v[28:31]
    ds_read_b128 v[52:55], v14 offset:34816
    v_mfma_f32_16x16x32_bf16 v[32:35], v[224:227], v[72:75], v[32:35]
    ds_read_b128 v[56:59], v14 offset:38912
    v_mfma_f32_16x16x32_bf16 v[32:35], v[228:231], v[80:83], v[32:35]
    ds_read_b128 v[60:63], v14 offset:43008
    v_mfma_f32_16x16x32_bf16 v[28:31], v[228:231], v[76:79], v[28:31]
    ds_read_b128 v[64:67], v14 offset:47104
    s_waitcnt lgkmcnt(4)
    v_mfma_f32_16x16x32_bf16 v[28:31], v[232:235], v[84:87], v[28:31]
    ds_read_b128 v[68:71], v14 offset:35840
    v_mfma_f32_16x16x32_bf16 v[32:35], v[232:235], v[88:91], v[32:35]
    ds_read_b128 v[72:75], v14 offset:39936
    v_mfma_f32_16x16x32_bf16 v[32:35], v[236:239], v[96:99], v[32:35]
    ds_read_b128 v[76:79], v14 offset:44032
    v_mfma_f32_16x16x32_bf16 v[28:31], v[236:239], v[92:95], v[28:31]
    ds_read_b128 v[80:83], v14 offset:48128
    s_barrier
    s_waitcnt lgkmcnt(4)
    v_mfma_f32_16x16x32_bf16 v[28:31], v[240:243], v[52:55], v[28:31]
    ds_read_b128 v[84:87], v15 offset:0
    v_mfma_f32_16x16x32_bf16 v[32:35], v[240:243], v[56:59], v[32:35]
    ds_read_b128 v[88:91], v15 offset:4096
    v_mfma_f32_16x16x32_bf16 v[32:35], v[244:247], v[64:67], v[32:35]
    ds_read_b128 v[92:95], v15 offset:8192
    v_mfma_f32_16x16x32_bf16 v[28:31], v[244:247], v[60:63], v[28:31]
    ds_read_b128 v[96:99], v15 offset:12288
    s_waitcnt lgkmcnt(4)
    v_mfma_f32_16x16x32_bf16 v[28:31], v[248:251], v[68:71], v[28:31]
    ds_read_b128 v[52:55], v15 offset:1024
    v_mfma_f32_16x16x32_bf16 v[32:35], v[248:251], v[72:75], v[32:35]
    ds_read_b128 v[56:59], v15 offset:5120
    v_mfma_f32_16x16x32_bf16 v[32:35], v[252:255], v[80:83], v[32:35]
    ds_read_b128 v[60:63], v15 offset:9216
    v_mfma_f32_16x16x32_bf16 v[28:31], v[252:255], v[76:79], v[28:31]
    ds_read_b128 v[64:67], v15 offset:13312
    s_waitcnt lgkmcnt(4)
    v_mfma_f32_16x16x32_bf16 v[36:39], v[128:131], v[84:87], v[36:39]
    ds_read_b128 v[68:71], v15 offset:2048
    v_mfma_f32_16x16x32_bf16 v[40:43], v[128:131], v[88:91], v[40:43]
    ds_read_b128 v[72:75], v15 offset:6144
    v_mfma_f32_16x16x32_bf16 v[40:43], v[132:135], v[96:99], v[40:43]
    ds_read_b128 v[76:79], v15 offset:10240
    v_mfma_f32_16x16x32_bf16 v[36:39], v[132:135], v[92:95], v[36:39]
    ds_read_b128 v[80:83], v15 offset:14336
    v_add_u32 v28, 0x10000, v28
    v_add_u32 v30, 0x10000, v30
    v_add_u32 v32, 0x10000, v32
    v_add_u32 v34, 0x10000, v34
    v_and_b32 v28, 0xfffe0000, v28
    v_and_b32 v30, 0xfffe0000, v30
    v_and_b32 v32, 0xfffe0000, v32
    v_and_b32 v34, 0xfffe0000, v34
    v_cvt_pk_bf16_f32 v28, v28, v29
    v_cvt_pk_bf16_f32 v29, v30, v31
    v_cvt_pk_bf16_f32 v30, v32, v33
    v_cvt_pk_bf16_f32 v31, v34, v35
    s_add_u32 s36, s39, 131072
    v_permlane16_swap_b32 v28, v30
    v_permlane16_swap_b32 v29, v31
    s_waitcnt lgkmcnt(4)
    v_mfma_f32_16x16x32_bf16 v[36:39], v[136:139], v[52:55], v[36:39]
    ds_read_b128 v[84:87], v15 offset:3072
    v_mfma_f32_16x16x32_bf16 v[40:43], v[136:139], v[56:59], v[40:43]
    ds_read_b128 v[88:91], v15 offset:7168
    v_mfma_f32_16x16x32_bf16 v[40:43], v[140:143], v[64:67], v[40:43]
    ds_read_b128 v[92:95], v15 offset:11264
    v_mfma_f32_16x16x32_bf16 v[36:39], v[140:143], v[60:63], v[36:39]
    ds_read_b128 v[96:99], v15 offset:15360
    s_barrier
    s_waitcnt lgkmcnt(4)
    v_mfma_f32_16x16x32_bf16 v[36:39], v[144:147], v[68:71], v[36:39]
    ds_read_b128 v[52:55], v15 offset:16384
    v_mfma_f32_16x16x32_bf16 v[40:43], v[144:147], v[72:75], v[40:43]
    ds_read_b128 v[56:59], v15 offset:20480
    v_mfma_f32_16x16x32_bf16 v[40:43], v[148:151], v[80:83], v[40:43]
    ds_read_b128 v[60:63], v15 offset:24576
    v_mfma_f32_16x16x32_bf16 v[36:39], v[148:151], v[76:79], v[36:39]
    ds_read_b128 v[64:67], v15 offset:28672
    s_waitcnt lgkmcnt(4)
    v_mfma_f32_16x16x32_bf16 v[36:39], v[152:155], v[84:87], v[36:39]
    ds_read_b128 v[68:71], v15 offset:17408
    v_mfma_f32_16x16x32_bf16 v[40:43], v[152:155], v[88:91], v[40:43]
    ds_read_b128 v[72:75], v15 offset:21504
    v_mfma_f32_16x16x32_bf16 v[40:43], v[156:159], v[96:99], v[40:43]
    ds_read_b128 v[76:79], v15 offset:25600
    v_mfma_f32_16x16x32_bf16 v[36:39], v[156:159], v[92:95], v[36:39]
    ds_read_b128 v[80:83], v15 offset:29696
    s_waitcnt lgkmcnt(4)
    v_mfma_f32_16x16x32_bf16 v[36:39], v[160:163], v[52:55], v[36:39]
    ds_read_b128 v[84:87], v15 offset:18432
    v_mfma_f32_16x16x32_bf16 v[40:43], v[160:163], v[56:59], v[40:43]
    ds_read_b128 v[88:91], v15 offset:22528
    v_mfma_f32_16x16x32_bf16 v[40:43], v[164:167], v[64:67], v[40:43]
    ds_read_b128 v[92:95], v15 offset:26624
    v_mfma_f32_16x16x32_bf16 v[36:39], v[164:167], v[60:63], v[36:39]
    ds_read_b128 v[96:99], v15 offset:30720
    s_waitcnt lgkmcnt(4)
    v_mfma_f32_16x16x32_bf16 v[36:39], v[168:171], v[68:71], v[36:39]
    ds_read_b128 v[52:55], v15 offset:19456
    v_mfma_f32_16x16x32_bf16 v[40:43], v[168:171], v[72:75], v[40:43]
    ds_read_b128 v[56:59], v15 offset:23552
    v_mfma_f32_16x16x32_bf16 v[40:43], v[172:175], v[80:83], v[40:43]
    ds_read_b128 v[60:63], v15 offset:27648
    v_mfma_f32_16x16x32_bf16 v[36:39], v[172:175], v[76:79], v[36:39]
    ds_read_b128 v[64:67], v15 offset:31744
    s_barrier
    s_waitcnt lgkmcnt(4)
    v_mfma_f32_16x16x32_bf16 v[36:39], v[176:179], v[84:87], v[36:39]
    ds_read_b128 v[68:71], v15 offset:32768
    v_mfma_f32_16x16x32_bf16 v[40:43], v[176:179], v[88:91], v[40:43]
    ds_read_b128 v[72:75], v15 offset:36864
    v_mfma_f32_16x16x32_bf16 v[40:43], v[180:183], v[96:99], v[40:43]
    ds_read_b128 v[76:79], v15 offset:40960
    v_mfma_f32_16x16x32_bf16 v[36:39], v[180:183], v[92:95], v[36:39]
    ds_read_b128 v[80:83], v15 offset:45056
    s_waitcnt lgkmcnt(4)
    v_mfma_f32_16x16x32_bf16 v[36:39], v[184:187], v[52:55], v[36:39]
    ds_read_b128 v[84:87], v15 offset:33792
    v_mfma_f32_16x16x32_bf16 v[40:43], v[184:187], v[56:59], v[40:43]
    ds_read_b128 v[88:91], v15 offset:37888
    v_mfma_f32_16x16x32_bf16 v[40:43], v[188:191], v[64:67], v[40:43]
    ds_read_b128 v[92:95], v15 offset:41984
    v_mfma_f32_16x16x32_bf16 v[36:39], v[188:191], v[60:63], v[36:39]
    ds_read_b128 v[96:99], v15 offset:46080
    s_waitcnt lgkmcnt(4)
    v_mfma_f32_16x16x32_bf16 v[36:39], v[192:195], v[68:71], v[36:39]
    ds_read_b128 v[52:55], v15 offset:34816
    v_mfma_f32_16x16x32_bf16 v[40:43], v[192:195], v[72:75], v[40:43]
    ds_read_b128 v[56:59], v15 offset:38912
    v_mfma_f32_16x16x32_bf16 v[40:43], v[196:199], v[80:83], v[40:43]
    ds_read_b128 v[60:63], v15 offset:43008
    v_mfma_f32_16x16x32_bf16 v[36:39], v[196:199], v[76:79], v[36:39]
    ds_read_b128 v[64:67], v15 offset:47104
    s_waitcnt lgkmcnt(4)
    v_mfma_f32_16x16x32_bf16 v[36:39], v[200:203], v[84:87], v[36:39]
    ds_read_b128 v[68:71], v15 offset:35840
    v_mfma_f32_16x16x32_bf16 v[40:43], v[200:203], v[88:91], v[40:43]
    ds_read_b128 v[72:75], v15 offset:39936
    v_mfma_f32_16x16x32_bf16 v[40:43], v[204:207], v[96:99], v[40:43]
    ds_read_b128 v[76:79], v15 offset:44032
    v_mfma_f32_16x16x32_bf16 v[36:39], v[204:207], v[92:95], v[36:39]
    ds_read_b128 v[80:83], v15 offset:48128
    s_barrier
    s_waitcnt lgkmcnt(4)
    v_mfma_f32_16x16x32_bf16 v[36:39], v[208:211], v[52:55], v[36:39]
    ds_read_b128 v[84:87], v14 offset:16384
    v_mfma_f32_16x16x32_bf16 v[40:43], v[208:211], v[56:59], v[40:43]
    ds_read_b128 v[88:91], v14 offset:20480
    v_mfma_f32_16x16x32_bf16 v[40:43], v[212:215], v[64:67], v[40:43]
    ds_read_b128 v[92:95], v14 offset:24576
    v_mfma_f32_16x16x32_bf16 v[36:39], v[212:215], v[60:63], v[36:39]
    ds_read_b128 v[96:99], v14 offset:28672
    s_waitcnt lgkmcnt(4)
    v_mfma_f32_16x16x32_bf16 v[36:39], v[216:219], v[68:71], v[36:39]
    ds_read_b128 v[52:55], v14 offset:17408
    v_mfma_f32_16x16x32_bf16 v[40:43], v[216:219], v[72:75], v[40:43]
    ds_read_b128 v[56:59], v14 offset:21504
    v_mfma_f32_16x16x32_bf16 v[40:43], v[220:223], v[80:83], v[40:43]
    ds_read_b128 v[60:63], v14 offset:25600
    v_mfma_f32_16x16x32_bf16 v[36:39], v[220:223], v[76:79], v[36:39]
    ds_read_b128 v[64:67], v14 offset:29696
    s_waitcnt lgkmcnt(4)
    v_mfma_f32_16x16x32_bf16 v[36:39], v[224:227], v[84:87], v[36:39]
    ds_read_b128 v[68:71], v14 offset:18432
    v_mfma_f32_16x16x32_bf16 v[40:43], v[224:227], v[88:91], v[40:43]
    ds_read_b128 v[72:75], v14 offset:22528
    v_mfma_f32_16x16x32_bf16 v[40:43], v[228:231], v[96:99], v[40:43]
    ds_read_b128 v[76:79], v14 offset:26624
    v_mfma_f32_16x16x32_bf16 v[36:39], v[228:231], v[92:95], v[36:39]
    ds_read_b128 v[80:83], v14 offset:30720
    s_waitcnt lgkmcnt(4)
    v_mfma_f32_16x16x32_bf16 v[36:39], v[232:235], v[52:55], v[36:39]
    ds_read_b128 v[84:87], v14 offset:19456
    v_mfma_f32_16x16x32_bf16 v[40:43], v[232:235], v[56:59], v[40:43]
    ds_read_b128 v[88:91], v14 offset:23552
    v_mfma_f32_16x16x32_bf16 v[40:43], v[236:239], v[64:67], v[40:43]
    ds_read_b128 v[92:95], v14 offset:27648
    v_mfma_f32_16x16x32_bf16 v[36:39], v[236:239], v[60:63], v[36:39]
    ds_read_b128 v[96:99], v14 offset:31744
    s_barrier
    s_waitcnt lgkmcnt(4)
    v_mfma_f32_16x16x32_bf16 v[36:39], v[240:243], v[68:71], v[36:39]
    ds_read_b128 v[52:55], v14 offset:32768
    v_mfma_f32_16x16x32_bf16 v[40:43], v[240:243], v[72:75], v[40:43]
    ds_read_b128 v[56:59], v14 offset:36864
    v_mfma_f32_16x16x32_bf16 v[40:43], v[244:247], v[80:83], v[40:43]
    ds_read_b128 v[60:63], v14 offset:40960
    v_mfma_f32_16x16x32_bf16 v[36:39], v[244:247], v[76:79], v[36:39]
    ds_read_b128 v[64:67], v14 offset:45056
    s_waitcnt lgkmcnt(4)
    v_mfma_f32_16x16x32_bf16 v[36:39], v[248:251], v[84:87], v[36:39]
    ds_read_b128 v[68:71], v14 offset:33792
    v_mfma_f32_16x16x32_bf16 v[40:43], v[248:251], v[88:91], v[40:43]
    ds_read_b128 v[72:75], v14 offset:37888
    v_mfma_f32_16x16x32_bf16 v[40:43], v[252:255], v[96:99], v[40:43]
    ds_read_b128 v[76:79], v14 offset:41984
    v_mfma_f32_16x16x32_bf16 v[36:39], v[252:255], v[92:95], v[36:39]
    ds_read_b128 v[80:83], v14 offset:46080
    s_waitcnt lgkmcnt(4)
    v_mfma_f32_16x16x32_bf16 v[44:47], v[128:131], v[52:55], v[44:47]
    ds_read_b128 v[84:87], v14 offset:34816
    v_mfma_f32_16x16x32_bf16 v[48:51], v[128:131], v[56:59], v[48:51]
    ds_read_b128 v[88:91], v14 offset:38912
    v_mfma_f32_16x16x32_bf16 v[48:51], v[132:135], v[64:67], v[48:51]
    ds_read_b128 v[92:95], v14 offset:43008
    v_mfma_f32_16x16x32_bf16 v[44:47], v[132:135], v[60:63], v[44:47]
    ds_read_b128 v[96:99], v14 offset:47104
    v_add_u32 v36, 0x10000, v36
    v_add_u32 v38, 0x10000, v38
    v_add_u32 v40, 0x10000, v40
    v_add_u32 v42, 0x10000, v42
    v_and_b32 v36, 0xfffe0000, v36
    v_and_b32 v38, 0xfffe0000, v38
    v_and_b32 v40, 0xfffe0000, v40
    v_and_b32 v42, 0xfffe0000, v42
    v_cvt_pk_bf16_f32 v36, v36, v37
    v_cvt_pk_bf16_f32 v37, v38, v39
    v_cvt_pk_bf16_f32 v38, v40, v41
    v_cvt_pk_bf16_f32 v39, v42, v43
    s_add_u32 s36, s39, 262144
    v_permlane16_swap_b32 v36, v38
    v_permlane16_swap_b32 v37, v39
    s_waitcnt lgkmcnt(4)
    v_mfma_f32_16x16x32_bf16 v[44:47], v[136:139], v[68:71], v[44:47]
    ds_read_b128 v[52:55], v14 offset:35840
    v_mfma_f32_16x16x32_bf16 v[48:51], v[136:139], v[72:75], v[48:51]
    ds_read_b128 v[56:59], v14 offset:39936
    v_mfma_f32_16x16x32_bf16 v[48:51], v[140:143], v[80:83], v[48:51]
    ds_read_b128 v[60:63], v14 offset:44032
    v_mfma_f32_16x16x32_bf16 v[44:47], v[140:143], v[76:79], v[44:47]
    ds_read_b128 v[64:67], v14 offset:48128
    s_barrier
    s_waitcnt lgkmcnt(4)
    v_mfma_f32_16x16x32_bf16 v[44:47], v[144:147], v[84:87], v[44:47]
    ds_read_b128 v[68:71], v15 offset:0
    v_mfma_f32_16x16x32_bf16 v[48:51], v[144:147], v[88:91], v[48:51]
    ds_read_b128 v[72:75], v15 offset:4096
    v_mfma_f32_16x16x32_bf16 v[48:51], v[148:151], v[96:99], v[48:51]
    ds_read_b128 v[76:79], v15 offset:8192
    v_mfma_f32_16x16x32_bf16 v[44:47], v[148:151], v[92:95], v[44:47]
    ds_read_b128 v[80:83], v15 offset:12288
    s_add_u32 s36, s39, 0
    buffer_store_dwordx4 v[20:23], v13, s[24:27], s36 offen sc1
    s_waitcnt lgkmcnt(4)
    v_mfma_f32_16x16x32_bf16 v[44:47], v[152:155], v[52:55], v[44:47]
    ds_read_b128 v[84:87], v15 offset:1024
    v_mfma_f32_16x16x32_bf16 v[48:51], v[152:155], v[56:59], v[48:51]
    ds_read_b128 v[88:91], v15 offset:5120
    v_mfma_f32_16x16x32_bf16 v[48:51], v[156:159], v[64:67], v[48:51]
    ds_read_b128 v[92:95], v15 offset:9216
    v_mfma_f32_16x16x32_bf16 v[44:47], v[156:159], v[60:63], v[44:47]
    ds_read_b128 v[96:99], v15 offset:13312
    s_add_u32 s36, s39, 131072
    buffer_store_dwordx4 v[28:31], v13, s[24:27], s36 offen sc1
    s_waitcnt lgkmcnt(4)
    v_mfma_f32_16x16x32_bf16 v[44:47], v[160:163], v[68:71], v[44:47]
    ds_read_b128 v[52:55], v15 offset:2048
    v_mfma_f32_16x16x32_bf16 v[48:51], v[160:163], v[72:75], v[48:51]
    ds_read_b128 v[56:59], v15 offset:6144
    v_mfma_f32_16x16x32_bf16 v[48:51], v[164:167], v[80:83], v[48:51]
    ds_read_b128 v[60:63], v15 offset:10240
    v_mfma_f32_16x16x32_bf16 v[44:47], v[164:167], v[76:79], v[44:47]
    ds_read_b128 v[64:67], v15 offset:14336
    s_add_u32 s36, s39, 262144
    buffer_store_dwordx4 v[36:39], v13, s[24:27], s36 offen sc1
    s_waitcnt lgkmcnt(4)
    v_mfma_f32_16x16x32_bf16 v[44:47], v[168:171], v[84:87], v[44:47]
    ds_read_b128 v[68:71], v15 offset:3072
    v_mfma_f32_16x16x32_bf16 v[48:51], v[168:171], v[88:91], v[48:51]
    ds_read_b128 v[72:75], v15 offset:7168
    v_mfma_f32_16x16x32_bf16 v[48:51], v[172:175], v[96:99], v[48:51]
    ds_read_b128 v[76:79], v15 offset:11264
    v_mfma_f32_16x16x32_bf16 v[44:47], v[172:175], v[92:95], v[44:47]
    ds_read_b128 v[80:83], v15 offset:15360
    s_barrier
    s_waitcnt lgkmcnt(4)
    v_mfma_f32_16x16x32_bf16 v[44:47], v[176:179], v[52:55], v[44:47]
    ds_read_b128 v[84:87], v15 offset:16384
    v_mfma_f32_16x16x32_bf16 v[48:51], v[176:179], v[56:59], v[48:51]
    ds_read_b128 v[88:91], v15 offset:20480
    v_mfma_f32_16x16x32_bf16 v[48:51], v[180:183], v[64:67], v[48:51]
    ds_read_b128 v[92:95], v15 offset:24576
    v_mfma_f32_16x16x32_bf16 v[44:47], v[180:183], v[60:63], v[44:47]
    ds_read_b128 v[96:99], v15 offset:28672
    s_waitcnt lgkmcnt(4)
    v_mfma_f32_16x16x32_bf16 v[44:47], v[184:187], v[68:71], v[44:47]
    ds_read_b128 v[52:55], v15 offset:17408
    v_mfma_f32_16x16x32_bf16 v[48:51], v[184:187], v[72:75], v[48:51]
    ds_read_b128 v[56:59], v15 offset:21504
    v_mfma_f32_16x16x32_bf16 v[48:51], v[188:191], v[80:83], v[48:51]
    ds_read_b128 v[60:63], v15 offset:25600
    v_mfma_f32_16x16x32_bf16 v[44:47], v[188:191], v[76:79], v[44:47]
    ds_read_b128 v[64:67], v15 offset:29696
    s_waitcnt lgkmcnt(4)
    v_mfma_f32_16x16x32_bf16 v[44:47], v[192:195], v[84:87], v[44:47]
    ds_read_b128 v[68:71], v15 offset:18432
    v_mfma_f32_16x16x32_bf16 v[48:51], v[192:195], v[88:91], v[48:51]
    ds_read_b128 v[72:75], v15 offset:22528
    v_mfma_f32_16x16x32_bf16 v[48:51], v[196:199], v[96:99], v[48:51]
    ds_read_b128 v[76:79], v15 offset:26624
    v_mfma_f32_16x16x32_bf16 v[44:47], v[196:199], v[92:95], v[44:47]
    ds_read_b128 v[80:83], v15 offset:30720
    s_waitcnt lgkmcnt(4)
    v_mfma_f32_16x16x32_bf16 v[44:47], v[200:203], v[52:55], v[44:47]
    ds_read_b128 v[84:87], v15 offset:19456
    v_mfma_f32_16x16x32_bf16 v[48:51], v[200:203], v[56:59], v[48:51]
    ds_read_b128 v[88:91], v15 offset:23552
    v_mfma_f32_16x16x32_bf16 v[48:51], v[204:207], v[64:67], v[48:51]
    ds_read_b128 v[92:95], v15 offset:27648
    v_mfma_f32_16x16x32_bf16 v[44:47], v[204:207], v[60:63], v[44:47]
    ds_read_b128 v[96:99], v15 offset:31744
    s_barrier
    s_waitcnt lgkmcnt(4)
    v_mfma_f32_16x16x32_bf16 v[44:47], v[208:211], v[68:71], v[44:47]
    ds_read_b128 v[52:55], v15 offset:32768
    v_mfma_f32_16x16x32_bf16 v[48:51], v[208:211], v[72:75], v[48:51]
    ds_read_b128 v[56:59], v15 offset:36864
    v_mfma_f32_16x16x32_bf16 v[48:51], v[212:215], v[80:83], v[48:51]
    ds_read_b128 v[60:63], v15 offset:40960
    v_mfma_f32_16x16x32_bf16 v[44:47], v[212:215], v[76:79], v[44:47]
    ds_read_b128 v[64:67], v15 offset:45056
    s_waitcnt lgkmcnt(4)
    v_mfma_f32_16x16x32_bf16 v[44:47], v[216:219], v[84:87], v[44:47]
    ds_read_b128 v[68:71], v15 offset:33792
    v_mfma_f32_16x16x32_bf16 v[48:51], v[216:219], v[88:91], v[48:51]
    ds_read_b128 v[72:75], v15 offset:37888
    v_mfma_f32_16x16x32_bf16 v[48:51], v[220:223], v[96:99], v[48:51]
    ds_read_b128 v[76:79], v15 offset:41984
    v_mfma_f32_16x16x32_bf16 v[44:47], v[220:223], v[92:95], v[44:47]
    ds_read_b128 v[80:83], v15 offset:46080
    s_waitcnt lgkmcnt(4)
    v_mfma_f32_16x16x32_bf16 v[44:47], v[224:227], v[52:55], v[44:47]
    ds_read_b128 v[84:87], v15 offset:34816
    v_mfma_f32_16x16x32_bf16 v[48:51], v[224:227], v[56:59], v[48:51]
    ds_read_b128 v[88:91], v15 offset:38912
    v_mfma_f32_16x16x32_bf16 v[48:51], v[228:231], v[64:67], v[48:51]
    ds_read_b128 v[92:95], v15 offset:43008
    v_mfma_f32_16x16x32_bf16 v[44:47], v[228:231], v[60:63], v[44:47]
    ds_read_b128 v[96:99], v15 offset:47104
    s_waitcnt lgkmcnt(4)
    v_mfma_f32_16x16x32_bf16 v[44:47], v[232:235], v[68:71], v[44:47]
    ds_read_b128 v[52:55], v15 offset:35840
    v_mfma_f32_16x16x32_bf16 v[48:51], v[232:235], v[72:75], v[48:51]
    ds_read_b128 v[56:59], v15 offset:39936
    v_mfma_f32_16x16x32_bf16 v[48:51], v[236:239], v[80:83], v[48:51]
    ds_read_b128 v[60:63], v15 offset:44032
    v_mfma_f32_16x16x32_bf16 v[44:47], v[236:239], v[76:79], v[44:47]
    ds_read_b128 v[64:67], v15 offset:48128
    ds_write_b128 v16, v[20:23] offset:0
    ds_write_b128 v16, v[28:31] offset:4096
    ds_write_b128 v16, v[36:39] offset:8192
    s_waitcnt lgkmcnt(7)
    v_mfma_f32_16x16x32_bf16 v[44:47], v[240:243], v[84:87], v[44:47]
    v_mfma_f32_16x16x32_bf16 v[48:51], v[240:243], v[88:91], v[48:51]
    v_mfma_f32_16x16x32_bf16 v[48:51], v[244:247], v[96:99], v[48:51]
    v_mfma_f32_16x16x32_bf16 v[44:47], v[244:247], v[92:95], v[44:47]
    s_waitcnt lgkmcnt(3)
    v_mfma_f32_16x16x32_bf16 v[44:47], v[248:251], v[52:55], v[44:47]
    v_mfma_f32_16x16x32_bf16 v[48:51], v[248:251], v[56:59], v[48:51]
    v_mfma_f32_16x16x32_bf16 v[48:51], v[252:255], v[64:67], v[48:51]
    v_mfma_f32_16x16x32_bf16 v[44:47], v[252:255], v[60:63], v[44:47]
    s_setprio 0
    s_nop 6
    v_add_u32 v44, 0x10000, v44
    v_add_u32 v46, 0x10000, v46
    v_add_u32 v48, 0x10000, v48
    v_add_u32 v50, 0x10000, v50
    v_and_b32 v44, 0xfffe0000, v44
    v_and_b32 v46, 0xfffe0000, v46
    v_and_b32 v48, 0xfffe0000, v48
    v_and_b32 v50, 0xfffe0000, v50
    v_cvt_pk_bf16_f32 v44, v44, v45
    v_cvt_pk_bf16_f32 v45, v46, v47
    v_cvt_pk_bf16_f32 v46, v48, v49
    v_cvt_pk_bf16_f32 v47, v50, v51
    s_add_u32 s36, s39, 393216
    v_permlane16_swap_b32 v44, v46
    v_permlane16_swap_b32 v45, v47
    s_add_u32 s36, s39, 393216
    buffer_store_dwordx4 v[44:47], v13, s[24:27], s36 offen sc1
    ds_write_b128 v16, v[44:47] offset:12288
    s_waitcnt lgkmcnt(0)
    s_barrier
    s_cmp_ge_u32 s30, 6
    s_cbranch_scc1 WLOAD
    s_and_b32 s35, s30, 1
    s_add_u32 s12, s62, 0x480000
    s_addc_u32 s13, s63, 0
    s_mov_b32 s14, 0x7e000
    s_mov_b32 s15, 0x20000
    s_mul_i32 s38, s35, 262144
    s_lshl_b32 s41, s35, 13
    s_mov_b32 s42, 0
    s_mov_b32 s44, s29
    s_add_u32 s54, s55, 1024
    v_mov_b32 v9, s54
    v_lshl_add_u32 v9, v1, 7, v9
    s_add_u32 s44, s44, 1
    s_and_b32 s44, s44, 15
    s_add_u32 s46, s29, 1
    s_and_b32 s46, s46, 15
    s_cmp_eq_u32 s28, s29
    s_cselect_b32 s47, s46, s28
    s_mov_b32 s42, 16384
    s_and_b32 s35, s30, 1
    s_lshl_b32 s35, s35, 7
    s_add_u32 s35, s35, s55
    s_add_u32 s35, s35, 0x1600
    s_and_b32 s40, s30, 1
    s_lshl_b32 s40, s40, 13
    s_lshl_b32 s53, s29, 7
    s_add_u32 s40, s40, s53
    s_add_u32 s40, s40, 23068672
    v_lshlrev_b32 v10, 3, v1
    s_add_u32 s20, s62, 0x1c8000
    s_addc_u32 s21, s63, 0
    s_mov_b32 s22, 0x6000
    s_mov_b32 s23, 0x20000
    s_and_b32 s34, s30, 1
    s_lshl_b32 s34, s34, 9
    s_call_b64 s[76:77], PREP_a_issue_3
    s_mov_b32 m0, s19
    s_mov_b32 s39, s16
    s_and_b32 s53, s30, 3
    s_lshl_b32 s53, s53, 7
    s_add_u32 s53, s53, s55
    s_add_u32 s53, s53, 0x400
    v_mov_b32 v14, 1
    v_mov_b32 v15, 0
    s_mov_b64 exec, 1
    s_waitcnt vmcnt(0)
    buffer_atomic_add v14, v15, s[56:59], s53 offen sc1
    s_mov_b64 exec, -1
    s_call_b64 s[76:77], SUB_rest_2
    s_waitcnt lgkmcnt(0)
    s_mov_b32 s53, 0
    s_add_u32 s54, s52, 16
    s_bfm_b64 exec, 4, 0
poll_32:
    buffer_load_dword v8, v9, s[56:59], 0 offen sc1
    s_waitcnt vmcnt(0)
    v_cmp_eq_u32 vcc, s54, v8
    s_nop 0
    s_cmp_eq_u64 vcc, exec
    s_cbranch_scc1 pok_33
    s_sleep 5
    s_add_u32 s53, s53, 1
    s_cmp_lt_u32 s53, s61
    s_cbranch_scc1 poll_32
    s_mov_b32 s61, 0
pok_33:
    s_mov_b64 exec, -1
    buffer_load_dwordx4 v2, s[12:15], s39 offen sc1 lds
    buffer_load_dwordx4 v2, s[12:15], s39 offen offset:1024 sc1 lds
    s_call_b64 s[76:77], PREP_a_issue_3
    s_add_u32 m0, m0, 2048
    s_add_u32 s39, s39, 65536
    buffer_load_dwordx4 v2, s[12:15], s39 offen sc1 lds
    buffer_load_dwordx4 v2, s[12:15], s39 offen offset:1024 sc1 lds
    s_add_u32 m0, m0, 2048
    s_add_u32 s39, s39, 65536
    buffer_load_dwordx4 v2, s[12:15], s39 offen sc1 lds
    buffer_load_dwordx4 v2, s[12:15], s39 offen offset:1024 sc1 lds
    s_add_u32 m0, m0, 2048
    s_add_u32 s39, s39, 65536
    buffer_load_dwordx4 v2, s[12:15], s39 offen sc1 lds
    buffer_load_dwordx4 v2, s[12:15], s39 offen offset:1024 sc1 lds
    s_mov_b32 m0, s19
    s_mov_b32 s39, s16
    buffer_load_dwordx4 v2, s[12:15], s39 offen sc1 lds
    buffer_load_dwordx4 v2, s[12:15], s39 offen offset:1024 sc1 lds
    s_call_b64 s[76:77], PREP_a_issue_3
    s_add_u32 m0, m0, 2048
    s_add_u32 s39, s39, 65536
    buffer_load_dwordx4 v2, s[12:15], s39 offen sc1 lds
    buffer_load_dwordx4 v2, s[12:15], s39 offen offset:1024 sc1 lds
    s_add_u32 m0, m0, 2048
    s_add_u32 s39, s39, 65536
    buffer_load_dwordx4 v2, s[12:15], s39 offen sc1 lds
    buffer_load_dwordx4 v2, s[12:15], s39 offen offset:1024 sc1 lds
    s_add_u32 m0, m0, 2048
    s_add_u32 s39, s39, 65536
    buffer_load_dwordx4 v2, s[12:15], s39 offen sc1 lds
    buffer_load_dwordx4 v2, s[12:15], s39 offen offset:1024 sc1 lds
    s_mov_b32 m0, s19
    s_mov_b32 s39, s16
    s_waitcnt vmcnt(8)
    s_barrier
    buffer_load_dwordx4 v2, s[12:15], s39 offen sc1 lds
    buffer_load_dwordx4 v2, s[12:15], s39 offen offset:1024 sc1 lds
    s_call_b64 s[76:77], PREP_a_issue_3
    s_add_u32 m0, m0, 2048
    s_add_u32 s39, s39, 65536
    buffer_load_dwordx4 v2, s[12:15], s39 offen sc1 lds
    buffer_load_dwordx4 v2, s[12:15], s39 offen offset:1024 sc1 lds
    s_add_u32 m0, m0, 2048
    s_add_u32 s39, s39, 65536
    buffer_load_dwordx4 v2, s[12:15], s39 offen sc1 lds
    buffer_load_dwordx4 v2, s[12:15], s39 offen offset:1024 sc1 lds
    s_add_u32 m0, m0, 2048
    s_add_u32 s39, s39, 65536
    buffer_load_dwordx4 v2, s[12:15], s39 offen sc1 lds
    buffer_load_dwordx4 v2, s[12:15], s39 offen offset:1024 sc1 lds
    s_mov_b32 m0, s19
    s_mov_b32 s39, s16
    s_add_u32 s36, s34, 155648
    v_add_u32 v51, s36, v10
    ds_read_b64 v[18:19], v51 offset:0
    ds_read_b64 v[20:21], v51 offset:1024
    ds_read_b64 v[22:23], v51 offset:2048
    ds_read_b64 v[24:25], v51 offset:3072
    s_lshr_b32 s53, s29, 3
    s_lshl_b32 s53, s53, 14
    s_and_b32 s36, s29, 7
    s_lshl_b32 s36, s36, 10
    s_add_u32 s36, s36, s53
    s_add_u32 s36, s36, s34
    s_waitcnt lgkmcnt(0)
    v_pk_add_f32 v[18:19], v[18:19], v[20:21]
    v_pk_add_f32 v[18:19], v[18:19], v[22:23]
    v_pk_add_f32 v[18:19], v[18:19], v[24:25]
    buffer_store_dwordx2 v[18:19], v10, s[20:23], s36 offen sc1
    s_waitcnt vmcnt(9)
    s_barrier
    buffer_load_dwordx4 v2, s[12:15], s39 offen sc1 lds
    buffer_load_dwordx4 v2, s[12:15], s39 offen offset:1024 sc1 lds
    s_call_b64 s[76:77], PREP_a_issue_3
    s_add_u32 m0, m0, 2048
    s_add_u32 s39, s39, 65536
    buffer_load_dwordx4 v2, s[12:15], s39 offen sc1 lds
    buffer_load_dwordx4 v2, s[12:15], s39 offen offset:1024 sc1 lds
    s_add_u32 m0, m0, 2048
    s_add_u32 s39, s39, 65536
    buffer_load_dwordx4 v2, s[12:15], s39 offen sc1 lds
    buffer_load_dwordx4 v2, s[12:15], s39 offen offset:1024 sc1 lds
    s_add_u32 m0, m0, 2048
    s_add_u32 s39, s39, 65536
    buffer_load_dwordx4 v2, s[12:15], s39 offen sc1 lds
    buffer_load_dwordx4 v2, s[12:15], s39 offen offset:1024 sc1 lds
    s_mov_b32 m0, s19
    s_mov_b32 s39, s16
    s_waitcnt vmcnt(9)
    s_barrier
    buffer_load_dwordx4 v2, s[12:15], s39 offen sc1 lds
    buffer_load_dwordx4 v2, s[12:15], s39 offen offset:1024 sc1 lds
    s_call_b64 s[76:77], PREP_a_issue_3
    s_add_u32 m0, m0, 2048
    s_add_u32 s39, s39, 65536
    buffer_load_dwordx4 v2, s[12:15], s39 offen sc1 lds
    buffer_load_dwordx4 v2, s[12:15], s39 offen offset:1024 sc1 lds
    s_add_u32 m0, m0, 2048
    s_add_u32 s39, s39, 65536
    buffer_load_dwordx4 v2, s[12:15], s39 offen sc1 lds
    buffer_load_dwordx4 v2, s[12:15], s39 offen offset:1024 sc1 lds
    s_add_u32 m0, m0, 2048
    s_add_u32 s39, s39, 65536
    buffer_load_dwordx4 v2, s[12:15], s39 offen sc1 lds
    buffer_load_dwordx4 v2, s[12:15], s39 offen offset:1024 sc1 lds
    s_mov_b32 m0, s19
    s_mov_b32 s39, s16
    s_waitcnt vmcnt(16)
    s_and_b32 s53, s30, 1
    s_lshl_b32 s53, s53, 7
    s_add_u32 s53, s53, s55
    s_add_u32 s53, s53, 0x1600
    v_mov_b32 v14, 1
    v_mov_b32 v15, 0
    s_mov_b64 exec, 1
    buffer_atomic_add v14, v15, s[56:59], s53 offen sc1
    s_mov_b64 exec, -1
    s_waitcnt vmcnt(9)
    s_barrier
    buffer_load_dwordx4 v2, s[12:15], s39 offen sc1 lds
    buffer_load_dwordx4 v2, s[12:15], s39 offen offset:1024 sc1 lds
    s_call_b64 s[76:77], PREP_a_issue_3
    s_add_u32 m0, m0, 2048
    s_add_u32 s39, s39, 65536
    buffer_load_dwordx4 v2, s[12:15], s39 offen sc1 lds
    buffer_load_dwordx4 v2, s[12:15], s39 offen offset:1024 sc1 lds
    s_add_u32 m0, m0, 2048
    s_add_u32 s39, s39, 65536
    buffer_load_dwordx4 v2, s[12:15], s39 offen sc1 lds
    buffer_load_dwordx4 v2, s[12:15], s39 offen offset:1024 sc1 lds
    s_add_u32 m0, m0, 2048
    s_add_u32 s39, s39, 65536
    buffer_load_dwordx4 v2, s[12:15], s39 offen sc1 lds
    buffer_load_dwordx4 v2, s[12:15], s39 offen offset:1024 sc1 lds
    s_mov_b32 m0, s19
    s_mov_b32 s39, s16
    s_waitcnt vmcnt(9)
    s_barrier
    buffer_load_dwordx4 v2, s[12:15], s39 offen sc1 lds
    buffer_load_dwordx4 v2, s[12:15], s39 offen offset:1024 sc1 lds
    s_call_b64 s[76:77], PREP_a_issue_3
    s_add_u32 m0, m0, 2048
    s_add_u32 s39, s39, 65536
    buffer_load_dwordx4 v2, s[12:15], s39 offen sc1 lds
    buffer_load_dwordx4 v2, s[12:15], s39 offen offset:1024 sc1 lds
    s_add_u32 m0, m0, 2048
    s_add_u32 s39, s39, 65536
    buffer_load_dwordx4 v2, s[12:15], s39 offen sc1 lds
    buffer_load_dwordx4 v2, s[12:15], s39 offen offset:1024 sc1 lds
    s_add_u32 m0, m0, 2048
    s_add_u32 s39, s39, 65536
    buffer_load_dwordx4 v2, s[12:15], s39 offen sc1 lds
    buffer_load_dwordx4 v2, s[12:15], s39 offen offset:1024 sc1 lds
    s_mov_b32 m0, s19
    s_mov_b32 s39, s16
    s_waitcnt vmcnt(8)
    s_barrier
    buffer_load_dwordx4 v2, s[12:15], s39 offen sc1 lds
    buffer_load_dwordx4 v2, s[12:15], s39 offen offset:1024 sc1 lds
    s_call_b64 s[76:77], PREP_a_issue_3
    s_add_u32 m0, m0, 2048
    s_add_u32 s39, s39, 65536
    buffer_load_dwordx4 v2, s[12:15], s39 offen sc1 lds
    buffer_load_dwordx4 v2, s[12:15], s39 offen offset:1024 sc1 lds
    s_add_u32 m0, m0, 2048
    s_add_u32 s39, s39, 65536
    buffer_load_dwordx4 v2, s[12:15], s39 offen sc1 lds
    buffer_load_dwordx4 v2, s[12:15], s39 offen offset:1024 sc1 lds
    s_add_u32 m0, m0, 2048
    s_add_u32 s39, s39, 65536
    buffer_load_dwordx4 v2, s[12:15], s39 offen sc1 lds
    buffer_load_dwordx4 v2, s[12:15], s39 offen offset:1024 sc1 lds
    s_mov_b32 m0, s19
    s_mov_b32 s39, s16
    s_waitcnt vmcnt(8)
    s_barrier
    buffer_load_dwordx4 v2, s[12:15], s39 offen sc1 lds
    buffer_load_dwordx4 v2, s[12:15], s39 offen offset:1024 sc1 lds
    s_call_b64 s[76:77], PREP_a_issue_3
    s_add_u32 m0, m0, 2048
    s_add_u32 s39, s39, 65536
    buffer_load_dwordx4 v2, s[12:15], s39 offen sc1 lds
    buffer_load_dwordx4 v2, s[12:15], s39 offen offset:1024 sc1 lds
    s_add_u32 m0, m0, 2048
    s_add_u32 s39, s39, 65536
    buffer_load_dwordx4 v2, s[12:15], s39 offen sc1 lds
    buffer_load_dwordx4 v2, s[12:15], s39 offen offset:1024 sc1 lds
    s_add_u32 m0, m0, 2048
    s_add_u32 s39, s39, 65536
    buffer_load_dwordx4 v2, s[12:15], s39 offen sc1 lds
    buffer_load_dwordx4 v2, s[12:15], s39 offen offset:1024 sc1 lds
    s_mov_b32 m0, s19
    s_mov_b32 s39, s16
    s_load_dword s32, s[4:5], s35
    s_load_dword s3, s[4:5], s40
    s_waitcnt vmcnt(8)
    s_barrier
    buffer_load_dwordx4 v2, s[12:15], s39 offen sc1 lds
    buffer_load_dwordx4 v2, s[12:15], s39 offen offset:1024 sc1 lds
    s_call_b64 s[76:77], PREP_a_issue_3
    s_add_u32 m0, m0, 2048
    s_add_u32 s39, s39, 65536
    buffer_load_dwordx4 v2, s[12:15], s39 offen sc1 lds
    buffer_load_dwordx4 v2, s[12:15], s39 offen offset:1024 sc1 lds
    s_add_u32 m0, m0, 2048
    s_add_u32 s39, s39, 65536
    buffer_load_dwordx4 v2, s[12:15], s39 offen sc1 lds
    buffer_load_dwordx4 v2, s[12:15], s39 offen offset:1024 sc1 lds
    s_add_u32 m0, m0, 2048
    s_add_u32 s39, s39, 65536
    buffer_load_dwordx4 v2, s[12:15], s39 offen sc1 lds
    buffer_load_dwordx4 v2, s[12:15], s39 offen offset:1024 sc1 lds
    s_mov_b32 m0, s19
    s_mov_b32 s39, s16
    s_add_u32 s54, s52, 16
    s_waitcnt lgkmcnt(0)
    s_cmp_eq_u32 s32, s54
    s_cbranch_scc1 fok_34
    v_mov_b32 v15, s35
    s_mov_b32 s53, 0
    s_add_u32 s54, s52, 16
    s_bfm_b64 exec, 1, 0
poll_35:
    buffer_load_dword v14, v15, s[56:59], 0 offen sc1
    s_waitcnt vmcnt(0)
    v_cmp_eq_u32 vcc, s54, v14
    s_nop 0
    s_cmp_eq_u64 vcc, exec
    s_cbranch_scc1 pok_36
    s_sleep 5
    s_add_u32 s53, s53, 1
    s_cmp_lt_u32 s53, s61
    s_cbranch_scc1 poll_35
    s_mov_b32 s61, 0
pok_36:
    s_mov_b64 exec, -1
fok_34:
    s_add_u32 s36, s34, 0
    buffer_load_dwordx2 v[18:19], v10, s[20:23], s36 offen offset:0 sc1
    buffer_load_dwordx2 v[20:21], v10, s[20:23], s36 offen offset:1024 sc1
    buffer_load_dwordx2 v[22:23], v10, s[20:23], s36 offen offset:2048 sc1
    buffer_load_dwordx2 v[24:25], v10, s[20:23], s36 offen offset:3072 sc1
    s_add_u32 s36, s36, 4096
    buffer_load_dwordx2 v[26:27], v10, s[20:23], s36 offen offset:0 sc1
    buffer_load_dwordx2 v[28:29], v10, s[20:23], s36 offen offset:1024 sc1
    buffer_load_dwordx2 v[30:31], v10, s[20:23], s36 offen offset:2048 sc1
    buffer_load_dwordx2 v[32:33], v10, s[20:23], s36 offen offset:3072 sc1
    s_waitcnt vmcnt(16)
    s_barrier
    buffer_load_dwordx4 v2, s[12:15], s39 offen sc1 lds
    buffer_load_dwordx4 v2, s[12:15], s39 offen offset:1024 sc1 lds
    s_call_b64 s[76:77], PREP_a_issue_3
    s_add_u32 m0, m0, 2048
    s_add_u32 s39, s39, 65536
    buffer_load_dwordx4 v2, s[12:15], s39 offen sc1 lds
    buffer_load_dwordx4 v2, s[12:15], s39 offen offset:1024 sc1 lds
    s_add_u32 m0, m0, 2048
    s_add_u32 s39, s39, 65536
    buffer_load_dwordx4 v2, s[12:15], s39 offen sc1 lds
    buffer_load_dwordx4 v2, s[12:15], s39 offen offset:1024 sc1 lds
    s_add_u32 m0, m0, 2048
    s_add_u32 s39, s39, 65536
    buffer_load_dwordx4 v2, s[12:15], s39 offen sc1 lds
    buffer_load_dwordx4 v2, s[12:15], s39 offen offset:1024 sc1 lds
    s_mov_b32 m0, s19
    s_mov_b32 s39, s16
    s_add_u32 s36, s34, 16384
    buffer_load_dwordx2 v[34:35], v10, s[20:23], s36 offen offset:0 sc1
    buffer_load_dwordx2 v[36:37], v10, s[20:23], s36 offen offset:1024 sc1
    buffer_load_dwordx2 v[38:39], v10, s[20:23], s36 offen offset:2048 sc1
    buffer_load_dwordx2 v[40:41], v10, s[20:23], s36 offen offset:3072 sc1
    s_add_u32 s36, s36, 4096
    buffer_load_dwordx2 v[42:43], v10, s[20:23], s36 offen offset:0 sc1
    buffer_load_dwordx2 v[44:45], v10, s[20:23], s36 offen offset:1024 sc1
    buffer_load_dwordx2 v[46:47], v10, s[20:23], s36 offen offset:2048 sc1
    buffer_load_dwordx2 v[48:49], v10, s[20:23], s36 offen offset:3072 sc1
    s_waitcnt vmcnt(24)
    s_barrier
    buffer_load_dwordx4 v2, s[12:15], s39 offen sc1 lds
    buffer_load_dwordx4 v2, s[12:15], s39 offen offset:1024 sc1 lds
    s_call_b64 s[76:77], PREP_a_issue_3
    s_add_u32 m0, m0, 2048
    s_add_u32 s39, s39, 65536
    buffer_load_dwordx4 v2, s[12:15], s39 offen sc1 lds
    buffer_load_dwordx4 v2, s[12:15], s39 offen offset:1024 sc1 lds
    s_add_u32 m0, m0, 2048
    s_add_u32 s39, s39, 65536
    buffer_load_dwordx4 v2, s[12:15], s39 offen sc1 lds
    buffer_load_dwordx4 v2, s[12:15], s39 offen offset:1024 sc1 lds
    s_add_u32 m0, m0, 2048
    s_add_u32 s39, s39, 65536
    buffer_load_dwordx4 v2, s[12:15], s39 offen sc1 lds
    buffer_load_dwordx4 v2, s[12:15], s39 offen offset:1024 sc1 lds
    s_mov_b32 m0, s19
    s_mov_b32 s39, s16
    s_add_u32 s54, s52, 16
    s_waitcnt lgkmcnt(0)
    s_cmp_eq_u32 s3, s54
    s_cbranch_scc1 fok_37
    v_mov_b32 v15, s40
    s_mov_b32 s53, 0
    s_add_u32 s54, s52, 16
    s_bfm_b64 exec, 1, 0
poll_38:
    buffer_load_dword v14, v15, s[56:59], 0 offen sc1
    s_waitcnt vmcnt(0)
    v_cmp_eq_u32 vcc, s54, v14
    s_nop 0
    s_cmp_eq_u64 vcc, exec
    s_cbranch_scc1 pok_39
    s_sleep 5
    s_add_u32 s53, s53, 1
    s_cmp_lt_u32 s53, s61
    s_cbranch_scc1 poll_38
    s_mov_b32 s61, 0
pok_39:
    s_mov_b64 exec, -1
fok_37:
    s_add_u32 s24, s4, 0x1420000
    s_addc_u32 s25, s5, 0
    s_mov_b32 s26, 0x38000
    s_mov_b32 s27, 0x20000
    s_cmp_eq_u32 s60, 0
    s_cselect_b32 s26, s26, 0
    s_and_b32 s36, s30, 1
    s_mul_i32 s36, s36, 448
    s_mul_i32 s37, s29, 896
    s_add_u32 s37, s36, s37
    v_lshrrev_b32 v13, 5, v1
    v_mul_u32_u24 v13, 14336, v13
    v_and_b32 v6, 496, v2
    v_add_u32 v13, v13, v6
    buffer_load_dwordx4 v[54:57], v13, s[24:27], s37 offen sc1
    s_add_u32 s37, s37, 28672
    buffer_load_dwordx4 v[58:61], v13, s[24:27], s37 offen sc1
    s_add_u32 s37, s37, 28672
    buffer_load_dwordx4 v[62:65], v13, s[24:27], s37 offen sc1
    s_add_u32 s37, s37, 28672
    buffer_load_dwordx4 v[66:69], v13, s[24:27], s37 offen sc1
    s_add_u32 s37, s37, 28672
    buffer_load_dwordx4 v[70:73], v13, s[24:27], s37 offen sc1
    s_add_u32 s37, s37, 28672
    buffer_load_dwordx4 v[74:77], v13, s[24:27], s37 offen sc1
    s_add_u32 s37, s37, 28672
    buffer_load_dwordx4 v[78:81], v13, s[24:27], s37 offen sc1
    s_add_u32 s37, s37, 28672
    buffer_load_dwordx4 v[82:85], v13, s[24:27], s37 offen sc1
    s_add_u32 s37, s37, 28672
    s_waitcnt vmcnt(24)
    s_barrier
    buffer_load_dwordx4 v2, s[12:15], s39 offen sc1 lds
    buffer_load_dwordx4 v2, s[12:15], s39 offen offset:1024 sc1 lds
    s_call_b64 s[76:77], PREP_a_issue_3
    s_add_u32 m0, m0, 2048
    s_add_u32 s39, s39, 65536
    buffer_load_dwordx4 v2, s[12:15], s39 offen sc1 lds
    buffer_load_dwordx4 v2, s[12:15], s39 offen offset:1024 sc1 lds
    s_add_u32 m0, m0, 2048
    s_add_u32 s39, s39, 65536
    buffer_load_dwordx4 v2, s[12:15], s39 offen sc1 lds
    buffer_load_dwordx4 v2, s[12:15], s39 offen offset:1024 sc1 lds
    s_add_u32 m0, m0, 2048
    s_add_u32 s39, s39, 65536
    buffer_load_dwordx4 v2, s[12:15], s39 offen sc1 lds
    buffer_load_dwordx4 v2, s[12:15], s39 offen offset:1024 sc1 lds
    s_mov_b32 m0, s19
    s_mov_b32 s39, s16
    s_waitcnt vmcnt(24)
    v_pk_add_f32 v[18:19], v[18:19], v[34:35]
    v_pk_add_f32 v[20:21], v[20:21], v[36:37]
    v_pk_add_f32 v[22:23], v[22:23], v[38:39]
    v_pk_add_f32 v[24:25], v[24:25], v[40:41]
    v_pk_add_f32 v[26:27], v[26:27], v[42:43]
    v_pk_add_f32 v[28:29], v[28:29], v[44:45]
    v_pk_add_f32 v[30:31], v[30:31], v[46:47]
    v_pk_add_f32 v[32:33], v[32:33], v[48:49]
    v_pk_add_f32 v[18:19], v[18:19], v[26:27]
    v_pk_add_f32 v[20:21], v[20:21], v[28:29]
    v_pk_add_f32 v[22:23], v[22:23], v[30:31]
    v_pk_add_f32 v[24:25], v[24:25], v[32:33]
    v_pk_add_f32 v[18:19], v[18:19], v[22:23]
    v_pk_add_f32 v[20:21], v[20:21], v[24:25]
    s_waitcnt vmcnt(16)
    s_barrier
    buffer_load_dwordx4 v2, s[12:15], s39 offen sc1 lds
    buffer_load_dwordx4 v2, s[12:15], s39 offen offset:1024 sc1 lds
    s_call_b64 s[76:77], PREP_a_issue_3
    s_add_u32 m0, m0, 2048
    s_add_u32 s39, s39, 65536
    buffer_load_dwordx4 v2, s[12:15], s39 offen sc1 lds
    buffer_load_dwordx4 v2, s[12:15], s39 offen offset:1024 sc1 lds
    s_add_u32 m0, m0, 2048
    s_add_u32 s39, s39, 65536
    buffer_load_dwordx4 v2, s[12:15], s39 offen sc1 lds
    buffer_load_dwordx4 v2, s[12:15], s39 offen offset:1024 sc1 lds
    s_add_u32 m0, m0, 2048
    s_add_u32 s39, s39, 65536
    buffer_load_dwordx4 v2, s[12:15], s39 offen sc1 lds
    buffer_load_dwordx4 v2, s[12:15], s39 offen offset:1024 sc1 lds
    s_mov_b32 m0, s19
    s_mov_b32 s39, s16
    v_pk_add_f32 v[18:19], v[18:19], v[20:21]
    v_mul_f32 v52, 0x3a800000, v18
    v_mul_f32 v50, 0x3a800000, v19
    v_fma_f32 v50, -v52, v52, v50
    v_max_f32 v50, 0, v50
    v_cvt_pk_bf16_f32 v52, v52, v52
    v_lshlrev_b32 v52, 16, v52
    v_cvt_pk_bf16_f32 v50, v50, v50
    v_lshlrev_b32 v50, 16, v50
    v_add_f32 v50, 0x3727c5ac, v50
    v_cvt_pk_bf16_f32 v50, v50, v50
    v_lshlrev_b32 v50, 16, v50
    v_sqrt_f32 v50, v50
    s_nop 0
    v_cvt_pk_bf16_f32 v50, v50, v50
    s_waitcnt vmcnt(8)
    s_barrier
    buffer_load_dwordx4 v2, s[12:15], s39 offen sc1 lds
    buffer_load_dwordx4 v2, s[12:15], s39 offen offset:1024 sc1 lds
    s_add_u32 m0, m0, 2048
    s_add_u32 s39, s39, 65536
    buffer_load_dwordx4 v2, s[12:15], s39 offen sc1 lds
    buffer_load_dwordx4 v2, s[12:15], s39 offen offset:1024 sc1 lds
    s_add_u32 m0, m0, 2048
    s_add_u32 s39, s39, 65536
    buffer_load_dwordx4 v2, s[12:15], s39 offen sc1 lds
    buffer_load_dwordx4 v2, s[12:15], s39 offen offset:1024 sc1 lds
    s_add_u32 m0, m0, 2048
    s_add_u32 s39, s39, 65536
    buffer_load_dwordx4 v2, s[12:15], s39 offen sc1 lds
    buffer_load_dwordx4 v2, s[12:15], s39 offen offset:1024 sc1 lds
    s_waitcnt vmcnt(24)
    v_lshlrev_b32 v50, 16, v50
    v_rcp_f32 v53, v50
    v_mov_b32 v18, v52
    v_mov_b32 v19, v50
    v_mul_f32 v20, 0xc0135761, v53
    v_mul_f32 v53, v53, v53
    v_mul_f32 v53, 0x3d372713, v53
    v_mul_f32 v21, v53, v20
    s_lshl1_add_u32 s36, s34, 160768
    v_add_u32 v51, s36, v2
    ds_write_b128 v51, v[18:21]
    s_cmp_lg_u32 s60, 0
    s_cbranch_scc1 pc_43
    v_pk_add_f32 v[54:55], v[54:55], v[58:59]
    v_pk_add_f32 v[56:57], v[56:57], v[60:61]
    v_pk_add_f32 v[54:55], v[54:55], v[62:63]
    v_pk_add_f32 v[56:57], v[56:57], v[64:65]
    v_pk_add_f32 v[54:55], v[54:55], v[66:67]
    v_pk_add_f32 v[56:57], v[56:57], v[68:69]
    v_pk_add_f32 v[54:55], v[54:55], v[70:71]
    v_pk_add_f32 v[56:57], v[56:57], v[72:73]
pc_43:
    s_waitcnt vmcnt(8)
    s_barrier
    s_cmp_lg_u32 s60, 0
    s_cbranch_scc1 pc_44
    v_pk_add_f32 v[54:55], v[54:55], v[74:75]
    v_pk_add_f32 v[56:57], v[56:57], v[76:77]
    v_pk_add_f32 v[54:55], v[54:55], v[78:79]
    v_pk_add_f32 v[56:57], v[56:57], v[80:81]
    v_pk_add_f32 v[54:55], v[54:55], v[82:83]
    v_pk_add_f32 v[56:57], v[56:57], v[84:85]
    v_mov_b32 v58, v54
    v_mov_b32 v59, v55
    v_mov_b32 v60, v56
    v_mov_b32 v61, v57
    v_permlane32_swap_b32 v54, v58
    v_permlane32_swap_b32 v55, v59
    v_permlane32_swap_b32 v56, v60
    v_permlane32_swap_b32 v57, v61
    v_pk_add_f32 v[54:55], v[54:55], v[58:59]
    v_pk_add_f32 v[56:57], v[56:57], v[60:61]
    s_and_b32 s36, s30, 1
    s_mul_i32 s36, s36, 448
    s_add_u32 s36, s36, 159744
    v_add_u32 v6, s36, v2
    s_bfm_b64 exec, 28, 0
    ds_write_b128 v6, v[54:57]
    s_mov_b64 exec, -1
    s_waitcnt lgkmcnt(0)
pc_44:
    s_waitcnt lgkmcnt(0)
    s_waitcnt vmcnt(0)
    s_barrier
    s_cmp_lg_u32 s60, 0
    s_cbranch_scc1 tw4_46
    s_mov_b64 s[48:49], s[74:75]
    s_lshl_b32 s45, s2, 1
    s_and_b32 s50, s30, 1
    s_add_u32 s45, s45, s50
    s_mul_i32 s45, s45, 14336
    s_mov_b32 s50, 7340032
    s_mov_b32 s51, 0x20000
    buffer_load_dwordx4 v[90:93], v2, s[48:51], s45 offen offset:0
    buffer_load_dwordx4 v[90:93], v2, s[48:51], s45 offen offset:1024
    buffer_load_dwordx4 v[90:93], v2, s[48:51], s45 offen offset:2048
    buffer_load_dwordx4 v[90:93], v2, s[48:51], s45 offen offset:3072
    s_add_u32 s45, s45, 4096
    buffer_load_dwordx4 v[90:93], v2, s[48:51], s45 offen offset:0
    buffer_load_dwordx4 v[90:93], v2, s[48:51], s45 offen offset:1024
    buffer_load_dwordx4 v[90:93], v2, s[48:51], s45 offen offset:2048
    buffer_load_dwordx4 v[90:93], v2, s[48:51], s45 offen offset:3072
    s_add_u32 s45, s45, 4096
    buffer_load_dwordx4 v[90:93], v2, s[48:51], s45 offen offset:0
    buffer_load_dwordx4 v[90:93], v2, s[48:51], s45 offen offset:1024
    buffer_load_dwordx4 v[90:93], v2, s[48:51], s45 offen offset:2048
    buffer_load_dwordx4 v[90:93], v2, s[48:51], s45 offen offset:3072
    s_add_u32 s45, s45, 4096
    buffer_load_dwordx4 v[90:93], v2, s[48:51], s45 offen offset:0
    buffer_load_dwordx4 v[90:93], v2, s[48:51], s45 offen offset:1024
tw4_46:
    s_barrier
    s_and_b32 s35, s30, 1
    s_mov_b32 s12, s62
    s_mov_b32 s13, s63
    s_mov_b32 s14, 0x1be000
    s_mov_b32 s15, 0x20000
    s_mul_i32 s38, s35, 917504
    s_mul_i32 s36, s31, 573440
    s_add_u32 s38, s38, s36
    s_mul_i32 s37, s31, 917504
    s_sub_u32 s37, 229376, s37
    s_lshl_b32 s41, s35, 13
    s_mov_b32 s42, 0
    s_mov_b32 s44, 0
    s_and_b32 s34, s30, 1
    s_lshl1_add_u32 s34, s31, s34
    s_lshl_b32 s34, s34, 7
    s_add_u32 s34, s34, s55
    s_add_u32 s34, s34, 0x1200
    s_and_b32 s35, s30, 1
    s_lshl1_add_u32 s35, s31, s35
    s_lshl_b32 s35, s35, 7
    s_add_u32 s35, s35, s55
    s_add_u32 s35, s35, 0x1400
    s_sub_u32 s48, s34, 512
    s_mov_b32 s44, 3
    s_add_u32 s36, s33, 4
    s_and_b32 s36, s36, 7
    s_mul_i32 s36, s36, 7
    s_add_u32 s36, s36, 2
    s_lshr_b32 s53, s36, 3
    s_lshl_b32 s53, s53, 14
    s_and_b32 s78, s36, 7
    s_lshl_b32 s78, s78, 10
    s_add_u32 s78, s78, s53
    s_add_u32 s36, s33, 4
    s_and_b32 s36, s36, 7
    s_mul_i32 s36, s36, 7
    s_add_u32 s36, s36, 6
    s_lshr_b32 s53, s36, 3
    s_lshl_b32 s53, s53, 14
    s_and_b32 s79, s36, 7
    s_lshl_b32 s79, s79, 10
    s_add_u32 s79, s79, s53
    s_add_u32 s36, s33, 4
    s_and_b32 s36, s36, 7
    s_mul_i32 s36, s36, 7
    s_add_u32 s36, s36, 3
    s_lshr_b32 s53, s36, 3
    s_lshl_b32 s53, s53, 14
    s_and_b32 s80, s36, 7
    s_lshl_b32 s80, s80, 10
    s_add_u32 s80, s80, s53
    s_add_u32 s36, s33, 5
    s_and_b32 s36, s36, 7
    s_mul_i32 s36, s36, 7
    s_add_u32 s36, s36, 2
    s_lshr_b32 s53, s36, 3
    s_lshl_b32 s53, s53, 14
    s_and_b32 s81, s36, 7
    s_lshl_b32 s81, s81, 10
    s_add_u32 s81, s81, s53
    s_add_u32 s36, s33, 5
    s_and_b32 s36, s36, 7
    s_mul_i32 s36, s36, 7
    s_add_u32 s36, s36, 6
    s_lshr_b32 s53, s36, 3
    s_lshl_b32 s53, s53, 14
    s_and_b32 s82, s36, 7
    s_lshl_b32 s82, s82, 10
    s_add_u32 s82, s82, s53
    s_add_u32 s36, s33, 5
    s_and_b32 s36, s36, 7
    s_mul_i32 s36, s36, 7
    s_add_u32 s36, s36, 3
    s_lshr_b32 s53, s36, 3
    s_lshl_b32 s53, s53, 14
    s_and_b32 s83, s36, 7
    s_lshl_b32 s83, s83, 10
    s_add_u32 s83, s83, s53
    s_add_u32 s36, s33, 6
    s_and_b32 s36, s36, 7
    s_mul_i32 s36, s36, 7
    s_add_u32 s36, s36, 2
    s_lshr_b32 s53, s36, 3
    s_lshl_b32 s53, s53, 14
    s_and_b32 s84, s36, 7
    s_lshl_b32 s84, s84, 10
    s_add_u32 s84, s84, s53
    s_add_u32 s36, s33, 6
    s_and_b32 s36, s36, 7
    s_mul_i32 s36, s36, 7
    s_add_u32 s36, s36, 6
    s_lshr_b32 s53, s36, 3
    s_lshl_b32 s53, s53, 14
    s_and_b32 s85, s36, 7
    s_lshl_b32 s85, s85, 10
    s_add_u32 s85, s85, s53
    s_add_u32 s36, s33, 6
    s_and_b32 s36, s36, 7
    s_mul_i32 s36, s36, 7
    s_add_u32 s36, s36, 3
    s_lshr_b32 s53, s36, 3
    s_lshl_b32 s53, s53, 14
    s_and_b32 s86, s36, 7
    s_lshl_b32 s86, s86, 10
    s_add_u32 s86, s86, s53
    s_add_u32 s36, s33, 7
    s_and_b32 s36, s36, 7
    s_mul_i32 s36, s36, 7
    s_add_u32 s36, s36, 2
    s_lshr_b32 s53, s36, 3
    s_lshl_b32 s53, s53, 14
    s_and_b32 s87, s36, 7
    s_lshl_b32 s87, s87, 10
    s_add_u32 s87, s87, s53
    s_add_u32 s36, s33, 7
    s_and_b32 s36, s36, 7
    s_mul_i32 s36, s36, 7
    s_add_u32 s36, s36, 6
    s_lshr_b32 s53, s36, 3
    s_lshl_b32 s53, s53, 14
    s_and_b32 s88, s36, 7
    s_lshl_b32 s88, s88, 10
    s_add_u32 s88, s88, s53
    s_add_u32 s36, s33, 7
    s_and_b32 s36, s36, 7
    s_mul_i32 s36, s36, 7
    s_add_u32 s36, s36, 3
    s_lshr_b32 s53, s36, 3
    s_lshl_b32 s53, s53, 14
    s_and_b32 s89, s36, 7
    s_lshl_b32 s89, s89, 10
    s_add_u32 s89, s89, s53
    s_mov_b64 s[8:9], s[68:69]
    s_mov_b32 s10, 2097152
    s_mov_b32 s11, 0x20000
    s_and_b32 s3, s30, 3
    s_lshl_b32 s36, s3, 14
    s_lshl_b32 s90, s29, 7
    s_add_u32 s90, s90, s36
    s_xor_b32 s90, s90, 128
    s_lshl_b32 s3, s3, 10
    s_call_b64 s[76:77], PREP_a_issue_4
    s_mov_b32 m0, s19
    s_mov_b32 s39, s16
    s_mov_b32 s40, s17
    s_waitcnt vmcnt(16)
    s_barrier
    s_load_dword s32, s[4:5], s48
    s_waitcnt vmcnt(8)
    s_barrier
    s_add_u32 s54, s52, 16
    s_waitcnt lgkmcnt(0)
    s_cmp_eq_u32 s32, s54
    s_cbranch_scc1 fok_47
    v_mov_b32 v9, s48
    s_mov_b32 s53, 0
    s_add_u32 s54, s52, 16
    s_bfm_b64 exec, 1, 0
poll_48:
    buffer_load_dword v8, v9, s[56:59], 0 offen sc1
    s_waitcnt vmcnt(0)
    v_cmp_eq_u32 vcc, s54, v8
    s_nop 0
    s_cmp_eq_u64 vcc, exec
    s_cbranch_scc1 pok_49
    s_sleep 5
    s_add_u32 s53, s53, 1
    s_cmp_lt_u32 s53, s61
    s_cbranch_scc1 poll_48
    s_mov_b32 s61, 0
pok_49:
    s_mov_b64 exec, -1
fok_47:
    buffer_load_dwordx4 v2, s[12:15], s39 offen sc1 lds
    s_add_u32 m0, m0, 1024
    s_nop 0
    buffer_load_dwordx4 v2, s[12:15], s40 offen sc1 lds
    s_call_b64 s[76:77], PREP_a_issue_4
    s_add_u32 m0, m0, 1024
    s_add_u32 s39, s39, 229376
    buffer_load_dwordx4 v2, s[12:15], s39 offen sc1 lds
    s_add_u32 m0, m0, 1024
    s_add_u32 s40, s40, 229376
    buffer_load_dwordx4 v2, s[12:15], s40 offen sc1 lds
    s_add_u32 m0, m0, 1024
    s_add_u32 s39, s39, s37
    buffer_load_dwordx4 v2, s[12:15], s39 offen sc1 lds
    s_add_u32 m0, m0, 1024
    s_add_u32 s40, s40, s37
    buffer_load_dwordx4 v2, s[12:15], s40 offen sc1 lds
    s_add_u32 m0, m0, 1024
    s_add_u32 s39, s39, 229376
    buffer_load_dwordx4 v2, s[12:15], s39 offen sc1 lds
    s_add_u32 m0, m0, 1024
    s_add_u32 s40, s40, 229376
    buffer_load_dwordx4 v2, s[12:15], s40 offen sc1 lds
    s_mov_b32 m0, s19
    s_mov_b32 s39, s16
    s_mov_b32 s40, s17
    s_waitcnt vmcnt(8)
    s_barrier
    buffer_load_dwordx4 v2, s[12:15], s39 offen sc1 lds
    s_add_u32 m0, m0, 1024
    s_nop 0
    buffer_load_dwordx4 v2, s[12:15], s40 offen sc1 lds
    s_mov_b32 s43, 1
ld_50:
    s_add_u32 s19, s41, s42
    s_lshl_b32 s45, s44, 1
    s_add_u32 s45, s45, 0
    s_sub_u32 s45, s45, 32
    s_mul_i32 s46, s45, 86
    s_lshr_b32 s46, s46, 8
    s_mul_i32 s47, s46, 3
    s_sub_u32 s47, s45, s47
    s_lshl_b32 s47, s47, 2
    s_lshr_b32 s47, 0x362, s47
    s_and_b32 s47, s47, 7
    s_cmp_ge_u32 s44, 10
    s_cselect_b32 s45, 9, 2
    s_cselect_b32 s51, 1, 0
    s_sub_u32 s45, s44, s45
    s_cmp_lt_u32 s44, 3
    s_cselect_b32 s45, 0, s45
    s_cselect_b32 s51, s44, s51
    s_lshl2_add_u32 s51, 0, s51
    s_cmp_lt_u32 s44, 17
    s_cselect_b32 s47, s51, s47
    s_cselect_b32 s46, s45, s46
    s_add_u32 s46, s46, s33
    s_and_b32 s46, s46, 7
    s_mul_i32 s46, s46, 7
    s_add_u32 s16, s46, s47
    s_lshr_b32 s53, s16, 3
    s_lshl_b32 s53, s53, 14
    s_and_b32 s16, s16, 7
    s_lshl_b32 s16, s16, 10
    s_add_u32 s16, s16, s53
    s_add_u32 s16, s16, s38
    s_lshl_b32 s45, s44, 1
    s_add_u32 s45, s45, 1
    s_sub_u32 s45, s45, 32
    s_mul_i32 s46, s45, 86
    s_lshr_b32 s46, s46, 8
    s_mul_i32 s47, s46, 3
    s_sub_u32 s47, s45, s47
    s_lshl_b32 s47, s47, 2
    s_lshr_b32 s47, 0x362, s47
    s_and_b32 s47, s47, 7
    s_cmp_ge_u32 s44, 10
    s_cselect_b32 s45, 9, 2
    s_cselect_b32 s51, 1, 0
    s_sub_u32 s45, s44, s45
    s_cmp_lt_u32 s44, 3
    s_cselect_b32 s45, 0, s45
    s_cselect_b32 s51, s44, s51
    s_lshl2_add_u32 s51, 1, s51
    s_cmp_lt_u32 s44, 17
    s_cselect_b32 s47, s51, s47
    s_cselect_b32 s46, s45, s46
    s_add_u32 s46, s46, s33
    s_and_b32 s46, s46, 7
    s_mul_i32 s46, s46, 7
    s_add_u32 s17, s46, s47
    s_lshr_b32 s53, s17, 3
    s_lshl_b32 s53, s53, 14
    s_and_b32 s17, s17, 7
    s_lshl_b32 s17, s17, 10
    s_add_u32 s17, s17, s53
    s_add_u32 s17, s17, s38
    s_add_u32 s44, s44, 1
    s_add_u32 s42, s42, 16384
    s_cmp_eq_u32 s42, 49152
    s_cselect_b32 s42, 0, s42
    s_add_u32 m0, m0, 1024
    s_add_u32 s39, s39, 229376
    buffer_load_dwordx4 v2, s[12:15], s39 offen sc1 lds
    s_add_u32 m0, m0, 1024
    s_add_u32 s40, s40, 229376
    buffer_load_dwordx4 v2, s[12:15], s40 offen sc1 lds
    s_add_u32 m0, m0, 1024
    s_add_u32 s39, s39, s37
    buffer_load_dwordx4 v2, s[12:15], s39 offen sc1 lds
    s_add_u32 m0, m0, 1024
    s_add_u32 s40, s40, s37
    buffer_load_dwordx4 v2, s[12:15], s40 offen sc1 lds
    s_add_u32 m0, m0, 1024
    s_add_u32 s39, s39, 229376
    buffer_load_dwordx4 v2, s[12:15], s39 offen sc1 lds
    s_add_u32 m0, m0, 1024
    s_add_u32 s40, s40, 229376
    buffer_load_dwordx4 v2, s[12:15], s40 offen sc1 lds
    s_mov_b32 m0, s19
    s_mov_b32 s39, s16
    s_mov_b32 s40, s17
    s_waitcnt vmcnt(8)
    s_barrier
    buffer_load_dwordx4 v2, s[12:15], s39 offen sc1 lds
    s_add_u32 m0, m0, 1024
    s_nop 0
    buffer_load_dwordx4 v2, s[12:15], s40 offen sc1 lds
    s_add_u32 s43, s43, 1
    s_cmp_lt_u32 s43, 4
    s_cbranch_scc1 ld_50
    s_call_b64 s[76:77], PREP_a_issue_4
    s_add_u32 m0, m0, 1024
    s_add_u32 s39, s39, 229376
    buffer_load_dwordx4 v2, s[12:15], s39 offen sc1 lds
    s_add_u32 m0, m0, 1024
    s_add_u32 s40, s40, 229376
    buffer_load_dwordx4 v2, s[12:15], s40 offen sc1 lds
    s_add_u32 m0, m0, 1024
    s_add_u32 s39, s39, s37
    buffer_load_dwordx4 v2, s[12:15], s39 offen sc1 lds
    s_add_u32 m0, m0, 1024
    s_add_u32 s40, s40, s37
    buffer_load_dwordx4 v2, s[12:15], s40 offen sc1 lds
    s_add_u32 m0, m0, 1024
    s_add_u32 s39, s39, 229376
    buffer_load_dwordx4 v2, s[12:15], s39 offen sc1 lds
    s_add_u32 m0, m0, 1024
    s_add_u32 s40, s40, 229376
    buffer_load_dwordx4 v2, s[12:15], s40 offen sc1 lds
    s_mov_b32 m0, s19
    s_mov_b32 s39, s16
    s_mov_b32 s40, s17
    s_waitcnt vmcnt(8)
    s_barrier
    buffer_load_dwordx4 v2, s[12:15], s39 offen sc1 lds
    s_add_u32 m0, m0, 1024
    s_nop 0
    buffer_load_dwordx4 v2, s[12:15], s40 offen sc1 lds
    s_load_dword s32, s[4:5], s34
    s_call_b64 s[76:77], PREP_a_issue_4
    s_add_u32 m0, m0, 1024
    s_add_u32 s39, s39, 229376
    buffer_load_dwordx4 v2, s[12:15], s39 offen sc1 lds
    s_add_u32 m0, m0, 1024
    s_add_u32 s40, s40, 229376
    buffer_load_dwordx4 v2, s[12:15], s40 offen sc1 lds
    s_add_u32 m0, m0, 1024
    s_add_u32 s39, s39, s37
    buffer_load_dwordx4 v2, s[12:15], s39 offen sc1 lds
    s_add_u32 m0, m0, 1024
    s_add_u32 s40, s40, s37
    buffer_load_dwordx4 v2, s[12:15], s40 offen sc1 lds
    s_add_u32 m0, m0, 1024
    s_add_u32 s39, s39, 229376
    buffer_load_dwordx4 v2, s[12:15], s39 offen sc1 lds
    s_add_u32 m0, m0, 1024
    s_add_u32 s40, s40, 229376
    buffer_load_dwordx4 v2, s[12:15], s40 offen sc1 lds
    s_mov_b32 m0, s19
    s_mov_b32 s39, s16
    s_mov_b32 s40, s17
    s_waitcnt vmcnt(8)
    s_barrier
    buffer_load_dwordx4 v2, s[12:15], s39 offen sc1 lds
    s_add_u32 m0, m0, 1024
    s_nop 0
    buffer_load_dwordx4 v2, s[12:15], s40 offen sc1 lds
    s_add_u32 s54, s52, 16
    s_waitcnt lgkmcnt(0)
    s_cmp_eq_u32 s32, s54
    s_cbranch_scc1 fok_51
    v_mov_b32 v9, s34
    s_mov_b32 s53, 0
    s_add_u32 s54, s52, 16
    s_bfm_b64 exec, 1, 0
poll_52:
    buffer_load_dword v8, v9, s[56:59], 0 offen sc1
    s_waitcnt vmcnt(0)
    v_cmp_eq_u32 vcc, s54, v8
    s_nop 0
    s_cmp_eq_u64 vcc, exec
    s_cbranch_scc1 pok_53
    s_sleep 5
    s_add_u32 s53, s53, 1
    s_cmp_lt_u32 s53, s61
    s_cbranch_scc1 poll_52
    s_mov_b32 s61, 0
pok_53:
    s_mov_b64 exec, -1
fok_51:
    s_call_b64 s[76:77], PREP_a_issue_4
    s_add_u32 m0, m0, 1024
    s_add_u32 s39, s39, 229376
    buffer_load_dwordx4 v2, s[12:15], s39 offen sc1 lds
    s_add_u32 m0, m0, 1024
    s_add_u32 s40, s40, 229376
    buffer_load_dwordx4 v2, s[12:15], s40 offen sc1 lds
    s_add_u32 m0, m0, 1024
    s_add_u32 s39, s39, s37
    buffer_load_dwordx4 v2, s[12:15], s39 offen sc1 lds
    s_add_u32 m0, m0, 1024
    s_add_u32 s40, s40, s37
    buffer_load_dwordx4 v2, s[12:15], s40 offen sc1 lds
    s_add_u32 m0, m0, 1024
    s_add_u32 s39, s39, 229376
    buffer_load_dwordx4 v2, s[12:15], s39 offen sc1 lds
    s_add_u32 m0, m0, 1024
    s_add_u32 s40, s40, 229376
    buffer_load_dwordx4 v2, s[12:15], s40 offen sc1 lds
    s_mov_b32 m0, s19
    s_mov_b32 s39, s16
    s_mov_b32 s40, s17
    s_waitcnt vmcnt(8)
    s_barrier
    buffer_load_dwordx4 v2, s[12:15], s39 offen sc1 lds
    s_add_u32 m0, m0, 1024
    s_nop 0
    buffer_load_dwordx4 v2, s[12:15], s40 offen sc1 lds
    s_mov_b32 s43, 1
ld_54:
    s_add_u32 s19, s41, s42
    s_lshl_b32 s45, s44, 1
    s_add_u32 s45, s45, 0
    s_sub_u32 s45, s45, 32
    s_mul_i32 s46, s45, 86
    s_lshr_b32 s46, s46, 8
    s_mul_i32 s47, s46, 3
    s_sub_u32 s47, s45, s47
    s_lshl_b32 s47, s47, 2
    s_lshr_b32 s47, 0x362, s47
    s_and_b32 s47, s47, 7
    s_cmp_ge_u32 s44, 10
    s_cselect_b32 s45, 9, 2
    s_cselect_b32 s51, 1, 0
    s_sub_u32 s45, s44, s45
    s_cmp_lt_u32 s44, 3
    s_cselect_b32 s45, 0, s45
    s_cselect_b32 s51, s44, s51
    s_lshl2_add_u32 s51, 0, s51
    s_cmp_lt_u32 s44, 17
    s_cselect_b32 s47, s51, s47
    s_cselect_b32 s46, s45, s46
    s_add_u32 s46, s46, s33
    s_and_b32 s46, s46, 7
    s_mul_i32 s46, s46, 7
    s_add_u32 s16, s46, s47
    s_lshr_b32 s53, s16, 3
    s_lshl_b32 s53, s53, 14
    s_and_b32 s16, s16, 7
    s_lshl_b32 s16, s16, 10
    s_add_u32 s16, s16, s53
    s_add_u32 s16, s16, s38
    s_lshl_b32 s45, s44, 1
    s_add_u32 s45, s45, 1
    s_sub_u32 s45, s45, 32
    s_mul_i32 s46, s45, 86
    s_lshr_b32 s46, s46, 8
    s_mul_i32 s47, s46, 3
    s_sub_u32 s47, s45, s47
    s_lshl_b32 s47, s47, 2
    s_lshr_b32 s47, 0x362, s47
    s_and_b32 s47, s47, 7
    s_cmp_ge_u32 s44, 10
    s_cselect_b32 s45, 9, 2
    s_cselect_b32 s51, 1, 0
    s_sub_u32 s45, s44, s45
    s_cmp_lt_u32 s44, 3
    s_cselect_b32 s45, 0, s45
    s_cselect_b32 s51, s44, s51
    s_lshl2_add_u32 s51, 1, s51
    s_cmp_lt_u32 s44, 17
    s_cselect_b32 s47, s51, s47
    s_cselect_b32 s46, s45, s46
    s_add_u32 s46, s46, s33
    s_and_b32 s46, s46, 7
    s_mul_i32 s46, s46, 7
    s_add_u32 s17, s46, s47
    s_lshr_b32 s53, s17, 3
    s_lshl_b32 s53, s53, 14
    s_and_b32 s17, s17, 7
    s_lshl_b32 s17, s17, 10
    s_add_u32 s17, s17, s53
    s_add_u32 s17, s17, s38
    s_add_u32 s44, s44, 1
    s_add_u32 s42, s42, 16384
    s_cmp_eq_u32 s42, 49152
    s_cselect_b32 s42, 0, s42
    s_add_u32 m0, m0, 1024
    s_add_u32 s39, s39, 229376
    buffer_load_dwordx4 v2, s[12:15], s39 offen sc1 lds
    s_add_u32 m0, m0, 1024
    s_add_u32 s40, s40, 229376
    buffer_load_dwordx4 v2, s[12:15], s40 offen sc1 lds
    s_add_u32 m0, m0, 1024
    s_add_u32 s39, s39, s37
    buffer_load_dwordx4 v2, s[12:15], s39 offen sc1 lds
    s_add_u32 m0, m0, 1024
    s_add_u32 s40, s40, s37
    buffer_load_dwordx4 v2, s[12:15], s40 offen sc1 lds
    s_add_u32 m0, m0, 1024
    s_add_u32 s39, s39, 229376
    buffer_load_dwordx4 v2, s[12:15], s39 offen sc1 lds
    s_add_u32 m0, m0, 1024
    s_add_u32 s40, s40, 229376
    buffer_load_dwordx4 v2, s[12:15], s40 offen sc1 lds
    s_mov_b32 m0, s19
    s_mov_b32 s39, s16
    s_mov_b32 s40, s17
    s_waitcnt vmcnt(8)
    s_barrier
    buffer_load_dwordx4 v2, s[12:15], s39 offen sc1 lds
    s_add_u32 m0, m0, 1024
    s_nop 0
    buffer_load_dwordx4 v2, s[12:15], s40 offen sc1 lds
    s_add_u32 s43, s43, 1
    s_cmp_lt_u32 s43, 5
    s_cbranch_scc1 ld_54
    s_call_b64 s[76:77], PREP_a_issue_4
    s_add_u32 m0, m0, 1024
    s_add_u32 s39, s39, 229376
    buffer_load_dwordx4 v2, s[12:15], s39 offen sc1 lds
    s_add_u32 m0, m0, 1024
    s_add_u32 s40, s40, 229376
    buffer_load_dwordx4 v2, s[12:15], s40 offen sc1 lds
    s_add_u32 m0, m0, 1024
    s_add_u32 s39, s39, s37
    buffer_load_dwordx4 v2, s[12:15], s39 offen sc1 lds
    s_add_u32 m0, m0, 1024
    s_add_u32 s40, s40, s37
    buffer_load_dwordx4 v2, s[12:15], s40 offen sc1 lds
    s_add_u32 m0, m0, 1024
    s_add_u32 s39, s39, 229376
    buffer_load_dwordx4 v2, s[12:15], s39 offen sc1 lds
    s_add_u32 m0, m0, 1024
    s_add_u32 s40, s40, 229376
    buffer_load_dwordx4 v2, s[12:15], s40 offen sc1 lds
    s_mov_b32 m0, s19
    s_mov_b32 s39, s16
    s_mov_b32 s40, s17
    s_waitcnt vmcnt(8)
    s_barrier
    buffer_load_dwordx4 v2, s[12:15], s39 offen sc1 lds
    s_add_u32 m0, m0, 1024
    s_nop 0
    buffer_load_dwordx4 v2, s[12:15], s40 offen sc1 lds
    s_load_dword s32, s[4:5], s35
    s_call_b64 s[76:77], PREP_a_issue_4
    s_add_u32 m0, m0, 1024
    s_add_u32 s39, s39, 229376
    buffer_load_dwordx4 v2, s[12:15], s39 offen sc1 lds
    s_add_u32 m0, m0, 1024
    s_add_u32 s40, s40, 229376
    buffer_load_dwordx4 v2, s[12:15], s40 offen sc1 lds
    s_add_u32 m0, m0, 1024
    s_add_u32 s39, s39, s37
    buffer_load_dwordx4 v2, s[12:15], s39 offen sc1 lds
    s_add_u32 m0, m0, 1024
    s_add_u32 s40, s40, s37
    buffer_load_dwordx4 v2, s[12:15], s40 offen sc1 lds
    s_add_u32 m0, m0, 1024
    s_add_u32 s39, s39, 229376
    buffer_load_dwordx4 v2, s[12:15], s39 offen sc1 lds
    s_add_u32 m0, m0, 1024
    s_add_u32 s40, s40, 229376
    buffer_load_dwordx4 v2, s[12:15], s40 offen sc1 lds
    s_mov_b32 m0, s19
    s_mov_b32 s39, s16
    s_mov_b32 s40, s17
    s_waitcnt vmcnt(8)
    s_barrier
    buffer_load_dwordx4 v2, s[12:15], s39 offen sc1 lds
    s_add_u32 m0, m0, 1024
    s_nop 0
    buffer_load_dwordx4 v2, s[12:15], s40 offen sc1 lds
    s_add_u32 s54, s52, 16
    s_waitcnt lgkmcnt(0)
    s_cmp_eq_u32 s32, s54
    s_cbranch_scc1 fok_55
    v_mov_b32 v9, s35
    s_mov_b32 s53, 0
    s_add_u32 s54, s52, 16
    s_bfm_b64 exec, 1, 0
poll_56:
    buffer_load_dword v8, v9, s[56:59], 0 offen sc1
    s_waitcnt vmcnt(0)
    v_cmp_eq_u32 vcc, s54, v8
    s_nop 0
    s_cmp_eq_u64 vcc, exec
    s_cbranch_scc1 pok_57
    s_sleep 5
    s_add_u32 s53, s53, 1
    s_cmp_lt_u32 s53, s61
    s_cbranch_scc1 poll_56
    s_mov_b32 s61, 0
pok_57:
    s_mov_b64 exec, -1
fok_55:
    s_call_b64 s[76:77], PREP_a_issue_4
    s_add_u32 m0, m0, 1024
    s_add_u32 s39, s39, 229376
    buffer_load_dwordx4 v2, s[12:15], s39 offen sc1 lds
    s_add_u32 m0, m0, 1024
    s_add_u32 s40, s40, 229376
    buffer_load_dwordx4 v2, s[12:15], s40 offen sc1 lds
    s_add_u32 m0, m0, 1024
    s_add_u32 s39, s39, s37
    buffer_load_dwordx4 v2, s[12:15], s39 offen sc1 lds
    s_add_u32 m0, m0, 1024
    s_add_u32 s40, s40, s37
    buffer_load_dwordx4 v2, s[12:15], s40 offen sc1 lds
    s_add_u32 m0, m0, 1024
    s_add_u32 s39, s39, 229376
    buffer_load_dwordx4 v2, s[12:15], s39 offen sc1 lds
    s_add_u32 m0, m0, 1024
    s_add_u32 s40, s40, 229376
    buffer_load_dwordx4 v2, s[12:15], s40 offen sc1 lds
    s_mov_b32 m0, s19
    s_mov_b32 s39, s16
    s_mov_b32 s40, s17
    s_waitcnt vmcnt(8)
    s_barrier
    buffer_load_dwordx4 v2, s[12:15], s39 offen sc1 lds
    s_add_u32 m0, m0, 1024
    s_nop 0
    buffer_load_dwordx4 v2, s[12:15], s40 offen sc1 lds
    s_mov_b32 s43, 1
ld_58:
    s_add_u32 s19, s41, s42
    s_lshl_b32 s45, s44, 1
    s_add_u32 s45, s45, 0
    s_sub_u32 s45, s45, 32
    s_mul_i32 s46, s45, 86
    s_lshr_b32 s46, s46, 8
    s_mul_i32 s47, s46, 3
    s_sub_u32 s47, s45, s47
    s_lshl_b32 s47, s47, 2
    s_lshr_b32 s47, 0x362, s47
    s_and_b32 s47, s47, 7
    s_cmp_ge_u32 s44, 10
    s_cselect_b32 s45, 9, 2
    s_cselect_b32 s51, 1, 0
    s_sub_u32 s45, s44, s45
    s_cmp_lt_u32 s44, 3
    s_cselect_b32 s45, 0, s45
    s_cselect_b32 s51, s44, s51
    s_lshl2_add_u32 s51, 0, s51
    s_cmp_lt_u32 s44, 17
    s_cselect_b32 s47, s51, s47
    s_cselect_b32 s46, s45, s46
    s_add_u32 s46, s46, s33
    s_and_b32 s46, s46, 7
    s_mul_i32 s46, s46, 7
    s_add_u32 s16, s46, s47
    s_lshr_b32 s53, s16, 3
    s_lshl_b32 s53, s53, 14
    s_and_b32 s16, s16, 7
    s_lshl_b32 s16, s16, 10
    s_add_u32 s16, s16, s53
    s_add_u32 s16, s16, s38
    s_lshl_b32 s45, s44, 1
    s_add_u32 s45, s45, 1
    s_sub_u32 s45, s45, 32
    s_mul_i32 s46, s45, 86
    s_lshr_b32 s46, s46, 8
    s_mul_i32 s47, s46, 3
    s_sub_u32 s47, s45, s47
    s_lshl_b32 s47, s47, 2
    s_lshr_b32 s47, 0x362, s47
    s_and_b32 s47, s47, 7
    s_cmp_ge_u32 s44, 10
    s_cselect_b32 s45, 9, 2
    s_cselect_b32 s51, 1, 0
    s_sub_u32 s45, s44, s45
    s_cmp_lt_u32 s44, 3
    s_cselect_b32 s45, 0, s45
    s_cselect_b32 s51, s44, s51
    s_lshl2_add_u32 s51, 1, s51
    s_cmp_lt_u32 s44, 17
    s_cselect_b32 s47, s51, s47
    s_cselect_b32 s46, s45, s46
    s_add_u32 s46, s46, s33
    s_and_b32 s46, s46, 7
    s_mul_i32 s46, s46, 7
    s_add_u32 s17, s46, s47
    s_lshr_b32 s53, s17, 3
    s_lshl_b32 s53, s53, 14
    s_and_b32 s17, s17, 7
    s_lshl_b32 s17, s17, 10
    s_add_u32 s17, s17, s53
    s_add_u32 s17, s17, s38
    s_add_u32 s44, s44, 1
    s_add_u32 s42, s42, 16384
    s_cmp_eq_u32 s42, 49152
    s_cselect_b32 s42, 0, s42
    s_add_u32 m0, m0, 1024
    s_add_u32 s39, s39, 229376
    buffer_load_dwordx4 v2, s[12:15], s39 offen sc1 lds
    s_add_u32 m0, m0, 1024
    s_add_u32 s40, s40, 229376
    buffer_load_dwordx4 v2, s[12:15], s40 offen sc1 lds
    s_add_u32 m0, m0, 1024
    s_add_u32 s39, s39, s37
    buffer_load_dwordx4 v2, s[12:15], s39 offen sc1 lds
    s_add_u32 m0, m0, 1024
    s_add_u32 s40, s40, s37
    buffer_load_dwordx4 v2, s[12:15], s40 offen sc1 lds
    s_add_u32 m0, m0, 1024
    s_add_u32 s39, s39, 229376
    buffer_load_dwordx4 v2, s[12:15], s39 offen sc1 lds
    s_add_u32 m0, m0, 1024
    s_add_u32 s40, s40, 229376
    buffer_load_dwordx4 v2, s[12:15], s40 offen sc1 lds
    s_mov_b32 m0, s19
    s_mov_b32 s39, s16
    s_mov_b32 s40, s17
    s_waitcnt vmcnt(8)
    s_barrier
    buffer_load_dwordx4 v2, s[12:15], s39 offen sc1 lds
    s_add_u32 m0, m0, 1024
    s_nop 0
    buffer_load_dwordx4 v2, s[12:15], s40 offen sc1 lds
    s_add_u32 s43, s43, 1
    s_cmp_lt_u32 s43, 5
    s_cbranch_scc1 ld_58
    s_call_b64 s[76:77], PREP_a_issue_4
    s_add_u32 m0, m0, 1024
    s_add_u32 s39, s39, 229376
    buffer_load_dwordx4 v2, s[12:15], s39 offen sc1 lds
    s_add_u32 m0, m0, 1024
    s_add_u32 s40, s40, 229376
    buffer_load_dwordx4 v2, s[12:15], s40 offen sc1 lds
    s_add_u32 m0, m0, 1024
    s_add_u32 s39, s39, s37
    buffer_load_dwordx4 v2, s[12:15], s39 offen sc1 lds
    s_add_u32 m0, m0, 1024
    s_add_u32 s40, s40, s37
    buffer_load_dwordx4 v2, s[12:15], s40 offen sc1 lds
    s_add_u32 m0, m0, 1024
    s_add_u32 s39, s39, 229376
    buffer_load_dwordx4 v2, s[12:15], s39 offen sc1 lds
    s_add_u32 m0, m0, 1024
    s_add_u32 s40, s40, 229376
    buffer_load_dwordx4 v2, s[12:15], s40 offen sc1 lds
    s_mov_b32 m0, s19
    s_mov_b32 s39, s16
    s_mov_b32 s40, s17
    s_waitcnt vmcnt(8)
    s_barrier
    s_add_u32 s39, s38, s37
    s_add_u32 s39, s39, 229376
    s_add_u32 m0, s41, 16384
    s_add_u32 s16, s39, s78
    s_add_u32 s17, s39, s79
    buffer_load_dwordx4 v2, s[12:15], s16 offen sc1 lds
    s_add_u32 m0, m0, 1024
    s_nop 0
    buffer_load_dwordx4 v2, s[12:15], s17 offen sc1 lds
    s_add_u32 m0, m0, 1024
    s_add_u32 s16, s16, 229376
    buffer_load_dwordx4 v2, s[12:15], s16 offen sc1 lds
    s_add_u32 m0, m0, 1024
    s_add_u32 s17, s17, 229376
    buffer_load_dwordx4 v2, s[12:15], s17 offen sc1 lds
    s_add_u32 m0, m0, 1024
    s_add_u32 s16, s39, s80
    s_add_u32 s17, s39, s81
    buffer_load_dwordx4 v2, s[12:15], s16 offen sc1 lds
    s_add_u32 m0, m0, 1024
    s_nop 0
    buffer_load_dwordx4 v2, s[12:15], s17 offen sc1 lds
    s_add_u32 m0, m0, 1024
    s_add_u32 s16, s16, 229376
    buffer_load_dwordx4 v2, s[12:15], s16 offen sc1 lds
    s_add_u32 m0, m0, 1024
    s_add_u32 s17, s17, 229376
    buffer_load_dwordx4 v2, s[12:15], s17 offen sc1 lds
    s_waitcnt vmcnt(8)
    s_barrier
    s_add_u32 m0, s41, 32768
    s_add_u32 s16, s39, s82
    s_add_u32 s17, s39, s83
    buffer_load_dwordx4 v2, s[12:15], s16 offen sc1 lds
    s_add_u32 m0, m0, 1024
    s_nop 0
    buffer_load_dwordx4 v2, s[12:15], s17 offen sc1 lds
    s_add_u32 m0, m0, 1024
    s_add_u32 s16, s16, 229376
    buffer_load_dwordx4 v2, s[12:15], s16 offen sc1 lds
    s_add_u32 m0, m0, 1024
    s_add_u32 s17, s17, 229376
    buffer_load_dwordx4 v2, s[12:15], s17 offen sc1 lds
    s_add_u32 m0, m0, 1024
    s_add_u32 s16, s39, s84
    s_add_u32 s17, s39, s85
    buffer_load_dwordx4 v2, s[12:15], s16 offen sc1 lds
    s_add_u32 m0, m0, 1024
    s_nop 0
    buffer_load_dwordx4 v2, s[12:15], s17 offen sc1 lds
    s_add_u32 m0, m0, 1024
    s_add_u32 s16, s16, 229376
    buffer_load_dwordx4 v2, s[12:15], s16 offen sc1 lds
    s_add_u32 m0, m0, 1024
    s_add_u32 s17, s17, 229376
    buffer_load_dwordx4 v2, s[12:15], s17 offen sc1 lds
    s_waitcnt vmcnt(8)
    s_barrier
    s_add_u32 m0, s41, 0
    s_add_u32 s16, s39, s86
    s_add_u32 s17, s39, s87
    buffer_load_dwordx4 v2, s[12:15], s16 offen sc1 lds
    s_add_u32 m0, m0, 1024
    s_nop 0
    buffer_load_dwordx4 v2, s[12:15], s17 offen sc1 lds
    s_add_u32 m0, m0, 1024
    s_add_u32 s16, s16, 229376
    buffer_load_dwordx4 v2, s[12:15], s16 offen sc1 lds
    s_add_u32 m0, m0, 1024
    s_add_u32 s17, s17, 229376
    buffer_load_dwordx4 v2, s[12:15], s17 offen sc1 lds
    s_add_u32 m0, m0, 1024
    s_add_u32 s16, s39, s88
    s_add_u32 s17, s39, s89
    buffer_load_dwordx4 v2, s[12:15], s16 offen sc1 lds
    s_add_u32 m0, m0, 1024
    s_nop 0
    buffer_load_dwordx4 v2, s[12:15], s17 offen sc1 lds
    s_add_u32 m0, m0, 1024
    s_add_u32 s16, s16, 229376
    buffer_load_dwordx4 v2, s[12:15], s16 offen sc1 lds
    s_add_u32 m0, m0, 1024
    s_add_u32 s17, s17, 229376
    buffer_load_dwordx4 v2, s[12:15], s17 offen sc1 lds
    s_cmp_lg_u32 s60, 0
    s_cbranch_scc1 tl_59
    s_call_b64 s[76:77], SUB_w1_piece_23
    s_waitcnt vmcnt(10)
    s_branch tz_60
tl_59:
    s_waitcnt vmcnt(8)
tz_60:
    s_barrier
    s_mov_b32 s39, s38
    s_add_u32 m0, s41, 16384
    s_add_u32 s16, s39, s78
    s_add_u32 s17, s39, s79
    buffer_load_dwordx4 v2, s[12:15], s16 offen sc1 lds
    s_add_u32 m0, m0, 1024
    s_nop 0
    buffer_load_dwordx4 v2, s[12:15], s17 offen sc1 lds
    s_add_u32 m0, m0, 1024
    s_add_u32 s16, s16, 229376
    buffer_load_dwordx4 v2, s[12:15], s16 offen sc1 lds
    s_add_u32 m0, m0, 1024
    s_add_u32 s17, s17, 229376
    buffer_load_dwordx4 v2, s[12:15], s17 offen sc1 lds
    s_add_u32 m0, m0, 1024
    s_add_u32 s16, s39, s80
    s_add_u32 s17, s39, s81
    buffer_load_dwordx4 v2, s[12:15], s16 offen sc1 lds
    s_add_u32 m0, m0, 1024
    s_nop 0
    buffer_load_dwordx4 v2, s[12:15], s17 offen sc1 lds
    s_add_u32 m0, m0, 1024
    s_add_u32 s16, s16, 229376
    buffer_load_dwordx4 v2, s[12:15], s16 offen sc1 lds
    s_add_u32 m0, m0, 1024
    s_add_u32 s17, s17, 229376
    buffer_load_dwordx4 v2, s[12:15], s17 offen sc1 lds
    s_cmp_lg_u32 s60, 0
    s_cbranch_scc1 tl_61
    s_call_b64 s[76:77], SUB_w1_piece_24
    s_waitcnt vmcnt(14)
    s_branch tz_62
tl_61:
    s_waitcnt vmcnt(8)
tz_62:
    s_barrier
    s_add_u32 m0, s41, 32768
    s_add_u32 s16, s39, s82
    s_add_u32 s17, s39, s83
    buffer_load_dwordx4 v2, s[12:15], s16 offen sc1 lds
    s_add_u32 m0, m0, 1024
    s_nop 0
    buffer_load_dwordx4 v2, s[12:15], s17 offen sc1 lds
    s_add_u32 m0, m0, 1024
    s_add_u32 s16, s16, 229376
    buffer_load_dwordx4 v2, s[12:15], s16 offen sc1 lds
    s_add_u32 m0, m0, 1024
    s_add_u32 s17, s17, 229376
    buffer_load_dwordx4 v2, s[12:15], s17 offen sc1 lds
    s_add_u32 m0, m0, 1024
    s_add_u32 s16, s39, s84
    s_add_u32 s17, s39, s85
    buffer_load_dwordx4 v2, s[12:15], s16 offen sc1 lds
    s_add_u32 m0, m0, 1024
    s_nop 0
    buffer_load_dwordx4 v2, s[12:15], s17 offen sc1 lds
    s_add_u32 m0, m0, 1024
    s_add_u32 s16, s16, 229376
    buffer_load_dwordx4 v2, s[12:15], s16 offen sc1 lds
    s_add_u32 m0, m0, 1024
    s_add_u32 s17, s17, 229376
    buffer_load_dwordx4 v2, s[12:15], s17 offen sc1 lds
    s_cmp_lg_u32 s60, 0
    s_cbranch_scc1 tl_63
    s_call_b64 s[76:77], SUB_w1_piece_25
    s_waitcnt vmcnt(16)
    s_branch tz_64
tl_63:
    s_waitcnt vmcnt(8)
tz_64:
    s_barrier
    s_add_u32 m0, s41, 0
    s_add_u32 s16, s39, s86
    s_add_u32 s17, s39, s87
    buffer_load_dwordx4 v2, s[12:15], s16 offen sc1 lds
    s_add_u32 m0, m0, 1024
    s_nop 0
    buffer_load_dwordx4 v2, s[12:15], s17 offen sc1 lds
    s_add_u32 m0, m0, 1024
    s_add_u32 s16, s16, 229376
    buffer_load_dwordx4 v2, s[12:15], s16 offen sc1 lds
    s_add_u32 m0, m0, 1024
    s_add_u32 s17, s17, 229376
    buffer_load_dwordx4 v2, s[12:15], s17 offen sc1 lds
    s_add_u32 m0, m0, 1024
    s_add_u32 s16, s39, s88
    s_add_u32 s17, s39, s89
    buffer_load_dwordx4 v2, s[12:15], s16 offen sc1 lds
    s_add_u32 m0, m0, 1024
    s_nop 0
    buffer_load_dwordx4 v2, s[12:15], s17 offen sc1 lds
    s_add_u32 m0, m0, 1024
    s_add_u32 s16, s16, 229376
    buffer_load_dwordx4 v2, s[12:15], s16 offen sc1 lds
    s_add_u32 m0, m0, 1024
    s_add_u32 s17, s17, 229376
    buffer_load_dwordx4 v2, s[12:15], s17 offen sc1 lds
    s_cmp_lg_u32 s60, 0
    s_cbranch_scc1 tl_65
    s_call_b64 s[76:77], SUB_w1_piece_26
    s_waitcnt vmcnt(18)
    s_branch tz_66
tl_65:
    s_waitcnt vmcnt(8)
tz_66:
    s_barrier
    s_cmp_lg_u32 s60, 0
    s_cbranch_scc1 tl_67
    s_call_b64 s[76:77], SUB_w1_piece_27
    s_waitcnt vmcnt(10)
    s_branch tz_68
tl_67:
    s_waitcnt vmcnt(0)
tz_68:
    s_barrier
    s_cmp_eq_u32 s60, 1
    s_cbranch_scc1 K_fin
    s_branch Y_END
WLOAD:
    s_mov_b64 s[12:13], s[72:73]
    s_mov_b32 s14, 7340032
    s_mov_b32 s15, 0x20000
    s_and_b32 s35, s30, 1
    s_mul_i32 s38, s29, 448
    s_mul_i32 s41, s35, 229376
    s_add_u32 s38, s38, s41
    s_mul_i32 s41, s35, 14336
    s_add_u32 s41, s41, 49152
    s_mov_b32 s42, 0
    s_mov_b32 s44, s29
    s_add_u32 s44, s44, 1
    s_and_b32 s44, s44, 15
    s_add_u32 s44, s44, 1
    s_and_b32 s44, s44, 15
    s_add_u32 s46, s29, 1
    s_and_b32 s46, s46, 15
    s_cmp_eq_u32 s28, s29
    s_cselect_b32 s47, s46, s28
    s_mov_b32 s42, 57344
    s_call_b64 s[76:77], PREP_w_issue_3
    s_mov_b32 m0, s19
    s_mov_b32 s39, s16
    s_waitcnt vmcnt(0)
    s_and_b32 s53, s30, 3
    s_lshl_b32 s53, s53, 7
    s_add_u32 s53, s53, s55
    s_add_u32 s53, s53, 0x400
    v_mov_b32 v14, 1
    v_mov_b32 v15, 0
    s_mov_b64 exec, 1
    buffer_atomic_add v14, v15, s[56:59], s53 offen sc1
    s_mov_b64 exec, -1
    s_call_b64 s[76:77], SUB_rest_2
    s_waitcnt lgkmcnt(0)
    buffer_load_dwordx4 v121, s[12:15], s39 offen  lds
    s_add_u32 m0, m0, 1024
    s_nop 0
    buffer_load_dwordx4 v122, s[12:15], s39 offen  lds
    s_add_u32 m0, m0, 1024
    s_nop 0
    buffer_load_dwordx4 v123, s[12:15], s39 offen  lds
    s_call_b64 s[76:77], PREP_w_issue_3
    s_add_u32 m0, m0, 1024
    s_nop 0
    buffer_load_dwordx4 v124, s[12:15], s39 offen  lds
    s_add_u32 m0, m0, 1024
    s_nop 0
    buffer_load_dwordx4 v125, s[12:15], s39 offen  lds
    s_add_u32 m0, m0, 1024
    s_nop 0
    buffer_load_dwordx4 v126, s[12:15], s39 offen  lds
    s_add_u32 m0, m0, 1024
    s_nop 0
    buffer_load_dwordx4 v127, s[12:15], s39 offen  lds
    s_add_u32 m0, m0, 1024
    s_add_u32 s39, s39, 114688
    buffer_load_dwordx4 v121, s[12:15], s39 offen  lds
    s_add_u32 m0, m0, 1024
    s_nop 0
    buffer_load_dwordx4 v122, s[12:15], s39 offen  lds
    s_add_u32 m0, m0, 1024
    s_nop 0
    buffer_load_dwordx4 v123, s[12:15], s39 offen  lds
    s_add_u32 m0, m0, 1024
    s_nop 0
    buffer_load_dwordx4 v124, s[12:15], s39 offen  lds
    s_add_u32 m0, m0, 1024
    s_nop 0
    buffer_load_dwordx4 v125, s[12:15], s39 offen  lds
    s_add_u32 m0, m0, 1024
    s_nop 0
    buffer_load_dwordx4 v126, s[12:15], s39 offen  lds
    s_add_u32 m0, m0, 1024
    s_nop 0
    buffer_load_dwordx4 v127, s[12:15], s39 offen  lds
    s_mov_b32 m0, s19
    s_mov_b32 s39, s16
    s_cmp_lg_u32 s60, 0
    s_cbranch_scc1 cs_69
    s_and_b32 s35, s30, 1
    v_lshrrev_b32 v112, 2, v1
    v_mul_u32_u24 v104, 448, v112
    v_and_b32 v113, 3, v1
    v_lshl_add_u32 v104, v113, 3, v104
    v_add_u32 v104, 49152, v104
    v_mul_u32_u24 v106, 448, v112
    v_and_b32 v113, 2, v1
    v_lshl_add_u32 v106, v113, 2, v106
    v_bfe_u32 v112, v1, 4, 1
    v_and_b32 v113, 1, v1
    v_xor_b32 v113, v113, v112
    v_lshl_add_u32 v106, v113, 5, v106
    s_lshl_b32 s36, s35, 4
    s_add_u32 s36, s36, 49344
    v_add_u32 v106, s36, v106
    s_lshl_b32 s36, s35, 8
    v_add_u32 v104, s36, v104
    v_lshlrev_b32 v112, 5, v112
    v_sub_u32 v105, v104, v112
    v_add_u32 v104, v104, v112
    s_cmp_eq_u32 s28, s29
    s_cselect_b32 s36, 0, 28672
    v_add_u32 v104, s36, v104
    v_add_u32 v105, s36, v105
    v_add_u32 v106, s36, v106
    ds_read_b64_tr_b16 v[48:49], v104 offset:0
    ds_read_b64_tr_b16 v[50:51], v104 offset:7168
    ds_read_b64_tr_b16 v[52:53], v104 offset:14336
    ds_read_b64_tr_b16 v[54:55], v104 offset:21504
    ds_read_b64_tr_b16 v[56:57], v105 offset:32
    ds_read_b64_tr_b16 v[58:59], v105 offset:7200
    ds_read_b64_tr_b16 v[60:61], v105 offset:14368
    ds_read_b64_tr_b16 v[62:63], v105 offset:21536
    ds_read_b64_tr_b16 v[64:65], v104 offset:64
    ds_read_b64_tr_b16 v[66:67], v104 offset:7232
    ds_read_b64_tr_b16 v[68:69], v104 offset:14400
    ds_read_b64_tr_b16 v[70:71], v104 offset:21568
    ds_read_b64_tr_b16 v[72:73], v105 offset:96
    ds_read_b64_tr_b16 v[74:75], v105 offset:7264
    ds_read_b64_tr_b16 v[76:77], v105 offset:14432
    ds_read_b64_tr_b16 v[78:79], v105 offset:21600
    ds_read_b64_tr_b16 v[80:81], v104 offset:128
    ds_read_b64_tr_b16 v[82:83], v104 offset:7296
    ds_read_b64_tr_b16 v[84:85], v104 offset:14464
    ds_read_b64_tr_b16 v[86:87], v104 offset:21632
    ds_read_b64_tr_b16 v[88:89], v105 offset:160
    ds_read_b64_tr_b16 v[90:91], v105 offset:7328
    ds_read_b64_tr_b16 v[92:93], v105 offset:14496
    ds_read_b64_tr_b16 v[94:95], v105 offset:21664
    ds_read_b64_tr_b16 v[96:97], v106 offset:0
    ds_read_b64_tr_b16 v[98:99], v106 offset:7168
    ds_read_b64_tr_b16 v[100:101], v106 offset:14336
    ds_read_b64_tr_b16 v[102:103], v106 offset:21504
    v_and_b32 v112, 15, v1
    v_mov_b32 v113, 0x3f803f80
    v_cmp_eq_u32 vcc, 0, v112
    s_nop 1
    v_cndmask_b32 v20, 0, v113, vcc
    v_cndmask_b32 v21, 0, v113, vcc
    v_cndmask_b32 v22, 0, v113, vcc
    v_cndmask_b32 v23, 0, v113, vcc
    v_cmp_eq_u32 vcc, 1, v112
    s_nop 1
    v_cndmask_b32 v24, 0, v113, vcc
    v_cndmask_b32 v25, 0, v113, vcc
    v_cndmask_b32 v26, 0, v113, vcc
    v_cndmask_b32 v27, 0, v113, vcc
    v_cmp_eq_u32 vcc, 2, v112
    s_nop 1
    v_cndmask_b32 v28, 0, v113, vcc
    v_cndmask_b32 v29, 0, v113, vcc
    v_cndmask_b32 v30, 0, v113, vcc
    v_cndmask_b32 v31, 0, v113, vcc
    v_cmp_eq_u32 vcc, 3, v112
    s_nop 1
    v_cndmask_b32 v32, 0, v113, vcc
    v_cndmask_b32 v33, 0, v113, vcc
    v_cndmask_b32 v34, 0, v113, vcc
    v_cndmask_b32 v35, 0, v113, vcc
    v_cmp_eq_u32 vcc, 4, v112
    s_nop 1
    v_cndmask_b32 v36, 0, v113, vcc
    v_cndmask_b32 v37, 0, v113, vcc
    v_cndmask_b32 v38, 0, v113, vcc
    v_cndmask_b32 v39, 0, v113, vcc
    v_cmp_eq_u32 vcc, 5, v112
    s_nop 1
    v_cndmask_b32 v40, 0, v113, vcc
    v_cndmask_b32 v41, 0, v113, vcc
    v_cndmask_b32 v42, 0, v113, vcc
    v_cndmask_b32 v43, 0, v113, vcc
    v_cmp_eq_u32 vcc, 6, v112
    s_nop 1
    v_cndmask_b32 v44, 0, v113, vcc
    v_cndmask_b32 v45, 0, v113, vcc
    v_cndmask_b32 v46, 0, v113, vcc
    v_cndmask_b32 v47, 0, v113, vcc
    v_and_b32 v114, 48, v1
    v_lshl_add_u32 v114, v112, 6, v114
    v_mov_b32 v113, 0x7f000000
    v_cmp_gt_u32 vcc, 7, v112
    s_nop 1
    v_cndmask_b32 v114, v113, v114, vcc
    s_add_u32 s20, s4, 0x1420000
    s_addc_u32 s21, s5, 0
    s_mov_b32 s22, 0x38000
    s_mov_b32 s23, 0x20000
    s_mul_i32 s36, s28, 14336
    s_lshl1_add_u32 s35, s29, s35
    s_mul_i32 s35, s35, 448
    s_add_u32 s35, s35, s36
    s_waitcnt lgkmcnt(0)
    v_mfma_f32_16x16x32_bf16 v[108:111], v[48:51], v[20:23], 0
    v_mfma_f32_16x16x32_bf16 v[108:111], v[52:55], v[20:23], v[108:111]
    v_mfma_f32_16x16x32_bf16 v[108:111], v[56:59], v[24:27], v[108:111]
    v_mfma_f32_16x16x32_bf16 v[108:111], v[60:63], v[24:27], v[108:111]
    v_mfma_f32_16x16x32_bf16 v[108:111], v[64:67], v[28:31], v[108:111]
    v_mfma_f32_16x16x32_bf16 v[108:111], v[68:71], v[28:31], v[108:111]
    v_mfma_f32_16x16x32_bf16 v[108:111], v[72:75], v[32:35], v[108:111]
    v_mfma_f32_16x16x32_bf16 v[108:111], v[76:79], v[32:35], v[108:111]
    v_mfma_f32_16x16x32_bf16 v[108:111], v[80:83], v[36:39], v[108:111]
    v_mfma_f32_16x16x32_bf16 v[108:111], v[84:87], v[36:39], v[108:111]
    v_mfma_f32_16x16x32_bf16 v[108:111], v[88:91], v[40:43], v[108:111]
    v_mfma_f32_16x16x32_bf16 v[108:111], v[92:95], v[40:43], v[108:111]
    v_mfma_f32_16x16x32_bf16 v[108:111], v[96:99], v[44:47], v[108:111]
    v_mfma_f32_16x16x32_bf16 v[108:111], v[100:103], v[44:47], v[108:111]
    s_nop 7
    buffer_store_dwordx4 v[108:111], v114, s[20:23], s35 offen sc1
cs_69:
    s_waitcnt vmcnt(15)
    s_barrier
    buffer_load_dwordx4 v121, s[12:15], s39 offen  lds
    s_add_u32 m0, m0, 1024
    s_nop 0
    buffer_load_dwordx4 v122, s[12:15], s39 offen  lds
    s_add_u32 m0, m0, 1024
    s_nop 0
    buffer_load_dwordx4 v123, s[12:15], s39 offen  lds
    s_call_b64 s[76:77], PREP_w_issue_3
    s_add_u32 m0, m0, 1024
    s_nop 0
    buffer_load_dwordx4 v124, s[12:15], s39 offen  lds
    s_add_u32 m0, m0, 1024
    s_nop 0
    buffer_load_dwordx4 v125, s[12:15], s39 offen  lds
    s_add_u32 m0, m0, 1024
    s_nop 0
    buffer_load_dwordx4 v126, s[12:15], s39 offen  lds
    s_add_u32 m0, m0, 1024
    s_nop 0
    buffer_load_dwordx4 v127, s[12:15], s39 offen  lds
    s_add_u32 m0, m0, 1024
    s_add_u32 s39, s39, 114688
    buffer_load_dwordx4 v121, s[12:15], s39 offen  lds
    s_add_u32 m0, m0, 1024
    s_nop 0
    buffer_load_dwordx4 v122, s[12:15], s39 offen  lds
    s_add_u32 m0, m0, 1024
    s_nop 0
    buffer_load_dwordx4 v123, s[12:15], s39 offen  lds
    s_add_u32 m0, m0, 1024
    s_nop 0
    buffer_load_dwordx4 v124, s[12:15], s39 offen  lds
    s_add_u32 m0, m0, 1024
    s_nop 0
    buffer_load_dwordx4 v125, s[12:15], s39 offen  lds
    s_add_u32 m0, m0, 1024
    s_nop 0
    buffer_load_dwordx4 v126, s[12:15], s39 offen  lds
    s_add_u32 m0, m0, 1024
    s_nop 0
    buffer_load_dwordx4 v127, s[12:15], s39 offen  lds
    s_mov_b32 m0, s19
    s_mov_b32 s39, s16
    s_waitcnt vmcnt(14)
    s_barrier
    buffer_load_dwordx4 v121, s[12:15], s39 offen  lds
    s_add_u32 m0, m0, 1024
    s_nop 0
    buffer_load_dwordx4 v122, s[12:15], s39 offen  lds
    s_add_u32 m0, m0, 1024
    s_nop 0
    buffer_load_dwordx4 v123, s[12:15], s39 offen  lds
    s_call_b64 s[76:77], PREP_w_issue_3
    s_add_u32 m0, m0, 1024
    s_nop 0
    buffer_load_dwordx4 v124, s[12:15], s39 offen  lds
    s_add_u32 m0, m0, 1024
    s_nop 0
    buffer_load_dwordx4 v125, s[12:15], s39 offen  lds
    s_add_u32 m0, m0, 1024
    s_nop 0
    buffer_load_dwordx4 v126, s[12:15], s39 offen  lds
    s_add_u32 m0, m0, 1024
    s_nop 0
    buffer_load_dwordx4 v127, s[12:15], s39 offen  lds
    s_add_u32 m0, m0, 1024
    s_add_u32 s39, s39, 114688
    buffer_load_dwordx4 v121, s[12:15], s39 offen  lds
    s_add_u32 m0, m0, 1024
    s_nop 0
    buffer_load_dwordx4 v122, s[12:15], s39 offen  lds
    s_add_u32 m0, m0, 1024
    s_nop 0
    buffer_load_dwordx4 v123, s[12:15], s39 offen  lds
    s_add_u32 m0, m0, 1024
    s_nop 0
    buffer_load_dwordx4 v124, s[12:15], s39 offen  lds
    s_add_u32 m0, m0, 1024
    s_nop 0
    buffer_load_dwordx4 v125, s[12:15], s39 offen  lds
    s_add_u32 m0, m0, 1024
    s_nop 0
    buffer_load_dwordx4 v126, s[12:15], s39 offen  lds
    s_add_u32 m0, m0, 1024
    s_nop 0
    buffer_load_dwordx4 v127, s[12:15], s39 offen  lds
    s_mov_b32 m0, s19
    s_mov_b32 s39, s16
    s_waitcnt vmcnt(14)
    s_barrier
    buffer_load_dwordx4 v121, s[12:15], s39 offen  lds
    s_add_u32 m0, m0, 1024
    s_nop 0
    buffer_load_dwordx4 v122, s[12:15], s39 offen  lds
    s_add_u32 m0, m0, 1024
    s_nop 0
    buffer_load_dwordx4 v123, s[12:15], s39 offen  lds
    s_call_b64 s[76:77], PREP_w_issue_3
    s_add_u32 m0, m0, 1024
    s_nop 0
    buffer_load_dwordx4 v124, s[12:15], s39 offen  lds
    s_add_u32 m0, m0, 1024
    s_nop 0
    buffer_load_dwordx4 v125, s[12:15], s39 offen  lds
    s_add_u32 m0, m0, 1024
    s_nop 0
    buffer_load_dwordx4 v126, s[12:15], s39 offen  lds
    s_add_u32 m0, m0, 1024
    s_nop 0
    buffer_load_dwordx4 v127, s[12:15], s39 offen  lds
    s_add_u32 m0, m0, 1024
    s_add_u32 s39, s39, 114688
    buffer_load_dwordx4 v121, s[12:15], s39 offen  lds
    s_add_u32 m0, m0, 1024
    s_nop 0
    buffer_load_dwordx4 v122, s[12:15], s39 offen  lds
    s_add_u32 m0, m0, 1024
    s_nop 0
    buffer_load_dwordx4 v123, s[12:15], s39 offen  lds
    s_add_u32 m0, m0, 1024
    s_nop 0
    buffer_load_dwordx4 v124, s[12:15], s39 offen  lds
    s_add_u32 m0, m0, 1024
    s_nop 0
    buffer_load_dwordx4 v125, s[12:15], s39 offen  lds
    s_add_u32 m0, m0, 1024
    s_nop 0
    buffer_load_dwordx4 v126, s[12:15], s39 offen  lds
    s_add_u32 m0, m0, 1024
    s_nop 0
    buffer_load_dwordx4 v127, s[12:15], s39 offen  lds
    s_mov_b32 m0, s19
    s_mov_b32 s39, s16
    s_waitcnt vmcnt(28)
    s_cmp_lg_u32 s60, 0
    s_cbranch_scc1 cs_70
    s_and_b32 s36, s30, 1
    s_lshl_b32 s36, s36, 13
    s_lshl_b32 s53, s29, 7
    s_add_u32 s36, s36, s53
    s_add_u32 s36, s36, 23068672
    v_mov_b32 v14, 1
    v_mov_b32 v15, 0
    s_mov_b64 exec, 1
    buffer_atomic_add v14, v15, s[56:59], s36 offen sc1
    s_mov_b64 exec, -1
cs_70:
    s_waitcnt vmcnt(14)
    s_barrier
    buffer_load_dwordx4 v121, s[12:15], s39 offen  lds
    s_add_u32 m0, m0, 1024
    s_nop 0
    buffer_load_dwordx4 v122, s[12:15], s39 offen  lds
    s_add_u32 m0, m0, 1024
    s_nop 0
    buffer_load_dwordx4 v123, s[12:15], s39 offen  lds
    s_mov_b32 s43, 1
ld_71:
    s_add_u32 s19, s41, s42
    s_cmp_eq_u32 s44, s47
    s_cselect_b32 s16, s46, s44
    s_mul_i32 s16, s16, 458752
    s_add_u32 s16, s16, s38
    s_add_u32 s44, s44, 1
    s_and_b32 s44, s44, 15
    s_add_u32 s42, s42, 28672
    s_cmp_eq_u32 s42, 86016
    s_cselect_b32 s42, 0, s42
    s_add_u32 m0, m0, 1024
    s_nop 0
    buffer_load_dwordx4 v124, s[12:15], s39 offen  lds
    s_add_u32 m0, m0, 1024
    s_nop 0
    buffer_load_dwordx4 v125, s[12:15], s39 offen  lds
    s_add_u32 m0, m0, 1024
    s_nop 0
    buffer_load_dwordx4 v126, s[12:15], s39 offen  lds
    s_add_u32 m0, m0, 1024
    s_nop 0
    buffer_load_dwordx4 v127, s[12:15], s39 offen  lds
    s_add_u32 m0, m0, 1024
    s_add_u32 s39, s39, 114688
    buffer_load_dwordx4 v121, s[12:15], s39 offen  lds
    s_add_u32 m0, m0, 1024
    s_nop 0
    buffer_load_dwordx4 v122, s[12:15], s39 offen  lds
    s_add_u32 m0, m0, 1024
    s_nop 0
    buffer_load_dwordx4 v123, s[12:15], s39 offen  lds
    s_add_u32 m0, m0, 1024
    s_nop 0
    buffer_load_dwordx4 v124, s[12:15], s39 offen  lds
    s_add_u32 m0, m0, 1024
    s_nop 0
    buffer_load_dwordx4 v125, s[12:15], s39 offen  lds
    s_add_u32 m0, m0, 1024
    s_nop 0
    buffer_load_dwordx4 v126, s[12:15], s39 offen  lds
    s_add_u32 m0, m0, 1024
    s_nop 0
    buffer_load_dwordx4 v127, s[12:15], s39 offen  lds
    s_mov_b32 m0, s19
    s_mov_b32 s39, s16
    s_waitcnt vmcnt(14)
    s_barrier
    buffer_load_dwordx4 v121, s[12:15], s39 offen  lds
    s_add_u32 m0, m0, 1024
    s_nop 0
    buffer_load_dwordx4 v122, s[12:15], s39 offen  lds
    s_add_u32 m0, m0, 1024
    s_nop 0
    buffer_load_dwordx4 v123, s[12:15], s39 offen  lds
    s_add_u32 s43, s43, 1
    s_cmp_lt_u32 s43, 9
    s_cbranch_scc1 ld_71
    s_call_b64 s[76:77], PREP_w_issue_3
    s_add_u32 m0, m0, 1024
    s_nop 0
    buffer_load_dwordx4 v124, s[12:15], s39 offen  lds
    s_add_u32 m0, m0, 1024
    s_nop 0
    buffer_load_dwordx4 v125, s[12:15], s39 offen  lds
    s_add_u32 m0, m0, 1024
    s_nop 0
    buffer_load_dwordx4 v126, s[12:15], s39 offen  lds
    s_add_u32 m0, m0, 1024
    s_nop 0
    buffer_load_dwordx4 v127, s[12:15], s39 offen  lds
    s_add_u32 m0, m0, 1024
    s_add_u32 s39, s39, 114688
    buffer_load_dwordx4 v121, s[12:15], s39 offen  lds
    s_add_u32 m0, m0, 1024
    s_nop 0
    buffer_load_dwordx4 v122, s[12:15], s39 offen  lds
    s_add_u32 m0, m0, 1024
    s_nop 0
    buffer_load_dwordx4 v123, s[12:15], s39 offen  lds
    s_add_u32 m0, m0, 1024
    s_nop 0
    buffer_load_dwordx4 v124, s[12:15], s39 offen  lds
    s_add_u32 m0, m0, 1024
    s_nop 0
    buffer_load_dwordx4 v125, s[12:15], s39 offen  lds
    s_add_u32 m0, m0, 1024
    s_nop 0
    buffer_load_dwordx4 v126, s[12:15], s39 offen  lds
    s_add_u32 m0, m0, 1024
    s_nop 0
    buffer_load_dwordx4 v127, s[12:15], s39 offen  lds
    s_mov_b32 m0, s19
    s_mov_b32 s39, s16
    s_waitcnt vmcnt(14)
    s_barrier
    buffer_load_dwordx4 v121, s[12:15], s39 offen  lds
    s_add_u32 m0, m0, 1024
    s_nop 0
    buffer_load_dwordx4 v122, s[12:15], s39 offen  lds
    s_add_u32 m0, m0, 1024
    s_nop 0
    buffer_load_dwordx4 v123, s[12:15], s39 offen  lds
    s_add_u32 m0, m0, 1024
    s_nop 0
    buffer_load_dwordx4 v124, s[12:15], s39 offen  lds
    s_add_u32 m0, m0, 1024
    s_nop 0
    buffer_load_dwordx4 v125, s[12:15], s39 offen  lds
    s_add_u32 m0, m0, 1024
    s_nop 0
    buffer_load_dwordx4 v126, s[12:15], s39 offen  lds
    s_add_u32 m0, m0, 1024
    s_nop 0
    buffer_load_dwordx4 v127, s[12:15], s39 offen  lds
    s_add_u32 m0, m0, 1024
    s_add_u32 s39, s39, 114688
    buffer_load_dwordx4 v121, s[12:15], s39 offen  lds
    s_add_u32 m0, m0, 1024
    s_nop 0
    buffer_load_dwordx4 v122, s[12:15], s39 offen  lds
    s_add_u32 m0, m0, 1024
    s_nop 0
    buffer_load_dwordx4 v123, s[12:15], s39 offen  lds
    s_add_u32 m0, m0, 1024
    s_nop 0
    buffer_load_dwordx4 v124, s[12:15], s39 offen  lds
    s_add_u32 m0, m0, 1024
    s_nop 0
    buffer_load_dwordx4 v125, s[12:15], s39 offen  lds
    s_add_u32 m0, m0, 1024
    s_nop 0
    buffer_load_dwordx4 v126, s[12:15], s39 offen  lds
    s_add_u32 m0, m0, 1024
    s_nop 0
    buffer_load_dwordx4 v127, s[12:15], s39 offen  lds
    s_waitcnt vmcnt(14)
    s_barrier
    s_waitcnt vmcnt(0)
    s_barrier
    s_barrier
    s_mov_b64 s[12:13], s[74:75]
    s_mov_b32 s14, 7340032
    s_mov_b32 s15, 0x20000
    s_and_b32 s35, s30, 1
    s_mul_i32 s38, s33, 256
    s_mul_i32 s41, s31, 3670016
    s_add_u32 s38, s38, s41
    s_mul_i32 s41, s35, 8192
    s_add_u32 s41, s41, 49152
    s_mov_b32 s42, 0
    s_mov_b32 s44, 0
    s_mov_b32 s49, s44
    s_and_b32 s43, s28, 0
    s_mul_i32 s43, s43, 6
    s_lshr_b32 s43, s43, 2
    s_mov_b32 s50, 0
wpre_72:
    s_mul_i32 s42, s43, 16384
    s_add_u32 s44, s49, s43
    s_add_u32 s19, s41, s42
    s_and_b32 s40, s30, 1
    s_lshl_b32 s45, s44, 1
    s_add_u32 s45, s45, s40
    s_sub_u32 s45, s45, 32
    s_mul_i32 s46, s45, 86
    s_lshr_b32 s46, s46, 8
    s_mul_i32 s47, s46, 3
    s_sub_u32 s47, s45, s47
    s_lshl_b32 s47, s47, 2
    s_lshr_b32 s47, 0x362, s47
    s_and_b32 s47, s47, 7
    s_cmp_ge_u32 s44, 10
    s_cselect_b32 s45, 9, 2
    s_cselect_b32 s51, 1, 0
    s_sub_u32 s45, s44, s45
    s_cmp_lt_u32 s44, 3
    s_cselect_b32 s45, 0, s45
    s_cselect_b32 s51, s44, s51
    s_lshl2_add_u32 s51, s40, s51
    s_cmp_lt_u32 s44, 17
    s_cselect_b32 s47, s51, s47
    s_cselect_b32 s46, s45, s46
    s_add_u32 s46, s46, s33
    s_and_b32 s46, s46, 7
    s_mul_i32 s46, s46, 7
    s_add_u32 s16, s46, s47
    s_mul_i32 s16, s16, 65536
    s_add_u32 s16, s16, s38
    s_add_u32 s44, s44, 1
    s_add_u32 s42, s42, 16384
    s_cmp_eq_u32 s42, 98304
    s_cselect_b32 s42, 0, s42
    s_mov_b32 m0, s19
    s_mov_b32 s39, s16
    buffer_load_dwordx4 v119, s[12:15], s39 offen  lds
    s_add_u32 m0, m0, 1024
    s_add_u32 s39, s39, 8192
    buffer_load_dwordx4 v120, s[12:15], s39 offen  lds
    s_add_u32 m0, m0, 1024
    s_add_u32 s39, s39, 8192
    buffer_load_dwordx4 v119, s[12:15], s39 offen  lds
    s_add_u32 m0, m0, 1024
    s_add_u32 s39, s39, 8192
    buffer_load_dwordx4 v120, s[12:15], s39 offen  lds
    s_waitcnt vmcnt(8)
    s_add_u32 m0, m0, 1024
    s_add_u32 s39, s39, 8192
    buffer_load_dwordx4 v119, s[12:15], s39 offen  lds
    s_add_u32 m0, m0, 1024
    s_add_u32 s39, s39, 8192
    buffer_load_dwordx4 v120, s[12:15], s39 offen  lds
    s_add_u32 m0, m0, 1024
    s_add_u32 s39, s39, 8192
    buffer_load_dwordx4 v119, s[12:15], s39 offen  lds
    s_add_u32 m0, m0, 1024
    s_add_u32 s39, s39, 8192
    buffer_load_dwordx4 v120, s[12:15], s39 offen  lds
    s_waitcnt vmcnt(8)
    s_add_u32 s43, s43, 1
    s_cmp_eq_u32 s43, 6
    s_cselect_b32 s43, 0, s43
    s_add_u32 s50, s50, 1
    s_cmp_lt_u32 s50, 6
    s_cbranch_scc1 wpre_72
    s_mov_b32 s42, 0
    s_add_u32 s44, s49, 6
    s_mov_b64 s[8:9], s[68:69]
    s_mov_b32 s10, 2097152
    s_mov_b32 s11, 0x20000
    s_and_b32 s3, s30, 3
    s_lshl_b32 s36, s3, 14
    s_lshl_b32 s90, s29, 7
    s_add_u32 s90, s90, s36
    s_xor_b32 s90, s90, 128
    s_lshl_b32 s3, s3, 10
    s_call_b64 s[76:77], PREP_w_issue_4
    s_mov_b32 m0, s19
    s_mov_b32 s39, s16
    s_waitcnt vmcnt(40)
    s_barrier
    s_waitcnt vmcnt(32)
    s_barrier
    buffer_load_dwordx4 v119, s[12:15], s39 offen  lds
    s_add_u32 m0, m0, 1024
    s_add_u32 s39, s39, 8192
    buffer_load_dwordx4 v120, s[12:15], s39 offen  lds
    s_mov_b32 s43, 1
ld_73:
    s_add_u32 s19, s41, s42
    s_and_b32 s40, s30, 1
    s_lshl_b32 s45, s44, 1
    s_add_u32 s45, s45, s40
    s_sub_u32 s45, s45, 32
    s_mul_i32 s46, s45, 86
    s_lshr_b32 s46, s46, 8
    s_mul_i32 s47, s46, 3
    s_sub_u32 s47, s45, s47
    s_lshl_b32 s47, s47, 2
    s_lshr_b32 s47, 0x362, s47
    s_and_b32 s47, s47, 7
    s_cmp_ge_u32 s44, 10
    s_cselect_b32 s45, 9, 2
    s_cselect_b32 s51, 1, 0
    s_sub_u32 s45, s44, s45
    s_cmp_lt_u32 s44, 3
    s_cselect_b32 s45, 0, s45
    s_cselect_b32 s51, s44, s51
    s_lshl2_add_u32 s51, s40, s51
    s_cmp_lt_u32 s44, 17
    s_cselect_b32 s47, s51, s47
    s_cselect_b32 s46, s45, s46
    s_add_u32 s46, s46, s33
    s_and_b32 s46, s46, 7
    s_mul_i32 s46, s46, 7
    s_add_u32 s16, s46, s47
    s_mul_i32 s16, s16, 65536
    s_add_u32 s16, s16, s38
    s_add_u32 s44, s44, 1
    s_add_u32 s42, s42, 16384
    s_cmp_eq_u32 s42, 98304
    s_cselect_b32 s42, 0, s42
    s_add_u32 m0, m0, 1024
    s_add_u32 s39, s39, 8192
    buffer_load_dwordx4 v119, s[12:15], s39 offen  lds
    s_add_u32 m0, m0, 1024
    s_add_u32 s39, s39, 8192
    buffer_load_dwordx4 v120, s[12:15], s39 offen  lds
    s_add_u32 m0, m0, 1024
    s_add_u32 s39, s39, 8192
    buffer_load_dwordx4 v119, s[12:15], s39 offen  lds
    s_add_u32 m0, m0, 1024
    s_add_u32 s39, s39, 8192
    buffer_load_dwordx4 v120, s[12:15], s39 offen  lds
    s_add_u32 m0, m0, 1024
    s_add_u32 s39, s39, 8192
    buffer_load_dwordx4 v119, s[12:15], s39 offen  lds
    s_add_u32 m0, m0, 1024
    s_add_u32 s39, s39, 8192
    buffer_load_dwordx4 v120, s[12:15], s39 offen  lds
    s_mov_b32 m0, s19
    s_mov_b32 s39, s16
    s_waitcnt vmcnt(32)
    s_barrier
    buffer_load_dwordx4 v119, s[12:15], s39 offen  lds
    s_add_u32 m0, m0, 1024
    s_add_u32 s39, s39, 8192
    buffer_load_dwordx4 v120, s[12:15], s39 offen  lds
    s_add_u32 s43, s43, 1
    s_cmp_lt_u32 s43, 20
    s_cbranch_scc1 ld_73
    s_call_b64 s[76:77], PREP_w_issue_4
    s_add_u32 m0, m0, 1024
    s_add_u32 s39, s39, 8192
    buffer_load_dwordx4 v119, s[12:15], s39 offen  lds
    s_add_u32 m0, m0, 1024
    s_add_u32 s39, s39, 8192
    buffer_load_dwordx4 v120, s[12:15], s39 offen  lds
    s_add_u32 m0, m0, 1024
    s_add_u32 s39, s39, 8192
    buffer_load_dwordx4 v119, s[12:15], s39 offen  lds
    s_add_u32 m0, m0, 1024
    s_add_u32 s39, s39, 8192
    buffer_load_dwordx4 v120, s[12:15], s39 offen  lds
    s_add_u32 m0, m0, 1024
    s_add_u32 s39, s39, 8192
    buffer_load_dwordx4 v119, s[12:15], s39 offen  lds
    s_add_u32 m0, m0, 1024
    s_add_u32 s39, s39, 8192
    buffer_load_dwordx4 v120, s[12:15], s39 offen  lds
    s_mov_b32 m0, s19
    s_mov_b32 s39, s16
    s_waitcnt vmcnt(32)
    s_barrier
    buffer_load_dwordx4 v119, s[12:15], s39 offen  lds
    s_add_u32 m0, m0, 1024
    s_add_u32 s39, s39, 8192
    buffer_load_dwordx4 v120, s[12:15], s39 offen  lds
    s_add_u32 m0, m0, 1024
    s_add_u32 s39, s39, 8192
    buffer_load_dwordx4 v119, s[12:15], s39 offen  lds
    s_add_u32 m0, m0, 1024
    s_add_u32 s39, s39, 8192
    buffer_load_dwordx4 v120, s[12:15], s39 offen  lds
    s_add_u32 m0, m0, 1024
    s_add_u32 s39, s39, 8192
    buffer_load_dwordx4 v119, s[12:15], s39 offen  lds
    s_add_u32 m0, m0, 1024
    s_add_u32 s39, s39, 8192
    buffer_load_dwordx4 v120, s[12:15], s39 offen  lds
    s_add_u32 m0, m0, 1024
    s_add_u32 s39, s39, 8192
    buffer_load_dwordx4 v119, s[12:15], s39 offen  lds
    s_add_u32 m0, m0, 1024
    s_add_u32 s39, s39, 8192
    buffer_load_dwordx4 v120, s[12:15], s39 offen  lds
    s_call_b64 s[76:77], PREP_w_issue_4
    s_mov_b32 m0, s19
    s_mov_b32 s39, s16
    s_waitcnt vmcnt(24)
    s_barrier
    buffer_load_dwordx4 v119, s[12:15], s39 offen  lds
    s_add_u32 m0, m0, 1024
    s_add_u32 s39, s39, 8192
    buffer_load_dwordx4 v120, s[12:15], s39 offen  lds
    s_add_u32 m0, m0, 1024
    s_add_u32 s39, s39, 8192
    buffer_load_dwordx4 v119, s[12:15], s39 offen  lds
    s_add_u32 m0, m0, 1024
    s_add_u32 s39, s39, 8192
    buffer_load_dwordx4 v120, s[12:15], s39 offen  lds
    s_add_u32 m0, m0, 1024
    s_add_u32 s39, s39, 8192
    buffer_load_dwordx4 v119, s[12:15], s39 offen  lds
    s_add_u32 m0, m0, 1024
    s_add_u32 s39, s39, 8192
    buffer_load_dwordx4 v120, s[12:15], s39 offen  lds
    s_add_u32 m0, m0, 1024
    s_add_u32 s39, s39, 8192
    buffer_load_dwordx4 v119, s[12:15], s39 offen  lds
    s_add_u32 m0, m0, 1024
    s_add_u32 s39, s39, 8192
    buffer_load_dwordx4 v120, s[12:15], s39 offen  lds
    s_cmp_lg_u32 s60, 0
    s_cbranch_scc1 tl_74
    s_call_b64 s[76:77], SUB_w1_piece_23
    s_waitcnt vmcnt(18)
    s_branch tz_75
tl_74:
    s_waitcnt vmcnt(16)
tz_75:
    s_barrier
    s_cmp_lg_u32 s60, 0
    s_cbranch_scc1 tl_76
    s_call_b64 s[76:77], SUB_w1_piece_24
    s_waitcnt vmcnt(6)
    s_branch tz_77
tl_76:
    s_waitcnt vmcnt(0)
tz_77:
    s_barrier
    s_cmp_lg_u32 s60, 0
    s_cbranch_scc1 tl_78
    s_call_b64 s[76:77], SUB_w1_piece_25
tl_78:
tz_79:
    s_barrier
    s_cmp_lg_u32 s60, 0
    s_cbranch_scc1 tl_80
    s_call_b64 s[76:77], SUB_w1_piece_26
tl_80:
tz_81:
    s_barrier
    s_cmp_lg_u32 s60, 0
    s_cbranch_scc1 tl_82
    s_call_b64 s[76:77], SUB_w1_piece_27
tl_82:
tz_83:
    s_barrier
    s_cmp_eq_u32 s60, 1
    s_cbranch_scc1 K_fin
    s_branch Y_END
Y_END:
    v_and_b32 v81, 7, v0
    v_lshrrev_b32 v84, 6, v0
    v_lshlrev_b32 v84, 4, v84
    v_bfe_u32 v85, v0, 3, 3
    v_add_u32 v84, v84, v85
    s_lshr_b32 s78, s67, 1
    s_lshl_b32 s78, s78, 16
    s_and_b32 s79, s67, 1
    s_lshl_b32 s79, s79, 7
    s_add_u32 s78, s78, s79
    s_lshr_b32 s79, s30, 1
    s_lshl_b32 s79, s79, 13
    s_add_u32 s78, s78, s79
    v_lshlrev_b32 v78, 8, v84
    v_lshl_add_u32 v78, v81, 4, v78
    v_add_u32 v78, s78, v78
    s_lshl_b32 s78, s28, 7
    s_lshl_b32 s79, s67, 3
    s_add_u32 s78, s78, s79
    v_add_u32 v79, s78, v81
    v_lshlrev_b32 v80, 11, v79
    v_and_b32 v85, 3, v79
    v_lshrrev_b32 v82, 2, v79
    v_lshlrev_b32 v82, 14, v82
    v_lshl_add_u32 v82, v85, 11, v82
    v_lshl_add_u32 v82, v84, 4, v82
    v_lshrrev_b32 v85, 2, v84
    v_lshlrev_b32 v85, 3, v85
    v_and_b32 v84, 3, v84
    v_add_u32 v84, v84, v85
    v_lshl_add_u32 v80, v84, 3, v80
    v_lshlrev_b32 v79, 3, v79
    v_lshl_add_u32 v79, v84, 14, v79
    s_add_u32 s80, s4, 0x1800000
    s_addc_u32 s81, s5, 0
    s_mov_b32 s82, 0x400000
    s_mov_b32 s83, 0x20000
    s_mov_b32 s78, 0
    buffer_load_dwordx2 v[110:111], v79, s[80:83], s78 offen sc1
    s_mov_b32 s78, 65536
    buffer_load_dwordx2 v[112:113], v79, s[80:83], s78 offen sc1
    s_mov_b32 s78, 262144
    buffer_load_dwordx2 v[114:115], v79, s[80:83], s78 offen sc1
    s_mov_b32 s78, 327680
    buffer_load_dwordx2 v[116:117], v79, s[80:83], s78 offen sc1
    s_waitcnt vmcnt(10)
    s_barrier
    s_and_b32 s36, s30, 3
    s_lshl_b32 s36, s36, 10
    v_add_u32 v8, s36, v2
    v_add_u32 v9, 65536, v8
    v_add_u32 v10, 131072, v8
    ds_write_b128 v8, v[12:15] offset:49152
    ds_write_b128 v8, v[16:19] offset:53248
    ds_write_b128 v8, v[20:23] offset:57344
    ds_write_b128 v8, v[24:27] offset:61440
    ds_write_b128 v9, v[28:31] offset:0
    ds_write_b128 v9, v[32:35] offset:4096
    ds_write_b128 v9, v[36:39] offset:8192
    ds_write_b128 v9, v[40:43] offset:12288
    ds_write_b128 v10, v[44:47] offset:0
    ds_write_b128 v10, v[48:51] offset:4096
    ds_write_b128 v10, v[52:55] offset:8192
    ds_write_b128 v10, v[56:59] offset:12288
    ds_write_b128 v8, v[60:63] offset:24576
    ds_write_b128 v8, v[64:67] offset:28672
    s_waitcnt lgkmcnt(0)
NEXT:
    s_setprio 0
    s_add_u32 s60, s60, 1
    s_add_u32 s55, s55, 67108864
    s_add_u32 s62, s62, 67108864
    s_addc_u32 s63, s63, 0
    s_branch LAYER
K_fin:
    s_endpgm
PREP_a_issue_3:
    s_add_u32 s19, s41, s42
    s_cmp_eq_u32 s44, s47
    s_cselect_b32 s16, s46, s44
    s_cmp_eq_u32 s44, s46
    s_cselect_b32 s16, s47, s16
    s_lshr_b32 s45, s16, 2
    s_lshl_b32 s45, s45, 14
    s_and_b32 s16, s16, 3
    s_lshl_b32 s16, s16, 11
    s_add_u32 s16, s16, s45
    s_add_u32 s16, s16, s38
    s_add_u32 s44, s44, 1
    s_and_b32 s44, s44, 15
    s_add_u32 s42, s42, 16384
    s_cmp_eq_u32 s42, 49152
    s_cselect_b32 s42, 0, s42
    s_setpc_b64 s[76:77]
SUB_rest_2:
    v_lshlrev_b32 v108, 16, v20
    v_and_b32 v109, 0xffff0000, v20
    v_lshlrev_b32 v110, 16, v21
    v_and_b32 v111, 0xffff0000, v21
    v_lshlrev_b32 v112, 16, v22
    v_and_b32 v113, 0xffff0000, v22
    v_lshlrev_b32 v114, 16, v23
    v_and_b32 v115, 0xffff0000, v23
    v_pk_add_f32 v[24:25], v[108:109], v[110:111]
    v_pk_mul_f32 v[26:27], v[108:109], v[108:109]
    v_pk_fma_f32 v[26:27], v[110:111], v[110:111], v[26:27]
    v_pk_add_f32 v[24:25], v[24:25], v[112:113]
    v_pk_fma_f32 v[26:27], v[112:113], v[112:113], v[26:27]
    v_pk_add_f32 v[24:25], v[24:25], v[114:115]
    v_pk_fma_f32 v[26:27], v[114:115], v[114:115], v[26:27]
    v_add_f32 v100, v24, v25
    v_add_f32 v101, v26, v27
    v_lshlrev_b32 v108, 16, v28
    v_and_b32 v109, 0xffff0000, v28
    v_lshlrev_b32 v110, 16, v29
    v_and_b32 v111, 0xffff0000, v29
    v_lshlrev_b32 v112, 16, v30
    v_and_b32 v113, 0xffff0000, v30
    v_lshlrev_b32 v114, 16, v31
    v_and_b32 v115, 0xffff0000, v31
    v_pk_add_f32 v[32:33], v[108:109], v[110:111]
    v_pk_mul_f32 v[34:35], v[108:109], v[108:109]
    v_pk_fma_f32 v[34:35], v[110:111], v[110:111], v[34:35]
    v_pk_add_f32 v[32:33], v[32:33], v[112:113]
    v_pk_fma_f32 v[34:35], v[112:113], v[112:113], v[34:35]
    v_pk_add_f32 v[32:33], v[32:33], v[114:115]
    v_pk_fma_f32 v[34:35], v[114:115], v[114:115], v[34:35]
    v_add_f32 v102, v32, v33
    v_add_f32 v103, v34, v35
    v_lshlrev_b32 v108, 16, v36
    v_and_b32 v109, 0xffff0000, v36
    v_lshlrev_b32 v110, 16, v37
    v_and_b32 v111, 0xffff0000, v37
    v_lshlrev_b32 v112, 16, v38
    v_and_b32 v113, 0xffff0000, v38
    v_lshlrev_b32 v114, 16, v39
    v_and_b32 v115, 0xffff0000, v39
    v_pk_add_f32 v[40:41], v[108:109], v[110:111]
    v_pk_mul_f32 v[42:43], v[108:109], v[108:109]
    v_pk_fma_f32 v[42:43], v[110:111], v[110:111], v[42:43]
    v_pk_add_f32 v[40:41], v[40:41], v[112:113]
    v_pk_fma_f32 v[42:43], v[112:113], v[112:113], v[42:43]
    v_pk_add_f32 v[40:41], v[40:41], v[114:115]
    v_pk_fma_f32 v[42:43], v[114:115], v[114:115], v[42:43]
    v_add_f32 v104, v40, v41
    v_add_f32 v105, v42, v43
    v_lshlrev_b32 v108, 16, v44
    v_and_b32 v109, 0xffff0000, v44
    v_lshlrev_b32 v110, 16, v45
    v_and_b32 v111, 0xffff0000, v45
    v_lshlrev_b32 v112, 16, v46
    v_and_b32 v113, 0xffff0000, v46
    v_lshlrev_b32 v114, 16, v47
    v_and_b32 v115, 0xffff0000, v47
    v_pk_add_f32 v[48:49], v[108:109], v[110:111]
    v_pk_mul_f32 v[50:51], v[108:109], v[108:109]
    v_pk_fma_f32 v[50:51], v[110:111], v[110:111], v[50:51]
    v_pk_add_f32 v[48:49], v[48:49], v[112:113]
    v_pk_fma_f32 v[50:51], v[112:113], v[112:113], v[50:51]
    v_pk_add_f32 v[48:49], v[48:49], v[114:115]
    v_pk_fma_f32 v[50:51], v[114:115], v[114:115], v[50:51]
    v_add_f32 v106, v48, v49
    v_add_f32 v107, v50, v51
    s_and_b32 s36, s30, 3
    s_lshl_b32 s36, s36, 10
    s_add_u32 s36, s36, 155648
    v_lshlrev_b32 v6, 3, v1
    v_add_u32 v6, s36, v6
    v_permlane32_swap_b32 v100, v102
    v_permlane32_swap_b32 v104, v106
    v_permlane32_swap_b32 v101, v103
    v_permlane32_swap_b32 v105, v107
    v_pk_add_f32 v[100:101], v[100:101], v[102:103]
    v_pk_add_f32 v[104:105], v[104:105], v[106:107]
    ds_write_b64 v6, v[100:101] offset:0
    ds_write_b64 v6, v[104:105] offset:512
    s_setpc_b64 s[76:77]
PREP_a_issue_4:
    s_add_u32 s19, s41, s42
    s_lshl_b32 s45, s44, 1
    s_add_u32 s45, s45, 0
    s_sub_u32 s45, s45, 32
    s_mul_i32 s46, s45, 86
    s_lshr_b32 s46, s46, 8
    s_mul_i32 s47, s46, 3
    s_sub_u32 s47, s45, s47
    s_lshl_b32 s47, s47, 2
    s_lshr_b32 s47, 0x362, s47
    s_and_b32 s47, s47, 7
    s_cmp_ge_u32 s44, 10
    s_cselect_b32 s45, 9, 2
    s_cselect_b32 s51, 1, 0
    s_sub_u32 s45, s44, s45
    s_cmp_lt_u32 s44, 3
    s_cselect_b32 s45, 0, s45
    s_cselect_b32 s51, s44, s51
    s_lshl2_add_u32 s51, 0, s51
    s_cmp_lt_u32 s44, 17
    s_cselect_b32 s47, s51, s47
    s_cselect_b32 s46, s45, s46
    s_add_u32 s46, s46, s33
    s_and_b32 s46, s46, 7
    s_mul_i32 s46, s46, 7
    s_add_u32 s16, s46, s47
    s_lshr_b32 s53, s16, 3
    s_lshl_b32 s53, s53, 14
    s_and_b32 s16, s16, 7
    s_lshl_b32 s16, s16, 10
    s_add_u32 s16, s16, s53
    s_add_u32 s16, s16, s38
    s_lshl_b32 s45, s44, 1
    s_add_u32 s45, s45, 1
    s_sub_u32 s45, s45, 32
    s_mul_i32 s46, s45, 86
    s_lshr_b32 s46, s46, 8
    s_mul_i32 s47, s46, 3
    s_sub_u32 s47, s45, s47
    s_lshl_b32 s47, s47, 2
    s_lshr_b32 s47, 0x362, s47
    s_and_b32 s47, s47, 7
    s_cmp_ge_u32 s44, 10
    s_cselect_b32 s45, 9, 2
    s_cselect_b32 s51, 1, 0
    s_sub_u32 s45, s44, s45
    s_cmp_lt_u32 s44, 3
    s_cselect_b32 s45, 0, s45
    s_cselect_b32 s51, s44, s51
    s_lshl2_add_u32 s51, 1, s51
    s_cmp_lt_u32 s44, 17
    s_cselect_b32 s47, s51, s47
    s_cselect_b32 s46, s45, s46
    s_add_u32 s46, s46, s33
    s_and_b32 s46, s46, 7
    s_mul_i32 s46, s46, 7
    s_add_u32 s17, s46, s47
    s_lshr_b32 s53, s17, 3
    s_lshl_b32 s53, s53, 14
    s_and_b32 s17, s17, 7
    s_lshl_b32 s17, s17, 10
    s_add_u32 s17, s17, s53
    s_add_u32 s17, s17, s38
    s_add_u32 s44, s44, 1
    s_add_u32 s42, s42, 16384
    s_cmp_eq_u32 s42, 49152
    s_cselect_b32 s42, 0, s42
    s_setpc_b64 s[76:77]
SUB_w1_piece_23:
    s_add_u32 s36, s90, 393216
    buffer_load_dwordx4 v[12:15], v118, s[8:11], s36 offen
    s_add_u32 s36, s36, 65536
    buffer_load_dwordx4 v[16:19], v118, s[8:11], s36 offen
    s_setpc_b64 s[76:77]
SUB_w1_piece_24:
    s_add_u32 s36, s90, 524288
    buffer_load_dwordx4 v[20:23], v118, s[8:11], s36 offen
    s_add_u32 s36, s36, 65536
    buffer_load_dwordx4 v[24:27], v118, s[8:11], s36 offen
    s_add_u32 s36, s90, 655360
    buffer_load_dwordx4 v[28:31], v118, s[8:11], s36 offen
    s_add_u32 s36, s36, 65536
    buffer_load_dwordx4 v[32:35], v118, s[8:11], s36 offen
    s_setpc_b64 s[76:77]
SUB_w1_piece_25:
    s_add_u32 s36, s90, 786432
    buffer_load_dwordx4 v[36:39], v118, s[8:11], s36 offen
    s_add_u32 s36, s36, 65536
    buffer_load_dwordx4 v[40:43], v118, s[8:11], s36 offen
    s_add_u32 s36, s90, 1703936
    buffer_load_dwordx4 v[44:47], v118, s[8:11], s36 offen
    s_add_u32 s36, s36, 65536
    buffer_load_dwordx4 v[48:51], v118, s[8:11], s36 offen
    s_setpc_b64 s[76:77]
SUB_w1_piece_26:
    s_add_u32 s36, s90, 1835008
    buffer_load_dwordx4 v[52:55], v118, s[8:11], s36 offen
    s_add_u32 s36, s36, 65536
    buffer_load_dwordx4 v[56:59], v118, s[8:11], s36 offen
    s_add_u32 s36, s90, 0
    buffer_load_dwordx4 v[60:63], v118, s[8:11], s36 offen
    s_add_u32 s36, s36, 65536
    buffer_load_dwordx4 v[64:67], v118, s[8:11], s36 offen
    s_add_u32 s36, s90, 1966080
    s_add_u32 m0, s3, 147456
    s_nop 0
    buffer_load_dwordx4 v118, s[8:11], s36 offen lds
    s_add_u32 s36, s36, 65536
    s_add_u32 m0, s3, 151552
    s_nop 0
    buffer_load_dwordx4 v118, s[8:11], s36 offen lds
    s_setpc_b64 s[76:77]
SUB_w1_piece_27:
    s_add_u32 s36, s90, 1441792
    s_add_u32 m0, s3, 114688
    s_nop 0
    buffer_load_dwordx4 v118, s[8:11], s36 offen lds
    s_add_u32 s36, s36, 65536
    s_add_u32 m0, s3, 118784
    s_nop 0
    buffer_load_dwordx4 v118, s[8:11], s36 offen lds
    s_add_u32 s36, s90, 1572864
    s_add_u32 m0, s3, 122880
    s_nop 0
    buffer_load_dwordx4 v118, s[8:11], s36 offen lds
    s_add_u32 s36, s36, 65536
    s_add_u32 m0, s3, 126976
    s_nop 0
    buffer_load_dwordx4 v118, s[8:11], s36 offen lds
    s_setpc_b64 s[76:77]
PREP_w_issue_3:
    s_add_u32 s19, s41, s42
    s_cmp_eq_u32 s44, s47
    s_cselect_b32 s16, s46, s44
    s_mul_i32 s16, s16, 458752
    s_add_u32 s16, s16, s38
    s_add_u32 s44, s44, 1
    s_and_b32 s44, s44, 15
    s_add_u32 s42, s42, 28672
    s_cmp_eq_u32 s42, 86016
    s_cselect_b32 s42, 0, s42
    s_setpc_b64 s[76:77]
PREP_w_issue_4:
    s_add_u32 s19, s41, s42
    s_and_b32 s40, s30, 1
    s_lshl_b32 s45, s44, 1
    s_add_u32 s45, s45, s40
    s_sub_u32 s45, s45, 32
    s_mul_i32 s46, s45, 86
    s_lshr_b32 s46, s46, 8
    s_mul_i32 s47, s46, 3
    s_sub_u32 s47, s45, s47
    s_lshl_b32 s47, s47, 2
    s_lshr_b32 s47, 0x362, s47
    s_and_b32 s47, s47, 7
    s_cmp_ge_u32 s44, 10
    s_cselect_b32 s45, 9, 2
    s_cselect_b32 s51, 1, 0
    s_sub_u32 s45, s44, s45
    s_cmp_lt_u32 s44, 3
    s_cselect_b32 s45, 0, s45
    s_cselect_b32 s51, s44, s51
    s_lshl2_add_u32 s51, s40, s51
    s_cmp_lt_u32 s44, 17
    s_cselect_b32 s47, s51, s47
    s_cselect_b32 s46, s45, s46
    s_add_u32 s46, s46, s33
    s_and_b32 s46, s46, 7
    s_mul_i32 s46, s46, 7
    s_add_u32 s16, s46, s47
    s_mul_i32 s16, s16, 65536
    s_add_u32 s16, s16, s38
    s_add_u32 s44, s44, 1
    s_add_u32 s42, s42, 16384
    s_cmp_eq_u32 s42, 98304
    s_cselect_b32 s42, 0, s42
    s_setpc_b64 s[76:77]
K_end:
    s_endpgm
.section .rodata,"a"
.p2align 6
.amdhsa_kernel interleave_layers__ssm_conv_h3__mixer_s_mlp__prompt_kernel
  .amdhsa_next_free_vgpr 256
  .amdhsa_next_free_sgpr 102
  .amdhsa_accum_offset 256
  .amdhsa_group_segment_fixed_size 0
  .amdhsa_kernarg_size 112
  .amdhsa_user_sgpr_count 2
  .amdhsa_user_sgpr_kernarg_segment_ptr 1
  .amdhsa_system_sgpr_workgroup_id_x 1
  .amdhsa_float_denorm_mode_32 3
.end_amdhsa_kernel
```

```asm
; @launch grid=(256,1,1) block=(512,1,1) lds=163840
.amdgcn_target "amdgcn-amd-amdhsa--gfx950"
.text
.globl interleave_layers__ssm_conv_h3__mixer_s_mlp__prompt_kernel
.p2align 8
.type interleave_layers__ssm_conv_h3__mixer_s_mlp__prompt_kernel,@function
interleave_layers__ssm_conv_h3__mixer_s_mlp__prompt_kernel:
    s_cmp_ge_u32 s2, 256
    s_cbranch_scc1 K_end
    s_load_dwordx8 s[8:15], s[0:1], 8
    s_load_dwordx2 s[6:7], s[0:1], 0
    s_load_dwordx8 s[68:75], s[0:1], 56
    s_load_dwordx2 s[4:5], s[0:1], 104
    s_load_dwordx2 s[84:85], s[0:1], 96
    s_memrealtime s[46:47]
    s_load_dwordx2 s[76:77], s[0:1], 40
    v_lshrrev_b32 v1, 6, v0
    s_nop 0
    v_readfirstlane_b32 s30, v1
    s_getpc_b64 s[48:49]
K_pc:
    s_lshr_b32 s36, s2, 3
    s_lshl_b32 s36, s36, 12
    v_lshlrev_b32 v252, 3, v0
    v_add_u32 v252, s36, v252
    v_cmp_gt_u32 vcc, K_end-K_pc-8, v252
    s_nop 0
    s_and_saveexec_b64 s[36:37], vcc
    s_cbranch_execz K_3
    v_mov_b32 v253, s49
    v_add_co_u32 v252, vcc, s48, v252
    s_nop 1
    v_addc_co_u32 v253, vcc, 0, v253, vcc
    global_load_dword v250, v[252:253], off
K_3:
    s_mov_b64 exec, -1
    v_bfe_u32 v8, v0, 4, 2
    v_and_b32 v9, 15, v0
    v_lshlrev_b32 v6, 11, v8
    v_lshlrev_b32 v8, 1, v8
    v_xor_b32 v8, v8, v9
    v_lshl_add_u32 v8, v8, 4, v6
    s_and_b32 s34, s2, 7
    s_lshr_b32 s35, s2, 3
    s_lshl_b32 s36, s35, 17
    s_lshl_b32 s37, s34, 8
    s_add_u32 s36, s36, s37
    s_lshl_b32 s37, s30, 6
    s_and_b32 s38, s37, 128
    s_add_u32 s37, s37, 64
    s_and_b32 s37, s37, 128
    v_xor_b32 v6, s38, v8
    v_xor_b32 v7, s37, v8
    s_lshl_b32 s37, s30, 14
    s_add_u32 s37, s37, s36
    s_add_u32 s38, s37, 8192
    s_lshl_b32 s39, s30, 11
    s_mov_b32 s18, 4194304
    s_mov_b32 s19, 0x20000
    s_mov_b32 s22, s18
    s_mov_b32 s23, s19
    s_add_u32 m0, s39, 99328
    s_waitcnt lgkmcnt(0)
    s_mov_b64 s[16:17], s[8:9]
    s_mov_b64 s[20:21], s[10:11]
    buffer_load_dwordx4 v6, s[16:19], s37 offen nt lds
    s_add_u32 m0, m0, 1024
    s_nop 0
    buffer_load_dwordx4 v7, s[16:19], s38 offen nt lds
    s_add_u32 m0, s39, 115712
    s_nop 0
    buffer_load_dwordx4 v6, s[20:23], s37 offen nt lds
    s_add_u32 m0, m0, 1024
    s_nop 0
    buffer_load_dwordx4 v6, s[20:23], s38 offen nt lds
    s_mov_b32 s86, 256
    s_mov_b32 s87, 0x20000
    v_mov_b32 v10, 0
    s_cmp_lg_u32 s30, 0
    s_cbranch_scc1 KV_t0
    s_sub_u32 s36, s36, 8192
    v_add_u32 v8, s36, v8
    s_mov_b32 m0, 98304
    s_nop 0
    buffer_load_dwordx4 v8, s[16:19], 0 offen nt lds
    s_cmp_lg_u32 s2, 0
    s_cbranch_scc1 KV_t0
    s_lshl_b32 s44, s46, 6
    s_or_b32 s44, s44, 1
    v_mov_b32 v9, s44
    s_mov_b64 exec, 1
    buffer_store_dword v9, v10, s[84:87], 0 offen sc1
    s_mov_b64 exec, -1
KV_t0:
    s_lshl_b32 s37, s34, 10
    s_lshl_b32 s38, s30, 7
    s_add_u32 s37, s37, s38
    v_and_b32 v9, 15, v0
    v_lshlrev_b32 v9, 3, v9
    s_mov_b32 s24, s12
    s_mov_b32 s25, s13
    s_mov_b32 s26, 0x2000
    s_mov_b32 s27, 0x20000
    buffer_load_dwordx2 v[12:13], v9, s[24:27], s37 offen
    v_and_b32 v1, 63, v0
    v_lshlrev_b32 v2, 4, v1
    v_lshlrev_b32 v3, 2, v1
    s_and_b32 s32, s2, 7
    s_lshr_b32 s33, s2, 3
    s_and_b32 s28, s32, 2
    s_lshr_b32 s34, s32, 2
    s_or_b32 s28, s28, s34
    s_lshl_b32 s28, s28, 2
    s_and_b32 s34, s33, 3
    s_add_u32 s28, s28, s34
    s_and_b32 s31, s32, 1
    s_lshr_b32 s33, s33, 2
    s_lshl_b32 s29, s31, 3
    s_add_u32 s29, s29, s33
    s_and_b32 s67, s33, 4
    s_add_u32 s67, s67, s33
    s_lshl2_add_u32 s67, s31, s67
    s_mov_b32 s60, 0
    s_mov_b32 s61, 40000
    s_mov_b32 s52, 0
    s_mov_b32 s55, 0
    s_mov_b32 s92, 0
    s_mov_b32 s93, 0
    s_mov_b32 s94, 0
    s_mov_b32 s98, 1
    s_mov_b32 s56, s4
    s_mov_b32 s57, s5
    s_mov_b32 s58, 0xa000000
    s_mov_b32 s59, 0x20000
    s_add_u32 s62, s4, 33554432
    s_addc_u32 s63, s5, 0
    s_cmp_lg_u32 s30, 4
    s_cbranch_scc1 HB_1
    v_add_u32 v14, 162816, v3
    ds_write_b32 v14, v10
HB_1:
    s_mov_b64 s[88:89], s[70:71]
    s_mov_b32 s90, 2097152
    s_mov_b32 s91, 0x20000
    s_lshl3_add_u32 s36, s2, s30
    s_lshl_b32 s36, s36, 10
    s_mov_b64 s[80:81], s[68:69]
    s_mov_b32 s82, 2097152
    s_mov_b32 s83, 0x20000
    s_mov_b32 s50, s36
    v_lshrrev_b32 v14, 3, v1
    v_lshlrev_b32 v118, 11, v14
    v_and_b32 v14, 6, v14
    v_and_b32 v15, 7, v1
    v_xor_b32 v14, v14, v15
    v_lshl_add_u32 v118, v14, 4, v118
    v_mov_b32 v119, 0
    v_mov_b32 v120, 0
    v_mov_b32 v121, 0
    v_mov_b32 v122, 0
    v_mov_b32 v123, 0
    v_mov_b32 v124, 0
    v_mov_b32 v125, 0
    v_mov_b32 v126, 0
    v_mov_b32 v127, 0
    s_lshl_b32 s48, s29, 7
    s_lshl_b32 s36, s30, 14
    s_add_u32 s48, s48, s36
    s_lshl_b32 s49, s30, 10
    s_add_u32 s48, s48, 1048576
    s_and_b32 s41, s30, 3
    s_and_b32 s38, s2, 7
    s_lshl_b32 s38, s38, 5
    s_lshr_b32 s39, s2, 3
    s_add_u32 s38, s38, s39
    s_lshl_b32 s39, s38, 2
    s_add_u32 s39, s39, s41
    s_mul_i32 s40, s41, 21504
    s_lshl_b32 s36, s39, 12
    s_add_u32 s12, s14, s36
    s_addc_u32 s13, s15, 0
    s_mov_b32 s14, 4096
    s_mov_b32 s15, 0x20000
    s_lshr_b32 s45, s30, 2
    s_lshl_b32 s45, s45, 11
    s_add_u32 s36, s45, 0xffffffc0
    v_add_u32 v22, s36, v2
    v_add_u32 v23, 16, v22
    s_add_u32 s36, s45, 0x3c0
    v_add_u32 v24, s36, v2
    v_add_u32 v25, 16, v24
    s_mov_b32 s36, 4032
    v_add_u32 v26, s36, v2
    v_add_u32 v27, 16, v26
    v_add_u32 v19, s40, v2
    v_add_u32 v20, s45, v19
    s_lshl_b32 s36, s38, 14
    s_add_u32 s36, s36, 25165824
    s_add_u32 s20, s4, s36
    s_addc_u32 s21, s5, 0
    s_mov_b32 s22, 16384
    s_mov_b32 s23, 0x20000
    s_lshl_b32 s36, s30, 6
    v_lshrrev_b32 v94, 2, v1
    v_and_b32 v97, 48, v2
    v_lshl_add_u32 v97, v94, 8, v97
    v_add_u32 v97, s36, v97
    s_lshr_b32 s36, s39, 1
    s_lshl_b32 s36, s36, 2
    s_load_dword s41, s[76:77], s36
    v_and_b32 v100, 15, v1
    v_lshrrev_b32 v101, 4, v1
    v_and_b32 v94, 3, v100
    v_mul_u32_u24 v98, 4160, v94
    v_lshl_add_u32 v98, v101, 4, v98
    v_lshrrev_b32 v94, 2, v100
    v_lshl_add_u32 v98, v94, 3, v98
    v_add_u32 v98, s40, v98
    v_sub_u32 v94, 15, v100
    v_lshlrev_b32 v99, 5, v94
    v_add_u32 v99, s40, v99
    v_lshl_add_u32 v99, v101, 4, v99
    s_lshr_b32 s36, s38, 2
    s_lshl_b32 s36, s36, 12
    s_add_u32 s36, s36, 23330816
    v_lshlrev_b32 v102, 7, v1
    v_add_u32 v102, s36, v102
    v_and_b32 v81, 7, v0
    v_lshrrev_b32 v84, 6, v0
    v_lshlrev_b32 v84, 4, v84
    v_bfe_u32 v85, v0, 3, 3
    v_add_u32 v84, v84, v85
    s_lshr_b32 s78, s67, 1
    s_lshl_b32 s78, s78, 16
    s_and_b32 s79, s67, 1
    s_lshl_b32 s79, s79, 7
    s_add_u32 s78, s78, s79
    s_lshr_b32 s79, s30, 1
    s_lshl_b32 s79, s79, 13
    s_add_u32 s78, s78, s79
    v_lshlrev_b32 v78, 8, v84
    v_lshl_add_u32 v78, v81, 4, v78
    v_add_u32 v78, s78, v78
    s_lshl_b32 s78, s28, 7
    s_lshl_b32 s79, s67, 3
    s_add_u32 s78, s78, s79
    v_add_u32 v79, s78, v81
    v_lshlrev_b32 v80, 11, v79
    v_and_b32 v85, 3, v79
    v_lshrrev_b32 v82, 2, v79
    v_lshlrev_b32 v82, 14, v82
    v_lshl_add_u32 v82, v85, 11, v82
    v_lshl_add_u32 v82, v84, 4, v82
    v_lshrrev_b32 v85, 2, v84
    v_lshlrev_b32 v85, 3, v85
    v_and_b32 v84, 3, v84
    v_add_u32 v84, v84, v85
    v_lshl_add_u32 v80, v84, 3, v80
    v_lshlrev_b32 v79, 3, v79
    v_lshl_add_u32 v79, v84, 14, v79
    s_mov_b32 s8, s6
    s_mov_b32 s9, s7
    s_mov_b32 s10, 0x400000
    s_mov_b32 s11, 0x20000
    v_mov_b32 v60, 0
    v_mov_b32 v61, 0
    v_mov_b32 v62, 0
    v_mov_b32 v63, 0
    s_bfm_b64 exec, 40, 0
    ds_write_b128 v19, v[60:63] offset:20736
    s_mov_b64 exec, -1
    s_and_b32 s34, s2, 7
    s_lshr_b32 s35, s2, 3
    v_bfe_u32 v14, v1, 2, 3
    v_xor_b32 v14, s30, v14
    v_lshlrev_b32 v16, 5, v14
    v_and_b32 v14, 3, v1
    v_lshl_add_u32 v16, v14, 3, v16
    v_bfe_u32 v14, v1, 2, 2
    v_lshl_add_u32 v16, v14, 8, v16
    v_lshrrev_b32 v14, 4, v1
    v_lshl_add_u32 v16, v14, 12, v16
    v_add_u32 v16, 98304, v16
    v_xor_b32 v17, 128, v16
    s_add_u32 s16, s4, 0x1800000
    s_addc_u32 s17, s5, 0
    s_mov_b32 s18, 0x400000
    s_mov_b32 s19, 0x20000
    v_bfe_u32 v18, v1, 2, 2
    v_lshlrev_b32 v18, 14, v18
    v_and_b32 v14, 3, v1
    v_lshl_add_u32 v18, v14, 6, v18
    v_bfe_u32 v14, v1, 4, 1
    v_lshrrev_b32 v15, 5, v1
    v_lshl_add_u32 v14, v14, 1, v15
    v_xor_b32 v14, 3, v14
    v_lshl_add_u32 v18, v14, 4, v18
    s_lshl3_add_u32 s42, s34, s30
    s_lshl_b32 s43, s42, 16
    s_sub_u32 s37, 31, s35
    s_lshl_b32 s37, s37, 9
    s_add_u32 s43, s43, s37
    s_lshl_b32 s44, s42, 5
    s_add_u32 s44, s44, s35
    s_lshl_b32 s44, s44, 7
    s_add_u32 s44, s44, 23330816
    s_cmp_lt_u32 s30, 4
    s_cbranch_scc1 HB_4
    v_lshrrev_b32 v14, 4, v1
    v_lshlrev_b32 v119, 11, v14
    v_add_u32 v14, 0, v14
    v_lshlrev_b32 v14, 1, v14
    v_and_b32 v15, 15, v1
    v_xor_b32 v14, v14, v15
    v_lshl_add_u32 v119, v14, 4, v119
    v_lshrrev_b32 v14, 4, v1
    v_lshlrev_b32 v120, 11, v14
    v_add_u32 v14, 4, v14
    v_lshlrev_b32 v14, 1, v14
    v_and_b32 v15, 15, v1
    v_xor_b32 v14, v14, v15
    v_lshl_add_u32 v120, v14, 4, v120
    v_add_u32 v15, 0, v1
    v_mul_u32_u24 v14, 2341, v15
    v_lshrrev_b32 v14, 16, v14
    v_mul_u32_u24 v121, 28, v14
    v_sub_u32 v15, v15, v121
    v_mul_u32_u24 v121, 7168, v14
    v_lshrrev_b32 v14, 1, v14
    v_and_b32 v14, 2, v14
    v_lshrrev_b32 v200, 2, v15
    v_cmp_eq_u32 vcc, 3, v200
    s_nop 1
    v_cndmask_b32 v200, 0, 1, vcc
    v_lshrrev_b32 v14, v200, v14
    v_xor_b32 v15, v15, v14
    v_lshl_add_u32 v121, v15, 4, v121
    v_add_u32 v15, 64, v1
    v_mul_u32_u24 v14, 2341, v15
    v_lshrrev_b32 v14, 16, v14
    v_mul_u32_u24 v122, 28, v14
    v_sub_u32 v15, v15, v122
    v_mul_u32_u24 v122, 7168, v14
    v_lshrrev_b32 v14, 1, v14
    v_and_b32 v14, 2, v14
    v_lshrrev_b32 v200, 2, v15
    v_cmp_eq_u32 vcc, 3, v200
    s_nop 1
    v_cndmask_b32 v200, 0, 1, vcc
    v_lshrrev_b32 v14, v200, v14
    v_xor_b32 v15, v15, v14
    v_lshl_add_u32 v122, v15, 4, v122
    v_add_u32 v15, 128, v1
    v_mul_u32_u24 v14, 2341, v15
    v_lshrrev_b32 v14, 16, v14
    v_mul_u32_u24 v123, 28, v14
    v_sub_u32 v15, v15, v123
    v_mul_u32_u24 v123, 7168, v14
    v_lshrrev_b32 v14, 1, v14
    v_and_b32 v14, 2, v14
    v_lshrrev_b32 v200, 2, v15
    v_cmp_eq_u32 vcc, 3, v200
    s_nop 1
    v_cndmask_b32 v200, 0, 1, vcc
    v_lshrrev_b32 v14, v200, v14
    v_xor_b32 v15, v15, v14
    v_lshl_add_u32 v123, v15, 4, v123
    v_add_u32 v15, 192, v1
    v_mul_u32_u24 v14, 2341, v15
    v_lshrrev_b32 v14, 16, v14
    v_mul_u32_u24 v124, 28, v14
    v_sub_u32 v15, v15, v124
    v_mul_u32_u24 v124, 7168, v14
    v_lshrrev_b32 v14, 1, v14
    v_and_b32 v14, 2, v14
    v_lshrrev_b32 v200, 2, v15
    v_cmp_eq_u32 vcc, 3, v200
    s_nop 1
    v_cndmask_b32 v200, 0, 1, vcc
    v_lshrrev_b32 v14, v200, v14
    v_xor_b32 v15, v15, v14
    v_lshl_add_u32 v124, v15, 4, v124
    v_add_u32 v15, 256, v1
    v_mul_u32_u24 v14, 2341, v15
    v_lshrrev_b32 v14, 16, v14
    v_mul_u32_u24 v125, 28, v14
    v_sub_u32 v15, v15, v125
    v_mul_u32_u24 v125, 7168, v14
    v_lshrrev_b32 v14, 1, v14
    v_and_b32 v14, 2, v14
    v_lshrrev_b32 v200, 2, v15
    v_cmp_eq_u32 vcc, 3, v200
    s_nop 1
    v_cndmask_b32 v200, 0, 1, vcc
    v_lshrrev_b32 v14, v200, v14
    v_xor_b32 v15, v15, v14
    v_lshl_add_u32 v125, v15, 4, v125
    v_add_u32 v15, 320, v1
    v_mul_u32_u24 v14, 2341, v15
    v_lshrrev_b32 v14, 16, v14
    v_mul_u32_u24 v126, 28, v14
    v_sub_u32 v15, v15, v126
    v_mul_u32_u24 v126, 7168, v14
    v_lshrrev_b32 v14, 1, v14
    v_and_b32 v14, 2, v14
    v_lshrrev_b32 v200, 2, v15
    v_cmp_eq_u32 vcc, 3, v200
    s_nop 1
    v_cndmask_b32 v200, 0, 1, vcc
    v_lshrrev_b32 v14, v200, v14
    v_xor_b32 v15, v15, v14
    v_lshl_add_u32 v126, v15, 4, v126
    v_add_u32 v15, 384, v1
    v_mul_u32_u24 v14, 2341, v15
    v_lshrrev_b32 v14, 16, v14
    v_mul_u32_u24 v127, 28, v14
    v_sub_u32 v15, v15, v127
    v_mul_u32_u24 v127, 7168, v14
    v_lshrrev_b32 v14, 1, v14
    v_and_b32 v14, 2, v14
    v_lshrrev_b32 v200, 2, v15
    v_cmp_eq_u32 vcc, 3, v200
    s_nop 1
    v_cndmask_b32 v200, 0, 1, vcc
    v_lshrrev_b32 v14, v200, v14
    v_xor_b32 v15, v15, v14
    v_lshl_add_u32 v127, v15, 4, v127
HB_4:
    buffer_load_dwordx4 v[28:31], v22, s[12:15], 0 offen nt
    buffer_load_dwordx2 v[32:33], v23, s[12:15], 0 offen nt
    buffer_load_dwordx4 v[34:37], v24, s[12:15], 0 offen nt
    buffer_load_dwordx2 v[38:39], v25, s[12:15], 0 offen nt
    buffer_load_dwordx4 v[40:43], v26, s[12:15], 0 offen nt
    buffer_load_dwordx2 v[44:45], v27, s[12:15], 0 offen nt
    buffer_load_dwordx4 v[240:243], v2, s[88:91], s50 offen
    s_cmp_ge_u32 s30, 4
    s_cbranch_scc1 HB_3
    s_mul_i32 s36, s30, 21568
    v_lshrrev_b32 v94, 1, v100
    v_mul_u32_u24 v108, 72, v94
    v_and_b32 v94, 1, v100
    v_lshl_add_u32 v108, v94, 4, v108
    v_lshl_add_u32 v108, v101, 2, v108
    v_add_u32 v108, s36, v108
    v_add_u32 v109, 1152, v108
    v_add_u32 v110, 2304, v108
    v_add_u32 v111, 3456, v108
    v_bfe_u32 v94, v1, 2, 2
    v_mul_u32_u24 v103, 21568, v94
    v_mul_u32_u24 v94, 72, v101
    v_add_u32 v103, v103, v94
    v_and_b32 v94, 3, v1
    v_lshl_add_u32 v103, v94, 3, v103
    s_mul_i32 s36, s30, 1152
    v_add_u32 v103, s36, v103
    s_waitcnt lgkmcnt(0)
    s_bitcmp1_b32 s39, 0
    s_cselect_b32 s36, 0, 16
    s_lshl_b32 s41, s41, s36
    s_and_b32 s41, s41, 0xffff0000
    s_lshr_b32 s36, s41, 16
    v_lshl_add_u32 v94, v101, 3, v100
    v_sub_u32 v94, 15, v94
    v_and_b32 v95, 1, v94
    v_cmp_eq_u32 vcc, 1, v95
    v_mov_b32 v95, s36
    v_mov_b32 v96, s41
    v_cndmask_b32 v95, v95, v96, vcc
    v_ashrrev_i32 v94, 1, v94
    v_cmp_eq_u32 vcc, 0, v94
    s_nop 1
    v_cndmask_b32 v104, 0, v95, vcc
    v_cmp_eq_u32 vcc, 1, v94
    s_nop 1
    v_cndmask_b32 v105, 0, v95, vcc
    v_cmp_eq_u32 vcc, 2, v94
    s_nop 1
    v_cndmask_b32 v106, 0, v95, vcc
    v_cmp_eq_u32 vcc, 3, v94
    s_nop 1
    v_cndmask_b32 v107, 0, v95, vcc
HB_3:
    s_waitcnt vmcnt(7) lgkmcnt(0)
    s_barrier
    ds_read_b64_tr_b16 v[128:129], v16 offset:0
    ds_read_b64_tr_b16 v[130:131], v16 offset:1024
    ds_read_b64_tr_b16 v[132:133], v16 offset:2048
    ds_read_b64_tr_b16 v[134:135], v16 offset:3072
    ds_read_b64_tr_b16 v[136:137], v17 offset:4096
    ds_read_b64_tr_b16 v[138:139], v16 offset:17408
    ds_read_b64_tr_b16 v[140:141], v16 offset:18432
    ds_read_b64_tr_b16 v[142:143], v16 offset:19456
    ds_read_b64_tr_b16 v[144:145], v16 offset:20480
    s_load_dword s52, s[84:85], 0
    v_lshlrev_b32 v46, 16, v12
    v_and_b32 v47, 0xffff0000, v12
    v_lshlrev_b32 v48, 16, v13
    v_and_b32 v49, 0xffff0000, v13
    s_waitcnt lgkmcnt(0)
    v_lshlrev_b32 v146, 16, v128
    v_and_b32 v147, 0xffff0000, v128
    v_lshlrev_b32 v148, 16, v129
    v_and_b32 v149, 0xffff0000, v129
    v_lshlrev_b32 v150, 16, v130
    v_and_b32 v151, 0xffff0000, v130
    v_lshlrev_b32 v152, 16, v131
    v_and_b32 v153, 0xffff0000, v131
    v_lshlrev_b32 v154, 16, v132
    v_and_b32 v155, 0xffff0000, v132
    v_lshlrev_b32 v156, 16, v133
    v_and_b32 v157, 0xffff0000, v133
    v_lshlrev_b32 v158, 16, v134
    v_and_b32 v159, 0xffff0000, v134
    v_lshlrev_b32 v160, 16, v135
    v_and_b32 v161, 0xffff0000, v135
    v_lshlrev_b32 v162, 16, v136
    v_and_b32 v163, 0xffff0000, v136
    v_lshlrev_b32 v164, 16, v137
    v_and_b32 v165, 0xffff0000, v137
    v_mul_f32 v166, v147, v49
    v_mul_f32 v167, v148, v49
    v_mul_f32 v168, v149, v49
    v_mul_f32 v169, v150, v49
    v_mul_f32 v170, v151, v49
    v_mul_f32 v171, v152, v49
    v_mul_f32 v172, v153, v49
    v_mul_f32 v173, v154, v49
    v_mul_f32 v174, v155, v49
    v_mul_f32 v175, v156, v49
    v_mul_f32 v176, v157, v49
    v_mul_f32 v177, v158, v49
    v_mul_f32 v178, v159, v49
    v_mul_f32 v179, v160, v49
    v_mul_f32 v180, v161, v49
    v_mul_f32 v181, v162, v49
    v_fmac_f32 v166, v148, v48
    v_fmac_f32 v167, v149, v48
    v_fmac_f32 v168, v150, v48
    v_fmac_f32 v169, v151, v48
    v_fmac_f32 v170, v152, v48
    v_fmac_f32 v171, v153, v48
    v_fmac_f32 v172, v154, v48
    v_fmac_f32 v173, v155, v48
    v_fmac_f32 v174, v156, v48
    v_fmac_f32 v175, v157, v48
    v_fmac_f32 v176, v158, v48
    v_fmac_f32 v177, v159, v48
    v_fmac_f32 v178, v160, v48
    v_fmac_f32 v179, v161, v48
    v_fmac_f32 v180, v162, v48
    v_fmac_f32 v181, v163, v48
    v_fmac_f32 v166, v149, v47
    v_fmac_f32 v167, v150, v47
    v_fmac_f32 v168, v151, v47
    v_fmac_f32 v169, v152, v47
    v_fmac_f32 v170, v153, v47
    v_fmac_f32 v171, v154, v47
    v_fmac_f32 v172, v155, v47
    v_fmac_f32 v173, v156, v47
    v_fmac_f32 v174, v157, v47
    v_fmac_f32 v175, v158, v47
    v_fmac_f32 v176, v159, v47
    v_fmac_f32 v177, v160, v47
    v_fmac_f32 v178, v161, v47
    v_fmac_f32 v179, v162, v47
    v_fmac_f32 v180, v163, v47
    v_fmac_f32 v181, v164, v47
    v_fmac_f32 v166, v150, v46
    v_fmac_f32 v167, v151, v46
    v_fmac_f32 v168, v152, v46
    v_fmac_f32 v169, v153, v46
    v_fmac_f32 v170, v154, v46
    v_fmac_f32 v171, v155, v46
    v_fmac_f32 v172, v156, v46
    v_fmac_f32 v173, v157, v46
    v_fmac_f32 v174, v158, v46
    v_fmac_f32 v175, v159, v46
    v_fmac_f32 v176, v160, v46
    v_fmac_f32 v177, v161, v46
    v_fmac_f32 v178, v162, v46
    v_fmac_f32 v179, v163, v46
    v_fmac_f32 v180, v164, v46
    v_fmac_f32 v181, v165, v46
    v_lshlrev_b32 v146, 16, v138
    v_and_b32 v147, 0xffff0000, v138
    v_lshlrev_b32 v148, 16, v139
    v_and_b32 v149, 0xffff0000, v139
    v_lshlrev_b32 v150, 16, v140
    v_and_b32 v151, 0xffff0000, v140
    v_lshlrev_b32 v152, 16, v141
    v_and_b32 v153, 0xffff0000, v141
    v_lshlrev_b32 v154, 16, v142
    v_and_b32 v155, 0xffff0000, v142
    v_lshlrev_b32 v156, 16, v143
    v_and_b32 v157, 0xffff0000, v143
    v_lshlrev_b32 v158, 16, v144
    v_and_b32 v159, 0xffff0000, v144
    v_lshlrev_b32 v160, 16, v145
    v_and_b32 v161, 0xffff0000, v145
    v_mul_f32 v166, v166, v146
    v_mul_f32 v167, v167, v147
    v_mul_f32 v168, v168, v148
    v_mul_f32 v169, v169, v149
    v_mul_f32 v170, v170, v150
    v_mul_f32 v171, v171, v151
    v_mul_f32 v172, v172, v152
    v_mul_f32 v173, v173, v153
    v_mul_f32 v174, v174, v154
    v_mul_f32 v175, v175, v155
    v_mul_f32 v176, v176, v156
    v_mul_f32 v177, v177, v157
    v_mul_f32 v178, v178, v158
    v_mul_f32 v179, v179, v159
    v_mul_f32 v180, v180, v160
    v_mul_f32 v181, v181, v161
    v_add_u32 v167, 0x10000, v167
    v_and_b32 v167, 0xfffe0000, v167
    v_add_u32 v169, 0x10000, v169
    v_and_b32 v169, 0xfffe0000, v169
    v_add_u32 v171, 0x10000, v171
    v_and_b32 v171, 0xfffe0000, v171
    v_add_u32 v173, 0x10000, v173
    v_and_b32 v173, 0xfffe0000, v173
    v_add_u32 v175, 0x10000, v175
    v_and_b32 v175, 0xfffe0000, v175
    v_add_u32 v177, 0x10000, v177
    v_and_b32 v177, 0xfffe0000, v177
    v_add_u32 v179, 0x10000, v179
    v_and_b32 v179, 0xfffe0000, v179
    v_add_u32 v181, 0x10000, v181
    v_and_b32 v181, 0xfffe0000, v181
    v_cvt_pk_bf16_f32 v52, v173, v172
    v_cvt_pk_bf16_f32 v53, v171, v170
    v_cvt_pk_bf16_f32 v54, v169, v168
    v_cvt_pk_bf16_f32 v55, v167, v166
    v_cvt_pk_bf16_f32 v56, v181, v180
    v_cvt_pk_bf16_f32 v57, v179, v178
    v_cvt_pk_bf16_f32 v58, v177, v176
    v_cvt_pk_bf16_f32 v59, v175, v174
    s_cmp_lg_u32 s52, 0
    s_cbranch_scc1 HB_q
    s_mov_b32 s53, 0
HB_p:
    buffer_load_dword v14, v10, s[84:87], 0 offen sc1
    s_waitcnt vmcnt(0)
    v_readfirstlane_b32 s52, v14
    s_nop 0
    s_cmp_lg_u32 s52, 0
    s_cbranch_scc1 HB_q
    s_add_u32 s53, s53, 1
    s_cmp_lt_u32 s53, s61
    s_cbranch_scc1 HB_p
    s_mov_b32 s52, 1
    s_mov_b32 s61, 0
HB_q:
    v_permlane32_swap_b32 v52, v56
    v_permlane32_swap_b32 v53, v57
    v_permlane32_swap_b32 v54, v58
    v_permlane32_swap_b32 v55, v59
    v_mov_b32 v14, s52
    buffer_store_dwordx4 v[52:55], v18, s[16:19], s43 offen offset:256 sc1
    buffer_store_dwordx4 v[56:59], v18, s[16:19], s43 offen offset:0 sc1
    s_waitcnt vmcnt(3)
    v_alignbit_b32 v128, v29, v28, 16
    v_mov_b32 v132, v29
    v_alignbit_b32 v136, v30, v29, 16
    v_alignbit_b32 v129, v30, v29, 16
    v_mov_b32 v133, v30
    v_alignbit_b32 v137, v31, v30, 16
    v_alignbit_b32 v130, v31, v30, 16
    v_mov_b32 v134, v31
    v_alignbit_b32 v138, v32, v31, 16
    v_alignbit_b32 v131, v32, v31, 16
    v_mov_b32 v135, v32
    v_alignbit_b32 v139, v33, v32, 16
    ds_write_b128 v20, v[128:131] offset:0
    ds_write_b128 v20, v[132:135] offset:4160
    ds_write_b128 v20, v[136:139] offset:8320
    ds_write_b128 v20, v[30:33] offset:12480
    v_alignbit_b32 v140, v35, v34, 16
    v_mov_b32 v144, v35
    v_alignbit_b32 v148, v36, v35, 16
    v_alignbit_b32 v141, v36, v35, 16
    v_mov_b32 v145, v36
    v_alignbit_b32 v149, v37, v36, 16
    v_alignbit_b32 v142, v37, v36, 16
    v_mov_b32 v146, v37
    v_alignbit_b32 v150, v38, v37, 16
    v_alignbit_b32 v143, v38, v37, 16
    v_mov_b32 v147, v38
    v_alignbit_b32 v151, v39, v38, 16
    ds_write_b128 v20, v[140:143] offset:1024
    ds_write_b128 v20, v[144:147] offset:5184
    ds_write_b128 v20, v[148:151] offset:9344
    ds_write_b128 v20, v[36:39] offset:13504
    s_waitcnt vmcnt(0)
    s_mov_b64 exec, 1
    buffer_store_dword v14, v10, s[56:59], s44 offen sc1
    s_mov_b64 exec, -1
    s_cmp_lg_u32 s30, 5
    s_cbranch_scc1 KV_n3
    s_lshl_b32 s36, s2, 14
    s_add_u32 s36, s36, 29360128
    v_lshrrev_b32 v15, 3, v1
    v_mul_u32_u24 v15, 8064, v15
    v_add_u32 v15, v15, v2
    s_mov_b64 exec, 0xffff
    buffer_store_dwordx4 v[60:63], v15, s[56:59], s36 offen sc1
    s_mov_b64 exec, -1
KV_n3:
    v_alignbit_b32 v152, v41, v40, 16
    v_mov_b32 v156, v41
    v_alignbit_b32 v160, v42, v41, 16
    v_alignbit_b32 v153, v42, v41, 16
    v_mov_b32 v157, v42
    v_alignbit_b32 v161, v43, v42, 16
    v_alignbit_b32 v154, v43, v42, 16
    v_mov_b32 v158, v43
    v_alignbit_b32 v162, v44, v43, 16
    v_alignbit_b32 v155, v44, v43, 16
    v_mov_b32 v159, v44
    v_alignbit_b32 v163, v45, v44, 16
    s_mov_b64 exec, 0xf
    ds_write_b128 v19, v[152:155] offset:4096
    ds_write_b128 v19, v[156:159] offset:8256
    ds_write_b128 v19, v[160:163] offset:12416
    ds_write_b128 v19, v[42:45] offset:16576
    s_mov_b64 exec, -1
    s_waitcnt lgkmcnt(0)
    s_barrier
    s_add_u32 s36, s48, 0
    s_add_u32 m0, s49, 90112
    s_nop 0
    buffer_load_dwordx4 v118, s[88:91], s36 offen lds
    s_add_u32 s36, s48, 131072
    s_add_u32 m0, s49, 98304
    s_nop 0
    buffer_load_dwordx4 v118, s[88:91], s36 offen lds
    s_add_u32 s36, s48, 262144
    s_add_u32 m0, s49, 106496
    s_nop 0
    buffer_load_dwordx4 v118, s[88:91], s36 offen lds
    s_add_u32 s36, s48, 393216
    s_add_u32 m0, s49, 114688
    s_nop 0
    buffer_load_dwordx4 v118, s[88:91], s36 offen lds
    s_add_u32 s36, s48, 524288
    s_add_u32 m0, s49, 122880
    s_nop 0
    buffer_load_dwordx4 v118, s[88:91], s36 offen lds
    s_add_u32 s36, s48, 655360
    s_add_u32 m0, s49, 131072
    s_nop 0
    buffer_load_dwordx4 v118, s[88:91], s36 offen lds
    s_add_u32 s36, s48, 786432
    s_add_u32 m0, s49, 139264
    s_nop 0
    buffer_load_dwordx4 v118, s[88:91], s36 offen lds
    s_add_u32 s36, s48, 917504
    s_add_u32 m0, s49, 147456
    s_nop 0
    buffer_load_dwordx4 v118, s[88:91], s36 offen lds
    s_cmp_ge_u32 s30, 4
    s_cbranch_scc1 FR_b
    s_lshl_b32 s44, s30, 12
    s_mov_b32 s45, 0x07060302
    s_cmp_lg_u32 s30, 0
    s_cbranch_scc1 CV_w
    s_mov_b32 s53, 0
    s_add_u32 s54, s52, 0
    s_bfm_b64 exec, 32, 0
poll_1:
    buffer_load_dword v8, v102, s[56:59], 0 offen sc1
    s_waitcnt vmcnt(0)
    v_cmp_eq_u32 vcc, s54, v8
    s_nop 0
    s_cmp_eq_u64 vcc, exec
    s_cbranch_scc1 pok_2
    s_sleep 5
    s_add_u32 s53, s53, 1
    s_cmp_lt_u32 s53, s61
    s_cbranch_scc1 poll_1
    s_mov_b32 s61, 0
pok_2:
    s_mov_b64 exec, -1
CV_w:
    s_add_u32 m0, s40, 16640
    s_mov_b32 s36, 0
    s_waitcnt vmcnt(0)
    s_barrier
    buffer_load_dwordx4 v97, s[20:23], s36 offen offset:0 sc1 lds
    s_add_u32 s36, s36, 3072
    buffer_load_dwordx4 v97, s[20:23], s36 offen offset:1024 sc1 lds
    s_add_u32 s36, s36, 3072
    buffer_load_dwordx4 v97, s[20:23], s36 offen offset:2048 sc1 lds
    s_add_u32 s36, s36, 3072
    buffer_load_dwordx4 v97, s[20:23], s36 offen offset:3072 sc1 lds
    s_barrier
    buffer_load_dwordx2 v[86:87], v80, s[8:11], 0 offen offset:0 nt
    buffer_load_dwordx2 v[88:89], v80, s[8:11], 0 offen offset:32 nt
    buffer_load_dwordx2 v[90:91], v80, s[8:11], 0 offen offset:128 nt
    buffer_load_dwordx2 v[92:93], v80, s[8:11], 0 offen offset:160 nt
    ds_read_b64 v[120:121], v98 offset:32
    ds_read_b64 v[122:123], v98 offset:40
    ds_read_b64 v[124:125], v98 offset:544
    ds_read_b64 v[126:127], v98 offset:552
    ds_read_b64 v[128:129], v98 offset:1056
    ds_read_b64 v[130:131], v98 offset:1064
    ds_read_b64 v[132:133], v98 offset:1568
    ds_read_b64 v[134:135], v98 offset:1576
    ds_read_b64 v[136:137], v98 offset:2080
    ds_read_b64 v[138:139], v98 offset:2088
    ds_read_b64 v[140:141], v98 offset:2592
    ds_read_b64 v[142:143], v98 offset:2600
    ds_read_b64 v[144:145], v98 offset:3104
    ds_read_b64 v[146:147], v98 offset:3112
    ds_read_b64 v[148:149], v98 offset:3616
    ds_read_b64 v[150:151], v98 offset:3624
    s_waitcnt vmcnt(4)
    ds_read_b128 v[184:187], v99 offset:20224
    ds_read_b128 v[188:191], v99 offset:19712
    ds_read_b128 v[192:195], v99 offset:19200
    ds_read_b128 v[196:199], v99 offset:18688
    ds_read_b128 v[200:203], v99 offset:18176
    ds_read_b128 v[204:207], v99 offset:17664
    ds_read_b128 v[208:211], v99 offset:17152
    ds_read_b128 v[212:215], v99 offset:16640
    s_waitcnt lgkmcnt(0)
    v_mfma_f32_16x16x32_bf16 v[12:15], v[104:107], v[184:187], 0
    v_mfma_f32_16x16x32_bf16 v[16:19], v[104:107], v[188:191], 0
    v_mfma_f32_16x16x32_bf16 v[20:23], v[104:107], v[192:195], 0
    v_mfma_f32_16x16x32_bf16 v[24:27], v[104:107], v[196:199], 0
    v_mfma_f32_16x16x32_bf16 v[28:31], v[104:107], v[200:203], 0
    v_mfma_f32_16x16x32_bf16 v[32:35], v[104:107], v[204:207], 0
    v_mfma_f32_16x16x32_bf16 v[36:39], v[104:107], v[208:211], 0
    v_mfma_f32_16x16x32_bf16 v[40:43], v[104:107], v[212:215], 0
    s_mov_b32 s43, 0
CV_r:
    s_waitcnt lgkmcnt(0)
    v_mfma_f32_16x16x32_bf16 v[12:15], v[120:123], v[184:187], v[12:15]
    ds_read_b128 v[216:219], v99 offset:20288
    v_mfma_f32_16x16x32_bf16 v[16:19], v[120:123], v[188:191], v[16:19]
    ds_read_b128 v[220:223], v99 offset:19776
    v_mfma_f32_16x16x32_bf16 v[20:23], v[120:123], v[192:195], v[20:23]
    ds_read_b128 v[224:227], v99 offset:19264
    v_mfma_f32_16x16x32_bf16 v[24:27], v[120:123], v[196:199], v[24:27]
    ds_read_b128 v[228:231], v99 offset:18752
    v_mfma_f32_16x16x32_bf16 v[28:31], v[120:123], v[200:203], v[28:31]
    ds_read_b128 v[232:235], v99 offset:18240
    v_mfma_f32_16x16x32_bf16 v[32:35], v[120:123], v[204:207], v[32:35]
    ds_read_b128 v[236:239], v99 offset:17728
    v_mfma_f32_16x16x32_bf16 v[36:39], v[120:123], v[208:211], v[36:39]
    ds_read_b128 v[240:243], v99 offset:17216
    v_mfma_f32_16x16x32_bf16 v[40:43], v[120:123], v[212:215], v[40:43]
    ds_read_b128 v[244:247], v99 offset:16704
    v_mfma_f32_16x16x32_bf16 v[16:19], v[124:127], v[184:187], v[16:19]
    ds_read_b64 v[152:153], v98 offset:96
    v_mfma_f32_16x16x32_bf16 v[20:23], v[124:127], v[188:191], v[20:23]
    ds_read_b64 v[154:155], v98 offset:104
    v_mfma_f32_16x16x32_bf16 v[24:27], v[124:127], v[192:195], v[24:27]
    ds_read_b64 v[156:157], v98 offset:608
    v_mfma_f32_16x16x32_bf16 v[28:31], v[124:127], v[196:199], v[28:31]
    ds_read_b64 v[158:159], v98 offset:616
    v_mfma_f32_16x16x32_bf16 v[32:35], v[124:127], v[200:203], v[32:35]
    ds_read_b64 v[160:161], v98 offset:1120
    v_mfma_f32_16x16x32_bf16 v[36:39], v[124:127], v[204:207], v[36:39]
    ds_read_b64 v[162:163], v98 offset:1128
    v_mfma_f32_16x16x32_bf16 v[40:43], v[124:127], v[208:211], v[40:43]
    v_mfma_f32_16x16x32_bf16 v[20:23], v[128:131], v[184:187], v[20:23]
    v_mfma_f32_16x16x32_bf16 v[24:27], v[128:131], v[188:191], v[24:27]
    v_mfma_f32_16x16x32_bf16 v[28:31], v[128:131], v[192:195], v[28:31]
    v_mfma_f32_16x16x32_bf16 v[32:35], v[128:131], v[196:199], v[32:35]
    v_mfma_f32_16x16x32_bf16 v[36:39], v[128:131], v[200:203], v[36:39]
    v_mfma_f32_16x16x32_bf16 v[40:43], v[128:131], v[204:207], v[40:43]
    v_mfma_f32_16x16x32_bf16 v[24:27], v[132:135], v[184:187], v[24:27]
    v_mfma_f32_16x16x32_bf16 v[28:31], v[132:135], v[188:191], v[28:31]
    v_mfma_f32_16x16x32_bf16 v[32:35], v[132:135], v[192:195], v[32:35]
    v_mfma_f32_16x16x32_bf16 v[36:39], v[132:135], v[196:199], v[36:39]
    v_mfma_f32_16x16x32_bf16 v[40:43], v[132:135], v[200:203], v[40:43]
    v_mfma_f32_16x16x32_bf16 v[28:31], v[136:139], v[184:187], v[28:31]
    v_mfma_f32_16x16x32_bf16 v[32:35], v[136:139], v[188:191], v[32:35]
    v_mfma_f32_16x16x32_bf16 v[36:39], v[136:139], v[192:195], v[36:39]
    v_mfma_f32_16x16x32_bf16 v[40:43], v[136:139], v[196:199], v[40:43]
    v_mfma_f32_16x16x32_bf16 v[32:35], v[140:143], v[184:187], v[32:35]
    v_mfma_f32_16x16x32_bf16 v[36:39], v[140:143], v[188:191], v[36:39]
    v_mfma_f32_16x16x32_bf16 v[40:43], v[140:143], v[192:195], v[40:43]
    v_mfma_f32_16x16x32_bf16 v[36:39], v[144:147], v[184:187], v[36:39]
    v_mfma_f32_16x16x32_bf16 v[40:43], v[144:147], v[188:191], v[40:43]
    v_mfma_f32_16x16x32_bf16 v[40:43], v[148:151], v[184:187], v[40:43]
    ds_read_b64 v[164:165], v98 offset:1632
    ds_read_b64 v[166:167], v98 offset:1640
    ds_read_b64 v[168:169], v98 offset:2144
    ds_read_b64 v[170:171], v98 offset:2152
    ds_read_b64 v[172:173], v98 offset:2656
    ds_read_b64 v[174:175], v98 offset:2664
    ds_read_b64 v[176:177], v98 offset:3168
    ds_read_b64 v[178:179], v98 offset:3176
    ds_read_b64 v[180:181], v98 offset:3680
    ds_read_b64 v[182:183], v98 offset:3688
    s_waitcnt lgkmcnt(0)
    v_mfma_f32_16x16x32_bf16 v[12:15], v[152:155], v[216:219], v[12:15]
    ds_read_b128 v[184:187], v99 offset:20352
    v_mfma_f32_16x16x32_bf16 v[16:19], v[152:155], v[220:223], v[16:19]
    ds_read_b128 v[188:191], v99 offset:19840
    v_mfma_f32_16x16x32_bf16 v[20:23], v[152:155], v[224:227], v[20:23]
    ds_read_b128 v[192:195], v99 offset:19328
    v_mfma_f32_16x16x32_bf16 v[24:27], v[152:155], v[228:231], v[24:27]
    ds_read_b128 v[196:199], v99 offset:18816
    v_mfma_f32_16x16x32_bf16 v[28:31], v[152:155], v[232:235], v[28:31]
    ds_read_b128 v[200:203], v99 offset:18304
    v_mfma_f32_16x16x32_bf16 v[32:35], v[152:155], v[236:239], v[32:35]
    ds_read_b128 v[204:207], v99 offset:17792
    v_mfma_f32_16x16x32_bf16 v[36:39], v[152:155], v[240:243], v[36:39]
    ds_read_b128 v[208:211], v99 offset:17280
    v_mfma_f32_16x16x32_bf16 v[40:43], v[152:155], v[244:247], v[40:43]
    ds_read_b128 v[212:215], v99 offset:16768
    v_mfma_f32_16x16x32_bf16 v[16:19], v[156:159], v[216:219], v[16:19]
    ds_read_b64 v[120:121], v98 offset:160
    v_mfma_f32_16x16x32_bf16 v[20:23], v[156:159], v[220:223], v[20:23]
    ds_read_b64 v[122:123], v98 offset:168
    v_mfma_f32_16x16x32_bf16 v[24:27], v[156:159], v[224:227], v[24:27]
    ds_read_b64 v[124:125], v98 offset:672
    v_mfma_f32_16x16x32_bf16 v[28:31], v[156:159], v[228:231], v[28:31]
    ds_read_b64 v[126:127], v98 offset:680
    v_mfma_f32_16x16x32_bf16 v[32:35], v[156:159], v[232:235], v[32:35]
    ds_read_b64 v[128:129], v98 offset:1184
    v_mfma_f32_16x16x32_bf16 v[36:39], v[156:159], v[236:239], v[36:39]
    ds_read_b64 v[130:131], v98 offset:1192
    v_mfma_f32_16x16x32_bf16 v[40:43], v[156:159], v[240:243], v[40:43]
    v_mfma_f32_16x16x32_bf16 v[20:23], v[160:163], v[216:219], v[20:23]
    v_mfma_f32_16x16x32_bf16 v[24:27], v[160:163], v[220:223], v[24:27]
    v_mfma_f32_16x16x32_bf16 v[28:31], v[160:163], v[224:227], v[28:31]
    v_mfma_f32_16x16x32_bf16 v[32:35], v[160:163], v[228:231], v[32:35]
    v_mfma_f32_16x16x32_bf16 v[36:39], v[160:163], v[232:235], v[36:39]
    v_mfma_f32_16x16x32_bf16 v[40:43], v[160:163], v[236:239], v[40:43]
    v_mfma_f32_16x16x32_bf16 v[24:27], v[164:167], v[216:219], v[24:27]
    v_mfma_f32_16x16x32_bf16 v[28:31], v[164:167], v[220:223], v[28:31]
    v_mfma_f32_16x16x32_bf16 v[32:35], v[164:167], v[224:227], v[32:35]
    v_mfma_f32_16x16x32_bf16 v[36:39], v[164:167], v[228:231], v[36:39]
    v_mfma_f32_16x16x32_bf16 v[40:43], v[164:167], v[232:235], v[40:43]
    v_mfma_f32_16x16x32_bf16 v[28:31], v[168:171], v[216:219], v[28:31]
    v_mfma_f32_16x16x32_bf16 v[32:35], v[168:171], v[220:223], v[32:35]
    v_mfma_f32_16x16x32_bf16 v[36:39], v[168:171], v[224:227], v[36:39]
    v_mfma_f32_16x16x32_bf16 v[40:43], v[168:171], v[228:231], v[40:43]
    v_mfma_f32_16x16x32_bf16 v[32:35], v[172:175], v[216:219], v[32:35]
    v_mfma_f32_16x16x32_bf16 v[36:39], v[172:175], v[220:223], v[36:39]
    v_mfma_f32_16x16x32_bf16 v[40:43], v[172:175], v[224:227], v[40:43]
    v_mfma_f32_16x16x32_bf16 v[36:39], v[176:179], v[216:219], v[36:39]
    v_mfma_f32_16x16x32_bf16 v[40:43], v[176:179], v[220:223], v[40:43]
    v_mfma_f32_16x16x32_bf16 v[40:43], v[180:183], v[216:219], v[40:43]
    ds_read_b64 v[132:133], v98 offset:1696
    ds_read_b64 v[134:135], v98 offset:1704
    ds_read_b64 v[136:137], v98 offset:2208
    ds_read_b64 v[138:139], v98 offset:2216
    ds_read_b64 v[140:141], v98 offset:2720
    ds_read_b64 v[142:143], v98 offset:2728
    ds_read_b64 v[144:145], v98 offset:3232
    ds_read_b64 v[146:147], v98 offset:3240
    ds_read_b64 v[148:149], v98 offset:3744
    ds_read_b64 v[150:151], v98 offset:3752
    v_add_u32 v98, 128, v98
    v_add_u32 v99, 128, v99
    s_add_u32 s43, s43, 1
    s_cmp_lt_u32 s43, 3
    s_cbranch_scc1 CV_r
CV_l:
    s_waitcnt lgkmcnt(0)
    v_mfma_f32_16x16x32_bf16 v[12:15], v[120:123], v[184:187], v[12:15]
    ds_read_b128 v[216:219], v99 offset:20288
    v_mfma_f32_16x16x32_bf16 v[16:19], v[120:123], v[188:191], v[16:19]
    ds_read_b128 v[220:223], v99 offset:19776
    v_mfma_f32_16x16x32_bf16 v[20:23], v[120:123], v[192:195], v[20:23]
    ds_read_b128 v[224:227], v99 offset:19264
    v_mfma_f32_16x16x32_bf16 v[24:27], v[120:123], v[196:199], v[24:27]
    ds_read_b128 v[228:231], v99 offset:18752
    v_mfma_f32_16x16x32_bf16 v[28:31], v[120:123], v[200:203], v[28:31]
    ds_read_b128 v[232:235], v99 offset:18240
    v_mfma_f32_16x16x32_bf16 v[32:35], v[120:123], v[204:207], v[32:35]
    ds_read_b128 v[236:239], v99 offset:17728
    v_mfma_f32_16x16x32_bf16 v[36:39], v[120:123], v[208:211], v[36:39]
    ds_read_b128 v[240:243], v99 offset:17216
    v_mfma_f32_16x16x32_bf16 v[40:43], v[120:123], v[212:215], v[40:43]
    ds_read_b128 v[244:247], v99 offset:16704
    v_mfma_f32_16x16x32_bf16 v[16:19], v[124:127], v[184:187], v[16:19]
    ds_read_b64 v[152:153], v98 offset:96
    v_mfma_f32_16x16x32_bf16 v[20:23], v[124:127], v[188:191], v[20:23]
    ds_read_b64 v[154:155], v98 offset:104
    v_mfma_f32_16x16x32_bf16 v[24:27], v[124:127], v[192:195], v[24:27]
    ds_read_b64 v[156:157], v98 offset:608
    v_mfma_f32_16x16x32_bf16 v[28:31], v[124:127], v[196:199], v[28:31]
    ds_read_b64 v[158:159], v98 offset:616
    v_mfma_f32_16x16x32_bf16 v[32:35], v[124:127], v[200:203], v[32:35]
    ds_read_b64 v[160:161], v98 offset:1120
    v_mfma_f32_16x16x32_bf16 v[36:39], v[124:127], v[204:207], v[36:39]
    ds_read_b64 v[162:163], v98 offset:1128
    v_mfma_f32_16x16x32_bf16 v[40:43], v[124:127], v[208:211], v[40:43]
    ds_read_b64 v[164:165], v98 offset:1632
    v_mfma_f32_16x16x32_bf16 v[20:23], v[128:131], v[184:187], v[20:23]
    ds_read_b64 v[166:167], v98 offset:1640
    v_mfma_f32_16x16x32_bf16 v[24:27], v[128:131], v[188:191], v[24:27]
    ds_read_b64 v[168:169], v98 offset:2144
    v_mfma_f32_16x16x32_bf16 v[28:31], v[128:131], v[192:195], v[28:31]
    ds_read_b64 v[170:171], v98 offset:2152
    v_mfma_f32_16x16x32_bf16 v[32:35], v[128:131], v[196:199], v[32:35]
    ds_read_b64 v[172:173], v98 offset:2656
    v_mfma_f32_16x16x32_bf16 v[36:39], v[128:131], v[200:203], v[36:39]
    ds_read_b64 v[174:175], v98 offset:2664
    v_mfma_f32_16x16x32_bf16 v[40:43], v[128:131], v[204:207], v[40:43]
    ds_read_b64 v[176:177], v98 offset:3168
    v_mfma_f32_16x16x32_bf16 v[24:27], v[132:135], v[184:187], v[24:27]
    ds_read_b64 v[178:179], v98 offset:3176
    v_mfma_f32_16x16x32_bf16 v[28:31], v[132:135], v[188:191], v[28:31]
    ds_read_b64 v[180:181], v98 offset:3680
    v_mfma_f32_16x16x32_bf16 v[32:35], v[132:135], v[192:195], v[32:35]
    ds_read_b64 v[182:183], v98 offset:3688
    v_mfma_f32_16x16x32_bf16 v[36:39], v[132:135], v[196:199], v[36:39]
    v_mfma_f32_16x16x32_bf16 v[40:43], v[132:135], v[200:203], v[40:43]
    v_mfma_f32_16x16x32_bf16 v[28:31], v[136:139], v[184:187], v[28:31]
    v_mfma_f32_16x16x32_bf16 v[32:35], v[136:139], v[188:191], v[32:35]
    v_mfma_f32_16x16x32_bf16 v[36:39], v[136:139], v[192:195], v[36:39]
    v_mfma_f32_16x16x32_bf16 v[40:43], v[136:139], v[196:199], v[40:43]
    v_mfma_f32_16x16x32_bf16 v[32:35], v[140:143], v[184:187], v[32:35]
    v_mfma_f32_16x16x32_bf16 v[36:39], v[140:143], v[188:191], v[36:39]
    v_mfma_f32_16x16x32_bf16 v[40:43], v[140:143], v[192:195], v[40:43]
    v_mfma_f32_16x16x32_bf16 v[36:39], v[144:147], v[184:187], v[36:39]
    v_mfma_f32_16x16x32_bf16 v[40:43], v[144:147], v[188:191], v[40:43]
    v_mfma_f32_16x16x32_bf16 v[40:43], v[148:151], v[184:187], v[40:43]
    s_waitcnt lgkmcnt(0)
    v_mfma_f32_16x16x32_bf16 v[12:15], v[152:155], v[216:219], v[12:15]
    ds_read_b128 v[184:187], v99 offset:20352
    v_mfma_f32_16x16x32_bf16 v[16:19], v[152:155], v[220:223], v[16:19]
    ds_read_b128 v[188:191], v99 offset:19840
    v_mfma_f32_16x16x32_bf16 v[20:23], v[152:155], v[224:227], v[20:23]
    ds_read_b128 v[192:195], v99 offset:19328
    v_mfma_f32_16x16x32_bf16 v[24:27], v[152:155], v[228:231], v[24:27]
    ds_read_b128 v[196:199], v99 offset:18816
    v_mfma_f32_16x16x32_bf16 v[28:31], v[152:155], v[232:235], v[28:31]
    ds_read_b128 v[200:203], v99 offset:18304
    v_mfma_f32_16x16x32_bf16 v[32:35], v[152:155], v[236:239], v[32:35]
    ds_read_b128 v[204:207], v99 offset:17792
    v_mfma_f32_16x16x32_bf16 v[36:39], v[152:155], v[240:243], v[36:39]
    ds_read_b128 v[208:211], v99 offset:17280
    v_mfma_f32_16x16x32_bf16 v[40:43], v[152:155], v[244:247], v[40:43]
    ds_read_b128 v[212:215], v99 offset:16768
    v_mfma_f32_16x16x32_bf16 v[16:19], v[156:159], v[216:219], v[16:19]
    ds_read_b64 v[120:121], v98 offset:160
    v_mfma_f32_16x16x32_bf16 v[20:23], v[156:159], v[220:223], v[20:23]
    ds_read_b64 v[122:123], v98 offset:168
    v_mfma_f32_16x16x32_bf16 v[24:27], v[156:159], v[224:227], v[24:27]
    ds_read_b64 v[124:125], v98 offset:672
    v_mfma_f32_16x16x32_bf16 v[28:31], v[156:159], v[228:231], v[28:31]
    ds_read_b64 v[126:127], v98 offset:680
    v_mfma_f32_16x16x32_bf16 v[32:35], v[156:159], v[232:235], v[32:35]
    ds_read_b64 v[128:129], v98 offset:1184
    v_mfma_f32_16x16x32_bf16 v[36:39], v[156:159], v[236:239], v[36:39]
    ds_read_b64 v[130:131], v98 offset:1192
    v_mfma_f32_16x16x32_bf16 v[40:43], v[156:159], v[240:243], v[40:43]
    ds_read_b64 v[132:133], v98 offset:1696
    v_mfma_f32_16x16x32_bf16 v[20:23], v[160:163], v[216:219], v[20:23]
    ds_read_b64 v[134:135], v98 offset:1704
    v_mfma_f32_16x16x32_bf16 v[24:27], v[160:163], v[220:223], v[24:27]
    ds_read_b64 v[136:137], v98 offset:2208
    v_mfma_f32_16x16x32_bf16 v[28:31], v[160:163], v[224:227], v[28:31]
    ds_read_b64 v[138:139], v98 offset:2216
    v_mfma_f32_16x16x32_bf16 v[32:35], v[160:163], v[228:231], v[32:35]
    ds_read_b64 v[140:141], v98 offset:2720
    v_mfma_f32_16x16x32_bf16 v[36:39], v[160:163], v[232:235], v[36:39]
    ds_read_b64 v[142:143], v98 offset:2728
    v_mfma_f32_16x16x32_bf16 v[40:43], v[160:163], v[236:239], v[40:43]
    ds_read_b64 v[144:145], v98 offset:3232
    v_mfma_f32_16x16x32_bf16 v[24:27], v[164:167], v[216:219], v[24:27]
    ds_read_b64 v[146:147], v98 offset:3240
    v_mfma_f32_16x16x32_bf16 v[28:31], v[164:167], v[220:223], v[28:31]
    ds_read_b64 v[148:149], v98 offset:3744
    v_mfma_f32_16x16x32_bf16 v[32:35], v[164:167], v[224:227], v[32:35]
    ds_read_b64 v[150:151], v98 offset:3752
    v_mfma_f32_16x16x32_bf16 v[36:39], v[164:167], v[228:231], v[36:39]
    v_add_u32 v98, 128, v98
    v_mfma_f32_16x16x32_bf16 v[40:43], v[164:167], v[232:235], v[40:43]
    v_add_u32 v99, 128, v99
    v_mfma_f32_16x16x32_bf16 v[28:31], v[168:171], v[216:219], v[28:31]
    s_add_u32 s43, s43, 1
    v_mfma_f32_16x16x32_bf16 v[32:35], v[168:171], v[220:223], v[32:35]
    s_cmp_lt_u32 s43, 4
    v_mfma_f32_16x16x32_bf16 v[36:39], v[168:171], v[224:227], v[36:39]
    v_mfma_f32_16x16x32_bf16 v[40:43], v[168:171], v[228:231], v[40:43]
    v_mfma_f32_16x16x32_bf16 v[32:35], v[172:175], v[216:219], v[32:35]
    v_mfma_f32_16x16x32_bf16 v[36:39], v[172:175], v[220:223], v[36:39]
    v_mfma_f32_16x16x32_bf16 v[40:43], v[172:175], v[224:227], v[40:43]
    v_mfma_f32_16x16x32_bf16 v[36:39], v[176:179], v[216:219], v[36:39]
    v_mfma_f32_16x16x32_bf16 v[40:43], v[176:179], v[220:223], v[40:43]
    v_mfma_f32_16x16x32_bf16 v[40:43], v[180:183], v[216:219], v[40:43]
    s_cbranch_scc1 CV_l
    s_bitcmp1_b32 s30, 0
    s_waitcnt lgkmcnt(0)
    s_cbranch_scc1 CV_o
    v_perm_b32 v12, v14, v12, s45
    v_perm_b32 v13, v15, v13, s45
    v_or_b32 v12, 0x10001, v12
    v_or_b32 v13, 0x10001, v13
    ds_write2_b32 v108, v12, v13 offset0:0 offset1:8
    v_perm_b32 v16, v18, v16, s45
    v_perm_b32 v17, v19, v17, s45
    v_or_b32 v16, 0x10001, v16
    v_or_b32 v17, 0x10001, v17
    ds_write2_b32 v108, v16, v17 offset0:144 offset1:152
    v_perm_b32 v20, v22, v20, s45
    v_perm_b32 v21, v23, v21, s45
    v_or_b32 v20, 0x10001, v20
    v_or_b32 v21, 0x10001, v21
    ds_write2_b32 v109, v20, v21 offset0:0 offset1:8
    v_perm_b32 v24, v26, v24, s45
    v_perm_b32 v25, v27, v25, s45
    v_or_b32 v24, 0x10001, v24
    v_or_b32 v25, 0x10001, v25
    ds_write2_b32 v109, v24, v25 offset0:144 offset1:152
    v_perm_b32 v28, v30, v28, s45
    v_perm_b32 v29, v31, v29, s45
    v_or_b32 v28, 0x10001, v28
    v_or_b32 v29, 0x10001, v29
    ds_write2_b32 v110, v28, v29 offset0:0 offset1:8
    v_perm_b32 v32, v34, v32, s45
    v_perm_b32 v33, v35, v33, s45
    v_or_b32 v32, 0x10001, v32
    v_or_b32 v33, 0x10001, v33
    ds_write2_b32 v110, v32, v33 offset0:144 offset1:152
    v_perm_b32 v36, v38, v36, s45
    v_perm_b32 v37, v39, v37, s45
    v_or_b32 v36, 0x10001, v36
    v_or_b32 v37, 0x10001, v37
    ds_write2_b32 v111, v36, v37 offset0:0 offset1:8
    v_perm_b32 v40, v42, v40, s45
    v_perm_b32 v41, v43, v41, s45
    v_or_b32 v40, 0x10001, v40
    v_or_b32 v41, 0x10001, v41
    ds_write2_b32 v111, v40, v41 offset0:144 offset1:152
    s_branch CV_e
CV_o:
    v_cvt_pk_bf16_f32 v12, v12, v14
    v_cvt_pk_bf16_f32 v13, v13, v15
    ds_write2_b32 v108, v12, v13 offset0:0 offset1:8
    v_cvt_pk_bf16_f32 v16, v16, v18
    v_cvt_pk_bf16_f32 v17, v17, v19
    ds_write2_b32 v108, v16, v17 offset0:144 offset1:152
    v_cvt_pk_bf16_f32 v20, v20, v22
    v_cvt_pk_bf16_f32 v21, v21, v23
    ds_write2_b32 v109, v20, v21 offset0:0 offset1:8
    v_cvt_pk_bf16_f32 v24, v24, v26
    v_cvt_pk_bf16_f32 v25, v25, v27
    ds_write2_b32 v109, v24, v25 offset0:144 offset1:152
    v_cvt_pk_bf16_f32 v28, v28, v30
    v_cvt_pk_bf16_f32 v29, v29, v31
    ds_write2_b32 v110, v28, v29 offset0:0 offset1:8
    v_cvt_pk_bf16_f32 v32, v32, v34
    v_cvt_pk_bf16_f32 v33, v33, v35
    ds_write2_b32 v110, v32, v33 offset0:144 offset1:152
    v_cvt_pk_bf16_f32 v36, v36, v38
    v_cvt_pk_bf16_f32 v37, v37, v39
    ds_write2_b32 v111, v36, v37 offset0:0 offset1:8
    v_cvt_pk_bf16_f32 v40, v40, v42
    v_cvt_pk_bf16_f32 v41, v41, v43
    ds_write2_b32 v111, v40, v41 offset0:144 offset1:152
CV_e:
    v_mov_b32 v8, 162824
    v_mov_b32 v9, 1
    s_waitcnt lgkmcnt(0)
    s_mov_b64 exec, 1
    ds_add_u32 v8, v9
    s_mov_b64 exec, -1
    v_mov_b32 v8, 162824
spin_3:
    ds_read_b32 v9, v8
    s_waitcnt lgkmcnt(0)
    v_readfirstlane_b32 s53, v9
    s_nop 0
    s_cmp_ge_u32 s53, 8
    s_cbranch_scc0 spin_3
    ds_read_b64_tr_b16 v[120:121], v103 offset:0
    ds_read_b64_tr_b16 v[122:123], v103 offset:32
    ds_read_b64_tr_b16 v[124:125], v103 offset:288
    ds_read_b64_tr_b16 v[126:127], v103 offset:320
    ds_read_b64_tr_b16 v[128:129], v103 offset:576
    ds_read_b64_tr_b16 v[130:131], v103 offset:608
    ds_read_b64_tr_b16 v[132:133], v103 offset:864
    ds_read_b64_tr_b16 v[134:135], v103 offset:896
    s_waitcnt lgkmcnt(6)
    buffer_store_dwordx4 v[120:123], v2, s[20:23], s44 offen offset:0 sc1
    s_waitcnt lgkmcnt(4)
    buffer_store_dwordx4 v[124:127], v2, s[20:23], s44 offen offset:1024 sc1
    s_waitcnt lgkmcnt(2)
    buffer_store_dwordx4 v[128:131], v2, s[20:23], s44 offen offset:2048 sc1
    s_waitcnt lgkmcnt(0)
    buffer_store_dwordx4 v[132:135], v2, s[20:23], s44 offen offset:3072 sc1
    s_waitcnt vmcnt(4)
    s_branch FR_end
FR_b:
    v_lshrrev_b32 v10, 2, v1
    v_lshlrev_b32 v74, 7, v10
    v_bfe_u32 v10, v10, 1, 2
    s_and_b32 s35, s30, 2
    v_and_b32 v11, 1, v1
    v_or_b32 v11, s35, v11
    v_xor_b32 v10, v10, v11
    v_lshl_add_u32 v74, v10, 5, v74
    v_and_b32 v10, 2, v1
    v_lshl_add_u32 v74, v10, 2, v74
    s_and_b32 s35, s30, 1
    s_lshl_b32 s35, s35, 4
    v_add_u32 v74, s35, v74
    v_add_u32 v75, 65536, v74
    v_add_u32 v76, 131072, v74
    s_and_b32 s36, s30, 3
    s_lshl_b32 s36, s36, 14
    s_lshl_b32 s48, s29, 7
    s_add_u32 s48, s48, s36
    s_cmp_lg_u32 s30, 5
    s_cbranch_scc1 FB_np
    s_waitcnt vmcnt(8)
    s_lshl_b32 s42, s2, 14
    s_add_u32 s42, s42, 29360128
    s_memtime s[34:35]
    s_waitcnt lgkmcnt(0)
    s_load_dword s32, s[4:5], s42 offset:0 glc
    s_waitcnt lgkmcnt(0)
    s_memtime s[40:41]
    s_waitcnt lgkmcnt(0)
    s_sub_u32 s46, s40, s34
    s_memtime s[34:35]
    s_waitcnt lgkmcnt(0)
    s_load_dword s32, s[4:5], s42 offset:8192 glc
    s_waitcnt lgkmcnt(0)
    s_memtime s[40:41]
    s_waitcnt lgkmcnt(0)
    s_sub_u32 s47, s40, s34
    s_cmp_lt_u32 s47, s46
    s_cselect_b32 s45, 1, 0
    s_lshr_b32 s46, s28, 2
    s_xor_b32 s45, s45, s46
    s_lshr_b32 s46, s2, 7
    s_xor_b32 s45, s45, s46
    s_and_b32 s45, s45, 1
    s_lshl_b32 s45, s45, 1
FB_np:
    s_lshr_b32 s53, s28, 3
    s_lshl_b32 s53, s53, 2
    s_and_b32 s54, s28, 3
    s_add_u32 s53, s53, s54
    s_lshl_b32 s53, s53, 23
    s_lshr_b32 s54, s28, 2
    s_xor_b32 s54, s54, s94
    s_and_b32 s54, s54, 1
    s_lshl_b32 s54, s54, 13
    s_add_u32 s37, s53, s54
    s_add_u32 s37, s37, 33554432
    s_andn2_b32 s37, s37, 0x2000
    s_lshl_b32 s43, s29, 7
    s_add_u32 s37, s37, s43
    s_add_u32 s37, s37, 1835008
    s_add_u32 s43, s43, 23068672
    v_mov_b32 v102, s52
    v_and_b32 v103, 1, v1
    v_lshlrev_b32 v103, 13, v103
    v_bfe_u32 v104, v1, 1, 1
    v_lshl_add_u32 v103, v104, 26, v103
    v_lshrrev_b32 v104, 2, v1
    v_lshl_add_u32 v103, v104, 11, v103
    s_waitcnt vmcnt(0) lgkmcnt(0)
    s_barrier
    ds_read_b64_tr_b16 v[132:133], v75 offset:24576
    ds_read_b64_tr_b16 v[134:135], v75 offset:26624
    ds_read_b64_tr_b16 v[140:141], v75 offset:28672
    ds_read_b64_tr_b16 v[142:143], v75 offset:30720
    ds_read_b64_tr_b16 v[148:149], v75 offset:32768
    ds_read_b64_tr_b16 v[150:151], v75 offset:34816
    ds_read_b64_tr_b16 v[156:157], v75 offset:36864
    ds_read_b64_tr_b16 v[158:159], v75 offset:38912
    ds_read_b64_tr_b16 v[164:165], v75 offset:40960
    ds_read_b64_tr_b16 v[166:167], v75 offset:43008
    ds_read_b64_tr_b16 v[172:173], v75 offset:45056
    ds_read_b64_tr_b16 v[174:175], v75 offset:47104
    ds_read_b64_tr_b16 v[180:181], v75 offset:49152
    ds_read_b64_tr_b16 v[182:183], v75 offset:51200
    ds_read_b64_tr_b16 v[188:189], v75 offset:53248
    ds_read_b64_tr_b16 v[190:191], v75 offset:55296
    ds_read_b64_tr_b16 v[196:197], v75 offset:57344
    ds_read_b64_tr_b16 v[198:199], v75 offset:59392
    ds_read_b64_tr_b16 v[204:205], v75 offset:61440
    ds_read_b64_tr_b16 v[206:207], v75 offset:63488
    ds_read_b64_tr_b16 v[212:213], v76 offset:0
    ds_read_b64_tr_b16 v[214:215], v76 offset:2048
    ds_read_b64_tr_b16 v[220:221], v76 offset:4096
    ds_read_b64_tr_b16 v[222:223], v76 offset:6144
    ds_read_b64_tr_b16 v[228:229], v76 offset:8192
    ds_read_b64_tr_b16 v[230:231], v76 offset:10240
    ds_read_b64_tr_b16 v[236:237], v76 offset:12288
    ds_read_b64_tr_b16 v[238:239], v76 offset:14336
    ds_read_b64_tr_b16 v[244:245], v76 offset:16384
    ds_read_b64_tr_b16 v[246:247], v76 offset:18432
    ds_read_b64_tr_b16 v[252:253], v76 offset:20480
    ds_read_b64_tr_b16 v[254:255], v76 offset:22528
    s_waitcnt lgkmcnt(0)
    s_barrier
    s_cmp_lg_u32 s30, 5
    s_cbranch_scc1 FB_na
    s_lshl_b32 s36, s2, 7
    s_add_u32 s36, s36, 23592960
    s_add_u32 s45, s45, s52
    s_getreg_b32 s53, hwreg(HW_REG_XCC_ID, 0, 4)
    s_lshl2_add_u32 s45, s53, s45
    v_mov_b32 v8, s45
    s_mov_b64 exec, 1
    buffer_store_dword v8, v2, s[56:59], s36 offen sc1
    s_mov_b64 exec, -1
FB_na:
    buffer_load_dwordx4 v[12:15], v2, s[80:83], s50 offen
    s_sub_u32 s50, s50, 4096
    buffer_load_dwordx4 v[12:15], v2, s[80:83], s50 offen
    s_sub_u32 s50, s50, 4096
    buffer_load_dwordx2 v[86:87], v80, s[8:11], 0 offen offset:0 nt
    buffer_load_dwordx2 v[88:89], v80, s[8:11], 0 offen offset:32 nt
    buffer_load_dwordx2 v[90:91], v80, s[8:11], 0 offen offset:128 nt
    buffer_load_dwordx2 v[92:93], v80, s[8:11], 0 offen offset:160 nt
    s_setprio 0
    s_cmp_lg_u32 s30, 4
    s_cbranch_scc1 FB_ni
    s_mov_b64 exec, 0xfff
    buffer_store_dword v102, v103, s[56:59], s37 offen sc1
    s_cmp_lg_u32 s28, 0
    s_cbranch_scc1 FB_n2
    s_mov_b64 exec, 3
    buffer_store_dword v102, v103, s[56:59], s43 offen sc1
FB_n2:
    s_mov_b64 exec, -1
FB_ni:
    s_add_u32 s36, s48, 0
    buffer_load_dwordx4 v[128:131], v118, s[88:91], s36 offen
    s_add_u32 s36, s36, 65536
    buffer_load_dwordx4 v[136:139], v118, s[88:91], s36 offen
    s_add_u32 s36, s48, 131072
    buffer_load_dwordx4 v[144:147], v118, s[88:91], s36 offen
    s_add_u32 s36, s36, 65536
    buffer_load_dwordx4 v[152:155], v118, s[88:91], s36 offen
    s_and_b32 s49, s30, 3
    s_lshl_b32 s36, s49, 14
    s_lshl_b32 s48, s29, 7
    s_add_u32 s48, s48, s36
    s_lshl_b32 s49, s49, 10
    s_xor_b32 s48, s48, 128
    s_add_u32 s36, s48, 1441792
    s_add_u32 m0, s49, 114688
    s_nop 0
    buffer_load_dwordx4 v118, s[80:83], s36 offen lds
    s_add_u32 s36, s36, 65536
    s_add_u32 m0, s49, 118784
    s_nop 0
    buffer_load_dwordx4 v118, s[80:83], s36 offen lds
    s_add_u32 s36, s48, 1572864
    s_add_u32 m0, s49, 122880
    s_nop 0
    buffer_load_dwordx4 v118, s[80:83], s36 offen lds
    s_add_u32 s36, s36, 65536
    s_add_u32 m0, s49, 126976
    s_nop 0
    buffer_load_dwordx4 v118, s[80:83], s36 offen lds
    s_add_u32 s36, s48, 1966080
    s_add_u32 m0, s49, 147456
    s_nop 0
    buffer_load_dwordx4 v118, s[80:83], s36 offen lds
    s_add_u32 s36, s36, 65536
    s_add_u32 m0, s49, 151552
    s_nop 0
    buffer_load_dwordx4 v118, s[80:83], s36 offen lds
    s_add_u32 s36, s48, 1703936
    s_add_u32 m0, s49, 131072
    s_nop 0
    buffer_load_dwordx4 v118, s[80:83], s36 offen lds
    s_add_u32 s36, s36, 65536
    s_add_u32 m0, s49, 135168
    s_nop 0
    buffer_load_dwordx4 v118, s[80:83], s36 offen lds
    s_add_u32 s36, s48, 1835008
    s_add_u32 m0, s49, 139264
    s_nop 0
    buffer_load_dwordx4 v118, s[80:83], s36 offen lds
    s_add_u32 s36, s36, 65536
    s_add_u32 m0, s49, 143360
    s_nop 0
    buffer_load_dwordx4 v118, s[80:83], s36 offen lds
    s_waitcnt vmcnt(14)
    v_mov_b32 v6, 162824
    v_mov_b32 v7, 1
    s_waitcnt lgkmcnt(0)
    s_mov_b64 exec, 1
    ds_add_u32 v6, v7
    s_mov_b64 exec, -1
    s_add_u32 s36, s48, 393216
    buffer_load_dwordx4 v[28:31], v118, s[80:83], s36 offen
    s_add_u32 s36, s36, 65536
    buffer_load_dwordx4 v[32:35], v118, s[80:83], s36 offen
    s_add_u32 s36, s48, 524288
    buffer_load_dwordx4 v[36:39], v118, s[80:83], s36 offen
    s_add_u32 s36, s36, 65536
    buffer_load_dwordx4 v[40:43], v118, s[80:83], s36 offen
    s_add_u32 s36, s48, 655360
    buffer_load_dwordx4 v[52:55], v118, s[80:83], s36 offen
    s_add_u32 s36, s36, 65536
    buffer_load_dwordx4 v[56:59], v118, s[80:83], s36 offen
    s_add_u32 s36, s48, 786432
    buffer_load_dwordx4 v[60:63], v118, s[80:83], s36 offen
    s_add_u32 s36, s36, 65536
    buffer_load_dwordx4 v[64:67], v118, s[80:83], s36 offen
    s_add_u32 s36, s48, 0
    buffer_load_dwordx4 v[94:97], v118, s[80:83], s36 offen
    s_add_u32 s36, s36, 65536
    buffer_load_dwordx4 v[98:101], v118, s[80:83], s36 offen
    s_xor_b32 s48, s48, 128
    s_add_u32 s36, s48, 262144
    buffer_load_dwordx4 v[160:163], v118, s[88:91], s36 offen
    s_add_u32 s36, s36, 65536
    buffer_load_dwordx4 v[168:171], v118, s[88:91], s36 offen
    s_add_u32 s36, s48, 393216
    buffer_load_dwordx4 v[176:179], v118, s[88:91], s36 offen
    s_add_u32 s36, s36, 65536
    buffer_load_dwordx4 v[184:187], v118, s[88:91], s36 offen
    s_add_u32 s36, s48, 524288
    buffer_load_dwordx4 v[192:195], v118, s[88:91], s36 offen
    s_add_u32 s36, s36, 65536
    buffer_load_dwordx4 v[200:203], v118, s[88:91], s36 offen
    s_and_b32 s42, s30, 3
    s_lshl_b32 s42, s42, 13
    s_add_u32 s42, s42, 23592960
    v_lshlrev_b32 v8, 7, v1
    buffer_load_dword v10, v8, s[56:59], s42 offen sc1
    s_add_u32 s36, s48, 655360
    buffer_load_dwordx4 v[208:211], v118, s[88:91], s36 offen
    s_add_u32 s36, s36, 65536
    buffer_load_dwordx4 v[216:219], v118, s[88:91], s36 offen
    s_add_u32 s36, s48, 786432
    buffer_load_dwordx4 v[224:227], v118, s[88:91], s36 offen
    s_add_u32 s36, s36, 65536
    buffer_load_dwordx4 v[232:235], v118, s[88:91], s36 offen
    s_add_u32 s36, s48, 917504
    buffer_load_dwordx4 v[240:243], v118, s[88:91], s36 offen
    s_add_u32 s36, s36, 65536
    buffer_load_dwordx4 v[248:251], v118, s[88:91], s36 offen
    s_setprio 0
    s_mov_b32 s53, 0
    s_waitcnt vmcnt(6)
R_fp:
    v_and_b32 v11, 0xffffffc1, v10
    v_cmp_eq_u32 vcc, s52, v11
    s_nop 0
    s_cmp_eq_u64 vcc, exec
    s_cbranch_scc1 R_fq
    s_sleep 3
    buffer_load_dword v10, v8, s[56:59], s42 offen sc1
    s_waitcnt vmcnt(0)
    s_add_u32 s53, s53, 1
    s_cmp_lt_u32 s53, s61
    s_cbranch_scc1 R_fp
    s_mov_b32 s61, 0
R_fq:
    s_getreg_b32 s53, hwreg(HW_REG_XCC_ID, 0, 4)
    v_bfe_u32 v11, v10, 2, 4
    v_cmp_ne_u32 s[34:35], s53, v11
    v_and_b32 v11, 2, v10
    v_cmp_ne_u32 vcc, 0, v11
    s_nop 0
    s_bcnt1_i32_b64 s36, vcc
    s_or_b32 s34, s34, s35
    s_bitcmp1_b32 s34, s2
    s_cselect_b32 s34, 0x10000, 0
    s_add_u32 s36, s36, s34
    v_mov_b32 v10, s36
    v_mov_b32 v11, 162844
    s_mov_b64 exec, 1
    ds_add_u32 v11, v10
    s_mov_b64 exec, -1
FR_end:
    v_and_b32 v81, 7, v0
    v_lshlrev_b32 v72, 6, v81
    v_add_u32 v72, 161792, v72
    s_lshl_b32 s35, s30, 3
    v_add_u32 v71, s35, v72
    v_lshlrev_b32 v12, 16, v86
    v_and_b32 v13, 0xffff0000, v86
    v_lshlrev_b32 v14, 16, v87
    v_and_b32 v15, 0xffff0000, v87
    v_lshlrev_b32 v16, 16, v88
    v_and_b32 v17, 0xffff0000, v88
    v_lshlrev_b32 v18, 16, v89
    v_and_b32 v19, 0xffff0000, v89
    v_lshlrev_b32 v20, 16, v90
    v_and_b32 v21, 0xffff0000, v90
    v_lshlrev_b32 v22, 16, v91
    v_and_b32 v23, 0xffff0000, v91
    v_lshlrev_b32 v24, 16, v92
    v_and_b32 v25, 0xffff0000, v92
    v_lshlrev_b32 v26, 16, v93
    v_and_b32 v27, 0xffff0000, v93
    v_pk_add_f32 v[48:49], v[12:13], v[14:15]
    v_pk_mul_f32 v[50:51], v[12:13], v[12:13]
    v_pk_fma_f32 v[50:51], v[14:15], v[14:15], v[50:51]
    v_pk_add_f32 v[48:49], v[48:49], v[16:17]
    v_pk_fma_f32 v[50:51], v[16:17], v[16:17], v[50:51]
    v_pk_add_f32 v[48:49], v[48:49], v[18:19]
    v_pk_fma_f32 v[50:51], v[18:19], v[18:19], v[50:51]
    v_pk_add_f32 v[48:49], v[48:49], v[20:21]
    v_pk_fma_f32 v[50:51], v[20:21], v[20:21], v[50:51]
    v_pk_add_f32 v[48:49], v[48:49], v[22:23]
    v_pk_fma_f32 v[50:51], v[22:23], v[22:23], v[50:51]
    v_pk_add_f32 v[48:49], v[48:49], v[24:25]
    v_pk_fma_f32 v[50:51], v[24:25], v[24:25], v[50:51]
    v_pk_add_f32 v[48:49], v[48:49], v[26:27]
    v_pk_fma_f32 v[50:51], v[26:27], v[26:27], v[50:51]
    v_add_f32 v46, v48, v49
    v_add_f32 v47, v50, v51
    s_nop 0
    v_add_f32_dpp v46, v46, v46 row_ror:8 row_mask:0xf bank_mask:0xf
    v_add_f32_dpp v47, v47, v47 row_ror:8 row_mask:0xf bank_mask:0xf
    v_mov_b32 v48, v46
    v_mov_b32 v49, v47
    s_nop 0
    v_permlane16_swap_b32 v46, v48
    v_permlane16_swap_b32 v47, v49
    v_pk_add_f32 v[46:47], v[46:47], v[48:49]
    v_mov_b32 v48, v46
    v_mov_b32 v49, v47
    s_nop 0
    v_permlane32_swap_b32 v46, v48
    v_permlane32_swap_b32 v47, v49
    v_pk_add_f32 v[46:47], v[46:47], v[48:49]
    ds_write_b64 v71, v[46:47] offset:0
    s_waitcnt lgkmcnt(0)
    s_barrier
LAYER:
    v_and_b32 v81, 7, v0
    v_lshlrev_b32 v72, 6, v81
    v_add_u32 v72, 161792, v72
    s_lshl_b32 s35, s30, 3
    v_add_u32 v71, s35, v72
    v_lshrrev_b32 v6, 2, v1
    v_lshlrev_b32 v74, 7, v6
    v_bfe_u32 v6, v6, 1, 2
    s_and_b32 s35, s30, 2
    v_and_b32 v7, 1, v1
    v_or_b32 v7, s35, v7
    v_xor_b32 v6, v6, v7
    v_lshl_add_u32 v74, v6, 5, v74
    v_and_b32 v6, 2, v1
    v_lshl_add_u32 v74, v6, 2, v74
    s_and_b32 s35, s30, 1
    s_lshl_b32 s35, s35, 4
    v_add_u32 v74, s35, v74
    v_add_u32 v75, 65536, v74
    v_add_u32 v76, 131072, v74
    s_cmp_eq_u32 s60, 0
    s_cbranch_scc1 R_l0
    s_sub_u32 s12, s62, 0x3b80000
    s_subb_u32 s13, s63, 0
    s_mov_b32 s14, 0x7e000
    s_mov_b32 s15, 0x20000
    s_lshl_b32 s22, s60, 24
    s_lshl_b32 s23, s94, 13
    s_add_u32 s22, s22, s23
    s_add_u32 s22, s22, 167772160
    s_add_u32 s20, s4, s22
    s_addc_u32 s21, s5, 0
    s_mov_b32 s22, 8380416
    s_mov_b32 s23, 0x20000
    buffer_load_dwordx4 v[86:89], v78, s[12:15], 0 offen offset:0 sc1
    buffer_load_dwordx4 v[90:93], v78, s[12:15], 0 offen offset:2048 sc1
    s_waitcnt vmcnt(2)
    v_lshlrev_b32 v102, 16, v110
    v_and_b32 v103, 0xffff0000, v110
    v_lshlrev_b32 v104, 16, v111
    v_and_b32 v105, 0xffff0000, v111
    v_lshlrev_b32 v106, 16, v112
    v_and_b32 v107, 0xffff0000, v112
    v_lshlrev_b32 v108, 16, v113
    v_and_b32 v109, 0xffff0000, v113
    v_lshlrev_b32 v110, 16, v114
    v_and_b32 v111, 0xffff0000, v114
    v_lshlrev_b32 v112, 16, v115
    v_and_b32 v113, 0xffff0000, v115
    v_lshlrev_b32 v114, 16, v116
    v_and_b32 v115, 0xffff0000, v116
    v_lshlrev_b32 v116, 16, v117
    v_and_b32 v117, 0xffff0000, v117
    s_mov_b32 s53, 0
dw_4:
    s_waitcnt vmcnt(0)
    v_and_b32 v6, v86, v87
    v_and_b32 v7, v90, v91
    v_bitop3_b32 v6, v88, v89, v6 bitop3:0x80
    v_bitop3_b32 v7, v92, v93, v7 bitop3:0x80
    v_bitop3_b32 v6, v6, v7, 1 bitop3:0x80
    v_cmp_eq_u32 vcc, 0, v6
    s_nop 0
    s_cmp_eq_u64 vcc, 0
    s_cbranch_scc1 dok_5
    s_mov_b64 exec, vcc
    s_sleep 2
    buffer_load_dwordx4 v[86:89], v78, s[12:15], 0 offen offset:0 sc1
    buffer_load_dwordx4 v[90:93], v78, s[12:15], 0 offen offset:2048 sc1
    s_add_u32 s53, s53, 1
    s_cmp_lt_u32 s53, s61
    s_cbranch_scc1 dw_4
    s_mov_b32 s61, 0
    s_waitcnt vmcnt(0)
dok_5:
    s_mov_b64 exec, -1
    s_mov_b32 s36, 0x3f803f80
    v_dot2_f32_bf16 v48, v86, s36, 0
    v_dot2_f32_bf16 v50, v86, v86, 0
    v_dot2_f32_bf16 v49, v87, s36, 0
    v_dot2_f32_bf16 v51, v87, v87, 0
    v_dot2_f32_bf16 v48, v88, s36, v48
    v_dot2_f32_bf16 v50, v88, v88, v50
    v_dot2_f32_bf16 v49, v89, s36, v49
    v_dot2_f32_bf16 v51, v89, v89, v51
    v_dot2_f32_bf16 v48, v90, s36, v48
    v_dot2_f32_bf16 v50, v90, v90, v50
    v_dot2_f32_bf16 v49, v91, s36, v49
    v_dot2_f32_bf16 v51, v91, v91, v51
    v_dot2_f32_bf16 v48, v92, s36, v48
    v_dot2_f32_bf16 v50, v92, v92, v50
    v_dot2_f32_bf16 v49, v93, s36, v49
    v_dot2_f32_bf16 v51, v93, v93, v51
    s_nop 2
    v_add_f32 v46, v48, v49
    v_add_f32 v47, v50, v51
    s_nop 0
    v_add_f32_dpp v46, v46, v46 row_ror:8 row_mask:0xf bank_mask:0xf
    v_add_f32_dpp v47, v47, v47 row_ror:8 row_mask:0xf bank_mask:0xf
    v_mov_b32 v48, v46
    v_mov_b32 v49, v47
    s_nop 0
    v_permlane16_swap_b32 v46, v48
    v_permlane16_swap_b32 v47, v49
    v_pk_add_f32 v[46:47], v[46:47], v[48:49]
    v_mov_b32 v48, v46
    v_mov_b32 v49, v47
    s_nop 0
    v_permlane32_swap_b32 v46, v48
    v_permlane32_swap_b32 v47, v49
    v_pk_add_f32 v[46:47], v[46:47], v[48:49]
    ds_write_b64 v71, v[46:47] offset:0
    v_lshlrev_b32 v12, 16, v86
    v_and_b32 v13, 0xffff0000, v86
    v_lshlrev_b32 v14, 16, v87
    v_and_b32 v15, 0xffff0000, v87
    v_lshlrev_b32 v16, 16, v88
    v_and_b32 v17, 0xffff0000, v88
    v_lshlrev_b32 v18, 16, v89
    v_and_b32 v19, 0xffff0000, v89
    v_lshlrev_b32 v20, 16, v90
    v_and_b32 v21, 0xffff0000, v90
    v_lshlrev_b32 v22, 16, v91
    v_and_b32 v23, 0xffff0000, v91
    v_lshlrev_b32 v24, 16, v92
    v_and_b32 v25, 0xffff0000, v92
    v_lshlrev_b32 v26, 16, v93
    v_and_b32 v27, 0xffff0000, v93
    s_waitcnt lgkmcnt(0)
    s_barrier
    ds_read_b128 v[52:55], v72 offset:0
    ds_read_b128 v[56:59], v72 offset:16
    ds_read_b128 v[60:63], v72 offset:32
    ds_read_b128 v[64:67], v72 offset:48
    s_waitcnt lgkmcnt(0)
    v_pk_add_f32 v[52:53], v[52:53], v[54:55]
    v_pk_add_f32 v[56:57], v[56:57], v[58:59]
    v_pk_add_f32 v[60:61], v[60:61], v[62:63]
    v_pk_add_f32 v[64:65], v[64:65], v[66:67]
    v_pk_add_f32 v[52:53], v[52:53], v[56:57]
    v_pk_add_f32 v[60:61], v[60:61], v[64:65]
    v_pk_add_f32 v[52:53], v[52:53], v[60:61]
    v_mul_f32 v68, 0x3a800000, v52
    v_mul_f32 v70, 0x3a800000, v53
    v_fma_f32 v70, -v68, v68, v70
    v_max_f32 v70, 0, v70
    v_add_f32 v70, 0x3727c5ac, v70
    v_rsq_f32 v69, v70
    s_nop 0
    v_mul_f32 v68, -v68, v69
    v_pk_fma_f32 v[28:29], v[12:13], v[68:69], v[68:69] op_sel:[0,1,0] op_sel_hi:[1,1,0]
    v_pk_fma_f32 v[30:31], v[14:15], v[68:69], v[68:69] op_sel:[0,1,0] op_sel_hi:[1,1,0]
    v_pk_fma_f32 v[32:33], v[16:17], v[68:69], v[68:69] op_sel:[0,1,0] op_sel_hi:[1,1,0]
    v_pk_fma_f32 v[34:35], v[18:19], v[68:69], v[68:69] op_sel:[0,1,0] op_sel_hi:[1,1,0]
    v_pk_fma_f32 v[36:37], v[20:21], v[68:69], v[68:69] op_sel:[0,1,0] op_sel_hi:[1,1,0]
    v_pk_fma_f32 v[38:39], v[22:23], v[68:69], v[68:69] op_sel:[0,1,0] op_sel_hi:[1,1,0]
    v_pk_fma_f32 v[40:41], v[24:25], v[68:69], v[68:69] op_sel:[0,1,0] op_sel_hi:[1,1,0]
    v_pk_fma_f32 v[42:43], v[26:27], v[68:69], v[68:69] op_sel:[0,1,0] op_sel_hi:[1,1,0]
    s_branch R_s2
R_l0:
    s_cmp_lt_u32 s30, 4
    s_cbranch_scc1 R_f2
    s_and_b32 s36, s30, 3
    s_lshl_b32 s36, s36, 10
    v_add_u32 v8, s36, v2
    v_add_u32 v9, 65536, v8
    ds_write_b128 v8, v[28:31] offset:49152
    ds_write_b128 v8, v[32:35] offset:53248
    ds_write_b128 v8, v[36:39] offset:57344
    ds_write_b128 v8, v[40:43] offset:61440
    ds_write_b128 v9, v[52:55] offset:0
    ds_write_b128 v9, v[56:59] offset:4096
    ds_write_b128 v9, v[60:63] offset:8192
    ds_write_b128 v9, v[64:67] offset:12288
    ds_write_b128 v8, v[94:97] offset:24576
    ds_write_b128 v8, v[98:101] offset:28672
R_f2:
    v_mov_b32 v6, 162844
    ds_read_b32 v7, v6
    ds_read_b128 v[52:55], v72 offset:0
    ds_read_b128 v[56:59], v72 offset:16
    ds_read_b128 v[60:63], v72 offset:32
    ds_read_b128 v[64:67], v72 offset:48
    s_waitcnt lgkmcnt(0)
    v_pk_add_f32 v[52:53], v[52:53], v[54:55]
    v_pk_add_f32 v[56:57], v[56:57], v[58:59]
    v_pk_add_f32 v[60:61], v[60:61], v[62:63]
    v_pk_add_f32 v[64:65], v[64:65], v[66:67]
    v_pk_add_f32 v[52:53], v[52:53], v[56:57]
    v_pk_add_f32 v[60:61], v[60:61], v[64:65]
    v_pk_add_f32 v[52:53], v[52:53], v[60:61]
    v_mul_f32 v68, 0x3a800000, v52
    v_mul_f32 v70, 0x3a800000, v53
    v_fma_f32 v70, -v68, v68, v70
    v_max_f32 v70, 0, v70
    v_add_f32 v70, 0x3727c5ac, v70
    v_rsq_f32 v69, v70
    s_nop 0
    v_mul_f32 v68, -v68, v69
    v_pk_fma_f32 v[28:29], v[12:13], v[68:69], v[68:69] op_sel:[0,1,0] op_sel_hi:[1,1,0]
    v_pk_fma_f32 v[30:31], v[14:15], v[68:69], v[68:69] op_sel:[0,1,0] op_sel_hi:[1,1,0]
    v_pk_fma_f32 v[32:33], v[16:17], v[68:69], v[68:69] op_sel:[0,1,0] op_sel_hi:[1,1,0]
    v_pk_fma_f32 v[34:35], v[18:19], v[68:69], v[68:69] op_sel:[0,1,0] op_sel_hi:[1,1,0]
    v_pk_fma_f32 v[36:37], v[20:21], v[68:69], v[68:69] op_sel:[0,1,0] op_sel_hi:[1,1,0]
    v_pk_fma_f32 v[38:39], v[22:23], v[68:69], v[68:69] op_sel:[0,1,0] op_sel_hi:[1,1,0]
    v_pk_fma_f32 v[40:41], v[24:25], v[68:69], v[68:69] op_sel:[0,1,0] op_sel_hi:[1,1,0]
    v_pk_fma_f32 v[42:43], v[26:27], v[68:69], v[68:69] op_sel:[0,1,0] op_sel_hi:[1,1,0]
    v_readfirstlane_b32 s94, v7
    s_nop 0
    s_lshr_b32 s98, s94, 16
    s_and_b32 s94, s94, 0xffff
    s_cmp_gt_u32 s94, 127
    s_cselect_b32 s94, 1, 0
    s_lshr_b32 s53, s28, 3
    s_lshl_b32 s53, s53, 2
    s_and_b32 s54, s28, 3
    s_add_u32 s53, s53, s54
    s_lshl_b32 s53, s53, 23
    s_lshr_b32 s54, s28, 2
    s_xor_b32 s54, s54, s94
    s_and_b32 s54, s54, 1
    s_lshl_b32 s54, s54, 13
    s_add_u32 s55, s53, s54
    s_add_u32 s55, s55, 33554432
    s_add_u32 s62, s4, s55
    s_addc_u32 s63, s5, 0
    s_sub_u32 s36, s28, 1
    s_max_i32 s36, s36, 0
    s_lshr_b32 s53, s36, 3
    s_lshl_b32 s53, s53, 2
    s_and_b32 s54, s36, 3
    s_add_u32 s53, s53, s54
    s_lshl_b32 s53, s53, 23
    s_lshr_b32 s54, s36, 2
    s_xor_b32 s54, s54, s94
    s_and_b32 s54, s54, 1
    s_lshl_b32 s54, s54, 13
    s_add_u32 s92, s53, s54
    s_add_u32 s92, s92, 33554432
    s_sub_u32 s92, s92, s55
    s_add_u32 s36, s28, 1
    s_min_u32 s36, s36, 15
    s_lshr_b32 s53, s36, 3
    s_lshl_b32 s53, s53, 2
    s_and_b32 s54, s36, 3
    s_add_u32 s53, s53, s54
    s_lshl_b32 s53, s53, 23
    s_lshr_b32 s54, s36, 2
    s_xor_b32 s54, s54, s94
    s_and_b32 s54, s54, 1
    s_lshl_b32 s54, s54, 13
    s_add_u32 s93, s53, s54
    s_add_u32 s93, s93, 33554432
    s_sub_u32 s93, s93, s55
    s_add_u32 s55, s55, 1835008
    s_lshl_b32 s22, s60, 24
    s_lshl_b32 s23, s94, 13
    s_add_u32 s22, s22, s23
    s_add_u32 s22, s22, 167772160
    s_add_u32 s20, s4, s22
    s_addc_u32 s21, s5, 0
    s_mov_b32 s22, 8380416
    s_mov_b32 s23, 0x20000
    s_add_u32 s80, s4, 0x1800000
    s_addc_u32 s81, s5, 0
    s_mov_b32 s82, 0x400000
    s_mov_b32 s83, 0x20000
    s_mov_b32 s78, 0
    buffer_load_dwordx2 v[110:111], v79, s[80:83], s78 offen sc1
    s_mov_b32 s78, 65536
    buffer_load_dwordx2 v[112:113], v79, s[80:83], s78 offen sc1
    s_mov_b32 s78, 262144
    buffer_load_dwordx2 v[114:115], v79, s[80:83], s78 offen sc1
    s_mov_b32 s78, 327680
    buffer_load_dwordx2 v[116:117], v79, s[80:83], s78 offen sc1
    s_cmp_lt_u32 s30, 4
    s_cbranch_scc1 R_f3
    s_waitcnt vmcnt(4)
    s_and_b32 s36, s30, 3
    s_lshl_b32 s36, s36, 10
    v_add_u32 v8, s36, v2
    v_add_u32 v9, 65536, v8
    ds_write_b128 v8, v[128:131] offset:0
    ds_write_b128 v8, v[136:139] offset:4096
    ds_write_b128 v8, v[144:147] offset:8192
    ds_write_b128 v8, v[152:155] offset:12288
    ds_write_b128 v8, v[160:163] offset:16384
    ds_write_b128 v8, v[168:171] offset:20480
    ds_write_b128 v9, v[176:179] offset:16384
    ds_write_b128 v9, v[184:187] offset:20480
    ds_write_b128 v9, v[192:195] offset:24576
    ds_write_b128 v9, v[200:203] offset:28672
    ds_write_b128 v8, v[208:211] offset:32768
    ds_write_b128 v8, v[216:219] offset:36864
    ds_write_b128 v8, v[224:227] offset:40960
    ds_write_b128 v8, v[232:235] offset:45056
    ds_write_b128 v9, v[240:243] offset:32768
    ds_write_b128 v9, v[248:251] offset:36864
R_f3:
    s_mov_b32 s53, 0
dw_6:
    s_waitcnt vmcnt(0)
    v_and_b32 v6, v110, v111
    v_and_b32 v7, v114, v115
    v_bitop3_b32 v6, v112, v113, v6 bitop3:0x80
    v_bitop3_b32 v7, v116, v117, v7 bitop3:0x80
    v_bitop3_b32 v6, v6, v7, 1 bitop3:0x80
    v_cmp_eq_u32 vcc, 0, v6
    s_nop 0
    s_cmp_eq_u64 vcc, 0
    s_cbranch_scc1 dok_7
    s_mov_b64 exec, vcc
    s_sleep 4
    s_mov_b32 s78, 0
    buffer_load_dwordx2 v[110:111], v79, s[80:83], s78 offen sc1
    s_mov_b32 s78, 65536
    buffer_load_dwordx2 v[112:113], v79, s[80:83], s78 offen sc1
    s_mov_b32 s78, 262144
    buffer_load_dwordx2 v[114:115], v79, s[80:83], s78 offen sc1
    s_mov_b32 s78, 327680
    buffer_load_dwordx2 v[116:117], v79, s[80:83], s78 offen sc1
    s_add_u32 s53, s53, 1
    s_cmp_lt_u32 s53, s61
    s_cbranch_scc1 dw_6
    s_mov_b32 s61, 0
    s_waitcnt vmcnt(0)
dok_7:
    s_mov_b64 exec, -1
    v_lshlrev_b32 v102, 16, v110
    v_and_b32 v103, 0xffff0000, v110
    v_lshlrev_b32 v104, 16, v111
    v_and_b32 v105, 0xffff0000, v111
    v_lshlrev_b32 v106, 16, v112
    v_and_b32 v107, 0xffff0000, v112
    v_lshlrev_b32 v108, 16, v113
    v_and_b32 v109, 0xffff0000, v113
    v_lshlrev_b32 v110, 16, v114
    v_and_b32 v111, 0xffff0000, v114
    v_lshlrev_b32 v112, 16, v115
    v_and_b32 v113, 0xffff0000, v115
    v_lshlrev_b32 v114, 16, v116
    v_and_b32 v115, 0xffff0000, v116
    v_lshlrev_b32 v116, 16, v117
    v_and_b32 v117, 0xffff0000, v117
R_s2:
    v_pk_fma_f32 v[12:13], v[28:29], v[102:103], v[12:13]
    v_pk_fma_f32 v[14:15], v[30:31], v[104:105], v[14:15]
    v_pk_fma_f32 v[16:17], v[32:33], v[106:107], v[16:17]
    v_pk_fma_f32 v[18:19], v[34:35], v[108:109], v[18:19]
    v_cvt_pk_bf16_f32 v86, v12, v13
    v_cvt_pk_bf16_f32 v87, v14, v15
    v_cvt_pk_bf16_f32 v88, v16, v17
    v_cvt_pk_bf16_f32 v89, v18, v19
    buffer_store_dwordx4 v[86:89], v82, s[20:23], 0 offen offset:0 sc1
    v_pk_fma_f32 v[20:21], v[36:37], v[110:111], v[20:21]
    v_pk_fma_f32 v[22:23], v[38:39], v[112:113], v[22:23]
    v_pk_fma_f32 v[24:25], v[40:41], v[114:115], v[24:25]
    v_pk_fma_f32 v[26:27], v[42:43], v[116:117], v[26:27]
    v_cvt_pk_bf16_f32 v90, v20, v21
    v_cvt_pk_bf16_f32 v91, v22, v23
    v_cvt_pk_bf16_f32 v92, v24, v25
    v_cvt_pk_bf16_f32 v93, v26, v27
    buffer_store_dwordx4 v[90:93], v82, s[20:23], 0 offen offset:128 sc1
    v_pk_add_f32 v[48:49], v[12:13], v[14:15]
    v_pk_mul_f32 v[50:51], v[12:13], v[12:13]
    v_pk_fma_f32 v[50:51], v[14:15], v[14:15], v[50:51]
    v_pk_add_f32 v[48:49], v[48:49], v[16:17]
    v_pk_fma_f32 v[50:51], v[16:17], v[16:17], v[50:51]
    v_pk_add_f32 v[48:49], v[48:49], v[18:19]
    v_pk_fma_f32 v[50:51], v[18:19], v[18:19], v[50:51]
    v_pk_add_f32 v[48:49], v[48:49], v[20:21]
    v_pk_fma_f32 v[50:51], v[20:21], v[20:21], v[50:51]
    v_pk_add_f32 v[48:49], v[48:49], v[22:23]
    v_pk_fma_f32 v[50:51], v[22:23], v[22:23], v[50:51]
    v_pk_add_f32 v[48:49], v[48:49], v[24:25]
    v_pk_fma_f32 v[50:51], v[24:25], v[24:25], v[50:51]
    v_pk_add_f32 v[48:49], v[48:49], v[26:27]
    v_pk_fma_f32 v[50:51], v[26:27], v[26:27], v[50:51]
    v_add_f32 v46, v48, v49
    v_add_f32 v47, v50, v51
    s_nop 0
    v_add_f32_dpp v46, v46, v46 row_ror:8 row_mask:0xf bank_mask:0xf
    v_add_f32_dpp v47, v47, v47 row_ror:8 row_mask:0xf bank_mask:0xf
    v_mov_b32 v48, v46
    v_mov_b32 v49, v47
    s_nop 0
    v_permlane16_swap_b32 v46, v48
    v_permlane16_swap_b32 v47, v49
    v_pk_add_f32 v[46:47], v[46:47], v[48:49]
    v_mov_b32 v48, v46
    v_mov_b32 v49, v47
    s_nop 0
    v_permlane32_swap_b32 v46, v48
    v_permlane32_swap_b32 v47, v49
    v_pk_add_f32 v[46:47], v[46:47], v[48:49]
    ds_write_b64 v71, v[46:47] offset:1536
    s_waitcnt lgkmcnt(0)
    s_barrier
    s_cmp_ge_u32 s30, 4
    s_cbranch_scc1 LOADERS
    s_cmp_lg_u32 s30, 3
    s_cbranch_scc1 R_nl
    ds_read_b128 v[52:55], v72 offset:1536
    ds_read_b128 v[56:59], v72 offset:1552
    ds_read_b128 v[60:63], v72 offset:1568
    ds_read_b128 v[64:67], v72 offset:1584
    s_waitcnt lgkmcnt(0)
    v_pk_add_f32 v[52:53], v[52:53], v[54:55]
    v_pk_add_f32 v[56:57], v[56:57], v[58:59]
    v_pk_add_f32 v[60:61], v[60:61], v[62:63]
    v_pk_add_f32 v[64:65], v[64:65], v[66:67]
    v_pk_add_f32 v[52:53], v[52:53], v[56:57]
    v_pk_add_f32 v[60:61], v[60:61], v[64:65]
    v_pk_add_f32 v[52:53], v[52:53], v[60:61]
    v_mul_f32 v68, 0x3a800000, v52
    v_mul_f32 v70, 0x3a800000, v53
    v_fma_f32 v70, -v68, v68, v70
    v_max_f32 v70, 0, v70
    v_mov_b32 v32, v68
    v_mov_b32 v33, v70
    v_cvt_pk_bf16_f32 v68, v68, v68
    v_lshlrev_b32 v68, 16, v68
    v_cvt_pk_bf16_f32 v70, v70, v70
    v_lshlrev_b32 v70, 16, v70
    v_add_f32 v70, 0x3727c5ac, v70
    v_cvt_pk_bf16_f32 v70, v70, v70
    v_lshlrev_b32 v70, 16, v70
    v_sqrt_f32 v70, v70
    s_nop 0
    v_cvt_pk_bf16_f32 v70, v70, v70
    v_lshlrev_b32 v70, 16, v70
    v_rcp_f32 v69, v70
    v_sub_f32 v32, v32, v68
    v_mul_f32 v32, v32, v69
    v_mul_f32 v33, v33, v69
    v_mul_f32 v33, v33, v69
    v_cvt_pk_bf16_f32 v32, v32, v32
    v_lshlrev_b32 v32, 16, v32
    v_cvt_pk_bf16_f32 v33, v33, v33
    v_lshlrev_b32 v33, 16, v33
    v_add_f32 v33, 0x3727c5ac, v33
    v_cvt_pk_bf16_f32 v33, v33, v33
    v_lshlrev_b32 v33, 16, v33
    v_sqrt_f32 v33, v33
    s_nop 0
    v_cvt_pk_bf16_f32 v33, v33, v33
    v_lshlrev_b32 v33, 16, v33
    v_cvt_pk_bf16_f32 v28, v68, v70
    v_cvt_pk_bf16_f32 v30, v32, v33
    v_mov_b32 v29, s52
    v_mov_b32 v31, s52
    s_lshl_b32 s26, s60, 15
    s_add_u32 s26, s26, 23199744
    s_add_u32 s24, s4, s26
    s_addc_u32 s25, s5, 0
    s_mov_b32 s26, 32768
    s_mov_b32 s27, 0x20000
    s_lshl_b32 s36, s28, 4
    s_add_u32 s36, s36, s67
    s_lshl_b32 s36, s36, 7
    s_mov_b64 exec, 0xff
    buffer_store_dwordx4 v[28:31], v2, s[24:27], s36 offen sc1
    s_mov_b64 exec, -1
R_nl:
    v_mov_b32 v6, 1
    v_mov_b32 v7, 0
    s_cmp_eq_u32 s30, 3
    s_waitcnt vmcnt(1)
    s_cbranch_scc1 R_n2
    s_waitcnt vmcnt(0)
R_n2:
    s_barrier
    s_cmp_lg_u32 s30, 0
    s_cbranch_scc1 R_n3
    s_mov_b64 exec, 1
    buffer_atomic_add v6, v7, s[56:59], s55 offen sc1
    s_mov_b64 exec, -1
R_n3:
    ds_read_b64_tr_b16 v[180:181], v75 offset:49152
    ds_read_b64_tr_b16 v[182:183], v75 offset:51200
    ds_read_b64_tr_b16 v[188:189], v75 offset:53248
    ds_read_b64_tr_b16 v[190:191], v75 offset:55296
    ds_read_b64_tr_b16 v[196:197], v75 offset:57344
    ds_read_b64_tr_b16 v[198:199], v75 offset:59392
    ds_read_b64_tr_b16 v[204:205], v75 offset:61440
    ds_read_b64_tr_b16 v[206:207], v75 offset:63488
    ds_read_b64_tr_b16 v[244:245], v76 offset:16384
    ds_read_b64_tr_b16 v[246:247], v76 offset:18432
    ds_read_b64_tr_b16 v[252:253], v76 offset:20480
    ds_read_b64_tr_b16 v[254:255], v76 offset:22528
    ds_read_b64_tr_b16 v[212:213], v76 offset:0
    ds_read_b64_tr_b16 v[214:215], v76 offset:2048
    ds_read_b64_tr_b16 v[220:221], v76 offset:4096
    ds_read_b64_tr_b16 v[222:223], v76 offset:6144
    ds_read_b64_tr_b16 v[228:229], v76 offset:8192
    ds_read_b64_tr_b16 v[230:231], v76 offset:10240
    ds_read_b64_tr_b16 v[236:237], v76 offset:12288
    ds_read_b64_tr_b16 v[238:239], v76 offset:14336
    ds_read_b64_tr_b16 v[176:177], v74 offset:49152
    ds_read_b64_tr_b16 v[178:179], v74 offset:51200
    ds_read_b64_tr_b16 v[184:185], v74 offset:53248
    ds_read_b64_tr_b16 v[186:187], v74 offset:55296
    ds_read_b64_tr_b16 v[192:193], v74 offset:57344
    ds_read_b64_tr_b16 v[194:195], v74 offset:59392
    ds_read_b64_tr_b16 v[200:201], v74 offset:61440
    ds_read_b64_tr_b16 v[202:203], v74 offset:63488
    ds_read_b64_tr_b16 v[208:209], v75 offset:0
    ds_read_b64_tr_b16 v[210:211], v75 offset:2048
    ds_read_b64_tr_b16 v[216:217], v75 offset:4096
    ds_read_b64_tr_b16 v[218:219], v75 offset:6144
    ds_read_b64_tr_b16 v[224:225], v75 offset:8192
    ds_read_b64_tr_b16 v[226:227], v75 offset:10240
    ds_read_b64_tr_b16 v[232:233], v75 offset:12288
    ds_read_b64_tr_b16 v[234:235], v75 offset:14336
    ds_read_b64_tr_b16 v[128:129], v74 offset:24576
    ds_read_b64_tr_b16 v[130:131], v74 offset:26624
    ds_read_b64_tr_b16 v[136:137], v74 offset:28672
    ds_read_b64_tr_b16 v[138:139], v74 offset:30720
    v_and_b32 v8, 15, v1
    v_lshrrev_b32 v9, 4, v1
    v_xor_b32 v6, v9, v8
    v_lshlrev_b32 v7, 8, v8
    v_xor_b32 v10, 0, v6
    v_lshl_add_u32 v10, v10, 4, v7
    v_add_u32 v14, 106496, v10
    v_xor_b32 v11, 4, v6
    v_lshl_add_u32 v11, v11, 4, v7
    v_add_u32 v15, 106496, v11
    v_xor_b32 v12, 8, v6
    v_lshl_add_u32 v12, v12, 4, v7
    v_add_u32 v16, 106496, v12
    v_xor_b32 v13, 12, v6
    v_lshl_add_u32 v13, v13, 4, v7
    v_add_u32 v17, 106496, v13
    v_lshlrev_b32 v18, 4, v8
    v_add_u32 v18, 155648, v18
    s_add_u32 s16, s62, 0x400000
    s_addc_u32 s17, s63, 0
    s_mov_b32 s18, 0x7e000
    s_mov_b32 s19, 0x20000
    v_and_b32 v6, 1, v9
    v_lshlrev_b32 v114, 16, v6
    v_lshrrev_b32 v6, 1, v9
    v_lshl_add_u32 v114, v6, 8, v114
    v_lshl_add_u32 v114, v8, 4, v114
    s_bfe_u32 s36, s30, 0x10001
    s_lshl1_add_u32 s36, s29, s36
    s_xor_b32 s36, s36, 2
    s_lshr_b32 s53, s36, 3
    s_lshl_b32 s53, s53, 14
    s_and_b32 s39, s36, 7
    s_lshl_b32 s39, s39, 10
    s_add_u32 s39, s39, s53
    s_and_b32 s36, s30, 1
    s_lshl_b32 s36, s36, 9
    s_add_u32 s39, s39, s36
    s_and_b32 s8, s30, 3
    s_lshl_b32 s8, s8, 15
    s_and_b32 s53, s30, 2
    s_lshl_b32 s53, s53, 11
    s_and_b32 s12, s30, 1
    s_lshl_b32 s12, s12, 13
    s_add_u32 s12, s12, s53
    s_and_b32 s20, s30, 1
    s_lshl_b32 s20, s20, 8
    s_add_u32 s20, s20, s55
    s_add_u32 s21, s52, 16
    v_mov_b32 v112, 0x7f000000
    v_writelane_b32 v112, 0, 0
    v_mov_b32 v113, 1
    s_and_b32 s40, s30, 1
    s_lshl1_add_u32 s40, s31, s40
    s_lshl_b32 s40, s40, 7
    s_add_u32 s40, s40, s55
    v_mov_b32 v88, 0x3f803f80
    v_mov_b32 v89, 0x3f803f80
    v_mov_b32 v90, 0x3f803f80
    v_mov_b32 v91, 0x3f803f80
    s_waitcnt lgkmcnt(0)
    s_nop 0
    v_mfma_f32_16x16x32_bf16 v[84:87], v[180:183], v[88:91], 0
    v_mfma_f32_16x16x32_bf16 v[84:87], v[188:191], v[88:91], v[84:87]
    v_mfma_f32_16x16x32_bf16 v[84:87], v[196:199], v[88:91], v[84:87]
    v_mfma_f32_16x16x32_bf16 v[84:87], v[204:207], v[88:91], v[84:87]
    v_mfma_f32_16x16x32_bf16 v[84:87], v[244:247], v[88:91], v[84:87]
    v_mfma_f32_16x16x32_bf16 v[84:87], v[252:255], v[88:91], v[84:87]
    v_mfma_f32_16x16x32_bf16 v[84:87], v[212:215], v[88:91], v[84:87]
    v_mfma_f32_16x16x32_bf16 v[84:87], v[220:223], v[88:91], v[84:87]
    v_mfma_f32_16x16x32_bf16 v[84:87], v[228:231], v[88:91], v[84:87]
    v_mfma_f32_16x16x32_bf16 v[84:87], v[236:239], v[88:91], v[84:87]
    v_mfma_f32_16x16x32_bf16 v[84:87], v[176:179], v[88:91], v[84:87]
    v_mfma_f32_16x16x32_bf16 v[84:87], v[184:187], v[88:91], v[84:87]
    v_mfma_f32_16x16x32_bf16 v[84:87], v[192:195], v[88:91], v[84:87]
    v_mfma_f32_16x16x32_bf16 v[84:87], v[200:203], v[88:91], v[84:87]
    v_mfma_f32_16x16x32_bf16 v[84:87], v[208:211], v[88:91], v[84:87]
    v_mfma_f32_16x16x32_bf16 v[84:87], v[216:219], v[88:91], v[84:87]
    v_mfma_f32_16x16x32_bf16 v[84:87], v[224:227], v[88:91], v[84:87]
    v_mfma_f32_16x16x32_bf16 v[84:87], v[232:235], v[88:91], v[84:87]
    v_mfma_f32_16x16x32_bf16 v[84:87], v[128:131], v[88:91], v[84:87]
    v_mfma_f32_16x16x32_bf16 v[84:87], v[136:139], v[88:91], v[84:87]
    s_cmp_lg_u32 s30, 0
    s_cbranch_scc1 pdone_8
    s_add_u32 s54, s55, 0
    s_bitcmp1_b32 s29, 2
    s_cselect_b32 s53, s93, s92
    s_add_u32 s53, s53, s54
    v_mov_b32 v105, s54
    v_writelane_b32 v105, s53, 1
    s_mov_b32 s53, 0
    s_add_u32 s54, s52, 16
    s_bfm_b64 exec, 2, 0
poll_9:
    buffer_load_dword v104, v105, s[56:59], 0 offen sc1
    s_waitcnt vmcnt(0)
    v_cmp_eq_u32 vcc, s54, v104
    s_nop 0
    s_cmp_eq_u64 vcc, exec
    s_cbranch_scc1 pok_10
    s_sleep 3
    s_add_u32 s53, s53, 1
    s_cmp_lt_u32 s53, s61
    s_cbranch_scc1 poll_9
    s_mov_b32 s61, 0
pok_10:
    s_mov_b64 exec, -1
pdone_8:
    s_waitcnt lgkmcnt(0)
    s_barrier
    ds_read_b64_tr_b16 v[240:241], v75 offset:16384
    ds_read_b64_tr_b16 v[242:243], v75 offset:18432
    ds_read_b64_tr_b16 v[248:249], v75 offset:20480
    ds_read_b64_tr_b16 v[250:251], v75 offset:22528
    ds_read_b64_tr_b16 v[132:133], v75 offset:24576
    ds_read_b64_tr_b16 v[134:135], v75 offset:26624
    ds_read_b64_tr_b16 v[140:141], v75 offset:28672
    ds_read_b64_tr_b16 v[142:143], v75 offset:30720
    ds_read_b64_tr_b16 v[144:145], v74 offset:32768
    ds_read_b64_tr_b16 v[146:147], v74 offset:34816
    ds_read_b64_tr_b16 v[152:153], v74 offset:36864
    ds_read_b64_tr_b16 v[154:155], v74 offset:38912
    ds_read_b64_tr_b16 v[160:161], v74 offset:40960
    ds_read_b64_tr_b16 v[162:163], v74 offset:43008
    ds_read_b64_tr_b16 v[168:169], v74 offset:45056
    ds_read_b64_tr_b16 v[170:171], v74 offset:47104
    ds_read_b64_tr_b16 v[148:149], v75 offset:32768
    ds_read_b64_tr_b16 v[150:151], v75 offset:34816
    ds_read_b64_tr_b16 v[156:157], v75 offset:36864
    ds_read_b64_tr_b16 v[158:159], v75 offset:38912
    ds_read_b64_tr_b16 v[164:165], v75 offset:40960
    ds_read_b64_tr_b16 v[166:167], v75 offset:43008
    ds_read_b64_tr_b16 v[172:173], v75 offset:45056
    ds_read_b64_tr_b16 v[174:175], v75 offset:47104
    s_waitcnt lgkmcnt(12)
    v_mfma_f32_16x16x32_bf16 v[84:87], v[240:243], v[88:91], v[84:87]
    v_mfma_f32_16x16x32_bf16 v[84:87], v[248:251], v[88:91], v[84:87]
    v_mfma_f32_16x16x32_bf16 v[84:87], v[132:135], v[88:91], v[84:87]
    v_mfma_f32_16x16x32_bf16 v[84:87], v[140:143], v[88:91], v[84:87]
    v_mfma_f32_16x16x32_bf16 v[84:87], v[144:147], v[88:91], v[84:87]
    v_mfma_f32_16x16x32_bf16 v[84:87], v[152:155], v[88:91], v[84:87]
    s_waitcnt lgkmcnt(0)
    v_mfma_f32_16x16x32_bf16 v[84:87], v[160:163], v[88:91], v[84:87]
    v_mfma_f32_16x16x32_bf16 v[84:87], v[168:171], v[88:91], v[84:87]
    v_mfma_f32_16x16x32_bf16 v[84:87], v[148:151], v[88:91], v[84:87]
    v_mfma_f32_16x16x32_bf16 v[84:87], v[156:159], v[88:91], v[84:87]
    v_mfma_f32_16x16x32_bf16 v[84:87], v[164:167], v[88:91], v[84:87]
    v_mfma_f32_16x16x32_bf16 v[84:87], v[172:175], v[88:91], v[84:87]
    s_barrier
    ds_read_b128 v[36:39], v14 offset:16384
    ds_read_b128 v[40:43], v14 offset:20480
    ds_read_b128 v[44:47], v14 offset:24576
    ds_read_b128 v[48:51], v14 offset:28672
    ds_read_b128 v[52:55], v15 offset:16384
    ds_read_b128 v[56:59], v15 offset:20480
    ds_read_b128 v[60:63], v15 offset:24576
    ds_read_b128 v[64:67], v15 offset:28672
    s_waitcnt lgkmcnt(4)
    v_mfma_f32_16x16x32_bf16 v[20:23], v[128:131], v[36:39], 0
    ds_read_b128 v[68:71], v16 offset:16384
    v_mfma_f32_16x16x32_bf16 v[24:27], v[128:131], v[40:43], 0
    ds_read_b128 v[72:75], v16 offset:20480
    v_mfma_f32_16x16x32_bf16 v[24:27], v[132:135], v[48:51], v[24:27]
    ds_read_b128 v[76:79], v16 offset:24576
    v_mfma_f32_16x16x32_bf16 v[20:23], v[132:135], v[44:47], v[20:23]
    ds_read_b128 v[80:83], v16 offset:28672
    s_waitcnt lgkmcnt(4)
    v_mfma_f32_16x16x32_bf16 v[20:23], v[136:139], v[52:55], v[20:23]
    ds_read_b128 v[36:39], v17 offset:16384
    v_mfma_f32_16x16x32_bf16 v[24:27], v[136:139], v[56:59], v[24:27]
    ds_read_b128 v[40:43], v17 offset:20480
    v_mfma_f32_16x16x32_bf16 v[24:27], v[140:143], v[64:67], v[24:27]
    ds_read_b128 v[44:47], v17 offset:24576
    v_mfma_f32_16x16x32_bf16 v[20:23], v[140:143], v[60:63], v[20:23]
    ds_read_b128 v[48:51], v17 offset:28672
    s_barrier
    s_waitcnt lgkmcnt(4)
    v_mfma_f32_16x16x32_bf16 v[20:23], v[144:147], v[68:71], v[20:23]
    ds_read_b128 v[52:55], v14 offset:32768
    v_mfma_f32_16x16x32_bf16 v[24:27], v[144:147], v[72:75], v[24:27]
    ds_read_b128 v[56:59], v14 offset:36864
    v_mfma_f32_16x16x32_bf16 v[24:27], v[148:151], v[80:83], v[24:27]
    ds_read_b128 v[60:63], v14 offset:40960
    v_mfma_f32_16x16x32_bf16 v[20:23], v[148:151], v[76:79], v[20:23]
    ds_read_b128 v[64:67], v14 offset:45056
    s_waitcnt lgkmcnt(4)
    v_mfma_f32_16x16x32_bf16 v[20:23], v[152:155], v[36:39], v[20:23]
    ds_read_b128 v[68:71], v15 offset:32768
    v_mfma_f32_16x16x32_bf16 v[24:27], v[152:155], v[40:43], v[24:27]
    ds_read_b128 v[72:75], v15 offset:36864
    v_mfma_f32_16x16x32_bf16 v[24:27], v[156:159], v[48:51], v[24:27]
    ds_read_b128 v[76:79], v15 offset:40960
    v_mfma_f32_16x16x32_bf16 v[20:23], v[156:159], v[44:47], v[20:23]
    ds_read_b128 v[80:83], v15 offset:45056
    s_waitcnt lgkmcnt(4)
    v_mfma_f32_16x16x32_bf16 v[20:23], v[160:163], v[52:55], v[20:23]
    ds_read_b128 v[36:39], v16 offset:32768
    v_mfma_f32_16x16x32_bf16 v[24:27], v[160:163], v[56:59], v[24:27]
    ds_read_b128 v[40:43], v16 offset:36864
    v_mfma_f32_16x16x32_bf16 v[24:27], v[164:167], v[64:67], v[24:27]
    ds_read_b128 v[44:47], v16 offset:40960
    v_mfma_f32_16x16x32_bf16 v[20:23], v[164:167], v[60:63], v[20:23]
    ds_read_b128 v[48:51], v16 offset:45056
    s_waitcnt lgkmcnt(4)
    v_mfma_f32_16x16x32_bf16 v[20:23], v[168:171], v[68:71], v[20:23]
    ds_read_b128 v[52:55], v17 offset:32768
    v_mfma_f32_16x16x32_bf16 v[24:27], v[168:171], v[72:75], v[24:27]
    ds_read_b128 v[56:59], v17 offset:36864
    v_mfma_f32_16x16x32_bf16 v[24:27], v[172:175], v[80:83], v[24:27]
    ds_read_b128 v[60:63], v17 offset:40960
    v_mfma_f32_16x16x32_bf16 v[20:23], v[172:175], v[76:79], v[20:23]
    ds_read_b128 v[64:67], v17 offset:45056
    s_barrier
    s_waitcnt lgkmcnt(4)
    v_mfma_f32_16x16x32_bf16 v[20:23], v[176:179], v[36:39], v[20:23]
    ds_read_b128 v[68:71], v10 offset:16384
    v_mfma_f32_16x16x32_bf16 v[24:27], v[176:179], v[40:43], v[24:27]
    ds_read_b128 v[72:75], v10 offset:20480
    v_mfma_f32_16x16x32_bf16 v[24:27], v[180:183], v[48:51], v[24:27]
    ds_read_b128 v[76:79], v10 offset:24576
    v_mfma_f32_16x16x32_bf16 v[20:23], v[180:183], v[44:47], v[20:23]
    ds_read_b128 v[80:83], v10 offset:28672
    s_waitcnt lgkmcnt(4)
    v_mfma_f32_16x16x32_bf16 v[20:23], v[184:187], v[52:55], v[20:23]
    ds_read_b128 v[36:39], v11 offset:16384
    v_mfma_f32_16x16x32_bf16 v[24:27], v[184:187], v[56:59], v[24:27]
    ds_read_b128 v[40:43], v11 offset:20480
    v_mfma_f32_16x16x32_bf16 v[24:27], v[188:191], v[64:67], v[24:27]
    ds_read_b128 v[44:47], v11 offset:24576
    v_mfma_f32_16x16x32_bf16 v[20:23], v[188:191], v[60:63], v[20:23]
    ds_read_b128 v[48:51], v11 offset:28672
    s_waitcnt lgkmcnt(4)
    v_mfma_f32_16x16x32_bf16 v[20:23], v[192:195], v[68:71], v[20:23]
    ds_read_b128 v[52:55], v12 offset:16384
    v_mfma_f32_16x16x32_bf16 v[24:27], v[192:195], v[72:75], v[24:27]
    ds_read_b128 v[56:59], v12 offset:20480
    v_mfma_f32_16x16x32_bf16 v[24:27], v[196:199], v[80:83], v[24:27]
    ds_read_b128 v[60:63], v12 offset:24576
    v_mfma_f32_16x16x32_bf16 v[20:23], v[196:199], v[76:79], v[20:23]
    ds_read_b128 v[64:67], v12 offset:28672
    s_waitcnt lgkmcnt(4)
    v_mfma_f32_16x16x32_bf16 v[20:23], v[200:203], v[36:39], v[20:23]
    ds_read_b128 v[68:71], v13 offset:16384
    v_mfma_f32_16x16x32_bf16 v[24:27], v[200:203], v[40:43], v[24:27]
    ds_read_b128 v[72:75], v13 offset:20480
    v_mfma_f32_16x16x32_bf16 v[24:27], v[204:207], v[48:51], v[24:27]
    ds_read_b128 v[76:79], v13 offset:24576
    v_mfma_f32_16x16x32_bf16 v[20:23], v[204:207], v[44:47], v[20:23]
    ds_read_b128 v[80:83], v13 offset:28672
    s_barrier
    s_waitcnt lgkmcnt(4)
    v_mfma_f32_16x16x32_bf16 v[20:23], v[208:211], v[52:55], v[20:23]
    ds_read_b128 v[36:39], v10 offset:32768
    v_mfma_f32_16x16x32_bf16 v[24:27], v[208:211], v[56:59], v[24:27]
    ds_read_b128 v[40:43], v10 offset:36864
    v_mfma_f32_16x16x32_bf16 v[24:27], v[212:215], v[64:67], v[24:27]
    ds_read_b128 v[44:47], v10 offset:40960
    v_mfma_f32_16x16x32_bf16 v[20:23], v[212:215], v[60:63], v[20:23]
    ds_read_b128 v[48:51], v10 offset:45056
    s_waitcnt lgkmcnt(4)
    v_mfma_f32_16x16x32_bf16 v[20:23], v[216:219], v[68:71], v[20:23]
    ds_read_b128 v[52:55], v11 offset:32768
    v_mfma_f32_16x16x32_bf16 v[24:27], v[216:219], v[72:75], v[24:27]
    ds_read_b128 v[56:59], v11 offset:36864
    v_mfma_f32_16x16x32_bf16 v[24:27], v[220:223], v[80:83], v[24:27]
    ds_read_b128 v[60:63], v11 offset:40960
    v_mfma_f32_16x16x32_bf16 v[20:23], v[220:223], v[76:79], v[20:23]
    ds_read_b128 v[64:67], v11 offset:45056
    s_waitcnt lgkmcnt(4)
    v_mfma_f32_16x16x32_bf16 v[20:23], v[224:227], v[36:39], v[20:23]
    ds_read_b128 v[68:71], v12 offset:32768
    v_mfma_f32_16x16x32_bf16 v[24:27], v[224:227], v[40:43], v[24:27]
    ds_read_b128 v[72:75], v12 offset:36864
    v_mfma_f32_16x16x32_bf16 v[24:27], v[228:231], v[48:51], v[24:27]
    ds_read_b128 v[76:79], v12 offset:40960
    v_mfma_f32_16x16x32_bf16 v[20:23], v[228:231], v[44:47], v[20:23]
    ds_read_b128 v[80:83], v12 offset:45056
    s_waitcnt lgkmcnt(4)
    v_mfma_f32_16x16x32_bf16 v[20:23], v[232:235], v[52:55], v[20:23]
    ds_read_b128 v[36:39], v13 offset:32768
    v_mfma_f32_16x16x32_bf16 v[24:27], v[232:235], v[56:59], v[24:27]
    ds_read_b128 v[40:43], v13 offset:36864
    v_mfma_f32_16x16x32_bf16 v[24:27], v[236:239], v[64:67], v[24:27]
    ds_read_b128 v[44:47], v13 offset:40960
    v_mfma_f32_16x16x32_bf16 v[20:23], v[236:239], v[60:63], v[20:23]
    ds_read_b128 v[48:51], v13 offset:45056
    s_barrier
    ds_read_b128 v[88:91], v18 offset:0
    ds_read_b128 v[92:95], v18 offset:2048
    ds_read_b128 v[96:99], v18 offset:256
    ds_read_b128 v[100:103], v18 offset:2304
    s_waitcnt lgkmcnt(8)
    v_mfma_f32_16x16x32_bf16 v[20:23], v[240:243], v[68:71], v[20:23]
    ds_read_b128 v[52:55], v14 offset:0
    v_mfma_f32_16x16x32_bf16 v[24:27], v[240:243], v[72:75], v[24:27]
    ds_read_b128 v[56:59], v14 offset:4096
    v_mfma_f32_16x16x32_bf16 v[24:27], v[244:247], v[80:83], v[24:27]
    ds_read_b128 v[60:63], v14 offset:8192
    v_mfma_f32_16x16x32_bf16 v[20:23], v[244:247], v[76:79], v[20:23]
    ds_read_b128 v[64:67], v14 offset:12288
    s_waitcnt lgkmcnt(8)
    v_mfma_f32_16x16x32_bf16 v[20:23], v[248:251], v[36:39], v[20:23]
    ds_read_b128 v[68:71], v15 offset:0
    v_mfma_f32_16x16x32_bf16 v[24:27], v[248:251], v[40:43], v[24:27]
    ds_read_b128 v[72:75], v15 offset:4096
    v_mfma_f32_16x16x32_bf16 v[24:27], v[252:255], v[48:51], v[24:27]
    ds_read_b128 v[76:79], v15 offset:8192
    v_mfma_f32_16x16x32_bf16 v[20:23], v[252:255], v[44:47], v[20:23]
    ds_read_b128 v[80:83], v15 offset:12288
    s_waitcnt lgkmcnt(4)
    v_mfma_f32_16x16x32_bf16 v[28:31], v[128:131], v[52:55], 0
    ds_read_b128 v[36:39], v16 offset:0
    v_mfma_f32_16x16x32_bf16 v[32:35], v[128:131], v[56:59], 0
    ds_read_b128 v[40:43], v16 offset:4096
    v_mfma_f32_16x16x32_bf16 v[32:35], v[132:135], v[64:67], v[32:35]
    ds_read_b128 v[44:47], v16 offset:8192
    v_mfma_f32_16x16x32_bf16 v[28:31], v[132:135], v[60:63], v[28:31]
    ds_read_b128 v[48:51], v16 offset:12288
    v_pk_fma_f32 v[20:21], v[88:89], v[84:85], v[20:21]
    v_pk_fma_f32 v[22:23], v[88:89], v[86:87], v[22:23]
    v_pk_fma_f32 v[24:25], v[96:97], v[84:85], v[24:25]
    v_pk_fma_f32 v[26:27], v[96:97], v[86:87], v[26:27]
    v_pk_mul_f32 v[104:105], v[20:21], v[20:21]
    v_pk_mul_f32 v[106:107], v[22:23], v[22:23]
    v_pk_mul_f32 v[108:109], v[24:25], v[24:25]
    v_pk_mul_f32 v[110:111], v[26:27], v[26:27]
    v_pk_fma_f32 v[104:105], v[104:105], v[92:93], v[90:91]
    v_pk_fma_f32 v[106:107], v[106:107], v[92:93], v[90:91]
    v_pk_fma_f32 v[108:109], v[108:109], v[100:101], v[98:99]
    v_pk_fma_f32 v[110:111], v[110:111], v[100:101], v[98:99]
    v_pk_mul_f32 v[104:105], v[104:105], v[20:21]
    v_pk_mul_f32 v[106:107], v[106:107], v[22:23]
    v_pk_mul_f32 v[108:109], v[108:109], v[24:25]
    v_pk_mul_f32 v[110:111], v[110:111], v[26:27]
    v_exp_f32 v104, v104
    v_exp_f32 v105, v105
    v_exp_f32 v106, v106
    v_exp_f32 v107, v107
    v_exp_f32 v108, v108
    v_exp_f32 v109, v109
    v_exp_f32 v110, v110
    v_exp_f32 v111, v111
    v_pk_fma_f32 v[104:105], v[104:105], v[94:95], v[94:95]
    v_pk_fma_f32 v[106:107], v[106:107], v[94:95], v[94:95]
    v_pk_fma_f32 v[108:109], v[108:109], v[102:103], v[102:103]
    v_pk_fma_f32 v[110:111], v[110:111], v[102:103], v[102:103]
    v_rcp_f32 v104, v104
    v_rcp_f32 v105, v105
    v_rcp_f32 v106, v106
    v_rcp_f32 v107, v107
    v_rcp_f32 v108, v108
    v_rcp_f32 v109, v109
    v_rcp_f32 v110, v110
    v_rcp_f32 v111, v111
    v_pk_mul_f32 v[20:21], v[20:21], v[104:105]
    v_pk_mul_f32 v[22:23], v[22:23], v[106:107]
    v_pk_mul_f32 v[24:25], v[24:25], v[108:109]
    v_pk_mul_f32 v[26:27], v[26:27], v[110:111]
    v_add_u32 v20, 0x10000, v20
    v_add_u32 v22, 0x10000, v22
    v_add_u32 v24, 0x10000, v24
    v_add_u32 v26, 0x10000, v26
    v_and_b32 v20, 0xfffe0000, v20
    v_and_b32 v22, 0xfffe0000, v22
    v_and_b32 v24, 0xfffe0000, v24
    v_and_b32 v26, 0xfffe0000, v26
    v_cvt_pk_bf16_f32 v104, v20, v21
    v_cvt_pk_bf16_f32 v105, v22, v23
    v_cvt_pk_bf16_f32 v106, v24, v25
    v_cvt_pk_bf16_f32 v107, v26, v27
    s_add_u32 s36, s39, 0
    v_permlane16_swap_b32 v104, v106
    v_permlane16_swap_b32 v105, v107
    buffer_store_dwordx4 v[104:107], v114, s[16:19], s36 offen sc1
    s_waitcnt lgkmcnt(4)
    v_mfma_f32_16x16x32_bf16 v[28:31], v[136:139], v[68:71], v[28:31]
    ds_read_b128 v[52:55], v17 offset:0
    v_mfma_f32_16x16x32_bf16 v[32:35], v[136:139], v[72:75], v[32:35]
    ds_read_b128 v[56:59], v17 offset:4096
    v_mfma_f32_16x16x32_bf16 v[32:35], v[140:143], v[80:83], v[32:35]
    ds_read_b128 v[60:63], v17 offset:8192
    v_mfma_f32_16x16x32_bf16 v[28:31], v[140:143], v[76:79], v[28:31]
    ds_read_b128 v[64:67], v17 offset:12288
    s_barrier
    s_waitcnt lgkmcnt(4)
    v_mfma_f32_16x16x32_bf16 v[28:31], v[144:147], v[36:39], v[28:31]
    ds_read_b128 v[68:71], v14 offset:16384
    v_mfma_f32_16x16x32_bf16 v[32:35], v[144:147], v[40:43], v[32:35]
    ds_read_b128 v[72:75], v14 offset:20480
    v_mfma_f32_16x16x32_bf16 v[32:35], v[148:151], v[48:51], v[32:35]
    ds_read_b128 v[76:79], v14 offset:24576
    v_mfma_f32_16x16x32_bf16 v[28:31], v[148:151], v[44:47], v[28:31]
    ds_read_b128 v[80:83], v14 offset:28672
    s_waitcnt lgkmcnt(4)
    v_mfma_f32_16x16x32_bf16 v[28:31], v[152:155], v[52:55], v[28:31]
    ds_read_b128 v[36:39], v15 offset:16384
    v_mfma_f32_16x16x32_bf16 v[32:35], v[152:155], v[56:59], v[32:35]
    ds_read_b128 v[40:43], v15 offset:20480
    v_mfma_f32_16x16x32_bf16 v[32:35], v[156:159], v[64:67], v[32:35]
    ds_read_b128 v[44:47], v15 offset:24576
    v_mfma_f32_16x16x32_bf16 v[28:31], v[156:159], v[60:63], v[28:31]
    ds_read_b128 v[48:51], v15 offset:28672
    s_waitcnt lgkmcnt(4)
    v_mfma_f32_16x16x32_bf16 v[28:31], v[160:163], v[68:71], v[28:31]
    ds_read_b128 v[52:55], v16 offset:16384
    v_mfma_f32_16x16x32_bf16 v[32:35], v[160:163], v[72:75], v[32:35]
    ds_read_b128 v[56:59], v16 offset:20480
    v_mfma_f32_16x16x32_bf16 v[32:35], v[164:167], v[80:83], v[32:35]
    ds_read_b128 v[60:63], v16 offset:24576
    v_mfma_f32_16x16x32_bf16 v[28:31], v[164:167], v[76:79], v[28:31]
    ds_read_b128 v[64:67], v16 offset:28672
    s_waitcnt lgkmcnt(4)
    v_mfma_f32_16x16x32_bf16 v[28:31], v[168:171], v[36:39], v[28:31]
    ds_read_b128 v[68:71], v17 offset:16384
    v_mfma_f32_16x16x32_bf16 v[32:35], v[168:171], v[40:43], v[32:35]
    ds_read_b128 v[72:75], v17 offset:20480
    v_mfma_f32_16x16x32_bf16 v[32:35], v[172:175], v[48:51], v[32:35]
    ds_read_b128 v[76:79], v17 offset:24576
    v_mfma_f32_16x16x32_bf16 v[28:31], v[172:175], v[44:47], v[28:31]
    ds_read_b128 v[80:83], v17 offset:28672
    s_barrier
    s_waitcnt lgkmcnt(4)
    v_mfma_f32_16x16x32_bf16 v[28:31], v[176:179], v[52:55], v[28:31]
    ds_read_b128 v[36:39], v14 offset:32768
    v_mfma_f32_16x16x32_bf16 v[32:35], v[176:179], v[56:59], v[32:35]
    ds_read_b128 v[40:43], v14 offset:36864
    v_mfma_f32_16x16x32_bf16 v[32:35], v[180:183], v[64:67], v[32:35]
    ds_read_b128 v[44:47], v14 offset:40960
    v_mfma_f32_16x16x32_bf16 v[28:31], v[180:183], v[60:63], v[28:31]
    ds_read_b128 v[48:51], v14 offset:45056
    s_waitcnt lgkmcnt(4)
    v_mfma_f32_16x16x32_bf16 v[28:31], v[184:187], v[68:71], v[28:31]
    ds_read_b128 v[52:55], v15 offset:32768
    v_mfma_f32_16x16x32_bf16 v[32:35], v[184:187], v[72:75], v[32:35]
    ds_read_b128 v[56:59], v15 offset:36864
    v_mfma_f32_16x16x32_bf16 v[32:35], v[188:191], v[80:83], v[32:35]
    ds_read_b128 v[60:63], v15 offset:40960
    v_mfma_f32_16x16x32_bf16 v[28:31], v[188:191], v[76:79], v[28:31]
    ds_read_b128 v[64:67], v15 offset:45056
    s_waitcnt lgkmcnt(4)
    v_mfma_f32_16x16x32_bf16 v[28:31], v[192:195], v[36:39], v[28:31]
    ds_read_b128 v[68:71], v16 offset:32768
    v_mfma_f32_16x16x32_bf16 v[32:35], v[192:195], v[40:43], v[32:35]
    ds_read_b128 v[72:75], v16 offset:36864
    v_mfma_f32_16x16x32_bf16 v[32:35], v[196:199], v[48:51], v[32:35]
    ds_read_b128 v[76:79], v16 offset:40960
    v_mfma_f32_16x16x32_bf16 v[28:31], v[196:199], v[44:47], v[28:31]
    ds_read_b128 v[80:83], v16 offset:45056
    s_waitcnt lgkmcnt(4)
    v_mfma_f32_16x16x32_bf16 v[28:31], v[200:203], v[52:55], v[28:31]
    ds_read_b128 v[36:39], v17 offset:32768
    v_mfma_f32_16x16x32_bf16 v[32:35], v[200:203], v[56:59], v[32:35]
    ds_read_b128 v[40:43], v17 offset:36864
    v_mfma_f32_16x16x32_bf16 v[32:35], v[204:207], v[64:67], v[32:35]
    ds_read_b128 v[44:47], v17 offset:40960
    v_mfma_f32_16x16x32_bf16 v[28:31], v[204:207], v[60:63], v[28:31]
    ds_read_b128 v[48:51], v17 offset:45056
    s_barrier
    s_waitcnt lgkmcnt(4)
    v_mfma_f32_16x16x32_bf16 v[28:31], v[208:211], v[68:71], v[28:31]
    ds_read_b128 v[52:55], v10 offset:16384
    v_mfma_f32_16x16x32_bf16 v[32:35], v[208:211], v[72:75], v[32:35]
    ds_read_b128 v[56:59], v10 offset:20480
    v_mfma_f32_16x16x32_bf16 v[32:35], v[212:215], v[80:83], v[32:35]
    ds_read_b128 v[60:63], v10 offset:24576
    v_mfma_f32_16x16x32_bf16 v[28:31], v[212:215], v[76:79], v[28:31]
    ds_read_b128 v[64:67], v10 offset:28672
    s_waitcnt lgkmcnt(4)
    v_mfma_f32_16x16x32_bf16 v[28:31], v[216:219], v[36:39], v[28:31]
    ds_read_b128 v[68:71], v11 offset:16384
    v_mfma_f32_16x16x32_bf16 v[32:35], v[216:219], v[40:43], v[32:35]
    ds_read_b128 v[72:75], v11 offset:20480
    v_mfma_f32_16x16x32_bf16 v[32:35], v[220:223], v[48:51], v[32:35]
    ds_read_b128 v[76:79], v11 offset:24576
    v_mfma_f32_16x16x32_bf16 v[28:31], v[220:223], v[44:47], v[28:31]
    ds_read_b128 v[80:83], v11 offset:28672
    s_waitcnt lgkmcnt(4)
    v_mfma_f32_16x16x32_bf16 v[28:31], v[224:227], v[52:55], v[28:31]
    ds_read_b128 v[36:39], v12 offset:16384
    v_mfma_f32_16x16x32_bf16 v[32:35], v[224:227], v[56:59], v[32:35]
    ds_read_b128 v[40:43], v12 offset:20480
    v_mfma_f32_16x16x32_bf16 v[32:35], v[228:231], v[64:67], v[32:35]
    ds_read_b128 v[44:47], v12 offset:24576
    v_mfma_f32_16x16x32_bf16 v[28:31], v[228:231], v[60:63], v[28:31]
    ds_read_b128 v[48:51], v12 offset:28672
    s_waitcnt lgkmcnt(4)
    v_mfma_f32_16x16x32_bf16 v[28:31], v[232:235], v[68:71], v[28:31]
    ds_read_b128 v[52:55], v13 offset:16384
    v_mfma_f32_16x16x32_bf16 v[32:35], v[232:235], v[72:75], v[32:35]
    ds_read_b128 v[56:59], v13 offset:20480
    v_mfma_f32_16x16x32_bf16 v[32:35], v[236:239], v[80:83], v[32:35]
    ds_read_b128 v[60:63], v13 offset:24576
    v_mfma_f32_16x16x32_bf16 v[28:31], v[236:239], v[76:79], v[28:31]
    ds_read_b128 v[64:67], v13 offset:28672
    s_barrier
    ds_read_b128 v[88:91], v18 offset:512
    ds_read_b128 v[92:95], v18 offset:2560
    ds_read_b128 v[96:99], v18 offset:768
    ds_read_b128 v[100:103], v18 offset:2816
    s_waitcnt vmcnt(0)
    buffer_atomic_add v113, v112, s[56:59], s40 offen offset:2048 sc1
    s_waitcnt lgkmcnt(8)
    v_mfma_f32_16x16x32_bf16 v[28:31], v[240:243], v[36:39], v[28:31]
    ds_read_b128 v[68:71], v10 offset:32768
    v_mfma_f32_16x16x32_bf16 v[32:35], v[240:243], v[40:43], v[32:35]
    ds_read_b128 v[72:75], v10 offset:36864
    v_mfma_f32_16x16x32_bf16 v[32:35], v[244:247], v[48:51], v[32:35]
    ds_read_b128 v[76:79], v10 offset:40960
    v_mfma_f32_16x16x32_bf16 v[28:31], v[244:247], v[44:47], v[28:31]
    ds_read_b128 v[80:83], v10 offset:45056
    s_waitcnt lgkmcnt(8)
    v_mfma_f32_16x16x32_bf16 v[28:31], v[248:251], v[52:55], v[28:31]
    ds_read_b128 v[36:39], v11 offset:32768
    v_mfma_f32_16x16x32_bf16 v[32:35], v[248:251], v[56:59], v[32:35]
    ds_read_b128 v[40:43], v11 offset:36864
    v_mfma_f32_16x16x32_bf16 v[32:35], v[252:255], v[64:67], v[32:35]
    ds_read_b128 v[44:47], v11 offset:40960
    v_mfma_f32_16x16x32_bf16 v[28:31], v[252:255], v[60:63], v[28:31]
    ds_read_b128 v[48:51], v11 offset:45056
    s_waitcnt lgkmcnt(4)
    v_mfma_f32_16x16x32_bf16 v[20:23], v[128:131], v[68:71], 0
    ds_read_b128 v[52:55], v12 offset:32768
    v_mfma_f32_16x16x32_bf16 v[24:27], v[128:131], v[72:75], 0
    ds_read_b128 v[56:59], v12 offset:36864
    v_mfma_f32_16x16x32_bf16 v[24:27], v[132:135], v[80:83], v[24:27]
    ds_read_b128 v[60:63], v12 offset:40960
    v_mfma_f32_16x16x32_bf16 v[20:23], v[132:135], v[76:79], v[20:23]
    ds_read_b128 v[64:67], v12 offset:45056
    v_pk_fma_f32 v[28:29], v[88:89], v[84:85], v[28:29]
    v_pk_fma_f32 v[30:31], v[88:89], v[86:87], v[30:31]
    v_pk_fma_f32 v[32:33], v[96:97], v[84:85], v[32:33]
    v_pk_fma_f32 v[34:35], v[96:97], v[86:87], v[34:35]
    v_pk_mul_f32 v[104:105], v[28:29], v[28:29]
    v_pk_mul_f32 v[106:107], v[30:31], v[30:31]
    v_pk_mul_f32 v[108:109], v[32:33], v[32:33]
    v_pk_mul_f32 v[110:111], v[34:35], v[34:35]
    v_pk_fma_f32 v[104:105], v[104:105], v[92:93], v[90:91]
    v_pk_fma_f32 v[106:107], v[106:107], v[92:93], v[90:91]
    v_pk_fma_f32 v[108:109], v[108:109], v[100:101], v[98:99]
    v_pk_fma_f32 v[110:111], v[110:111], v[100:101], v[98:99]
    v_pk_mul_f32 v[104:105], v[104:105], v[28:29]
    v_pk_mul_f32 v[106:107], v[106:107], v[30:31]
    v_pk_mul_f32 v[108:109], v[108:109], v[32:33]
    v_pk_mul_f32 v[110:111], v[110:111], v[34:35]
    v_exp_f32 v104, v104
    v_exp_f32 v105, v105
    v_exp_f32 v106, v106
    v_exp_f32 v107, v107
    v_exp_f32 v108, v108
    v_exp_f32 v109, v109
    v_exp_f32 v110, v110
    v_exp_f32 v111, v111
    v_pk_fma_f32 v[104:105], v[104:105], v[94:95], v[94:95]
    v_pk_fma_f32 v[106:107], v[106:107], v[94:95], v[94:95]
    v_pk_fma_f32 v[108:109], v[108:109], v[102:103], v[102:103]
    v_pk_fma_f32 v[110:111], v[110:111], v[102:103], v[102:103]
    v_rcp_f32 v104, v104
    v_rcp_f32 v105, v105
    v_rcp_f32 v106, v106
    v_rcp_f32 v107, v107
    v_rcp_f32 v108, v108
    v_rcp_f32 v109, v109
    v_rcp_f32 v110, v110
    v_rcp_f32 v111, v111
    v_pk_mul_f32 v[28:29], v[28:29], v[104:105]
    v_pk_mul_f32 v[30:31], v[30:31], v[106:107]
    v_pk_mul_f32 v[32:33], v[32:33], v[108:109]
    v_pk_mul_f32 v[34:35], v[34:35], v[110:111]
    v_add_u32 v28, 0x10000, v28
    v_add_u32 v30, 0x10000, v30
    v_add_u32 v32, 0x10000, v32
    v_add_u32 v34, 0x10000, v34
    v_and_b32 v28, 0xfffe0000, v28
    v_and_b32 v30, 0xfffe0000, v30
    v_and_b32 v32, 0xfffe0000, v32
    v_and_b32 v34, 0xfffe0000, v34
    v_cvt_pk_bf16_f32 v104, v28, v29
    v_cvt_pk_bf16_f32 v105, v30, v31
    v_cvt_pk_bf16_f32 v106, v32, v33
    v_cvt_pk_bf16_f32 v107, v34, v35
    s_add_u32 s36, s39, 131072
    v_permlane16_swap_b32 v104, v106
    v_permlane16_swap_b32 v105, v107
    buffer_store_dwordx4 v[104:107], v114, s[16:19], s36 offen sc1
    s_waitcnt lgkmcnt(4)
    v_mfma_f32_16x16x32_bf16 v[20:23], v[136:139], v[36:39], v[20:23]
    ds_read_b128 v[68:71], v13 offset:32768
    v_mfma_f32_16x16x32_bf16 v[24:27], v[136:139], v[40:43], v[24:27]
    ds_read_b128 v[72:75], v13 offset:36864
    v_mfma_f32_16x16x32_bf16 v[24:27], v[140:143], v[48:51], v[24:27]
    ds_read_b128 v[76:79], v13 offset:40960
    v_mfma_f32_16x16x32_bf16 v[20:23], v[140:143], v[44:47], v[20:23]
    ds_read_b128 v[80:83], v13 offset:45056
    s_barrier
    s_waitcnt lgkmcnt(4)
    v_mfma_f32_16x16x32_bf16 v[20:23], v[144:147], v[52:55], v[20:23]
    ds_read_b128 v[36:39], v14 offset:0
    v_mfma_f32_16x16x32_bf16 v[24:27], v[144:147], v[56:59], v[24:27]
    ds_read_b128 v[40:43], v14 offset:4096
    v_mfma_f32_16x16x32_bf16 v[24:27], v[148:151], v[64:67], v[24:27]
    ds_read_b128 v[44:47], v14 offset:8192
    v_mfma_f32_16x16x32_bf16 v[20:23], v[148:151], v[60:63], v[20:23]
    ds_read_b128 v[48:51], v14 offset:12288
    s_waitcnt lgkmcnt(4)
    v_mfma_f32_16x16x32_bf16 v[20:23], v[152:155], v[68:71], v[20:23]
    ds_read_b128 v[52:55], v15 offset:0
    v_mfma_f32_16x16x32_bf16 v[24:27], v[152:155], v[72:75], v[24:27]
    ds_read_b128 v[56:59], v15 offset:4096
    v_mfma_f32_16x16x32_bf16 v[24:27], v[156:159], v[80:83], v[24:27]
    ds_read_b128 v[60:63], v15 offset:8192
    v_mfma_f32_16x16x32_bf16 v[20:23], v[156:159], v[76:79], v[20:23]
    ds_read_b128 v[64:67], v15 offset:12288
    s_waitcnt lgkmcnt(4)
    v_mfma_f32_16x16x32_bf16 v[20:23], v[160:163], v[36:39], v[20:23]
    ds_read_b128 v[68:71], v16 offset:0
    v_mfma_f32_16x16x32_bf16 v[24:27], v[160:163], v[40:43], v[24:27]
    ds_read_b128 v[72:75], v16 offset:4096
    v_mfma_f32_16x16x32_bf16 v[24:27], v[164:167], v[48:51], v[24:27]
    ds_read_b128 v[76:79], v16 offset:8192
    v_mfma_f32_16x16x32_bf16 v[20:23], v[164:167], v[44:47], v[20:23]
    ds_read_b128 v[80:83], v16 offset:12288
    s_waitcnt lgkmcnt(4)
    v_mfma_f32_16x16x32_bf16 v[20:23], v[168:171], v[52:55], v[20:23]
    ds_read_b128 v[36:39], v17 offset:0
    v_mfma_f32_16x16x32_bf16 v[24:27], v[168:171], v[56:59], v[24:27]
    ds_read_b128 v[40:43], v17 offset:4096
    v_mfma_f32_16x16x32_bf16 v[24:27], v[172:175], v[64:67], v[24:27]
    ds_read_b128 v[44:47], v17 offset:8192
    v_mfma_f32_16x16x32_bf16 v[20:23], v[172:175], v[60:63], v[20:23]
    ds_read_b128 v[48:51], v17 offset:12288
    s_barrier
    s_waitcnt lgkmcnt(4)
    v_mfma_f32_16x16x32_bf16 v[20:23], v[176:179], v[68:71], v[20:23]
    ds_read_b128 v[52:55], v14 offset:16384
    v_mfma_f32_16x16x32_bf16 v[24:27], v[176:179], v[72:75], v[24:27]
    ds_read_b128 v[56:59], v14 offset:20480
    v_mfma_f32_16x16x32_bf16 v[24:27], v[180:183], v[80:83], v[24:27]
    ds_read_b128 v[60:63], v14 offset:24576
    v_mfma_f32_16x16x32_bf16 v[20:23], v[180:183], v[76:79], v[20:23]
    ds_read_b128 v[64:67], v14 offset:28672
    s_waitcnt lgkmcnt(4)
    v_mfma_f32_16x16x32_bf16 v[20:23], v[184:187], v[36:39], v[20:23]
    ds_read_b128 v[68:71], v15 offset:16384
    v_mfma_f32_16x16x32_bf16 v[24:27], v[184:187], v[40:43], v[24:27]
    ds_read_b128 v[72:75], v15 offset:20480
    v_mfma_f32_16x16x32_bf16 v[24:27], v[188:191], v[48:51], v[24:27]
    ds_read_b128 v[76:79], v15 offset:24576
    v_mfma_f32_16x16x32_bf16 v[20:23], v[188:191], v[44:47], v[20:23]
    ds_read_b128 v[80:83], v15 offset:28672
    s_waitcnt lgkmcnt(4)
    v_mfma_f32_16x16x32_bf16 v[20:23], v[192:195], v[52:55], v[20:23]
    ds_read_b128 v[36:39], v16 offset:16384
    v_mfma_f32_16x16x32_bf16 v[24:27], v[192:195], v[56:59], v[24:27]
    ds_read_b128 v[40:43], v16 offset:20480
    v_mfma_f32_16x16x32_bf16 v[24:27], v[196:199], v[64:67], v[24:27]
    ds_read_b128 v[44:47], v16 offset:24576
    v_mfma_f32_16x16x32_bf16 v[20:23], v[196:199], v[60:63], v[20:23]
    ds_read_b128 v[48:51], v16 offset:28672
    s_waitcnt lgkmcnt(4)
    v_mfma_f32_16x16x32_bf16 v[20:23], v[200:203], v[68:71], v[20:23]
    ds_read_b128 v[52:55], v17 offset:16384
    v_mfma_f32_16x16x32_bf16 v[24:27], v[200:203], v[72:75], v[24:27]
    ds_read_b128 v[56:59], v17 offset:20480
    v_mfma_f32_16x16x32_bf16 v[24:27], v[204:207], v[80:83], v[24:27]
    ds_read_b128 v[60:63], v17 offset:24576
    v_mfma_f32_16x16x32_bf16 v[20:23], v[204:207], v[76:79], v[20:23]
    ds_read_b128 v[64:67], v17 offset:28672
    s_barrier
    s_waitcnt lgkmcnt(4)
    v_mfma_f32_16x16x32_bf16 v[20:23], v[208:211], v[36:39], v[20:23]
    ds_read_b128 v[68:71], v14 offset:32768
    v_mfma_f32_16x16x32_bf16 v[24:27], v[208:211], v[40:43], v[24:27]
    ds_read_b128 v[72:75], v14 offset:36864
    v_mfma_f32_16x16x32_bf16 v[24:27], v[212:215], v[48:51], v[24:27]
    ds_read_b128 v[76:79], v14 offset:40960
    v_mfma_f32_16x16x32_bf16 v[20:23], v[212:215], v[44:47], v[20:23]
    ds_read_b128 v[80:83], v14 offset:45056
    s_waitcnt lgkmcnt(4)
    v_mfma_f32_16x16x32_bf16 v[20:23], v[216:219], v[52:55], v[20:23]
    ds_read_b128 v[36:39], v15 offset:32768
    v_mfma_f32_16x16x32_bf16 v[24:27], v[216:219], v[56:59], v[24:27]
    ds_read_b128 v[40:43], v15 offset:36864
    v_mfma_f32_16x16x32_bf16 v[24:27], v[220:223], v[64:67], v[24:27]
    ds_read_b128 v[44:47], v15 offset:40960
    v_mfma_f32_16x16x32_bf16 v[20:23], v[220:223], v[60:63], v[20:23]
    ds_read_b128 v[48:51], v15 offset:45056
    s_waitcnt lgkmcnt(4)
    v_mfma_f32_16x16x32_bf16 v[20:23], v[224:227], v[68:71], v[20:23]
    ds_read_b128 v[52:55], v16 offset:32768
    v_mfma_f32_16x16x32_bf16 v[24:27], v[224:227], v[72:75], v[24:27]
    ds_read_b128 v[56:59], v16 offset:36864
    v_mfma_f32_16x16x32_bf16 v[24:27], v[228:231], v[80:83], v[24:27]
    ds_read_b128 v[60:63], v16 offset:40960
    v_mfma_f32_16x16x32_bf16 v[20:23], v[228:231], v[76:79], v[20:23]
    ds_read_b128 v[64:67], v16 offset:45056
    s_waitcnt lgkmcnt(4)
    v_mfma_f32_16x16x32_bf16 v[20:23], v[232:235], v[36:39], v[20:23]
    ds_read_b128 v[68:71], v17 offset:32768
    v_mfma_f32_16x16x32_bf16 v[24:27], v[232:235], v[40:43], v[24:27]
    ds_read_b128 v[72:75], v17 offset:36864
    v_mfma_f32_16x16x32_bf16 v[24:27], v[236:239], v[48:51], v[24:27]
    ds_read_b128 v[76:79], v17 offset:40960
    v_mfma_f32_16x16x32_bf16 v[20:23], v[236:239], v[44:47], v[20:23]
    ds_read_b128 v[80:83], v17 offset:45056
    s_barrier
    ds_read_b128 v[88:91], v18 offset:1024
    ds_read_b128 v[92:95], v18 offset:3072
    ds_read_b128 v[96:99], v18 offset:1280
    ds_read_b128 v[100:103], v18 offset:3328
    s_waitcnt vmcnt(0)
    buffer_atomic_add v113, v112, s[56:59], s40 offen offset:2560 sc1
    s_waitcnt lgkmcnt(8)
    v_mfma_f32_16x16x32_bf16 v[20:23], v[240:243], v[52:55], v[20:23]
    ds_read_b128 v[36:39], v10 offset:16384
    v_mfma_f32_16x16x32_bf16 v[24:27], v[240:243], v[56:59], v[24:27]
    ds_read_b128 v[40:43], v10 offset:20480
    v_mfma_f32_16x16x32_bf16 v[24:27], v[244:247], v[64:67], v[24:27]
    ds_read_b128 v[44:47], v10 offset:24576
    v_mfma_f32_16x16x32_bf16 v[20:23], v[244:247], v[60:63], v[20:23]
    ds_read_b128 v[48:51], v10 offset:28672
    s_waitcnt lgkmcnt(8)
    v_mfma_f32_16x16x32_bf16 v[20:23], v[248:251], v[68:71], v[20:23]
    ds_read_b128 v[52:55], v11 offset:16384
    v_mfma_f32_16x16x32_bf16 v[24:27], v[248:251], v[72:75], v[24:27]
    ds_read_b128 v[56:59], v11 offset:20480
    v_mfma_f32_16x16x32_bf16 v[24:27], v[252:255], v[80:83], v[24:27]
    ds_read_b128 v[60:63], v11 offset:24576
    v_mfma_f32_16x16x32_bf16 v[20:23], v[252:255], v[76:79], v[20:23]
    ds_read_b128 v[64:67], v11 offset:28672
    s_waitcnt lgkmcnt(4)
    v_mfma_f32_16x16x32_bf16 v[28:31], v[128:131], v[36:39], 0
    ds_read_b128 v[68:71], v12 offset:16384
    v_mfma_f32_16x16x32_bf16 v[32:35], v[128:131], v[40:43], 0
    ds_read_b128 v[72:75], v12 offset:20480
    v_mfma_f32_16x16x32_bf16 v[32:35], v[132:135], v[48:51], v[32:35]
    ds_read_b128 v[76:79], v12 offset:24576
    v_mfma_f32_16x16x32_bf16 v[28:31], v[132:135], v[44:47], v[28:31]
    ds_read_b128 v[80:83], v12 offset:28672
    v_pk_fma_f32 v[20:21], v[88:89], v[84:85], v[20:21]
    v_pk_fma_f32 v[22:23], v[88:89], v[86:87], v[22:23]
    v_pk_fma_f32 v[24:25], v[96:97], v[84:85], v[24:25]
    v_pk_fma_f32 v[26:27], v[96:97], v[86:87], v[26:27]
    v_pk_mul_f32 v[104:105], v[20:21], v[20:21]
    v_pk_mul_f32 v[106:107], v[22:23], v[22:23]
    v_pk_mul_f32 v[108:109], v[24:25], v[24:25]
    v_pk_mul_f32 v[110:111], v[26:27], v[26:27]
    v_pk_fma_f32 v[104:105], v[104:105], v[92:93], v[90:91]
    v_pk_fma_f32 v[106:107], v[106:107], v[92:93], v[90:91]
    v_pk_fma_f32 v[108:109], v[108:109], v[100:101], v[98:99]
    v_pk_fma_f32 v[110:111], v[110:111], v[100:101], v[98:99]
    v_pk_mul_f32 v[104:105], v[104:105], v[20:21]
    v_pk_mul_f32 v[106:107], v[106:107], v[22:23]
    v_pk_mul_f32 v[108:109], v[108:109], v[24:25]
    v_pk_mul_f32 v[110:111], v[110:111], v[26:27]
    v_exp_f32 v104, v104
    v_exp_f32 v105, v105
    v_exp_f32 v106, v106
    v_exp_f32 v107, v107
    v_exp_f32 v108, v108
    v_exp_f32 v109, v109
    v_exp_f32 v110, v110
    v_exp_f32 v111, v111
    v_pk_fma_f32 v[104:105], v[104:105], v[94:95], v[94:95]
    v_pk_fma_f32 v[106:107], v[106:107], v[94:95], v[94:95]
    v_pk_fma_f32 v[108:109], v[108:109], v[102:103], v[102:103]
    v_pk_fma_f32 v[110:111], v[110:111], v[102:103], v[102:103]
    v_rcp_f32 v104, v104
    v_rcp_f32 v105, v105
    v_rcp_f32 v106, v106
    v_rcp_f32 v107, v107
    v_rcp_f32 v108, v108
    v_rcp_f32 v109, v109
    v_rcp_f32 v110, v110
    v_rcp_f32 v111, v111
    v_pk_mul_f32 v[20:21], v[20:21], v[104:105]
    v_pk_mul_f32 v[22:23], v[22:23], v[106:107]
    v_pk_mul_f32 v[24:25], v[24:25], v[108:109]
    v_pk_mul_f32 v[26:27], v[26:27], v[110:111]
    v_add_u32 v20, 0x10000, v20
    v_add_u32 v22, 0x10000, v22
    v_add_u32 v24, 0x10000, v24
    v_add_u32 v26, 0x10000, v26
    v_and_b32 v20, 0xfffe0000, v20
    v_and_b32 v22, 0xfffe0000, v22
    v_and_b32 v24, 0xfffe0000, v24
    v_and_b32 v26, 0xfffe0000, v26
    v_cvt_pk_bf16_f32 v104, v20, v21
    v_cvt_pk_bf16_f32 v105, v22, v23
    v_cvt_pk_bf16_f32 v106, v24, v25
    v_cvt_pk_bf16_f32 v107, v26, v27
    s_add_u32 s36, s39, 262144
    v_permlane16_swap_b32 v104, v106
    v_permlane16_swap_b32 v105, v107
    buffer_store_dwordx4 v[104:107], v114, s[16:19], s36 offen sc1
    s_waitcnt lgkmcnt(4)
    v_mfma_f32_16x16x32_bf16 v[28:31], v[136:139], v[52:55], v[28:31]
    ds_read_b128 v[36:39], v13 offset:16384
    v_mfma_f32_16x16x32_bf16 v[32:35], v[136:139], v[56:59], v[32:35]
    ds_read_b128 v[40:43], v13 offset:20480
    v_mfma_f32_16x16x32_bf16 v[32:35], v[140:143], v[64:67], v[32:35]
    ds_read_b128 v[44:47], v13 offset:24576
    v_mfma_f32_16x16x32_bf16 v[28:31], v[140:143], v[60:63], v[28:31]
    ds_read_b128 v[48:51], v13 offset:28672
    s_barrier
    s_waitcnt lgkmcnt(4)
    v_mfma_f32_16x16x32_bf16 v[28:31], v[144:147], v[68:71], v[28:31]
    ds_read_b128 v[52:55], v10 offset:32768
    v_mfma_f32_16x16x32_bf16 v[32:35], v[144:147], v[72:75], v[32:35]
    ds_read_b128 v[56:59], v10 offset:36864
    v_mfma_f32_16x16x32_bf16 v[32:35], v[148:151], v[80:83], v[32:35]
    ds_read_b128 v[60:63], v10 offset:40960
    v_mfma_f32_16x16x32_bf16 v[28:31], v[148:151], v[76:79], v[28:31]
    ds_read_b128 v[64:67], v10 offset:45056
    s_waitcnt lgkmcnt(4)
    v_mfma_f32_16x16x32_bf16 v[28:31], v[152:155], v[36:39], v[28:31]
    ds_read_b128 v[68:71], v11 offset:32768
    v_mfma_f32_16x16x32_bf16 v[32:35], v[152:155], v[40:43], v[32:35]
    ds_read_b128 v[72:75], v11 offset:36864
    v_mfma_f32_16x16x32_bf16 v[32:35], v[156:159], v[48:51], v[32:35]
    ds_read_b128 v[76:79], v11 offset:40960
    v_mfma_f32_16x16x32_bf16 v[28:31], v[156:159], v[44:47], v[28:31]
    ds_read_b128 v[80:83], v11 offset:45056
    s_waitcnt lgkmcnt(4)
    v_mfma_f32_16x16x32_bf16 v[28:31], v[160:163], v[52:55], v[28:31]
    ds_read_b128 v[36:39], v12 offset:32768
    v_mfma_f32_16x16x32_bf16 v[32:35], v[160:163], v[56:59], v[32:35]
    ds_read_b128 v[40:43], v12 offset:36864
    v_mfma_f32_16x16x32_bf16 v[32:35], v[164:167], v[64:67], v[32:35]
    ds_read_b128 v[44:47], v12 offset:40960
    v_mfma_f32_16x16x32_bf16 v[28:31], v[164:167], v[60:63], v[28:31]
    ds_read_b128 v[48:51], v12 offset:45056
    s_waitcnt lgkmcnt(4)
    v_mfma_f32_16x16x32_bf16 v[28:31], v[168:171], v[68:71], v[28:31]
    ds_read_b128 v[52:55], v13 offset:32768
    v_mfma_f32_16x16x32_bf16 v[32:35], v[168:171], v[72:75], v[32:35]
    ds_read_b128 v[56:59], v13 offset:36864
    v_mfma_f32_16x16x32_bf16 v[32:35], v[172:175], v[80:83], v[32:35]
    ds_read_b128 v[60:63], v13 offset:40960
    v_mfma_f32_16x16x32_bf16 v[28:31], v[172:175], v[76:79], v[28:31]
    ds_read_b128 v[64:67], v13 offset:45056
    s_barrier
    s_waitcnt lgkmcnt(4)
    v_mfma_f32_16x16x32_bf16 v[28:31], v[176:179], v[36:39], v[28:31]
    ds_read_b128 v[68:71], v14 offset:0
    v_mfma_f32_16x16x32_bf16 v[32:35], v[176:179], v[40:43], v[32:35]
    ds_read_b128 v[72:75], v14 offset:4096
    v_mfma_f32_16x16x32_bf16 v[32:35], v[180:183], v[48:51], v[32:35]
    ds_read_b128 v[76:79], v14 offset:8192
    v_mfma_f32_16x16x32_bf16 v[28:31], v[180:183], v[44:47], v[28:31]
    ds_read_b128 v[80:83], v14 offset:12288
    s_waitcnt lgkmcnt(4)
    v_mfma_f32_16x16x32_bf16 v[28:31], v[184:187], v[52:55], v[28:31]
    ds_read_b128 v[36:39], v15 offset:0
    v_mfma_f32_16x16x32_bf16 v[32:35], v[184:187], v[56:59], v[32:35]
    ds_read_b128 v[40:43], v15 offset:4096
    v_mfma_f32_16x16x32_bf16 v[32:35], v[188:191], v[64:67], v[32:35]
    ds_read_b128 v[44:47], v15 offset:8192
    v_mfma_f32_16x16x32_bf16 v[28:31], v[188:191], v[60:63], v[28:31]
    ds_read_b128 v[48:51], v15 offset:12288
    s_waitcnt lgkmcnt(4)
    v_mfma_f32_16x16x32_bf16 v[28:31], v[192:195], v[68:71], v[28:31]
    ds_read_b128 v[52:55], v16 offset:0
    v_mfma_f32_16x16x32_bf16 v[32:35], v[192:195], v[72:75], v[32:35]
    ds_read_b128 v[56:59], v16 offset:4096
    v_mfma_f32_16x16x32_bf16 v[32:35], v[196:199], v[80:83], v[32:35]
    ds_read_b128 v[60:63], v16 offset:8192
    v_mfma_f32_16x16x32_bf16 v[28:31], v[196:199], v[76:79], v[28:31]
    ds_read_b128 v[64:67], v16 offset:12288
    s_waitcnt lgkmcnt(4)
    v_mfma_f32_16x16x32_bf16 v[28:31], v[200:203], v[36:39], v[28:31]
    ds_read_b128 v[68:71], v17 offset:0
    v_mfma_f32_16x16x32_bf16 v[32:35], v[200:203], v[40:43], v[32:35]
    ds_read_b128 v[72:75], v17 offset:4096
    v_mfma_f32_16x16x32_bf16 v[32:35], v[204:207], v[48:51], v[32:35]
    ds_read_b128 v[76:79], v17 offset:8192
    v_mfma_f32_16x16x32_bf16 v[28:31], v[204:207], v[44:47], v[28:31]
    ds_read_b128 v[80:83], v17 offset:12288
    s_barrier
    s_waitcnt lgkmcnt(4)
    v_mfma_f32_16x16x32_bf16 v[28:31], v[208:211], v[52:55], v[28:31]
    ds_read_b128 v[36:39], v14 offset:16384
    v_mfma_f32_16x16x32_bf16 v[32:35], v[208:211], v[56:59], v[32:35]
    ds_read_b128 v[40:43], v14 offset:20480
    v_mfma_f32_16x16x32_bf16 v[32:35], v[212:215], v[64:67], v[32:35]
    ds_read_b128 v[44:47], v14 offset:24576
    v_mfma_f32_16x16x32_bf16 v[28:31], v[212:215], v[60:63], v[28:31]
    ds_read_b128 v[48:51], v14 offset:28672
    s_waitcnt lgkmcnt(4)
    v_mfma_f32_16x16x32_bf16 v[28:31], v[216:219], v[68:71], v[28:31]
    ds_read_b128 v[52:55], v15 offset:16384
    v_mfma_f32_16x16x32_bf16 v[32:35], v[216:219], v[72:75], v[32:35]
    ds_read_b128 v[56:59], v15 offset:20480
    v_mfma_f32_16x16x32_bf16 v[32:35], v[220:223], v[80:83], v[32:35]
    ds_read_b128 v[60:63], v15 offset:24576
    v_mfma_f32_16x16x32_bf16 v[28:31], v[220:223], v[76:79], v[28:31]
    ds_read_b128 v[64:67], v15 offset:28672
    s_waitcnt vmcnt(0)
    buffer_atomic_add v113, v112, s[56:59], s40 offen offset:3072 sc1
    s_waitcnt lgkmcnt(4)
    v_mfma_f32_16x16x32_bf16 v[28:31], v[224:227], v[36:39], v[28:31]
    ds_read_b128 v[68:71], v16 offset:16384
    v_mfma_f32_16x16x32_bf16 v[32:35], v[224:227], v[40:43], v[32:35]
    ds_read_b128 v[72:75], v16 offset:20480
    v_mfma_f32_16x16x32_bf16 v[32:35], v[228:231], v[48:51], v[32:35]
    ds_read_b128 v[76:79], v16 offset:24576
    v_mfma_f32_16x16x32_bf16 v[28:31], v[228:231], v[44:47], v[28:31]
    ds_read_b128 v[80:83], v16 offset:28672
    s_waitcnt lgkmcnt(4)
    v_mfma_f32_16x16x32_bf16 v[28:31], v[232:235], v[52:55], v[28:31]
    ds_read_b128 v[36:39], v17 offset:16384
    v_mfma_f32_16x16x32_bf16 v[32:35], v[232:235], v[56:59], v[32:35]
    ds_read_b128 v[40:43], v17 offset:20480
    v_mfma_f32_16x16x32_bf16 v[32:35], v[236:239], v[64:67], v[32:35]
    ds_read_b128 v[44:47], v17 offset:24576
    v_mfma_f32_16x16x32_bf16 v[28:31], v[236:239], v[60:63], v[28:31]
    ds_read_b128 v[48:51], v17 offset:28672
    s_barrier
    ds_read_b128 v[88:91], v18 offset:1536
    ds_read_b128 v[92:95], v18 offset:3584
    ds_read_b128 v[96:99], v18 offset:1792
    ds_read_b128 v[100:103], v18 offset:3840
    s_waitcnt lgkmcnt(8)
    v_mfma_f32_16x16x32_bf16 v[28:31], v[240:243], v[68:71], v[28:31]
    v_mfma_f32_16x16x32_bf16 v[32:35], v[240:243], v[72:75], v[32:35]
    v_mfma_f32_16x16x32_bf16 v[32:35], v[244:247], v[80:83], v[32:35]
    v_mfma_f32_16x16x32_bf16 v[28:31], v[244:247], v[76:79], v[28:31]
    s_waitcnt lgkmcnt(4)
    v_mfma_f32_16x16x32_bf16 v[28:31], v[248:251], v[36:39], v[28:31]
    v_mfma_f32_16x16x32_bf16 v[32:35], v[248:251], v[40:43], v[32:35]
    v_mfma_f32_16x16x32_bf16 v[32:35], v[252:255], v[48:51], v[32:35]
    v_mfma_f32_16x16x32_bf16 v[28:31], v[252:255], v[44:47], v[28:31]
    s_setprio 1
    s_waitcnt lgkmcnt(0)
    s_load_dword s32, s[4:5], s20 offset:2560
    s_load_dword s3, s[4:5], s20 offset:2688
    s_add_u32 m0, s12, 106496
    s_add_u32 s49, s8, 20480
    buffer_load_dwordx4 v2, s[16:19], s49 offen offset:0 sc1 lds
    buffer_load_dwordx4 v2, s[16:19], s49 offen offset:1024 sc1 lds
    buffer_load_dwordx4 v2, s[16:19], s49 offen offset:2048 sc1 lds
    buffer_load_dwordx4 v2, s[16:19], s49 offen offset:3072 sc1 lds
    v_pk_fma_f32 v[28:29], v[88:89], v[84:85], v[28:29]
    v_pk_fma_f32 v[30:31], v[88:89], v[86:87], v[30:31]
    v_pk_fma_f32 v[32:33], v[96:97], v[84:85], v[32:33]
    v_pk_fma_f32 v[34:35], v[96:97], v[86:87], v[34:35]
    v_pk_mul_f32 v[104:105], v[28:29], v[28:29]
    v_pk_mul_f32 v[106:107], v[30:31], v[30:31]
    v_pk_mul_f32 v[108:109], v[32:33], v[32:33]
    v_pk_mul_f32 v[110:111], v[34:35], v[34:35]
    v_pk_fma_f32 v[104:105], v[104:105], v[92:93], v[90:91]
    v_pk_fma_f32 v[106:107], v[106:107], v[92:93], v[90:91]
    v_pk_fma_f32 v[108:109], v[108:109], v[100:101], v[98:99]
    v_pk_fma_f32 v[110:111], v[110:111], v[100:101], v[98:99]
    v_pk_mul_f32 v[104:105], v[104:105], v[28:29]
    v_pk_mul_f32 v[106:107], v[106:107], v[30:31]
    v_pk_mul_f32 v[108:109], v[108:109], v[32:33]
    v_pk_mul_f32 v[110:111], v[110:111], v[34:35]
    v_exp_f32 v104, v104
    v_exp_f32 v105, v105
    v_exp_f32 v106, v106
    v_exp_f32 v107, v107
    v_exp_f32 v108, v108
    v_exp_f32 v109, v109
    v_exp_f32 v110, v110
    v_exp_f32 v111, v111
    v_pk_fma_f32 v[104:105], v[104:105], v[94:95], v[94:95]
    v_pk_fma_f32 v[106:107], v[106:107], v[94:95], v[94:95]
    v_pk_fma_f32 v[108:109], v[108:109], v[102:103], v[102:103]
    v_pk_fma_f32 v[110:111], v[110:111], v[102:103], v[102:103]
    v_rcp_f32 v104, v104
    v_rcp_f32 v105, v105
    v_rcp_f32 v106, v106
    v_rcp_f32 v107, v107
    v_rcp_f32 v108, v108
    v_rcp_f32 v109, v109
    v_rcp_f32 v110, v110
    v_rcp_f32 v111, v111
    v_pk_mul_f32 v[28:29], v[28:29], v[104:105]
    v_pk_mul_f32 v[30:31], v[30:31], v[106:107]
    v_pk_mul_f32 v[32:33], v[32:33], v[108:109]
    v_pk_mul_f32 v[34:35], v[34:35], v[110:111]
    v_add_u32 v28, 0x10000, v28
    v_add_u32 v30, 0x10000, v30
    v_add_u32 v32, 0x10000, v32
    v_add_u32 v34, 0x10000, v34
    v_and_b32 v28, 0xfffe0000, v28
    v_and_b32 v30, 0xfffe0000, v30
    v_and_b32 v32, 0xfffe0000, v32
    v_and_b32 v34, 0xfffe0000, v34
    v_cvt_pk_bf16_f32 v104, v28, v29
    v_cvt_pk_bf16_f32 v105, v30, v31
    v_cvt_pk_bf16_f32 v106, v32, v33
    v_cvt_pk_bf16_f32 v107, v34, v35
    s_add_u32 s36, s39, 393216
    v_permlane16_swap_b32 v104, v106
    v_permlane16_swap_b32 v105, v107
    buffer_store_dwordx4 v[104:107], v114, s[16:19], s36 offen sc1
    s_add_u32 m0, s12, 122880
    s_add_u32 s49, s8, 131072
    s_barrier
    s_waitcnt lgkmcnt(0)
    s_cmp_eq_u32 s32, s21
    s_cselect_b32 s32, s3, 0
    s_cmp_eq_u32 s32, s21
    s_cbranch_scc1 hok_11
    s_add_u32 s53, s20, 2560
    v_lshlrev_b32 v85, 7, v1
    v_add_u32 v85, s53, v85
    s_mov_b32 s53, 0
    s_add_u32 s54, s52, 16
    s_bfm_b64 exec, 2, 0
poll_12:
    buffer_load_dword v84, v85, s[56:59], 0 offen sc1
    s_waitcnt vmcnt(0)
    v_cmp_eq_u32 vcc, s54, v84
    s_nop 0
    s_cmp_eq_u64 vcc, exec
    s_cbranch_scc1 pok_13
    s_sleep 8
    s_add_u32 s53, s53, 1
    s_cmp_lt_u32 s53, s61
    s_cbranch_scc1 poll_12
    s_mov_b32 s61, 0
pok_13:
    s_mov_b64 exec, -1
hok_11:
    buffer_load_dwordx4 v2, s[16:19], s49 offen offset:0 sc1 lds
    buffer_load_dwordx4 v2, s[16:19], s49 offen offset:1024 sc1 lds
    buffer_load_dwordx4 v2, s[16:19], s49 offen offset:2048 sc1 lds
    buffer_load_dwordx4 v2, s[16:19], s49 offen offset:3072 sc1 lds
    s_add_u32 m0, s12, 139264
    s_add_u32 s49, s8, 135168
    s_barrier
    buffer_load_dwordx4 v2, s[16:19], s49 offen offset:0 sc1 lds
    buffer_load_dwordx4 v2, s[16:19], s49 offen offset:1024 sc1 lds
    buffer_load_dwordx4 v2, s[16:19], s49 offen offset:2048 sc1 lds
    buffer_load_dwordx4 v2, s[16:19], s49 offen offset:3072 sc1 lds
    s_add_u32 m0, s12, 16384
    s_add_u32 s49, s8, 147456
    s_waitcnt vmcnt(9)
    s_barrier
    s_waitcnt vmcnt(8)
    buffer_atomic_add v113, v112, s[56:59], s40 offen offset:3584 sc1
    buffer_load_dwordx4 v2, s[16:19], s49 offen offset:0 sc1 lds
    buffer_load_dwordx4 v2, s[16:19], s49 offen offset:1024 sc1 lds
    buffer_load_dwordx4 v2, s[16:19], s49 offen offset:2048 sc1 lds
    buffer_load_dwordx4 v2, s[16:19], s49 offen offset:3072 sc1 lds
    s_add_u32 m0, s12, 32768
    s_add_u32 s49, s8, 151552
    s_waitcnt vmcnt(9)
    s_barrier
    s_load_dword s32, s[4:5], s20 offset:3072
    s_load_dword s3, s[4:5], s20 offset:3200
    buffer_load_dwordx4 v2, s[16:19], s49 offen offset:0 sc1 lds
    buffer_load_dwordx4 v2, s[16:19], s49 offen offset:1024 sc1 lds
    buffer_load_dwordx4 v2, s[16:19], s49 offen offset:2048 sc1 lds
    buffer_load_dwordx4 v2, s[16:19], s49 offen offset:3072 sc1 lds
    s_add_u32 m0, s12, 106496
    s_add_u32 s49, s8, 262144
    s_waitcnt vmcnt(9)
    s_barrier
    s_waitcnt lgkmcnt(0)
    s_cmp_eq_u32 s32, s21
    s_cselect_b32 s32, s3, 0
    s_cmp_eq_u32 s32, s21
    s_cbranch_scc1 hok_14
    s_add_u32 s53, s20, 3072
    v_lshlrev_b32 v85, 7, v1
    v_add_u32 v85, s53, v85
    s_mov_b32 s53, 0
    s_add_u32 s54, s52, 16
    s_bfm_b64 exec, 2, 0
poll_15:
    buffer_load_dword v84, v85, s[56:59], 0 offen sc1
    s_waitcnt vmcnt(0)
    v_cmp_eq_u32 vcc, s54, v84
    s_nop 0
    s_cmp_eq_u64 vcc, exec
    s_cbranch_scc1 pok_16
    s_sleep 8
    s_add_u32 s53, s53, 1
    s_cmp_lt_u32 s53, s61
    s_cbranch_scc1 poll_15
    s_mov_b32 s61, 0
pok_16:
    s_mov_b64 exec, -1
hok_14:
    buffer_load_dwordx4 v2, s[16:19], s49 offen offset:0 sc1 lds
    buffer_load_dwordx4 v2, s[16:19], s49 offen offset:1024 sc1 lds
    buffer_load_dwordx4 v2, s[16:19], s49 offen offset:2048 sc1 lds
    buffer_load_dwordx4 v2, s[16:19], s49 offen offset:3072 sc1 lds
    s_add_u32 m0, s12, 122880
    s_add_u32 s49, s8, 266240
    s_waitcnt vmcnt(8)
    s_barrier
    buffer_load_dwordx4 v2, s[16:19], s49 offen offset:0 sc1 lds
    buffer_load_dwordx4 v2, s[16:19], s49 offen offset:1024 sc1 lds
    buffer_load_dwordx4 v2, s[16:19], s49 offen offset:2048 sc1 lds
    buffer_load_dwordx4 v2, s[16:19], s49 offen offset:3072 sc1 lds
    s_add_u32 m0, s12, 139264
    s_add_u32 s49, s8, 278528
    s_waitcnt vmcnt(8)
    s_barrier
    buffer_load_dwordx4 v2, s[16:19], s49 offen offset:0 sc1 lds
    buffer_load_dwordx4 v2, s[16:19], s49 offen offset:1024 sc1 lds
    buffer_load_dwordx4 v2, s[16:19], s49 offen offset:2048 sc1 lds
    buffer_load_dwordx4 v2, s[16:19], s49 offen offset:3072 sc1 lds
    s_add_u32 m0, s12, 16384
    s_add_u32 s49, s8, 282624
    s_waitcnt vmcnt(8)
    s_barrier
    s_load_dword s32, s[4:5], s20 offset:3584
    s_load_dword s3, s[4:5], s20 offset:3712
    buffer_load_dwordx4 v2, s[16:19], s49 offen offset:0 sc1 lds
    buffer_load_dwordx4 v2, s[16:19], s49 offen offset:1024 sc1 lds
    buffer_load_dwordx4 v2, s[16:19], s49 offen offset:2048 sc1 lds
    buffer_load_dwordx4 v2, s[16:19], s49 offen offset:3072 sc1 lds
    s_add_u32 m0, s12, 32768
    s_add_u32 s49, s8, 393216
    s_waitcnt vmcnt(8)
    s_barrier
    s_waitcnt lgkmcnt(0)
    s_cmp_eq_u32 s32, s21
    s_cselect_b32 s32, s3, 0
    s_cmp_eq_u32 s32, s21
    s_cbranch_scc1 hok_17
    s_add_u32 s53, s20, 3584
    v_lshlrev_b32 v85, 7, v1
    v_add_u32 v85, s53, v85
    s_mov_b32 s53, 0
    s_add_u32 s54, s52, 16
    s_bfm_b64 exec, 2, 0
poll_18:
    buffer_load_dword v84, v85, s[56:59], 0 offen sc1
    s_waitcnt vmcnt(0)
    v_cmp_eq_u32 vcc, s54, v84
    s_nop 0
    s_cmp_eq_u64 vcc, exec
    s_cbranch_scc1 pok_19
    s_sleep 8
    s_add_u32 s53, s53, 1
    s_cmp_lt_u32 s53, s61
    s_cbranch_scc1 poll_18
    s_mov_b32 s61, 0
pok_19:
    s_mov_b64 exec, -1
hok_17:
    buffer_load_dwordx4 v2, s[16:19], s49 offen offset:0 sc1 lds
    buffer_load_dwordx4 v2, s[16:19], s49 offen offset:1024 sc1 lds
    buffer_load_dwordx4 v2, s[16:19], s49 offen offset:2048 sc1 lds
    buffer_load_dwordx4 v2, s[16:19], s49 offen offset:3072 sc1 lds
    s_add_u32 m0, s12, 106496
    s_add_u32 s49, s8, 397312
    s_waitcnt vmcnt(8)
    s_barrier
    buffer_load_dwordx4 v2, s[16:19], s49 offen offset:0 sc1 lds
    buffer_load_dwordx4 v2, s[16:19], s49 offen offset:1024 sc1 lds
    buffer_load_dwordx4 v2, s[16:19], s49 offen offset:2048 sc1 lds
    buffer_load_dwordx4 v2, s[16:19], s49 offen offset:3072 sc1 lds
    s_add_u32 m0, s12, 122880
    s_add_u32 s49, s8, 409600
    s_waitcnt vmcnt(8)
    s_barrier
    buffer_load_dwordx4 v2, s[16:19], s49 offen offset:0 sc1 lds
    buffer_load_dwordx4 v2, s[16:19], s49 offen offset:1024 sc1 lds
    buffer_load_dwordx4 v2, s[16:19], s49 offen offset:2048 sc1 lds
    buffer_load_dwordx4 v2, s[16:19], s49 offen offset:3072 sc1 lds
    s_add_u32 m0, s12, 139264
    s_add_u32 s49, s8, 413696
    s_waitcnt vmcnt(8)
    s_barrier
    buffer_load_dwordx4 v2, s[16:19], s49 offen offset:0 sc1 lds
    buffer_load_dwordx4 v2, s[16:19], s49 offen offset:1024 sc1 lds
    buffer_load_dwordx4 v2, s[16:19], s49 offen offset:2048 sc1 lds
    buffer_load_dwordx4 v2, s[16:19], s49 offen offset:3072 sc1 lds
    s_waitcnt vmcnt(8)
    s_barrier
    s_lshr_b32 s34, s30, 1
    s_and_b32 s35, s30, 1
    v_and_b32 v22, 15, v1
    v_lshrrev_b32 v23, 4, v1
    s_mul_i32 s37, s34, 4
    s_mul_i32 s36, s34, 8192
    v_add_u32 v12, s36, v2
    v_lshrrev_b32 v18, 2, v1
    v_mul_u32_u24 v13, 448, v18
    v_and_b32 v19, 3, v1
    v_lshl_add_u32 v13, v19, 3, v13
    v_add_u32 v13, 49152, v13
    v_mul_u32_u24 v15, 448, v18
    v_and_b32 v19, 2, v1
    v_lshl_add_u32 v15, v19, 2, v15
    v_bfe_u32 v18, v1, 4, 1
    v_and_b32 v19, 1, v1
    v_lshl_add_u32 v15, v19, 5, v15
    v_xor_b32 v19, s35, v18
    v_lshl_add_u32 v15, v19, 4, v15
    v_add_u32 v15, 49344, v15
    s_lshl_b32 s36, s35, 8
    v_add_u32 v13, s36, v13
    v_lshlrev_b32 v18, 5, v18
    v_sub_u32 v14, v13, v18
    v_add_u32 v13, v13, v18
    s_mov_b32 s42, 0
    s_mov_b32 s43, 0
    s_mov_b32 s48, 0
    v_mov_b32 v17, v12
    v_mov_b32 v18, v13
    v_mov_b32 v19, v14
    v_mov_b32 v20, v15
    s_waitcnt vmcnt(4)
    s_barrier
    s_waitcnt vmcnt(0)
    s_barrier
    s_setprio 0
    s_waitcnt lgkmcnt(0)
    s_barrier
    ds_read_b128 v[136:139], v17 offset:0
    ds_read_b128 v[140:143], v17 offset:2048
    ds_read_b128 v[144:147], v17 offset:4096
    ds_read_b128 v[148:151], v17 offset:6144
    ds_read_b64_tr_b16 v[152:153], v18 offset:0
    ds_read_b64_tr_b16 v[154:155], v18 offset:7168
    ds_read_b64_tr_b16 v[156:157], v19 offset:32
    ds_read_b64_tr_b16 v[158:159], v19 offset:7200
    ds_read_b64_tr_b16 v[160:161], v18 offset:64
    ds_read_b64_tr_b16 v[162:163], v18 offset:7232
    ds_read_b64_tr_b16 v[164:165], v19 offset:96
    ds_read_b64_tr_b16 v[166:167], v19 offset:7264
    ds_read_b64_tr_b16 v[168:169], v18 offset:128
    ds_read_b64_tr_b16 v[170:171], v18 offset:7296
    ds_read_b64_tr_b16 v[172:173], v19 offset:160
    ds_read_b64_tr_b16 v[174:175], v19 offset:7328
    ds_read_b64_tr_b16 v[176:177], v20 offset:0
    ds_read_b64_tr_b16 v[178:179], v20 offset:7168
    s_waitcnt lgkmcnt(0)
    v_mfma_f32_16x16x32_bf16 v[24:27], v[152:155], v[136:139], 0
    ds_read_b128 v[180:183], v17 offset:1024
    v_mfma_f32_16x16x32_bf16 v[52:55], v[152:155], v[140:143], 0
    ds_read_b128 v[184:187], v17 offset:3072
    v_mfma_f32_16x16x32_bf16 v[80:83], v[152:155], v[144:147], 0
    ds_read_b128 v[188:191], v17 offset:5120
    v_mfma_f32_16x16x32_bf16 v[108:111], v[152:155], v[148:151], 0
    ds_read_b128 v[192:195], v17 offset:7168
    v_mfma_f32_16x16x32_bf16 v[112:115], v[156:159], v[148:151], 0
    ds_read_b64_tr_b16 v[196:197], v18 offset:14336
    v_mfma_f32_16x16x32_bf16 v[84:87], v[156:159], v[144:147], 0
    ds_read_b64_tr_b16 v[198:199], v18 offset:21504
    v_mfma_f32_16x16x32_bf16 v[56:59], v[156:159], v[140:143], 0
    v_mfma_f32_16x16x32_bf16 v[28:31], v[156:159], v[136:139], 0
    ds_read_b64_tr_b16 v[200:201], v19 offset:14368
    v_mfma_f32_16x16x32_bf16 v[32:35], v[160:163], v[136:139], 0
    ds_read_b64_tr_b16 v[202:203], v19 offset:21536
    v_mfma_f32_16x16x32_bf16 v[60:63], v[160:163], v[140:143], 0
    ds_read_b64_tr_b16 v[204:205], v18 offset:14400
    v_mfma_f32_16x16x32_bf16 v[88:91], v[160:163], v[144:147], 0
    ds_read_b64_tr_b16 v[206:207], v18 offset:21568
    v_mfma_f32_16x16x32_bf16 v[116:119], v[160:163], v[148:151], 0
    ds_read_b64_tr_b16 v[208:209], v19 offset:14432
    v_mfma_f32_16x16x32_bf16 v[120:123], v[164:167], v[148:151], 0
    ds_read_b64_tr_b16 v[210:211], v19 offset:21600
    v_mfma_f32_16x16x32_bf16 v[92:95], v[164:167], v[144:147], 0
    v_mfma_f32_16x16x32_bf16 v[64:67], v[164:167], v[140:143], 0
    ds_read_b64_tr_b16 v[212:213], v18 offset:14464
    v_mfma_f32_16x16x32_bf16 v[36:39], v[164:167], v[136:139], 0
    ds_read_b64_tr_b16 v[214:215], v18 offset:21632
    v_mfma_f32_16x16x32_bf16 v[40:43], v[168:171], v[136:139], 0
    ds_read_b64_tr_b16 v[216:217], v19 offset:14496
    v_mfma_f32_16x16x32_bf16 v[68:71], v[168:171], v[140:143], 0
    ds_read_b64_tr_b16 v[218:219], v19 offset:21664
    v_mfma_f32_16x16x32_bf16 v[96:99], v[168:171], v[144:147], 0
    ds_read_b64_tr_b16 v[220:221], v20 offset:14336
    v_mfma_f32_16x16x32_bf16 v[124:127], v[168:171], v[148:151], 0
    ds_read_b64_tr_b16 v[222:223], v20 offset:21504
    v_mfma_f32_16x16x32_bf16 v[128:131], v[172:175], v[148:151], 0
    s_add_u32 s42, s42, 16384
    s_cmp_eq_u32 s42, 49152
    v_mfma_f32_16x16x32_bf16 v[100:103], v[172:175], v[144:147], 0
    s_cselect_b32 s42, 0, s42
    s_add_u32 s48, s48, 28672
    v_mfma_f32_16x16x32_bf16 v[72:75], v[172:175], v[140:143], 0
    s_cmp_eq_u32 s48, 86016
    s_cselect_b32 s48, 0, s48
    v_mfma_f32_16x16x32_bf16 v[44:47], v[172:175], v[136:139], 0
    v_add_u32 v17, s42, v12
    v_add_u32 v18, s48, v13
    v_mfma_f32_16x16x32_bf16 v[48:51], v[176:179], v[136:139], 0
    v_add_u32 v19, s48, v14
    v_add_u32 v20, s48, v15
    v_mfma_f32_16x16x32_bf16 v[76:79], v[176:179], v[140:143], 0
    v_mfma_f32_16x16x32_bf16 v[104:107], v[176:179], v[144:147], 0
    v_mfma_f32_16x16x32_bf16 v[132:135], v[176:179], v[148:151], 0
    s_waitcnt lgkmcnt(0)
    v_mfma_f32_16x16x32_bf16 v[24:27], v[196:199], v[180:183], v[24:27]
    v_mfma_f32_16x16x32_bf16 v[52:55], v[196:199], v[184:187], v[52:55]
    v_mfma_f32_16x16x32_bf16 v[80:83], v[196:199], v[188:191], v[80:83]
    v_mfma_f32_16x16x32_bf16 v[108:111], v[196:199], v[192:195], v[108:111]
    v_mfma_f32_16x16x32_bf16 v[112:115], v[200:203], v[192:195], v[112:115]
    v_mfma_f32_16x16x32_bf16 v[84:87], v[200:203], v[188:191], v[84:87]
    v_mfma_f32_16x16x32_bf16 v[56:59], v[200:203], v[184:187], v[56:59]
    v_mfma_f32_16x16x32_bf16 v[28:31], v[200:203], v[180:183], v[28:31]
    v_mfma_f32_16x16x32_bf16 v[32:35], v[204:207], v[180:183], v[32:35]
    v_mfma_f32_16x16x32_bf16 v[60:63], v[204:207], v[184:187], v[60:63]
    v_mfma_f32_16x16x32_bf16 v[88:91], v[204:207], v[188:191], v[88:91]
    v_mfma_f32_16x16x32_bf16 v[116:119], v[204:207], v[192:195], v[116:119]
    v_mfma_f32_16x16x32_bf16 v[120:123], v[208:211], v[192:195], v[120:123]
    v_mfma_f32_16x16x32_bf16 v[92:95], v[208:211], v[188:191], v[92:95]
    v_mfma_f32_16x16x32_bf16 v[64:67], v[208:211], v[184:187], v[64:67]
    v_mfma_f32_16x16x32_bf16 v[36:39], v[208:211], v[180:183], v[36:39]
    v_mfma_f32_16x16x32_bf16 v[40:43], v[212:215], v[180:183], v[40:43]
    v_mfma_f32_16x16x32_bf16 v[68:71], v[212:215], v[184:187], v[68:71]
    v_mfma_f32_16x16x32_bf16 v[96:99], v[212:215], v[188:191], v[96:99]
    v_mfma_f32_16x16x32_bf16 v[124:127], v[212:215], v[192:195], v[124:127]
    v_mfma_f32_16x16x32_bf16 v[128:131], v[216:219], v[192:195], v[128:131]
    s_add_u32 s43, s43, 1
    v_mfma_f32_16x16x32_bf16 v[100:103], v[216:219], v[188:191], v[100:103]
    v_mfma_f32_16x16x32_bf16 v[72:75], v[216:219], v[184:187], v[72:75]
    v_mfma_f32_16x16x32_bf16 v[44:47], v[216:219], v[180:183], v[44:47]
    v_mfma_f32_16x16x32_bf16 v[48:51], v[220:223], v[180:183], v[48:51]
    v_mfma_f32_16x16x32_bf16 v[76:79], v[220:223], v[184:187], v[76:79]
    v_mfma_f32_16x16x32_bf16 v[104:107], v[220:223], v[188:191], v[104:107]
    v_mfma_f32_16x16x32_bf16 v[132:135], v[220:223], v[192:195], v[132:135]
    s_load_dwordx2 s[6:7], s[0:1], 88
    s_mov_b32 s16, s62
    s_mov_b32 s17, s63
    s_mov_b32 s18, 0x1be000
    s_mov_b32 s19, 0x20000
    s_mul_i32 s39, s37, 229376
    s_mul_i32 s40, s29, 7
    s_lshl2_add_u32 s41, s35, s40
    s_add_u32 s36, s41, 0
    s_lshr_b32 s53, s36, 3
    s_lshl_b32 s53, s53, 14
    s_and_b32 s44, s36, 7
    s_lshl_b32 s44, s44, 10
    s_add_u32 s44, s44, s53
    s_add_u32 s44, s44, s39
    s_add_u32 s36, s41, 1
    s_lshr_b32 s53, s36, 3
    s_lshl_b32 s53, s53, 14
    s_and_b32 s45, s36, 7
    s_lshl_b32 s45, s45, 10
    s_add_u32 s45, s45, s53
    s_add_u32 s45, s45, s39
    s_add_u32 s36, s41, 2
    s_lshr_b32 s53, s36, 3
    s_lshl_b32 s53, s53, 14
    s_and_b32 s46, s36, 7
    s_lshl_b32 s46, s46, 10
    s_add_u32 s46, s46, s53
    s_add_u32 s46, s46, s39
    s_add_u32 s36, s40, 3
    s_lshr_b32 s53, s36, 3
    s_lshl_b32 s53, s53, 14
    s_and_b32 s47, s36, 7
    s_lshl_b32 s47, s47, 10
    s_add_u32 s47, s47, s53
    s_add_u32 s47, s47, s39
    s_lshl_b32 s36, s35, 9
    s_add_u32 s47, s47, s36
    s_lshl1_add_u32 s49, s31, s34
    s_lshl_b32 s49, s49, 7
    s_add_u32 s49, s49, s55
    s_add_u32 s49, s49, 0x1000
    s_lshl_b32 s86, s60, 24
    s_lshl_b32 s87, s94, 13
    s_add_u32 s86, s86, s87
    s_add_u32 s86, s86, 167772160
    s_add_u32 s84, s4, s86
    s_addc_u32 s85, s5, 0
    s_mov_b32 s86, 8380416
    s_mov_b32 s87, 0x20000
    s_add_u32 s88, s62, 0x480000
    s_addc_u32 s89, s63, 0
    s_mov_b32 s90, 0x7e000
    s_mov_b32 s91, 0x20000
    s_add_u32 s24, s62, 0x400000
    s_addc_u32 s25, s63, 0
    s_mov_b32 s26, 0x7e000
    s_mov_b32 s27, 0x20000
    s_lshl1_add_u32 s39, s33, s35
    s_lshl_b32 s36, s39, 1
    s_lshr_b32 s53, s36, 3
    s_lshl_b32 s53, s53, 14
    s_and_b32 s40, s36, 7
    s_lshl_b32 s40, s40, 10
    s_add_u32 s40, s40, s53
    s_lshl1_add_u32 s38, s31, s37
    s_lshl_b32 s36, s38, 16
    s_add_u32 s40, s40, s36
    s_add_u32 s12, s40, 65536
    s_xor_b32 s41, s40, 0x20000
    s_lshl3_add_u32 s38, s28, s38
    s_lshl_b32 s39, s39, 7
    s_lshl_b32 s13, s38, 16
    s_add_u32 s13, s13, s39
    s_add_u32 s14, s13, 65536
    s_lshl_b32 s38, s38, 15
    s_add_u32 s38, s38, s39
    s_add_u32 s39, s38, 32768
    s_mov_b32 s15, 0xffff0000
    s_waitcnt lgkmcnt(0)
    s_mov_b32 s20, s6
    s_mov_b32 s21, s7
    s_mov_b32 s22, 0x400000
    s_mov_b32 s23, 0x20000
    v_lshrrev_b32 v254, 1, v23
    v_lshlrev_b32 v254, 8, v254
    v_lshl_add_u32 v254, v22, 4, v254
    v_and_b32 v6, 1, v23
    v_lshl_add_u32 v254, v6, 3, v254
    v_lshrrev_b32 v6, 2, v22
    v_cmp_eq_u32 vcc, v6, v23
    v_and_b32 v6, 1, v22
    v_lshlrev_b32 v6, 4, v6
    v_mov_b32 v224, 0x3f80
    v_lshlrev_b32 v6, v6, v224
    v_cndmask_b32 v6, 0, v6, vcc
    v_and_b32 v224, 2, v22
    v_cmp_eq_u32 vcc, 0, v224
    v_mov_b32 v224, 0
    v_mov_b32 v225, 0
    v_mov_b32 v228, 0
    v_mov_b32 v229, 0
    v_cndmask_b32 v226, 0, v6, vcc
    v_cndmask_b32 v227, v6, v224, vcc
    v_and_b32 v6, 3, v22
    v_lshrrev_b32 v255, 2, v22
    v_lshlrev_b32 v255, 14, v255
    v_lshl_add_u32 v255, v6, 11, v255
    v_lshl_add_u32 v255, v23, 4, v255
    v_mov_b32 v8, 1
    v_mov_b32 v9, 0x7f000000
    v_writelane_b32 v9, 0, 0
    v_and_b32 v11, 1, v23
    v_lshlrev_b32 v10, 11, v22
    v_lshl_add_u32 v10, v11, 5, v10
    v_lshrrev_b32 v11, 1, v23
    v_lshl_add_u32 v10, v11, 4, v10
    v_lshrrev_b32 v11, 3, v22
    v_mul_u32_u24 v11, 16320, v11
    v_sub_u32 v10, v10, v11
    v_add_u32 v11, 16384, v10
    s_mul_i32 s36, s35, 448
    s_add_u32 s36, s36, 159744
    v_lshlrev_b32 v6, 4, v23
    v_add_u32 v6, s36, v6
    s_lshl_b32 s36, s34, 10
    s_add_u32 s36, s36, 160768
    v_lshlrev_b32 v7, 4, v22
    v_add_u32 v7, s36, v7
    s_lshl1_add_u32 s36, s37, s35
    s_lshl2_add_u32 s36, s31, s36
    s_lshl_b32 s36, s36, 10
    v_add_u32 v22, s36, v2
    v_xor_b32 v23, 4096, v22
    s_barrier
    ds_read_b128 v[136:139], v17 offset:0
    ds_read_b128 v[140:143], v17 offset:2048
    ds_read_b128 v[144:147], v17 offset:4096
    ds_read_b128 v[148:151], v17 offset:6144
    ds_read_b64_tr_b16 v[152:153], v18 offset:0
    ds_read_b64_tr_b16 v[154:155], v18 offset:7168
    ds_read_b64_tr_b16 v[156:157], v19 offset:32
    ds_read_b64_tr_b16 v[158:159], v19 offset:7200
    ds_read_b64_tr_b16 v[160:161], v18 offset:64
    ds_read_b64_tr_b16 v[162:163], v18 offset:7232
    ds_read_b64_tr_b16 v[164:165], v19 offset:96
    ds_read_b64_tr_b16 v[166:167], v19 offset:7264
    ds_read_b64_tr_b16 v[168:169], v18 offset:128
    ds_read_b64_tr_b16 v[170:171], v18 offset:7296
    ds_read_b64_tr_b16 v[172:173], v19 offset:160
    ds_read_b64_tr_b16 v[174:175], v19 offset:7328
    ds_read_b64_tr_b16 v[176:177], v20 offset:0
    ds_read_b64_tr_b16 v[178:179], v20 offset:7168
mm_20:
    s_waitcnt lgkmcnt(0)
    v_mfma_f32_16x16x32_bf16 v[24:27], v[152:155], v[136:139], v[24:27]
    ds_read_b128 v[180:183], v17 offset:1024
    v_mfma_f32_16x16x32_bf16 v[52:55], v[152:155], v[140:143], v[52:55]
    ds_read_b128 v[184:187], v17 offset:3072
    v_mfma_f32_16x16x32_bf16 v[80:83], v[152:155], v[144:147], v[80:83]
    ds_read_b128 v[188:191], v17 offset:5120
    v_mfma_f32_16x16x32_bf16 v[108:111], v[152:155], v[148:151], v[108:111]
    ds_read_b128 v[192:195], v17 offset:7168
    v_mfma_f32_16x16x32_bf16 v[112:115], v[156:159], v[148:151], v[112:115]
    ds_read_b64_tr_b16 v[196:197], v18 offset:14336
    v_mfma_f32_16x16x32_bf16 v[84:87], v[156:159], v[144:147], v[84:87]
    ds_read_b64_tr_b16 v[198:199], v18 offset:21504
    v_mfma_f32_16x16x32_bf16 v[56:59], v[156:159], v[140:143], v[56:59]
    v_mfma_f32_16x16x32_bf16 v[28:31], v[156:159], v[136:139], v[28:31]
    ds_read_b64_tr_b16 v[200:201], v19 offset:14368
    v_mfma_f32_16x16x32_bf16 v[32:35], v[160:163], v[136:139], v[32:35]
    ds_read_b64_tr_b16 v[202:203], v19 offset:21536
    v_mfma_f32_16x16x32_bf16 v[60:63], v[160:163], v[140:143], v[60:63]
    ds_read_b64_tr_b16 v[204:205], v18 offset:14400
    v_mfma_f32_16x16x32_bf16 v[88:91], v[160:163], v[144:147], v[88:91]
    ds_read_b64_tr_b16 v[206:207], v18 offset:21568
    v_mfma_f32_16x16x32_bf16 v[116:119], v[160:163], v[148:151], v[116:119]
    ds_read_b64_tr_b16 v[208:209], v19 offset:14432
    v_mfma_f32_16x16x32_bf16 v[120:123], v[164:167], v[148:151], v[120:123]
    ds_read_b64_tr_b16 v[210:211], v19 offset:21600
    v_mfma_f32_16x16x32_bf16 v[92:95], v[164:167], v[144:147], v[92:95]
    v_mfma_f32_16x16x32_bf16 v[64:67], v[164:167], v[140:143], v[64:67]
    ds_read_b64_tr_b16 v[212:213], v18 offset:14464
    v_mfma_f32_16x16x32_bf16 v[36:39], v[164:167], v[136:139], v[36:39]
    ds_read_b64_tr_b16 v[214:215], v18 offset:21632
    v_mfma_f32_16x16x32_bf16 v[40:43], v[168:171], v[136:139], v[40:43]
    ds_read_b64_tr_b16 v[216:217], v19 offset:14496
    v_mfma_f32_16x16x32_bf16 v[68:71], v[168:171], v[140:143], v[68:71]
    ds_read_b64_tr_b16 v[218:219], v19 offset:21664
    v_mfma_f32_16x16x32_bf16 v[96:99], v[168:171], v[144:147], v[96:99]
    ds_read_b64_tr_b16 v[220:221], v20 offset:14336
    v_mfma_f32_16x16x32_bf16 v[124:127], v[168:171], v[148:151], v[124:127]
    ds_read_b64_tr_b16 v[222:223], v20 offset:21504
    v_mfma_f32_16x16x32_bf16 v[128:131], v[172:175], v[148:151], v[128:131]
    s_add_u32 s42, s42, 16384
    s_cmp_eq_u32 s42, 49152
    v_mfma_f32_16x16x32_bf16 v[100:103], v[172:175], v[144:147], v[100:103]
    s_cselect_b32 s42, 0, s42
    s_add_u32 s48, s48, 28672
    v_mfma_f32_16x16x32_bf16 v[72:75], v[172:175], v[140:143], v[72:75]
    s_cmp_eq_u32 s48, 86016
    s_cselect_b32 s48, 0, s48
    v_mfma_f32_16x16x32_bf16 v[44:47], v[172:175], v[136:139], v[44:47]
    v_add_u32 v17, s42, v12
    v_add_u32 v18, s48, v13
    v_mfma_f32_16x16x32_bf16 v[48:51], v[176:179], v[136:139], v[48:51]
    v_add_u32 v19, s48, v14
    v_add_u32 v20, s48, v15
    v_mfma_f32_16x16x32_bf16 v[76:79], v[176:179], v[140:143], v[76:79]
    v_mfma_f32_16x16x32_bf16 v[104:107], v[176:179], v[144:147], v[104:107]
    v_mfma_f32_16x16x32_bf16 v[132:135], v[176:179], v[148:151], v[132:135]
    s_waitcnt lgkmcnt(0)
    s_barrier
    v_mfma_f32_16x16x32_bf16 v[24:27], v[196:199], v[180:183], v[24:27]
    ds_read_b128 v[136:139], v17 offset:0
    v_mfma_f32_16x16x32_bf16 v[52:55], v[196:199], v[184:187], v[52:55]
    ds_read_b128 v[140:143], v17 offset:2048
    v_mfma_f32_16x16x32_bf16 v[80:83], v[196:199], v[188:191], v[80:83]
    ds_read_b128 v[144:147], v17 offset:4096
    v_mfma_f32_16x16x32_bf16 v[108:111], v[196:199], v[192:195], v[108:111]
    ds_read_b128 v[148:151], v17 offset:6144
    v_mfma_f32_16x16x32_bf16 v[112:115], v[200:203], v[192:195], v[112:115]
    ds_read_b64_tr_b16 v[152:153], v18 offset:0
    v_mfma_f32_16x16x32_bf16 v[84:87], v[200:203], v[188:191], v[84:87]
    ds_read_b64_tr_b16 v[154:155], v18 offset:7168
    v_mfma_f32_16x16x32_bf16 v[56:59], v[200:203], v[184:187], v[56:59]
    v_mfma_f32_16x16x32_bf16 v[28:31], v[200:203], v[180:183], v[28:31]
    ds_read_b64_tr_b16 v[156:157], v19 offset:32
    v_mfma_f32_16x16x32_bf16 v[32:35], v[204:207], v[180:183], v[32:35]
    ds_read_b64_tr_b16 v[158:159], v19 offset:7200
    v_mfma_f32_16x16x32_bf16 v[60:63], v[204:207], v[184:187], v[60:63]
    ds_read_b64_tr_b16 v[160:161], v18 offset:64
    v_mfma_f32_16x16x32_bf16 v[88:91], v[204:207], v[188:191], v[88:91]
    ds_read_b64_tr_b16 v[162:163], v18 offset:7232
    v_mfma_f32_16x16x32_bf16 v[116:119], v[204:207], v[192:195], v[116:119]
    ds_read_b64_tr_b16 v[164:165], v19 offset:96
    v_mfma_f32_16x16x32_bf16 v[120:123], v[208:211], v[192:195], v[120:123]
    ds_read_b64_tr_b16 v[166:167], v19 offset:7264
    v_mfma_f32_16x16x32_bf16 v[92:95], v[208:211], v[188:191], v[92:95]
    v_mfma_f32_16x16x32_bf16 v[64:67], v[208:211], v[184:187], v[64:67]
    ds_read_b64_tr_b16 v[168:169], v18 offset:128
    v_mfma_f32_16x16x32_bf16 v[36:39], v[208:211], v[180:183], v[36:39]
    ds_read_b64_tr_b16 v[170:171], v18 offset:7296
    v_mfma_f32_16x16x32_bf16 v[40:43], v[212:215], v[180:183], v[40:43]
    ds_read_b64_tr_b16 v[172:173], v19 offset:160
    v_mfma_f32_16x16x32_bf16 v[68:71], v[212:215], v[184:187], v[68:71]
    ds_read_b64_tr_b16 v[174:175], v19 offset:7328
    v_mfma_f32_16x16x32_bf16 v[96:99], v[212:215], v[188:191], v[96:99]
    ds_read_b64_tr_b16 v[176:177], v20 offset:0
    v_mfma_f32_16x16x32_bf16 v[124:127], v[212:215], v[192:195], v[124:127]
    ds_read_b64_tr_b16 v[178:179], v20 offset:7168
    v_mfma_f32_16x16x32_bf16 v[128:131], v[216:219], v[192:195], v[128:131]
    s_add_u32 s43, s43, 1
    v_mfma_f32_16x16x32_bf16 v[100:103], v[216:219], v[188:191], v[100:103]
    s_cmp_lt_u32 s43, 15
    v_mfma_f32_16x16x32_bf16 v[72:75], v[216:219], v[184:187], v[72:75]
    v_mfma_f32_16x16x32_bf16 v[44:47], v[216:219], v[180:183], v[44:47]
    v_mfma_f32_16x16x32_bf16 v[48:51], v[220:223], v[180:183], v[48:51]
    v_mfma_f32_16x16x32_bf16 v[76:79], v[220:223], v[184:187], v[76:79]
    v_mfma_f32_16x16x32_bf16 v[104:107], v[220:223], v[188:191], v[104:107]
    v_mfma_f32_16x16x32_bf16 v[132:135], v[220:223], v[192:195], v[132:135]
    s_cbranch_scc1 mm_20
    s_waitcnt lgkmcnt(0)
    v_mfma_f32_16x16x32_bf16 v[24:27], v[152:155], v[136:139], v[24:27]
    ds_read_b128 v[180:183], v17 offset:1024
    v_mfma_f32_16x16x32_bf16 v[52:55], v[152:155], v[140:143], v[52:55]
    ds_read_b128 v[184:187], v17 offset:3072
    v_mfma_f32_16x16x32_bf16 v[80:83], v[152:155], v[144:147], v[80:83]
    ds_read_b128 v[188:191], v17 offset:5120
    v_mfma_f32_16x16x32_bf16 v[108:111], v[152:155], v[148:151], v[108:111]
    ds_read_b128 v[192:195], v17 offset:7168
    v_mfma_f32_16x16x32_bf16 v[112:115], v[156:159], v[148:151], v[112:115]
    ds_read_b64_tr_b16 v[196:197], v18 offset:14336
    v_mfma_f32_16x16x32_bf16 v[84:87], v[156:159], v[144:147], v[84:87]
    ds_read_b64_tr_b16 v[198:199], v18 offset:21504
    v_mfma_f32_16x16x32_bf16 v[56:59], v[156:159], v[140:143], v[56:59]
    v_mfma_f32_16x16x32_bf16 v[28:31], v[156:159], v[136:139], v[28:31]
    ds_read_b64_tr_b16 v[200:201], v19 offset:14368
    v_mfma_f32_16x16x32_bf16 v[32:35], v[160:163], v[136:139], v[32:35]
    ds_read_b64_tr_b16 v[202:203], v19 offset:21536
    v_mfma_f32_16x16x32_bf16 v[60:63], v[160:163], v[140:143], v[60:63]
    ds_read_b64_tr_b16 v[204:205], v18 offset:14400
    v_mfma_f32_16x16x32_bf16 v[88:91], v[160:163], v[144:147], v[88:91]
    ds_read_b64_tr_b16 v[206:207], v18 offset:21568
    v_mfma_f32_16x16x32_bf16 v[116:119], v[160:163], v[148:151], v[116:119]
    ds_read_b64_tr_b16 v[208:209], v19 offset:14432
    v_mfma_f32_16x16x32_bf16 v[120:123], v[164:167], v[148:151], v[120:123]
    ds_read_b64_tr_b16 v[210:211], v19 offset:21600
    v_mfma_f32_16x16x32_bf16 v[92:95], v[164:167], v[144:147], v[92:95]
    v_mfma_f32_16x16x32_bf16 v[64:67], v[164:167], v[140:143], v[64:67]
    ds_read_b64_tr_b16 v[212:213], v18 offset:14464
    v_mfma_f32_16x16x32_bf16 v[36:39], v[164:167], v[136:139], v[36:39]
    ds_read_b64_tr_b16 v[214:215], v18 offset:21632
    v_mfma_f32_16x16x32_bf16 v[40:43], v[168:171], v[136:139], v[40:43]
    ds_read_b64_tr_b16 v[216:217], v19 offset:14496
    v_mfma_f32_16x16x32_bf16 v[68:71], v[168:171], v[140:143], v[68:71]
    ds_read_b64_tr_b16 v[218:219], v19 offset:21664
    v_mfma_f32_16x16x32_bf16 v[96:99], v[168:171], v[144:147], v[96:99]
    ds_read_b64_tr_b16 v[220:221], v20 offset:14336
    v_mfma_f32_16x16x32_bf16 v[124:127], v[168:171], v[148:151], v[124:127]
    ds_read_b64_tr_b16 v[222:223], v20 offset:21504
    v_mfma_f32_16x16x32_bf16 v[128:131], v[172:175], v[148:151], v[128:131]
    v_mfma_f32_16x16x32_bf16 v[100:103], v[172:175], v[144:147], v[100:103]
    v_mfma_f32_16x16x32_bf16 v[72:75], v[172:175], v[140:143], v[72:75]
    v_mfma_f32_16x16x32_bf16 v[44:47], v[172:175], v[136:139], v[44:47]
    v_mfma_f32_16x16x32_bf16 v[48:51], v[176:179], v[136:139], v[48:51]
    v_mfma_f32_16x16x32_bf16 v[76:79], v[176:179], v[140:143], v[76:79]
    v_mfma_f32_16x16x32_bf16 v[104:107], v[176:179], v[144:147], v[104:107]
    v_mfma_f32_16x16x32_bf16 v[132:135], v[176:179], v[148:151], v[132:135]
    s_waitcnt lgkmcnt(0)
    s_barrier
    v_mfma_f32_16x16x32_bf16 v[24:27], v[196:199], v[180:183], v[24:27]
    ds_read_b128 v[136:139], v6 offset:0
    v_mfma_f32_16x16x32_bf16 v[52:55], v[196:199], v[184:187], v[52:55]
    ds_read_b128 v[140:143], v6 offset:64
    v_mfma_f32_16x16x32_bf16 v[80:83], v[196:199], v[188:191], v[80:83]
    v_mfma_f32_16x16x32_bf16 v[108:111], v[196:199], v[192:195], v[108:111]
    ds_read_b128 v[144:147], v6 offset:128
    v_mfma_f32_16x16x32_bf16 v[112:115], v[200:203], v[192:195], v[112:115]
    v_mfma_f32_16x16x32_bf16 v[84:87], v[200:203], v[188:191], v[84:87]
    ds_read_b128 v[148:151], v6 offset:192
    v_mfma_f32_16x16x32_bf16 v[56:59], v[200:203], v[184:187], v[56:59]
    v_mfma_f32_16x16x32_bf16 v[28:31], v[200:203], v[180:183], v[28:31]
    ds_read_b128 v[152:155], v6 offset:256
    v_mfma_f32_16x16x32_bf16 v[32:35], v[204:207], v[180:183], v[32:35]
    v_mfma_f32_16x16x32_bf16 v[60:63], v[204:207], v[184:187], v[60:63]
    ds_read_b128 v[156:159], v6 offset:320
    v_mfma_f32_16x16x32_bf16 v[88:91], v[204:207], v[188:191], v[88:91]
    v_mfma_f32_16x16x32_bf16 v[116:119], v[204:207], v[192:195], v[116:119]
    ds_read_b128 v[160:163], v6 offset:384
    v_mfma_f32_16x16x32_bf16 v[120:123], v[208:211], v[192:195], v[120:123]
    v_mfma_f32_16x16x32_bf16 v[92:95], v[208:211], v[188:191], v[92:95]
    ds_read_b128 v[164:167], v7 offset:0
    v_mfma_f32_16x16x32_bf16 v[64:67], v[208:211], v[184:187], v[64:67]
    v_mfma_f32_16x16x32_bf16 v[36:39], v[208:211], v[180:183], v[36:39]
    ds_read_b128 v[168:171], v7 offset:256
    v_mfma_f32_16x16x32_bf16 v[40:43], v[212:215], v[180:183], v[40:43]
    v_mfma_f32_16x16x32_bf16 v[68:71], v[212:215], v[184:187], v[68:71]
    ds_read_b128 v[172:175], v7 offset:512
    v_mfma_f32_16x16x32_bf16 v[96:99], v[212:215], v[188:191], v[96:99]
    v_mfma_f32_16x16x32_bf16 v[124:127], v[212:215], v[192:195], v[124:127]
    ds_read_b128 v[176:179], v7 offset:768
    v_mfma_f32_16x16x32_bf16 v[128:131], v[216:219], v[192:195], v[128:131]
    v_mfma_f32_16x16x32_bf16 v[100:103], v[216:219], v[188:191], v[100:103]
    v_mfma_f32_16x16x32_bf16 v[72:75], v[216:219], v[184:187], v[72:75]
    v_mfma_f32_16x16x32_bf16 v[44:47], v[216:219], v[180:183], v[44:47]
    v_mfma_f32_16x16x32_bf16 v[48:51], v[220:223], v[180:183], v[48:51]
    v_mfma_f32_16x16x32_bf16 v[76:79], v[220:223], v[184:187], v[76:79]
    v_mfma_f32_16x16x32_bf16 v[104:107], v[220:223], v[188:191], v[104:107]
    v_mfma_f32_16x16x32_bf16 v[132:135], v[220:223], v[192:195], v[132:135]
    s_waitcnt lgkmcnt(0)
    s_nop 7
    v_pk_fma_f32 v[24:25], v[164:165], v[136:137], v[24:25] op_sel_hi:[0,1,1] neg_lo:[1,0,0] neg_hi:[1,0,0]
    v_pk_fma_f32 v[26:27], v[164:165], v[138:139], v[26:27] op_sel_hi:[0,1,1] neg_lo:[1,0,0] neg_hi:[1,0,0]
    v_pk_fma_f32 v[28:29], v[164:165], v[140:141], v[28:29] op_sel_hi:[0,1,1] neg_lo:[1,0,0] neg_hi:[1,0,0]
    v_pk_fma_f32 v[30:31], v[164:165], v[142:143], v[30:31] op_sel_hi:[0,1,1] neg_lo:[1,0,0] neg_hi:[1,0,0]
    v_pk_mul_f32 v[192:193], v[24:25], v[24:25]
    v_pk_mul_f32 v[194:195], v[26:27], v[26:27]
    v_pk_mul_f32 v[196:197], v[28:29], v[28:29]
    v_pk_mul_f32 v[198:199], v[30:31], v[30:31]
    v_pk_fma_f32 v[192:193], v[192:193], v[166:167], v[166:167] op_sel:[0,1,0] op_sel_hi:[1,1,0]
    v_pk_fma_f32 v[194:195], v[194:195], v[166:167], v[166:167] op_sel:[0,1,0] op_sel_hi:[1,1,0]
    v_pk_fma_f32 v[196:197], v[196:197], v[166:167], v[166:167] op_sel:[0,1,0] op_sel_hi:[1,1,0]
    v_pk_fma_f32 v[198:199], v[198:199], v[166:167], v[166:167] op_sel:[0,1,0] op_sel_hi:[1,1,0]
    v_pk_mul_f32 v[192:193], v[192:193], v[24:25]
    v_pk_mul_f32 v[194:195], v[194:195], v[26:27]
    v_pk_mul_f32 v[196:197], v[196:197], v[28:29]
    v_pk_mul_f32 v[198:199], v[198:199], v[30:31]
    v_exp_f32 v192, v192
    v_exp_f32 v193, v193
    v_exp_f32 v194, v194
    v_exp_f32 v195, v195
    v_exp_f32 v196, v196
    v_exp_f32 v197, v197
    v_exp_f32 v198, v198
    v_exp_f32 v199, v199
    v_pk_fma_f32 v[192:193], v[192:193], v[164:165], v[164:165] op_sel:[0,1,1] op_sel_hi:[1,1,1]
    v_pk_fma_f32 v[194:195], v[194:195], v[164:165], v[164:165] op_sel:[0,1,1] op_sel_hi:[1,1,1]
    v_pk_fma_f32 v[196:197], v[196:197], v[164:165], v[164:165] op_sel:[0,1,1] op_sel_hi:[1,1,1]
    v_pk_fma_f32 v[198:199], v[198:199], v[164:165], v[164:165] op_sel:[0,1,1] op_sel_hi:[1,1,1]
    v_rcp_f32 v192, v192
    v_rcp_f32 v193, v193
    v_rcp_f32 v194, v194
    v_rcp_f32 v195, v195
    v_rcp_f32 v196, v196
    v_rcp_f32 v197, v197
    v_rcp_f32 v198, v198
    v_rcp_f32 v199, v199
    v_pk_mul_f32 v[24:25], v[24:25], v[192:193]
    v_pk_mul_f32 v[26:27], v[26:27], v[194:195]
    v_pk_mul_f32 v[28:29], v[28:29], v[196:197]
    v_pk_mul_f32 v[30:31], v[30:31], v[198:199]
    v_cvt_pk_bf16_f32 v24, v24, v25
    v_cvt_pk_bf16_f32 v25, v26, v27
    v_cvt_pk_bf16_f32 v26, v28, v29
    v_cvt_pk_bf16_f32 v27, v30, v31
    ds_write_b128 v22, v[24:27] offset:0
    s_add_u32 s36, s44, 0
    buffer_store_dwordx4 v[24:27], v2, s[16:19], s36 offen sc1
    v_pk_fma_f32 v[52:53], v[168:169], v[136:137], v[52:53] op_sel_hi:[0,1,1] neg_lo:[1,0,0] neg_hi:[1,0,0]
    v_pk_fma_f32 v[54:55], v[168:169], v[138:139], v[54:55] op_sel_hi:[0,1,1] neg_lo:[1,0,0] neg_hi:[1,0,0]
    v_pk_fma_f32 v[56:57], v[168:169], v[140:141], v[56:57] op_sel_hi:[0,1,1] neg_lo:[1,0,0] neg_hi:[1,0,0]
    v_pk_fma_f32 v[58:59], v[168:169], v[142:143], v[58:59] op_sel_hi:[0,1,1] neg_lo:[1,0,0] neg_hi:[1,0,0]
    v_pk_mul_f32 v[192:193], v[52:53], v[52:53]
    v_pk_mul_f32 v[194:195], v[54:55], v[54:55]
    v_pk_mul_f32 v[196:197], v[56:57], v[56:57]
    v_pk_mul_f32 v[198:199], v[58:59], v[58:59]
    v_pk_fma_f32 v[192:193], v[192:193], v[170:171], v[170:171] op_sel:[0,1,0] op_sel_hi:[1,1,0]
    v_pk_fma_f32 v[194:195], v[194:195], v[170:171], v[170:171] op_sel:[0,1,0] op_sel_hi:[1,1,0]
    v_pk_fma_f32 v[196:197], v[196:197], v[170:171], v[170:171] op_sel:[0,1,0] op_sel_hi:[1,1,0]
    v_pk_fma_f32 v[198:199], v[198:199], v[170:171], v[170:171] op_sel:[0,1,0] op_sel_hi:[1,1,0]
    v_pk_mul_f32 v[192:193], v[192:193], v[52:53]
    v_pk_mul_f32 v[194:195], v[194:195], v[54:55]
    v_pk_mul_f32 v[196:197], v[196:197], v[56:57]
    v_pk_mul_f32 v[198:199], v[198:199], v[58:59]
    v_exp_f32 v192, v192
    v_exp_f32 v193, v193
    v_exp_f32 v194, v194
    v_exp_f32 v195, v195
    v_exp_f32 v196, v196
    v_exp_f32 v197, v197
    v_exp_f32 v198, v198
    v_exp_f32 v199, v199
    v_pk_fma_f32 v[192:193], v[192:193], v[168:169], v[168:169] op_sel:[0,1,1] op_sel_hi:[1,1,1]
    v_pk_fma_f32 v[194:195], v[194:195], v[168:169], v[168:169] op_sel:[0,1,1] op_sel_hi:[1,1,1]
    v_pk_fma_f32 v[196:197], v[196:197], v[168:169], v[168:169] op_sel:[0,1,1] op_sel_hi:[1,1,1]
    v_pk_fma_f32 v[198:199], v[198:199], v[168:169], v[168:169] op_sel:[0,1,1] op_sel_hi:[1,1,1]
    v_rcp_f32 v192, v192
    v_rcp_f32 v193, v193
    v_rcp_f32 v194, v194
    v_rcp_f32 v195, v195
    v_rcp_f32 v196, v196
    v_rcp_f32 v197, v197
    v_rcp_f32 v198, v198
    v_rcp_f32 v199, v199
    v_pk_mul_f32 v[52:53], v[52:53], v[192:193]
    v_pk_mul_f32 v[54:55], v[54:55], v[194:195]
    v_pk_mul_f32 v[56:57], v[56:57], v[196:197]
    v_pk_mul_f32 v[58:59], v[58:59], v[198:199]
    v_cvt_pk_bf16_f32 v52, v52, v53
    v_cvt_pk_bf16_f32 v53, v54, v55
    v_cvt_pk_bf16_f32 v54, v56, v57
    v_cvt_pk_bf16_f32 v55, v58, v59
    ds_write_b128 v22, v[52:55] offset:2048
    s_add_u32 s36, s44, 229376
    buffer_store_dwordx4 v[52:55], v2, s[16:19], s36 offen sc1
    v_pk_fma_f32 v[80:81], v[172:173], v[136:137], v[80:81] op_sel_hi:[0,1,1] neg_lo:[1,0,0] neg_hi:[1,0,0]
    v_pk_fma_f32 v[82:83], v[172:173], v[138:139], v[82:83] op_sel_hi:[0,1,1] neg_lo:[1,0,0] neg_hi:[1,0,0]
    v_pk_fma_f32 v[84:85], v[172:173], v[140:141], v[84:85] op_sel_hi:[0,1,1] neg_lo:[1,0,0] neg_hi:[1,0,0]
    v_pk_fma_f32 v[86:87], v[172:173], v[142:143], v[86:87] op_sel_hi:[0,1,1] neg_lo:[1,0,0] neg_hi:[1,0,0]
    v_pk_mul_f32 v[192:193], v[80:81], v[80:81]
    v_pk_mul_f32 v[194:195], v[82:83], v[82:83]
    v_pk_mul_f32 v[196:197], v[84:85], v[84:85]
    v_pk_mul_f32 v[198:199], v[86:87], v[86:87]
    v_pk_fma_f32 v[192:193], v[192:193], v[174:175], v[174:175] op_sel:[0,1,0] op_sel_hi:[1,1,0]
    v_pk_fma_f32 v[194:195], v[194:195], v[174:175], v[174:175] op_sel:[0,1,0] op_sel_hi:[1,1,0]
    v_pk_fma_f32 v[196:197], v[196:197], v[174:175], v[174:175] op_sel:[0,1,0] op_sel_hi:[1,1,0]
    v_pk_fma_f32 v[198:199], v[198:199], v[174:175], v[174:175] op_sel:[0,1,0] op_sel_hi:[1,1,0]
    v_pk_mul_f32 v[192:193], v[192:193], v[80:81]
    v_pk_mul_f32 v[194:195], v[194:195], v[82:83]
    v_pk_mul_f32 v[196:197], v[196:197], v[84:85]
    v_pk_mul_f32 v[198:199], v[198:199], v[86:87]
    v_exp_f32 v192, v192
    v_exp_f32 v193, v193
    v_exp_f32 v194, v194
    v_exp_f32 v195, v195
    v_exp_f32 v196, v196
    v_exp_f32 v197, v197
    v_exp_f32 v198, v198
    v_exp_f32 v199, v199
    v_pk_fma_f32 v[192:193], v[192:193], v[172:173], v[172:173] op_sel:[0,1,1] op_sel_hi:[1,1,1]
    v_pk_fma_f32 v[194:195], v[194:195], v[172:173], v[172:173] op_sel:[0,1,1] op_sel_hi:[1,1,1]
    v_pk_fma_f32 v[196:197], v[196:197], v[172:173], v[172:173] op_sel:[0,1,1] op_sel_hi:[1,1,1]
    v_pk_fma_f32 v[198:199], v[198:199], v[172:173], v[172:173] op_sel:[0,1,1] op_sel_hi:[1,1,1]
    v_rcp_f32 v192, v192
    v_rcp_f32 v193, v193
    v_rcp_f32 v194, v194
    v_rcp_f32 v195, v195
    v_rcp_f32 v196, v196
    v_rcp_f32 v197, v197
    v_rcp_f32 v198, v198
    v_rcp_f32 v199, v199
    v_pk_mul_f32 v[80:81], v[80:81], v[192:193]
    v_pk_mul_f32 v[82:83], v[82:83], v[194:195]
    v_pk_mul_f32 v[84:85], v[84:85], v[196:197]
    v_pk_mul_f32 v[86:87], v[86:87], v[198:199]
    v_cvt_pk_bf16_f32 v80, v80, v81
    v_cvt_pk_bf16_f32 v81, v82, v83
    v_cvt_pk_bf16_f32 v82, v84, v85
    v_cvt_pk_bf16_f32 v83, v86, v87
    ds_write_b128 v23, v[80:83] offset:0
    s_add_u32 s36, s44, 458752
    buffer_store_dwordx4 v[80:83], v2, s[16:19], s36 offen sc1
    v_pk_fma_f32 v[108:109], v[176:177], v[136:137], v[108:109] op_sel_hi:[0,1,1] neg_lo:[1,0,0] neg_hi:[1,0,0]
    v_pk_fma_f32 v[110:111], v[176:177], v[138:139], v[110:111] op_sel_hi:[0,1,1] neg_lo:[1,0,0] neg_hi:[1,0,0]
    v_pk_fma_f32 v[112:113], v[176:177], v[140:141], v[112:113] op_sel_hi:[0,1,1] neg_lo:[1,0,0] neg_hi:[1,0,0]
    v_pk_fma_f32 v[114:115], v[176:177], v[142:143], v[114:115] op_sel_hi:[0,1,1] neg_lo:[1,0,0] neg_hi:[1,0,0]
    v_pk_mul_f32 v[192:193], v[108:109], v[108:109]
    v_pk_mul_f32 v[194:195], v[110:111], v[110:111]
    v_pk_mul_f32 v[196:197], v[112:113], v[112:113]
    v_pk_mul_f32 v[198:199], v[114:115], v[114:115]
    v_pk_fma_f32 v[192:193], v[192:193], v[178:179], v[178:179] op_sel:[0,1,0] op_sel_hi:[1,1,0]
    v_pk_fma_f32 v[194:195], v[194:195], v[178:179], v[178:179] op_sel:[0,1,0] op_sel_hi:[1,1,0]
    v_pk_fma_f32 v[196:197], v[196:197], v[178:179], v[178:179] op_sel:[0,1,0] op_sel_hi:[1,1,0]
    v_pk_fma_f32 v[198:199], v[198:199], v[178:179], v[178:179] op_sel:[0,1,0] op_sel_hi:[1,1,0]
    v_pk_mul_f32 v[192:193], v[192:193], v[108:109]
    v_pk_mul_f32 v[194:195], v[194:195], v[110:111]
    v_pk_mul_f32 v[196:197], v[196:197], v[112:113]
    v_pk_mul_f32 v[198:199], v[198:199], v[114:115]
    v_exp_f32 v192, v192
    v_exp_f32 v193, v193
    v_exp_f32 v194, v194
    v_exp_f32 v195, v195
    v_exp_f32 v196, v196
    v_exp_f32 v197, v197
    v_exp_f32 v198, v198
    v_exp_f32 v199, v199
    v_pk_fma_f32 v[192:193], v[192:193], v[176:177], v[176:177] op_sel:[0,1,1] op_sel_hi:[1,1,1]
    v_pk_fma_f32 v[194:195], v[194:195], v[176:177], v[176:177] op_sel:[0,1,1] op_sel_hi:[1,1,1]
    v_pk_fma_f32 v[196:197], v[196:197], v[176:177], v[176:177] op_sel:[0,1,1] op_sel_hi:[1,1,1]
    v_pk_fma_f32 v[198:199], v[198:199], v[176:177], v[176:177] op_sel:[0,1,1] op_sel_hi:[1,1,1]
    v_rcp_f32 v192, v192
    v_rcp_f32 v193, v193
    v_rcp_f32 v194, v194
    v_rcp_f32 v195, v195
    v_rcp_f32 v196, v196
    v_rcp_f32 v197, v197
    v_rcp_f32 v198, v198
    v_rcp_f32 v199, v199
    v_pk_mul_f32 v[108:109], v[108:109], v[192:193]
    v_pk_mul_f32 v[110:111], v[110:111], v[194:195]
    v_pk_mul_f32 v[112:113], v[112:113], v[196:197]
    v_pk_mul_f32 v[114:115], v[114:115], v[198:199]
    v_cvt_pk_bf16_f32 v108, v108, v109
    v_cvt_pk_bf16_f32 v109, v110, v111
    v_cvt_pk_bf16_f32 v110, v112, v113
    v_cvt_pk_bf16_f32 v111, v114, v115
    ds_write_b128 v23, v[108:111] offset:2048
    s_add_u32 s36, s44, 688128
    buffer_store_dwordx4 v[108:111], v2, s[16:19], s36 offen sc1
    v_pk_fma_f32 v[32:33], v[164:165], v[144:145], v[32:33] op_sel_hi:[0,1,1] neg_lo:[1,0,0] neg_hi:[1,0,0]
    v_pk_fma_f32 v[34:35], v[164:165], v[146:147], v[34:35] op_sel_hi:[0,1,1] neg_lo:[1,0,0] neg_hi:[1,0,0]
    v_pk_fma_f32 v[36:37], v[164:165], v[148:149], v[36:37] op_sel_hi:[0,1,1] neg_lo:[1,0,0] neg_hi:[1,0,0]
    v_pk_fma_f32 v[38:39], v[164:165], v[150:151], v[38:39] op_sel_hi:[0,1,1] neg_lo:[1,0,0] neg_hi:[1,0,0]
    v_pk_mul_f32 v[192:193], v[32:33], v[32:33]
    v_pk_mul_f32 v[194:195], v[34:35], v[34:35]
    v_pk_mul_f32 v[196:197], v[36:37], v[36:37]
    v_pk_mul_f32 v[198:199], v[38:39], v[38:39]
    v_pk_fma_f32 v[192:193], v[192:193], v[166:167], v[166:167] op_sel:[0,1,0] op_sel_hi:[1,1,0]
    v_pk_fma_f32 v[194:195], v[194:195], v[166:167], v[166:167] op_sel:[0,1,0] op_sel_hi:[1,1,0]
    v_pk_fma_f32 v[196:197], v[196:197], v[166:167], v[166:167] op_sel:[0,1,0] op_sel_hi:[1,1,0]
    v_pk_fma_f32 v[198:199], v[198:199], v[166:167], v[166:167] op_sel:[0,1,0] op_sel_hi:[1,1,0]
    v_pk_mul_f32 v[192:193], v[192:193], v[32:33]
    v_pk_mul_f32 v[194:195], v[194:195], v[34:35]
    v_pk_mul_f32 v[196:197], v[196:197], v[36:37]
    v_pk_mul_f32 v[198:199], v[198:199], v[38:39]
    v_exp_f32 v192, v192
    v_exp_f32 v193, v193
    v_exp_f32 v194, v194
    v_exp_f32 v195, v195
    v_exp_f32 v196, v196
    v_exp_f32 v197, v197
    v_exp_f32 v198, v198
    v_exp_f32 v199, v199
    v_pk_fma_f32 v[192:193], v[192:193], v[164:165], v[164:165] op_sel:[0,1,1] op_sel_hi:[1,1,1]
    v_pk_fma_f32 v[194:195], v[194:195], v[164:165], v[164:165] op_sel:[0,1,1] op_sel_hi:[1,1,1]
    v_pk_fma_f32 v[196:197], v[196:197], v[164:165], v[164:165] op_sel:[0,1,1] op_sel_hi:[1,1,1]
    v_pk_fma_f32 v[198:199], v[198:199], v[164:165], v[164:165] op_sel:[0,1,1] op_sel_hi:[1,1,1]
    v_rcp_f32 v192, v192
    v_rcp_f32 v193, v193
    v_rcp_f32 v194, v194
    v_rcp_f32 v195, v195
    v_rcp_f32 v196, v196
    v_rcp_f32 v197, v197
    v_rcp_f32 v198, v198
    v_rcp_f32 v199, v199
    v_pk_mul_f32 v[32:33], v[32:33], v[192:193]
    v_pk_mul_f32 v[34:35], v[34:35], v[194:195]
    v_pk_mul_f32 v[36:37], v[36:37], v[196:197]
    v_pk_mul_f32 v[38:39], v[38:39], v[198:199]
    v_cvt_pk_bf16_f32 v32, v32, v33
    v_cvt_pk_bf16_f32 v33, v34, v35
    v_cvt_pk_bf16_f32 v34, v36, v37
    v_cvt_pk_bf16_f32 v35, v38, v39
    ds_write_b128 v22, v[32:35] offset:16384
    v_pk_fma_f32 v[60:61], v[168:169], v[144:145], v[60:61] op_sel_hi:[0,1,1] neg_lo:[1,0,0] neg_hi:[1,0,0]
    v_pk_fma_f32 v[62:63], v[168:169], v[146:147], v[62:63] op_sel_hi:[0,1,1] neg_lo:[1,0,0] neg_hi:[1,0,0]
    v_pk_fma_f32 v[64:65], v[168:169], v[148:149], v[64:65] op_sel_hi:[0,1,1] neg_lo:[1,0,0] neg_hi:[1,0,0]
    v_pk_fma_f32 v[66:67], v[168:169], v[150:151], v[66:67] op_sel_hi:[0,1,1] neg_lo:[1,0,0] neg_hi:[1,0,0]
    v_pk_mul_f32 v[192:193], v[60:61], v[60:61]
    v_pk_mul_f32 v[194:195], v[62:63], v[62:63]
    v_pk_mul_f32 v[196:197], v[64:65], v[64:65]
    v_pk_mul_f32 v[198:199], v[66:67], v[66:67]
    v_pk_fma_f32 v[192:193], v[192:193], v[170:171], v[170:171] op_sel:[0,1,0] op_sel_hi:[1,1,0]
    v_pk_fma_f32 v[194:195], v[194:195], v[170:171], v[170:171] op_sel:[0,1,0] op_sel_hi:[1,1,0]
    v_pk_fma_f32 v[196:197], v[196:197], v[170:171], v[170:171] op_sel:[0,1,0] op_sel_hi:[1,1,0]
    v_pk_fma_f32 v[198:199], v[198:199], v[170:171], v[170:171] op_sel:[0,1,0] op_sel_hi:[1,1,0]
    v_pk_mul_f32 v[192:193], v[192:193], v[60:61]
    v_pk_mul_f32 v[194:195], v[194:195], v[62:63]
    v_pk_mul_f32 v[196:197], v[196:197], v[64:65]
    v_pk_mul_f32 v[198:199], v[198:199], v[66:67]
    v_exp_f32 v192, v192
    v_exp_f32 v193, v193
    v_exp_f32 v194, v194
    v_exp_f32 v195, v195
    v_exp_f32 v196, v196
    v_exp_f32 v197, v197
    v_exp_f32 v198, v198
    v_exp_f32 v199, v199
    v_pk_fma_f32 v[192:193], v[192:193], v[168:169], v[168:169] op_sel:[0,1,1] op_sel_hi:[1,1,1]
    v_pk_fma_f32 v[194:195], v[194:195], v[168:169], v[168:169] op_sel:[0,1,1] op_sel_hi:[1,1,1]
    v_pk_fma_f32 v[196:197], v[196:197], v[168:169], v[168:169] op_sel:[0,1,1] op_sel_hi:[1,1,1]
    v_pk_fma_f32 v[198:199], v[198:199], v[168:169], v[168:169] op_sel:[0,1,1] op_sel_hi:[1,1,1]
    v_rcp_f32 v192, v192
    v_rcp_f32 v193, v193
    v_rcp_f32 v194, v194
    v_rcp_f32 v195, v195
    v_rcp_f32 v196, v196
    v_rcp_f32 v197, v197
    v_rcp_f32 v198, v198
    v_rcp_f32 v199, v199
    v_pk_mul_f32 v[60:61], v[60:61], v[192:193]
    v_pk_mul_f32 v[62:63], v[62:63], v[194:195]
    v_pk_mul_f32 v[64:65], v[64:65], v[196:197]
    v_pk_mul_f32 v[66:67], v[66:67], v[198:199]
    v_cvt_pk_bf16_f32 v60, v60, v61
    v_cvt_pk_bf16_f32 v61, v62, v63
    v_cvt_pk_bf16_f32 v62, v64, v65
    v_cvt_pk_bf16_f32 v63, v66, v67
    ds_write_b128 v22, v[60:63] offset:18432
    v_pk_fma_f32 v[88:89], v[172:173], v[144:145], v[88:89] op_sel_hi:[0,1,1] neg_lo:[1,0,0] neg_hi:[1,0,0]
    v_pk_fma_f32 v[90:91], v[172:173], v[146:147], v[90:91] op_sel_hi:[0,1,1] neg_lo:[1,0,0] neg_hi:[1,0,0]
    v_pk_fma_f32 v[92:93], v[172:173], v[148:149], v[92:93] op_sel_hi:[0,1,1] neg_lo:[1,0,0] neg_hi:[1,0,0]
    v_pk_fma_f32 v[94:95], v[172:173], v[150:151], v[94:95] op_sel_hi:[0,1,1] neg_lo:[1,0,0] neg_hi:[1,0,0]
    v_pk_mul_f32 v[192:193], v[88:89], v[88:89]
    v_pk_mul_f32 v[194:195], v[90:91], v[90:91]
    v_pk_mul_f32 v[196:197], v[92:93], v[92:93]
    v_pk_mul_f32 v[198:199], v[94:95], v[94:95]
    v_pk_fma_f32 v[192:193], v[192:193], v[174:175], v[174:175] op_sel:[0,1,0] op_sel_hi:[1,1,0]
    v_pk_fma_f32 v[194:195], v[194:195], v[174:175], v[174:175] op_sel:[0,1,0] op_sel_hi:[1,1,0]
    v_pk_fma_f32 v[196:197], v[196:197], v[174:175], v[174:175] op_sel:[0,1,0] op_sel_hi:[1,1,0]
    v_pk_fma_f32 v[198:199], v[198:199], v[174:175], v[174:175] op_sel:[0,1,0] op_sel_hi:[1,1,0]
    v_pk_mul_f32 v[192:193], v[192:193], v[88:89]
    v_pk_mul_f32 v[194:195], v[194:195], v[90:91]
    v_pk_mul_f32 v[196:197], v[196:197], v[92:93]
    v_pk_mul_f32 v[198:199], v[198:199], v[94:95]
    v_exp_f32 v192, v192
    v_exp_f32 v193, v193
    v_exp_f32 v194, v194
    v_exp_f32 v195, v195
    v_exp_f32 v196, v196
    v_exp_f32 v197, v197
    v_exp_f32 v198, v198
    v_exp_f32 v199, v199
    v_pk_fma_f32 v[192:193], v[192:193], v[172:173], v[172:173] op_sel:[0,1,1] op_sel_hi:[1,1,1]
    v_pk_fma_f32 v[194:195], v[194:195], v[172:173], v[172:173] op_sel:[0,1,1] op_sel_hi:[1,1,1]
    v_pk_fma_f32 v[196:197], v[196:197], v[172:173], v[172:173] op_sel:[0,1,1] op_sel_hi:[1,1,1]
    v_pk_fma_f32 v[198:199], v[198:199], v[172:173], v[172:173] op_sel:[0,1,1] op_sel_hi:[1,1,1]
    v_rcp_f32 v192, v192
    v_rcp_f32 v193, v193
    v_rcp_f32 v194, v194
    v_rcp_f32 v195, v195
    v_rcp_f32 v196, v196
    v_rcp_f32 v197, v197
    v_rcp_f32 v198, v198
    v_rcp_f32 v199, v199
    v_pk_mul_f32 v[88:89], v[88:89], v[192:193]
    v_pk_mul_f32 v[90:91], v[90:91], v[194:195]
    v_pk_mul_f32 v[92:93], v[92:93], v[196:197]
    v_pk_mul_f32 v[94:95], v[94:95], v[198:199]
    v_cvt_pk_bf16_f32 v88, v88, v89
    v_cvt_pk_bf16_f32 v89, v90, v91
    v_cvt_pk_bf16_f32 v90, v92, v93
    v_cvt_pk_bf16_f32 v91, v94, v95
    ds_write_b128 v23, v[88:91] offset:16384
    s_waitcnt vmcnt(0)
    buffer_atomic_add v8, v9, s[56:59], s49 offen offset:0 sc1
    buffer_load_dwordx4 v[180:183], v255, s[84:87], s13 offen offset:0 sc1
    buffer_load_dwordx4 v[184:187], v2, s[88:91], s40 offen offset:0 sc1
    v_pk_fma_f32 v[116:117], v[176:177], v[144:145], v[116:117] op_sel_hi:[0,1,1] neg_lo:[1,0,0] neg_hi:[1,0,0]
    v_pk_fma_f32 v[118:119], v[176:177], v[146:147], v[118:119] op_sel_hi:[0,1,1] neg_lo:[1,0,0] neg_hi:[1,0,0]
    v_pk_fma_f32 v[120:121], v[176:177], v[148:149], v[120:121] op_sel_hi:[0,1,1] neg_lo:[1,0,0] neg_hi:[1,0,0]
    v_pk_fma_f32 v[122:123], v[176:177], v[150:151], v[122:123] op_sel_hi:[0,1,1] neg_lo:[1,0,0] neg_hi:[1,0,0]
    v_pk_mul_f32 v[192:193], v[116:117], v[116:117]
    v_pk_mul_f32 v[194:195], v[118:119], v[118:119]
    v_pk_mul_f32 v[196:197], v[120:121], v[120:121]
    v_pk_mul_f32 v[198:199], v[122:123], v[122:123]
    v_pk_fma_f32 v[192:193], v[192:193], v[178:179], v[178:179] op_sel:[0,1,0] op_sel_hi:[1,1,0]
    v_pk_fma_f32 v[194:195], v[194:195], v[178:179], v[178:179] op_sel:[0,1,0] op_sel_hi:[1,1,0]
    v_pk_fma_f32 v[196:197], v[196:197], v[178:179], v[178:179] op_sel:[0,1,0] op_sel_hi:[1,1,0]
    v_pk_fma_f32 v[198:199], v[198:199], v[178:179], v[178:179] op_sel:[0,1,0] op_sel_hi:[1,1,0]
    v_pk_mul_f32 v[192:193], v[192:193], v[116:117]
    v_pk_mul_f32 v[194:195], v[194:195], v[118:119]
    v_pk_mul_f32 v[196:197], v[196:197], v[120:121]
    v_pk_mul_f32 v[198:199], v[198:199], v[122:123]
    v_exp_f32 v192, v192
    v_exp_f32 v193, v193
    v_exp_f32 v194, v194
    v_exp_f32 v195, v195
    v_exp_f32 v196, v196
    v_exp_f32 v197, v197
    v_exp_f32 v198, v198
    v_exp_f32 v199, v199
    v_pk_fma_f32 v[192:193], v[192:193], v[176:177], v[176:177] op_sel:[0,1,1] op_sel_hi:[1,1,1]
    v_pk_fma_f32 v[194:195], v[194:195], v[176:177], v[176:177] op_sel:[0,1,1] op_sel_hi:[1,1,1]
    v_pk_fma_f32 v[196:197], v[196:197], v[176:177], v[176:177] op_sel:[0,1,1] op_sel_hi:[1,1,1]
    v_pk_fma_f32 v[198:199], v[198:199], v[176:177], v[176:177] op_sel:[0,1,1] op_sel_hi:[1,1,1]
    v_rcp_f32 v192, v192
    v_rcp_f32 v193, v193
    v_rcp_f32 v194, v194
    v_rcp_f32 v195, v195
    v_rcp_f32 v196, v196
    v_rcp_f32 v197, v197
    v_rcp_f32 v198, v198
    v_rcp_f32 v199, v199
    v_pk_mul_f32 v[116:117], v[116:117], v[192:193]
    v_pk_mul_f32 v[118:119], v[118:119], v[194:195]
    v_pk_mul_f32 v[120:121], v[120:121], v[196:197]
    v_pk_mul_f32 v[122:123], v[122:123], v[198:199]
    v_cvt_pk_bf16_f32 v116, v116, v117
    v_cvt_pk_bf16_f32 v117, v118, v119
    v_cvt_pk_bf16_f32 v118, v120, v121
    v_cvt_pk_bf16_f32 v119, v122, v123
    ds_write_b128 v23, v[116:119] offset:18432
    buffer_load_dwordx4 v[200:203], v255, s[84:87], s13 offen offset:64 sc1
    buffer_load_dwordx4 v[204:207], v2, s[88:91], s40 offen offset:1024 sc1
    v_pk_fma_f32 v[40:41], v[164:165], v[152:153], v[40:41] op_sel_hi:[0,1,1] neg_lo:[1,0,0] neg_hi:[1,0,0]
    v_pk_fma_f32 v[42:43], v[164:165], v[154:155], v[42:43] op_sel_hi:[0,1,1] neg_lo:[1,0,0] neg_hi:[1,0,0]
    v_pk_fma_f32 v[44:45], v[164:165], v[156:157], v[44:45] op_sel_hi:[0,1,1] neg_lo:[1,0,0] neg_hi:[1,0,0]
    v_pk_fma_f32 v[46:47], v[164:165], v[158:159], v[46:47] op_sel_hi:[0,1,1] neg_lo:[1,0,0] neg_hi:[1,0,0]
    v_pk_mul_f32 v[192:193], v[40:41], v[40:41]
    v_pk_mul_f32 v[194:195], v[42:43], v[42:43]
    v_pk_mul_f32 v[196:197], v[44:45], v[44:45]
    v_pk_mul_f32 v[198:199], v[46:47], v[46:47]
    v_pk_fma_f32 v[192:193], v[192:193], v[166:167], v[166:167] op_sel:[0,1,0] op_sel_hi:[1,1,0]
    v_pk_fma_f32 v[194:195], v[194:195], v[166:167], v[166:167] op_sel:[0,1,0] op_sel_hi:[1,1,0]
    v_pk_fma_f32 v[196:197], v[196:197], v[166:167], v[166:167] op_sel:[0,1,0] op_sel_hi:[1,1,0]
    v_pk_fma_f32 v[198:199], v[198:199], v[166:167], v[166:167] op_sel:[0,1,0] op_sel_hi:[1,1,0]
    v_pk_mul_f32 v[192:193], v[192:193], v[40:41]
    v_pk_mul_f32 v[194:195], v[194:195], v[42:43]
    v_pk_mul_f32 v[196:197], v[196:197], v[44:45]
    v_pk_mul_f32 v[198:199], v[198:199], v[46:47]
    v_exp_f32 v192, v192
    v_exp_f32 v193, v193
    v_exp_f32 v194, v194
    v_exp_f32 v195, v195
    v_exp_f32 v196, v196
    v_exp_f32 v197, v197
    v_exp_f32 v198, v198
    v_exp_f32 v199, v199
    v_pk_fma_f32 v[192:193], v[192:193], v[164:165], v[164:165] op_sel:[0,1,1] op_sel_hi:[1,1,1]
    v_pk_fma_f32 v[194:195], v[194:195], v[164:165], v[164:165] op_sel:[0,1,1] op_sel_hi:[1,1,1]
    v_pk_fma_f32 v[196:197], v[196:197], v[164:165], v[164:165] op_sel:[0,1,1] op_sel_hi:[1,1,1]
    v_pk_fma_f32 v[198:199], v[198:199], v[164:165], v[164:165] op_sel:[0,1,1] op_sel_hi:[1,1,1]
    v_rcp_f32 v192, v192
    v_rcp_f32 v193, v193
    v_rcp_f32 v194, v194
    v_rcp_f32 v195, v195
    v_rcp_f32 v196, v196
    v_rcp_f32 v197, v197
    v_rcp_f32 v198, v198
    v_rcp_f32 v199, v199
    v_pk_mul_f32 v[40:41], v[40:41], v[192:193]
    v_pk_mul_f32 v[42:43], v[42:43], v[194:195]
    v_pk_mul_f32 v[44:45], v[44:45], v[196:197]
    v_pk_mul_f32 v[46:47], v[46:47], v[198:199]
    v_cvt_pk_bf16_f32 v230, v40, v41
    v_cvt_pk_bf16_f32 v231, v42, v43
    v_cvt_pk_bf16_f32 v232, v44, v45
    v_cvt_pk_bf16_f32 v233, v46, v47
    ds_write_b128 v22, v[230:233] offset:32768
    buffer_load_dwordx4 v[208:211], v255, s[84:87], s14 offen offset:0 sc1
    buffer_load_dwordx4 v[212:215], v2, s[88:91], s12 offen offset:0 sc1
    v_pk_fma_f32 v[68:69], v[168:169], v[152:153], v[68:69] op_sel_hi:[0,1,1] neg_lo:[1,0,0] neg_hi:[1,0,0]
    v_pk_fma_f32 v[70:71], v[168:169], v[154:155], v[70:71] op_sel_hi:[0,1,1] neg_lo:[1,0,0] neg_hi:[1,0,0]
    v_pk_fma_f32 v[72:73], v[168:169], v[156:157], v[72:73] op_sel_hi:[0,1,1] neg_lo:[1,0,0] neg_hi:[1,0,0]
    v_pk_fma_f32 v[74:75], v[168:169], v[158:159], v[74:75] op_sel_hi:[0,1,1] neg_lo:[1,0,0] neg_hi:[1,0,0]
    v_pk_mul_f32 v[192:193], v[68:69], v[68:69]
    v_pk_mul_f32 v[194:195], v[70:71], v[70:71]
    v_pk_mul_f32 v[196:197], v[72:73], v[72:73]
    v_pk_mul_f32 v[198:199], v[74:75], v[74:75]
    v_pk_fma_f32 v[192:193], v[192:193], v[170:171], v[170:171] op_sel:[0,1,0] op_sel_hi:[1,1,0]
    v_pk_fma_f32 v[194:195], v[194:195], v[170:171], v[170:171] op_sel:[0,1,0] op_sel_hi:[1,1,0]
    v_pk_fma_f32 v[196:197], v[196:197], v[170:171], v[170:171] op_sel:[0,1,0] op_sel_hi:[1,1,0]
    v_pk_fma_f32 v[198:199], v[198:199], v[170:171], v[170:171] op_sel:[0,1,0] op_sel_hi:[1,1,0]
    v_pk_mul_f32 v[192:193], v[192:193], v[68:69]
    v_pk_mul_f32 v[194:195], v[194:195], v[70:71]
    v_pk_mul_f32 v[196:197], v[196:197], v[72:73]
    v_pk_mul_f32 v[198:199], v[198:199], v[74:75]
    v_exp_f32 v192, v192
    v_exp_f32 v193, v193
    v_exp_f32 v194, v194
    v_exp_f32 v195, v195
    v_exp_f32 v196, v196
    v_exp_f32 v197, v197
    v_exp_f32 v198, v198
    v_exp_f32 v199, v199
    v_pk_fma_f32 v[192:193], v[192:193], v[168:169], v[168:169] op_sel:[0,1,1] op_sel_hi:[1,1,1]
    v_pk_fma_f32 v[194:195], v[194:195], v[168:169], v[168:169] op_sel:[0,1,1] op_sel_hi:[1,1,1]
    v_pk_fma_f32 v[196:197], v[196:197], v[168:169], v[168:169] op_sel:[0,1,1] op_sel_hi:[1,1,1]
    v_pk_fma_f32 v[198:199], v[198:199], v[168:169], v[168:169] op_sel:[0,1,1] op_sel_hi:[1,1,1]
    v_rcp_f32 v192, v192
    v_rcp_f32 v193, v193
    v_rcp_f32 v194, v194
    v_rcp_f32 v195, v195
    v_rcp_f32 v196, v196
    v_rcp_f32 v197, v197
    v_rcp_f32 v198, v198
    v_rcp_f32 v199, v199
    v_pk_mul_f32 v[68:69], v[68:69], v[192:193]
    v_pk_mul_f32 v[70:71], v[70:71], v[194:195]
    v_pk_mul_f32 v[72:73], v[72:73], v[196:197]
    v_pk_mul_f32 v[74:75], v[74:75], v[198:199]
    v_cvt_pk_bf16_f32 v234, v68, v69
    v_cvt_pk_bf16_f32 v235, v70, v71
    v_cvt_pk_bf16_f32 v236, v72, v73
    v_cvt_pk_bf16_f32 v237, v74, v75
    ds_write_b128 v22, v[234:237] offset:34816
    buffer_load_dwordx4 v[216:219], v255, s[84:87], s14 offen offset:64 sc1
    buffer_load_dwordx4 v[220:223], v2, s[88:91], s12 offen offset:1024 sc1
    v_pk_fma_f32 v[96:97], v[172:173], v[152:153], v[96:97] op_sel_hi:[0,1,1] neg_lo:[1,0,0] neg_hi:[1,0,0]
    v_pk_fma_f32 v[98:99], v[172:173], v[154:155], v[98:99] op_sel_hi:[0,1,1] neg_lo:[1,0,0] neg_hi:[1,0,0]
    v_pk_fma_f32 v[100:101], v[172:173], v[156:157], v[100:101] op_sel_hi:[0,1,1] neg_lo:[1,0,0] neg_hi:[1,0,0]
    v_pk_fma_f32 v[102:103], v[172:173], v[158:159], v[102:103] op_sel_hi:[0,1,1] neg_lo:[1,0,0] neg_hi:[1,0,0]
    v_pk_mul_f32 v[192:193], v[96:97], v[96:97]
    v_pk_mul_f32 v[194:195], v[98:99], v[98:99]
    v_pk_mul_f32 v[196:197], v[100:101], v[100:101]
    v_pk_mul_f32 v[198:199], v[102:103], v[102:103]
    v_pk_fma_f32 v[192:193], v[192:193], v[174:175], v[174:175] op_sel:[0,1,0] op_sel_hi:[1,1,0]
    v_pk_fma_f32 v[194:195], v[194:195], v[174:175], v[174:175] op_sel:[0,1,0] op_sel_hi:[1,1,0]
    v_pk_fma_f32 v[196:197], v[196:197], v[174:175], v[174:175] op_sel:[0,1,0] op_sel_hi:[1,1,0]
    v_pk_fma_f32 v[198:199], v[198:199], v[174:175], v[174:175] op_sel:[0,1,0] op_sel_hi:[1,1,0]
    v_pk_mul_f32 v[192:193], v[192:193], v[96:97]
    v_pk_mul_f32 v[194:195], v[194:195], v[98:99]
    v_pk_mul_f32 v[196:197], v[196:197], v[100:101]
    v_pk_mul_f32 v[198:199], v[198:199], v[102:103]
    v_exp_f32 v192, v192
    v_exp_f32 v193, v193
    v_exp_f32 v194, v194
    v_exp_f32 v195, v195
    v_exp_f32 v196, v196
    v_exp_f32 v197, v197
    v_exp_f32 v198, v198
    v_exp_f32 v199, v199
    v_pk_fma_f32 v[192:193], v[192:193], v[172:173], v[172:173] op_sel:[0,1,1] op_sel_hi:[1,1,1]
    v_pk_fma_f32 v[194:195], v[194:195], v[172:173], v[172:173] op_sel:[0,1,1] op_sel_hi:[1,1,1]
    v_pk_fma_f32 v[196:197], v[196:197], v[172:173], v[172:173] op_sel:[0,1,1] op_sel_hi:[1,1,1]
    v_pk_fma_f32 v[198:199], v[198:199], v[172:173], v[172:173] op_sel:[0,1,1] op_sel_hi:[1,1,1]
    v_rcp_f32 v192, v192
    v_rcp_f32 v193, v193
    v_rcp_f32 v194, v194
    v_rcp_f32 v195, v195
    v_rcp_f32 v196, v196
    v_rcp_f32 v197, v197
    v_rcp_f32 v198, v198
    v_rcp_f32 v199, v199
    v_pk_mul_f32 v[96:97], v[96:97], v[192:193]
    v_pk_mul_f32 v[98:99], v[98:99], v[194:195]
    v_pk_mul_f32 v[100:101], v[100:101], v[196:197]
    v_pk_mul_f32 v[102:103], v[102:103], v[198:199]
    v_cvt_pk_bf16_f32 v238, v96, v97
    v_cvt_pk_bf16_f32 v239, v98, v99
    v_cvt_pk_bf16_f32 v240, v100, v101
    v_cvt_pk_bf16_f32 v241, v102, v103
    ds_write_b128 v23, v[238:241] offset:32768
    v_pk_fma_f32 v[124:125], v[176:177], v[152:153], v[124:125] op_sel_hi:[0,1,1] neg_lo:[1,0,0] neg_hi:[1,0,0]
    v_pk_fma_f32 v[126:127], v[176:177], v[154:155], v[126:127] op_sel_hi:[0,1,1] neg_lo:[1,0,0] neg_hi:[1,0,0]
    v_pk_fma_f32 v[128:129], v[176:177], v[156:157], v[128:129] op_sel_hi:[0,1,1] neg_lo:[1,0,0] neg_hi:[1,0,0]
    v_pk_fma_f32 v[130:131], v[176:177], v[158:159], v[130:131] op_sel_hi:[0,1,1] neg_lo:[1,0,0] neg_hi:[1,0,0]
    v_pk_mul_f32 v[192:193], v[124:125], v[124:125]
    v_pk_mul_f32 v[194:195], v[126:127], v[126:127]
    v_pk_mul_f32 v[196:197], v[128:129], v[128:129]
    v_pk_mul_f32 v[198:199], v[130:131], v[130:131]
    v_pk_fma_f32 v[192:193], v[192:193], v[178:179], v[178:179] op_sel:[0,1,0] op_sel_hi:[1,1,0]
    v_pk_fma_f32 v[194:195], v[194:195], v[178:179], v[178:179] op_sel:[0,1,0] op_sel_hi:[1,1,0]
    v_pk_fma_f32 v[196:197], v[196:197], v[178:179], v[178:179] op_sel:[0,1,0] op_sel_hi:[1,1,0]
    v_pk_fma_f32 v[198:199], v[198:199], v[178:179], v[178:179] op_sel:[0,1,0] op_sel_hi:[1,1,0]
    v_pk_mul_f32 v[192:193], v[192:193], v[124:125]
    v_pk_mul_f32 v[194:195], v[194:195], v[126:127]
    v_pk_mul_f32 v[196:197], v[196:197], v[128:129]
    v_pk_mul_f32 v[198:199], v[198:199], v[130:131]
    v_exp_f32 v192, v192
    v_exp_f32 v193, v193
    v_exp_f32 v194, v194
    v_exp_f32 v195, v195
    v_exp_f32 v196, v196
    v_exp_f32 v197, v197
    v_exp_f32 v198, v198
    v_exp_f32 v199, v199
    v_pk_fma_f32 v[192:193], v[192:193], v[176:177], v[176:177] op_sel:[0,1,1] op_sel_hi:[1,1,1]
    v_pk_fma_f32 v[194:195], v[194:195], v[176:177], v[176:177] op_sel:[0,1,1] op_sel_hi:[1,1,1]
    v_pk_fma_f32 v[196:197], v[196:197], v[176:177], v[176:177] op_sel:[0,1,1] op_sel_hi:[1,1,1]
    v_pk_fma_f32 v[198:199], v[198:199], v[176:177], v[176:177] op_sel:[0,1,1] op_sel_hi:[1,1,1]
    v_rcp_f32 v192, v192
    v_rcp_f32 v193, v193
    v_rcp_f32 v194, v194
    v_rcp_f32 v195, v195
    v_rcp_f32 v196, v196
    v_rcp_f32 v197, v197
    v_rcp_f32 v198, v198
    v_rcp_f32 v199, v199
    v_pk_mul_f32 v[124:125], v[124:125], v[192:193]
    v_pk_mul_f32 v[126:127], v[126:127], v[194:195]
    v_pk_mul_f32 v[128:129], v[128:129], v[196:197]
    v_pk_mul_f32 v[130:131], v[130:131], v[198:199]
    v_cvt_pk_bf16_f32 v242, v124, v125
    v_cvt_pk_bf16_f32 v243, v126, v127
    v_cvt_pk_bf16_f32 v244, v128, v129
    v_cvt_pk_bf16_f32 v245, v130, v131
    ds_write_b128 v23, v[242:245] offset:34816
    v_pk_fma_f32 v[48:49], v[164:165], v[160:161], v[48:49] op_sel_hi:[0,1,1] neg_lo:[1,0,0] neg_hi:[1,0,0]
    v_pk_fma_f32 v[50:51], v[164:165], v[162:163], v[50:51] op_sel_hi:[0,1,1] neg_lo:[1,0,0] neg_hi:[1,0,0]
    v_pk_fma_f32 v[76:77], v[168:169], v[160:161], v[76:77] op_sel_hi:[0,1,1] neg_lo:[1,0,0] neg_hi:[1,0,0]
    v_pk_fma_f32 v[78:79], v[168:169], v[162:163], v[78:79] op_sel_hi:[0,1,1] neg_lo:[1,0,0] neg_hi:[1,0,0]
    v_pk_mul_f32 v[192:193], v[48:49], v[48:49]
    v_pk_mul_f32 v[194:195], v[50:51], v[50:51]
    v_pk_mul_f32 v[196:197], v[76:77], v[76:77]
    v_pk_mul_f32 v[198:199], v[78:79], v[78:79]
    v_pk_fma_f32 v[192:193], v[192:193], v[166:167], v[166:167] op_sel:[0,1,0] op_sel_hi:[1,1,0]
    v_pk_fma_f32 v[194:195], v[194:195], v[166:167], v[166:167] op_sel:[0,1,0] op_sel_hi:[1,1,0]
    v_pk_fma_f32 v[196:197], v[196:197], v[170:171], v[170:171] op_sel:[0,1,0] op_sel_hi:[1,1,0]
    v_pk_fma_f32 v[198:199], v[198:199], v[170:171], v[170:171] op_sel:[0,1,0] op_sel_hi:[1,1,0]
    v_pk_mul_f32 v[192:193], v[192:193], v[48:49]
    v_pk_mul_f32 v[194:195], v[194:195], v[50:51]
    v_pk_mul_f32 v[196:197], v[196:197], v[76:77]
    v_pk_mul_f32 v[198:199], v[198:199], v[78:79]
    v_exp_f32 v192, v192
    v_exp_f32 v193, v193
    v_exp_f32 v194, v194
    v_exp_f32 v195, v195
    v_exp_f32 v196, v196
    v_exp_f32 v197, v197
    v_exp_f32 v198, v198
    v_exp_f32 v199, v199
    v_pk_fma_f32 v[192:193], v[192:193], v[164:165], v[164:165] op_sel:[0,1,1] op_sel_hi:[1,1,1]
    v_pk_fma_f32 v[194:195], v[194:195], v[164:165], v[164:165] op_sel:[0,1,1] op_sel_hi:[1,1,1]
    v_pk_fma_f32 v[196:197], v[196:197], v[168:169], v[168:169] op_sel:[0,1,1] op_sel_hi:[1,1,1]
    v_pk_fma_f32 v[198:199], v[198:199], v[168:169], v[168:169] op_sel:[0,1,1] op_sel_hi:[1,1,1]
    v_rcp_f32 v192, v192
    v_rcp_f32 v193, v193
    v_rcp_f32 v194, v194
    v_rcp_f32 v195, v195
    v_rcp_f32 v196, v196
    v_rcp_f32 v197, v197
    v_rcp_f32 v198, v198
    v_rcp_f32 v199, v199
    v_pk_mul_f32 v[48:49], v[48:49], v[192:193]
    v_pk_mul_f32 v[50:51], v[50:51], v[194:195]
    v_pk_mul_f32 v[76:77], v[76:77], v[196:197]
    v_pk_mul_f32 v[78:79], v[78:79], v[198:199]
    v_cvt_pk_bf16_f32 v246, v48, v49
    v_cvt_pk_bf16_f32 v247, v50, v51
    s_add_u32 s36, s45, 0
    buffer_store_dwordx4 v[32:35], v2, s[16:19], s36 offen sc1
    v_cvt_pk_bf16_f32 v248, v76, v77
    v_cvt_pk_bf16_f32 v249, v78, v79
    s_add_u32 s36, s45, 229376
    buffer_store_dwordx4 v[60:63], v2, s[16:19], s36 offen sc1
    v_pk_fma_f32 v[104:105], v[172:173], v[160:161], v[104:105] op_sel_hi:[0,1,1] neg_lo:[1,0,0] neg_hi:[1,0,0]
    v_pk_fma_f32 v[106:107], v[172:173], v[162:163], v[106:107] op_sel_hi:[0,1,1] neg_lo:[1,0,0] neg_hi:[1,0,0]
    v_pk_fma_f32 v[132:133], v[176:177], v[160:161], v[132:133] op_sel_hi:[0,1,1] neg_lo:[1,0,0] neg_hi:[1,0,0]
    v_pk_fma_f32 v[134:135], v[176:177], v[162:163], v[134:135] op_sel_hi:[0,1,1] neg_lo:[1,0,0] neg_hi:[1,0,0]
    v_pk_mul_f32 v[192:193], v[104:105], v[104:105]
    v_pk_mul_f32 v[194:195], v[106:107], v[106:107]
    v_pk_mul_f32 v[196:197], v[132:133], v[132:133]
    v_pk_mul_f32 v[198:199], v[134:135], v[134:135]
    v_pk_fma_f32 v[192:193], v[192:193], v[174:175], v[174:175] op_sel:[0,1,0] op_sel_hi:[1,1,0]
    v_pk_fma_f32 v[194:195], v[194:195], v[174:175], v[174:175] op_sel:[0,1,0] op_sel_hi:[1,1,0]
    v_pk_fma_f32 v[196:197], v[196:197], v[178:179], v[178:179] op_sel:[0,1,0] op_sel_hi:[1,1,0]
    v_pk_fma_f32 v[198:199], v[198:199], v[178:179], v[178:179] op_sel:[0,1,0] op_sel_hi:[1,1,0]
    v_pk_mul_f32 v[192:193], v[192:193], v[104:105]
    v_pk_mul_f32 v[194:195], v[194:195], v[106:107]
    v_pk_mul_f32 v[196:197], v[196:197], v[132:133]
    v_pk_mul_f32 v[198:199], v[198:199], v[134:135]
    v_exp_f32 v192, v192
    v_exp_f32 v193, v193
    v_exp_f32 v194, v194
    v_exp_f32 v195, v195
    v_exp_f32 v196, v196
    v_exp_f32 v197, v197
    v_exp_f32 v198, v198
    v_exp_f32 v199, v199
    v_pk_fma_f32 v[192:193], v[192:193], v[172:173], v[172:173] op_sel:[0,1,1] op_sel_hi:[1,1,1]
    v_pk_fma_f32 v[194:195], v[194:195], v[172:173], v[172:173] op_sel:[0,1,1] op_sel_hi:[1,1,1]
    v_pk_fma_f32 v[196:197], v[196:197], v[176:177], v[176:177] op_sel:[0,1,1] op_sel_hi:[1,1,1]
    v_pk_fma_f32 v[198:199], v[198:199], v[176:177], v[176:177] op_sel:[0,1,1] op_sel_hi:[1,1,1]
    v_rcp_f32 v192, v192
    v_rcp_f32 v193, v193
    v_rcp_f32 v194, v194
    v_rcp_f32 v195, v195
    v_rcp_f32 v196, v196
    v_rcp_f32 v197, v197
    v_rcp_f32 v198, v198
    v_rcp_f32 v199, v199
    v_pk_mul_f32 v[104:105], v[104:105], v[192:193]
    v_pk_mul_f32 v[106:107], v[106:107], v[194:195]
    v_pk_mul_f32 v[132:133], v[132:133], v[196:197]
    v_pk_mul_f32 v[134:135], v[134:135], v[198:199]
    v_cvt_pk_bf16_f32 v250, v104, v105
    v_cvt_pk_bf16_f32 v251, v106, v107
    s_add_u32 s36, s45, 458752
    buffer_store_dwordx4 v[88:91], v2, s[16:19], s36 offen sc1
    v_cvt_pk_bf16_f32 v252, v132, v133
    v_cvt_pk_bf16_f32 v253, v134, v135
    s_add_u32 s36, s45, 688128
    buffer_store_dwordx4 v[116:119], v2, s[16:19], s36 offen sc1
    s_waitcnt vmcnt(4) lgkmcnt(0)
    v_lshrrev_b32 v18, 2, v1
    v_mul_u32_u24 v13, 256, v18
    v_and_b32 v19, 3, v1
    v_lshl_add_u32 v13, v19, 3, v13
    v_add_u32 v13, 49152, v13
    v_and_b32 v18, 7, v18
    s_mul_i32 s36, s35, 4
    s_add_u32 s36, s36, 3
    v_xor_b32 v19, s36, v18
    v_lshl_add_u32 v16, v19, 5, v13
    s_mul_i32 s36, s35, 4
    s_add_u32 s36, s36, 2
    v_xor_b32 v19, s36, v18
    v_lshl_add_u32 v15, v19, 5, v13
    s_mul_i32 s36, s35, 4
    s_add_u32 s36, s36, 1
    v_xor_b32 v19, s36, v18
    v_lshl_add_u32 v14, v19, 5, v13
    s_mul_i32 s36, s35, 4
    s_add_u32 s36, s36, 0
    v_xor_b32 v19, s36, v18
    v_lshl_add_u32 v13, v19, 5, v13
    s_mov_b32 s42, 0
    s_mov_b32 s43, 0
    s_mov_b32 s48, 0
    v_mov_b32 v17, v12
    v_mov_b32 v18, v13
    v_mov_b32 v19, v14
    v_mov_b32 v20, v15
    v_mov_b32 v21, v16
    v_mov_b32 v56, 0x10000
    s_waitcnt lgkmcnt(0)
    s_barrier
    ds_read_b128 v[24:27], v17 offset:0
    ds_read_b128 v[28:31], v17 offset:2048
    ds_read_b128 v[32:35], v17 offset:4096
    ds_read_b128 v[36:39], v17 offset:6144
    ds_read_b64_tr_b16 v[40:41], v18 offset:0
    ds_read_b64_tr_b16 v[42:43], v18 offset:4096
    ds_read_b64_tr_b16 v[44:45], v19 offset:0
    ds_read_b64_tr_b16 v[46:47], v19 offset:4096
    ds_read_b64_tr_b16 v[48:49], v20 offset:0
    ds_read_b64_tr_b16 v[50:51], v20 offset:4096
    ds_read_b64_tr_b16 v[52:53], v21 offset:0
    ds_read_b64_tr_b16 v[54:55], v21 offset:4096
    v_mfma_f32_16x16x32_bf16 v[120:123], v[226:229], v[180:183], 0
    v_mfma_f32_16x16x32_bf16 v[124:127], v[224:227], v[180:183], 0
    v_mfma_f32_16x16x32_bf16 v[128:131], v[226:229], v[200:203], 0
    v_mfma_f32_16x16x32_bf16 v[132:135], v[224:227], v[200:203], 0
    v_mfma_f32_16x16x32_bf16 v[136:139], v[226:229], v[208:211], 0
    v_mfma_f32_16x16x32_bf16 v[140:143], v[224:227], v[208:211], 0
    v_mfma_f32_16x16x32_bf16 v[144:147], v[226:229], v[216:219], 0
    v_mfma_f32_16x16x32_bf16 v[148:151], v[224:227], v[216:219], 0
    v_mfma_f32_16x16x32_bf16 v[120:123], v[226:229], v[184:187], v[120:123]
    v_mfma_f32_16x16x32_bf16 v[124:127], v[224:227], v[184:187], v[124:127]
    v_mfma_f32_16x16x32_bf16 v[128:131], v[226:229], v[204:207], v[128:131]
    v_mfma_f32_16x16x32_bf16 v[132:135], v[224:227], v[204:207], v[132:135]
    v_mfma_f32_16x16x32_bf16 v[136:139], v[226:229], v[212:215], v[136:139]
    v_mfma_f32_16x16x32_bf16 v[140:143], v[224:227], v[212:215], v[140:143]
    v_mfma_f32_16x16x32_bf16 v[144:147], v[226:229], v[220:223], v[144:147]
    v_mfma_f32_16x16x32_bf16 v[148:151], v[224:227], v[220:223], v[148:151]
    s_waitcnt lgkmcnt(0)
    v_mfma_f32_16x16x32_bf16 v[120:123], v[40:43], v[24:27], v[120:123]
    ds_read_b128 v[184:187], v17 offset:1024
    ds_read_b128 v[188:191], v17 offset:3072
    v_mfma_f32_16x16x32_bf16 v[136:139], v[40:43], v[28:31], v[136:139]
    ds_read_b128 v[192:195], v17 offset:5120
    v_mfma_f32_16x16x32_bf16 v[152:155], v[40:43], v[32:35], 0
    ds_read_b128 v[196:199], v17 offset:7168
    v_mfma_f32_16x16x32_bf16 v[168:171], v[40:43], v[36:39], 0
    s_add_u32 s36, s46, 0
    buffer_store_dwordx4 v[230:233], v2, s[16:19], s36 offen sc1
    v_mfma_f32_16x16x32_bf16 v[172:175], v[44:47], v[36:39], 0
    ds_read_b64_tr_b16 v[200:201], v18 offset:8192
    v_mfma_f32_16x16x32_bf16 v[156:159], v[44:47], v[32:35], 0
    ds_read_b64_tr_b16 v[202:203], v18 offset:12288
    v_mfma_f32_16x16x32_bf16 v[140:143], v[44:47], v[28:31], v[140:143]
    ds_read_b64_tr_b16 v[204:205], v19 offset:8192
    s_add_u32 s36, s47, 0
    buffer_store_dwordx2 v[246:247], v254, s[16:19], s36 offen sc1
    v_mfma_f32_16x16x32_bf16 v[124:127], v[44:47], v[24:27], v[124:127]
    ds_read_b64_tr_b16 v[206:207], v19 offset:12288
    v_mfma_f32_16x16x32_bf16 v[128:131], v[48:51], v[24:27], v[128:131]
    ds_read_b64_tr_b16 v[208:209], v20 offset:8192
    v_mfma_f32_16x16x32_bf16 v[144:147], v[48:51], v[28:31], v[144:147]
    ds_read_b64_tr_b16 v[210:211], v20 offset:12288
    v_mfma_f32_16x16x32_bf16 v[160:163], v[48:51], v[32:35], 0
    ds_read_b64_tr_b16 v[212:213], v21 offset:8192
    v_mfma_f32_16x16x32_bf16 v[176:179], v[48:51], v[36:39], 0
    ds_read_b64_tr_b16 v[214:215], v21 offset:12288
    s_add_u32 s42, s42, 16384
    s_cmp_eq_u32 s42, 49152
    s_cselect_b32 s42, 0, s42
    v_mfma_f32_16x16x32_bf16 v[180:183], v[52:55], v[36:39], 0
    s_add_u32 s48, s48, 16384
    s_cmp_eq_u32 s48, 98304
    s_cselect_b32 s48, 0, s48
    v_mfma_f32_16x16x32_bf16 v[164:167], v[52:55], v[32:35], 0
    v_add_u32 v17, s42, v12
    v_add_u32 v18, s48, v13
    v_add_u32 v19, s48, v14
    v_mfma_f32_16x16x32_bf16 v[148:151], v[52:55], v[28:31], v[148:151]
    v_add_u32 v20, s48, v15
    v_add_u32 v21, s48, v16
    v_mfma_f32_16x16x32_bf16 v[132:135], v[52:55], v[24:27], v[132:135]
    s_waitcnt lgkmcnt(0)
    s_barrier
    v_mfma_f32_16x16x32_bf16 v[120:123], v[200:203], v[184:187], v[120:123]
    ds_read_b128 v[24:27], v17 offset:0
    ds_read_b128 v[28:31], v17 offset:2048
    v_mfma_f32_16x16x32_bf16 v[136:139], v[200:203], v[188:191], v[136:139]
    ds_read_b128 v[32:35], v17 offset:4096
    v_mfma_f32_16x16x32_bf16 v[152:155], v[200:203], v[192:195], v[152:155]
    ds_read_b128 v[36:39], v17 offset:6144
    v_mfma_f32_16x16x32_bf16 v[168:171], v[200:203], v[196:199], v[168:171]
    s_add_u32 s36, s46, 229376
    buffer_store_dwordx4 v[234:237], v2, s[16:19], s36 offen sc1
    v_mfma_f32_16x16x32_bf16 v[172:175], v[204:207], v[196:199], v[172:175]
    ds_read_b64_tr_b16 v[40:41], v18 offset:0
    v_mfma_f32_16x16x32_bf16 v[156:159], v[204:207], v[192:195], v[156:159]
    ds_read_b64_tr_b16 v[42:43], v18 offset:4096
    v_mfma_f32_16x16x32_bf16 v[140:143], v[204:207], v[188:191], v[140:143]
    ds_read_b64_tr_b16 v[44:45], v19 offset:0
    s_add_u32 s36, s47, 229376
    buffer_store_dwordx2 v[248:249], v254, s[16:19], s36 offen sc1
    v_mfma_f32_16x16x32_bf16 v[124:127], v[204:207], v[184:187], v[124:127]
    ds_read_b64_tr_b16 v[46:47], v19 offset:4096
    v_mfma_f32_16x16x32_bf16 v[128:131], v[208:211], v[184:187], v[128:131]
    ds_read_b64_tr_b16 v[48:49], v20 offset:0
    v_mfma_f32_16x16x32_bf16 v[144:147], v[208:211], v[188:191], v[144:147]
    ds_read_b64_tr_b16 v[50:51], v20 offset:4096
    v_mfma_f32_16x16x32_bf16 v[160:163], v[208:211], v[192:195], v[160:163]
    ds_read_b64_tr_b16 v[52:53], v21 offset:0
    v_mfma_f32_16x16x32_bf16 v[176:179], v[208:211], v[196:199], v[176:179]
    ds_read_b64_tr_b16 v[54:55], v21 offset:4096
    s_add_u32 s43, s43, 1
    v_mfma_f32_16x16x32_bf16 v[180:183], v[212:215], v[196:199], v[180:183]
    s_cmp_lt_u32 s43, 27
    v_mfma_f32_16x16x32_bf16 v[164:167], v[212:215], v[192:195], v[164:167]
    v_mfma_f32_16x16x32_bf16 v[148:151], v[212:215], v[188:191], v[148:151]
    v_mfma_f32_16x16x32_bf16 v[132:135], v[212:215], v[184:187], v[132:135]
    s_waitcnt lgkmcnt(0)
    v_mfma_f32_16x16x32_bf16 v[120:123], v[40:43], v[24:27], v[120:123]
    ds_read_b128 v[184:187], v17 offset:1024
    ds_read_b128 v[188:191], v17 offset:3072
    v_mfma_f32_16x16x32_bf16 v[136:139], v[40:43], v[28:31], v[136:139]
    ds_read_b128 v[192:195], v17 offset:5120
    v_mfma_f32_16x16x32_bf16 v[152:155], v[40:43], v[32:35], v[152:155]
    ds_read_b128 v[196:199], v17 offset:7168
    v_mfma_f32_16x16x32_bf16 v[168:171], v[40:43], v[36:39], v[168:171]
    s_add_u32 s36, s46, 458752
    buffer_store_dwordx4 v[238:241], v2, s[16:19], s36 offen sc1
    v_mfma_f32_16x16x32_bf16 v[172:175], v[44:47], v[36:39], v[172:175]
    ds_read_b64_tr_b16 v[200:201], v18 offset:8192
    v_mfma_f32_16x16x32_bf16 v[156:159], v[44:47], v[32:35], v[156:159]
    ds_read_b64_tr_b16 v[202:203], v18 offset:12288
    v_mfma_f32_16x16x32_bf16 v[140:143], v[44:47], v[28:31], v[140:143]
    ds_read_b64_tr_b16 v[204:205], v19 offset:8192
    s_add_u32 s36, s47, 458752
    buffer_store_dwordx2 v[250:251], v254, s[16:19], s36 offen sc1
    v_mfma_f32_16x16x32_bf16 v[124:127], v[44:47], v[24:27], v[124:127]
    ds_read_b64_tr_b16 v[206:207], v19 offset:12288
    v_mfma_f32_16x16x32_bf16 v[128:131], v[48:51], v[24:27], v[128:131]
    ds_read_b64_tr_b16 v[208:209], v20 offset:8192
    v_mfma_f32_16x16x32_bf16 v[144:147], v[48:51], v[28:31], v[144:147]
    ds_read_b64_tr_b16 v[210:211], v20 offset:12288
    v_mfma_f32_16x16x32_bf16 v[160:163], v[48:51], v[32:35], v[160:163]
    ds_read_b64_tr_b16 v[212:213], v21 offset:8192
    v_mfma_f32_16x16x32_bf16 v[176:179], v[48:51], v[36:39], v[176:179]
    ds_read_b64_tr_b16 v[214:215], v21 offset:12288
    s_add_u32 s42, s42, 16384
    s_cmp_eq_u32 s42, 49152
    s_cselect_b32 s42, 0, s42
    v_mfma_f32_16x16x32_bf16 v[180:183], v[52:55], v[36:39], v[180:183]
    s_add_u32 s48, s48, 16384
    s_cmp_eq_u32 s48, 98304
    s_cselect_b32 s48, 0, s48
    v_mfma_f32_16x16x32_bf16 v[164:167], v[52:55], v[32:35], v[164:167]
    v_add_u32 v17, s42, v12
    v_add_u32 v18, s48, v13
    v_add_u32 v19, s48, v14
    v_mfma_f32_16x16x32_bf16 v[148:151], v[52:55], v[28:31], v[148:151]
    v_add_u32 v20, s48, v15
    v_add_u32 v21, s48, v16
    v_mfma_f32_16x16x32_bf16 v[132:135], v[52:55], v[24:27], v[132:135]
    s_waitcnt lgkmcnt(0)
    s_barrier
    v_mfma_f32_16x16x32_bf16 v[120:123], v[200:203], v[184:187], v[120:123]
    ds_read_b128 v[24:27], v17 offset:0
    ds_read_b128 v[28:31], v17 offset:2048
    v_mfma_f32_16x16x32_bf16 v[136:139], v[200:203], v[188:191], v[136:139]
    ds_read_b128 v[32:35], v17 offset:4096
    v_mfma_f32_16x16x32_bf16 v[152:155], v[200:203], v[192:195], v[152:155]
    ds_read_b128 v[36:39], v17 offset:6144
    v_mfma_f32_16x16x32_bf16 v[168:171], v[200:203], v[196:199], v[168:171]
    s_add_u32 s36, s46, 688128
    buffer_store_dwordx4 v[242:245], v2, s[16:19], s36 offen sc1
    v_mfma_f32_16x16x32_bf16 v[172:175], v[204:207], v[196:199], v[172:175]
    ds_read_b64_tr_b16 v[40:41], v18 offset:0
    v_mfma_f32_16x16x32_bf16 v[156:159], v[204:207], v[192:195], v[156:159]
    ds_read_b64_tr_b16 v[42:43], v18 offset:4096
    v_mfma_f32_16x16x32_bf16 v[140:143], v[204:207], v[188:191], v[140:143]
    ds_read_b64_tr_b16 v[44:45], v19 offset:0
    s_add_u32 s36, s47, 688128
    buffer_store_dwordx2 v[252:253], v254, s[16:19], s36 offen sc1
    v_mfma_f32_16x16x32_bf16 v[124:127], v[204:207], v[184:187], v[124:127]
    ds_read_b64_tr_b16 v[46:47], v19 offset:4096
    v_mfma_f32_16x16x32_bf16 v[128:131], v[208:211], v[184:187], v[128:131]
    ds_read_b64_tr_b16 v[48:49], v20 offset:0
    v_mfma_f32_16x16x32_bf16 v[144:147], v[208:211], v[188:191], v[144:147]
    ds_read_b64_tr_b16 v[50:51], v20 offset:4096
    v_mfma_f32_16x16x32_bf16 v[160:163], v[208:211], v[192:195], v[160:163]
    ds_read_b64_tr_b16 v[52:53], v21 offset:0
    v_mfma_f32_16x16x32_bf16 v[176:179], v[208:211], v[196:199], v[176:179]
    ds_read_b64_tr_b16 v[54:55], v21 offset:4096
    s_add_u32 s43, s43, 1
    v_mfma_f32_16x16x32_bf16 v[180:183], v[212:215], v[196:199], v[180:183]
    s_cmp_lt_u32 s43, 27
    v_mfma_f32_16x16x32_bf16 v[164:167], v[212:215], v[192:195], v[164:167]
    v_mfma_f32_16x16x32_bf16 v[148:151], v[212:215], v[188:191], v[148:151]
    v_mfma_f32_16x16x32_bf16 v[132:135], v[212:215], v[184:187], v[132:135]
    s_waitcnt vmcnt(8)
    buffer_atomic_add v8, v9, s[56:59], s49 offen offset:512 sc1
mm_21:
    s_waitcnt lgkmcnt(0)
    v_mfma_f32_16x16x32_bf16 v[120:123], v[40:43], v[24:27], v[120:123]
    ds_read_b128 v[184:187], v17 offset:1024
    v_mfma_f32_16x16x32_bf16 v[136:139], v[40:43], v[28:31], v[136:139]
    ds_read_b128 v[188:191], v17 offset:3072
    v_mfma_f32_16x16x32_bf16 v[152:155], v[40:43], v[32:35], v[152:155]
    ds_read_b128 v[192:195], v17 offset:5120
    v_mfma_f32_16x16x32_bf16 v[168:171], v[40:43], v[36:39], v[168:171]
    ds_read_b128 v[196:199], v17 offset:7168
    v_mfma_f32_16x16x32_bf16 v[172:175], v[44:47], v[36:39], v[172:175]
    ds_read_b64_tr_b16 v[200:201], v18 offset:8192
    v_mfma_f32_16x16x32_bf16 v[156:159], v[44:47], v[32:35], v[156:159]
    ds_read_b64_tr_b16 v[202:203], v18 offset:12288
    v_mfma_f32_16x16x32_bf16 v[140:143], v[44:47], v[28:31], v[140:143]
    ds_read_b64_tr_b16 v[204:205], v19 offset:8192
    v_mfma_f32_16x16x32_bf16 v[124:127], v[44:47], v[24:27], v[124:127]
    ds_read_b64_tr_b16 v[206:207], v19 offset:12288
    v_mfma_f32_16x16x32_bf16 v[128:131], v[48:51], v[24:27], v[128:131]
    ds_read_b64_tr_b16 v[208:209], v20 offset:8192
    v_mfma_f32_16x16x32_bf16 v[144:147], v[48:51], v[28:31], v[144:147]
    ds_read_b64_tr_b16 v[210:211], v20 offset:12288
    v_mfma_f32_16x16x32_bf16 v[160:163], v[48:51], v[32:35], v[160:163]
    ds_read_b64_tr_b16 v[212:213], v21 offset:8192
    v_mfma_f32_16x16x32_bf16 v[176:179], v[48:51], v[36:39], v[176:179]
    ds_read_b64_tr_b16 v[214:215], v21 offset:12288
    s_add_u32 s42, s42, 16384
    s_cmp_eq_u32 s42, 49152
    s_cselect_b32 s42, 0, s42
    v_mfma_f32_16x16x32_bf16 v[180:183], v[52:55], v[36:39], v[180:183]
    s_add_u32 s48, s48, 16384
    s_cmp_eq_u32 s48, 98304
    s_cselect_b32 s48, 0, s48
    v_mfma_f32_16x16x32_bf16 v[164:167], v[52:55], v[32:35], v[164:167]
    v_add_u32 v17, s42, v12
    v_add_u32 v18, s48, v13
    v_add_u32 v19, s48, v14
    v_mfma_f32_16x16x32_bf16 v[148:151], v[52:55], v[28:31], v[148:151]
    v_add_u32 v20, s48, v15
    v_add_u32 v21, s48, v16
    v_mfma_f32_16x16x32_bf16 v[132:135], v[52:55], v[24:27], v[132:135]
    s_waitcnt lgkmcnt(0)
    s_barrier
    v_mfma_f32_16x16x32_bf16 v[120:123], v[200:203], v[184:187], v[120:123]
    ds_read_b128 v[24:27], v17 offset:0
    v_mfma_f32_16x16x32_bf16 v[136:139], v[200:203], v[188:191], v[136:139]
    ds_read_b128 v[28:31], v17 offset:2048
    v_mfma_f32_16x16x32_bf16 v[152:155], v[200:203], v[192:195], v[152:155]
    ds_read_b128 v[32:35], v17 offset:4096
    v_mfma_f32_16x16x32_bf16 v[168:171], v[200:203], v[196:199], v[168:171]
    ds_read_b128 v[36:39], v17 offset:6144
    v_mfma_f32_16x16x32_bf16 v[172:175], v[204:207], v[196:199], v[172:175]
    ds_read_b64_tr_b16 v[40:41], v18 offset:0
    v_mfma_f32_16x16x32_bf16 v[156:159], v[204:207], v[192:195], v[156:159]
    ds_read_b64_tr_b16 v[42:43], v18 offset:4096
    v_mfma_f32_16x16x32_bf16 v[140:143], v[204:207], v[188:191], v[140:143]
    ds_read_b64_tr_b16 v[44:45], v19 offset:0
    v_mfma_f32_16x16x32_bf16 v[124:127], v[204:207], v[184:187], v[124:127]
    ds_read_b64_tr_b16 v[46:47], v19 offset:4096
    v_mfma_f32_16x16x32_bf16 v[128:131], v[208:211], v[184:187], v[128:131]
    ds_read_b64_tr_b16 v[48:49], v20 offset:0
    v_mfma_f32_16x16x32_bf16 v[144:147], v[208:211], v[188:191], v[144:147]
    ds_read_b64_tr_b16 v[50:51], v20 offset:4096
    v_mfma_f32_16x16x32_bf16 v[160:163], v[208:211], v[192:195], v[160:163]
    ds_read_b64_tr_b16 v[52:53], v21 offset:0
    v_mfma_f32_16x16x32_bf16 v[176:179], v[208:211], v[196:199], v[176:179]
    ds_read_b64_tr_b16 v[54:55], v21 offset:4096
    s_add_u32 s43, s43, 1
    v_mfma_f32_16x16x32_bf16 v[180:183], v[212:215], v[196:199], v[180:183]
    s_cmp_lt_u32 s43, 4
    v_mfma_f32_16x16x32_bf16 v[164:167], v[212:215], v[192:195], v[164:167]
    v_mfma_f32_16x16x32_bf16 v[148:151], v[212:215], v[188:191], v[148:151]
    v_mfma_f32_16x16x32_bf16 v[132:135], v[212:215], v[184:187], v[132:135]
    s_cbranch_scc1 mm_21
    s_waitcnt vmcnt(0)
    buffer_atomic_add v8, v9, s[56:59], s49 offen offset:1024 sc1
mm_22:
    s_waitcnt lgkmcnt(0)
    v_mfma_f32_16x16x32_bf16 v[120:123], v[40:43], v[24:27], v[120:123]
    ds_read_b128 v[184:187], v17 offset:1024
    v_mfma_f32_16x16x32_bf16 v[136:139], v[40:43], v[28:31], v[136:139]
    ds_read_b128 v[188:191], v17 offset:3072
    v_mfma_f32_16x16x32_bf16 v[152:155], v[40:43], v[32:35], v[152:155]
    ds_read_b128 v[192:195], v17 offset:5120
    v_mfma_f32_16x16x32_bf16 v[168:171], v[40:43], v[36:39], v[168:171]
    ds_read_b128 v[196:199], v17 offset:7168
    v_mfma_f32_16x16x32_bf16 v[172:175], v[44:47], v[36:39], v[172:175]
    ds_read_b64_tr_b16 v[200:201], v18 offset:8192
    v_mfma_f32_16x16x32_bf16 v[156:159], v[44:47], v[32:35], v[156:159]
    ds_read_b64_tr_b16 v[202:203], v18 offset:12288
    v_mfma_f32_16x16x32_bf16 v[140:143], v[44:47], v[28:31], v[140:143]
    ds_read_b64_tr_b16 v[204:205], v19 offset:8192
    v_mfma_f32_16x16x32_bf16 v[124:127], v[44:47], v[24:27], v[124:127]
    ds_read_b64_tr_b16 v[206:207], v19 offset:12288
    v_mfma_f32_16x16x32_bf16 v[128:131], v[48:51], v[24:27], v[128:131]
    ds_read_b64_tr_b16 v[208:209], v20 offset:8192
    v_mfma_f32_16x16x32_bf16 v[144:147], v[48:51], v[28:31], v[144:147]
    ds_read_b64_tr_b16 v[210:211], v20 offset:12288
    v_mfma_f32_16x16x32_bf16 v[160:163], v[48:51], v[32:35], v[160:163]
    ds_read_b64_tr_b16 v[212:213], v21 offset:8192
    v_mfma_f32_16x16x32_bf16 v[176:179], v[48:51], v[36:39], v[176:179]
    ds_read_b64_tr_b16 v[214:215], v21 offset:12288
    s_add_u32 s42, s42, 16384
    s_cmp_eq_u32 s42, 49152
    s_cselect_b32 s42, 0, s42
    v_mfma_f32_16x16x32_bf16 v[180:183], v[52:55], v[36:39], v[180:183]
    s_add_u32 s48, s48, 16384
    s_cmp_eq_u32 s48, 98304
    s_cselect_b32 s48, 0, s48
    v_mfma_f32_16x16x32_bf16 v[164:167], v[52:55], v[32:35], v[164:167]
    v_add_u32 v17, s42, v12
    v_add_u32 v18, s48, v13
    v_add_u32 v19, s48, v14
    v_mfma_f32_16x16x32_bf16 v[148:151], v[52:55], v[28:31], v[148:151]
    v_add_u32 v20, s48, v15
    v_add_u32 v21, s48, v16
    v_mfma_f32_16x16x32_bf16 v[132:135], v[52:55], v[24:27], v[132:135]
    s_waitcnt lgkmcnt(0)
    s_barrier
    v_mfma_f32_16x16x32_bf16 v[120:123], v[200:203], v[184:187], v[120:123]
    ds_read_b128 v[24:27], v17 offset:0
    v_mfma_f32_16x16x32_bf16 v[136:139], v[200:203], v[188:191], v[136:139]
    ds_read_b128 v[28:31], v17 offset:2048
    v_mfma_f32_16x16x32_bf16 v[152:155], v[200:203], v[192:195], v[152:155]
    ds_read_b128 v[32:35], v17 offset:4096
    v_mfma_f32_16x16x32_bf16 v[168:171], v[200:203], v[196:199], v[168:171]
    ds_read_b128 v[36:39], v17 offset:6144
    v_mfma_f32_16x16x32_bf16 v[172:175], v[204:207], v[196:199], v[172:175]
    ds_read_b64_tr_b16 v[40:41], v18 offset:0
    v_mfma_f32_16x16x32_bf16 v[156:159], v[204:207], v[192:195], v[156:159]
    ds_read_b64_tr_b16 v[42:43], v18 offset:4096
    v_mfma_f32_16x16x32_bf16 v[140:143], v[204:207], v[188:191], v[140:143]
    ds_read_b64_tr_b16 v[44:45], v19 offset:0
    v_mfma_f32_16x16x32_bf16 v[124:127], v[204:207], v[184:187], v[124:127]
    ds_read_b64_tr_b16 v[46:47], v19 offset:4096
    v_mfma_f32_16x16x32_bf16 v[128:131], v[208:211], v[184:187], v[128:131]
    ds_read_b64_tr_b16 v[48:49], v20 offset:0
    v_mfma_f32_16x16x32_bf16 v[144:147], v[208:211], v[188:191], v[144:147]
    ds_read_b64_tr_b16 v[50:51], v20 offset:4096
    v_mfma_f32_16x16x32_bf16 v[160:163], v[208:211], v[192:195], v[160:163]
    ds_read_b64_tr_b16 v[52:53], v21 offset:0
    v_mfma_f32_16x16x32_bf16 v[176:179], v[208:211], v[196:199], v[176:179]
    ds_read_b64_tr_b16 v[54:55], v21 offset:4096
    s_add_u32 s43, s43, 1
    v_mfma_f32_16x16x32_bf16 v[180:183], v[212:215], v[196:199], v[180:183]
    s_cmp_lt_u32 s43, 21
    v_mfma_f32_16x16x32_bf16 v[164:167], v[212:215], v[192:195], v[164:167]
    v_mfma_f32_16x16x32_bf16 v[148:151], v[212:215], v[188:191], v[148:151]
    v_mfma_f32_16x16x32_bf16 v[132:135], v[212:215], v[184:187], v[132:135]
    s_cbranch_scc1 mm_22
    s_waitcnt lgkmcnt(0)
    v_mfma_f32_16x16x32_bf16 v[120:123], v[40:43], v[24:27], v[120:123]
    ds_read_b128 v[184:187], v17 offset:1024
    v_mfma_f32_16x16x32_bf16 v[136:139], v[40:43], v[28:31], v[136:139]
    ds_read_b128 v[188:191], v17 offset:3072
    v_mfma_f32_16x16x32_bf16 v[152:155], v[40:43], v[32:35], v[152:155]
    ds_read_b128 v[192:195], v17 offset:5120
    v_mfma_f32_16x16x32_bf16 v[168:171], v[40:43], v[36:39], v[168:171]
    ds_read_b128 v[196:199], v17 offset:7168
    v_mfma_f32_16x16x32_bf16 v[172:175], v[44:47], v[36:39], v[172:175]
    ds_read_b64_tr_b16 v[200:201], v18 offset:8192
    v_mfma_f32_16x16x32_bf16 v[156:159], v[44:47], v[32:35], v[156:159]
    ds_read_b64_tr_b16 v[202:203], v18 offset:12288
    v_mfma_f32_16x16x32_bf16 v[140:143], v[44:47], v[28:31], v[140:143]
    ds_read_b64_tr_b16 v[204:205], v19 offset:8192
    v_mfma_f32_16x16x32_bf16 v[124:127], v[44:47], v[24:27], v[124:127]
    ds_read_b64_tr_b16 v[206:207], v19 offset:12288
    v_mfma_f32_16x16x32_bf16 v[128:131], v[48:51], v[24:27], v[128:131]
    ds_read_b64_tr_b16 v[208:209], v20 offset:8192
    v_mfma_f32_16x16x32_bf16 v[144:147], v[48:51], v[28:31], v[144:147]
    ds_read_b64_tr_b16 v[210:211], v20 offset:12288
    v_mfma_f32_16x16x32_bf16 v[160:163], v[48:51], v[32:35], v[160:163]
    ds_read_b64_tr_b16 v[212:213], v21 offset:8192
    v_mfma_f32_16x16x32_bf16 v[176:179], v[48:51], v[36:39], v[176:179]
    ds_read_b64_tr_b16 v[214:215], v21 offset:12288
    v_add_u32 v18, 49152, v13
    v_mfma_f32_16x16x32_bf16 v[180:183], v[52:55], v[36:39], v[180:183]
    v_add_u32 v19, 49152, v14
    v_mfma_f32_16x16x32_bf16 v[164:167], v[52:55], v[32:35], v[164:167]
    v_add_u32 v20, 49152, v15
    v_mfma_f32_16x16x32_bf16 v[148:151], v[52:55], v[28:31], v[148:151]
    v_add_u32 v21, 49152, v16
    v_mfma_f32_16x16x32_bf16 v[132:135], v[52:55], v[24:27], v[132:135]
    s_waitcnt lgkmcnt(0)
    s_barrier
    v_mfma_f32_16x16x32_bf16 v[120:123], v[200:203], v[184:187], v[120:123]
    ds_read_b128 v[232:235], v12 offset:16384
    ds_read_b128 v[236:239], v12 offset:18432
    v_mfma_f32_16x16x32_bf16 v[136:139], v[200:203], v[188:191], v[136:139]
    ds_read_b128 v[240:243], v12 offset:17408
    ds_read_b128 v[244:247], v12 offset:19456
    v_mfma_f32_16x16x32_bf16 v[152:155], v[200:203], v[192:195], v[152:155]
    ds_read_b64_tr_b16 v[24:25], v18 offset:16384
    v_mfma_f32_16x16x32_bf16 v[168:171], v[200:203], v[196:199], v[168:171]
    ds_read_b64_tr_b16 v[26:27], v18 offset:20480
    ds_read_b64_tr_b16 v[28:29], v19 offset:16384
    v_mfma_f32_16x16x32_bf16 v[172:175], v[204:207], v[196:199], v[172:175]
    ds_read_b64_tr_b16 v[30:31], v19 offset:20480
    ds_read_b64_tr_b16 v[32:33], v20 offset:16384
    v_mfma_f32_16x16x32_bf16 v[156:159], v[204:207], v[192:195], v[156:159]
    ds_read_b64_tr_b16 v[34:35], v20 offset:20480
    v_mfma_f32_16x16x32_bf16 v[140:143], v[204:207], v[188:191], v[140:143]
    ds_read_b64_tr_b16 v[36:37], v21 offset:16384
    ds_read_b64_tr_b16 v[38:39], v21 offset:20480
    v_mfma_f32_16x16x32_bf16 v[124:127], v[204:207], v[184:187], v[124:127]
    ds_read_b64_tr_b16 v[40:41], v18 offset:24576
    ds_read_b64_tr_b16 v[42:43], v18 offset:28672
    v_mfma_f32_16x16x32_bf16 v[128:131], v[208:211], v[184:187], v[128:131]
    ds_read_b64_tr_b16 v[44:45], v19 offset:24576
    v_mfma_f32_16x16x32_bf16 v[144:147], v[208:211], v[188:191], v[144:147]
    ds_read_b64_tr_b16 v[46:47], v19 offset:28672
    ds_read_b64_tr_b16 v[48:49], v20 offset:24576
    v_mfma_f32_16x16x32_bf16 v[160:163], v[208:211], v[192:195], v[160:163]
    ds_read_b64_tr_b16 v[50:51], v20 offset:28672
    ds_read_b64_tr_b16 v[52:53], v21 offset:24576
    v_mfma_f32_16x16x32_bf16 v[176:179], v[208:211], v[196:199], v[176:179]
    ds_read_b64_tr_b16 v[54:55], v21 offset:28672
    v_mfma_f32_16x16x32_bf16 v[180:183], v[212:215], v[196:199], v[180:183]
    v_mfma_f32_16x16x32_bf16 v[164:167], v[212:215], v[192:195], v[164:167]
    v_mfma_f32_16x16x32_bf16 v[148:151], v[212:215], v[188:191], v[148:151]
    v_mfma_f32_16x16x32_bf16 v[132:135], v[212:215], v[184:187], v[132:135]
    s_waitcnt lgkmcnt(8)
    v_mfma_f32_16x16x32_bf16 v[152:155], v[24:27], v[232:235], v[152:155]
    ds_read_b128 v[88:91], v12 offset:20480
    ds_read_b128 v[92:95], v12 offset:22528
    v_mfma_f32_16x16x32_bf16 v[168:171], v[24:27], v[236:239], v[168:171]
    ds_read_b128 v[96:99], v12 offset:21504
    v_mfma_f32_16x16x32_bf16 v[172:175], v[28:31], v[236:239], v[172:175]
    ds_read_b128 v[100:103], v12 offset:23552
    v_mfma_f32_16x16x32_bf16 v[156:159], v[28:31], v[232:235], v[156:159]
    ds_read_b64_tr_b16 v[184:185], v18 offset:32768
    v_mfma_f32_16x16x32_bf16 v[160:163], v[32:35], v[232:235], v[160:163]
    ds_read_b64_tr_b16 v[186:187], v18 offset:36864
    ds_read_b64_tr_b16 v[188:189], v19 offset:32768
    v_mfma_f32_16x16x32_bf16 v[176:179], v[32:35], v[236:239], v[176:179]
    ds_read_b64_tr_b16 v[190:191], v19 offset:36864
    v_mfma_f32_16x16x32_bf16 v[180:183], v[36:39], v[236:239], v[180:183]
    ds_read_b64_tr_b16 v[192:193], v20 offset:32768
    v_mfma_f32_16x16x32_bf16 v[164:167], v[36:39], v[232:235], v[164:167]
    ds_read_b64_tr_b16 v[194:195], v20 offset:36864
    s_waitcnt lgkmcnt(10)
    v_mfma_f32_16x16x32_bf16 v[152:155], v[40:43], v[240:243], v[152:155]
    ds_read_b64_tr_b16 v[196:197], v21 offset:32768
    ds_read_b64_tr_b16 v[198:199], v21 offset:36864
    v_mfma_f32_16x16x32_bf16 v[168:171], v[40:43], v[244:247], v[168:171]
    ds_read_b64_tr_b16 v[200:201], v18 offset:40960
    v_mfma_f32_16x16x32_bf16 v[172:175], v[44:47], v[244:247], v[172:175]
    ds_read_b64_tr_b16 v[202:203], v18 offset:45056
    v_mfma_f32_16x16x32_bf16 v[156:159], v[44:47], v[240:243], v[156:159]
    ds_read_b64_tr_b16 v[204:205], v19 offset:40960
    v_mfma_f32_16x16x32_bf16 v[160:163], v[48:51], v[240:243], v[160:163]
    ds_read_b64_tr_b16 v[206:207], v19 offset:45056
    ds_read_b64_tr_b16 v[208:209], v20 offset:40960
    v_mfma_f32_16x16x32_bf16 v[176:179], v[48:51], v[244:247], v[176:179]
    ds_read_b64_tr_b16 v[210:211], v20 offset:45056
    v_mfma_f32_16x16x32_bf16 v[180:183], v[52:55], v[244:247], v[180:183]
    ds_read_b64_tr_b16 v[212:213], v21 offset:40960
    v_mfma_f32_16x16x32_bf16 v[164:167], v[52:55], v[240:243], v[164:167]
    ds_read_b64_tr_b16 v[214:215], v21 offset:45056
    s_waitcnt lgkmcnt(8)
    s_barrier
    v_mfma_f32_16x16x32_bf16 v[152:155], v[184:187], v[88:91], v[152:155]
    ds_read_b128 v[232:235], v12 offset:32768
    ds_read_b128 v[236:239], v12 offset:34816
    v_mfma_f32_16x16x32_bf16 v[168:171], v[184:187], v[92:95], v[168:171]
    ds_read_b128 v[240:243], v12 offset:33792
    v_mfma_f32_16x16x32_bf16 v[172:175], v[188:191], v[92:95], v[172:175]
    ds_read_b128 v[244:247], v12 offset:35840
    v_mfma_f32_16x16x32_bf16 v[156:159], v[188:191], v[88:91], v[156:159]
    ds_read_b64_tr_b16 v[24:25], v13 offset:0
    v_mfma_f32_16x16x32_bf16 v[160:163], v[192:195], v[88:91], v[160:163]
    ds_read_b64_tr_b16 v[26:27], v13 offset:4096
    ds_read_b64_tr_b16 v[28:29], v14 offset:0
    v_mfma_f32_16x16x32_bf16 v[176:179], v[192:195], v[92:95], v[176:179]
    ds_read_b64_tr_b16 v[30:31], v14 offset:4096
    v_mfma_f32_16x16x32_bf16 v[180:183], v[196:199], v[92:95], v[180:183]
    ds_read_b64_tr_b16 v[32:33], v15 offset:0
    v_mfma_f32_16x16x32_bf16 v[164:167], v[196:199], v[88:91], v[164:167]
    ds_read_b64_tr_b16 v[34:35], v15 offset:4096
    s_waitcnt lgkmcnt(10)
    v_mfma_f32_16x16x32_bf16 v[152:155], v[200:203], v[96:99], v[152:155]
    ds_read_b64_tr_b16 v[36:37], v16 offset:0
    ds_read_b64_tr_b16 v[38:39], v16 offset:4096
    v_mfma_f32_16x16x32_bf16 v[168:171], v[200:203], v[100:103], v[168:171]
    ds_read_b64_tr_b16 v[40:41], v13 offset:8192
    v_mfma_f32_16x16x32_bf16 v[172:175], v[204:207], v[100:103], v[172:175]
    ds_read_b64_tr_b16 v[42:43], v13 offset:12288
    v_mfma_f32_16x16x32_bf16 v[156:159], v[204:207], v[96:99], v[156:159]
    ds_read_b64_tr_b16 v[44:45], v14 offset:8192
    v_mfma_f32_16x16x32_bf16 v[160:163], v[208:211], v[96:99], v[160:163]
    ds_read_b64_tr_b16 v[46:47], v14 offset:12288
    ds_read_b64_tr_b16 v[48:49], v15 offset:8192
    v_mfma_f32_16x16x32_bf16 v[176:179], v[208:211], v[100:103], v[176:179]
    ds_read_b64_tr_b16 v[50:51], v15 offset:12288
    v_mfma_f32_16x16x32_bf16 v[180:183], v[212:215], v[100:103], v[180:183]
    ds_read_b64_tr_b16 v[52:53], v16 offset:8192
    v_mfma_f32_16x16x32_bf16 v[164:167], v[212:215], v[96:99], v[164:167]
    ds_read_b64_tr_b16 v[54:55], v16 offset:12288
    s_waitcnt lgkmcnt(8)
    v_mfma_f32_16x16x32_bf16 v[152:155], v[24:27], v[232:235], v[152:155]
    ds_read_b128 v[88:91], v12 offset:36864
    ds_read_b128 v[92:95], v12 offset:38912
    v_mfma_f32_16x16x32_bf16 v[168:171], v[24:27], v[236:239], v[168:171]
    ds_read_b128 v[96:99], v12 offset:37888
    v_mfma_f32_16x16x32_bf16 v[172:175], v[28:31], v[236:239], v[172:175]
    ds_read_b128 v[100:103], v12 offset:39936
    v_mfma_f32_16x16x32_bf16 v[156:159], v[28:31], v[232:235], v[156:159]
    ds_read_b64_tr_b16 v[184:185], v13 offset:16384
    v_mfma_f32_16x16x32_bf16 v[160:163], v[32:35], v[232:235], v[160:163]
    ds_read_b64_tr_b16 v[186:187], v13 offset:20480
    ds_read_b64_tr_b16 v[188:189], v14 offset:16384
    v_mfma_f32_16x16x32_bf16 v[176:179], v[32:35], v[236:239], v[176:179]
    ds_read_b64_tr_b16 v[190:191], v14 offset:20480
    v_mfma_f32_16x16x32_bf16 v[180:183], v[36:39], v[236:239], v[180:183]
    ds_read_b64_tr_b16 v[192:193], v15 offset:16384
    v_mfma_f32_16x16x32_bf16 v[164:167], v[36:39], v[232:235], v[164:167]
    ds_read_b64_tr_b16 v[194:195], v15 offset:20480
    s_waitcnt lgkmcnt(10)
    v_mfma_f32_16x16x32_bf16 v[152:155], v[40:43], v[240:243], v[152:155]
    ds_read_b64_tr_b16 v[196:197], v16 offset:16384
    ds_read_b64_tr_b16 v[198:199], v16 offset:20480
    v_mfma_f32_16x16x32_bf16 v[168:171], v[40:43], v[244:247], v[168:171]
    ds_read_b64_tr_b16 v[200:201], v13 offset:24576
    v_mfma_f32_16x16x32_bf16 v[172:175], v[44:47], v[244:247], v[172:175]
    ds_read_b64_tr_b16 v[202:203], v13 offset:28672
    v_mfma_f32_16x16x32_bf16 v[156:159], v[44:47], v[240:243], v[156:159]
    ds_read_b64_tr_b16 v[204:205], v14 offset:24576
    v_mfma_f32_16x16x32_bf16 v[160:163], v[48:51], v[240:243], v[160:163]
    ds_read_b64_tr_b16 v[206:207], v14 offset:28672
    ds_read_b64_tr_b16 v[208:209], v15 offset:24576
    v_mfma_f32_16x16x32_bf16 v[176:179], v[48:51], v[244:247], v[176:179]
    ds_read_b64_tr_b16 v[210:211], v15 offset:28672
    v_mfma_f32_16x16x32_bf16 v[180:183], v[52:55], v[244:247], v[180:183]
    ds_read_b64_tr_b16 v[212:213], v16 offset:24576
    v_mfma_f32_16x16x32_bf16 v[164:167], v[52:55], v[240:243], v[164:167]
    ds_read_b64_tr_b16 v[214:215], v16 offset:28672
    s_waitcnt lgkmcnt(8)
    s_barrier
    v_mfma_f32_16x16x32_bf16 v[152:155], v[184:187], v[88:91], v[152:155]
    ds_read_b128 v[232:235], v12 offset:0
    ds_read_b128 v[236:239], v12 offset:2048
    v_mfma_f32_16x16x32_bf16 v[168:171], v[184:187], v[92:95], v[168:171]
    ds_read_b128 v[240:243], v12 offset:1024
    v_mfma_f32_16x16x32_bf16 v[172:175], v[188:191], v[92:95], v[172:175]
    ds_read_b128 v[244:247], v12 offset:3072
    v_mfma_f32_16x16x32_bf16 v[156:159], v[188:191], v[88:91], v[156:159]
    ds_read_b64_tr_b16 v[24:25], v13 offset:32768
    v_mfma_f32_16x16x32_bf16 v[160:163], v[192:195], v[88:91], v[160:163]
    ds_read_b64_tr_b16 v[26:27], v13 offset:36864
    ds_read_b64_tr_b16 v[28:29], v14 offset:32768
    v_mfma_f32_16x16x32_bf16 v[176:179], v[192:195], v[92:95], v[176:179]
    ds_read_b64_tr_b16 v[30:31], v14 offset:36864
    v_mfma_f32_16x16x32_bf16 v[180:183], v[196:199], v[92:95], v[180:183]
    ds_read_b64_tr_b16 v[32:33], v15 offset:32768
    v_mfma_f32_16x16x32_bf16 v[164:167], v[196:199], v[88:91], v[164:167]
    ds_read_b64_tr_b16 v[34:35], v15 offset:36864
    s_waitcnt lgkmcnt(10)
    v_mfma_f32_16x16x32_bf16 v[152:155], v[200:203], v[96:99], v[152:155]
    ds_read_b64_tr_b16 v[36:37], v16 offset:32768
    ds_read_b64_tr_b16 v[38:39], v16 offset:36864
    v_mfma_f32_16x16x32_bf16 v[168:171], v[200:203], v[100:103], v[168:171]
    ds_read_b64_tr_b16 v[40:41], v13 offset:40960
    v_mfma_f32_16x16x32_bf16 v[172:175], v[204:207], v[100:103], v[172:175]
    ds_read_b64_tr_b16 v[42:43], v13 offset:45056
    v_mfma_f32_16x16x32_bf16 v[156:159], v[204:207], v[96:99], v[156:159]
    ds_read_b64_tr_b16 v[44:45], v14 offset:40960
    v_mfma_f32_16x16x32_bf16 v[160:163], v[208:211], v[96:99], v[160:163]
    ds_read_b64_tr_b16 v[46:47], v14 offset:45056
    ds_read_b64_tr_b16 v[48:49], v15 offset:40960
    v_mfma_f32_16x16x32_bf16 v[176:179], v[208:211], v[100:103], v[176:179]
    ds_read_b64_tr_b16 v[50:51], v15 offset:45056
    v_mfma_f32_16x16x32_bf16 v[180:183], v[212:215], v[100:103], v[180:183]
    ds_read_b64_tr_b16 v[52:53], v16 offset:40960
    v_mfma_f32_16x16x32_bf16 v[164:167], v[212:215], v[96:99], v[164:167]
    ds_read_b64_tr_b16 v[54:55], v16 offset:45056
    s_waitcnt lgkmcnt(8)
    v_mfma_f32_16x16x32_bf16 v[152:155], v[24:27], v[232:235], v[152:155]
    ds_read_b128 v[88:91], v12 offset:4096
    ds_read_b128 v[92:95], v12 offset:6144
    v_mfma_f32_16x16x32_bf16 v[168:171], v[24:27], v[236:239], v[168:171]
    ds_read_b128 v[96:99], v12 offset:5120
    v_mfma_f32_16x16x32_bf16 v[172:175], v[28:31], v[236:239], v[172:175]
    ds_read_b128 v[100:103], v12 offset:7168
    v_mfma_f32_16x16x32_bf16 v[156:159], v[28:31], v[232:235], v[156:159]
    ds_read_b64_tr_b16 v[184:185], v18 offset:0
    v_mfma_f32_16x16x32_bf16 v[160:163], v[32:35], v[232:235], v[160:163]
    ds_read_b64_tr_b16 v[186:187], v18 offset:4096
    ds_read_b64_tr_b16 v[188:189], v19 offset:0
    v_mfma_f32_16x16x32_bf16 v[176:179], v[32:35], v[236:239], v[176:179]
    ds_read_b64_tr_b16 v[190:191], v19 offset:4096
    v_mfma_f32_16x16x32_bf16 v[180:183], v[36:39], v[236:239], v[180:183]
    ds_read_b64_tr_b16 v[192:193], v20 offset:0
    v_mfma_f32_16x16x32_bf16 v[164:167], v[36:39], v[232:235], v[164:167]
    ds_read_b64_tr_b16 v[194:195], v20 offset:4096
    s_waitcnt lgkmcnt(10)
    v_mfma_f32_16x16x32_bf16 v[152:155], v[40:43], v[240:243], v[152:155]
    ds_read_b64_tr_b16 v[196:197], v21 offset:0
    ds_read_b64_tr_b16 v[198:199], v21 offset:4096
    v_mfma_f32_16x16x32_bf16 v[168:171], v[40:43], v[244:247], v[168:171]
    ds_read_b64_tr_b16 v[200:201], v18 offset:8192
    v_mfma_f32_16x16x32_bf16 v[172:175], v[44:47], v[244:247], v[172:175]
    ds_read_b64_tr_b16 v[202:203], v18 offset:12288
    v_mfma_f32_16x16x32_bf16 v[156:159], v[44:47], v[240:243], v[156:159]
    ds_read_b64_tr_b16 v[204:205], v19 offset:8192
    v_mfma_f32_16x16x32_bf16 v[160:163], v[48:51], v[240:243], v[160:163]
    ds_read_b64_tr_b16 v[206:207], v19 offset:12288
    ds_read_b64_tr_b16 v[208:209], v20 offset:8192
    v_mfma_f32_16x16x32_bf16 v[176:179], v[48:51], v[244:247], v[176:179]
    ds_read_b64_tr_b16 v[210:211], v20 offset:12288
    v_mfma_f32_16x16x32_bf16 v[180:183], v[52:55], v[244:247], v[180:183]
    ds_read_b64_tr_b16 v[212:213], v21 offset:8192
    v_mfma_f32_16x16x32_bf16 v[164:167], v[52:55], v[240:243], v[164:167]
    ds_read_b64_tr_b16 v[214:215], v21 offset:12288
    s_waitcnt lgkmcnt(8)
    s_barrier
    v_mfma_f32_16x16x32_bf16 v[152:155], v[184:187], v[88:91], v[152:155]
    ds_read_b128 v[232:235], v12 offset:16384
    ds_read_b128 v[236:239], v12 offset:18432
    v_mfma_f32_16x16x32_bf16 v[168:171], v[184:187], v[92:95], v[168:171]
    ds_read_b128 v[240:243], v12 offset:17408
    v_mfma_f32_16x16x32_bf16 v[172:175], v[188:191], v[92:95], v[172:175]
    ds_read_b128 v[244:247], v12 offset:19456
    v_mfma_f32_16x16x32_bf16 v[156:159], v[188:191], v[88:91], v[156:159]
    ds_read_b64_tr_b16 v[24:25], v18 offset:16384
    v_mfma_f32_16x16x32_bf16 v[160:163], v[192:195], v[88:91], v[160:163]
    ds_read_b64_tr_b16 v[26:27], v18 offset:20480
    ds_read_b64_tr_b16 v[28:29], v19 offset:16384
    v_mfma_f32_16x16x32_bf16 v[176:179], v[192:195], v[92:95], v[176:179]
    ds_read_b64_tr_b16 v[30:31], v19 offset:20480
    v_mfma_f32_16x16x32_bf16 v[180:183], v[196:199], v[92:95], v[180:183]
    ds_read_b64_tr_b16 v[32:33], v20 offset:16384
    v_mfma_f32_16x16x32_bf16 v[164:167], v[196:199], v[88:91], v[164:167]
    ds_read_b64_tr_b16 v[34:35], v20 offset:20480
    s_waitcnt lgkmcnt(10)
    v_mfma_f32_16x16x32_bf16 v[152:155], v[200:203], v[96:99], v[152:155]
    ds_read_b64_tr_b16 v[36:37], v21 offset:16384
    ds_read_b64_tr_b16 v[38:39], v21 offset:20480
    v_mfma_f32_16x16x32_bf16 v[168:171], v[200:203], v[100:103], v[168:171]
    ds_read_b64_tr_b16 v[40:41], v18 offset:24576
    v_mfma_f32_16x16x32_bf16 v[172:175], v[204:207], v[100:103], v[172:175]
    ds_read_b64_tr_b16 v[42:43], v18 offset:28672
    v_mfma_f32_16x16x32_bf16 v[156:159], v[204:207], v[96:99], v[156:159]
    ds_read_b64_tr_b16 v[44:45], v19 offset:24576
    v_mfma_f32_16x16x32_bf16 v[160:163], v[208:211], v[96:99], v[160:163]
    ds_read_b64_tr_b16 v[46:47], v19 offset:28672
    ds_read_b64_tr_b16 v[48:49], v20 offset:24576
    v_mfma_f32_16x16x32_bf16 v[176:179], v[208:211], v[100:103], v[176:179]
    ds_read_b64_tr_b16 v[50:51], v20 offset:28672
    v_mfma_f32_16x16x32_bf16 v[180:183], v[212:215], v[100:103], v[180:183]
    ds_read_b64_tr_b16 v[52:53], v21 offset:24576
    v_mfma_f32_16x16x32_bf16 v[164:167], v[212:215], v[96:99], v[164:167]
    ds_read_b64_tr_b16 v[54:55], v21 offset:28672
    s_waitcnt lgkmcnt(8)
    v_mfma_f32_16x16x32_bf16 v[120:123], v[24:27], v[232:235], v[120:123]
    ds_read_b128 v[88:91], v12 offset:20480
    ds_read_b128 v[92:95], v12 offset:22528
    v_mfma_f32_16x16x32_bf16 v[136:139], v[24:27], v[236:239], v[136:139]
    ds_read_b128 v[96:99], v12 offset:21504
    v_mfma_f32_16x16x32_bf16 v[140:143], v[28:31], v[236:239], v[140:143]
    ds_read_b128 v[100:103], v12 offset:23552
    v_mfma_f32_16x16x32_bf16 v[124:127], v[28:31], v[232:235], v[124:127]
    ds_read_b64_tr_b16 v[184:185], v18 offset:32768
    v_and_or_b32 v152, v152, s15, v56
    v_and_or_b32 v154, v154, s15, v56
    v_and_or_b32 v156, v156, s15, v56
    v_and_or_b32 v158, v158, s15, v56
    v_cvt_pk_bf16_f32 v152, v152, v153
    v_cvt_pk_bf16_f32 v153, v154, v155
    v_cvt_pk_bf16_f32 v154, v156, v157
    v_cvt_pk_bf16_f32 v155, v158, v159
    buffer_store_dwordx4 v[152:155], v2, s[24:27], s41 offen offset:0 sc1
    v_and_or_b32 v160, v160, s15, v56
    v_and_or_b32 v162, v162, s15, v56
    v_and_or_b32 v164, v164, s15, v56
    v_and_or_b32 v166, v166, s15, v56
    v_cvt_pk_bf16_f32 v160, v160, v161
    v_cvt_pk_bf16_f32 v161, v162, v163
    v_cvt_pk_bf16_f32 v162, v164, v165
    v_cvt_pk_bf16_f32 v163, v166, v167
    buffer_store_dwordx4 v[160:163], v2, s[24:27], s41 offen offset:1024 sc1
    s_add_u32 s36, s41, 65536
    v_and_or_b32 v168, v168, s15, v56
    v_and_or_b32 v170, v170, s15, v56
    v_and_or_b32 v172, v172, s15, v56
    v_and_or_b32 v174, v174, s15, v56
    v_cvt_pk_bf16_f32 v168, v168, v169
    v_cvt_pk_bf16_f32 v169, v170, v171
    v_cvt_pk_bf16_f32 v170, v172, v173
    v_cvt_pk_bf16_f32 v171, v174, v175
    buffer_store_dwordx4 v[168:171], v2, s[24:27], s36 offen offset:0 sc1
    v_and_or_b32 v176, v176, s15, v56
    v_and_or_b32 v178, v178, s15, v56
    v_and_or_b32 v180, v180, s15, v56
    v_and_or_b32 v182, v182, s15, v56
    v_cvt_pk_bf16_f32 v176, v176, v177
    v_cvt_pk_bf16_f32 v177, v178, v179
    v_cvt_pk_bf16_f32 v178, v180, v181
    v_cvt_pk_bf16_f32 v179, v182, v183
    buffer_store_dwordx4 v[176:179], v2, s[24:27], s36 offen offset:1024 sc1
    v_mfma_f32_16x16x32_bf16 v[128:131], v[32:35], v[232:235], v[128:131]
    ds_read_b64_tr_b16 v[186:187], v18 offset:36864
    ds_read_b64_tr_b16 v[188:189], v19 offset:32768
    v_mfma_f32_16x16x32_bf16 v[144:147], v[32:35], v[236:239], v[144:147]
    ds_read_b64_tr_b16 v[190:191], v19 offset:36864
    v_mfma_f32_16x16x32_bf16 v[148:151], v[36:39], v[236:239], v[148:151]
    ds_read_b64_tr_b16 v[192:193], v20 offset:32768
    v_mfma_f32_16x16x32_bf16 v[132:135], v[36:39], v[232:235], v[132:135]
    ds_read_b64_tr_b16 v[194:195], v20 offset:36864
    s_waitcnt lgkmcnt(10)
    v_mfma_f32_16x16x32_bf16 v[120:123], v[40:43], v[240:243], v[120:123]
    ds_read_b64_tr_b16 v[196:197], v21 offset:32768
    ds_read_b64_tr_b16 v[198:199], v21 offset:36864
    v_mfma_f32_16x16x32_bf16 v[136:139], v[40:43], v[244:247], v[136:139]
    ds_read_b64_tr_b16 v[200:201], v18 offset:40960
    v_mfma_f32_16x16x32_bf16 v[140:143], v[44:47], v[244:247], v[140:143]
    ds_read_b64_tr_b16 v[202:203], v18 offset:45056
    v_mfma_f32_16x16x32_bf16 v[124:127], v[44:47], v[240:243], v[124:127]
    ds_read_b64_tr_b16 v[204:205], v19 offset:40960
    v_mfma_f32_16x16x32_bf16 v[128:131], v[48:51], v[240:243], v[128:131]
    ds_read_b64_tr_b16 v[206:207], v19 offset:45056
    ds_read_b64_tr_b16 v[208:209], v20 offset:40960
    v_mfma_f32_16x16x32_bf16 v[144:147], v[48:51], v[244:247], v[144:147]
    ds_read_b64_tr_b16 v[210:211], v20 offset:45056
    v_mfma_f32_16x16x32_bf16 v[148:151], v[52:55], v[244:247], v[148:151]
    ds_read_b64_tr_b16 v[212:213], v21 offset:40960
    v_mfma_f32_16x16x32_bf16 v[132:135], v[52:55], v[240:243], v[132:135]
    ds_read_b64_tr_b16 v[214:215], v21 offset:45056
    s_waitcnt lgkmcnt(8)
    s_barrier
    v_mfma_f32_16x16x32_bf16 v[120:123], v[184:187], v[88:91], v[120:123]
    ds_read_b128 v[232:235], v12 offset:32768
    ds_read_b128 v[236:239], v12 offset:34816
    v_mfma_f32_16x16x32_bf16 v[136:139], v[184:187], v[92:95], v[136:139]
    ds_read_b128 v[240:243], v12 offset:33792
    v_mfma_f32_16x16x32_bf16 v[140:143], v[188:191], v[92:95], v[140:143]
    ds_read_b128 v[244:247], v12 offset:35840
    v_mfma_f32_16x16x32_bf16 v[124:127], v[188:191], v[88:91], v[124:127]
    ds_read_b64_tr_b16 v[24:25], v13 offset:0
    v_mfma_f32_16x16x32_bf16 v[128:131], v[192:195], v[88:91], v[128:131]
    ds_read_b64_tr_b16 v[26:27], v13 offset:4096
    ds_read_b64_tr_b16 v[28:29], v14 offset:0
    v_mfma_f32_16x16x32_bf16 v[144:147], v[192:195], v[92:95], v[144:147]
    ds_read_b64_tr_b16 v[30:31], v14 offset:4096
    v_mfma_f32_16x16x32_bf16 v[148:151], v[196:199], v[92:95], v[148:151]
    ds_read_b64_tr_b16 v[32:33], v15 offset:0
    v_mfma_f32_16x16x32_bf16 v[132:135], v[196:199], v[88:91], v[132:135]
    ds_read_b64_tr_b16 v[34:35], v15 offset:4096
    s_waitcnt lgkmcnt(10)
    v_mfma_f32_16x16x32_bf16 v[120:123], v[200:203], v[96:99], v[120:123]
    ds_read_b64_tr_b16 v[36:37], v16 offset:0
    ds_read_b64_tr_b16 v[38:39], v16 offset:4096
    v_mfma_f32_16x16x32_bf16 v[136:139], v[200:203], v[100:103], v[136:139]
    ds_read_b64_tr_b16 v[40:41], v13 offset:8192
    v_mfma_f32_16x16x32_bf16 v[140:143], v[204:207], v[100:103], v[140:143]
    ds_read_b64_tr_b16 v[42:43], v13 offset:12288
    v_mfma_f32_16x16x32_bf16 v[124:127], v[204:207], v[96:99], v[124:127]
    ds_read_b64_tr_b16 v[44:45], v14 offset:8192
    v_mfma_f32_16x16x32_bf16 v[128:131], v[208:211], v[96:99], v[128:131]
    ds_read_b64_tr_b16 v[46:47], v14 offset:12288
    ds_read_b64_tr_b16 v[48:49], v15 offset:8192
    v_mfma_f32_16x16x32_bf16 v[144:147], v[208:211], v[100:103], v[144:147]
    ds_read_b64_tr_b16 v[50:51], v15 offset:12288
    v_mfma_f32_16x16x32_bf16 v[148:151], v[212:215], v[100:103], v[148:151]
    ds_read_b64_tr_b16 v[52:53], v16 offset:8192
    v_mfma_f32_16x16x32_bf16 v[132:135], v[212:215], v[96:99], v[132:135]
    ds_read_b64_tr_b16 v[54:55], v16 offset:12288
    s_waitcnt lgkmcnt(8)
    v_mfma_f32_16x16x32_bf16 v[120:123], v[24:27], v[232:235], v[120:123]
    ds_read_b128 v[88:91], v12 offset:36864
    ds_read_b128 v[92:95], v12 offset:38912
    v_mfma_f32_16x16x32_bf16 v[136:139], v[24:27], v[236:239], v[136:139]
    ds_read_b128 v[96:99], v12 offset:37888
    v_mfma_f32_16x16x32_bf16 v[140:143], v[28:31], v[236:239], v[140:143]
    ds_read_b128 v[100:103], v12 offset:39936
    v_mfma_f32_16x16x32_bf16 v[124:127], v[28:31], v[232:235], v[124:127]
    ds_read_b64_tr_b16 v[184:185], v13 offset:16384
    v_mfma_f32_16x16x32_bf16 v[128:131], v[32:35], v[232:235], v[128:131]
    ds_read_b64_tr_b16 v[186:187], v13 offset:20480
    ds_read_b64_tr_b16 v[188:189], v14 offset:16384
    v_mfma_f32_16x16x32_bf16 v[144:147], v[32:35], v[236:239], v[144:147]
    ds_read_b64_tr_b16 v[190:191], v14 offset:20480
    v_mfma_f32_16x16x32_bf16 v[148:151], v[36:39], v[236:239], v[148:151]
    ds_read_b64_tr_b16 v[192:193], v15 offset:16384
    v_mfma_f32_16x16x32_bf16 v[132:135], v[36:39], v[232:235], v[132:135]
    ds_read_b64_tr_b16 v[194:195], v15 offset:20480
    s_waitcnt lgkmcnt(10)
    v_mfma_f32_16x16x32_bf16 v[120:123], v[40:43], v[240:243], v[120:123]
    ds_read_b64_tr_b16 v[196:197], v16 offset:16384
    ds_read_b64_tr_b16 v[198:199], v16 offset:20480
    v_mfma_f32_16x16x32_bf16 v[136:139], v[40:43], v[244:247], v[136:139]
    ds_read_b64_tr_b16 v[200:201], v13 offset:24576
    v_mfma_f32_16x16x32_bf16 v[140:143], v[44:47], v[244:247], v[140:143]
    ds_read_b64_tr_b16 v[202:203], v13 offset:28672
    v_mfma_f32_16x16x32_bf16 v[124:127], v[44:47], v[240:243], v[124:127]
    ds_read_b64_tr_b16 v[204:205], v14 offset:24576
    v_mfma_f32_16x16x32_bf16 v[128:131], v[48:51], v[240:243], v[128:131]
    ds_read_b64_tr_b16 v[206:207], v14 offset:28672
    ds_read_b64_tr_b16 v[208:209], v15 offset:24576
    v_mfma_f32_16x16x32_bf16 v[144:147], v[48:51], v[244:247], v[144:147]
    ds_read_b64_tr_b16 v[210:211], v15 offset:28672
    v_mfma_f32_16x16x32_bf16 v[148:151], v[52:55], v[244:247], v[148:151]
    ds_read_b64_tr_b16 v[212:213], v16 offset:24576
    v_mfma_f32_16x16x32_bf16 v[132:135], v[52:55], v[240:243], v[132:135]
    ds_read_b64_tr_b16 v[214:215], v16 offset:28672
    s_waitcnt lgkmcnt(8)
    s_barrier
    v_mfma_f32_16x16x32_bf16 v[120:123], v[184:187], v[88:91], v[120:123]
    ds_read_b128 v[232:235], v12 offset:0
    ds_read_b128 v[236:239], v12 offset:2048
    v_mfma_f32_16x16x32_bf16 v[136:139], v[184:187], v[92:95], v[136:139]
    ds_read_b128 v[240:243], v12 offset:1024
    v_mfma_f32_16x16x32_bf16 v[140:143], v[188:191], v[92:95], v[140:143]
    ds_read_b128 v[244:247], v12 offset:3072
    v_mfma_f32_16x16x32_bf16 v[124:127], v[188:191], v[88:91], v[124:127]
    ds_read_b64_tr_b16 v[24:25], v13 offset:32768
    v_mfma_f32_16x16x32_bf16 v[128:131], v[192:195], v[88:91], v[128:131]
    ds_read_b64_tr_b16 v[26:27], v13 offset:36864
    ds_read_b64_tr_b16 v[28:29], v14 offset:32768
    v_mfma_f32_16x16x32_bf16 v[144:147], v[192:195], v[92:95], v[144:147]
    ds_read_b64_tr_b16 v[30:31], v14 offset:36864
    v_mfma_f32_16x16x32_bf16 v[148:151], v[196:199], v[92:95], v[148:151]
    ds_read_b64_tr_b16 v[32:33], v15 offset:32768
    v_mfma_f32_16x16x32_bf16 v[132:135], v[196:199], v[88:91], v[132:135]
    ds_read_b64_tr_b16 v[34:35], v15 offset:36864
    s_waitcnt lgkmcnt(10)
    v_mfma_f32_16x16x32_bf16 v[120:123], v[200:203], v[96:99], v[120:123]
    ds_read_b64_tr_b16 v[36:37], v16 offset:32768
    ds_read_b64_tr_b16 v[38:39], v16 offset:36864
    v_mfma_f32_16x16x32_bf16 v[136:139], v[200:203], v[100:103], v[136:139]
    ds_read_b64_tr_b16 v[40:41], v13 offset:40960
    v_mfma_f32_16x16x32_bf16 v[140:143], v[204:207], v[100:103], v[140:143]
    ds_read_b64_tr_b16 v[42:43], v13 offset:45056
    v_mfma_f32_16x16x32_bf16 v[124:127], v[204:207], v[96:99], v[124:127]
    ds_read_b64_tr_b16 v[44:45], v14 offset:40960
    v_mfma_f32_16x16x32_bf16 v[128:131], v[208:211], v[96:99], v[128:131]
    ds_read_b64_tr_b16 v[46:47], v14 offset:45056
    ds_read_b64_tr_b16 v[48:49], v15 offset:40960
    v_mfma_f32_16x16x32_bf16 v[144:147], v[208:211], v[100:103], v[144:147]
    ds_read_b64_tr_b16 v[50:51], v15 offset:45056
    v_mfma_f32_16x16x32_bf16 v[148:151], v[212:215], v[100:103], v[148:151]
    ds_read_b64_tr_b16 v[52:53], v16 offset:40960
    v_mfma_f32_16x16x32_bf16 v[132:135], v[212:215], v[96:99], v[132:135]
    ds_read_b64_tr_b16 v[54:55], v16 offset:45056
    s_waitcnt lgkmcnt(8)
    v_mfma_f32_16x16x32_bf16 v[120:123], v[24:27], v[232:235], v[120:123]
    ds_read_b128 v[88:91], v12 offset:4096
    ds_read_b128 v[92:95], v12 offset:6144
    v_mfma_f32_16x16x32_bf16 v[136:139], v[24:27], v[236:239], v[136:139]
    ds_read_b128 v[96:99], v12 offset:5120
    v_mfma_f32_16x16x32_bf16 v[140:143], v[28:31], v[236:239], v[140:143]
    ds_read_b128 v[100:103], v12 offset:7168
    v_mfma_f32_16x16x32_bf16 v[124:127], v[28:31], v[232:235], v[124:127]
    ds_read_b64_tr_b16 v[184:185], v18 offset:0
    buffer_load_dwordx4 v[152:155], v2, s[24:27], s40 offen offset:0 sc1
    buffer_load_dwordx4 v[156:159], v2, s[24:27], s40 offen offset:1024 sc1
    buffer_load_dwordx4 v[160:163], v2, s[24:27], s12 offen offset:0 sc1
    buffer_load_dwordx4 v[164:167], v2, s[24:27], s12 offen offset:1024 sc1
    v_mfma_f32_16x16x32_bf16 v[128:131], v[32:35], v[232:235], v[128:131]
    ds_read_b64_tr_b16 v[186:187], v18 offset:4096
    ds_read_b64_tr_b16 v[188:189], v19 offset:0
    v_mfma_f32_16x16x32_bf16 v[144:147], v[32:35], v[236:239], v[144:147]
    ds_read_b64_tr_b16 v[190:191], v19 offset:4096
    v_mfma_f32_16x16x32_bf16 v[148:151], v[36:39], v[236:239], v[148:151]
    ds_read_b64_tr_b16 v[192:193], v20 offset:0
    v_mfma_f32_16x16x32_bf16 v[132:135], v[36:39], v[232:235], v[132:135]
    ds_read_b64_tr_b16 v[194:195], v20 offset:4096
    s_waitcnt lgkmcnt(10)
    v_mfma_f32_16x16x32_bf16 v[120:123], v[40:43], v[240:243], v[120:123]
    ds_read_b64_tr_b16 v[196:197], v21 offset:0
    ds_read_b64_tr_b16 v[198:199], v21 offset:4096
    v_mfma_f32_16x16x32_bf16 v[136:139], v[40:43], v[244:247], v[136:139]
    ds_read_b64_tr_b16 v[200:201], v18 offset:8192
    v_mfma_f32_16x16x32_bf16 v[140:143], v[44:47], v[244:247], v[140:143]
    ds_read_b64_tr_b16 v[202:203], v18 offset:12288
    v_mfma_f32_16x16x32_bf16 v[124:127], v[44:47], v[240:243], v[124:127]
    ds_read_b64_tr_b16 v[204:205], v19 offset:8192
    v_mfma_f32_16x16x32_bf16 v[128:131], v[48:51], v[240:243], v[128:131]
    ds_read_b64_tr_b16 v[206:207], v19 offset:12288
    ds_read_b64_tr_b16 v[208:209], v20 offset:8192
    v_mfma_f32_16x16x32_bf16 v[144:147], v[48:51], v[244:247], v[144:147]
    ds_read_b64_tr_b16 v[210:211], v20 offset:12288
    v_mfma_f32_16x16x32_bf16 v[148:151], v[52:55], v[244:247], v[148:151]
    ds_read_b64_tr_b16 v[212:213], v21 offset:8192
    v_mfma_f32_16x16x32_bf16 v[132:135], v[52:55], v[240:243], v[132:135]
    ds_read_b64_tr_b16 v[214:215], v21 offset:12288
    s_waitcnt lgkmcnt(8)
    v_mfma_f32_16x16x32_bf16 v[120:123], v[184:187], v[88:91], v[120:123]
    v_mfma_f32_16x16x32_bf16 v[136:139], v[184:187], v[92:95], v[136:139]
    v_mfma_f32_16x16x32_bf16 v[140:143], v[188:191], v[92:95], v[140:143]
    v_mfma_f32_16x16x32_bf16 v[124:127], v[188:191], v[88:91], v[124:127]
    v_mfma_f32_16x16x32_bf16 v[128:131], v[192:195], v[88:91], v[128:131]
    v_mfma_f32_16x16x32_bf16 v[144:147], v[192:195], v[92:95], v[144:147]
    v_mfma_f32_16x16x32_bf16 v[148:151], v[196:199], v[92:95], v[148:151]
    v_mfma_f32_16x16x32_bf16 v[132:135], v[196:199], v[88:91], v[132:135]
    s_waitcnt lgkmcnt(0)
    s_barrier
    v_mfma_f32_16x16x32_bf16 v[120:123], v[200:203], v[96:99], v[120:123]
    v_mfma_f32_16x16x32_bf16 v[136:139], v[200:203], v[100:103], v[136:139]
    v_mfma_f32_16x16x32_bf16 v[140:143], v[204:207], v[100:103], v[140:143]
    v_mfma_f32_16x16x32_bf16 v[124:127], v[204:207], v[96:99], v[124:127]
    v_mfma_f32_16x16x32_bf16 v[128:131], v[208:211], v[96:99], v[128:131]
    v_mfma_f32_16x16x32_bf16 v[144:147], v[208:211], v[100:103], v[144:147]
    v_mfma_f32_16x16x32_bf16 v[148:151], v[212:215], v[100:103], v[148:151]
    v_mfma_f32_16x16x32_bf16 v[132:135], v[212:215], v[96:99], v[132:135]
    s_mov_b32 s53, 0
dw_23:
    s_waitcnt vmcnt(0)
    v_and_b32 v6, v152, v153
    v_and_b32 v7, v160, v161
    v_bitop3_b32 v6, v154, v155, v6 bitop3:0x80
    v_bitop3_b32 v7, v162, v163, v7 bitop3:0x80
    v_bitop3_b32 v6, v156, v157, v6 bitop3:0x80
    v_bitop3_b32 v7, v164, v165, v7 bitop3:0x80
    v_bitop3_b32 v6, v158, v159, v6 bitop3:0x80
    v_bitop3_b32 v7, v166, v167, v7 bitop3:0x80
    v_bitop3_b32 v6, v6, v7, 1 bitop3:0x80
    v_cmp_eq_u32 vcc, 0, v6
    s_nop 0
    s_cmp_eq_u64 vcc, 0
    s_cbranch_scc1 dok_24
    s_mov_b64 exec, vcc
    s_sleep 1
    buffer_load_dwordx4 v[152:155], v2, s[24:27], s40 offen offset:0 sc1
    buffer_load_dwordx4 v[156:159], v2, s[24:27], s40 offen offset:1024 sc1
    buffer_load_dwordx4 v[160:163], v2, s[24:27], s12 offen offset:0 sc1
    buffer_load_dwordx4 v[164:167], v2, s[24:27], s12 offen offset:1024 sc1
    s_add_u32 s53, s53, 1
    s_cmp_lt_u32 s53, s61
    s_cbranch_scc1 dw_23
    s_mov_b32 s61, 0
    s_waitcnt vmcnt(0)
dok_24:
    s_mov_b64 exec, -1
    v_mfma_f32_16x16x32_bf16 v[120:123], v[226:229], v[152:155], v[120:123]
    v_mfma_f32_16x16x32_bf16 v[124:127], v[224:227], v[152:155], v[124:127]
    v_mfma_f32_16x16x32_bf16 v[128:131], v[226:229], v[156:159], v[128:131]
    v_mfma_f32_16x16x32_bf16 v[132:135], v[224:227], v[156:159], v[132:135]
    v_mfma_f32_16x16x32_bf16 v[136:139], v[226:229], v[160:163], v[136:139]
    v_mfma_f32_16x16x32_bf16 v[140:143], v[224:227], v[160:163], v[140:143]
    v_mfma_f32_16x16x32_bf16 v[144:147], v[226:229], v[164:167], v[144:147]
    v_mfma_f32_16x16x32_bf16 v[148:151], v[224:227], v[164:167], v[148:151]
    s_cmp_eq_u32 s60, 1
    s_cbranch_scc1 G4_last
    s_cmp_eq_u32 s98, 0
    s_cbranch_scc1 G4_near
    v_and_or_b32 v120, v120, s15, v56
    v_and_or_b32 v122, v122, s15, v56
    v_and_or_b32 v124, v124, s15, v56
    v_and_or_b32 v126, v126, s15, v56
    v_cvt_pk_bf16_f32 v120, v120, v121
    v_cvt_pk_bf16_f32 v121, v122, v123
    v_cvt_pk_bf16_f32 v122, v124, v125
    v_cvt_pk_bf16_f32 v123, v126, v127
    buffer_store_dwordx4 v[120:123], v2, s[88:91], s40 offen offset:0 sc1
    v_and_or_b32 v128, v128, s15, v56
    v_and_or_b32 v130, v130, s15, v56
    v_and_or_b32 v132, v132, s15, v56
    v_and_or_b32 v134, v134, s15, v56
    v_cvt_pk_bf16_f32 v128, v128, v129
    v_cvt_pk_bf16_f32 v129, v130, v131
    v_cvt_pk_bf16_f32 v130, v132, v133
    v_cvt_pk_bf16_f32 v131, v134, v135
    buffer_store_dwordx4 v[128:131], v2, s[88:91], s40 offen offset:1024 sc1
    s_add_u32 s36, s40, 65536
    v_and_or_b32 v136, v136, s15, v56
    v_and_or_b32 v138, v138, s15, v56
    v_and_or_b32 v140, v140, s15, v56
    v_and_or_b32 v142, v142, s15, v56
    v_cvt_pk_bf16_f32 v136, v136, v137
    v_cvt_pk_bf16_f32 v137, v138, v139
    v_cvt_pk_bf16_f32 v138, v140, v141
    v_cvt_pk_bf16_f32 v139, v142, v143
    buffer_store_dwordx4 v[136:139], v2, s[88:91], s36 offen offset:0 sc1
    v_and_or_b32 v144, v144, s15, v56
    v_and_or_b32 v146, v146, s15, v56
    v_and_or_b32 v148, v148, s15, v56
    v_and_or_b32 v150, v150, s15, v56
    v_cvt_pk_bf16_f32 v144, v144, v145
    v_cvt_pk_bf16_f32 v145, v146, v147
    v_cvt_pk_bf16_f32 v146, v148, v149
    v_cvt_pk_bf16_f32 v147, v150, v151
    buffer_store_dwordx4 v[144:147], v2, s[88:91], s36 offen offset:1024 sc1
    s_branch G4_out
G4_near:
    v_and_or_b32 v120, v120, s15, v56
    v_and_or_b32 v122, v122, s15, v56
    v_and_or_b32 v124, v124, s15, v56
    v_and_or_b32 v126, v126, s15, v56
    v_cvt_pk_bf16_f32 v120, v120, v121
    v_cvt_pk_bf16_f32 v121, v122, v123
    v_cvt_pk_bf16_f32 v122, v124, v125
    v_cvt_pk_bf16_f32 v123, v126, v127
    buffer_store_dwordx4 v[120:123], v2, s[88:91], s40 offen offset:0
    v_and_or_b32 v128, v128, s15, v56
    v_and_or_b32 v130, v130, s15, v56
    v_and_or_b32 v132, v132, s15, v56
    v_and_or_b32 v134, v134, s15, v56
    v_cvt_pk_bf16_f32 v128, v128, v129
    v_cvt_pk_bf16_f32 v129, v130, v131
    v_cvt_pk_bf16_f32 v130, v132, v133
    v_cvt_pk_bf16_f32 v131, v134, v135
    buffer_store_dwordx4 v[128:131], v2, s[88:91], s40 offen offset:1024
    s_add_u32 s36, s40, 65536
    v_and_or_b32 v136, v136, s15, v56
    v_and_or_b32 v138, v138, s15, v56
    v_and_or_b32 v140, v140, s15, v56
    v_and_or_b32 v142, v142, s15, v56
    v_cvt_pk_bf16_f32 v136, v136, v137
    v_cvt_pk_bf16_f32 v137, v138, v139
    v_cvt_pk_bf16_f32 v138, v140, v141
    v_cvt_pk_bf16_f32 v139, v142, v143
    buffer_store_dwordx4 v[136:139], v2, s[88:91], s36 offen offset:0
    v_and_or_b32 v144, v144, s15, v56
    v_and_or_b32 v146, v146, s15, v56
    v_and_or_b32 v148, v148, s15, v56
    v_and_or_b32 v150, v150, s15, v56
    v_cvt_pk_bf16_f32 v144, v144, v145
    v_cvt_pk_bf16_f32 v145, v146, v147
    v_cvt_pk_bf16_f32 v146, v148, v149
    v_cvt_pk_bf16_f32 v147, v150, v151
    buffer_store_dwordx4 v[144:147], v2, s[88:91], s36 offen offset:1024
G4_out:
    v_and_b32 v81, 7, v0
    v_lshrrev_b32 v84, 6, v0
    v_lshlrev_b32 v84, 4, v84
    v_bfe_u32 v85, v0, 3, 3
    v_add_u32 v84, v84, v85
    s_lshr_b32 s78, s67, 1
    s_lshl_b32 s78, s78, 16
    s_and_b32 s79, s67, 1
    s_lshl_b32 s79, s79, 7
    s_add_u32 s78, s78, s79
    s_lshr_b32 s79, s30, 1
    s_lshl_b32 s79, s79, 13
    s_add_u32 s78, s78, s79
    v_lshlrev_b32 v78, 8, v84
    v_lshl_add_u32 v78, v81, 4, v78
    v_add_u32 v78, s78, v78
    s_lshl_b32 s78, s28, 7
    s_lshl_b32 s79, s67, 3
    s_add_u32 s78, s78, s79
    v_add_u32 v79, s78, v81
    v_lshlrev_b32 v80, 11, v79
    v_and_b32 v85, 3, v79
    v_lshrrev_b32 v82, 2, v79
    v_lshlrev_b32 v82, 14, v82
    v_lshl_add_u32 v82, v85, 11, v82
    v_lshl_add_u32 v82, v84, 4, v82
    v_lshrrev_b32 v85, 2, v84
    v_lshlrev_b32 v85, 3, v85
    v_and_b32 v84, 3, v84
    v_add_u32 v84, v84, v85
    v_lshl_add_u32 v80, v84, 3, v80
    v_lshlrev_b32 v79, 3, v79
    v_lshl_add_u32 v79, v84, 14, v79
    s_add_u32 s80, s4, 0x1800000
    s_addc_u32 s81, s5, 0
    s_mov_b32 s82, 0x400000
    s_mov_b32 s83, 0x20000
    s_mov_b32 s78, 0
    buffer_load_dwordx2 v[110:111], v79, s[80:83], s78 offen sc1
    s_mov_b32 s78, 65536
    buffer_load_dwordx2 v[112:113], v79, s[80:83], s78 offen sc1
    s_mov_b32 s78, 262144
    buffer_load_dwordx2 v[114:115], v79, s[80:83], s78 offen sc1
    s_mov_b32 s78, 327680
    buffer_load_dwordx2 v[116:117], v79, s[80:83], s78 offen sc1
    s_branch NEXT
G4_last:
    v_cvt_pk_bf16_f32 v120, v120, v121
    v_cvt_pk_bf16_f32 v121, v122, v123
    v_cvt_pk_bf16_f32 v122, v124, v125
    v_cvt_pk_bf16_f32 v123, v126, v127
    s_nop 0
    v_permlane16_swap_b32 v120, v122
    v_permlane16_swap_b32 v121, v123
    v_cvt_pk_bf16_f32 v128, v128, v129
    v_cvt_pk_bf16_f32 v129, v130, v131
    v_cvt_pk_bf16_f32 v130, v132, v133
    v_cvt_pk_bf16_f32 v131, v134, v135
    s_nop 0
    v_permlane16_swap_b32 v128, v130
    v_permlane16_swap_b32 v129, v131
    v_mov_b32 v132, v120
    v_mov_b32 v133, v121
    v_mov_b32 v134, v122
    v_mov_b32 v135, v123
    v_mov_b32_dpp v120, v128 row_ror:8 row_mask:0xf bank_mask:0xc
    v_mov_b32_dpp v121, v129 row_ror:8 row_mask:0xf bank_mask:0xc
    v_mov_b32_dpp v122, v130 row_ror:8 row_mask:0xf bank_mask:0xc
    v_mov_b32_dpp v123, v131 row_ror:8 row_mask:0xf bank_mask:0xc
    v_mov_b32_dpp v128, v132 row_ror:8 row_mask:0xf bank_mask:0x3
    v_mov_b32_dpp v129, v133 row_ror:8 row_mask:0xf bank_mask:0x3
    v_mov_b32_dpp v130, v134 row_ror:8 row_mask:0xf bank_mask:0x3
    v_mov_b32_dpp v131, v135 row_ror:8 row_mask:0xf bank_mask:0x3
    buffer_store_dwordx4 v[120:123], v10, s[20:23], s38 offen sc1
    buffer_store_dwordx4 v[128:131], v11, s[20:23], s38 offen sc1
    v_cvt_pk_bf16_f32 v136, v136, v137
    v_cvt_pk_bf16_f32 v137, v138, v139
    v_cvt_pk_bf16_f32 v138, v140, v141
    v_cvt_pk_bf16_f32 v139, v142, v143
    s_nop 0
    v_permlane16_swap_b32 v136, v138
    v_permlane16_swap_b32 v137, v139
    v_cvt_pk_bf16_f32 v144, v144, v145
    v_cvt_pk_bf16_f32 v145, v146, v147
    v_cvt_pk_bf16_f32 v146, v148, v149
    v_cvt_pk_bf16_f32 v147, v150, v151
    s_nop 0
    v_permlane16_swap_b32 v144, v146
    v_permlane16_swap_b32 v145, v147
    v_mov_b32 v148, v136
    v_mov_b32 v149, v137
    v_mov_b32 v150, v138
    v_mov_b32 v151, v139
    v_mov_b32_dpp v136, v144 row_ror:8 row_mask:0xf bank_mask:0xc
    v_mov_b32_dpp v137, v145 row_ror:8 row_mask:0xf bank_mask:0xc
    v_mov_b32_dpp v138, v146 row_ror:8 row_mask:0xf bank_mask:0xc
    v_mov_b32_dpp v139, v147 row_ror:8 row_mask:0xf bank_mask:0xc
    v_mov_b32_dpp v144, v148 row_ror:8 row_mask:0xf bank_mask:0x3
    v_mov_b32_dpp v145, v149 row_ror:8 row_mask:0xf bank_mask:0x3
    v_mov_b32_dpp v146, v150 row_ror:8 row_mask:0xf bank_mask:0x3
    v_mov_b32_dpp v147, v151 row_ror:8 row_mask:0xf bank_mask:0x3
    buffer_store_dwordx4 v[136:139], v10, s[20:23], s39 offen sc1
    buffer_store_dwordx4 v[144:147], v11, s[20:23], s39 offen sc1
    s_branch K_fin
LOADERS:
    s_mov_b64 s[80:81], s[68:69]
    s_mov_b32 s82, 2097152
    s_mov_b32 s83, 0x20000
    s_cmp_lg_u32 s60, 0
    s_cbranch_scc1 WY_1
    ds_read_b64_tr_b16 v[128:129], v74 offset:0
    ds_read_b64_tr_b16 v[130:131], v74 offset:2048
    ds_read_b64_tr_b16 v[136:137], v74 offset:4096
    ds_read_b64_tr_b16 v[138:139], v74 offset:6144
    ds_read_b64_tr_b16 v[144:145], v74 offset:8192
    ds_read_b64_tr_b16 v[146:147], v74 offset:10240
    ds_read_b64_tr_b16 v[152:153], v74 offset:12288
    ds_read_b64_tr_b16 v[154:155], v74 offset:14336
    ds_read_b64_tr_b16 v[160:161], v74 offset:16384
    ds_read_b64_tr_b16 v[162:163], v74 offset:18432
    ds_read_b64_tr_b16 v[168:169], v74 offset:20480
    ds_read_b64_tr_b16 v[170:171], v74 offset:22528
    ds_read_b64_tr_b16 v[176:177], v75 offset:16384
    ds_read_b64_tr_b16 v[178:179], v75 offset:18432
    ds_read_b64_tr_b16 v[184:185], v75 offset:20480
    ds_read_b64_tr_b16 v[186:187], v75 offset:22528
    ds_read_b64_tr_b16 v[192:193], v75 offset:24576
    ds_read_b64_tr_b16 v[194:195], v75 offset:26624
    ds_read_b64_tr_b16 v[200:201], v75 offset:28672
    ds_read_b64_tr_b16 v[202:203], v75 offset:30720
    ds_read_b64_tr_b16 v[208:209], v74 offset:32768
    ds_read_b64_tr_b16 v[210:211], v74 offset:34816
    ds_read_b64_tr_b16 v[216:217], v74 offset:36864
    ds_read_b64_tr_b16 v[218:219], v74 offset:38912
    ds_read_b64_tr_b16 v[224:225], v74 offset:40960
    ds_read_b64_tr_b16 v[226:227], v74 offset:43008
    ds_read_b64_tr_b16 v[232:233], v74 offset:45056
    ds_read_b64_tr_b16 v[234:235], v74 offset:47104
    ds_read_b64_tr_b16 v[240:241], v75 offset:32768
    ds_read_b64_tr_b16 v[242:243], v75 offset:34816
    ds_read_b64_tr_b16 v[248:249], v75 offset:36864
    ds_read_b64_tr_b16 v[250:251], v75 offset:38912
    s_branch WY_2
WY_1:
    s_and_b32 s49, s30, 3
    s_lshl_b32 s36, s49, 14
    s_lshl_b32 s48, s29, 7
    s_add_u32 s48, s48, s36
    s_lshl_b32 s49, s49, 10
    s_xor_b32 s48, s48, 128
    s_add_u32 s36, s48, 917504
    s_add_u32 m0, s49, 81920
    s_nop 0
    buffer_load_dwordx4 v118, s[80:83], s36 offen lds
    s_add_u32 s36, s36, 65536
    s_add_u32 m0, s49, 86016
    s_nop 0
    buffer_load_dwordx4 v118, s[80:83], s36 offen lds
    s_add_u32 s36, s48, 1048576
    s_add_u32 m0, s49, 90112
    s_nop 0
    buffer_load_dwordx4 v118, s[80:83], s36 offen lds
    s_add_u32 s36, s36, 65536
    s_add_u32 m0, s49, 94208
    s_nop 0
    buffer_load_dwordx4 v118, s[80:83], s36 offen lds
WY_2:
    v_and_b32 v8, 15, v1
    v_lshrrev_b32 v9, 4, v1
    s_and_b32 s34, s30, 1
    s_and_b32 s37, s30, 3
    s_lshr_b32 s38, s29, 3
    s_add_u32 s38, s38, 1
    s_sub_u32 s39, 0, s38
    s_bitcmp1_b32 s29, 2
    s_cselect_b32 s38, s38, s39
    s_lshl_b32 s35, s28, 7
    s_cmp_lt_u32 s37, 2
    s_cselect_b32 s36, s38, 0
    s_add_u32 s36, s36, s35
    s_lshl_b32 s45, s34, 6
    s_add_u32 s36, s36, s45
    v_add_u32 v72, s36, v1
    s_movk_i32 s45, 2048
    v_cmp_gt_u32 s[46:47], s45, v72
    v_lshlrev_b32 v72, 4, v72
    s_lshl_b32 s22, s60, 15
    s_add_u32 s22, s22, 23199744
    s_add_u32 s20, s4, s22
    s_addc_u32 s21, s5, 0
    s_mov_b32 s22, 32768
    s_mov_b32 s23, 0x20000
    s_lshl_b32 s36, s37, 2
    v_add_u32 v6, s36, v9
    v_xor_b32 v10, v6, v8
    s_add_u32 s36, s35, s38
    s_add_u32 s36, s36, 16
    v_add_u32 v6, s36, v6
    v_and_b32 v7, 3, v6
    v_lshrrev_b32 v11, 2, v6
    v_lshlrev_b32 v11, 14, v11
    v_lshl_add_u32 v11, v7, 11, v11
    v_lshl_add_u32 v11, v10, 4, v11
    v_subrev_u32 v10, 65536, v11
    s_lshl_b32 s44, s37, 10
    s_lshl_b32 s14, s60, 24
    s_lshl_b32 s15, s94, 13
    s_add_u32 s14, s14, s15
    s_add_u32 s14, s14, 167772160
    s_add_u32 s12, s4, s14
    s_addc_u32 s13, s5, 0
    s_mov_b32 s14, 8380416
    s_mov_b32 s15, 0x20000
    s_cmp_lg_u32 s60, 0
    s_waitcnt vmcnt(4)
    s_cbranch_scc1 WY_6
    s_waitcnt vmcnt(0) lgkmcnt(0)
    s_barrier
    s_and_b32 s49, s30, 3
    s_lshl_b32 s36, s49, 14
    s_lshl_b32 s48, s29, 7
    s_add_u32 s48, s48, s36
    s_lshl_b32 s49, s49, 10
    s_xor_b32 s48, s48, 128
    s_add_u32 s36, s48, 917504
    s_add_u32 m0, s49, 81920
    s_nop 0
    buffer_load_dwordx4 v118, s[80:83], s36 offen lds
    s_add_u32 s36, s36, 65536
    s_add_u32 m0, s49, 86016
    s_nop 0
    buffer_load_dwordx4 v118, s[80:83], s36 offen lds
    s_add_u32 s36, s48, 1048576
    s_add_u32 m0, s49, 90112
    s_nop 0
    buffer_load_dwordx4 v118, s[80:83], s36 offen lds
    s_add_u32 s36, s36, 65536
    s_add_u32 m0, s49, 94208
    s_nop 0
    buffer_load_dwordx4 v118, s[80:83], s36 offen lds
    s_branch WY_7
WY_6:
    s_barrier
WY_7:
    s_add_u32 s36, s48, 131072
    s_add_u32 m0, s49, 32768
    s_nop 0
    buffer_load_dwordx4 v118, s[80:83], s36 offen lds
    s_add_u32 s36, s36, 65536
    s_add_u32 m0, s49, 36864
    s_nop 0
    buffer_load_dwordx4 v118, s[80:83], s36 offen lds
    s_add_u32 s36, s48, 262144
    s_add_u32 m0, s49, 40960
    s_nop 0
    buffer_load_dwordx4 v118, s[80:83], s36 offen lds
    s_add_u32 s36, s36, 65536
    s_add_u32 m0, s49, 45056
    s_nop 0
    buffer_load_dwordx4 v118, s[80:83], s36 offen lds
    s_add_u32 s36, s48, 1179648
    s_add_u32 m0, s49, 98304
    s_nop 0
    buffer_load_dwordx4 v118, s[80:83], s36 offen lds
    s_add_u32 s36, s36, 65536
    s_add_u32 m0, s49, 102400
    s_nop 0
    buffer_load_dwordx4 v118, s[80:83], s36 offen lds
    s_add_u32 s36, s48, 1310720
    s_add_u32 m0, s49, 106496
    s_nop 0
    buffer_load_dwordx4 v118, s[80:83], s36 offen lds
    s_add_u32 s36, s36, 65536
    s_add_u32 m0, s49, 110592
    s_nop 0
    buffer_load_dwordx4 v118, s[80:83], s36 offen lds
    v_lshrrev_b32 v6, 3, v1
    v_and_b32 v17, 7, v1
    v_xor_b32 v17, v17, v6
    s_lshl_b32 s36, s37, 3
    s_add_u32 s36, s36, s35
    v_add_u32 v6, s36, v6
    v_and_b32 v7, 3, v6
    v_lshrrev_b32 v12, 2, v6
    v_lshlrev_b32 v12, 14, v12
    v_lshl_add_u32 v12, v7, 11, v12
    s_lshl_b32 s36, s29, 7
    v_lshl_add_u32 v12, v17, 4, v12
    v_add_u32 v12, s36, v12
    v_lshrrev_b32 v6, 1, v9
    s_lshl_b32 s36, s37, 1
    v_add_u32 v6, s36, v6
    v_and_b32 v7, 7, v8
    v_xor_b32 v6, v6, v7
    v_lshlrev_b32 v17, 7, v8
    v_lshl_add_u32 v17, v6, 4, v17
    v_and_b32 v6, 1, v9
    v_lshl_add_u32 v17, v6, 3, v17
    v_and_b32 v6, 1, v9
    v_lshlrev_b32 v13, 16, v6
    v_lshrrev_b32 v6, 1, v9
    v_lshl_add_u32 v13, v6, 8, v13
    v_lshl_add_u32 v13, v8, 4, v13
    s_bfe_u32 s36, s30, 0x10001
    s_lshl1_add_u32 s36, s29, s36
    s_lshr_b32 s53, s36, 3
    s_lshl_b32 s53, s53, 14
    s_and_b32 s39, s36, 7
    s_lshl_b32 s39, s39, 10
    s_add_u32 s39, s39, s53
    s_and_b32 s36, s30, 1
    s_lshl_b32 s36, s36, 9
    s_add_u32 s39, s39, s36
    v_mov_b32 v14, v2
    v_add_u32 v15, 106496, v2
    v_lshrrev_b32 v6, 5, v13
    v_and_b32 v6, 2048, v6
    v_and_b32 v16, 511, v13
    v_add_u32 v16, v16, v6
    s_lshl_b32 s36, s37, 9
    v_add_u32 v16, s36, v16
    s_add_u32 s16, s62, 0x400000
    s_addc_u32 s17, s63, 0
    s_mov_b32 s18, 0x7e000
    s_mov_b32 s19, 0x20000
    s_add_u32 s24, s62, 0x480000
    s_addc_u32 s25, s63, 0
    s_mov_b32 s26, 0x7e000
    s_mov_b32 s27, 0x20000
    s_and_b32 s78, s30, 3
    s_lshl_b32 s78, s78, 15
    s_and_b32 s53, s30, 2
    s_lshl_b32 s53, s53, 11
    s_and_b32 s82, s30, 1
    s_lshl_b32 s82, s82, 13
    s_add_u32 s82, s82, s53
    s_and_b32 s84, s30, 1
    s_lshl_b32 s84, s84, 8
    s_add_u32 s84, s84, s55
    s_add_u32 s85, s52, 16
    s_mov_b64 s[8:9], s[72:73]
    s_mov_b32 s10, 7340032
    s_mov_b32 s11, 0x20000
    s_add_u32 s89, s29, 1
    s_and_b32 s89, s89, 15
    s_cmp_lg_u32 s28, s29
    s_cselect_b32 s89, s28, s89
    s_and_b32 s90, s30, 3
    s_mul_i32 s36, s29, 448
    s_lshl2_add_u32 s88, s29, s90
    s_mul_i32 s88, s88, 114688
    s_add_u32 s88, s88, s36
    s_lshl2_add_u32 s89, s89, s90
    s_mul_i32 s89, s89, 114688
    s_add_u32 s89, s89, s36
    s_mul_i32 s90, s90, 7168
    s_waitcnt vmcnt(0) lgkmcnt(0)
    s_setprio 1
    s_add_u32 m0, s44, 122880
    s_mov_b32 s49, 0
    s_barrier
    buffer_load_dwordx4 v[52:55], v72, s[20:23], 0 offen sc1
    buffer_load_dwordx4 v10, s[12:15], s49 offen offset:0 sc1 lds
    s_add_u32 m0, s44, 130048
    s_nop 0
    buffer_load_dwordx4 v10, s[12:15], s49 offen offset:1024 sc1 lds
    s_add_u32 m0, s44, 126976
    s_nop 0
    buffer_load_dwordx4 v11, s[12:15], s49 offen offset:0 sc1 lds
    s_add_u32 m0, s44, 134144
    s_nop 0
    buffer_load_dwordx4 v11, s[12:15], s49 offen offset:1024 sc1 lds
    s_add_u32 m0, s44, 139264
    s_mov_b32 s49, 256
    buffer_load_dwordx4 v10, s[12:15], s49 offen offset:0 sc1 lds
    s_add_u32 m0, s44, 146432
    s_nop 0
    buffer_load_dwordx4 v10, s[12:15], s49 offen offset:1024 sc1 lds
    s_add_u32 m0, s44, 143360
    s_nop 0
    buffer_load_dwordx4 v11, s[12:15], s49 offen offset:0 sc1 lds
    s_add_u32 m0, s44, 150528
    s_nop 0
    buffer_load_dwordx4 v11, s[12:15], s49 offen offset:1024 sc1 lds
    s_add_u32 m0, s44, 16384
    s_mov_b32 s49, 512
    buffer_load_dwordx4 v10, s[12:15], s49 offen offset:0 sc1 lds
    s_add_u32 m0, s44, 23552
    s_nop 0
    buffer_load_dwordx4 v10, s[12:15], s49 offen offset:1024 sc1 lds
    s_add_u32 m0, s44, 20480
    s_nop 0
    buffer_load_dwordx4 v11, s[12:15], s49 offen offset:0 sc1 lds
    s_add_u32 m0, s44, 27648
    s_nop 0
    buffer_load_dwordx4 v11, s[12:15], s49 offen offset:1024 sc1 lds
    s_add_u32 m0, s44, 32768
    s_mov_b32 s49, 768
    s_waitcnt vmcnt(8)
    s_barrier
    buffer_load_dwordx4 v10, s[12:15], s49 offen offset:0 sc1 lds
    s_add_u32 m0, s44, 39936
    s_nop 0
    buffer_load_dwordx4 v10, s[12:15], s49 offen offset:1024 sc1 lds
    s_add_u32 m0, s44, 36864
    s_nop 0
    buffer_load_dwordx4 v11, s[12:15], s49 offen offset:0 sc1 lds
    s_add_u32 m0, s44, 44032
    s_nop 0
    buffer_load_dwordx4 v11, s[12:15], s49 offen offset:1024 sc1 lds
    v_mov_b32 v10, v11
    v_add_u32 v11, 65536, v11
    s_mov_b32 s53, 0
lns_25:
    v_cmp_eq_u32 vcc, s52, v53
    v_cmp_eq_u32 s[50:51], s52, v55
    s_nop 0
    s_and_b64 vcc, vcc, s[50:51]
    s_orn2_b64 vcc, vcc, s[46:47]
    s_cmp_eq_u64 vcc, -1
    s_cbranch_scc1 lnk_26
    buffer_load_dwordx4 v[52:55], v72, s[20:23], 0 offen sc1
    s_waitcnt vmcnt(0)
    s_add_u32 s53, s53, 1
    s_cmp_lt_u32 s53, s61
    s_cbranch_scc1 lns_25
    s_mov_b32 s61, 0
lnk_26:
    v_lshlrev_b32 v56, 16, v52
    v_and_b32 v57, 0xffff0000, v52
    v_lshlrev_b32 v58, 16, v54
    v_and_b32 v59, 0xffff0000, v54
    v_cndmask_b32 v57, 1.0, v57, s[46:47]
    v_cndmask_b32 v59, 1.0, v59, s[46:47]
    s_lshl_b32 s36, s34, 10
    s_add_u32 s36, s36, 155648
    v_add_u32 v6, s36, v2
    s_cmp_ge_u32 s37, 2
    s_cbranch_scc1 lnx_27
    v_mul_f32 v66, v57, v59
    v_fma_f32 v60, -v58, v57, -v56
    v_rcp_f32 v7, v66
    v_mov_b32 v67, v66
    v_mov_b32 v61, v60
    v_mul_f32 v62, 0xc0135761, v7
    v_mul_f32 v7, v7, v7
    v_mov_b32 v63, v62
    v_mul_f32 v7, 0x3d372713, v7
    v_mul_f32 v64, v7, v62
    v_mov_b32 v65, v64
    ds_write_b128 v6, v[60:63] offset:0
    ds_write_b128 v6, v[64:67] offset:2048
    s_branch lnd_28
lnx_27:
    v_rcp_f32 v60, v57
    s_nop 0
    v_mul_f32 v62, -v56, v60
    v_mov_b32 v61, v60
    v_mov_b32 v63, v62
    ds_write_b128 v6, v[60:63] offset:5120
lnd_28:
    v_lshlrev_b32 v7, 4, v8
    v_add_u32 v7, 160768, v7
    s_add_u32 m0, s44, 106496
    s_mov_b32 s49, 65536
    s_waitcnt vmcnt(8)
    s_barrier
    buffer_load_dwordx4 v10, s[12:15], s49 offen offset:0 sc1 lds
    s_add_u32 m0, s44, 113664
    s_nop 0
    buffer_load_dwordx4 v10, s[12:15], s49 offen offset:1024 sc1 lds
    s_add_u32 m0, s44, 110592
    s_nop 0
    buffer_load_dwordx4 v11, s[12:15], s49 offen offset:0 sc1 lds
    s_add_u32 m0, s44, 117760
    s_nop 0
    buffer_load_dwordx4 v11, s[12:15], s49 offen offset:1024 sc1 lds
    s_add_u32 m0, s44, 122880
    s_mov_b32 s49, 65792
    s_waitcnt vmcnt(8)
    s_barrier
    buffer_load_dwordx4 v10, s[12:15], s49 offen offset:0 sc1 lds
    s_add_u32 m0, s44, 130048
    s_nop 0
    buffer_load_dwordx4 v10, s[12:15], s49 offen offset:1024 sc1 lds
    s_add_u32 m0, s44, 126976
    s_nop 0
    buffer_load_dwordx4 v11, s[12:15], s49 offen offset:0 sc1 lds
    s_add_u32 m0, s44, 134144
    s_nop 0
    buffer_load_dwordx4 v11, s[12:15], s49 offen offset:1024 sc1 lds
    s_add_u32 m0, s44, 139264
    s_mov_b32 s49, 66048
    s_waitcnt vmcnt(8)
    s_barrier
    buffer_load_dwordx4 v10, s[12:15], s49 offen offset:0 sc1 lds
    s_add_u32 m0, s44, 146432
    s_nop 0
    buffer_load_dwordx4 v10, s[12:15], s49 offen offset:1024 sc1 lds
    s_add_u32 m0, s44, 143360
    s_nop 0
    buffer_load_dwordx4 v11, s[12:15], s49 offen offset:0 sc1 lds
    s_add_u32 m0, s44, 150528
    s_nop 0
    buffer_load_dwordx4 v11, s[12:15], s49 offen offset:1024 sc1 lds
    s_waitcnt lgkmcnt(0)
    s_add_u32 m0, s44, 16384
    s_mov_b32 s49, 66304
    s_waitcnt vmcnt(8)
    s_barrier
    buffer_load_dwordx4 v10, s[12:15], s49 offen offset:0 sc1 lds
    s_add_u32 m0, s44, 23552
    s_nop 0
    buffer_load_dwordx4 v10, s[12:15], s49 offen offset:1024 sc1 lds
    s_add_u32 m0, s44, 20480
    s_nop 0
    buffer_load_dwordx4 v11, s[12:15], s49 offen offset:0 sc1 lds
    s_add_u32 m0, s44, 27648
    s_nop 0
    buffer_load_dwordx4 v11, s[12:15], s49 offen offset:1024 sc1 lds
    s_add_u32 m0, s44, 0
    s_mov_b32 s36, 0
    buffer_load_dwordx4 v12, s[12:15], s36 offen sc1 lds
    s_add_u32 m0, s44, 4096
    s_mov_b32 s36, 131072
    buffer_load_dwordx4 v12, s[12:15], s36 offen sc1 lds
    s_add_u32 m0, s44, 8192
    s_mov_b32 s36, 262144
    buffer_load_dwordx4 v12, s[12:15], s36 offen sc1 lds
    s_add_u32 m0, s44, 12288
    s_mov_b32 s36, 393216
    buffer_load_dwordx4 v12, s[12:15], s36 offen sc1 lds
    s_add_u32 m0, s90, 77824
    s_nop 0
    buffer_load_dwordx4 v121, s[8:11], s89 offen lds
    s_add_u32 m0, s90, 78848
    s_nop 0
    buffer_load_dwordx4 v122, s[8:11], s89 offen lds
    s_add_u32 m0, s44, 32768
    s_mov_b32 s49, 196608
    s_waitcnt vmcnt(14)
    s_barrier
    buffer_load_dwordx4 v10, s[12:15], s49 offen offset:0 sc1 lds
    s_add_u32 m0, s44, 39936
    s_nop 0
    buffer_load_dwordx4 v10, s[12:15], s49 offen offset:1024 sc1 lds
    s_add_u32 m0, s44, 36864
    s_nop 0
    buffer_load_dwordx4 v11, s[12:15], s49 offen offset:0 sc1 lds
    s_add_u32 m0, s44, 44032
    s_nop 0
    buffer_load_dwordx4 v11, s[12:15], s49 offen offset:1024 sc1 lds
    s_add_u32 m0, s44, 106496
    s_mov_b32 s49, 196864
    s_waitcnt vmcnt(14)
    s_barrier
    buffer_load_dwordx4 v10, s[12:15], s49 offen offset:0 sc1 lds
    s_add_u32 m0, s44, 113664
    s_nop 0
    buffer_load_dwordx4 v10, s[12:15], s49 offen offset:1024 sc1 lds
    s_add_u32 m0, s44, 110592
    s_nop 0
    buffer_load_dwordx4 v11, s[12:15], s49 offen offset:0 sc1 lds
    s_add_u32 m0, s44, 117760
    s_nop 0
    buffer_load_dwordx4 v11, s[12:15], s49 offen offset:1024 sc1 lds
    s_add_u32 m0, s44, 122880
    s_mov_b32 s49, 197120
    s_waitcnt vmcnt(10)
    s_barrier
    buffer_load_dwordx4 v10, s[12:15], s49 offen offset:0 sc1 lds
    s_add_u32 m0, s44, 130048
    s_nop 0
    buffer_load_dwordx4 v10, s[12:15], s49 offen offset:1024 sc1 lds
    s_add_u32 m0, s44, 126976
    s_nop 0
    buffer_load_dwordx4 v11, s[12:15], s49 offen offset:0 sc1 lds
    s_add_u32 m0, s44, 134144
    s_nop 0
    buffer_load_dwordx4 v11, s[12:15], s49 offen offset:1024 sc1 lds
    ds_read_b64 v[22:23], v17 offset:0
    ds_read_b128 v[60:63], v7 offset:0
    ds_read_b64 v[26:27], v17 offset:2048
    ds_read_b128 v[64:67], v7 offset:256
    s_add_u32 m0, s44, 139264
    s_mov_b32 s49, 197376
    s_waitcnt vmcnt(8)
    s_barrier
    buffer_load_dwordx4 v10, s[12:15], s49 offen offset:0 sc1 lds
    s_waitcnt lgkmcnt(0)
    v_lshlrev_b32 v20, 16, v22
    v_and_b32 v21, 0xffff0000, v22
    v_lshlrev_b32 v22, 16, v23
    v_and_b32 v23, 0xffff0000, v23
    s_add_u32 m0, s44, 146432
    s_nop 0
    buffer_load_dwordx4 v10, s[12:15], s49 offen offset:1024 sc1 lds
    v_pk_fma_f32 v[20:21], v[20:21], v[60:61], v[62:63]
    v_pk_fma_f32 v[22:23], v[22:23], v[60:61], v[62:63]
    v_lshlrev_b32 v24, 16, v26
    v_and_b32 v25, 0xffff0000, v26
    v_lshlrev_b32 v26, 16, v27
    s_add_u32 m0, s44, 143360
    s_nop 0
    buffer_load_dwordx4 v11, s[12:15], s49 offen offset:0 sc1 lds
    v_and_b32 v27, 0xffff0000, v27
    v_pk_fma_f32 v[24:25], v[24:25], v[64:65], v[66:67]
    v_pk_fma_f32 v[26:27], v[26:27], v[64:65], v[66:67]
    s_add_u32 m0, s44, 150528
    s_nop 0
    buffer_load_dwordx4 v11, s[12:15], s49 offen offset:1024 sc1 lds
    ds_read_b64 v[30:31], v17 offset:4096
    ds_read_b128 v[60:63], v7 offset:512
    ds_read_b64 v[34:35], v17 offset:6144
    ds_read_b128 v[64:67], v7 offset:768
    s_add_u32 m0, s90, 79872
    s_nop 0
    buffer_load_dwordx4 v123, s[8:11], s89 offen lds
    s_add_u32 m0, s90, 80896
    s_nop 0
    buffer_load_dwordx4 v124, s[8:11], s89 offen lds
    s_add_u32 m0, s90, 81920
    s_nop 0
    buffer_load_dwordx4 v125, s[8:11], s89 offen lds
    s_add_u32 m0, s90, 82944
    s_nop 0
    buffer_load_dwordx4 v126, s[8:11], s89 offen lds
    s_add_u32 m0, s90, 83968
    s_nop 0
    buffer_load_dwordx4 v127, s[8:11], s89 offen lds
    s_add_u32 m0, s90, 49152
    s_nop 0
    buffer_load_dwordx4 v121, s[8:11], s88 offen lds
    s_add_u32 m0, s44, 16384
    s_mov_b32 s49, 327680
    s_waitcnt vmcnt(14)
    s_barrier
    buffer_load_dwordx4 v10, s[12:15], s49 offen offset:0 sc1 lds
    s_waitcnt lgkmcnt(0)
    v_lshlrev_b32 v28, 16, v30
    v_and_b32 v29, 0xffff0000, v30
    v_lshlrev_b32 v30, 16, v31
    v_and_b32 v31, 0xffff0000, v31
    s_add_u32 m0, s44, 23552
    s_nop 0
    buffer_load_dwordx4 v10, s[12:15], s49 offen offset:1024 sc1 lds
    v_pk_fma_f32 v[28:29], v[28:29], v[60:61], v[62:63]
    v_pk_fma_f32 v[30:31], v[30:31], v[60:61], v[62:63]
    v_lshlrev_b32 v32, 16, v34
    v_and_b32 v33, 0xffff0000, v34
    v_lshlrev_b32 v34, 16, v35
    s_add_u32 m0, s44, 20480
    s_nop 0
    buffer_load_dwordx4 v11, s[12:15], s49 offen offset:0 sc1 lds
    v_and_b32 v35, 0xffff0000, v35
    v_pk_fma_f32 v[32:33], v[32:33], v[64:65], v[66:67]
    v_pk_fma_f32 v[34:35], v[34:35], v[64:65], v[66:67]
    s_add_u32 m0, s44, 27648
    s_nop 0
    buffer_load_dwordx4 v11, s[12:15], s49 offen offset:1024 sc1 lds
    ds_read_b64 v[38:39], v17 offset:8192
    ds_read_b128 v[60:63], v7 offset:1024
    ds_read_b64 v[42:43], v17 offset:10240
    ds_read_b128 v[64:67], v7 offset:1280
    s_add_u32 m0, s44, 32768
    s_mov_b32 s49, 327936
    s_waitcnt vmcnt(14)
    s_barrier
    buffer_load_dwordx4 v10, s[12:15], s49 offen offset:0 sc1 lds
    s_waitcnt lgkmcnt(0)
    v_lshlrev_b32 v36, 16, v38
    v_and_b32 v37, 0xffff0000, v38
    v_lshlrev_b32 v38, 16, v39
    v_and_b32 v39, 0xffff0000, v39
    s_add_u32 m0, s44, 39936
    s_nop 0
    buffer_load_dwordx4 v10, s[12:15], s49 offen offset:1024 sc1 lds
    v_pk_fma_f32 v[36:37], v[36:37], v[60:61], v[62:63]
    v_pk_fma_f32 v[38:39], v[38:39], v[60:61], v[62:63]
    v_lshlrev_b32 v40, 16, v42
    v_and_b32 v41, 0xffff0000, v42
    v_lshlrev_b32 v42, 16, v43
    s_add_u32 m0, s44, 36864
    s_nop 0
    buffer_load_dwordx4 v11, s[12:15], s49 offen offset:0 sc1 lds
    v_and_b32 v43, 0xffff0000, v43
    v_pk_fma_f32 v[40:41], v[40:41], v[64:65], v[66:67]
    v_pk_fma_f32 v[42:43], v[42:43], v[64:65], v[66:67]
    s_add_u32 m0, s44, 44032
    s_nop 0
    buffer_load_dwordx4 v11, s[12:15], s49 offen offset:1024 sc1 lds
    ds_read_b64 v[46:47], v17 offset:12288
    ds_read_b128 v[60:63], v7 offset:1536
    ds_read_b64 v[50:51], v17 offset:14336
    ds_read_b128 v[64:67], v7 offset:1792
    s_add_u32 m0, s44, 106496
    s_mov_b32 s49, 328192
    s_waitcnt vmcnt(14)
    s_barrier
    buffer_load_dwordx4 v10, s[12:15], s49 offen offset:0 sc1 lds
    s_waitcnt lgkmcnt(0)
    v_lshlrev_b32 v44, 16, v46
    v_and_b32 v45, 0xffff0000, v46
    v_lshlrev_b32 v46, 16, v47
    v_and_b32 v47, 0xffff0000, v47
    s_add_u32 m0, s44, 113664
    s_nop 0
    buffer_load_dwordx4 v10, s[12:15], s49 offen offset:1024 sc1 lds
    v_pk_fma_f32 v[44:45], v[44:45], v[60:61], v[62:63]
    v_pk_fma_f32 v[46:47], v[46:47], v[60:61], v[62:63]
    v_lshlrev_b32 v48, 16, v50
    v_and_b32 v49, 0xffff0000, v50
    v_lshlrev_b32 v50, 16, v51
    s_add_u32 m0, s44, 110592
    s_nop 0
    buffer_load_dwordx4 v11, s[12:15], s49 offen offset:0 sc1 lds
    v_and_b32 v51, 0xffff0000, v51
    v_pk_fma_f32 v[48:49], v[48:49], v[64:65], v[66:67]
    v_pk_fma_f32 v[50:51], v[50:51], v[64:65], v[66:67]
    s_add_u32 m0, s44, 117760
    s_nop 0
    buffer_load_dwordx4 v11, s[12:15], s49 offen offset:1024 sc1 lds
    s_add_u32 m0, s44, 122880
    s_mov_b32 s49, 328448
    s_waitcnt vmcnt(8)
    s_barrier
    s_load_dword s32, s[4:5], s84 offset:2048
    s_load_dword s3, s[4:5], s84 offset:2176
    buffer_load_dwordx4 v10, s[12:15], s49 offen offset:0 sc1 lds
    s_add_u32 m0, s44, 130048
    s_nop 0
    buffer_load_dwordx4 v10, s[12:15], s49 offen offset:1024 sc1 lds
    s_add_u32 m0, s44, 126976
    s_nop 0
    buffer_load_dwordx4 v11, s[12:15], s49 offen offset:0 sc1 lds
    s_add_u32 m0, s44, 134144
    s_nop 0
    buffer_load_dwordx4 v11, s[12:15], s49 offen offset:1024 sc1 lds
    s_add_u32 m0, s90, 50176
    s_nop 0
    buffer_load_dwordx4 v122, s[8:11], s88 offen lds
    s_add_u32 m0, s90, 51200
    s_nop 0
    buffer_load_dwordx4 v123, s[8:11], s88 offen lds
    s_add_u32 m0, s90, 52224
    s_nop 0
    buffer_load_dwordx4 v124, s[8:11], s88 offen lds
    s_add_u32 m0, s90, 53248
    s_nop 0
    buffer_load_dwordx4 v125, s[8:11], s88 offen lds
    s_add_u32 m0, s90, 54272
    s_nop 0
    buffer_load_dwordx4 v126, s[8:11], s88 offen lds
    s_add_u32 m0, s90, 55296
    s_nop 0
    buffer_load_dwordx4 v127, s[8:11], s88 offen lds
    s_add_u32 m0, s82, 139264
    s_add_u32 s49, s78, 0
    s_waitcnt vmcnt(14)
    s_barrier
    s_waitcnt lgkmcnt(0)
    s_cmp_eq_u32 s32, s85
    s_cselect_b32 s32, s3, 0
    s_cmp_eq_u32 s32, s85
    s_cbranch_scc1 hok_29
    s_add_u32 s53, s84, 2048
    v_lshlrev_b32 v109, 7, v1
    v_add_u32 v109, s53, v109
    s_mov_b32 s53, 0
    s_add_u32 s54, s52, 16
    s_bfm_b64 exec, 2, 0
poll_30:
    buffer_load_dword v108, v109, s[56:59], 0 offen sc1
    s_waitcnt vmcnt(0)
    v_cmp_eq_u32 vcc, s54, v108
    s_nop 0
    s_cmp_eq_u64 vcc, exec
    s_cbranch_scc1 pok_31
    s_sleep 8
    s_add_u32 s53, s53, 1
    s_cmp_lt_u32 s53, s61
    s_cbranch_scc1 poll_30
    s_mov_b32 s61, 0
pok_31:
    s_mov_b64 exec, -1
hok_29:
    buffer_load_dwordx4 v2, s[16:19], s49 offen offset:0 sc1 lds
    buffer_load_dwordx4 v2, s[16:19], s49 offen offset:1024 sc1 lds
    buffer_load_dwordx4 v2, s[16:19], s49 offen offset:2048 sc1 lds
    buffer_load_dwordx4 v2, s[16:19], s49 offen offset:3072 sc1 lds
    s_add_u32 m0, s82, 16384
    s_add_u32 s49, s78, 4096
    s_waitcnt vmcnt(14)
    s_barrier
    buffer_load_dwordx4 v2, s[16:19], s49 offen offset:0 sc1 lds
    buffer_load_dwordx4 v2, s[16:19], s49 offen offset:1024 sc1 lds
    buffer_load_dwordx4 v2, s[16:19], s49 offen offset:2048 sc1 lds
    buffer_load_dwordx4 v2, s[16:19], s49 offen offset:3072 sc1 lds
    s_add_u32 m0, s82, 32768
    s_add_u32 s49, s78, 16384
    s_waitcnt vmcnt(14)
    s_barrier
    buffer_load_dwordx4 v2, s[16:19], s49 offen offset:0 sc1 lds
    buffer_load_dwordx4 v2, s[16:19], s49 offen offset:1024 sc1 lds
    buffer_load_dwordx4 v2, s[16:19], s49 offen offset:2048 sc1 lds
    buffer_load_dwordx4 v2, s[16:19], s49 offen offset:3072 sc1 lds
    s_setprio 0
    s_waitcnt vmcnt(8)
    s_barrier
    ds_read_b128 v[52:55], v15 offset:32768
    ds_read_b128 v[56:59], v15 offset:36864
    ds_read_b128 v[60:63], v15 offset:40960
    ds_read_b128 v[64:67], v15 offset:45056
    ds_read_b128 v[68:71], v15 offset:33792
    ds_read_b128 v[72:75], v15 offset:37888
    ds_read_b128 v[76:79], v15 offset:41984
    ds_read_b128 v[80:83], v15 offset:46080
    s_waitcnt lgkmcnt(4)
    v_mfma_f32_16x16x32_bf16 v[20:23], v[128:131], v[52:55], v[20:23]
    ds_read_b128 v[84:87], v15 offset:34816
    v_mfma_f32_16x16x32_bf16 v[24:27], v[128:131], v[56:59], v[24:27]
    ds_read_b128 v[88:91], v15 offset:38912
    v_mfma_f32_16x16x32_bf16 v[24:27], v[132:135], v[64:67], v[24:27]
    ds_read_b128 v[92:95], v15 offset:43008
    v_mfma_f32_16x16x32_bf16 v[20:23], v[132:135], v[60:63], v[20:23]
    ds_read_b128 v[96:99], v15 offset:47104
    s_waitcnt lgkmcnt(4)
    v_mfma_f32_16x16x32_bf16 v[20:23], v[136:139], v[68:71], v[20:23]
    ds_read_b128 v[52:55], v15 offset:35840
    v_mfma_f32_16x16x32_bf16 v[24:27], v[136:139], v[72:75], v[24:27]
    ds_read_b128 v[56:59], v15 offset:39936
    v_mfma_f32_16x16x32_bf16 v[24:27], v[140:143], v[80:83], v[24:27]
    ds_read_b128 v[60:63], v15 offset:44032
    v_mfma_f32_16x16x32_bf16 v[20:23], v[140:143], v[76:79], v[20:23]
    ds_read_b128 v[64:67], v15 offset:48128
    s_waitcnt vmcnt(4)
    s_barrier
    s_waitcnt lgkmcnt(4)
    v_mfma_f32_16x16x32_bf16 v[20:23], v[144:147], v[84:87], v[20:23]
    ds_read_b128 v[68:71], v14 offset:16384
    v_mfma_f32_16x16x32_bf16 v[24:27], v[144:147], v[88:91], v[24:27]
    ds_read_b128 v[72:75], v14 offset:20480
    v_mfma_f32_16x16x32_bf16 v[24:27], v[148:151], v[96:99], v[24:27]
    ds_read_b128 v[76:79], v14 offset:24576
    v_mfma_f32_16x16x32_bf16 v[20:23], v[148:151], v[92:95], v[20:23]
    ds_read_b128 v[80:83], v14 offset:28672
    s_waitcnt lgkmcnt(4)
    v_mfma_f32_16x16x32_bf16 v[20:23], v[152:155], v[52:55], v[20:23]
    ds_read_b128 v[84:87], v14 offset:17408
    v_mfma_f32_16x16x32_bf16 v[24:27], v[152:155], v[56:59], v[24:27]
    ds_read_b128 v[88:91], v14 offset:21504
    v_mfma_f32_16x16x32_bf16 v[24:27], v[156:159], v[64:67], v[24:27]
    ds_read_b128 v[92:95], v14 offset:25600
    v_mfma_f32_16x16x32_bf16 v[20:23], v[156:159], v[60:63], v[20:23]
    ds_read_b128 v[96:99], v14 offset:29696
    s_waitcnt lgkmcnt(4)
    v_mfma_f32_16x16x32_bf16 v[20:23], v[160:163], v[68:71], v[20:23]
    ds_read_b128 v[52:55], v14 offset:18432
    v_mfma_f32_16x16x32_bf16 v[24:27], v[160:163], v[72:75], v[24:27]
    ds_read_b128 v[56:59], v14 offset:22528
    v_mfma_f32_16x16x32_bf16 v[24:27], v[164:167], v[80:83], v[24:27]
    ds_read_b128 v[60:63], v14 offset:26624
    v_mfma_f32_16x16x32_bf16 v[20:23], v[164:167], v[76:79], v[20:23]
    ds_read_b128 v[64:67], v14 offset:30720
    s_waitcnt lgkmcnt(4)
    v_mfma_f32_16x16x32_bf16 v[20:23], v[168:171], v[84:87], v[20:23]
    ds_read_b128 v[68:71], v14 offset:19456
    v_mfma_f32_16x16x32_bf16 v[24:27], v[168:171], v[88:91], v[24:27]
    ds_read_b128 v[72:75], v14 offset:23552
    v_mfma_f32_16x16x32_bf16 v[24:27], v[172:175], v[96:99], v[24:27]
    ds_read_b128 v[76:79], v14 offset:27648
    v_mfma_f32_16x16x32_bf16 v[20:23], v[172:175], v[92:95], v[20:23]
    ds_read_b128 v[80:83], v14 offset:31744
    s_waitcnt vmcnt(0)
    s_barrier
    s_waitcnt lgkmcnt(4)
    v_mfma_f32_16x16x32_bf16 v[20:23], v[176:179], v[52:55], v[20:23]
    ds_read_b128 v[84:87], v14 offset:32768
    v_mfma_f32_16x16x32_bf16 v[24:27], v[176:179], v[56:59], v[24:27]
    ds_read_b128 v[88:91], v14 offset:36864
    v_mfma_f32_16x16x32_bf16 v[24:27], v[180:183], v[64:67], v[24:27]
    ds_read_b128 v[92:95], v14 offset:40960
    v_mfma_f32_16x16x32_bf16 v[20:23], v[180:183], v[60:63], v[20:23]
    ds_read_b128 v[96:99], v14 offset:45056
    s_waitcnt lgkmcnt(4)
    v_mfma_f32_16x16x32_bf16 v[20:23], v[184:187], v[68:71], v[20:23]
    ds_read_b128 v[52:55], v14 offset:33792
    v_mfma_f32_16x16x32_bf16 v[24:27], v[184:187], v[72:75], v[24:27]
    ds_read_b128 v[56:59], v14 offset:37888
    v_mfma_f32_16x16x32_bf16 v[24:27], v[188:191], v[80:83], v[24:27]
    ds_read_b128 v[60:63], v14 offset:41984
    v_mfma_f32_16x16x32_bf16 v[20:23], v[188:191], v[76:79], v[20:23]
    ds_read_b128 v[64:67], v14 offset:46080
    s_waitcnt lgkmcnt(4)
    v_mfma_f32_16x16x32_bf16 v[20:23], v[192:195], v[84:87], v[20:23]
    ds_read_b128 v[68:71], v14 offset:34816
    v_mfma_f32_16x16x32_bf16 v[24:27], v[192:195], v[88:91], v[24:27]
    ds_read_b128 v[72:75], v14 offset:38912
    v_mfma_f32_16x16x32_bf16 v[24:27], v[196:199], v[96:99], v[24:27]
    ds_read_b128 v[76:79], v14 offset:43008
    v_mfma_f32_16x16x32_bf16 v[20:23], v[196:199], v[92:95], v[20:23]
    ds_read_b128 v[80:83], v14 offset:47104
    s_waitcnt lgkmcnt(4)
    v_mfma_f32_16x16x32_bf16 v[20:23], v[200:203], v[52:55], v[20:23]
    ds_read_b128 v[84:87], v14 offset:35840
    v_mfma_f32_16x16x32_bf16 v[24:27], v[200:203], v[56:59], v[24:27]
    ds_read_b128 v[88:91], v14 offset:39936
    v_mfma_f32_16x16x32_bf16 v[24:27], v[204:207], v[64:67], v[24:27]
    ds_read_b128 v[92:95], v14 offset:44032
    v_mfma_f32_16x16x32_bf16 v[20:23], v[204:207], v[60:63], v[20:23]
    ds_read_b128 v[96:99], v14 offset:48128
    s_barrier
    s_waitcnt lgkmcnt(4)
    v_mfma_f32_16x16x32_bf16 v[20:23], v[208:211], v[68:71], v[20:23]
    ds_read_b128 v[52:55], v15 offset:0
    v_mfma_f32_16x16x32_bf16 v[24:27], v[208:211], v[72:75], v[24:27]
    ds_read_b128 v[56:59], v15 offset:4096
    v_mfma_f32_16x16x32_bf16 v[24:27], v[212:215], v[80:83], v[24:27]
    ds_read_b128 v[60:63], v15 offset:8192
    v_mfma_f32_16x16x32_bf16 v[20:23], v[212:215], v[76:79], v[20:23]
    ds_read_b128 v[64:67], v15 offset:12288
    s_waitcnt lgkmcnt(4)
    v_mfma_f32_16x16x32_bf16 v[20:23], v[216:219], v[84:87], v[20:23]
    ds_read_b128 v[68:71], v15 offset:1024
    v_mfma_f32_16x16x32_bf16 v[24:27], v[216:219], v[88:91], v[24:27]
    ds_read_b128 v[72:75], v15 offset:5120
    v_mfma_f32_16x16x32_bf16 v[24:27], v[220:223], v[96:99], v[24:27]
    ds_read_b128 v[76:79], v15 offset:9216
    v_mfma_f32_16x16x32_bf16 v[20:23], v[220:223], v[92:95], v[20:23]
    ds_read_b128 v[80:83], v15 offset:13312
    s_waitcnt lgkmcnt(4)
    v_mfma_f32_16x16x32_bf16 v[20:23], v[224:227], v[52:55], v[20:23]
    ds_read_b128 v[84:87], v15 offset:2048
    v_mfma_f32_16x16x32_bf16 v[24:27], v[224:227], v[56:59], v[24:27]
    ds_read_b128 v[88:91], v15 offset:6144
    v_mfma_f32_16x16x32_bf16 v[24:27], v[228:231], v[64:67], v[24:27]
    ds_read_b128 v[92:95], v15 offset:10240
    v_mfma_f32_16x16x32_bf16 v[20:23], v[228:231], v[60:63], v[20:23]
    ds_read_b128 v[96:99], v15 offset:14336
    s_waitcnt lgkmcnt(4)
    v_mfma_f32_16x16x32_bf16 v[20:23], v[232:235], v[68:71], v[20:23]
    ds_read_b128 v[52:55], v15 offset:3072
    v_mfma_f32_16x16x32_bf16 v[24:27], v[232:235], v[72:75], v[24:27]
    ds_read_b128 v[56:59], v15 offset:7168
    v_mfma_f32_16x16x32_bf16 v[24:27], v[236:239], v[80:83], v[24:27]
    ds_read_b128 v[60:63], v15 offset:11264
    v_mfma_f32_16x16x32_bf16 v[20:23], v[236:239], v[76:79], v[20:23]
    ds_read_b128 v[64:67], v15 offset:15360
    s_barrier
    s_waitcnt lgkmcnt(4)
    v_mfma_f32_16x16x32_bf16 v[20:23], v[240:243], v[84:87], v[20:23]
    ds_read_b128 v[68:71], v15 offset:16384
    v_mfma_f32_16x16x32_bf16 v[24:27], v[240:243], v[88:91], v[24:27]
    ds_read_b128 v[72:75], v15 offset:20480
    v_mfma_f32_16x16x32_bf16 v[24:27], v[244:247], v[96:99], v[24:27]
    ds_read_b128 v[76:79], v15 offset:24576
    v_mfma_f32_16x16x32_bf16 v[20:23], v[244:247], v[92:95], v[20:23]
    ds_read_b128 v[80:83], v15 offset:28672
    s_waitcnt lgkmcnt(4)
    v_mfma_f32_16x16x32_bf16 v[20:23], v[248:251], v[52:55], v[20:23]
    ds_read_b128 v[84:87], v15 offset:17408
    v_mfma_f32_16x16x32_bf16 v[24:27], v[248:251], v[56:59], v[24:27]
    ds_read_b128 v[88:91], v15 offset:21504
    v_mfma_f32_16x16x32_bf16 v[24:27], v[252:255], v[64:67], v[24:27]
    ds_read_b128 v[92:95], v15 offset:25600
    v_mfma_f32_16x16x32_bf16 v[20:23], v[252:255], v[60:63], v[20:23]
    ds_read_b128 v[96:99], v15 offset:29696
    s_waitcnt lgkmcnt(4)
    v_mfma_f32_16x16x32_bf16 v[28:31], v[128:131], v[68:71], v[28:31]
    ds_read_b128 v[52:55], v15 offset:18432
    v_mfma_f32_16x16x32_bf16 v[32:35], v[128:131], v[72:75], v[32:35]
    ds_read_b128 v[56:59], v15 offset:22528
    v_mfma_f32_16x16x32_bf16 v[32:35], v[132:135], v[80:83], v[32:35]
    ds_read_b128 v[60:63], v15 offset:26624
    v_mfma_f32_16x16x32_bf16 v[28:31], v[132:135], v[76:79], v[28:31]
    ds_read_b128 v[64:67], v15 offset:30720
    v_add_u32 v20, 0x10000, v20
    v_add_u32 v22, 0x10000, v22
    v_add_u32 v24, 0x10000, v24
    v_add_u32 v26, 0x10000, v26
    v_and_b32 v20, 0xfffe0000, v20
    v_and_b32 v22, 0xfffe0000, v22
    v_and_b32 v24, 0xfffe0000, v24
    v_and_b32 v26, 0xfffe0000, v26
    v_cvt_pk_bf16_f32 v20, v20, v21
    v_cvt_pk_bf16_f32 v21, v22, v23
    v_cvt_pk_bf16_f32 v22, v24, v25
    v_cvt_pk_bf16_f32 v23, v26, v27
    s_add_u32 s36, s39, 0
    v_permlane16_swap_b32 v20, v22
    v_permlane16_swap_b32 v21, v23
    s_waitcnt lgkmcnt(4)
    v_mfma_f32_16x16x32_bf16 v[28:31], v[136:139], v[84:87], v[28:31]
    ds_read_b128 v[68:71], v15 offset:19456
    v_mfma_f32_16x16x32_bf16 v[32:35], v[136:139], v[88:91], v[32:35]
    ds_read_b128 v[72:75], v15 offset:23552
    v_mfma_f32_16x16x32_bf16 v[32:35], v[140:143], v[96:99], v[32:35]
    ds_read_b128 v[76:79], v15 offset:27648
    v_mfma_f32_16x16x32_bf16 v[28:31], v[140:143], v[92:95], v[28:31]
    ds_read_b128 v[80:83], v15 offset:31744
    s_barrier
    s_waitcnt lgkmcnt(4)
    v_mfma_f32_16x16x32_bf16 v[28:31], v[144:147], v[52:55], v[28:31]
    ds_read_b128 v[84:87], v15 offset:32768
    v_mfma_f32_16x16x32_bf16 v[32:35], v[144:147], v[56:59], v[32:35]
    ds_read_b128 v[88:91], v15 offset:36864
    v_mfma_f32_16x16x32_bf16 v[32:35], v[148:151], v[64:67], v[32:35]
    ds_read_b128 v[92:95], v15 offset:40960
    v_mfma_f32_16x16x32_bf16 v[28:31], v[148:151], v[60:63], v[28:31]
    ds_read_b128 v[96:99], v15 offset:45056
    s_waitcnt lgkmcnt(4)
    v_mfma_f32_16x16x32_bf16 v[28:31], v[152:155], v[68:71], v[28:31]
    ds_read_b128 v[52:55], v15 offset:33792
    v_mfma_f32_16x16x32_bf16 v[32:35], v[152:155], v[72:75], v[32:35]
    ds_read_b128 v[56:59], v15 offset:37888
    v_mfma_f32_16x16x32_bf16 v[32:35], v[156:159], v[80:83], v[32:35]
    ds_read_b128 v[60:63], v15 offset:41984
    v_mfma_f32_16x16x32_bf16 v[28:31], v[156:159], v[76:79], v[28:31]
    ds_read_b128 v[64:67], v15 offset:46080
    s_waitcnt lgkmcnt(4)
    v_mfma_f32_16x16x32_bf16 v[28:31], v[160:163], v[84:87], v[28:31]
    ds_read_b128 v[68:71], v15 offset:34816
    v_mfma_f32_16x16x32_bf16 v[32:35], v[160:163], v[88:91], v[32:35]
    ds_read_b128 v[72:75], v15 offset:38912
    v_mfma_f32_16x16x32_bf16 v[32:35], v[164:167], v[96:99], v[32:35]
    ds_read_b128 v[76:79], v15 offset:43008
    v_mfma_f32_16x16x32_bf16 v[28:31], v[164:167], v[92:95], v[28:31]
    ds_read_b128 v[80:83], v15 offset:47104
    s_waitcnt lgkmcnt(4)
    v_mfma_f32_16x16x32_bf16 v[28:31], v[168:171], v[52:55], v[28:31]
    ds_read_b128 v[84:87], v15 offset:35840
    v_mfma_f32_16x16x32_bf16 v[32:35], v[168:171], v[56:59], v[32:35]
    ds_read_b128 v[88:91], v15 offset:39936
    v_mfma_f32_16x16x32_bf16 v[32:35], v[172:175], v[64:67], v[32:35]
    ds_read_b128 v[92:95], v15 offset:44032
    v_mfma_f32_16x16x32_bf16 v[28:31], v[172:175], v[60:63], v[28:31]
    ds_read_b128 v[96:99], v15 offset:48128
    s_barrier
    s_waitcnt lgkmcnt(4)
    v_mfma_f32_16x16x32_bf16 v[28:31], v[176:179], v[68:71], v[28:31]
    ds_read_b128 v[52:55], v14 offset:16384
    v_mfma_f32_16x16x32_bf16 v[32:35], v[176:179], v[72:75], v[32:35]
    ds_read_b128 v[56:59], v14 offset:20480
    v_mfma_f32_16x16x32_bf16 v[32:35], v[180:183], v[80:83], v[32:35]
    ds_read_b128 v[60:63], v14 offset:24576
    v_mfma_f32_16x16x32_bf16 v[28:31], v[180:183], v[76:79], v[28:31]
    ds_read_b128 v[64:67], v14 offset:28672
    s_waitcnt lgkmcnt(4)
    v_mfma_f32_16x16x32_bf16 v[28:31], v[184:187], v[84:87], v[28:31]
    ds_read_b128 v[68:71], v14 offset:17408
    v_mfma_f32_16x16x32_bf16 v[32:35], v[184:187], v[88:91], v[32:35]
    ds_read_b128 v[72:75], v14 offset:21504
    v_mfma_f32_16x16x32_bf16 v[32:35], v[188:191], v[96:99], v[32:35]
    ds_read_b128 v[76:79], v14 offset:25600
    v_mfma_f32_16x16x32_bf16 v[28:31], v[188:191], v[92:95], v[28:31]
    ds_read_b128 v[80:83], v14 offset:29696
    s_waitcnt lgkmcnt(4)
    v_mfma_f32_16x16x32_bf16 v[28:31], v[192:195], v[52:55], v[28:31]
    ds_read_b128 v[84:87], v14 offset:18432
    v_mfma_f32_16x16x32_bf16 v[32:35], v[192:195], v[56:59], v[32:35]
    ds_read_b128 v[88:91], v14 offset:22528
    v_mfma_f32_16x16x32_bf16 v[32:35], v[196:199], v[64:67], v[32:35]
    ds_read_b128 v[92:95], v14 offset:26624
    v_mfma_f32_16x16x32_bf16 v[28:31], v[196:199], v[60:63], v[28:31]
    ds_read_b128 v[96:99], v14 offset:30720
    s_waitcnt lgkmcnt(4)
    v_mfma_f32_16x16x32_bf16 v[28:31], v[200:203], v[68:71], v[28:31]
    ds_read_b128 v[52:55], v14 offset:19456
    v_mfma_f32_16x16x32_bf16 v[32:35], v[200:203], v[72:75], v[32:35]
    ds_read_b128 v[56:59], v14 offset:23552
    v_mfma_f32_16x16x32_bf16 v[32:35], v[204:207], v[80:83], v[32:35]
    ds_read_b128 v[60:63], v14 offset:27648
    v_mfma_f32_16x16x32_bf16 v[28:31], v[204:207], v[76:79], v[28:31]
    ds_read_b128 v[64:67], v14 offset:31744
    s_barrier
    s_waitcnt lgkmcnt(4)
    v_mfma_f32_16x16x32_bf16 v[28:31], v[208:211], v[84:87], v[28:31]
    ds_read_b128 v[68:71], v14 offset:32768
    v_mfma_f32_16x16x32_bf16 v[32:35], v[208:211], v[88:91], v[32:35]
    ds_read_b128 v[72:75], v14 offset:36864
    v_mfma_f32_16x16x32_bf16 v[32:35], v[212:215], v[96:99], v[32:35]
    ds_read_b128 v[76:79], v14 offset:40960
    v_mfma_f32_16x16x32_bf16 v[28:31], v[212:215], v[92:95], v[28:31]
    ds_read_b128 v[80:83], v14 offset:45056
    s_waitcnt lgkmcnt(4)
    v_mfma_f32_16x16x32_bf16 v[28:31], v[216:219], v[52:55], v[28:31]
    ds_read_b128 v[84:87], v14 offset:33792
    v_mfma_f32_16x16x32_bf16 v[32:35], v[216:219], v[56:59], v[32:35]
    ds_read_b128 v[88:91], v14 offset:37888
    v_mfma_f32_16x16x32_bf16 v[32:35], v[220:223], v[64:67], v[32:35]
    ds_read_b128 v[92:95], v14 offset:41984
    v_mfma_f32_16x16x32_bf16 v[28:31], v[220:223], v[60:63], v[28:31]
    ds_read_b128 v[96:99], v14 offset:46080
    s_waitcnt lgkmcnt(4)
    v_mfma_f32_16x16x32_bf16 v[28:31], v[224:227], v[68:71], v[28:31]
    ds_read_b128 v[52:55], v14 offset:34816
    v_mfma_f32_16x16x32_bf16 v[32:35], v[224:227], v[72:75], v[32:35]
    ds_read_b128 v[56:59], v14 offset:38912
    v_mfma_f32_16x16x32_bf16 v[32:35], v[228:231], v[80:83], v[32:35]
    ds_read_b128 v[60:63], v14 offset:43008
    v_mfma_f32_16x16x32_bf16 v[28:31], v[228:231], v[76:79], v[28:31]
    ds_read_b128 v[64:67], v14 offset:47104
    s_waitcnt lgkmcnt(4)
    v_mfma_f32_16x16x32_bf16 v[28:31], v[232:235], v[84:87], v[28:31]
    ds_read_b128 v[68:71], v14 offset:35840
    v_mfma_f32_16x16x32_bf16 v[32:35], v[232:235], v[88:91], v[32:35]
    ds_read_b128 v[72:75], v14 offset:39936
    v_mfma_f32_16x16x32_bf16 v[32:35], v[236:239], v[96:99], v[32:35]
    ds_read_b128 v[76:79], v14 offset:44032
    v_mfma_f32_16x16x32_bf16 v[28:31], v[236:239], v[92:95], v[28:31]
    ds_read_b128 v[80:83], v14 offset:48128
    s_barrier
    s_waitcnt lgkmcnt(4)
    v_mfma_f32_16x16x32_bf16 v[28:31], v[240:243], v[52:55], v[28:31]
    ds_read_b128 v[84:87], v15 offset:0
    v_mfma_f32_16x16x32_bf16 v[32:35], v[240:243], v[56:59], v[32:35]
    ds_read_b128 v[88:91], v15 offset:4096
    v_mfma_f32_16x16x32_bf16 v[32:35], v[244:247], v[64:67], v[32:35]
    ds_read_b128 v[92:95], v15 offset:8192
    v_mfma_f32_16x16x32_bf16 v[28:31], v[244:247], v[60:63], v[28:31]
    ds_read_b128 v[96:99], v15 offset:12288
    s_waitcnt lgkmcnt(4)
    v_mfma_f32_16x16x32_bf16 v[28:31], v[248:251], v[68:71], v[28:31]
    ds_read_b128 v[52:55], v15 offset:1024
    v_mfma_f32_16x16x32_bf16 v[32:35], v[248:251], v[72:75], v[32:35]
    ds_read_b128 v[56:59], v15 offset:5120
    v_mfma_f32_16x16x32_bf16 v[32:35], v[252:255], v[80:83], v[32:35]
    ds_read_b128 v[60:63], v15 offset:9216
    v_mfma_f32_16x16x32_bf16 v[28:31], v[252:255], v[76:79], v[28:31]
    ds_read_b128 v[64:67], v15 offset:13312
    s_waitcnt lgkmcnt(4)
    v_mfma_f32_16x16x32_bf16 v[36:39], v[128:131], v[84:87], v[36:39]
    ds_read_b128 v[68:71], v15 offset:2048
    v_mfma_f32_16x16x32_bf16 v[40:43], v[128:131], v[88:91], v[40:43]
    ds_read_b128 v[72:75], v15 offset:6144
    v_mfma_f32_16x16x32_bf16 v[40:43], v[132:135], v[96:99], v[40:43]
    ds_read_b128 v[76:79], v15 offset:10240
    v_mfma_f32_16x16x32_bf16 v[36:39], v[132:135], v[92:95], v[36:39]
    ds_read_b128 v[80:83], v15 offset:14336
    v_add_u32 v28, 0x10000, v28
    v_add_u32 v30, 0x10000, v30
    v_add_u32 v32, 0x10000, v32
    v_add_u32 v34, 0x10000, v34
    v_and_b32 v28, 0xfffe0000, v28
    v_and_b32 v30, 0xfffe0000, v30
    v_and_b32 v32, 0xfffe0000, v32
    v_and_b32 v34, 0xfffe0000, v34
    v_cvt_pk_bf16_f32 v28, v28, v29
    v_cvt_pk_bf16_f32 v29, v30, v31
    v_cvt_pk_bf16_f32 v30, v32, v33
    v_cvt_pk_bf16_f32 v31, v34, v35
    s_add_u32 s36, s39, 131072
    v_permlane16_swap_b32 v28, v30
    v_permlane16_swap_b32 v29, v31
    s_waitcnt lgkmcnt(4)
    v_mfma_f32_16x16x32_bf16 v[36:39], v[136:139], v[52:55], v[36:39]
    ds_read_b128 v[84:87], v15 offset:3072
    v_mfma_f32_16x16x32_bf16 v[40:43], v[136:139], v[56:59], v[40:43]
    ds_read_b128 v[88:91], v15 offset:7168
    v_mfma_f32_16x16x32_bf16 v[40:43], v[140:143], v[64:67], v[40:43]
    ds_read_b128 v[92:95], v15 offset:11264
    v_mfma_f32_16x16x32_bf16 v[36:39], v[140:143], v[60:63], v[36:39]
    ds_read_b128 v[96:99], v15 offset:15360
    s_barrier
    s_waitcnt lgkmcnt(4)
    v_mfma_f32_16x16x32_bf16 v[36:39], v[144:147], v[68:71], v[36:39]
    ds_read_b128 v[52:55], v15 offset:16384
    v_mfma_f32_16x16x32_bf16 v[40:43], v[144:147], v[72:75], v[40:43]
    ds_read_b128 v[56:59], v15 offset:20480
    v_mfma_f32_16x16x32_bf16 v[40:43], v[148:151], v[80:83], v[40:43]
    ds_read_b128 v[60:63], v15 offset:24576
    v_mfma_f32_16x16x32_bf16 v[36:39], v[148:151], v[76:79], v[36:39]
    ds_read_b128 v[64:67], v15 offset:28672
    s_waitcnt lgkmcnt(4)
    v_mfma_f32_16x16x32_bf16 v[36:39], v[152:155], v[84:87], v[36:39]
    ds_read_b128 v[68:71], v15 offset:17408
    v_mfma_f32_16x16x32_bf16 v[40:43], v[152:155], v[88:91], v[40:43]
    ds_read_b128 v[72:75], v15 offset:21504
    v_mfma_f32_16x16x32_bf16 v[40:43], v[156:159], v[96:99], v[40:43]
    ds_read_b128 v[76:79], v15 offset:25600
    v_mfma_f32_16x16x32_bf16 v[36:39], v[156:159], v[92:95], v[36:39]
    ds_read_b128 v[80:83], v15 offset:29696
    s_waitcnt lgkmcnt(4)
    v_mfma_f32_16x16x32_bf16 v[36:39], v[160:163], v[52:55], v[36:39]
    ds_read_b128 v[84:87], v15 offset:18432
    v_mfma_f32_16x16x32_bf16 v[40:43], v[160:163], v[56:59], v[40:43]
    ds_read_b128 v[88:91], v15 offset:22528
    v_mfma_f32_16x16x32_bf16 v[40:43], v[164:167], v[64:67], v[40:43]
    ds_read_b128 v[92:95], v15 offset:26624
    v_mfma_f32_16x16x32_bf16 v[36:39], v[164:167], v[60:63], v[36:39]
    ds_read_b128 v[96:99], v15 offset:30720
    s_waitcnt lgkmcnt(4)
    v_mfma_f32_16x16x32_bf16 v[36:39], v[168:171], v[68:71], v[36:39]
    ds_read_b128 v[52:55], v15 offset:19456
    v_mfma_f32_16x16x32_bf16 v[40:43], v[168:171], v[72:75], v[40:43]
    ds_read_b128 v[56:59], v15 offset:23552
    v_mfma_f32_16x16x32_bf16 v[40:43], v[172:175], v[80:83], v[40:43]
    ds_read_b128 v[60:63], v15 offset:27648
    v_mfma_f32_16x16x32_bf16 v[36:39], v[172:175], v[76:79], v[36:39]
    ds_read_b128 v[64:67], v15 offset:31744
    s_barrier
    s_waitcnt lgkmcnt(4)
    v_mfma_f32_16x16x32_bf16 v[36:39], v[176:179], v[84:87], v[36:39]
    ds_read_b128 v[68:71], v15 offset:32768
    v_mfma_f32_16x16x32_bf16 v[40:43], v[176:179], v[88:91], v[40:43]
    ds_read_b128 v[72:75], v15 offset:36864
    v_mfma_f32_16x16x32_bf16 v[40:43], v[180:183], v[96:99], v[40:43]
    ds_read_b128 v[76:79], v15 offset:40960
    v_mfma_f32_16x16x32_bf16 v[36:39], v[180:183], v[92:95], v[36:39]
    ds_read_b128 v[80:83], v15 offset:45056
    s_waitcnt lgkmcnt(4)
    v_mfma_f32_16x16x32_bf16 v[36:39], v[184:187], v[52:55], v[36:39]
    ds_read_b128 v[84:87], v15 offset:33792
    v_mfma_f32_16x16x32_bf16 v[40:43], v[184:187], v[56:59], v[40:43]
    ds_read_b128 v[88:91], v15 offset:37888
    v_mfma_f32_16x16x32_bf16 v[40:43], v[188:191], v[64:67], v[40:43]
    ds_read_b128 v[92:95], v15 offset:41984
    v_mfma_f32_16x16x32_bf16 v[36:39], v[188:191], v[60:63], v[36:39]
    ds_read_b128 v[96:99], v15 offset:46080
    s_waitcnt lgkmcnt(4)
    v_mfma_f32_16x16x32_bf16 v[36:39], v[192:195], v[68:71], v[36:39]
    ds_read_b128 v[52:55], v15 offset:34816
    v_mfma_f32_16x16x32_bf16 v[40:43], v[192:195], v[72:75], v[40:43]
    ds_read_b128 v[56:59], v15 offset:38912
    v_mfma_f32_16x16x32_bf16 v[40:43], v[196:199], v[80:83], v[40:43]
    ds_read_b128 v[60:63], v15 offset:43008
    v_mfma_f32_16x16x32_bf16 v[36:39], v[196:199], v[76:79], v[36:39]
    ds_read_b128 v[64:67], v15 offset:47104
    s_waitcnt lgkmcnt(4)
    v_mfma_f32_16x16x32_bf16 v[36:39], v[200:203], v[84:87], v[36:39]
    ds_read_b128 v[68:71], v15 offset:35840
    v_mfma_f32_16x16x32_bf16 v[40:43], v[200:203], v[88:91], v[40:43]
    ds_read_b128 v[72:75], v15 offset:39936
    v_mfma_f32_16x16x32_bf16 v[40:43], v[204:207], v[96:99], v[40:43]
    ds_read_b128 v[76:79], v15 offset:44032
    v_mfma_f32_16x16x32_bf16 v[36:39], v[204:207], v[92:95], v[36:39]
    ds_read_b128 v[80:83], v15 offset:48128
    s_barrier
    s_waitcnt lgkmcnt(4)
    v_mfma_f32_16x16x32_bf16 v[36:39], v[208:211], v[52:55], v[36:39]
    ds_read_b128 v[84:87], v14 offset:16384
    v_mfma_f32_16x16x32_bf16 v[40:43], v[208:211], v[56:59], v[40:43]
    ds_read_b128 v[88:91], v14 offset:20480
    v_mfma_f32_16x16x32_bf16 v[40:43], v[212:215], v[64:67], v[40:43]
    ds_read_b128 v[92:95], v14 offset:24576
    v_mfma_f32_16x16x32_bf16 v[36:39], v[212:215], v[60:63], v[36:39]
    ds_read_b128 v[96:99], v14 offset:28672
    s_waitcnt lgkmcnt(4)
    v_mfma_f32_16x16x32_bf16 v[36:39], v[216:219], v[68:71], v[36:39]
    ds_read_b128 v[52:55], v14 offset:17408
    v_mfma_f32_16x16x32_bf16 v[40:43], v[216:219], v[72:75], v[40:43]
    ds_read_b128 v[56:59], v14 offset:21504
    v_mfma_f32_16x16x32_bf16 v[40:43], v[220:223], v[80:83], v[40:43]
    ds_read_b128 v[60:63], v14 offset:25600
    v_mfma_f32_16x16x32_bf16 v[36:39], v[220:223], v[76:79], v[36:39]
    ds_read_b128 v[64:67], v14 offset:29696
    s_waitcnt lgkmcnt(4)
    v_mfma_f32_16x16x32_bf16 v[36:39], v[224:227], v[84:87], v[36:39]
    ds_read_b128 v[68:71], v14 offset:18432
    v_mfma_f32_16x16x32_bf16 v[40:43], v[224:227], v[88:91], v[40:43]
    ds_read_b128 v[72:75], v14 offset:22528
    v_mfma_f32_16x16x32_bf16 v[40:43], v[228:231], v[96:99], v[40:43]
    ds_read_b128 v[76:79], v14 offset:26624
    v_mfma_f32_16x16x32_bf16 v[36:39], v[228:231], v[92:95], v[36:39]
    ds_read_b128 v[80:83], v14 offset:30720
    s_waitcnt lgkmcnt(4)
    v_mfma_f32_16x16x32_bf16 v[36:39], v[232:235], v[52:55], v[36:39]
    ds_read_b128 v[84:87], v14 offset:19456
    v_mfma_f32_16x16x32_bf16 v[40:43], v[232:235], v[56:59], v[40:43]
    ds_read_b128 v[88:91], v14 offset:23552
    v_mfma_f32_16x16x32_bf16 v[40:43], v[236:239], v[64:67], v[40:43]
    ds_read_b128 v[92:95], v14 offset:27648
    v_mfma_f32_16x16x32_bf16 v[36:39], v[236:239], v[60:63], v[36:39]
    ds_read_b128 v[96:99], v14 offset:31744
    s_barrier
    s_waitcnt lgkmcnt(4)
    v_mfma_f32_16x16x32_bf16 v[36:39], v[240:243], v[68:71], v[36:39]
    ds_read_b128 v[52:55], v14 offset:32768
    v_mfma_f32_16x16x32_bf16 v[40:43], v[240:243], v[72:75], v[40:43]
    ds_read_b128 v[56:59], v14 offset:36864
    v_mfma_f32_16x16x32_bf16 v[40:43], v[244:247], v[80:83], v[40:43]
    ds_read_b128 v[60:63], v14 offset:40960
    v_mfma_f32_16x16x32_bf16 v[36:39], v[244:247], v[76:79], v[36:39]
    ds_read_b128 v[64:67], v14 offset:45056
    s_waitcnt lgkmcnt(4)
    v_mfma_f32_16x16x32_bf16 v[36:39], v[248:251], v[84:87], v[36:39]
    ds_read_b128 v[68:71], v14 offset:33792
    v_mfma_f32_16x16x32_bf16 v[40:43], v[248:251], v[88:91], v[40:43]
    ds_read_b128 v[72:75], v14 offset:37888
    v_mfma_f32_16x16x32_bf16 v[40:43], v[252:255], v[96:99], v[40:43]
    ds_read_b128 v[76:79], v14 offset:41984
    v_mfma_f32_16x16x32_bf16 v[36:39], v[252:255], v[92:95], v[36:39]
    ds_read_b128 v[80:83], v14 offset:46080
    s_waitcnt lgkmcnt(4)
    v_mfma_f32_16x16x32_bf16 v[44:47], v[128:131], v[52:55], v[44:47]
    ds_read_b128 v[84:87], v14 offset:34816
    v_mfma_f32_16x16x32_bf16 v[48:51], v[128:131], v[56:59], v[48:51]
    ds_read_b128 v[88:91], v14 offset:38912
    v_mfma_f32_16x16x32_bf16 v[48:51], v[132:135], v[64:67], v[48:51]
    ds_read_b128 v[92:95], v14 offset:43008
    v_mfma_f32_16x16x32_bf16 v[44:47], v[132:135], v[60:63], v[44:47]
    ds_read_b128 v[96:99], v14 offset:47104
    v_add_u32 v36, 0x10000, v36
    v_add_u32 v38, 0x10000, v38
    v_add_u32 v40, 0x10000, v40
    v_add_u32 v42, 0x10000, v42
    v_and_b32 v36, 0xfffe0000, v36
    v_and_b32 v38, 0xfffe0000, v38
    v_and_b32 v40, 0xfffe0000, v40
    v_and_b32 v42, 0xfffe0000, v42
    v_cvt_pk_bf16_f32 v36, v36, v37
    v_cvt_pk_bf16_f32 v37, v38, v39
    v_cvt_pk_bf16_f32 v38, v40, v41
    v_cvt_pk_bf16_f32 v39, v42, v43
    s_add_u32 s36, s39, 262144
    v_permlane16_swap_b32 v36, v38
    v_permlane16_swap_b32 v37, v39
    s_waitcnt lgkmcnt(4)
    v_mfma_f32_16x16x32_bf16 v[44:47], v[136:139], v[68:71], v[44:47]
    ds_read_b128 v[52:55], v14 offset:35840
    v_mfma_f32_16x16x32_bf16 v[48:51], v[136:139], v[72:75], v[48:51]
    ds_read_b128 v[56:59], v14 offset:39936
    v_mfma_f32_16x16x32_bf16 v[48:51], v[140:143], v[80:83], v[48:51]
    ds_read_b128 v[60:63], v14 offset:44032
    v_mfma_f32_16x16x32_bf16 v[44:47], v[140:143], v[76:79], v[44:47]
    ds_read_b128 v[64:67], v14 offset:48128
    s_barrier
    s_waitcnt lgkmcnt(4)
    v_mfma_f32_16x16x32_bf16 v[44:47], v[144:147], v[84:87], v[44:47]
    ds_read_b128 v[68:71], v15 offset:0
    v_mfma_f32_16x16x32_bf16 v[48:51], v[144:147], v[88:91], v[48:51]
    ds_read_b128 v[72:75], v15 offset:4096
    v_mfma_f32_16x16x32_bf16 v[48:51], v[148:151], v[96:99], v[48:51]
    ds_read_b128 v[76:79], v15 offset:8192
    v_mfma_f32_16x16x32_bf16 v[44:47], v[148:151], v[92:95], v[44:47]
    ds_read_b128 v[80:83], v15 offset:12288
    s_add_u32 s36, s39, 0
    buffer_store_dwordx4 v[20:23], v13, s[24:27], s36 offen sc1
    s_waitcnt lgkmcnt(4)
    v_mfma_f32_16x16x32_bf16 v[44:47], v[152:155], v[52:55], v[44:47]
    ds_read_b128 v[84:87], v15 offset:1024
    v_mfma_f32_16x16x32_bf16 v[48:51], v[152:155], v[56:59], v[48:51]
    ds_read_b128 v[88:91], v15 offset:5120
    v_mfma_f32_16x16x32_bf16 v[48:51], v[156:159], v[64:67], v[48:51]
    ds_read_b128 v[92:95], v15 offset:9216
    v_mfma_f32_16x16x32_bf16 v[44:47], v[156:159], v[60:63], v[44:47]
    ds_read_b128 v[96:99], v15 offset:13312
    s_add_u32 s36, s39, 131072
    buffer_store_dwordx4 v[28:31], v13, s[24:27], s36 offen sc1
    s_waitcnt lgkmcnt(4)
    v_mfma_f32_16x16x32_bf16 v[44:47], v[160:163], v[68:71], v[44:47]
    ds_read_b128 v[52:55], v15 offset:2048
    v_mfma_f32_16x16x32_bf16 v[48:51], v[160:163], v[72:75], v[48:51]
    ds_read_b128 v[56:59], v15 offset:6144
    v_mfma_f32_16x16x32_bf16 v[48:51], v[164:167], v[80:83], v[48:51]
    ds_read_b128 v[60:63], v15 offset:10240
    v_mfma_f32_16x16x32_bf16 v[44:47], v[164:167], v[76:79], v[44:47]
    ds_read_b128 v[64:67], v15 offset:14336
    s_add_u32 s36, s39, 262144
    buffer_store_dwordx4 v[36:39], v13, s[24:27], s36 offen sc1
    s_waitcnt lgkmcnt(4)
    v_mfma_f32_16x16x32_bf16 v[44:47], v[168:171], v[84:87], v[44:47]
    ds_read_b128 v[68:71], v15 offset:3072
    v_mfma_f32_16x16x32_bf16 v[48:51], v[168:171], v[88:91], v[48:51]
    ds_read_b128 v[72:75], v15 offset:7168
    v_mfma_f32_16x16x32_bf16 v[48:51], v[172:175], v[96:99], v[48:51]
    ds_read_b128 v[76:79], v15 offset:11264
    v_mfma_f32_16x16x32_bf16 v[44:47], v[172:175], v[92:95], v[44:47]
    ds_read_b128 v[80:83], v15 offset:15360
    s_barrier
    s_waitcnt lgkmcnt(4)
    v_mfma_f32_16x16x32_bf16 v[44:47], v[176:179], v[52:55], v[44:47]
    ds_read_b128 v[84:87], v15 offset:16384
    v_mfma_f32_16x16x32_bf16 v[48:51], v[176:179], v[56:59], v[48:51]
    ds_read_b128 v[88:91], v15 offset:20480
    v_mfma_f32_16x16x32_bf16 v[48:51], v[180:183], v[64:67], v[48:51]
    ds_read_b128 v[92:95], v15 offset:24576
    v_mfma_f32_16x16x32_bf16 v[44:47], v[180:183], v[60:63], v[44:47]
    ds_read_b128 v[96:99], v15 offset:28672
    s_waitcnt lgkmcnt(4)
    v_mfma_f32_16x16x32_bf16 v[44:47], v[184:187], v[68:71], v[44:47]
    ds_read_b128 v[52:55], v15 offset:17408
    v_mfma_f32_16x16x32_bf16 v[48:51], v[184:187], v[72:75], v[48:51]
    ds_read_b128 v[56:59], v15 offset:21504
    v_mfma_f32_16x16x32_bf16 v[48:51], v[188:191], v[80:83], v[48:51]
    ds_read_b128 v[60:63], v15 offset:25600
    v_mfma_f32_16x16x32_bf16 v[44:47], v[188:191], v[76:79], v[44:47]
    ds_read_b128 v[64:67], v15 offset:29696
    s_waitcnt lgkmcnt(4)
    v_mfma_f32_16x16x32_bf16 v[44:47], v[192:195], v[84:87], v[44:47]
    ds_read_b128 v[68:71], v15 offset:18432
    v_mfma_f32_16x16x32_bf16 v[48:51], v[192:195], v[88:91], v[48:51]
    ds_read_b128 v[72:75], v15 offset:22528
    v_mfma_f32_16x16x32_bf16 v[48:51], v[196:199], v[96:99], v[48:51]
    ds_read_b128 v[76:79], v15 offset:26624
    v_mfma_f32_16x16x32_bf16 v[44:47], v[196:199], v[92:95], v[44:47]
    ds_read_b128 v[80:83], v15 offset:30720
    s_waitcnt lgkmcnt(4)
    v_mfma_f32_16x16x32_bf16 v[44:47], v[200:203], v[52:55], v[44:47]
    ds_read_b128 v[84:87], v15 offset:19456
    v_mfma_f32_16x16x32_bf16 v[48:51], v[200:203], v[56:59], v[48:51]
    ds_read_b128 v[88:91], v15 offset:23552
    v_mfma_f32_16x16x32_bf16 v[48:51], v[204:207], v[64:67], v[48:51]
    ds_read_b128 v[92:95], v15 offset:27648
    v_mfma_f32_16x16x32_bf16 v[44:47], v[204:207], v[60:63], v[44:47]
    ds_read_b128 v[96:99], v15 offset:31744
    s_barrier
    s_waitcnt lgkmcnt(4)
    v_mfma_f32_16x16x32_bf16 v[44:47], v[208:211], v[68:71], v[44:47]
    ds_read_b128 v[52:55], v15 offset:32768
    v_mfma_f32_16x16x32_bf16 v[48:51], v[208:211], v[72:75], v[48:51]
    ds_read_b128 v[56:59], v15 offset:36864
    v_mfma_f32_16x16x32_bf16 v[48:51], v[212:215], v[80:83], v[48:51]
    ds_read_b128 v[60:63], v15 offset:40960
    v_mfma_f32_16x16x32_bf16 v[44:47], v[212:215], v[76:79], v[44:47]
    ds_read_b128 v[64:67], v15 offset:45056
    s_waitcnt lgkmcnt(4)
    v_mfma_f32_16x16x32_bf16 v[44:47], v[216:219], v[84:87], v[44:47]
    ds_read_b128 v[68:71], v15 offset:33792
    v_mfma_f32_16x16x32_bf16 v[48:51], v[216:219], v[88:91], v[48:51]
    ds_read_b128 v[72:75], v15 offset:37888
    v_mfma_f32_16x16x32_bf16 v[48:51], v[220:223], v[96:99], v[48:51]
    ds_read_b128 v[76:79], v15 offset:41984
    v_mfma_f32_16x16x32_bf16 v[44:47], v[220:223], v[92:95], v[44:47]
    ds_read_b128 v[80:83], v15 offset:46080
    s_waitcnt lgkmcnt(4)
    v_mfma_f32_16x16x32_bf16 v[44:47], v[224:227], v[52:55], v[44:47]
    ds_read_b128 v[84:87], v15 offset:34816
    v_mfma_f32_16x16x32_bf16 v[48:51], v[224:227], v[56:59], v[48:51]
    ds_read_b128 v[88:91], v15 offset:38912
    v_mfma_f32_16x16x32_bf16 v[48:51], v[228:231], v[64:67], v[48:51]
    ds_read_b128 v[92:95], v15 offset:43008
    v_mfma_f32_16x16x32_bf16 v[44:47], v[228:231], v[60:63], v[44:47]
    ds_read_b128 v[96:99], v15 offset:47104
    s_waitcnt lgkmcnt(4)
    v_mfma_f32_16x16x32_bf16 v[44:47], v[232:235], v[68:71], v[44:47]
    ds_read_b128 v[52:55], v15 offset:35840
    v_mfma_f32_16x16x32_bf16 v[48:51], v[232:235], v[72:75], v[48:51]
    ds_read_b128 v[56:59], v15 offset:39936
    v_mfma_f32_16x16x32_bf16 v[48:51], v[236:239], v[80:83], v[48:51]
    ds_read_b128 v[60:63], v15 offset:44032
    v_mfma_f32_16x16x32_bf16 v[44:47], v[236:239], v[76:79], v[44:47]
    ds_read_b128 v[64:67], v15 offset:48128
    ds_write_b128 v16, v[20:23] offset:0
    ds_write_b128 v16, v[28:31] offset:4096
    ds_write_b128 v16, v[36:39] offset:8192
    s_waitcnt lgkmcnt(7)
    v_mfma_f32_16x16x32_bf16 v[44:47], v[240:243], v[84:87], v[44:47]
    v_mfma_f32_16x16x32_bf16 v[48:51], v[240:243], v[88:91], v[48:51]
    v_mfma_f32_16x16x32_bf16 v[48:51], v[244:247], v[96:99], v[48:51]
    v_mfma_f32_16x16x32_bf16 v[44:47], v[244:247], v[92:95], v[44:47]
    s_waitcnt lgkmcnt(3)
    v_mfma_f32_16x16x32_bf16 v[44:47], v[248:251], v[52:55], v[44:47]
    v_mfma_f32_16x16x32_bf16 v[48:51], v[248:251], v[56:59], v[48:51]
    v_mfma_f32_16x16x32_bf16 v[48:51], v[252:255], v[64:67], v[48:51]
    v_mfma_f32_16x16x32_bf16 v[44:47], v[252:255], v[60:63], v[44:47]
    s_setprio 0
    s_nop 6
    v_add_u32 v44, 0x10000, v44
    v_add_u32 v46, 0x10000, v46
    v_add_u32 v48, 0x10000, v48
    v_add_u32 v50, 0x10000, v50
    v_and_b32 v44, 0xfffe0000, v44
    v_and_b32 v46, 0xfffe0000, v46
    v_and_b32 v48, 0xfffe0000, v48
    v_and_b32 v50, 0xfffe0000, v50
    v_cvt_pk_bf16_f32 v44, v44, v45
    v_cvt_pk_bf16_f32 v45, v46, v47
    v_cvt_pk_bf16_f32 v46, v48, v49
    v_cvt_pk_bf16_f32 v47, v50, v51
    s_add_u32 s36, s39, 393216
    v_permlane16_swap_b32 v44, v46
    v_permlane16_swap_b32 v45, v47
    s_add_u32 s36, s39, 393216
    buffer_store_dwordx4 v[44:47], v13, s[24:27], s36 offen sc1
    ds_write_b128 v16, v[44:47] offset:12288
    s_waitcnt lgkmcnt(0)
    s_barrier
    s_cmp_ge_u32 s30, 6
    s_cbranch_scc1 WLOAD
    s_and_b32 s35, s30, 1
    s_add_u32 s12, s62, 0x480000
    s_addc_u32 s13, s63, 0
    s_mov_b32 s14, 0x7e000
    s_mov_b32 s15, 0x20000
    s_mul_i32 s38, s35, 262144
    s_lshl_b32 s41, s35, 13
    s_mov_b32 s42, 0
    s_mov_b32 s44, s29
    s_add_u32 s54, s55, 1024
    v_mov_b32 v9, s54
    v_lshl_add_u32 v9, v1, 7, v9
    s_add_u32 s44, s44, 1
    s_and_b32 s44, s44, 15
    s_add_u32 s46, s29, 1
    s_and_b32 s46, s46, 15
    s_cmp_eq_u32 s28, s29
    s_cselect_b32 s47, s46, s28
    s_mov_b32 s42, 16384
    s_and_b32 s35, s30, 1
    s_lshl_b32 s35, s35, 7
    s_add_u32 s35, s35, s55
    s_add_u32 s35, s35, 0x1600
    s_and_b32 s40, s30, 1
    s_lshl_b32 s40, s40, 13
    s_lshl_b32 s53, s29, 7
    s_add_u32 s40, s40, s53
    s_add_u32 s40, s40, 23068672
    v_lshlrev_b32 v10, 3, v1
    s_add_u32 s20, s62, 0x1c8000
    s_addc_u32 s21, s63, 0
    s_mov_b32 s22, 0x6000
    s_mov_b32 s23, 0x20000
    s_and_b32 s34, s30, 1
    s_lshl_b32 s34, s34, 9
    s_call_b64 s[76:77], PREP_a_issue_3
    s_mov_b32 m0, s19
    s_mov_b32 s39, s16
    s_and_b32 s53, s30, 3
    s_lshl_b32 s53, s53, 7
    s_add_u32 s53, s53, s55
    s_add_u32 s53, s53, 0x400
    v_mov_b32 v14, 1
    v_mov_b32 v15, 0
    s_mov_b64 exec, 1
    s_waitcnt vmcnt(0)
    buffer_atomic_add v14, v15, s[56:59], s53 offen sc1
    s_mov_b64 exec, -1
    s_call_b64 s[76:77], SUB_rest_2
    s_waitcnt lgkmcnt(0)
    s_mov_b32 s53, 0
    s_add_u32 s54, s52, 16
    s_bfm_b64 exec, 4, 0
poll_32:
    buffer_load_dword v8, v9, s[56:59], 0 offen sc1
    s_waitcnt vmcnt(0)
    v_cmp_eq_u32 vcc, s54, v8
    s_nop 0
    s_cmp_eq_u64 vcc, exec
    s_cbranch_scc1 pok_33
    s_sleep 5
    s_add_u32 s53, s53, 1
    s_cmp_lt_u32 s53, s61
    s_cbranch_scc1 poll_32
    s_mov_b32 s61, 0
pok_33:
    s_mov_b64 exec, -1
    buffer_load_dwordx4 v2, s[12:15], s39 offen sc1 lds
    buffer_load_dwordx4 v2, s[12:15], s39 offen offset:1024 sc1 lds
    s_call_b64 s[76:77], PREP_a_issue_3
    s_add_u32 m0, m0, 2048
    s_add_u32 s39, s39, 65536
    buffer_load_dwordx4 v2, s[12:15], s39 offen sc1 lds
    buffer_load_dwordx4 v2, s[12:15], s39 offen offset:1024 sc1 lds
    s_add_u32 m0, m0, 2048
    s_add_u32 s39, s39, 65536
    buffer_load_dwordx4 v2, s[12:15], s39 offen sc1 lds
    buffer_load_dwordx4 v2, s[12:15], s39 offen offset:1024 sc1 lds
    s_add_u32 m0, m0, 2048
    s_add_u32 s39, s39, 65536
    buffer_load_dwordx4 v2, s[12:15], s39 offen sc1 lds
    buffer_load_dwordx4 v2, s[12:15], s39 offen offset:1024 sc1 lds
    s_mov_b32 m0, s19
    s_mov_b32 s39, s16
    buffer_load_dwordx4 v2, s[12:15], s39 offen sc1 lds
    buffer_load_dwordx4 v2, s[12:15], s39 offen offset:1024 sc1 lds
    s_call_b64 s[76:77], PREP_a_issue_3
    s_add_u32 m0, m0, 2048
    s_add_u32 s39, s39, 65536
    buffer_load_dwordx4 v2, s[12:15], s39 offen sc1 lds
    buffer_load_dwordx4 v2, s[12:15], s39 offen offset:1024 sc1 lds
    s_add_u32 m0, m0, 2048
    s_add_u32 s39, s39, 65536
    buffer_load_dwordx4 v2, s[12:15], s39 offen sc1 lds
    buffer_load_dwordx4 v2, s[12:15], s39 offen offset:1024 sc1 lds
    s_add_u32 m0, m0, 2048
    s_add_u32 s39, s39, 65536
    buffer_load_dwordx4 v2, s[12:15], s39 offen sc1 lds
    buffer_load_dwordx4 v2, s[12:15], s39 offen offset:1024 sc1 lds
    s_mov_b32 m0, s19
    s_mov_b32 s39, s16
    s_waitcnt vmcnt(8)
    s_barrier
    buffer_load_dwordx4 v2, s[12:15], s39 offen sc1 lds
    buffer_load_dwordx4 v2, s[12:15], s39 offen offset:1024 sc1 lds
    s_call_b64 s[76:77], PREP_a_issue_3
    s_add_u32 m0, m0, 2048
    s_add_u32 s39, s39, 65536
    buffer_load_dwordx4 v2, s[12:15], s39 offen sc1 lds
    buffer_load_dwordx4 v2, s[12:15], s39 offen offset:1024 sc1 lds
    s_add_u32 m0, m0, 2048
    s_add_u32 s39, s39, 65536
    buffer_load_dwordx4 v2, s[12:15], s39 offen sc1 lds
    buffer_load_dwordx4 v2, s[12:15], s39 offen offset:1024 sc1 lds
    s_add_u32 m0, m0, 2048
    s_add_u32 s39, s39, 65536
    buffer_load_dwordx4 v2, s[12:15], s39 offen sc1 lds
    buffer_load_dwordx4 v2, s[12:15], s39 offen offset:1024 sc1 lds
    s_mov_b32 m0, s19
    s_mov_b32 s39, s16
    s_add_u32 s36, s34, 155648
    v_add_u32 v51, s36, v10
    ds_read_b64 v[18:19], v51 offset:0
    ds_read_b64 v[20:21], v51 offset:1024
    ds_read_b64 v[22:23], v51 offset:2048
    ds_read_b64 v[24:25], v51 offset:3072
    s_lshr_b32 s53, s29, 3
    s_lshl_b32 s53, s53, 14
    s_and_b32 s36, s29, 7
    s_lshl_b32 s36, s36, 10
    s_add_u32 s36, s36, s53
    s_add_u32 s36, s36, s34
    s_waitcnt lgkmcnt(0)
    v_pk_add_f32 v[18:19], v[18:19], v[20:21]
    v_pk_add_f32 v[18:19], v[18:19], v[22:23]
    v_pk_add_f32 v[18:19], v[18:19], v[24:25]
    buffer_store_dwordx2 v[18:19], v10, s[20:23], s36 offen sc1
    s_waitcnt vmcnt(9)
    s_barrier
    buffer_load_dwordx4 v2, s[12:15], s39 offen sc1 lds
    buffer_load_dwordx4 v2, s[12:15], s39 offen offset:1024 sc1 lds
    s_call_b64 s[76:77], PREP_a_issue_3
    s_add_u32 m0, m0, 2048
    s_add_u32 s39, s39, 65536
    buffer_load_dwordx4 v2, s[12:15], s39 offen sc1 lds
    buffer_load_dwordx4 v2, s[12:15], s39 offen offset:1024 sc1 lds
    s_add_u32 m0, m0, 2048
    s_add_u32 s39, s39, 65536
    buffer_load_dwordx4 v2, s[12:15], s39 offen sc1 lds
    buffer_load_dwordx4 v2, s[12:15], s39 offen offset:1024 sc1 lds
    s_add_u32 m0, m0, 2048
    s_add_u32 s39, s39, 65536
    buffer_load_dwordx4 v2, s[12:15], s39 offen sc1 lds
    buffer_load_dwordx4 v2, s[12:15], s39 offen offset:1024 sc1 lds
    s_mov_b32 m0, s19
    s_mov_b32 s39, s16
    s_waitcnt vmcnt(9)
    s_barrier
    buffer_load_dwordx4 v2, s[12:15], s39 offen sc1 lds
    buffer_load_dwordx4 v2, s[12:15], s39 offen offset:1024 sc1 lds
    s_call_b64 s[76:77], PREP_a_issue_3
    s_add_u32 m0, m0, 2048
    s_add_u32 s39, s39, 65536
    buffer_load_dwordx4 v2, s[12:15], s39 offen sc1 lds
    buffer_load_dwordx4 v2, s[12:15], s39 offen offset:1024 sc1 lds
    s_add_u32 m0, m0, 2048
    s_add_u32 s39, s39, 65536
    buffer_load_dwordx4 v2, s[12:15], s39 offen sc1 lds
    buffer_load_dwordx4 v2, s[12:15], s39 offen offset:1024 sc1 lds
    s_add_u32 m0, m0, 2048
    s_add_u32 s39, s39, 65536
    buffer_load_dwordx4 v2, s[12:15], s39 offen sc1 lds
    buffer_load_dwordx4 v2, s[12:15], s39 offen offset:1024 sc1 lds
    s_mov_b32 m0, s19
    s_mov_b32 s39, s16
    s_waitcnt vmcnt(16)
    s_and_b32 s53, s30, 1
    s_lshl_b32 s53, s53, 7
    s_add_u32 s53, s53, s55
    s_add_u32 s53, s53, 0x1600
    v_mov_b32 v14, 1
    v_mov_b32 v15, 0
    s_mov_b64 exec, 1
    buffer_atomic_add v14, v15, s[56:59], s53 offen sc1
    s_mov_b64 exec, -1
    s_waitcnt vmcnt(9)
    s_barrier
    buffer_load_dwordx4 v2, s[12:15], s39 offen sc1 lds
    buffer_load_dwordx4 v2, s[12:15], s39 offen offset:1024 sc1 lds
    s_call_b64 s[76:77], PREP_a_issue_3
    s_add_u32 m0, m0, 2048
    s_add_u32 s39, s39, 65536
    buffer_load_dwordx4 v2, s[12:15], s39 offen sc1 lds
    buffer_load_dwordx4 v2, s[12:15], s39 offen offset:1024 sc1 lds
    s_add_u32 m0, m0, 2048
    s_add_u32 s39, s39, 65536
    buffer_load_dwordx4 v2, s[12:15], s39 offen sc1 lds
    buffer_load_dwordx4 v2, s[12:15], s39 offen offset:1024 sc1 lds
    s_add_u32 m0, m0, 2048
    s_add_u32 s39, s39, 65536
    buffer_load_dwordx4 v2, s[12:15], s39 offen sc1 lds
    buffer_load_dwordx4 v2, s[12:15], s39 offen offset:1024 sc1 lds
    s_mov_b32 m0, s19
    s_mov_b32 s39, s16
    s_waitcnt vmcnt(9)
    s_barrier
    buffer_load_dwordx4 v2, s[12:15], s39 offen sc1 lds
    buffer_load_dwordx4 v2, s[12:15], s39 offen offset:1024 sc1 lds
    s_call_b64 s[76:77], PREP_a_issue_3
    s_add_u32 m0, m0, 2048
    s_add_u32 s39, s39, 65536
    buffer_load_dwordx4 v2, s[12:15], s39 offen sc1 lds
    buffer_load_dwordx4 v2, s[12:15], s39 offen offset:1024 sc1 lds
    s_add_u32 m0, m0, 2048
    s_add_u32 s39, s39, 65536
    buffer_load_dwordx4 v2, s[12:15], s39 offen sc1 lds
    buffer_load_dwordx4 v2, s[12:15], s39 offen offset:1024 sc1 lds
    s_add_u32 m0, m0, 2048
    s_add_u32 s39, s39, 65536
    buffer_load_dwordx4 v2, s[12:15], s39 offen sc1 lds
    buffer_load_dwordx4 v2, s[12:15], s39 offen offset:1024 sc1 lds
    s_mov_b32 m0, s19
    s_mov_b32 s39, s16
    s_waitcnt vmcnt(8)
    s_barrier
    buffer_load_dwordx4 v2, s[12:15], s39 offen sc1 lds
    buffer_load_dwordx4 v2, s[12:15], s39 offen offset:1024 sc1 lds
    s_call_b64 s[76:77], PREP_a_issue_3
    s_add_u32 m0, m0, 2048
    s_add_u32 s39, s39, 65536
    buffer_load_dwordx4 v2, s[12:15], s39 offen sc1 lds
    buffer_load_dwordx4 v2, s[12:15], s39 offen offset:1024 sc1 lds
    s_add_u32 m0, m0, 2048
    s_add_u32 s39, s39, 65536
    buffer_load_dwordx4 v2, s[12:15], s39 offen sc1 lds
    buffer_load_dwordx4 v2, s[12:15], s39 offen offset:1024 sc1 lds
    s_add_u32 m0, m0, 2048
    s_add_u32 s39, s39, 65536
    buffer_load_dwordx4 v2, s[12:15], s39 offen sc1 lds
    buffer_load_dwordx4 v2, s[12:15], s39 offen offset:1024 sc1 lds
    s_mov_b32 m0, s19
    s_mov_b32 s39, s16
    s_waitcnt vmcnt(8)
    s_barrier
    buffer_load_dwordx4 v2, s[12:15], s39 offen sc1 lds
    buffer_load_dwordx4 v2, s[12:15], s39 offen offset:1024 sc1 lds
    s_call_b64 s[76:77], PREP_a_issue_3
    s_add_u32 m0, m0, 2048
    s_add_u32 s39, s39, 65536
    buffer_load_dwordx4 v2, s[12:15], s39 offen sc1 lds
    buffer_load_dwordx4 v2, s[12:15], s39 offen offset:1024 sc1 lds
    s_add_u32 m0, m0, 2048
    s_add_u32 s39, s39, 65536
    buffer_load_dwordx4 v2, s[12:15], s39 offen sc1 lds
    buffer_load_dwordx4 v2, s[12:15], s39 offen offset:1024 sc1 lds
    s_add_u32 m0, m0, 2048
    s_add_u32 s39, s39, 65536
    buffer_load_dwordx4 v2, s[12:15], s39 offen sc1 lds
    buffer_load_dwordx4 v2, s[12:15], s39 offen offset:1024 sc1 lds
    s_mov_b32 m0, s19
    s_mov_b32 s39, s16
    s_load_dword s32, s[4:5], s35
    s_load_dword s3, s[4:5], s40
    s_waitcnt vmcnt(8)
    s_barrier
    buffer_load_dwordx4 v2, s[12:15], s39 offen sc1 lds
    buffer_load_dwordx4 v2, s[12:15], s39 offen offset:1024 sc1 lds
    s_call_b64 s[76:77], PREP_a_issue_3
    s_add_u32 m0, m0, 2048
    s_add_u32 s39, s39, 65536
    buffer_load_dwordx4 v2, s[12:15], s39 offen sc1 lds
    buffer_load_dwordx4 v2, s[12:15], s39 offen offset:1024 sc1 lds
    s_add_u32 m0, m0, 2048
    s_add_u32 s39, s39, 65536
    buffer_load_dwordx4 v2, s[12:15], s39 offen sc1 lds
    buffer_load_dwordx4 v2, s[12:15], s39 offen offset:1024 sc1 lds
    s_add_u32 m0, m0, 2048
    s_add_u32 s39, s39, 65536
    buffer_load_dwordx4 v2, s[12:15], s39 offen sc1 lds
    buffer_load_dwordx4 v2, s[12:15], s39 offen offset:1024 sc1 lds
    s_mov_b32 m0, s19
    s_mov_b32 s39, s16
    s_add_u32 s54, s52, 16
    s_waitcnt lgkmcnt(0)
    s_cmp_eq_u32 s32, s54
    s_cbranch_scc1 fok_34
    v_mov_b32 v15, s35
    s_mov_b32 s53, 0
    s_add_u32 s54, s52, 16
    s_bfm_b64 exec, 1, 0
poll_35:
    buffer_load_dword v14, v15, s[56:59], 0 offen sc1
    s_waitcnt vmcnt(0)
    v_cmp_eq_u32 vcc, s54, v14
    s_nop 0
    s_cmp_eq_u64 vcc, exec
    s_cbranch_scc1 pok_36
    s_sleep 5
    s_add_u32 s53, s53, 1
    s_cmp_lt_u32 s53, s61
    s_cbranch_scc1 poll_35
    s_mov_b32 s61, 0
pok_36:
    s_mov_b64 exec, -1
fok_34:
    s_add_u32 s36, s34, 0
    buffer_load_dwordx2 v[18:19], v10, s[20:23], s36 offen offset:0 sc1
    buffer_load_dwordx2 v[20:21], v10, s[20:23], s36 offen offset:1024 sc1
    buffer_load_dwordx2 v[22:23], v10, s[20:23], s36 offen offset:2048 sc1
    buffer_load_dwordx2 v[24:25], v10, s[20:23], s36 offen offset:3072 sc1
    s_add_u32 s36, s36, 4096
    buffer_load_dwordx2 v[26:27], v10, s[20:23], s36 offen offset:0 sc1
    buffer_load_dwordx2 v[28:29], v10, s[20:23], s36 offen offset:1024 sc1
    buffer_load_dwordx2 v[30:31], v10, s[20:23], s36 offen offset:2048 sc1
    buffer_load_dwordx2 v[32:33], v10, s[20:23], s36 offen offset:3072 sc1
    s_waitcnt vmcnt(16)
    s_barrier
    buffer_load_dwordx4 v2, s[12:15], s39 offen sc1 lds
    buffer_load_dwordx4 v2, s[12:15], s39 offen offset:1024 sc1 lds
    s_call_b64 s[76:77], PREP_a_issue_3
    s_add_u32 m0, m0, 2048
    s_add_u32 s39, s39, 65536
    buffer_load_dwordx4 v2, s[12:15], s39 offen sc1 lds
    buffer_load_dwordx4 v2, s[12:15], s39 offen offset:1024 sc1 lds
    s_add_u32 m0, m0, 2048
    s_add_u32 s39, s39, 65536
    buffer_load_dwordx4 v2, s[12:15], s39 offen sc1 lds
    buffer_load_dwordx4 v2, s[12:15], s39 offen offset:1024 sc1 lds
    s_add_u32 m0, m0, 2048
    s_add_u32 s39, s39, 65536
    buffer_load_dwordx4 v2, s[12:15], s39 offen sc1 lds
    buffer_load_dwordx4 v2, s[12:15], s39 offen offset:1024 sc1 lds
    s_mov_b32 m0, s19
    s_mov_b32 s39, s16
    s_add_u32 s36, s34, 16384
    buffer_load_dwordx2 v[34:35], v10, s[20:23], s36 offen offset:0 sc1
    buffer_load_dwordx2 v[36:37], v10, s[20:23], s36 offen offset:1024 sc1
    buffer_load_dwordx2 v[38:39], v10, s[20:23], s36 offen offset:2048 sc1
    buffer_load_dwordx2 v[40:41], v10, s[20:23], s36 offen offset:3072 sc1
    s_add_u32 s36, s36, 4096
    buffer_load_dwordx2 v[42:43], v10, s[20:23], s36 offen offset:0 sc1
    buffer_load_dwordx2 v[44:45], v10, s[20:23], s36 offen offset:1024 sc1
    buffer_load_dwordx2 v[46:47], v10, s[20:23], s36 offen offset:2048 sc1
    buffer_load_dwordx2 v[48:49], v10, s[20:23], s36 offen offset:3072 sc1
    s_waitcnt vmcnt(24)
    s_barrier
    buffer_load_dwordx4 v2, s[12:15], s39 offen sc1 lds
    buffer_load_dwordx4 v2, s[12:15], s39 offen offset:1024 sc1 lds
    s_call_b64 s[76:77], PREP_a_issue_3
    s_add_u32 m0, m0, 2048
    s_add_u32 s39, s39, 65536
    buffer_load_dwordx4 v2, s[12:15], s39 offen sc1 lds
    buffer_load_dwordx4 v2, s[12:15], s39 offen offset:1024 sc1 lds
    s_add_u32 m0, m0, 2048
    s_add_u32 s39, s39, 65536
    buffer_load_dwordx4 v2, s[12:15], s39 offen sc1 lds
    buffer_load_dwordx4 v2, s[12:15], s39 offen offset:1024 sc1 lds
    s_add_u32 m0, m0, 2048
    s_add_u32 s39, s39, 65536
    buffer_load_dwordx4 v2, s[12:15], s39 offen sc1 lds
    buffer_load_dwordx4 v2, s[12:15], s39 offen offset:1024 sc1 lds
    s_mov_b32 m0, s19
    s_mov_b32 s39, s16
    s_add_u32 s54, s52, 16
    s_waitcnt lgkmcnt(0)
    s_cmp_eq_u32 s3, s54
    s_cbranch_scc1 fok_37
    v_mov_b32 v15, s40
    s_mov_b32 s53, 0
    s_add_u32 s54, s52, 16
    s_bfm_b64 exec, 1, 0
poll_38:
    buffer_load_dword v14, v15, s[56:59], 0 offen sc1
    s_waitcnt vmcnt(0)
    v_cmp_eq_u32 vcc, s54, v14
    s_nop 0
    s_cmp_eq_u64 vcc, exec
    s_cbranch_scc1 pok_39
    s_sleep 5
    s_add_u32 s53, s53, 1
    s_cmp_lt_u32 s53, s61
    s_cbranch_scc1 poll_38
    s_mov_b32 s61, 0
pok_39:
    s_mov_b64 exec, -1
fok_37:
    s_add_u32 s24, s4, 0x1420000
    s_addc_u32 s25, s5, 0
    s_mov_b32 s26, 0x38000
    s_mov_b32 s27, 0x20000
    s_cmp_eq_u32 s60, 0
    s_cselect_b32 s26, s26, 0
    s_and_b32 s36, s30, 1
    s_mul_i32 s36, s36, 448
    s_mul_i32 s37, s29, 896
    s_add_u32 s37, s36, s37
    v_lshrrev_b32 v13, 5, v1
    v_mul_u32_u24 v13, 14336, v13
    v_and_b32 v6, 496, v2
    v_add_u32 v13, v13, v6
    buffer_load_dwordx4 v[54:57], v13, s[24:27], s37 offen sc1
    s_add_u32 s37, s37, 28672
    buffer_load_dwordx4 v[58:61], v13, s[24:27], s37 offen sc1
    s_add_u32 s37, s37, 28672
    buffer_load_dwordx4 v[62:65], v13, s[24:27], s37 offen sc1
    s_add_u32 s37, s37, 28672
    buffer_load_dwordx4 v[66:69], v13, s[24:27], s37 offen sc1
    s_add_u32 s37, s37, 28672
    buffer_load_dwordx4 v[70:73], v13, s[24:27], s37 offen sc1
    s_add_u32 s37, s37, 28672
    buffer_load_dwordx4 v[74:77], v13, s[24:27], s37 offen sc1
    s_add_u32 s37, s37, 28672
    buffer_load_dwordx4 v[78:81], v13, s[24:27], s37 offen sc1
    s_add_u32 s37, s37, 28672
    buffer_load_dwordx4 v[82:85], v13, s[24:27], s37 offen sc1
    s_add_u32 s37, s37, 28672
    s_waitcnt vmcnt(24)
    s_barrier
    buffer_load_dwordx4 v2, s[12:15], s39 offen sc1 lds
    buffer_load_dwordx4 v2, s[12:15], s39 offen offset:1024 sc1 lds
    s_call_b64 s[76:77], PREP_a_issue_3
    s_add_u32 m0, m0, 2048
    s_add_u32 s39, s39, 65536
    buffer_load_dwordx4 v2, s[12:15], s39 offen sc1 lds
    buffer_load_dwordx4 v2, s[12:15], s39 offen offset:1024 sc1 lds
    s_add_u32 m0, m0, 2048
    s_add_u32 s39, s39, 65536
    buffer_load_dwordx4 v2, s[12:15], s39 offen sc1 lds
    buffer_load_dwordx4 v2, s[12:15], s39 offen offset:1024 sc1 lds
    s_add_u32 m0, m0, 2048
    s_add_u32 s39, s39, 65536
    buffer_load_dwordx4 v2, s[12:15], s39 offen sc1 lds
    buffer_load_dwordx4 v2, s[12:15], s39 offen offset:1024 sc1 lds
    s_mov_b32 m0, s19
    s_mov_b32 s39, s16
    s_waitcnt vmcnt(24)
    v_pk_add_f32 v[18:19], v[18:19], v[34:35]
    v_pk_add_f32 v[20:21], v[20:21], v[36:37]
    v_pk_add_f32 v[22:23], v[22:23], v[38:39]
    v_pk_add_f32 v[24:25], v[24:25], v[40:41]
    v_pk_add_f32 v[26:27], v[26:27], v[42:43]
    v_pk_add_f32 v[28:29], v[28:29], v[44:45]
    v_pk_add_f32 v[30:31], v[30:31], v[46:47]
    v_pk_add_f32 v[32:33], v[32:33], v[48:49]
    v_pk_add_f32 v[18:19], v[18:19], v[26:27]
    v_pk_add_f32 v[20:21], v[20:21], v[28:29]
    v_pk_add_f32 v[22:23], v[22:23], v[30:31]
    v_pk_add_f32 v[24:25], v[24:25], v[32:33]
    v_pk_add_f32 v[18:19], v[18:19], v[22:23]
    v_pk_add_f32 v[20:21], v[20:21], v[24:25]
    s_waitcnt vmcnt(16)
    s_barrier
    buffer_load_dwordx4 v2, s[12:15], s39 offen sc1 lds
    buffer_load_dwordx4 v2, s[12:15], s39 offen offset:1024 sc1 lds
    s_call_b64 s[76:77], PREP_a_issue_3
    s_add_u32 m0, m0, 2048
    s_add_u32 s39, s39, 65536
    buffer_load_dwordx4 v2, s[12:15], s39 offen sc1 lds
    buffer_load_dwordx4 v2, s[12:15], s39 offen offset:1024 sc1 lds
    s_add_u32 m0, m0, 2048
    s_add_u32 s39, s39, 65536
    buffer_load_dwordx4 v2, s[12:15], s39 offen sc1 lds
    buffer_load_dwordx4 v2, s[12:15], s39 offen offset:1024 sc1 lds
    s_add_u32 m0, m0, 2048
    s_add_u32 s39, s39, 65536
    buffer_load_dwordx4 v2, s[12:15], s39 offen sc1 lds
    buffer_load_dwordx4 v2, s[12:15], s39 offen offset:1024 sc1 lds
    s_mov_b32 m0, s19
    s_mov_b32 s39, s16
    v_pk_add_f32 v[18:19], v[18:19], v[20:21]
    v_mul_f32 v52, 0x3a800000, v18
    v_mul_f32 v50, 0x3a800000, v19
    v_fma_f32 v50, -v52, v52, v50
    v_max_f32 v50, 0, v50
    v_cvt_pk_bf16_f32 v52, v52, v52
    v_lshlrev_b32 v52, 16, v52
    v_cvt_pk_bf16_f32 v50, v50, v50
    v_lshlrev_b32 v50, 16, v50
    v_add_f32 v50, 0x3727c5ac, v50
    v_cvt_pk_bf16_f32 v50, v50, v50
    v_lshlrev_b32 v50, 16, v50
    v_sqrt_f32 v50, v50
    s_nop 0
    v_cvt_pk_bf16_f32 v50, v50, v50
    s_waitcnt vmcnt(8)
    s_barrier
    buffer_load_dwordx4 v2, s[12:15], s39 offen sc1 lds
    buffer_load_dwordx4 v2, s[12:15], s39 offen offset:1024 sc1 lds
    s_add_u32 m0, m0, 2048
    s_add_u32 s39, s39, 65536
    buffer_load_dwordx4 v2, s[12:15], s39 offen sc1 lds
    buffer_load_dwordx4 v2, s[12:15], s39 offen offset:1024 sc1 lds
    s_add_u32 m0, m0, 2048
    s_add_u32 s39, s39, 65536
    buffer_load_dwordx4 v2, s[12:15], s39 offen sc1 lds
    buffer_load_dwordx4 v2, s[12:15], s39 offen offset:1024 sc1 lds
    s_add_u32 m0, m0, 2048
    s_add_u32 s39, s39, 65536
    buffer_load_dwordx4 v2, s[12:15], s39 offen sc1 lds
    buffer_load_dwordx4 v2, s[12:15], s39 offen offset:1024 sc1 lds
    s_waitcnt vmcnt(24)
    v_lshlrev_b32 v50, 16, v50
    v_rcp_f32 v53, v50
    v_mov_b32 v18, v52
    v_mov_b32 v19, v50
    v_mul_f32 v20, 0xc0135761, v53
    v_mul_f32 v53, v53, v53
    v_mul_f32 v53, 0x3d372713, v53
    v_mul_f32 v21, v53, v20
    s_lshl1_add_u32 s36, s34, 160768
    v_add_u32 v51, s36, v2
    ds_write_b128 v51, v[18:21]
    s_cmp_lg_u32 s60, 0
    s_cbranch_scc1 pc_43
    v_pk_add_f32 v[54:55], v[54:55], v[58:59]
    v_pk_add_f32 v[56:57], v[56:57], v[60:61]
    v_pk_add_f32 v[54:55], v[54:55], v[62:63]
    v_pk_add_f32 v[56:57], v[56:57], v[64:65]
    v_pk_add_f32 v[54:55], v[54:55], v[66:67]
    v_pk_add_f32 v[56:57], v[56:57], v[68:69]
    v_pk_add_f32 v[54:55], v[54:55], v[70:71]
    v_pk_add_f32 v[56:57], v[56:57], v[72:73]
pc_43:
    s_waitcnt vmcnt(8)
    s_barrier
    s_cmp_lg_u32 s60, 0
    s_cbranch_scc1 pc_44
    v_pk_add_f32 v[54:55], v[54:55], v[74:75]
    v_pk_add_f32 v[56:57], v[56:57], v[76:77]
    v_pk_add_f32 v[54:55], v[54:55], v[78:79]
    v_pk_add_f32 v[56:57], v[56:57], v[80:81]
    v_pk_add_f32 v[54:55], v[54:55], v[82:83]
    v_pk_add_f32 v[56:57], v[56:57], v[84:85]
    v_mov_b32 v58, v54
    v_mov_b32 v59, v55
    v_mov_b32 v60, v56
    v_mov_b32 v61, v57
    v_permlane32_swap_b32 v54, v58
    v_permlane32_swap_b32 v55, v59
    v_permlane32_swap_b32 v56, v60
    v_permlane32_swap_b32 v57, v61
    v_pk_add_f32 v[54:55], v[54:55], v[58:59]
    v_pk_add_f32 v[56:57], v[56:57], v[60:61]
    s_and_b32 s36, s30, 1
    s_mul_i32 s36, s36, 448
    s_add_u32 s36, s36, 159744
    v_add_u32 v6, s36, v2
    s_bfm_b64 exec, 28, 0
    ds_write_b128 v6, v[54:57]
    s_mov_b64 exec, -1
    s_waitcnt lgkmcnt(0)
pc_44:
    s_waitcnt lgkmcnt(0)
    s_waitcnt vmcnt(0)
    s_barrier
    s_cmp_lg_u32 s60, 0
    s_cbranch_scc1 tw4_46
    s_mov_b64 s[48:49], s[74:75]
    s_lshl_b32 s45, s2, 1
    s_and_b32 s50, s30, 1
    s_add_u32 s45, s45, s50
    s_mul_i32 s45, s45, 14336
    s_mov_b32 s50, 7340032
    s_mov_b32 s51, 0x20000
    buffer_load_dwordx4 v[90:93], v2, s[48:51], s45 offen offset:0
    buffer_load_dwordx4 v[90:93], v2, s[48:51], s45 offen offset:1024
    buffer_load_dwordx4 v[90:93], v2, s[48:51], s45 offen offset:2048
    buffer_load_dwordx4 v[90:93], v2, s[48:51], s45 offen offset:3072
    s_add_u32 s45, s45, 4096
    buffer_load_dwordx4 v[90:93], v2, s[48:51], s45 offen offset:0
    buffer_load_dwordx4 v[90:93], v2, s[48:51], s45 offen offset:1024
    buffer_load_dwordx4 v[90:93], v2, s[48:51], s45 offen offset:2048
    buffer_load_dwordx4 v[90:93], v2, s[48:51], s45 offen offset:3072
    s_add_u32 s45, s45, 4096
    buffer_load_dwordx4 v[90:93], v2, s[48:51], s45 offen offset:0
    buffer_load_dwordx4 v[90:93], v2, s[48:51], s45 offen offset:1024
    buffer_load_dwordx4 v[90:93], v2, s[48:51], s45 offen offset:2048
    buffer_load_dwordx4 v[90:93], v2, s[48:51], s45 offen offset:3072
    s_add_u32 s45, s45, 4096
    buffer_load_dwordx4 v[90:93], v2, s[48:51], s45 offen offset:0
    buffer_load_dwordx4 v[90:93], v2, s[48:51], s45 offen offset:1024
tw4_46:
    s_barrier
    s_and_b32 s35, s30, 1
    s_mov_b32 s12, s62
    s_mov_b32 s13, s63
    s_mov_b32 s14, 0x1be000
    s_mov_b32 s15, 0x20000
    s_mul_i32 s38, s35, 917504
    s_mul_i32 s36, s31, 573440
    s_add_u32 s38, s38, s36
    s_mul_i32 s37, s31, 917504
    s_sub_u32 s37, 229376, s37
    s_lshl_b32 s41, s35, 13
    s_mov_b32 s42, 0
    s_mov_b32 s44, 0
    s_and_b32 s34, s30, 1
    s_lshl1_add_u32 s34, s31, s34
    s_lshl_b32 s34, s34, 7
    s_add_u32 s34, s34, s55
    s_add_u32 s34, s34, 0x1200
    s_and_b32 s35, s30, 1
    s_lshl1_add_u32 s35, s31, s35
    s_lshl_b32 s35, s35, 7
    s_add_u32 s35, s35, s55
    s_add_u32 s35, s35, 0x1400
    s_sub_u32 s48, s34, 512
    s_mov_b32 s44, 3
    s_add_u32 s36, s33, 4
    s_and_b32 s36, s36, 7
    s_mul_i32 s36, s36, 7
    s_add_u32 s36, s36, 2
    s_lshr_b32 s53, s36, 3
    s_lshl_b32 s53, s53, 14
    s_and_b32 s78, s36, 7
    s_lshl_b32 s78, s78, 10
    s_add_u32 s78, s78, s53
    s_add_u32 s36, s33, 4
    s_and_b32 s36, s36, 7
    s_mul_i32 s36, s36, 7
    s_add_u32 s36, s36, 6
    s_lshr_b32 s53, s36, 3
    s_lshl_b32 s53, s53, 14
    s_and_b32 s79, s36, 7
    s_lshl_b32 s79, s79, 10
    s_add_u32 s79, s79, s53
    s_add_u32 s36, s33, 4
    s_and_b32 s36, s36, 7
    s_mul_i32 s36, s36, 7
    s_add_u32 s36, s36, 3
    s_lshr_b32 s53, s36, 3
    s_lshl_b32 s53, s53, 14
    s_and_b32 s80, s36, 7
    s_lshl_b32 s80, s80, 10
    s_add_u32 s80, s80, s53
    s_add_u32 s36, s33, 5
    s_and_b32 s36, s36, 7
    s_mul_i32 s36, s36, 7
    s_add_u32 s36, s36, 2
    s_lshr_b32 s53, s36, 3
    s_lshl_b32 s53, s53, 14
    s_and_b32 s81, s36, 7
    s_lshl_b32 s81, s81, 10
    s_add_u32 s81, s81, s53
    s_add_u32 s36, s33, 5
    s_and_b32 s36, s36, 7
    s_mul_i32 s36, s36, 7
    s_add_u32 s36, s36, 6
    s_lshr_b32 s53, s36, 3
    s_lshl_b32 s53, s53, 14
    s_and_b32 s82, s36, 7
    s_lshl_b32 s82, s82, 10
    s_add_u32 s82, s82, s53
    s_add_u32 s36, s33, 5
    s_and_b32 s36, s36, 7
    s_mul_i32 s36, s36, 7
    s_add_u32 s36, s36, 3
    s_lshr_b32 s53, s36, 3
    s_lshl_b32 s53, s53, 14
    s_and_b32 s83, s36, 7
    s_lshl_b32 s83, s83, 10
    s_add_u32 s83, s83, s53
    s_add_u32 s36, s33, 6
    s_and_b32 s36, s36, 7
    s_mul_i32 s36, s36, 7
    s_add_u32 s36, s36, 2
    s_lshr_b32 s53, s36, 3
    s_lshl_b32 s53, s53, 14
    s_and_b32 s84, s36, 7
    s_lshl_b32 s84, s84, 10
    s_add_u32 s84, s84, s53
    s_add_u32 s36, s33, 6
    s_and_b32 s36, s36, 7
    s_mul_i32 s36, s36, 7
    s_add_u32 s36, s36, 6
    s_lshr_b32 s53, s36, 3
    s_lshl_b32 s53, s53, 14
    s_and_b32 s85, s36, 7
    s_lshl_b32 s85, s85, 10
    s_add_u32 s85, s85, s53
    s_add_u32 s36, s33, 6
    s_and_b32 s36, s36, 7
    s_mul_i32 s36, s36, 7
    s_add_u32 s36, s36, 3
    s_lshr_b32 s53, s36, 3
    s_lshl_b32 s53, s53, 14
    s_and_b32 s86, s36, 7
    s_lshl_b32 s86, s86, 10
    s_add_u32 s86, s86, s53
    s_add_u32 s36, s33, 7
    s_and_b32 s36, s36, 7
    s_mul_i32 s36, s36, 7
    s_add_u32 s36, s36, 2
    s_lshr_b32 s53, s36, 3
    s_lshl_b32 s53, s53, 14
    s_and_b32 s87, s36, 7
    s_lshl_b32 s87, s87, 10
    s_add_u32 s87, s87, s53
    s_add_u32 s36, s33, 7
    s_and_b32 s36, s36, 7
    s_mul_i32 s36, s36, 7
    s_add_u32 s36, s36, 6
    s_lshr_b32 s53, s36, 3
    s_lshl_b32 s53, s53, 14
    s_and_b32 s88, s36, 7
    s_lshl_b32 s88, s88, 10
    s_add_u32 s88, s88, s53
    s_add_u32 s36, s33, 7
    s_and_b32 s36, s36, 7
    s_mul_i32 s36, s36, 7
    s_add_u32 s36, s36, 3
    s_lshr_b32 s53, s36, 3
    s_lshl_b32 s53, s53, 14
    s_and_b32 s89, s36, 7
    s_lshl_b32 s89, s89, 10
    s_add_u32 s89, s89, s53
    s_mov_b64 s[8:9], s[68:69]
    s_mov_b32 s10, 2097152
    s_mov_b32 s11, 0x20000
    s_and_b32 s3, s30, 3
    s_lshl_b32 s36, s3, 14
    s_lshl_b32 s90, s29, 7
    s_add_u32 s90, s90, s36
    s_xor_b32 s90, s90, 128
    s_lshl_b32 s3, s3, 10
    s_call_b64 s[76:77], PREP_a_issue_4
    s_mov_b32 m0, s19
    s_mov_b32 s39, s16
    s_mov_b32 s40, s17
    s_waitcnt vmcnt(16)
    s_barrier
    s_load_dword s32, s[4:5], s48
    s_waitcnt vmcnt(8)
    s_barrier
    s_add_u32 s54, s52, 16
    s_waitcnt lgkmcnt(0)
    s_cmp_eq_u32 s32, s54
    s_cbranch_scc1 fok_47
    v_mov_b32 v9, s48
    s_mov_b32 s53, 0
    s_add_u32 s54, s52, 16
    s_bfm_b64 exec, 1, 0
poll_48:
    buffer_load_dword v8, v9, s[56:59], 0 offen sc1
    s_waitcnt vmcnt(0)
    v_cmp_eq_u32 vcc, s54, v8
    s_nop 0
    s_cmp_eq_u64 vcc, exec
    s_cbranch_scc1 pok_49
    s_sleep 5
    s_add_u32 s53, s53, 1
    s_cmp_lt_u32 s53, s61
    s_cbranch_scc1 poll_48
    s_mov_b32 s61, 0
pok_49:
    s_mov_b64 exec, -1
fok_47:
    buffer_load_dwordx4 v2, s[12:15], s39 offen sc1 lds
    s_add_u32 m0, m0, 1024
    s_nop 0
    buffer_load_dwordx4 v2, s[12:15], s40 offen sc1 lds
    s_call_b64 s[76:77], PREP_a_issue_4
    s_add_u32 m0, m0, 1024
    s_add_u32 s39, s39, 229376
    buffer_load_dwordx4 v2, s[12:15], s39 offen sc1 lds
    s_add_u32 m0, m0, 1024
    s_add_u32 s40, s40, 229376
    buffer_load_dwordx4 v2, s[12:15], s40 offen sc1 lds
    s_add_u32 m0, m0, 1024
    s_add_u32 s39, s39, s37
    buffer_load_dwordx4 v2, s[12:15], s39 offen sc1 lds
    s_add_u32 m0, m0, 1024
    s_add_u32 s40, s40, s37
    buffer_load_dwordx4 v2, s[12:15], s40 offen sc1 lds
    s_add_u32 m0, m0, 1024
    s_add_u32 s39, s39, 229376
    buffer_load_dwordx4 v2, s[12:15], s39 offen sc1 lds
    s_add_u32 m0, m0, 1024
    s_add_u32 s40, s40, 229376
    buffer_load_dwordx4 v2, s[12:15], s40 offen sc1 lds
    s_mov_b32 m0, s19
    s_mov_b32 s39, s16
    s_mov_b32 s40, s17
    s_waitcnt vmcnt(8)
    s_barrier
    buffer_load_dwordx4 v2, s[12:15], s39 offen sc1 lds
    s_add_u32 m0, m0, 1024
    s_nop 0
    buffer_load_dwordx4 v2, s[12:15], s40 offen sc1 lds
    s_mov_b32 s43, 1
ld_50:
    s_add_u32 s19, s41, s42
    s_lshl_b32 s45, s44, 1
    s_add_u32 s45, s45, 0
    s_sub_u32 s45, s45, 32
    s_mul_i32 s46, s45, 86
    s_lshr_b32 s46, s46, 8
    s_mul_i32 s47, s46, 3
    s_sub_u32 s47, s45, s47
    s_lshl_b32 s47, s47, 2
    s_lshr_b32 s47, 0x362, s47
    s_and_b32 s47, s47, 7
    s_cmp_ge_u32 s44, 10
    s_cselect_b32 s45, 9, 2
    s_cselect_b32 s51, 1, 0
    s_sub_u32 s45, s44, s45
    s_cmp_lt_u32 s44, 3
    s_cselect_b32 s45, 0, s45
    s_cselect_b32 s51, s44, s51
    s_lshl2_add_u32 s51, 0, s51
    s_cmp_lt_u32 s44, 17
    s_cselect_b32 s47, s51, s47
    s_cselect_b32 s46, s45, s46
    s_add_u32 s46, s46, s33
    s_and_b32 s46, s46, 7
    s_mul_i32 s46, s46, 7
    s_add_u32 s16, s46, s47
    s_lshr_b32 s53, s16, 3
    s_lshl_b32 s53, s53, 14
    s_and_b32 s16, s16, 7
    s_lshl_b32 s16, s16, 10
    s_add_u32 s16, s16, s53
    s_add_u32 s16, s16, s38
    s_lshl_b32 s45, s44, 1
    s_add_u32 s45, s45, 1
    s_sub_u32 s45, s45, 32
    s_mul_i32 s46, s45, 86
    s_lshr_b32 s46, s46, 8
    s_mul_i32 s47, s46, 3
    s_sub_u32 s47, s45, s47
    s_lshl_b32 s47, s47, 2
    s_lshr_b32 s47, 0x362, s47
    s_and_b32 s47, s47, 7
    s_cmp_ge_u32 s44, 10
    s_cselect_b32 s45, 9, 2
    s_cselect_b32 s51, 1, 0
    s_sub_u32 s45, s44, s45
    s_cmp_lt_u32 s44, 3
    s_cselect_b32 s45, 0, s45
    s_cselect_b32 s51, s44, s51
    s_lshl2_add_u32 s51, 1, s51
    s_cmp_lt_u32 s44, 17
    s_cselect_b32 s47, s51, s47
    s_cselect_b32 s46, s45, s46
    s_add_u32 s46, s46, s33
    s_and_b32 s46, s46, 7
    s_mul_i32 s46, s46, 7
    s_add_u32 s17, s46, s47
    s_lshr_b32 s53, s17, 3
    s_lshl_b32 s53, s53, 14
    s_and_b32 s17, s17, 7
    s_lshl_b32 s17, s17, 10
    s_add_u32 s17, s17, s53
    s_add_u32 s17, s17, s38
    s_add_u32 s44, s44, 1
    s_add_u32 s42, s42, 16384
    s_cmp_eq_u32 s42, 49152
    s_cselect_b32 s42, 0, s42
    s_add_u32 m0, m0, 1024
    s_add_u32 s39, s39, 229376
    buffer_load_dwordx4 v2, s[12:15], s39 offen sc1 lds
    s_add_u32 m0, m0, 1024
    s_add_u32 s40, s40, 229376
    buffer_load_dwordx4 v2, s[12:15], s40 offen sc1 lds
    s_add_u32 m0, m0, 1024
    s_add_u32 s39, s39, s37
    buffer_load_dwordx4 v2, s[12:15], s39 offen sc1 lds
    s_add_u32 m0, m0, 1024
    s_add_u32 s40, s40, s37
    buffer_load_dwordx4 v2, s[12:15], s40 offen sc1 lds
    s_add_u32 m0, m0, 1024
    s_add_u32 s39, s39, 229376
    buffer_load_dwordx4 v2, s[12:15], s39 offen sc1 lds
    s_add_u32 m0, m0, 1024
    s_add_u32 s40, s40, 229376
    buffer_load_dwordx4 v2, s[12:15], s40 offen sc1 lds
    s_mov_b32 m0, s19
    s_mov_b32 s39, s16
    s_mov_b32 s40, s17
    s_waitcnt vmcnt(8)
    s_barrier
    buffer_load_dwordx4 v2, s[12:15], s39 offen sc1 lds
    s_add_u32 m0, m0, 1024
    s_nop 0
    buffer_load_dwordx4 v2, s[12:15], s40 offen sc1 lds
    s_add_u32 s43, s43, 1
    s_cmp_lt_u32 s43, 4
    s_cbranch_scc1 ld_50
    s_call_b64 s[76:77], PREP_a_issue_4
    s_add_u32 m0, m0, 1024
    s_add_u32 s39, s39, 229376
    buffer_load_dwordx4 v2, s[12:15], s39 offen sc1 lds
    s_add_u32 m0, m0, 1024
    s_add_u32 s40, s40, 229376
    buffer_load_dwordx4 v2, s[12:15], s40 offen sc1 lds
    s_add_u32 m0, m0, 1024
    s_add_u32 s39, s39, s37
    buffer_load_dwordx4 v2, s[12:15], s39 offen sc1 lds
    s_add_u32 m0, m0, 1024
    s_add_u32 s40, s40, s37
    buffer_load_dwordx4 v2, s[12:15], s40 offen sc1 lds
    s_add_u32 m0, m0, 1024
    s_add_u32 s39, s39, 229376
    buffer_load_dwordx4 v2, s[12:15], s39 offen sc1 lds
    s_add_u32 m0, m0, 1024
    s_add_u32 s40, s40, 229376
    buffer_load_dwordx4 v2, s[12:15], s40 offen sc1 lds
    s_mov_b32 m0, s19
    s_mov_b32 s39, s16
    s_mov_b32 s40, s17
    s_waitcnt vmcnt(8)
    s_barrier
    buffer_load_dwordx4 v2, s[12:15], s39 offen sc1 lds
    s_add_u32 m0, m0, 1024
    s_nop 0
    buffer_load_dwordx4 v2, s[12:15], s40 offen sc1 lds
    s_load_dword s32, s[4:5], s34
    s_call_b64 s[76:77], PREP_a_issue_4
    s_add_u32 m0, m0, 1024
    s_add_u32 s39, s39, 229376
    buffer_load_dwordx4 v2, s[12:15], s39 offen sc1 lds
    s_add_u32 m0, m0, 1024
    s_add_u32 s40, s40, 229376
    buffer_load_dwordx4 v2, s[12:15], s40 offen sc1 lds
    s_add_u32 m0, m0, 1024
    s_add_u32 s39, s39, s37
    buffer_load_dwordx4 v2, s[12:15], s39 offen sc1 lds
    s_add_u32 m0, m0, 1024
    s_add_u32 s40, s40, s37
    buffer_load_dwordx4 v2, s[12:15], s40 offen sc1 lds
    s_add_u32 m0, m0, 1024
    s_add_u32 s39, s39, 229376
    buffer_load_dwordx4 v2, s[12:15], s39 offen sc1 lds
    s_add_u32 m0, m0, 1024
    s_add_u32 s40, s40, 229376
    buffer_load_dwordx4 v2, s[12:15], s40 offen sc1 lds
    s_mov_b32 m0, s19
    s_mov_b32 s39, s16
    s_mov_b32 s40, s17
    s_waitcnt vmcnt(8)
    s_barrier
    buffer_load_dwordx4 v2, s[12:15], s39 offen sc1 lds
    s_add_u32 m0, m0, 1024
    s_nop 0
    buffer_load_dwordx4 v2, s[12:15], s40 offen sc1 lds
    s_add_u32 s54, s52, 16
    s_waitcnt lgkmcnt(0)
    s_cmp_eq_u32 s32, s54
    s_cbranch_scc1 fok_51
    v_mov_b32 v9, s34
    s_mov_b32 s53, 0
    s_add_u32 s54, s52, 16
    s_bfm_b64 exec, 1, 0
poll_52:
    buffer_load_dword v8, v9, s[56:59], 0 offen sc1
    s_waitcnt vmcnt(0)
    v_cmp_eq_u32 vcc, s54, v8
    s_nop 0
    s_cmp_eq_u64 vcc, exec
    s_cbranch_scc1 pok_53
    s_sleep 5
    s_add_u32 s53, s53, 1
    s_cmp_lt_u32 s53, s61
    s_cbranch_scc1 poll_52
    s_mov_b32 s61, 0
pok_53:
    s_mov_b64 exec, -1
fok_51:
    s_call_b64 s[76:77], PREP_a_issue_4
    s_add_u32 m0, m0, 1024
    s_add_u32 s39, s39, 229376
    buffer_load_dwordx4 v2, s[12:15], s39 offen sc1 lds
    s_add_u32 m0, m0, 1024
    s_add_u32 s40, s40, 229376
    buffer_load_dwordx4 v2, s[12:15], s40 offen sc1 lds
    s_add_u32 m0, m0, 1024
    s_add_u32 s39, s39, s37
    buffer_load_dwordx4 v2, s[12:15], s39 offen sc1 lds
    s_add_u32 m0, m0, 1024
    s_add_u32 s40, s40, s37
    buffer_load_dwordx4 v2, s[12:15], s40 offen sc1 lds
    s_add_u32 m0, m0, 1024
    s_add_u32 s39, s39, 229376
    buffer_load_dwordx4 v2, s[12:15], s39 offen sc1 lds
    s_add_u32 m0, m0, 1024
    s_add_u32 s40, s40, 229376
    buffer_load_dwordx4 v2, s[12:15], s40 offen sc1 lds
    s_mov_b32 m0, s19
    s_mov_b32 s39, s16
    s_mov_b32 s40, s17
    s_waitcnt vmcnt(8)
    s_barrier
    buffer_load_dwordx4 v2, s[12:15], s39 offen sc1 lds
    s_add_u32 m0, m0, 1024
    s_nop 0
    buffer_load_dwordx4 v2, s[12:15], s40 offen sc1 lds
    s_mov_b32 s43, 1
ld_54:
    s_add_u32 s19, s41, s42
    s_lshl_b32 s45, s44, 1
    s_add_u32 s45, s45, 0
    s_sub_u32 s45, s45, 32
    s_mul_i32 s46, s45, 86
    s_lshr_b32 s46, s46, 8
    s_mul_i32 s47, s46, 3
    s_sub_u32 s47, s45, s47
    s_lshl_b32 s47, s47, 2
    s_lshr_b32 s47, 0x362, s47
    s_and_b32 s47, s47, 7
    s_cmp_ge_u32 s44, 10
    s_cselect_b32 s45, 9, 2
    s_cselect_b32 s51, 1, 0
    s_sub_u32 s45, s44, s45
    s_cmp_lt_u32 s44, 3
    s_cselect_b32 s45, 0, s45
    s_cselect_b32 s51, s44, s51
    s_lshl2_add_u32 s51, 0, s51
    s_cmp_lt_u32 s44, 17
    s_cselect_b32 s47, s51, s47
    s_cselect_b32 s46, s45, s46
    s_add_u32 s46, s46, s33
    s_and_b32 s46, s46, 7
    s_mul_i32 s46, s46, 7
    s_add_u32 s16, s46, s47
    s_lshr_b32 s53, s16, 3
    s_lshl_b32 s53, s53, 14
    s_and_b32 s16, s16, 7
    s_lshl_b32 s16, s16, 10
    s_add_u32 s16, s16, s53
    s_add_u32 s16, s16, s38
    s_lshl_b32 s45, s44, 1
    s_add_u32 s45, s45, 1
    s_sub_u32 s45, s45, 32
    s_mul_i32 s46, s45, 86
    s_lshr_b32 s46, s46, 8
    s_mul_i32 s47, s46, 3
    s_sub_u32 s47, s45, s47
    s_lshl_b32 s47, s47, 2
    s_lshr_b32 s47, 0x362, s47
    s_and_b32 s47, s47, 7
    s_cmp_ge_u32 s44, 10
    s_cselect_b32 s45, 9, 2
    s_cselect_b32 s51, 1, 0
    s_sub_u32 s45, s44, s45
    s_cmp_lt_u32 s44, 3
    s_cselect_b32 s45, 0, s45
    s_cselect_b32 s51, s44, s51
    s_lshl2_add_u32 s51, 1, s51
    s_cmp_lt_u32 s44, 17
    s_cselect_b32 s47, s51, s47
    s_cselect_b32 s46, s45, s46
    s_add_u32 s46, s46, s33
    s_and_b32 s46, s46, 7
    s_mul_i32 s46, s46, 7
    s_add_u32 s17, s46, s47
    s_lshr_b32 s53, s17, 3
    s_lshl_b32 s53, s53, 14
    s_and_b32 s17, s17, 7
    s_lshl_b32 s17, s17, 10
    s_add_u32 s17, s17, s53
    s_add_u32 s17, s17, s38
    s_add_u32 s44, s44, 1
    s_add_u32 s42, s42, 16384
    s_cmp_eq_u32 s42, 49152
    s_cselect_b32 s42, 0, s42
    s_add_u32 m0, m0, 1024
    s_add_u32 s39, s39, 229376
    buffer_load_dwordx4 v2, s[12:15], s39 offen sc1 lds
    s_add_u32 m0, m0, 1024
    s_add_u32 s40, s40, 229376
    buffer_load_dwordx4 v2, s[12:15], s40 offen sc1 lds
    s_add_u32 m0, m0, 1024
    s_add_u32 s39, s39, s37
    buffer_load_dwordx4 v2, s[12:15], s39 offen sc1 lds
    s_add_u32 m0, m0, 1024
    s_add_u32 s40, s40, s37
    buffer_load_dwordx4 v2, s[12:15], s40 offen sc1 lds
    s_add_u32 m0, m0, 1024
    s_add_u32 s39, s39, 229376
    buffer_load_dwordx4 v2, s[12:15], s39 offen sc1 lds
    s_add_u32 m0, m0, 1024
    s_add_u32 s40, s40, 229376
    buffer_load_dwordx4 v2, s[12:15], s40 offen sc1 lds
    s_mov_b32 m0, s19
    s_mov_b32 s39, s16
    s_mov_b32 s40, s17
    s_waitcnt vmcnt(8)
    s_barrier
    buffer_load_dwordx4 v2, s[12:15], s39 offen sc1 lds
    s_add_u32 m0, m0, 1024
    s_nop 0
    buffer_load_dwordx4 v2, s[12:15], s40 offen sc1 lds
    s_add_u32 s43, s43, 1
    s_cmp_lt_u32 s43, 5
    s_cbranch_scc1 ld_54
    s_call_b64 s[76:77], PREP_a_issue_4
    s_add_u32 m0, m0, 1024
    s_add_u32 s39, s39, 229376
    buffer_load_dwordx4 v2, s[12:15], s39 offen sc1 lds
    s_add_u32 m0, m0, 1024
    s_add_u32 s40, s40, 229376
    buffer_load_dwordx4 v2, s[12:15], s40 offen sc1 lds
    s_add_u32 m0, m0, 1024
    s_add_u32 s39, s39, s37
    buffer_load_dwordx4 v2, s[12:15], s39 offen sc1 lds
    s_add_u32 m0, m0, 1024
    s_add_u32 s40, s40, s37
    buffer_load_dwordx4 v2, s[12:15], s40 offen sc1 lds
    s_add_u32 m0, m0, 1024
    s_add_u32 s39, s39, 229376
    buffer_load_dwordx4 v2, s[12:15], s39 offen sc1 lds
    s_add_u32 m0, m0, 1024
    s_add_u32 s40, s40, 229376
    buffer_load_dwordx4 v2, s[12:15], s40 offen sc1 lds
    s_mov_b32 m0, s19
    s_mov_b32 s39, s16
    s_mov_b32 s40, s17
    s_waitcnt vmcnt(8)
    s_barrier
    buffer_load_dwordx4 v2, s[12:15], s39 offen sc1 lds
    s_add_u32 m0, m0, 1024
    s_nop 0
    buffer_load_dwordx4 v2, s[12:15], s40 offen sc1 lds
    s_load_dword s32, s[4:5], s35
    s_call_b64 s[76:77], PREP_a_issue_4
    s_add_u32 m0, m0, 1024
    s_add_u32 s39, s39, 229376
    buffer_load_dwordx4 v2, s[12:15], s39 offen sc1 lds
    s_add_u32 m0, m0, 1024
    s_add_u32 s40, s40, 229376
    buffer_load_dwordx4 v2, s[12:15], s40 offen sc1 lds
    s_add_u32 m0, m0, 1024
    s_add_u32 s39, s39, s37
    buffer_load_dwordx4 v2, s[12:15], s39 offen sc1 lds
    s_add_u32 m0, m0, 1024
    s_add_u32 s40, s40, s37
    buffer_load_dwordx4 v2, s[12:15], s40 offen sc1 lds
    s_add_u32 m0, m0, 1024
    s_add_u32 s39, s39, 229376
    buffer_load_dwordx4 v2, s[12:15], s39 offen sc1 lds
    s_add_u32 m0, m0, 1024
    s_add_u32 s40, s40, 229376
    buffer_load_dwordx4 v2, s[12:15], s40 offen sc1 lds
    s_mov_b32 m0, s19
    s_mov_b32 s39, s16
    s_mov_b32 s40, s17
    s_waitcnt vmcnt(8)
    s_barrier
    buffer_load_dwordx4 v2, s[12:15], s39 offen sc1 lds
    s_add_u32 m0, m0, 1024
    s_nop 0
    buffer_load_dwordx4 v2, s[12:15], s40 offen sc1 lds
    s_add_u32 s54, s52, 16
    s_waitcnt lgkmcnt(0)
    s_cmp_eq_u32 s32, s54
    s_cbranch_scc1 fok_55
    v_mov_b32 v9, s35
    s_mov_b32 s53, 0
    s_add_u32 s54, s52, 16
    s_bfm_b64 exec, 1, 0
poll_56:
    buffer_load_dword v8, v9, s[56:59], 0 offen sc1
    s_waitcnt vmcnt(0)
    v_cmp_eq_u32 vcc, s54, v8
    s_nop 0
    s_cmp_eq_u64 vcc, exec
    s_cbranch_scc1 pok_57
    s_sleep 5
    s_add_u32 s53, s53, 1
    s_cmp_lt_u32 s53, s61
    s_cbranch_scc1 poll_56
    s_mov_b32 s61, 0
pok_57:
    s_mov_b64 exec, -1
fok_55:
    s_call_b64 s[76:77], PREP_a_issue_4
    s_add_u32 m0, m0, 1024
    s_add_u32 s39, s39, 229376
    buffer_load_dwordx4 v2, s[12:15], s39 offen sc1 lds
    s_add_u32 m0, m0, 1024
    s_add_u32 s40, s40, 229376
    buffer_load_dwordx4 v2, s[12:15], s40 offen sc1 lds
    s_add_u32 m0, m0, 1024
    s_add_u32 s39, s39, s37
    buffer_load_dwordx4 v2, s[12:15], s39 offen sc1 lds
    s_add_u32 m0, m0, 1024
    s_add_u32 s40, s40, s37
    buffer_load_dwordx4 v2, s[12:15], s40 offen sc1 lds
    s_add_u32 m0, m0, 1024
    s_add_u32 s39, s39, 229376
    buffer_load_dwordx4 v2, s[12:15], s39 offen sc1 lds
    s_add_u32 m0, m0, 1024
    s_add_u32 s40, s40, 229376
    buffer_load_dwordx4 v2, s[12:15], s40 offen sc1 lds
    s_mov_b32 m0, s19
    s_mov_b32 s39, s16
    s_mov_b32 s40, s17
    s_waitcnt vmcnt(8)
    s_barrier
    buffer_load_dwordx4 v2, s[12:15], s39 offen sc1 lds
    s_add_u32 m0, m0, 1024
    s_nop 0
    buffer_load_dwordx4 v2, s[12:15], s40 offen sc1 lds
    s_mov_b32 s43, 1
ld_58:
    s_add_u32 s19, s41, s42
    s_lshl_b32 s45, s44, 1
    s_add_u32 s45, s45, 0
    s_sub_u32 s45, s45, 32
    s_mul_i32 s46, s45, 86
    s_lshr_b32 s46, s46, 8
    s_mul_i32 s47, s46, 3
    s_sub_u32 s47, s45, s47
    s_lshl_b32 s47, s47, 2
    s_lshr_b32 s47, 0x362, s47
    s_and_b32 s47, s47, 7
    s_cmp_ge_u32 s44, 10
    s_cselect_b32 s45, 9, 2
    s_cselect_b32 s51, 1, 0
    s_sub_u32 s45, s44, s45
    s_cmp_lt_u32 s44, 3
    s_cselect_b32 s45, 0, s45
    s_cselect_b32 s51, s44, s51
    s_lshl2_add_u32 s51, 0, s51
    s_cmp_lt_u32 s44, 17
    s_cselect_b32 s47, s51, s47
    s_cselect_b32 s46, s45, s46
    s_add_u32 s46, s46, s33
    s_and_b32 s46, s46, 7
    s_mul_i32 s46, s46, 7
    s_add_u32 s16, s46, s47
    s_lshr_b32 s53, s16, 3
    s_lshl_b32 s53, s53, 14
    s_and_b32 s16, s16, 7
    s_lshl_b32 s16, s16, 10
    s_add_u32 s16, s16, s53
    s_add_u32 s16, s16, s38
    s_lshl_b32 s45, s44, 1
    s_add_u32 s45, s45, 1
    s_sub_u32 s45, s45, 32
    s_mul_i32 s46, s45, 86
    s_lshr_b32 s46, s46, 8
    s_mul_i32 s47, s46, 3
    s_sub_u32 s47, s45, s47
    s_lshl_b32 s47, s47, 2
    s_lshr_b32 s47, 0x362, s47
    s_and_b32 s47, s47, 7
    s_cmp_ge_u32 s44, 10
    s_cselect_b32 s45, 9, 2
    s_cselect_b32 s51, 1, 0
    s_sub_u32 s45, s44, s45
    s_cmp_lt_u32 s44, 3
    s_cselect_b32 s45, 0, s45
    s_cselect_b32 s51, s44, s51
    s_lshl2_add_u32 s51, 1, s51
    s_cmp_lt_u32 s44, 17
    s_cselect_b32 s47, s51, s47
    s_cselect_b32 s46, s45, s46
    s_add_u32 s46, s46, s33
    s_and_b32 s46, s46, 7
    s_mul_i32 s46, s46, 7
    s_add_u32 s17, s46, s47
    s_lshr_b32 s53, s17, 3
    s_lshl_b32 s53, s53, 14
    s_and_b32 s17, s17, 7
    s_lshl_b32 s17, s17, 10
    s_add_u32 s17, s17, s53
    s_add_u32 s17, s17, s38
    s_add_u32 s44, s44, 1
    s_add_u32 s42, s42, 16384
    s_cmp_eq_u32 s42, 49152
    s_cselect_b32 s42, 0, s42
    s_add_u32 m0, m0, 1024
    s_add_u32 s39, s39, 229376
    buffer_load_dwordx4 v2, s[12:15], s39 offen sc1 lds
    s_add_u32 m0, m0, 1024
    s_add_u32 s40, s40, 229376
    buffer_load_dwordx4 v2, s[12:15], s40 offen sc1 lds
    s_add_u32 m0, m0, 1024
    s_add_u32 s39, s39, s37
    buffer_load_dwordx4 v2, s[12:15], s39 offen sc1 lds
    s_add_u32 m0, m0, 1024
    s_add_u32 s40, s40, s37
    buffer_load_dwordx4 v2, s[12:15], s40 offen sc1 lds
    s_add_u32 m0, m0, 1024
    s_add_u32 s39, s39, 229376
    buffer_load_dwordx4 v2, s[12:15], s39 offen sc1 lds
    s_add_u32 m0, m0, 1024
    s_add_u32 s40, s40, 229376
    buffer_load_dwordx4 v2, s[12:15], s40 offen sc1 lds
    s_mov_b32 m0, s19
    s_mov_b32 s39, s16
    s_mov_b32 s40, s17
    s_waitcnt vmcnt(8)
    s_barrier
    buffer_load_dwordx4 v2, s[12:15], s39 offen sc1 lds
    s_add_u32 m0, m0, 1024
    s_nop 0
    buffer_load_dwordx4 v2, s[12:15], s40 offen sc1 lds
    s_add_u32 s43, s43, 1
    s_cmp_lt_u32 s43, 5
    s_cbranch_scc1 ld_58
    s_call_b64 s[76:77], PREP_a_issue_4
    s_add_u32 m0, m0, 1024
    s_add_u32 s39, s39, 229376
    buffer_load_dwordx4 v2, s[12:15], s39 offen sc1 lds
    s_add_u32 m0, m0, 1024
    s_add_u32 s40, s40, 229376
    buffer_load_dwordx4 v2, s[12:15], s40 offen sc1 lds
    s_add_u32 m0, m0, 1024
    s_add_u32 s39, s39, s37
    buffer_load_dwordx4 v2, s[12:15], s39 offen sc1 lds
    s_add_u32 m0, m0, 1024
    s_add_u32 s40, s40, s37
    buffer_load_dwordx4 v2, s[12:15], s40 offen sc1 lds
    s_add_u32 m0, m0, 1024
    s_add_u32 s39, s39, 229376
    buffer_load_dwordx4 v2, s[12:15], s39 offen sc1 lds
    s_add_u32 m0, m0, 1024
    s_add_u32 s40, s40, 229376
    buffer_load_dwordx4 v2, s[12:15], s40 offen sc1 lds
    s_mov_b32 m0, s19
    s_mov_b32 s39, s16
    s_mov_b32 s40, s17
    s_waitcnt vmcnt(8)
    s_barrier
    s_add_u32 s39, s38, s37
    s_add_u32 s39, s39, 229376
    s_add_u32 m0, s41, 16384
    s_add_u32 s16, s39, s78
    s_add_u32 s17, s39, s79
    buffer_load_dwordx4 v2, s[12:15], s16 offen sc1 lds
    s_add_u32 m0, m0, 1024
    s_nop 0
    buffer_load_dwordx4 v2, s[12:15], s17 offen sc1 lds
    s_add_u32 m0, m0, 1024
    s_add_u32 s16, s16, 229376
    buffer_load_dwordx4 v2, s[12:15], s16 offen sc1 lds
    s_add_u32 m0, m0, 1024
    s_add_u32 s17, s17, 229376
    buffer_load_dwordx4 v2, s[12:15], s17 offen sc1 lds
    s_add_u32 m0, m0, 1024
    s_add_u32 s16, s39, s80
    s_add_u32 s17, s39, s81
    buffer_load_dwordx4 v2, s[12:15], s16 offen sc1 lds
    s_add_u32 m0, m0, 1024
    s_nop 0
    buffer_load_dwordx4 v2, s[12:15], s17 offen sc1 lds
    s_add_u32 m0, m0, 1024
    s_add_u32 s16, s16, 229376
    buffer_load_dwordx4 v2, s[12:15], s16 offen sc1 lds
    s_add_u32 m0, m0, 1024
    s_add_u32 s17, s17, 229376
    buffer_load_dwordx4 v2, s[12:15], s17 offen sc1 lds
    s_waitcnt vmcnt(8)
    s_barrier
    s_add_u32 m0, s41, 32768
    s_add_u32 s16, s39, s82
    s_add_u32 s17, s39, s83
    buffer_load_dwordx4 v2, s[12:15], s16 offen sc1 lds
    s_add_u32 m0, m0, 1024
    s_nop 0
    buffer_load_dwordx4 v2, s[12:15], s17 offen sc1 lds
    s_add_u32 m0, m0, 1024
    s_add_u32 s16, s16, 229376
    buffer_load_dwordx4 v2, s[12:15], s16 offen sc1 lds
    s_add_u32 m0, m0, 1024
    s_add_u32 s17, s17, 229376
    buffer_load_dwordx4 v2, s[12:15], s17 offen sc1 lds
    s_add_u32 m0, m0, 1024
    s_add_u32 s16, s39, s84
    s_add_u32 s17, s39, s85
    buffer_load_dwordx4 v2, s[12:15], s16 offen sc1 lds
    s_add_u32 m0, m0, 1024
    s_nop 0
    buffer_load_dwordx4 v2, s[12:15], s17 offen sc1 lds
    s_add_u32 m0, m0, 1024
    s_add_u32 s16, s16, 229376
    buffer_load_dwordx4 v2, s[12:15], s16 offen sc1 lds
    s_add_u32 m0, m0, 1024
    s_add_u32 s17, s17, 229376
    buffer_load_dwordx4 v2, s[12:15], s17 offen sc1 lds
    s_waitcnt vmcnt(8)
    s_barrier
    s_add_u32 m0, s41, 0
    s_add_u32 s16, s39, s86
    s_add_u32 s17, s39, s87
    buffer_load_dwordx4 v2, s[12:15], s16 offen sc1 lds
    s_add_u32 m0, m0, 1024
    s_nop 0
    buffer_load_dwordx4 v2, s[12:15], s17 offen sc1 lds
    s_add_u32 m0, m0, 1024
    s_add_u32 s16, s16, 229376
    buffer_load_dwordx4 v2, s[12:15], s16 offen sc1 lds
    s_add_u32 m0, m0, 1024
    s_add_u32 s17, s17, 229376
    buffer_load_dwordx4 v2, s[12:15], s17 offen sc1 lds
    s_add_u32 m0, m0, 1024
    s_add_u32 s16, s39, s88
    s_add_u32 s17, s39, s89
    buffer_load_dwordx4 v2, s[12:15], s16 offen sc1 lds
    s_add_u32 m0, m0, 1024
    s_nop 0
    buffer_load_dwordx4 v2, s[12:15], s17 offen sc1 lds
    s_add_u32 m0, m0, 1024
    s_add_u32 s16, s16, 229376
    buffer_load_dwordx4 v2, s[12:15], s16 offen sc1 lds
    s_add_u32 m0, m0, 1024
    s_add_u32 s17, s17, 229376
    buffer_load_dwordx4 v2, s[12:15], s17 offen sc1 lds
    s_cmp_lg_u32 s60, 0
    s_cbranch_scc1 tl_59
    s_call_b64 s[76:77], SUB_w1_piece_23
    s_waitcnt vmcnt(10)
    s_branch tz_60
tl_59:
    s_waitcnt vmcnt(8)
tz_60:
    s_barrier
    s_mov_b32 s39, s38
    s_add_u32 m0, s41, 16384
    s_add_u32 s16, s39, s78
    s_add_u32 s17, s39, s79
    buffer_load_dwordx4 v2, s[12:15], s16 offen sc1 lds
    s_add_u32 m0, m0, 1024
    s_nop 0
    buffer_load_dwordx4 v2, s[12:15], s17 offen sc1 lds
    s_add_u32 m0, m0, 1024
    s_add_u32 s16, s16, 229376
    buffer_load_dwordx4 v2, s[12:15], s16 offen sc1 lds
    s_add_u32 m0, m0, 1024
    s_add_u32 s17, s17, 229376
    buffer_load_dwordx4 v2, s[12:15], s17 offen sc1 lds
    s_add_u32 m0, m0, 1024
    s_add_u32 s16, s39, s80
    s_add_u32 s17, s39, s81
    buffer_load_dwordx4 v2, s[12:15], s16 offen sc1 lds
    s_add_u32 m0, m0, 1024
    s_nop 0
    buffer_load_dwordx4 v2, s[12:15], s17 offen sc1 lds
    s_add_u32 m0, m0, 1024
    s_add_u32 s16, s16, 229376
    buffer_load_dwordx4 v2, s[12:15], s16 offen sc1 lds
    s_add_u32 m0, m0, 1024
    s_add_u32 s17, s17, 229376
    buffer_load_dwordx4 v2, s[12:15], s17 offen sc1 lds
    s_cmp_lg_u32 s60, 0
    s_cbranch_scc1 tl_61
    s_call_b64 s[76:77], SUB_w1_piece_24
    s_waitcnt vmcnt(14)
    s_branch tz_62
tl_61:
    s_waitcnt vmcnt(8)
tz_62:
    s_barrier
    s_add_u32 m0, s41, 32768
    s_add_u32 s16, s39, s82
    s_add_u32 s17, s39, s83
    buffer_load_dwordx4 v2, s[12:15], s16 offen sc1 lds
    s_add_u32 m0, m0, 1024
    s_nop 0
    buffer_load_dwordx4 v2, s[12:15], s17 offen sc1 lds
    s_add_u32 m0, m0, 1024
    s_add_u32 s16, s16, 229376
    buffer_load_dwordx4 v2, s[12:15], s16 offen sc1 lds
    s_add_u32 m0, m0, 1024
    s_add_u32 s17, s17, 229376
    buffer_load_dwordx4 v2, s[12:15], s17 offen sc1 lds
    s_add_u32 m0, m0, 1024
    s_add_u32 s16, s39, s84
    s_add_u32 s17, s39, s85
    buffer_load_dwordx4 v2, s[12:15], s16 offen sc1 lds
    s_add_u32 m0, m0, 1024
    s_nop 0
    buffer_load_dwordx4 v2, s[12:15], s17 offen sc1 lds
    s_add_u32 m0, m0, 1024
    s_add_u32 s16, s16, 229376
    buffer_load_dwordx4 v2, s[12:15], s16 offen sc1 lds
    s_add_u32 m0, m0, 1024
    s_add_u32 s17, s17, 229376
    buffer_load_dwordx4 v2, s[12:15], s17 offen sc1 lds
    s_cmp_lg_u32 s60, 0
    s_cbranch_scc1 tl_63
    s_call_b64 s[76:77], SUB_w1_piece_25
    s_waitcnt vmcnt(16)
    s_branch tz_64
tl_63:
    s_waitcnt vmcnt(8)
tz_64:
    s_barrier
    s_add_u32 m0, s41, 0
    s_add_u32 s16, s39, s86
    s_add_u32 s17, s39, s87
    buffer_load_dwordx4 v2, s[12:15], s16 offen sc1 lds
    s_add_u32 m0, m0, 1024
    s_nop 0
    buffer_load_dwordx4 v2, s[12:15], s17 offen sc1 lds
    s_add_u32 m0, m0, 1024
    s_add_u32 s16, s16, 229376
    buffer_load_dwordx4 v2, s[12:15], s16 offen sc1 lds
    s_add_u32 m0, m0, 1024
    s_add_u32 s17, s17, 229376
    buffer_load_dwordx4 v2, s[12:15], s17 offen sc1 lds
    s_add_u32 m0, m0, 1024
    s_add_u32 s16, s39, s88
    s_add_u32 s17, s39, s89
    buffer_load_dwordx4 v2, s[12:15], s16 offen sc1 lds
    s_add_u32 m0, m0, 1024
    s_nop 0
    buffer_load_dwordx4 v2, s[12:15], s17 offen sc1 lds
    s_add_u32 m0, m0, 1024
    s_add_u32 s16, s16, 229376
    buffer_load_dwordx4 v2, s[12:15], s16 offen sc1 lds
    s_add_u32 m0, m0, 1024
    s_add_u32 s17, s17, 229376
    buffer_load_dwordx4 v2, s[12:15], s17 offen sc1 lds
    s_cmp_lg_u32 s60, 0
    s_cbranch_scc1 tl_65
    s_call_b64 s[76:77], SUB_w1_piece_26
    s_waitcnt vmcnt(18)
    s_branch tz_66
tl_65:
    s_waitcnt vmcnt(8)
tz_66:
    s_barrier
    s_cmp_lg_u32 s60, 0
    s_cbranch_scc1 tl_67
    s_call_b64 s[76:77], SUB_w1_piece_27
    s_waitcnt vmcnt(10)
    s_branch tz_68
tl_67:
    s_waitcnt vmcnt(0)
tz_68:
    s_barrier
    s_cmp_eq_u32 s60, 1
    s_cbranch_scc1 K_fin
    s_branch Y_END
WLOAD:
    s_mov_b64 s[12:13], s[72:73]
    s_mov_b32 s14, 7340032
    s_mov_b32 s15, 0x20000
    s_and_b32 s35, s30, 1
    s_mul_i32 s38, s29, 448
    s_mul_i32 s41, s35, 229376
    s_add_u32 s38, s38, s41
    s_mul_i32 s41, s35, 14336
    s_add_u32 s41, s41, 49152
    s_mov_b32 s42, 0
    s_mov_b32 s44, s29
    s_add_u32 s44, s44, 1
    s_and_b32 s44, s44, 15
    s_add_u32 s44, s44, 1
    s_and_b32 s44, s44, 15
    s_add_u32 s46, s29, 1
    s_and_b32 s46, s46, 15
    s_cmp_eq_u32 s28, s29
    s_cselect_b32 s47, s46, s28
    s_mov_b32 s42, 57344
    s_call_b64 s[76:77], PREP_w_issue_3
    s_mov_b32 m0, s19
    s_mov_b32 s39, s16
    s_waitcnt vmcnt(0)
    s_and_b32 s53, s30, 3
    s_lshl_b32 s53, s53, 7
    s_add_u32 s53, s53, s55
    s_add_u32 s53, s53, 0x400
    v_mov_b32 v14, 1
    v_mov_b32 v15, 0
    s_mov_b64 exec, 1
    buffer_atomic_add v14, v15, s[56:59], s53 offen sc1
    s_mov_b64 exec, -1
    s_call_b64 s[76:77], SUB_rest_2
    s_waitcnt lgkmcnt(0)
    buffer_load_dwordx4 v121, s[12:15], s39 offen  lds
    s_add_u32 m0, m0, 1024
    s_nop 0
    buffer_load_dwordx4 v122, s[12:15], s39 offen  lds
    s_add_u32 m0, m0, 1024
    s_nop 0
    buffer_load_dwordx4 v123, s[12:15], s39 offen  lds
    s_call_b64 s[76:77], PREP_w_issue_3
    s_add_u32 m0, m0, 1024
    s_nop 0
    buffer_load_dwordx4 v124, s[12:15], s39 offen  lds
    s_add_u32 m0, m0, 1024
    s_nop 0
    buffer_load_dwordx4 v125, s[12:15], s39 offen  lds
    s_add_u32 m0, m0, 1024
    s_nop 0
    buffer_load_dwordx4 v126, s[12:15], s39 offen  lds
    s_add_u32 m0, m0, 1024
    s_nop 0
    buffer_load_dwordx4 v127, s[12:15], s39 offen  lds
    s_add_u32 m0, m0, 1024
    s_add_u32 s39, s39, 114688
    buffer_load_dwordx4 v121, s[12:15], s39 offen  lds
    s_add_u32 m0, m0, 1024
    s_nop 0
    buffer_load_dwordx4 v122, s[12:15], s39 offen  lds
    s_add_u32 m0, m0, 1024
    s_nop 0
    buffer_load_dwordx4 v123, s[12:15], s39 offen  lds
    s_add_u32 m0, m0, 1024
    s_nop 0
    buffer_load_dwordx4 v124, s[12:15], s39 offen  lds
    s_add_u32 m0, m0, 1024
    s_nop 0
    buffer_load_dwordx4 v125, s[12:15], s39 offen  lds
    s_add_u32 m0, m0, 1024
    s_nop 0
    buffer_load_dwordx4 v126, s[12:15], s39 offen  lds
    s_add_u32 m0, m0, 1024
    s_nop 0
    buffer_load_dwordx4 v127, s[12:15], s39 offen  lds
    s_mov_b32 m0, s19
    s_mov_b32 s39, s16
    s_cmp_lg_u32 s60, 0
    s_cbranch_scc1 cs_69
    s_and_b32 s35, s30, 1
    v_lshrrev_b32 v112, 2, v1
    v_mul_u32_u24 v104, 448, v112
    v_and_b32 v113, 3, v1
    v_lshl_add_u32 v104, v113, 3, v104
    v_add_u32 v104, 49152, v104
    v_mul_u32_u24 v106, 448, v112
    v_and_b32 v113, 2, v1
    v_lshl_add_u32 v106, v113, 2, v106
    v_bfe_u32 v112, v1, 4, 1
    v_and_b32 v113, 1, v1
    v_lshl_add_u32 v106, v113, 5, v106
    v_xor_b32 v113, s35, v112
    v_lshl_add_u32 v106, v113, 4, v106
    v_add_u32 v106, 49344, v106
    s_lshl_b32 s36, s35, 8
    v_add_u32 v104, s36, v104
    v_lshlrev_b32 v112, 5, v112
    v_sub_u32 v105, v104, v112
    v_add_u32 v104, v104, v112
    s_cmp_eq_u32 s28, s29
    s_cselect_b32 s36, 0, 28672
    v_add_u32 v104, s36, v104
    v_add_u32 v105, s36, v105
    v_add_u32 v106, s36, v106
    ds_read_b64_tr_b16 v[48:49], v104 offset:0
    ds_read_b64_tr_b16 v[50:51], v104 offset:7168
    ds_read_b64_tr_b16 v[52:53], v104 offset:14336
    ds_read_b64_tr_b16 v[54:55], v104 offset:21504
    ds_read_b64_tr_b16 v[56:57], v105 offset:32
    ds_read_b64_tr_b16 v[58:59], v105 offset:7200
    ds_read_b64_tr_b16 v[60:61], v105 offset:14368
    ds_read_b64_tr_b16 v[62:63], v105 offset:21536
    ds_read_b64_tr_b16 v[64:65], v104 offset:64
    ds_read_b64_tr_b16 v[66:67], v104 offset:7232
    ds_read_b64_tr_b16 v[68:69], v104 offset:14400
    ds_read_b64_tr_b16 v[70:71], v104 offset:21568
    ds_read_b64_tr_b16 v[72:73], v105 offset:96
    ds_read_b64_tr_b16 v[74:75], v105 offset:7264
    ds_read_b64_tr_b16 v[76:77], v105 offset:14432
    ds_read_b64_tr_b16 v[78:79], v105 offset:21600
    ds_read_b64_tr_b16 v[80:81], v104 offset:128
    ds_read_b64_tr_b16 v[82:83], v104 offset:7296
    ds_read_b64_tr_b16 v[84:85], v104 offset:14464
    ds_read_b64_tr_b16 v[86:87], v104 offset:21632
    ds_read_b64_tr_b16 v[88:89], v105 offset:160
    ds_read_b64_tr_b16 v[90:91], v105 offset:7328
    ds_read_b64_tr_b16 v[92:93], v105 offset:14496
    ds_read_b64_tr_b16 v[94:95], v105 offset:21664
    ds_read_b64_tr_b16 v[96:97], v106 offset:0
    ds_read_b64_tr_b16 v[98:99], v106 offset:7168
    ds_read_b64_tr_b16 v[100:101], v106 offset:14336
    ds_read_b64_tr_b16 v[102:103], v106 offset:21504
    v_and_b32 v112, 15, v1
    v_mov_b32 v113, 0x3f803f80
    v_cmp_eq_u32 vcc, 0, v112
    s_nop 1
    v_cndmask_b32 v20, 0, v113, vcc
    v_cndmask_b32 v21, 0, v113, vcc
    v_cndmask_b32 v22, 0, v113, vcc
    v_cndmask_b32 v23, 0, v113, vcc
    v_cmp_eq_u32 vcc, 1, v112
    s_nop 1
    v_cndmask_b32 v24, 0, v113, vcc
    v_cndmask_b32 v25, 0, v113, vcc
    v_cndmask_b32 v26, 0, v113, vcc
    v_cndmask_b32 v27, 0, v113, vcc
    v_cmp_eq_u32 vcc, 2, v112
    s_nop 1
    v_cndmask_b32 v28, 0, v113, vcc
    v_cndmask_b32 v29, 0, v113, vcc
    v_cndmask_b32 v30, 0, v113, vcc
    v_cndmask_b32 v31, 0, v113, vcc
    v_cmp_eq_u32 vcc, 3, v112
    s_nop 1
    v_cndmask_b32 v32, 0, v113, vcc
    v_cndmask_b32 v33, 0, v113, vcc
    v_cndmask_b32 v34, 0, v113, vcc
    v_cndmask_b32 v35, 0, v113, vcc
    v_cmp_eq_u32 vcc, 4, v112
    s_nop 1
    v_cndmask_b32 v36, 0, v113, vcc
    v_cndmask_b32 v37, 0, v113, vcc
    v_cndmask_b32 v38, 0, v113, vcc
    v_cndmask_b32 v39, 0, v113, vcc
    v_cmp_eq_u32 vcc, 5, v112
    s_nop 1
    v_cndmask_b32 v40, 0, v113, vcc
    v_cndmask_b32 v41, 0, v113, vcc
    v_cndmask_b32 v42, 0, v113, vcc
    v_cndmask_b32 v43, 0, v113, vcc
    v_cmp_eq_u32 vcc, 6, v112
    s_nop 1
    v_cndmask_b32 v44, 0, v113, vcc
    v_cndmask_b32 v45, 0, v113, vcc
    v_cndmask_b32 v46, 0, v113, vcc
    v_cndmask_b32 v47, 0, v113, vcc
    v_and_b32 v114, 48, v1
    v_lshl_add_u32 v114, v112, 6, v114
    v_mov_b32 v113, 0x7f000000
    v_cmp_gt_u32 vcc, 7, v112
    s_nop 1
    v_cndmask_b32 v114, v113, v114, vcc
    s_add_u32 s20, s4, 0x1420000
    s_addc_u32 s21, s5, 0
    s_mov_b32 s22, 0x38000
    s_mov_b32 s23, 0x20000
    s_mul_i32 s36, s28, 14336
    s_lshl1_add_u32 s35, s29, s35
    s_mul_i32 s35, s35, 448
    s_add_u32 s35, s35, s36
    s_waitcnt lgkmcnt(0)
    v_mfma_f32_16x16x32_bf16 v[108:111], v[48:51], v[20:23], 0
    v_mfma_f32_16x16x32_bf16 v[108:111], v[52:55], v[20:23], v[108:111]
    v_mfma_f32_16x16x32_bf16 v[108:111], v[56:59], v[24:27], v[108:111]
    v_mfma_f32_16x16x32_bf16 v[108:111], v[60:63], v[24:27], v[108:111]
    v_mfma_f32_16x16x32_bf16 v[108:111], v[64:67], v[28:31], v[108:111]
    v_mfma_f32_16x16x32_bf16 v[108:111], v[68:71], v[28:31], v[108:111]
    v_mfma_f32_16x16x32_bf16 v[108:111], v[72:75], v[32:35], v[108:111]
    v_mfma_f32_16x16x32_bf16 v[108:111], v[76:79], v[32:35], v[108:111]
    v_mfma_f32_16x16x32_bf16 v[108:111], v[80:83], v[36:39], v[108:111]
    v_mfma_f32_16x16x32_bf16 v[108:111], v[84:87], v[36:39], v[108:111]
    v_mfma_f32_16x16x32_bf16 v[108:111], v[88:91], v[40:43], v[108:111]
    v_mfma_f32_16x16x32_bf16 v[108:111], v[92:95], v[40:43], v[108:111]
    v_mfma_f32_16x16x32_bf16 v[108:111], v[96:99], v[44:47], v[108:111]
    v_mfma_f32_16x16x32_bf16 v[108:111], v[100:103], v[44:47], v[108:111]
    s_nop 7
    buffer_store_dwordx4 v[108:111], v114, s[20:23], s35 offen sc1
cs_69:
    s_waitcnt vmcnt(15)
    s_barrier
    buffer_load_dwordx4 v121, s[12:15], s39 offen  lds
    s_add_u32 m0, m0, 1024
    s_nop 0
    buffer_load_dwordx4 v122, s[12:15], s39 offen  lds
    s_add_u32 m0, m0, 1024
    s_nop 0
    buffer_load_dwordx4 v123, s[12:15], s39 offen  lds
    s_call_b64 s[76:77], PREP_w_issue_3
    s_add_u32 m0, m0, 1024
    s_nop 0
    buffer_load_dwordx4 v124, s[12:15], s39 offen  lds
    s_add_u32 m0, m0, 1024
    s_nop 0
    buffer_load_dwordx4 v125, s[12:15], s39 offen  lds
    s_add_u32 m0, m0, 1024
    s_nop 0
    buffer_load_dwordx4 v126, s[12:15], s39 offen  lds
    s_add_u32 m0, m0, 1024
    s_nop 0
    buffer_load_dwordx4 v127, s[12:15], s39 offen  lds
    s_add_u32 m0, m0, 1024
    s_add_u32 s39, s39, 114688
    buffer_load_dwordx4 v121, s[12:15], s39 offen  lds
    s_add_u32 m0, m0, 1024
    s_nop 0
    buffer_load_dwordx4 v122, s[12:15], s39 offen  lds
    s_add_u32 m0, m0, 1024
    s_nop 0
    buffer_load_dwordx4 v123, s[12:15], s39 offen  lds
    s_add_u32 m0, m0, 1024
    s_nop 0
    buffer_load_dwordx4 v124, s[12:15], s39 offen  lds
    s_add_u32 m0, m0, 1024
    s_nop 0
    buffer_load_dwordx4 v125, s[12:15], s39 offen  lds
    s_add_u32 m0, m0, 1024
    s_nop 0
    buffer_load_dwordx4 v126, s[12:15], s39 offen  lds
    s_add_u32 m0, m0, 1024
    s_nop 0
    buffer_load_dwordx4 v127, s[12:15], s39 offen  lds
    s_mov_b32 m0, s19
    s_mov_b32 s39, s16
    s_waitcnt vmcnt(14)
    s_barrier
    buffer_load_dwordx4 v121, s[12:15], s39 offen  lds
    s_add_u32 m0, m0, 1024
    s_nop 0
    buffer_load_dwordx4 v122, s[12:15], s39 offen  lds
    s_add_u32 m0, m0, 1024
    s_nop 0
    buffer_load_dwordx4 v123, s[12:15], s39 offen  lds
    s_call_b64 s[76:77], PREP_w_issue_3
    s_add_u32 m0, m0, 1024
    s_nop 0
    buffer_load_dwordx4 v124, s[12:15], s39 offen  lds
    s_add_u32 m0, m0, 1024
    s_nop 0
    buffer_load_dwordx4 v125, s[12:15], s39 offen  lds
    s_add_u32 m0, m0, 1024
    s_nop 0
    buffer_load_dwordx4 v126, s[12:15], s39 offen  lds
    s_add_u32 m0, m0, 1024
    s_nop 0
    buffer_load_dwordx4 v127, s[12:15], s39 offen  lds
    s_add_u32 m0, m0, 1024
    s_add_u32 s39, s39, 114688
    buffer_load_dwordx4 v121, s[12:15], s39 offen  lds
    s_add_u32 m0, m0, 1024
    s_nop 0
    buffer_load_dwordx4 v122, s[12:15], s39 offen  lds
    s_add_u32 m0, m0, 1024
    s_nop 0
    buffer_load_dwordx4 v123, s[12:15], s39 offen  lds
    s_add_u32 m0, m0, 1024
    s_nop 0
    buffer_load_dwordx4 v124, s[12:15], s39 offen  lds
    s_add_u32 m0, m0, 1024
    s_nop 0
    buffer_load_dwordx4 v125, s[12:15], s39 offen  lds
    s_add_u32 m0, m0, 1024
    s_nop 0
    buffer_load_dwordx4 v126, s[12:15], s39 offen  lds
    s_add_u32 m0, m0, 1024
    s_nop 0
    buffer_load_dwordx4 v127, s[12:15], s39 offen  lds
    s_mov_b32 m0, s19
    s_mov_b32 s39, s16
    s_waitcnt vmcnt(14)
    s_barrier
    buffer_load_dwordx4 v121, s[12:15], s39 offen  lds
    s_add_u32 m0, m0, 1024
    s_nop 0
    buffer_load_dwordx4 v122, s[12:15], s39 offen  lds
    s_add_u32 m0, m0, 1024
    s_nop 0
    buffer_load_dwordx4 v123, s[12:15], s39 offen  lds
    s_call_b64 s[76:77], PREP_w_issue_3
    s_add_u32 m0, m0, 1024
    s_nop 0
    buffer_load_dwordx4 v124, s[12:15], s39 offen  lds
    s_add_u32 m0, m0, 1024
    s_nop 0
    buffer_load_dwordx4 v125, s[12:15], s39 offen  lds
    s_add_u32 m0, m0, 1024
    s_nop 0
    buffer_load_dwordx4 v126, s[12:15], s39 offen  lds
    s_add_u32 m0, m0, 1024
    s_nop 0
    buffer_load_dwordx4 v127, s[12:15], s39 offen  lds
    s_add_u32 m0, m0, 1024
    s_add_u32 s39, s39, 114688
    buffer_load_dwordx4 v121, s[12:15], s39 offen  lds
    s_add_u32 m0, m0, 1024
    s_nop 0
    buffer_load_dwordx4 v122, s[12:15], s39 offen  lds
    s_add_u32 m0, m0, 1024
    s_nop 0
    buffer_load_dwordx4 v123, s[12:15], s39 offen  lds
    s_add_u32 m0, m0, 1024
    s_nop 0
    buffer_load_dwordx4 v124, s[12:15], s39 offen  lds
    s_add_u32 m0, m0, 1024
    s_nop 0
    buffer_load_dwordx4 v125, s[12:15], s39 offen  lds
    s_add_u32 m0, m0, 1024
    s_nop 0
    buffer_load_dwordx4 v126, s[12:15], s39 offen  lds
    s_add_u32 m0, m0, 1024
    s_nop 0
    buffer_load_dwordx4 v127, s[12:15], s39 offen  lds
    s_mov_b32 m0, s19
    s_mov_b32 s39, s16
    s_waitcnt vmcnt(28)
    s_cmp_lg_u32 s60, 0
    s_cbranch_scc1 cs_70
    s_and_b32 s36, s30, 1
    s_lshl_b32 s36, s36, 13
    s_lshl_b32 s53, s29, 7
    s_add_u32 s36, s36, s53
    s_add_u32 s36, s36, 23068672
    v_mov_b32 v14, 1
    v_mov_b32 v15, 0
    s_mov_b64 exec, 1
    buffer_atomic_add v14, v15, s[56:59], s36 offen sc1
    s_mov_b64 exec, -1
cs_70:
    s_waitcnt vmcnt(14)
    s_barrier
    buffer_load_dwordx4 v121, s[12:15], s39 offen  lds
    s_add_u32 m0, m0, 1024
    s_nop 0
    buffer_load_dwordx4 v122, s[12:15], s39 offen  lds
    s_add_u32 m0, m0, 1024
    s_nop 0
    buffer_load_dwordx4 v123, s[12:15], s39 offen  lds
    s_mov_b32 s43, 1
ld_71:
    s_add_u32 s19, s41, s42
    s_cmp_eq_u32 s44, s47
    s_cselect_b32 s16, s46, s44
    s_mul_i32 s16, s16, 458752
    s_add_u32 s16, s16, s38
    s_add_u32 s44, s44, 1
    s_and_b32 s44, s44, 15
    s_add_u32 s42, s42, 28672
    s_cmp_eq_u32 s42, 86016
    s_cselect_b32 s42, 0, s42
    s_add_u32 m0, m0, 1024
    s_nop 0
    buffer_load_dwordx4 v124, s[12:15], s39 offen  lds
    s_add_u32 m0, m0, 1024
    s_nop 0
    buffer_load_dwordx4 v125, s[12:15], s39 offen  lds
    s_add_u32 m0, m0, 1024
    s_nop 0
    buffer_load_dwordx4 v126, s[12:15], s39 offen  lds
    s_add_u32 m0, m0, 1024
    s_nop 0
    buffer_load_dwordx4 v127, s[12:15], s39 offen  lds
    s_add_u32 m0, m0, 1024
    s_add_u32 s39, s39, 114688
    buffer_load_dwordx4 v121, s[12:15], s39 offen  lds
    s_add_u32 m0, m0, 1024
    s_nop 0
    buffer_load_dwordx4 v122, s[12:15], s39 offen  lds
    s_add_u32 m0, m0, 1024
    s_nop 0
    buffer_load_dwordx4 v123, s[12:15], s39 offen  lds
    s_add_u32 m0, m0, 1024
    s_nop 0
    buffer_load_dwordx4 v124, s[12:15], s39 offen  lds
    s_add_u32 m0, m0, 1024
    s_nop 0
    buffer_load_dwordx4 v125, s[12:15], s39 offen  lds
    s_add_u32 m0, m0, 1024
    s_nop 0
    buffer_load_dwordx4 v126, s[12:15], s39 offen  lds
    s_add_u32 m0, m0, 1024
    s_nop 0
    buffer_load_dwordx4 v127, s[12:15], s39 offen  lds
    s_mov_b32 m0, s19
    s_mov_b32 s39, s16
    s_waitcnt vmcnt(14)
    s_barrier
    buffer_load_dwordx4 v121, s[12:15], s39 offen  lds
    s_add_u32 m0, m0, 1024
    s_nop 0
    buffer_load_dwordx4 v122, s[12:15], s39 offen  lds
    s_add_u32 m0, m0, 1024
    s_nop 0
    buffer_load_dwordx4 v123, s[12:15], s39 offen  lds
    s_add_u32 s43, s43, 1
    s_cmp_lt_u32 s43, 9
    s_cbranch_scc1 ld_71
    s_call_b64 s[76:77], PREP_w_issue_3
    s_add_u32 m0, m0, 1024
    s_nop 0
    buffer_load_dwordx4 v124, s[12:15], s39 offen  lds
    s_add_u32 m0, m0, 1024
    s_nop 0
    buffer_load_dwordx4 v125, s[12:15], s39 offen  lds
    s_add_u32 m0, m0, 1024
    s_nop 0
    buffer_load_dwordx4 v126, s[12:15], s39 offen  lds
    s_add_u32 m0, m0, 1024
    s_nop 0
    buffer_load_dwordx4 v127, s[12:15], s39 offen  lds
    s_add_u32 m0, m0, 1024
    s_add_u32 s39, s39, 114688
    buffer_load_dwordx4 v121, s[12:15], s39 offen  lds
    s_add_u32 m0, m0, 1024
    s_nop 0
    buffer_load_dwordx4 v122, s[12:15], s39 offen  lds
    s_add_u32 m0, m0, 1024
    s_nop 0
    buffer_load_dwordx4 v123, s[12:15], s39 offen  lds
    s_add_u32 m0, m0, 1024
    s_nop 0
    buffer_load_dwordx4 v124, s[12:15], s39 offen  lds
    s_add_u32 m0, m0, 1024
    s_nop 0
    buffer_load_dwordx4 v125, s[12:15], s39 offen  lds
    s_add_u32 m0, m0, 1024
    s_nop 0
    buffer_load_dwordx4 v126, s[12:15], s39 offen  lds
    s_add_u32 m0, m0, 1024
    s_nop 0
    buffer_load_dwordx4 v127, s[12:15], s39 offen  lds
    s_mov_b32 m0, s19
    s_mov_b32 s39, s16
    s_waitcnt vmcnt(14)
    s_barrier
    buffer_load_dwordx4 v121, s[12:15], s39 offen  lds
    s_add_u32 m0, m0, 1024
    s_nop 0
    buffer_load_dwordx4 v122, s[12:15], s39 offen  lds
    s_add_u32 m0, m0, 1024
    s_nop 0
    buffer_load_dwordx4 v123, s[12:15], s39 offen  lds
    s_add_u32 m0, m0, 1024
    s_nop 0
    buffer_load_dwordx4 v124, s[12:15], s39 offen  lds
    s_add_u32 m0, m0, 1024
    s_nop 0
    buffer_load_dwordx4 v125, s[12:15], s39 offen  lds
    s_add_u32 m0, m0, 1024
    s_nop 0
    buffer_load_dwordx4 v126, s[12:15], s39 offen  lds
    s_add_u32 m0, m0, 1024
    s_nop 0
    buffer_load_dwordx4 v127, s[12:15], s39 offen  lds
    s_add_u32 m0, m0, 1024
    s_add_u32 s39, s39, 114688
    buffer_load_dwordx4 v121, s[12:15], s39 offen  lds
    s_add_u32 m0, m0, 1024
    s_nop 0
    buffer_load_dwordx4 v122, s[12:15], s39 offen  lds
    s_add_u32 m0, m0, 1024
    s_nop 0
    buffer_load_dwordx4 v123, s[12:15], s39 offen  lds
    s_add_u32 m0, m0, 1024
    s_nop 0
    buffer_load_dwordx4 v124, s[12:15], s39 offen  lds
    s_add_u32 m0, m0, 1024
    s_nop 0
    buffer_load_dwordx4 v125, s[12:15], s39 offen  lds
    s_add_u32 m0, m0, 1024
    s_nop 0
    buffer_load_dwordx4 v126, s[12:15], s39 offen  lds
    s_add_u32 m0, m0, 1024
    s_nop 0
    buffer_load_dwordx4 v127, s[12:15], s39 offen  lds
    s_waitcnt vmcnt(14)
    s_barrier
    s_waitcnt vmcnt(0)
    s_barrier
    s_barrier
    s_mov_b64 s[12:13], s[74:75]
    s_mov_b32 s14, 7340032
    s_mov_b32 s15, 0x20000
    s_and_b32 s35, s30, 1
    s_mul_i32 s38, s33, 256
    s_mul_i32 s41, s31, 3670016
    s_add_u32 s38, s38, s41
    s_mul_i32 s41, s35, 8192
    s_add_u32 s41, s41, 49152
    s_mov_b32 s42, 0
    s_mov_b32 s44, 0
    s_mov_b32 s49, s44
    s_and_b32 s43, s28, 0
    s_mul_i32 s43, s43, 6
    s_lshr_b32 s43, s43, 2
    s_mov_b32 s50, 0
wpre_72:
    s_mul_i32 s42, s43, 16384
    s_add_u32 s44, s49, s43
    s_add_u32 s19, s41, s42
    s_and_b32 s40, s30, 1
    s_lshl_b32 s45, s44, 1
    s_add_u32 s45, s45, s40
    s_sub_u32 s45, s45, 32
    s_mul_i32 s46, s45, 86
    s_lshr_b32 s46, s46, 8
    s_mul_i32 s47, s46, 3
    s_sub_u32 s47, s45, s47
    s_lshl_b32 s47, s47, 2
    s_lshr_b32 s47, 0x362, s47
    s_and_b32 s47, s47, 7
    s_cmp_ge_u32 s44, 10
    s_cselect_b32 s45, 9, 2
    s_cselect_b32 s51, 1, 0
    s_sub_u32 s45, s44, s45
    s_cmp_lt_u32 s44, 3
    s_cselect_b32 s45, 0, s45
    s_cselect_b32 s51, s44, s51
    s_lshl2_add_u32 s51, s40, s51
    s_cmp_lt_u32 s44, 17
    s_cselect_b32 s47, s51, s47
    s_cselect_b32 s46, s45, s46
    s_add_u32 s46, s46, s33
    s_and_b32 s46, s46, 7
    s_mul_i32 s46, s46, 7
    s_add_u32 s16, s46, s47
    s_mul_i32 s16, s16, 65536
    s_add_u32 s16, s16, s38
    s_add_u32 s44, s44, 1
    s_add_u32 s42, s42, 16384
    s_cmp_eq_u32 s42, 98304
    s_cselect_b32 s42, 0, s42
    s_mov_b32 m0, s19
    s_mov_b32 s39, s16
    buffer_load_dwordx4 v119, s[12:15], s39 offen  lds
    s_add_u32 m0, m0, 1024
    s_add_u32 s39, s39, 8192
    buffer_load_dwordx4 v120, s[12:15], s39 offen  lds
    s_add_u32 m0, m0, 1024
    s_add_u32 s39, s39, 8192
    buffer_load_dwordx4 v119, s[12:15], s39 offen  lds
    s_add_u32 m0, m0, 1024
    s_add_u32 s39, s39, 8192
    buffer_load_dwordx4 v120, s[12:15], s39 offen  lds
    s_waitcnt vmcnt(8)
    s_add_u32 m0, m0, 1024
    s_add_u32 s39, s39, 8192
    buffer_load_dwordx4 v119, s[12:15], s39 offen  lds
    s_add_u32 m0, m0, 1024
    s_add_u32 s39, s39, 8192
    buffer_load_dwordx4 v120, s[12:15], s39 offen  lds
    s_add_u32 m0, m0, 1024
    s_add_u32 s39, s39, 8192
    buffer_load_dwordx4 v119, s[12:15], s39 offen  lds
    s_add_u32 m0, m0, 1024
    s_add_u32 s39, s39, 8192
    buffer_load_dwordx4 v120, s[12:15], s39 offen  lds
    s_waitcnt vmcnt(8)
    s_add_u32 s43, s43, 1
    s_cmp_eq_u32 s43, 6
    s_cselect_b32 s43, 0, s43
    s_add_u32 s50, s50, 1
    s_cmp_lt_u32 s50, 6
    s_cbranch_scc1 wpre_72
    s_mov_b32 s42, 0
    s_add_u32 s44, s49, 6
    s_mov_b64 s[8:9], s[68:69]
    s_mov_b32 s10, 2097152
    s_mov_b32 s11, 0x20000
    s_and_b32 s3, s30, 3
    s_lshl_b32 s36, s3, 14
    s_lshl_b32 s90, s29, 7
    s_add_u32 s90, s90, s36
    s_xor_b32 s90, s90, 128
    s_lshl_b32 s3, s3, 10
    s_call_b64 s[76:77], PREP_w_issue_4
    s_mov_b32 m0, s19
    s_mov_b32 s39, s16
    s_waitcnt vmcnt(40)
    s_barrier
    s_waitcnt vmcnt(32)
    s_barrier
    buffer_load_dwordx4 v119, s[12:15], s39 offen  lds
    s_add_u32 m0, m0, 1024
    s_add_u32 s39, s39, 8192
    buffer_load_dwordx4 v120, s[12:15], s39 offen  lds
    s_mov_b32 s43, 1
ld_73:
    s_add_u32 s19, s41, s42
    s_and_b32 s40, s30, 1
    s_lshl_b32 s45, s44, 1
    s_add_u32 s45, s45, s40
    s_sub_u32 s45, s45, 32
    s_mul_i32 s46, s45, 86
    s_lshr_b32 s46, s46, 8
    s_mul_i32 s47, s46, 3
    s_sub_u32 s47, s45, s47
    s_lshl_b32 s47, s47, 2
    s_lshr_b32 s47, 0x362, s47
    s_and_b32 s47, s47, 7
    s_cmp_ge_u32 s44, 10
    s_cselect_b32 s45, 9, 2
    s_cselect_b32 s51, 1, 0
    s_sub_u32 s45, s44, s45
    s_cmp_lt_u32 s44, 3
    s_cselect_b32 s45, 0, s45
    s_cselect_b32 s51, s44, s51
    s_lshl2_add_u32 s51, s40, s51
    s_cmp_lt_u32 s44, 17
    s_cselect_b32 s47, s51, s47
    s_cselect_b32 s46, s45, s46
    s_add_u32 s46, s46, s33
    s_and_b32 s46, s46, 7
    s_mul_i32 s46, s46, 7
    s_add_u32 s16, s46, s47
    s_mul_i32 s16, s16, 65536
    s_add_u32 s16, s16, s38
    s_add_u32 s44, s44, 1
    s_add_u32 s42, s42, 16384
    s_cmp_eq_u32 s42, 98304
    s_cselect_b32 s42, 0, s42
    s_add_u32 m0, m0, 1024
    s_add_u32 s39, s39, 8192
    buffer_load_dwordx4 v119, s[12:15], s39 offen  lds
    s_add_u32 m0, m0, 1024
    s_add_u32 s39, s39, 8192
    buffer_load_dwordx4 v120, s[12:15], s39 offen  lds
    s_add_u32 m0, m0, 1024
    s_add_u32 s39, s39, 8192
    buffer_load_dwordx4 v119, s[12:15], s39 offen  lds
    s_add_u32 m0, m0, 1024
    s_add_u32 s39, s39, 8192
    buffer_load_dwordx4 v120, s[12:15], s39 offen  lds
    s_add_u32 m0, m0, 1024
    s_add_u32 s39, s39, 8192
    buffer_load_dwordx4 v119, s[12:15], s39 offen  lds
    s_add_u32 m0, m0, 1024
    s_add_u32 s39, s39, 8192
    buffer_load_dwordx4 v120, s[12:15], s39 offen  lds
    s_mov_b32 m0, s19
    s_mov_b32 s39, s16
    s_waitcnt vmcnt(32)
    s_barrier
    buffer_load_dwordx4 v119, s[12:15], s39 offen  lds
    s_add_u32 m0, m0, 1024
    s_add_u32 s39, s39, 8192
    buffer_load_dwordx4 v120, s[12:15], s39 offen  lds
    s_add_u32 s43, s43, 1
    s_cmp_lt_u32 s43, 20
    s_cbranch_scc1 ld_73
    s_call_b64 s[76:77], PREP_w_issue_4
    s_add_u32 m0, m0, 1024
    s_add_u32 s39, s39, 8192
    buffer_load_dwordx4 v119, s[12:15], s39 offen  lds
    s_add_u32 m0, m0, 1024
    s_add_u32 s39, s39, 8192
    buffer_load_dwordx4 v120, s[12:15], s39 offen  lds
    s_add_u32 m0, m0, 1024
    s_add_u32 s39, s39, 8192
    buffer_load_dwordx4 v119, s[12:15], s39 offen  lds
    s_add_u32 m0, m0, 1024
    s_add_u32 s39, s39, 8192
    buffer_load_dwordx4 v120, s[12:15], s39 offen  lds
    s_add_u32 m0, m0, 1024
    s_add_u32 s39, s39, 8192
    buffer_load_dwordx4 v119, s[12:15], s39 offen  lds
    s_add_u32 m0, m0, 1024
    s_add_u32 s39, s39, 8192
    buffer_load_dwordx4 v120, s[12:15], s39 offen  lds
    s_mov_b32 m0, s19
    s_mov_b32 s39, s16
    s_waitcnt vmcnt(32)
    s_barrier
    buffer_load_dwordx4 v119, s[12:15], s39 offen  lds
    s_add_u32 m0, m0, 1024
    s_add_u32 s39, s39, 8192
    buffer_load_dwordx4 v120, s[12:15], s39 offen  lds
    s_add_u32 m0, m0, 1024
    s_add_u32 s39, s39, 8192
    buffer_load_dwordx4 v119, s[12:15], s39 offen  lds
    s_add_u32 m0, m0, 1024
    s_add_u32 s39, s39, 8192
    buffer_load_dwordx4 v120, s[12:15], s39 offen  lds
    s_add_u32 m0, m0, 1024
    s_add_u32 s39, s39, 8192
    buffer_load_dwordx4 v119, s[12:15], s39 offen  lds
    s_add_u32 m0, m0, 1024
    s_add_u32 s39, s39, 8192
    buffer_load_dwordx4 v120, s[12:15], s39 offen  lds
    s_add_u32 m0, m0, 1024
    s_add_u32 s39, s39, 8192
    buffer_load_dwordx4 v119, s[12:15], s39 offen  lds
    s_add_u32 m0, m0, 1024
    s_add_u32 s39, s39, 8192
    buffer_load_dwordx4 v120, s[12:15], s39 offen  lds
    s_call_b64 s[76:77], PREP_w_issue_4
    s_mov_b32 m0, s19
    s_mov_b32 s39, s16
    s_waitcnt vmcnt(24)
    s_barrier
    buffer_load_dwordx4 v119, s[12:15], s39 offen  lds
    s_add_u32 m0, m0, 1024
    s_add_u32 s39, s39, 8192
    buffer_load_dwordx4 v120, s[12:15], s39 offen  lds
    s_add_u32 m0, m0, 1024
    s_add_u32 s39, s39, 8192
    buffer_load_dwordx4 v119, s[12:15], s39 offen  lds
    s_add_u32 m0, m0, 1024
    s_add_u32 s39, s39, 8192
    buffer_load_dwordx4 v120, s[12:15], s39 offen  lds
    s_add_u32 m0, m0, 1024
    s_add_u32 s39, s39, 8192
    buffer_load_dwordx4 v119, s[12:15], s39 offen  lds
    s_add_u32 m0, m0, 1024
    s_add_u32 s39, s39, 8192
    buffer_load_dwordx4 v120, s[12:15], s39 offen  lds
    s_add_u32 m0, m0, 1024
    s_add_u32 s39, s39, 8192
    buffer_load_dwordx4 v119, s[12:15], s39 offen  lds
    s_add_u32 m0, m0, 1024
    s_add_u32 s39, s39, 8192
    buffer_load_dwordx4 v120, s[12:15], s39 offen  lds
    s_cmp_lg_u32 s60, 0
    s_cbranch_scc1 tl_74
    s_call_b64 s[76:77], SUB_w1_piece_23
    s_waitcnt vmcnt(18)
    s_branch tz_75
tl_74:
    s_waitcnt vmcnt(16)
tz_75:
    s_barrier
    s_cmp_lg_u32 s60, 0
    s_cbranch_scc1 tl_76
    s_call_b64 s[76:77], SUB_w1_piece_24
    s_waitcnt vmcnt(6)
    s_branch tz_77
tl_76:
    s_waitcnt vmcnt(0)
tz_77:
    s_barrier
    s_cmp_lg_u32 s60, 0
    s_cbranch_scc1 tl_78
    s_call_b64 s[76:77], SUB_w1_piece_25
tl_78:
tz_79:
    s_barrier
    s_cmp_lg_u32 s60, 0
    s_cbranch_scc1 tl_80
    s_call_b64 s[76:77], SUB_w1_piece_26
tl_80:
tz_81:
    s_barrier
    s_cmp_lg_u32 s60, 0
    s_cbranch_scc1 tl_82
    s_call_b64 s[76:77], SUB_w1_piece_27
tl_82:
tz_83:
    s_barrier
    s_cmp_eq_u32 s60, 1
    s_cbranch_scc1 K_fin
    s_branch Y_END
Y_END:
    v_and_b32 v81, 7, v0
    v_lshrrev_b32 v84, 6, v0
    v_lshlrev_b32 v84, 4, v84
    v_bfe_u32 v85, v0, 3, 3
    v_add_u32 v84, v84, v85
    s_lshr_b32 s78, s67, 1
    s_lshl_b32 s78, s78, 16
    s_and_b32 s79, s67, 1
    s_lshl_b32 s79, s79, 7
    s_add_u32 s78, s78, s79
    s_lshr_b32 s79, s30, 1
    s_lshl_b32 s79, s79, 13
    s_add_u32 s78, s78, s79
    v_lshlrev_b32 v78, 8, v84
    v_lshl_add_u32 v78, v81, 4, v78
    v_add_u32 v78, s78, v78
    s_lshl_b32 s78, s28, 7
    s_lshl_b32 s79, s67, 3
    s_add_u32 s78, s78, s79
    v_add_u32 v79, s78, v81
    v_lshlrev_b32 v80, 11, v79
    v_and_b32 v85, 3, v79
    v_lshrrev_b32 v82, 2, v79
    v_lshlrev_b32 v82, 14, v82
    v_lshl_add_u32 v82, v85, 11, v82
    v_lshl_add_u32 v82, v84, 4, v82
    v_lshrrev_b32 v85, 2, v84
    v_lshlrev_b32 v85, 3, v85
    v_and_b32 v84, 3, v84
    v_add_u32 v84, v84, v85
    v_lshl_add_u32 v80, v84, 3, v80
    v_lshlrev_b32 v79, 3, v79
    v_lshl_add_u32 v79, v84, 14, v79
    s_add_u32 s80, s4, 0x1800000
    s_addc_u32 s81, s5, 0
    s_mov_b32 s82, 0x400000
    s_mov_b32 s83, 0x20000
    s_mov_b32 s78, 0
    buffer_load_dwordx2 v[110:111], v79, s[80:83], s78 offen sc1
    s_mov_b32 s78, 65536
    buffer_load_dwordx2 v[112:113], v79, s[80:83], s78 offen sc1
    s_mov_b32 s78, 262144
    buffer_load_dwordx2 v[114:115], v79, s[80:83], s78 offen sc1
    s_mov_b32 s78, 327680
    buffer_load_dwordx2 v[116:117], v79, s[80:83], s78 offen sc1
    s_waitcnt vmcnt(10)
    s_barrier
    s_and_b32 s36, s30, 3
    s_lshl_b32 s36, s36, 10
    v_add_u32 v8, s36, v2
    v_add_u32 v9, 65536, v8
    v_add_u32 v10, 131072, v8
    ds_write_b128 v8, v[12:15] offset:49152
    ds_write_b128 v8, v[16:19] offset:53248
    ds_write_b128 v8, v[20:23] offset:57344
    ds_write_b128 v8, v[24:27] offset:61440
    ds_write_b128 v9, v[28:31] offset:0
    ds_write_b128 v9, v[32:35] offset:4096
    ds_write_b128 v9, v[36:39] offset:8192
    ds_write_b128 v9, v[40:43] offset:12288
    ds_write_b128 v10, v[44:47] offset:0
    ds_write_b128 v10, v[48:51] offset:4096
    ds_write_b128 v10, v[52:55] offset:8192
    ds_write_b128 v10, v[56:59] offset:12288
    ds_write_b128 v8, v[60:63] offset:24576
    ds_write_b128 v8, v[64:67] offset:28672
    s_waitcnt lgkmcnt(0)
NEXT:
    s_setprio 0
    s_add_u32 s60, s60, 1
    s_add_u32 s55, s55, 67108864
    s_add_u32 s62, s62, 67108864
    s_addc_u32 s63, s63, 0
    s_branch LAYER
K_fin:
    s_endpgm
PREP_a_issue_3:
    s_add_u32 s19, s41, s42
    s_cmp_eq_u32 s44, s47
    s_cselect_b32 s16, s46, s44
    s_cmp_eq_u32 s44, s46
    s_cselect_b32 s16, s47, s16
    s_lshr_b32 s45, s16, 2
    s_lshl_b32 s45, s45, 14
    s_and_b32 s16, s16, 3
    s_lshl_b32 s16, s16, 11
    s_add_u32 s16, s16, s45
    s_add_u32 s16, s16, s38
    s_add_u32 s44, s44, 1
    s_and_b32 s44, s44, 15
    s_add_u32 s42, s42, 16384
    s_cmp_eq_u32 s42, 49152
    s_cselect_b32 s42, 0, s42
    s_setpc_b64 s[76:77]
SUB_rest_2:
    v_lshlrev_b32 v108, 16, v20
    v_and_b32 v109, 0xffff0000, v20
    v_lshlrev_b32 v110, 16, v21
    v_and_b32 v111, 0xffff0000, v21
    v_lshlrev_b32 v112, 16, v22
    v_and_b32 v113, 0xffff0000, v22
    v_lshlrev_b32 v114, 16, v23
    v_and_b32 v115, 0xffff0000, v23
    v_pk_add_f32 v[24:25], v[108:109], v[110:111]
    v_pk_mul_f32 v[26:27], v[108:109], v[108:109]
    v_pk_fma_f32 v[26:27], v[110:111], v[110:111], v[26:27]
    v_pk_add_f32 v[24:25], v[24:25], v[112:113]
    v_pk_fma_f32 v[26:27], v[112:113], v[112:113], v[26:27]
    v_pk_add_f32 v[24:25], v[24:25], v[114:115]
    v_pk_fma_f32 v[26:27], v[114:115], v[114:115], v[26:27]
    v_add_f32 v100, v24, v25
    v_add_f32 v101, v26, v27
    v_lshlrev_b32 v108, 16, v28
    v_and_b32 v109, 0xffff0000, v28
    v_lshlrev_b32 v110, 16, v29
    v_and_b32 v111, 0xffff0000, v29
    v_lshlrev_b32 v112, 16, v30
    v_and_b32 v113, 0xffff0000, v30
    v_lshlrev_b32 v114, 16, v31
    v_and_b32 v115, 0xffff0000, v31
    v_pk_add_f32 v[32:33], v[108:109], v[110:111]
    v_pk_mul_f32 v[34:35], v[108:109], v[108:109]
    v_pk_fma_f32 v[34:35], v[110:111], v[110:111], v[34:35]
    v_pk_add_f32 v[32:33], v[32:33], v[112:113]
    v_pk_fma_f32 v[34:35], v[112:113], v[112:113], v[34:35]
    v_pk_add_f32 v[32:33], v[32:33], v[114:115]
    v_pk_fma_f32 v[34:35], v[114:115], v[114:115], v[34:35]
    v_add_f32 v102, v32, v33
    v_add_f32 v103, v34, v35
    v_lshlrev_b32 v108, 16, v36
    v_and_b32 v109, 0xffff0000, v36
    v_lshlrev_b32 v110, 16, v37
    v_and_b32 v111, 0xffff0000, v37
    v_lshlrev_b32 v112, 16, v38
    v_and_b32 v113, 0xffff0000, v38
    v_lshlrev_b32 v114, 16, v39
    v_and_b32 v115, 0xffff0000, v39
    v_pk_add_f32 v[40:41], v[108:109], v[110:111]
    v_pk_mul_f32 v[42:43], v[108:109], v[108:109]
    v_pk_fma_f32 v[42:43], v[110:111], v[110:111], v[42:43]
    v_pk_add_f32 v[40:41], v[40:41], v[112:113]
    v_pk_fma_f32 v[42:43], v[112:113], v[112:113], v[42:43]
    v_pk_add_f32 v[40:41], v[40:41], v[114:115]
    v_pk_fma_f32 v[42:43], v[114:115], v[114:115], v[42:43]
    v_add_f32 v104, v40, v41
    v_add_f32 v105, v42, v43
    v_lshlrev_b32 v108, 16, v44
    v_and_b32 v109, 0xffff0000, v44
    v_lshlrev_b32 v110, 16, v45
    v_and_b32 v111, 0xffff0000, v45
    v_lshlrev_b32 v112, 16, v46
    v_and_b32 v113, 0xffff0000, v46
    v_lshlrev_b32 v114, 16, v47
    v_and_b32 v115, 0xffff0000, v47
    v_pk_add_f32 v[48:49], v[108:109], v[110:111]
    v_pk_mul_f32 v[50:51], v[108:109], v[108:109]
    v_pk_fma_f32 v[50:51], v[110:111], v[110:111], v[50:51]
    v_pk_add_f32 v[48:49], v[48:49], v[112:113]
    v_pk_fma_f32 v[50:51], v[112:113], v[112:113], v[50:51]
    v_pk_add_f32 v[48:49], v[48:49], v[114:115]
    v_pk_fma_f32 v[50:51], v[114:115], v[114:115], v[50:51]
    v_add_f32 v106, v48, v49
    v_add_f32 v107, v50, v51
    s_and_b32 s36, s30, 3
    s_lshl_b32 s36, s36, 10
    s_add_u32 s36, s36, 155648
    v_lshlrev_b32 v6, 3, v1
    v_add_u32 v6, s36, v6
    v_permlane32_swap_b32 v100, v102
    v_permlane32_swap_b32 v104, v106
    v_permlane32_swap_b32 v101, v103
    v_permlane32_swap_b32 v105, v107
    v_pk_add_f32 v[100:101], v[100:101], v[102:103]
    v_pk_add_f32 v[104:105], v[104:105], v[106:107]
    ds_write_b64 v6, v[100:101] offset:0
    ds_write_b64 v6, v[104:105] offset:512
    s_setpc_b64 s[76:77]
PREP_a_issue_4:
    s_add_u32 s19, s41, s42
    s_lshl_b32 s45, s44, 1
    s_add_u32 s45, s45, 0
    s_sub_u32 s45, s45, 32
    s_mul_i32 s46, s45, 86
    s_lshr_b32 s46, s46, 8
    s_mul_i32 s47, s46, 3
    s_sub_u32 s47, s45, s47
    s_lshl_b32 s47, s47, 2
    s_lshr_b32 s47, 0x362, s47
    s_and_b32 s47, s47, 7
    s_cmp_ge_u32 s44, 10
    s_cselect_b32 s45, 9, 2
    s_cselect_b32 s51, 1, 0
    s_sub_u32 s45, s44, s45
    s_cmp_lt_u32 s44, 3
    s_cselect_b32 s45, 0, s45
    s_cselect_b32 s51, s44, s51
    s_lshl2_add_u32 s51, 0, s51
    s_cmp_lt_u32 s44, 17
    s_cselect_b32 s47, s51, s47
    s_cselect_b32 s46, s45, s46
    s_add_u32 s46, s46, s33
    s_and_b32 s46, s46, 7
    s_mul_i32 s46, s46, 7
    s_add_u32 s16, s46, s47
    s_lshr_b32 s53, s16, 3
    s_lshl_b32 s53, s53, 14
    s_and_b32 s16, s16, 7
    s_lshl_b32 s16, s16, 10
    s_add_u32 s16, s16, s53
    s_add_u32 s16, s16, s38
    s_lshl_b32 s45, s44, 1
    s_add_u32 s45, s45, 1
    s_sub_u32 s45, s45, 32
    s_mul_i32 s46, s45, 86
    s_lshr_b32 s46, s46, 8
    s_mul_i32 s47, s46, 3
    s_sub_u32 s47, s45, s47
    s_lshl_b32 s47, s47, 2
    s_lshr_b32 s47, 0x362, s47
    s_and_b32 s47, s47, 7
    s_cmp_ge_u32 s44, 10
    s_cselect_b32 s45, 9, 2
    s_cselect_b32 s51, 1, 0
    s_sub_u32 s45, s44, s45
    s_cmp_lt_u32 s44, 3
    s_cselect_b32 s45, 0, s45
    s_cselect_b32 s51, s44, s51
    s_lshl2_add_u32 s51, 1, s51
    s_cmp_lt_u32 s44, 17
    s_cselect_b32 s47, s51, s47
    s_cselect_b32 s46, s45, s46
    s_add_u32 s46, s46, s33
    s_and_b32 s46, s46, 7
    s_mul_i32 s46, s46, 7
    s_add_u32 s17, s46, s47
    s_lshr_b32 s53, s17, 3
    s_lshl_b32 s53, s53, 14
    s_and_b32 s17, s17, 7
    s_lshl_b32 s17, s17, 10
    s_add_u32 s17, s17, s53
    s_add_u32 s17, s17, s38
    s_add_u32 s44, s44, 1
    s_add_u32 s42, s42, 16384
    s_cmp_eq_u32 s42, 49152
    s_cselect_b32 s42, 0, s42
    s_setpc_b64 s[76:77]
SUB_w1_piece_23:
    s_add_u32 s36, s90, 393216
    buffer_load_dwordx4 v[12:15], v118, s[8:11], s36 offen
    s_add_u32 s36, s36, 65536
    buffer_load_dwordx4 v[16:19], v118, s[8:11], s36 offen
    s_setpc_b64 s[76:77]
SUB_w1_piece_24:
    s_add_u32 s36, s90, 524288
    buffer_load_dwordx4 v[20:23], v118, s[8:11], s36 offen
    s_add_u32 s36, s36, 65536
    buffer_load_dwordx4 v[24:27], v118, s[8:11], s36 offen
    s_add_u32 s36, s90, 655360
    buffer_load_dwordx4 v[28:31], v118, s[8:11], s36 offen
    s_add_u32 s36, s36, 65536
    buffer_load_dwordx4 v[32:35], v118, s[8:11], s36 offen
    s_setpc_b64 s[76:77]
SUB_w1_piece_25:
    s_add_u32 s36, s90, 786432
    buffer_load_dwordx4 v[36:39], v118, s[8:11], s36 offen
    s_add_u32 s36, s36, 65536
    buffer_load_dwordx4 v[40:43], v118, s[8:11], s36 offen
    s_add_u32 s36, s90, 1703936
    buffer_load_dwordx4 v[44:47], v118, s[8:11], s36 offen
    s_add_u32 s36, s36, 65536
    buffer_load_dwordx4 v[48:51], v118, s[8:11], s36 offen
    s_setpc_b64 s[76:77]
SUB_w1_piece_26:
    s_add_u32 s36, s90, 1835008
    buffer_load_dwordx4 v[52:55], v118, s[8:11], s36 offen
    s_add_u32 s36, s36, 65536
    buffer_load_dwordx4 v[56:59], v118, s[8:11], s36 offen
    s_add_u32 s36, s90, 0
    buffer_load_dwordx4 v[60:63], v118, s[8:11], s36 offen
    s_add_u32 s36, s36, 65536
    buffer_load_dwordx4 v[64:67], v118, s[8:11], s36 offen
    s_add_u32 s36, s90, 1966080
    s_add_u32 m0, s3, 147456
    s_nop 0
    buffer_load_dwordx4 v118, s[8:11], s36 offen lds
    s_add_u32 s36, s36, 65536
    s_add_u32 m0, s3, 151552
    s_nop 0
    buffer_load_dwordx4 v118, s[8:11], s36 offen lds
    s_setpc_b64 s[76:77]
SUB_w1_piece_27:
    s_add_u32 s36, s90, 1441792
    s_add_u32 m0, s3, 114688
    s_nop 0
    buffer_load_dwordx4 v118, s[8:11], s36 offen lds
    s_add_u32 s36, s36, 65536
    s_add_u32 m0, s3, 118784
    s_nop 0
    buffer_load_dwordx4 v118, s[8:11], s36 offen lds
    s_add_u32 s36, s90, 1572864
    s_add_u32 m0, s3, 122880
    s_nop 0
    buffer_load_dwordx4 v118, s[8:11], s36 offen lds
    s_add_u32 s36, s36, 65536
    s_add_u32 m0, s3, 126976
    s_nop 0
    buffer_load_dwordx4 v118, s[8:11], s36 offen lds
    s_setpc_b64 s[76:77]
PREP_w_issue_3:
    s_add_u32 s19, s41, s42
    s_cmp_eq_u32 s44, s47
    s_cselect_b32 s16, s46, s44
    s_mul_i32 s16, s16, 458752
    s_add_u32 s16, s16, s38
    s_add_u32 s44, s44, 1
    s_and_b32 s44, s44, 15
    s_add_u32 s42, s42, 28672
    s_cmp_eq_u32 s42, 86016
    s_cselect_b32 s42, 0, s42
    s_setpc_b64 s[76:77]
PREP_w_issue_4:
    s_add_u32 s19, s41, s42
    s_and_b32 s40, s30, 1
    s_lshl_b32 s45, s44, 1
    s_add_u32 s45, s45, s40
    s_sub_u32 s45, s45, 32
    s_mul_i32 s46, s45, 86
    s_lshr_b32 s46, s46, 8
    s_mul_i32 s47, s46, 3
    s_sub_u32 s47, s45, s47
    s_lshl_b32 s47, s47, 2
    s_lshr_b32 s47, 0x362, s47
    s_and_b32 s47, s47, 7
    s_cmp_ge_u32 s44, 10
    s_cselect_b32 s45, 9, 2
    s_cselect_b32 s51, 1, 0
    s_sub_u32 s45, s44, s45
    s_cmp_lt_u32 s44, 3
    s_cselect_b32 s45, 0, s45
    s_cselect_b32 s51, s44, s51
    s_lshl2_add_u32 s51, s40, s51
    s_cmp_lt_u32 s44, 17
    s_cselect_b32 s47, s51, s47
    s_cselect_b32 s46, s45, s46
    s_add_u32 s46, s46, s33
    s_and_b32 s46, s46, 7
    s_mul_i32 s46, s46, 7
    s_add_u32 s16, s46, s47
    s_mul_i32 s16, s16, 65536
    s_add_u32 s16, s16, s38
    s_add_u32 s44, s44, 1
    s_add_u32 s42, s42, 16384
    s_cmp_eq_u32 s42, 98304
    s_cselect_b32 s42, 0, s42
    s_setpc_b64 s[76:77]
K_end:
    s_endpgm
.section .rodata,"a"
.p2align 6
.amdhsa_kernel interleave_layers__ssm_conv_h3__mixer_s_mlp__prompt_kernel
  .amdhsa_next_free_vgpr 256
  .amdhsa_next_free_sgpr 102
  .amdhsa_accum_offset 256
  .amdhsa_group_segment_fixed_size 0
  .amdhsa_kernarg_size 112
  .amdhsa_user_sgpr_count 2
  .amdhsa_user_sgpr_kernarg_segment_ptr 1
  .amdhsa_system_sgpr_workgroup_id_x 1
  .amdhsa_float_denorm_mode_32 3
.end_amdhsa_kernel
```
